```python
import torch

def _softmax(x, axis=-1):
    return torch.softmax(x, dim=axis)

def _gelu(x):
    return torch.nn.functional.gelu(x, approximate='tanh')

def _silu(x):
    return torch.nn.functional.silu(x)

def _sigmoid(x):
    return torch.sigmoid(x)

def _layernorm(x, axis=-1, eps=1e-05):
    m = x.mean(dim=axis, keepdim=True)
    v = x.var(dim=axis, keepdim=True, unbiased=False)
    return (x - m) / torch.sqrt(v + eps)

def _scatter_add(tgt, idx, src, axis=0):
    return tgt.clone().index_add_(axis, idx, src)

def _segment_sum(src, seg, n):
    out = torch.zeros((n,) + src.shape[1:], dtype=src.dtype)
    return out.index_add_(0, seg, src)

def _pad(x, pw):
    flat = tuple((v for pair in reversed(pw) for v in pair))
    return torch.nn.functional.pad(x, flat)
kernel_name = 'adaLN_cond__sliding_local_dilated__glu_gated_glu__prompt'

def setup_inputs():

    _w = lambda a: (lambda t: t.to(torch.bfloat16) if t.is_floating_point() else t)(torch.as_tensor(a))

    def _A_setup():
        B, S, D = (1, 2048, 1024)
        return {'x': _w((lambda *s: torch.randn(*s, dtype=torch.bfloat16) * 0.05)(B, S, D)), 'wqkv': _w((lambda *s: torch.randn(*s, dtype=torch.bfloat16) * 0.05)(D, 3 * D)), 'wo': _w((lambda *s: torch.randn(*s, dtype=torch.bfloat16) * 0.05)(D, D))}
    _A_in = _A_setup()

    def _B_setup():
        B, S, D, F = (1, 2048, 1024, 3584)
        return {'x': _w((lambda *s: torch.randn(*s, dtype=torch.bfloat16) * 0.05)(B, S, D)), 'w_gate': _w((lambda *s: torch.randn(*s, dtype=torch.bfloat16) * 0.05)(D, F)), 'w_up': _w((lambda *s: torch.randn(*s, dtype=torch.bfloat16) * 0.05)(D, F)), 'w_down': _w((lambda *s: torch.randn(*s, dtype=torch.bfloat16) * 0.05)(F, D))}
    _B_in = _B_setup()
    return {'A_x': _A_in['x'], 'A_wqkv': _A_in['wqkv'], 'A_wo': _A_in['wo'], 'B_x': _B_in['x'], 'B_w_gate': _B_in['w_gate'], 'B_w_up': _B_in['w_up'], 'B_w_down': _B_in['w_down'], 'c': _w((lambda *s: torch.randn(*s, dtype=torch.bfloat16) * 0.1)(1, 1024) * 8.0), 'w_mod': _w((lambda *s: torch.randn(*s, dtype=torch.bfloat16) * 0.1)(1024, 6 * 1024) * 1024 ** (-0.5) * 8.0)}

def reference(A_x, A_wqkv, A_wo, B_x, B_w_gate, B_w_up, B_w_down, c, w_mod):

    def _A_ref(x, wqkv, wo):
        B, S, D = x.shape
        H = 32
        Dh = D // H
        W, dil = (8, 2)
        qkv = (lambda x, *d: x.permute(*d))((x @ wqkv).reshape(B, S, 3, H, Dh), 2, 0, 3, 1, 4)
        q, k, v = (qkv[0], qkv[1], qkv[2])
        scale = Dh ** (-0.5)
        pos = torch.arange(S)
        off = torch.arange(W) * dil
        idx = pos[:, None] - off[None, :]
        mask = idx >= 0
        idx_c = torch.where(mask, idx, 0).reshape(-1)
        kg = k[:, :, idx_c, :].reshape(B, H, S, W, Dh)
        vg = v[:, :, idx_c, :].reshape(B, H, S, W, Dh)
        logits = torch.einsum('bhsd,bhswd->bhsw', q, kg) * scale
        logits = torch.where(mask[None, None, :, :], logits, -1000000000.0)
        attn = _softmax(logits, axis=-1)
        o = torch.einsum('bhsw,bhswd->bhsd', attn, vg)
        return (lambda x, *d: x.permute(*d))(o, 0, 2, 1, 3).reshape(B, S, D) @ wo

    def _B_ref(x, w_gate, w_up, w_down):
        g = torch.einsum('bsd,df->bsf', x, w_gate)
        u = torch.einsum('bsd,df->bsf', x, w_up)
        h = _sigmoid(g) * u
        return torch.einsum('bsf,fd->bsd', h, w_down)
    x = A_x
    mod = (_silu(c) @ w_mod).reshape(c.shape[0], 6, 1, -1)
    sa, ca, ga, sb, cb, gb = (mod[:, 0].clone(), mod[:, 1].clone(), mod[:, 2].clone(), mod[:, 3].clone(), mod[:, 4].clone(), mod[:, 5].clone())
    h = _layernorm(x, axis=-1) * (1 + ca) + sa
    x = x + ga * _A_ref(h, A_wqkv, A_wo)
    h = _layernorm(x, axis=-1) * (1 + cb) + sb
    x = x + gb * _B_ref(h, B_w_gate, B_w_up, B_w_down)
    return x
```

```asm
; @launch kernel=k2_kernel grid=(256,1,1) block=(512,1,1) lds=82944
; @launch kernel=k5_kernel grid=(256,1,1) block=(256,1,1) lds=163840
.amdgcn_target "amdgcn-amd-amdhsa--gfx950"
.text
.globl k2_kernel
.p2align 8
.type k2_kernel,@function
k2_kernel:
  s_cmp_ge_u32 s2, 256
  s_cbranch_scc1 L_end_1
  s_load_dwordx4 s[96:99], s[0:1], 0
  s_load_dwordx4 s[92:95], s[0:1], 56
  s_load_dwordx2 s[90:91], s[0:1], 80
  s_load_dwordx2 s[20:21], s[0:1], 88
  s_load_dwordx2 s[26:27], s[0:1], 16
  s_load_dwordx4 s[60:63], s[0:1], 32
  v_lshrrev_b32 v110, 6, v0
  v_and_b32 v104, 63, v0
  s_nop 0
  v_readfirstlane_b32 s3, v110
  v_lshlrev_b32 v119, 4, v104
  v_mov_b32 v100, 0
  v_mov_b32 v128, v0
  s_lshr_b32 s28, s2, 4
  s_lshl_b32 s28, s28, 3
  s_and_b32 s29, s2, 7
  s_add_u32 s28, s28, s29
  s_and_b32 s37, s2, 3
  s_lshl_b32 s37, s37, 6
  s_bitcmp1_b32 s2, 3
  s_cbranch_scc1 L_lnrole_3
  s_lshr_b32 s30, s28, 2
  s_and_b32 s31, s28, 3
  v_lshrrev_b32 v1, 3, v0
  v_lshlrev_b32 v1, 2, v1
  s_lshl_b32 s33, s31, 8
  v_add_u32 v1, s33, v1
  v_lshlrev_b32 v2, 1, v1
  s_movk_i32 s33, 12288
  v_mul_u32_u24 v1, s33, v1
  v_and_b32 v94, 7, v0
  v_lshl_add_u32 v1, v94, 4, v1
  s_lshl_b32 s35, s30, 7
  s_mul_i32 s34, s31, 24576
  s_lshl_b32 s33, s30, 8
  s_add_u32 s34, s34, s33
  v_lshlrev_b32 v95, 2, v104
  v_mov_b32 v96, -1
  s_waitcnt lgkmcnt(0)
  s_mov_b32 s44, s92
  s_mov_b32 s45, s93
  s_mov_b32 s46, 0x800
  s_mov_b32 s47, 0x20000
  s_mov_b32 s48, s94
  s_mov_b32 s49, s95
  s_mov_b32 s50, 0xc00000
  s_mov_b32 s51, 0x20000
  buffer_load_dwordx2 v[4:5], v2, s[44:47], 0 offen
  buffer_load_dwordx4 v[32:35], v1, s[48:51], s35 offen nt
  s_add_u32 s35, s35, 12288
  buffer_load_dwordx4 v[36:39], v1, s[48:51], s35 offen nt
  s_add_u32 s35, s35, 12288
  buffer_load_dwordx4 v[40:43], v1, s[48:51], s35 offen nt
  s_add_u32 s35, s35, 12288
  buffer_load_dwordx4 v[44:47], v1, s[48:51], s35 offen nt
  s_add_u32 s35, s35, 12288
  s_mov_b32 s12, s20
  s_mov_b32 s13, s21
  s_mov_b32 s14, 0x18000
  s_mov_b32 s15, 0x20000
  s_mov_b32 s40, s90
  s_mov_b32 s41, s91
  s_mov_b32 s42, 0x100
  s_mov_b32 s43, 0x20000
  s_add_u32 s64, s20, 0xc0000
  s_addc_u32 s65, s21, 0
  s_mov_b32 s66, 0x20000
  s_mov_b32 s67, 0x20000
  s_cmp_eq_u32 s3, 1
  s_cselect_b32 s14, 98304, 0
  buffer_store_dword v96, v95, s[12:15], s34 offen sc1
  s_mov_b32 s14, 98304
  s_mov_b32 s52, s98
  s_mov_b32 s53, s99
  s_mov_b32 s54, 0x600000
  s_mov_b32 s55, 0x20000
  v_lshrrev_b32 v90, 4, v104
  s_movk_i32 s33, 6144
  v_mul_u32_u24 v90, s33, v90
  v_and_b32 v91, 15, v104
  v_min_u32 v91, 11, v91
  v_and_b32 v92, 3, v91
  v_lshl_add_u32 v90, v92, 7, v90
  v_lshrrev_b32 v91, 2, v91
  v_lshl_add_u32 v90, v91, 11, v90
  s_lshr_b32 s56, s2, 4
  s_lshl_b32 s33, s3, 4
  s_add_u32 s56, s56, s33
  s_mul_i32 s57, s56, 24576
  s_bfe_u32 s33, s2, 0x20001
  s_lshl_b32 s33, s33, 9
  s_add_u32 s57, s57, s33
  s_mov_b32 s32, 0xbfb8aa3b
  s_waitcnt vmcnt(5)
  buffer_load_dword v88, v100, s[40:43], s37 offen sc1
  v_lshlrev_b32 v8, 16, v4
  v_and_b32 v9, 0xffff0000, v4
  v_lshlrev_b32 v10, 16, v5
  v_and_b32 v11, 0xffff0000, v5
  v_mul_f32 v24, s32, v8
  v_mul_f32 v25, s32, v9
  v_mul_f32 v26, s32, v10
  v_mul_f32 v27, s32, v11
  v_exp_f32 v24, v24
  v_exp_f32 v25, v25
  v_exp_f32 v26, v26
  v_exp_f32 v27, v27
  s_nop 0
  v_add_f32 v24, 1.0, v24
  v_add_f32 v25, 1.0, v25
  v_add_f32 v26, 1.0, v26
  v_add_f32 v27, 1.0, v27
  v_rcp_f32 v24, v24
  v_rcp_f32 v25, v25
  v_rcp_f32 v26, v26
  v_rcp_f32 v27, v27
  s_nop 0
  v_mul_f32 v8, v8, v24
  v_mul_f32 v9, v9, v25
  v_mul_f32 v10, v10, v26
  v_mul_f32 v11, v11, v27
  v_cvt_pk_bf16_f32 v24, v8, v9
  v_lshlrev_b32 v8, 16, v24
  v_and_b32 v9, 0xffff0000, v24
  v_cvt_pk_bf16_f32 v25, v10, v11
  v_lshlrev_b32 v10, 16, v25
  v_and_b32 v11, 0xffff0000, v25
  s_waitcnt vmcnt(5)
  v_lshlrev_b32 v24, 16, v32
  v_and_b32 v25, 0xffff0000, v32
  v_lshlrev_b32 v26, 16, v33
  v_and_b32 v27, 0xffff0000, v33
  v_lshlrev_b32 v28, 16, v34
  v_and_b32 v29, 0xffff0000, v34
  v_lshlrev_b32 v30, 16, v35
  v_and_b32 v31, 0xffff0000, v35
  v_mul_f32 v16, v24, v8
  v_mul_f32 v17, v25, v8
  v_mul_f32 v18, v26, v8
  v_mul_f32 v19, v27, v8
  v_mul_f32 v20, v28, v8
  v_mul_f32 v21, v29, v8
  v_mul_f32 v22, v30, v8
  v_mul_f32 v23, v31, v8
  s_waitcnt vmcnt(4)
  v_lshlrev_b32 v24, 16, v36
  v_and_b32 v25, 0xffff0000, v36
  v_lshlrev_b32 v26, 16, v37
  v_and_b32 v27, 0xffff0000, v37
  v_lshlrev_b32 v28, 16, v38
  v_and_b32 v29, 0xffff0000, v38
  v_lshlrev_b32 v30, 16, v39
  v_and_b32 v31, 0xffff0000, v39
  v_fmac_f32 v16, v24, v9
  v_fmac_f32 v17, v25, v9
  v_fmac_f32 v18, v26, v9
  v_fmac_f32 v19, v27, v9
  v_fmac_f32 v20, v28, v9
  v_fmac_f32 v21, v29, v9
  v_fmac_f32 v22, v30, v9
  v_fmac_f32 v23, v31, v9
  s_waitcnt vmcnt(3)
  v_lshlrev_b32 v24, 16, v40
  v_and_b32 v25, 0xffff0000, v40
  v_lshlrev_b32 v26, 16, v41
  v_and_b32 v27, 0xffff0000, v41
  v_lshlrev_b32 v28, 16, v42
  v_and_b32 v29, 0xffff0000, v42
  v_lshlrev_b32 v30, 16, v43
  v_and_b32 v31, 0xffff0000, v43
  v_fmac_f32 v16, v24, v10
  v_fmac_f32 v17, v25, v10
  v_fmac_f32 v18, v26, v10
  v_fmac_f32 v19, v27, v10
  v_fmac_f32 v20, v28, v10
  v_fmac_f32 v21, v29, v10
  v_fmac_f32 v22, v30, v10
  v_fmac_f32 v23, v31, v10
  s_waitcnt vmcnt(2)
  v_lshlrev_b32 v24, 16, v44
  v_and_b32 v25, 0xffff0000, v44
  v_lshlrev_b32 v26, 16, v45
  v_and_b32 v27, 0xffff0000, v45
  v_lshlrev_b32 v28, 16, v46
  v_and_b32 v29, 0xffff0000, v46
  v_lshlrev_b32 v30, 16, v47
  v_and_b32 v31, 0xffff0000, v47
  v_fmac_f32 v16, v24, v11
  v_fmac_f32 v17, v25, v11
  v_fmac_f32 v18, v26, v11
  v_fmac_f32 v19, v27, v11
  v_fmac_f32 v20, v28, v11
  v_fmac_f32 v21, v29, v11
  v_fmac_f32 v22, v30, v11
  v_fmac_f32 v23, v31, v11
  s_nop 1
  v_add_f32_dpp v16, v16, v16 row_ror:8 row_mask:0xf bank_mask:0xf
  v_add_f32_dpp v17, v17, v17 row_ror:8 row_mask:0xf bank_mask:0xf
  v_add_f32_dpp v18, v18, v18 row_ror:8 row_mask:0xf bank_mask:0xf
  v_add_f32_dpp v19, v19, v19 row_ror:8 row_mask:0xf bank_mask:0xf
  v_add_f32_dpp v20, v20, v20 row_ror:8 row_mask:0xf bank_mask:0xf
  v_add_f32_dpp v21, v21, v21 row_ror:8 row_mask:0xf bank_mask:0xf
  v_add_f32_dpp v22, v22, v22 row_ror:8 row_mask:0xf bank_mask:0xf
  v_add_f32_dpp v23, v23, v23 row_ror:8 row_mask:0xf bank_mask:0xf
  v_lshrrev_b32 v93, 4, v0
  v_lshlrev_b32 v93, 8, v93
  v_lshl_add_u32 v93, v94, 5, v93
  ds_write_b128 v93, v[16:19] offset:53248
  ds_write_b128 v93, v[20:23] offset:53264
  s_waitcnt vmcnt(1) lgkmcnt(0)
  s_barrier
  s_cmp_lg_u32 s3, 0
  s_cbranch_scc1 L_pfgo_5
  v_add_u32 v93, 53248, v95
  ds_read2st64_b32 v[32:33], v93 offset0:0 offset1:1
  ds_read2st64_b32 v[34:35], v93 offset0:2 offset1:3
  ds_read2st64_b32 v[36:37], v93 offset0:4 offset1:5
  ds_read2st64_b32 v[38:39], v93 offset0:6 offset1:7
  ds_read2st64_b32 v[40:41], v93 offset0:8 offset1:9
  ds_read2st64_b32 v[42:43], v93 offset0:10 offset1:11
  ds_read2st64_b32 v[44:45], v93 offset0:12 offset1:13
  ds_read2st64_b32 v[46:47], v93 offset0:14 offset1:15
  ds_read2st64_b32 v[48:49], v93 offset0:16 offset1:17
  ds_read2st64_b32 v[50:51], v93 offset0:18 offset1:19
  ds_read2st64_b32 v[52:53], v93 offset0:20 offset1:21
  ds_read2st64_b32 v[54:55], v93 offset0:22 offset1:23
  ds_read2st64_b32 v[56:57], v93 offset0:24 offset1:25
  ds_read2st64_b32 v[58:59], v93 offset0:26 offset1:27
  ds_read2st64_b32 v[60:61], v93 offset0:28 offset1:29
  ds_read2st64_b32 v[62:63], v93 offset0:30 offset1:31
  s_waitcnt lgkmcnt(0)
  v_pk_add_f32 v[32:33], v[32:33], v[48:49]
  v_pk_add_f32 v[34:35], v[34:35], v[50:51]
  v_pk_add_f32 v[36:37], v[36:37], v[52:53]
  v_pk_add_f32 v[38:39], v[38:39], v[54:55]
  v_pk_add_f32 v[40:41], v[40:41], v[56:57]
  v_pk_add_f32 v[42:43], v[42:43], v[58:59]
  v_pk_add_f32 v[44:45], v[44:45], v[60:61]
  v_pk_add_f32 v[46:47], v[46:47], v[62:63]
  v_pk_add_f32 v[32:33], v[32:33], v[40:41]
  v_pk_add_f32 v[34:35], v[34:35], v[42:43]
  v_pk_add_f32 v[36:37], v[36:37], v[44:45]
  v_pk_add_f32 v[38:39], v[38:39], v[46:47]
  v_pk_add_f32 v[32:33], v[32:33], v[36:37]
  v_pk_add_f32 v[34:35], v[34:35], v[38:39]
  v_pk_add_f32 v[32:33], v[32:33], v[34:35]
  v_add_f32 v32, v32, v33
  v_and_b32 v32, -2, v32
  buffer_store_dword v32, v95, s[12:15], s34 offen sc1
L_pfgo_5:
  s_mov_b32 s33, 262144
  s_waitcnt vmcnt(0)
L_nl_6:
  v_readfirstlane_b32 s100, v88
  s_cmp_lg_u32 s100, 0
  s_cbranch_scc1 L_nok_7
  buffer_load_dword v88, v100, s[40:43], s37 offen sc1
  s_sub_u32 s33, s33, 1
  s_waitcnt vmcnt(0)
  s_cmp_lg_u32 s33, 0
  s_cbranch_scc1 L_nl_6
L_nok_7:
  s_cmp_lg_u32 s3, 1
  s_cbranch_scc1 L_notw1_8
  v_mov_b32 v92, s100
  s_add_u32 s33, s28, 1024
  s_lshl_b32 s33, s33, 6
  s_mov_b64 exec, 1
  buffer_store_dword v92, v100, s[64:67], s33 offen sc1
  s_mov_b64 exec, -1
L_notw1_8:
  s_barrier
  s_getpc_b64 s[58:59]
  L_pc_9:
  s_sub_u32 s58, s58, L_pc_9-k2_kernel
  s_subb_u32 s59, s59, 0
  s_lshl_b32 s33, s56, 13
  v_lshlrev_b32 v86, 7, v104
  v_add_u32 v86, s33, v86
  v_min_u32 v86, L_code_end-k2_kernel-4, v86
  v_mov_b32 v87, s59
  v_add_co_u32 v86, vcc, s58, v86
  s_nop 1
  v_addc_co_u32 v87, vcc, 0, v87, vcc
  global_load_dword v113, v[86:87], off
  s_lshl_b32 s35, s30, 8
  s_add_u32 s35, s35, 4096
  buffer_load_dwordx4 v[32:35], v1, s[48:51], s35 offen offset:0 nt
  buffer_load_dwordx4 v[48:51], v1, s[48:51], s35 offen offset:128 nt
  s_add_u32 s35, s35, 12288
  buffer_load_dwordx4 v[36:39], v1, s[48:51], s35 offen offset:0 nt
  buffer_load_dwordx4 v[52:55], v1, s[48:51], s35 offen offset:128 nt
  s_add_u32 s35, s35, 12288
  buffer_load_dwordx4 v[40:43], v1, s[48:51], s35 offen offset:0 nt
  buffer_load_dwordx4 v[56:59], v1, s[48:51], s35 offen offset:128 nt
  s_add_u32 s35, s35, 12288
  buffer_load_dwordx4 v[44:47], v1, s[48:51], s35 offen offset:0 nt
  buffer_load_dwordx4 v[60:63], v1, s[48:51], s35 offen offset:128 nt
  s_add_u32 s35, s35, 12288
  v_lshrrev_b32 v93, 4, v0
  v_lshlrev_b32 v93, 8, v93
  v_lshl_add_u32 v93, v94, 5, v93
  v_add_u32 v93, 63808, v93
  s_waitcnt vmcnt(0)
  v_lshlrev_b32 v24, 16, v32
  v_and_b32 v25, 0xffff0000, v32
  v_lshlrev_b32 v26, 16, v33
  v_and_b32 v27, 0xffff0000, v33
  v_lshlrev_b32 v28, 16, v34
  v_and_b32 v29, 0xffff0000, v34
  v_lshlrev_b32 v30, 16, v35
  v_and_b32 v31, 0xffff0000, v35
  v_mul_f32 v16, v24, v8
  v_mul_f32 v17, v25, v8
  v_mul_f32 v18, v26, v8
  v_mul_f32 v19, v27, v8
  v_mul_f32 v20, v28, v8
  v_mul_f32 v21, v29, v8
  v_mul_f32 v22, v30, v8
  v_mul_f32 v23, v31, v8
  v_lshlrev_b32 v24, 16, v36
  v_and_b32 v25, 0xffff0000, v36
  v_lshlrev_b32 v26, 16, v37
  v_and_b32 v27, 0xffff0000, v37
  v_lshlrev_b32 v28, 16, v38
  v_and_b32 v29, 0xffff0000, v38
  v_lshlrev_b32 v30, 16, v39
  v_and_b32 v31, 0xffff0000, v39
  v_fmac_f32 v16, v24, v9
  v_fmac_f32 v17, v25, v9
  v_fmac_f32 v18, v26, v9
  v_fmac_f32 v19, v27, v9
  v_fmac_f32 v20, v28, v9
  v_fmac_f32 v21, v29, v9
  v_fmac_f32 v22, v30, v9
  v_fmac_f32 v23, v31, v9
  v_lshlrev_b32 v24, 16, v40
  v_and_b32 v25, 0xffff0000, v40
  v_lshlrev_b32 v26, 16, v41
  v_and_b32 v27, 0xffff0000, v41
  v_lshlrev_b32 v28, 16, v42
  v_and_b32 v29, 0xffff0000, v42
  v_lshlrev_b32 v30, 16, v43
  v_and_b32 v31, 0xffff0000, v43
  v_fmac_f32 v16, v24, v10
  v_fmac_f32 v17, v25, v10
  v_fmac_f32 v18, v26, v10
  v_fmac_f32 v19, v27, v10
  v_fmac_f32 v20, v28, v10
  v_fmac_f32 v21, v29, v10
  v_fmac_f32 v22, v30, v10
  v_fmac_f32 v23, v31, v10
  v_lshlrev_b32 v24, 16, v44
  v_and_b32 v25, 0xffff0000, v44
  v_lshlrev_b32 v26, 16, v45
  v_and_b32 v27, 0xffff0000, v45
  v_lshlrev_b32 v28, 16, v46
  v_and_b32 v29, 0xffff0000, v46
  v_lshlrev_b32 v30, 16, v47
  v_and_b32 v31, 0xffff0000, v47
  v_fmac_f32 v16, v24, v11
  v_fmac_f32 v17, v25, v11
  v_fmac_f32 v18, v26, v11
  v_fmac_f32 v19, v27, v11
  v_fmac_f32 v20, v28, v11
  v_fmac_f32 v21, v29, v11
  v_fmac_f32 v22, v30, v11
  v_fmac_f32 v23, v31, v11
  s_nop 1
  v_add_f32_dpp v16, v16, v16 row_ror:8 row_mask:0xf bank_mask:0xf
  v_add_f32_dpp v17, v17, v17 row_ror:8 row_mask:0xf bank_mask:0xf
  v_add_f32_dpp v18, v18, v18 row_ror:8 row_mask:0xf bank_mask:0xf
  v_add_f32_dpp v19, v19, v19 row_ror:8 row_mask:0xf bank_mask:0xf
  v_add_f32_dpp v20, v20, v20 row_ror:8 row_mask:0xf bank_mask:0xf
  v_add_f32_dpp v21, v21, v21 row_ror:8 row_mask:0xf bank_mask:0xf
  v_add_f32_dpp v22, v22, v22 row_ror:8 row_mask:0xf bank_mask:0xf
  v_add_f32_dpp v23, v23, v23 row_ror:8 row_mask:0xf bank_mask:0xf
  ds_write_b128 v93, v[16:19] offset:0
  ds_write_b128 v93, v[20:23] offset:16
  s_nop 1
  v_lshlrev_b32 v24, 16, v48
  v_and_b32 v25, 0xffff0000, v48
  v_lshlrev_b32 v26, 16, v49
  v_and_b32 v27, 0xffff0000, v49
  v_lshlrev_b32 v28, 16, v50
  v_and_b32 v29, 0xffff0000, v50
  v_lshlrev_b32 v30, 16, v51
  v_and_b32 v31, 0xffff0000, v51
  v_mul_f32 v16, v24, v8
  v_mul_f32 v17, v25, v8
  v_mul_f32 v18, v26, v8
  v_mul_f32 v19, v27, v8
  v_mul_f32 v20, v28, v8
  v_mul_f32 v21, v29, v8
  v_mul_f32 v22, v30, v8
  v_mul_f32 v23, v31, v8
  v_lshlrev_b32 v24, 16, v52
  v_and_b32 v25, 0xffff0000, v52
  v_lshlrev_b32 v26, 16, v53
  v_and_b32 v27, 0xffff0000, v53
  v_lshlrev_b32 v28, 16, v54
  v_and_b32 v29, 0xffff0000, v54
  v_lshlrev_b32 v30, 16, v55
  v_and_b32 v31, 0xffff0000, v55
  v_fmac_f32 v16, v24, v9
  v_fmac_f32 v17, v25, v9
  v_fmac_f32 v18, v26, v9
  v_fmac_f32 v19, v27, v9
  v_fmac_f32 v20, v28, v9
  v_fmac_f32 v21, v29, v9
  v_fmac_f32 v22, v30, v9
  v_fmac_f32 v23, v31, v9
  v_lshlrev_b32 v24, 16, v56
  v_and_b32 v25, 0xffff0000, v56
  v_lshlrev_b32 v26, 16, v57
  v_and_b32 v27, 0xffff0000, v57
  v_lshlrev_b32 v28, 16, v58
  v_and_b32 v29, 0xffff0000, v58
  v_lshlrev_b32 v30, 16, v59
  v_and_b32 v31, 0xffff0000, v59
  v_fmac_f32 v16, v24, v10
  v_fmac_f32 v17, v25, v10
  v_fmac_f32 v18, v26, v10
  v_fmac_f32 v19, v27, v10
  v_fmac_f32 v20, v28, v10
  v_fmac_f32 v21, v29, v10
  v_fmac_f32 v22, v30, v10
  v_fmac_f32 v23, v31, v10
  v_lshlrev_b32 v24, 16, v60
  v_and_b32 v25, 0xffff0000, v60
  v_lshlrev_b32 v26, 16, v61
  v_and_b32 v27, 0xffff0000, v61
  v_lshlrev_b32 v28, 16, v62
  v_and_b32 v29, 0xffff0000, v62
  v_lshlrev_b32 v30, 16, v63
  v_and_b32 v31, 0xffff0000, v63
  v_fmac_f32 v16, v24, v11
  v_fmac_f32 v17, v25, v11
  v_fmac_f32 v18, v26, v11
  v_fmac_f32 v19, v27, v11
  v_fmac_f32 v20, v28, v11
  v_fmac_f32 v21, v29, v11
  v_fmac_f32 v22, v30, v11
  v_fmac_f32 v23, v31, v11
  s_nop 1
  v_add_f32_dpp v16, v16, v16 row_ror:8 row_mask:0xf bank_mask:0xf
  v_add_f32_dpp v17, v17, v17 row_ror:8 row_mask:0xf bank_mask:0xf
  v_add_f32_dpp v18, v18, v18 row_ror:8 row_mask:0xf bank_mask:0xf
  v_add_f32_dpp v19, v19, v19 row_ror:8 row_mask:0xf bank_mask:0xf
  v_add_f32_dpp v20, v20, v20 row_ror:8 row_mask:0xf bank_mask:0xf
  v_add_f32_dpp v21, v21, v21 row_ror:8 row_mask:0xf bank_mask:0xf
  v_add_f32_dpp v22, v22, v22 row_ror:8 row_mask:0xf bank_mask:0xf
  v_add_f32_dpp v23, v23, v23 row_ror:8 row_mask:0xf bank_mask:0xf
  ds_write_b128 v93, v[16:19] offset:8192
  ds_write_b128 v93, v[20:23] offset:8208
  s_nop 1
  s_waitcnt lgkmcnt(0)
  s_barrier
  s_cmp_lt_u32 s3, 6
  s_cbranch_scc1 L_g2d_10
  s_and_b32 s33, s3, 1
  s_lshl_b32 s32, s33, 13
  s_add_u32 s32, s32, 63808
  v_add_u32 v93, s32, v95
  ds_read2st64_b32 v[32:33], v93 offset0:0 offset1:1
  ds_read2st64_b32 v[34:35], v93 offset0:2 offset1:3
  ds_read2st64_b32 v[36:37], v93 offset0:4 offset1:5
  ds_read2st64_b32 v[38:39], v93 offset0:6 offset1:7
  ds_read2st64_b32 v[40:41], v93 offset0:8 offset1:9
  ds_read2st64_b32 v[42:43], v93 offset0:10 offset1:11
  ds_read2st64_b32 v[44:45], v93 offset0:12 offset1:13
  ds_read2st64_b32 v[46:47], v93 offset0:14 offset1:15
  ds_read2st64_b32 v[48:49], v93 offset0:16 offset1:17
  ds_read2st64_b32 v[50:51], v93 offset0:18 offset1:19
  ds_read2st64_b32 v[52:53], v93 offset0:20 offset1:21
  ds_read2st64_b32 v[54:55], v93 offset0:22 offset1:23
  ds_read2st64_b32 v[56:57], v93 offset0:24 offset1:25
  ds_read2st64_b32 v[58:59], v93 offset0:26 offset1:27
  ds_read2st64_b32 v[60:61], v93 offset0:28 offset1:29
  ds_read2st64_b32 v[62:63], v93 offset0:30 offset1:31
  s_mul_i32 s34, s31, 24576
  s_lshl_b32 s32, s30, 9
  s_add_u32 s34, s34, s32
  s_lshl_b32 s32, s33, 8
  s_add_u32 s34, s34, s32
  s_add_u32 s34, s34, 8192
  s_waitcnt lgkmcnt(0)
  v_add_f32 v32, v32, v48
  v_add_f32 v33, v33, v49
  v_add_f32 v34, v34, v50
  v_add_f32 v35, v35, v51
  v_add_f32 v36, v36, v52
  v_add_f32 v37, v37, v53
  v_add_f32 v38, v38, v54
  v_add_f32 v39, v39, v55
  v_add_f32 v40, v40, v56
  v_add_f32 v41, v41, v57
  v_add_f32 v42, v42, v58
  v_add_f32 v43, v43, v59
  v_add_f32 v44, v44, v60
  v_add_f32 v45, v45, v61
  v_add_f32 v46, v46, v62
  v_add_f32 v47, v47, v63
  v_add_f32 v32, v32, v40
  v_add_f32 v33, v33, v41
  v_add_f32 v34, v34, v42
  v_add_f32 v35, v35, v43
  v_add_f32 v36, v36, v44
  v_add_f32 v37, v37, v45
  v_add_f32 v38, v38, v46
  v_add_f32 v39, v39, v47
  v_add_f32 v32, v32, v36
  v_add_f32 v33, v33, v37
  v_add_f32 v34, v34, v38
  v_add_f32 v35, v35, v39
  v_add_f32 v32, v32, v34
  v_add_f32 v33, v33, v35
  v_add_f32 v32, v32, v33
  buffer_store_dword v32, v95, s[12:15], s34 offen sc1
L_g2d_10:
  s_and_b32 s32, s2, 7
  s_lshr_b32 s34, s2, 3
  s_and_b32 s30, s32, 1
  s_lshl_b32 s30, s30, 3
  s_and_b32 s31, s34, 7
  s_add_u32 s30, s30, s31
  s_lshr_b32 s31, s32, 1
  s_lshl_b32 s31, s31, 2
  s_lshr_b32 s34, s34, 3
  s_add_u32 s31, s31, s34
  v_lshrrev_b32 v110, 3, v104
  v_and_b32 v111, 6, v110
  v_and_b32 v112, 7, v104
  v_xor_b32 v111, v111, v112
  s_movk_i32 s33, 6144
  v_mul_u32_u24 v110, s33, v110
  v_lshl_add_u32 v110, v111, 4, v110
  s_mul_i32 s32, s3, 49152
  s_lshl_b32 s33, s31, 7
  s_add_u32 s32, s32, s33
  v_add_u32 v107, s32, v110
  v_add_u32 v108, 1024, v107
  v_add_u32 v109, 2048, v107
  s_mul_i32 s38, s3, 3072
  s_lshl_b32 s39, s3, 8
  s_add_u32 s39, s39, 12288
  s_mov_b32 s16, 0
  s_mov_b32 s17, 0
  s_mov_b32 s19, 0
  s_mov_b32 s8, s98
  s_mov_b32 s9, s99
  s_mov_b32 s10, 0x600000
  s_mov_b32 s11, 0x20000
  s_cmp_ge_u32 s3, 4
  s_cbranch_scc1 L_sk_11
  s_add_u32 m0, s38, 0
  s_nop 0
  buffer_load_dwordx4 v107, s[8:11], s17 offen lds
  buffer_load_dwordx4 v108, s[8:11], s17 offen offset:1024 lds
  buffer_load_dwordx4 v109, s[8:11], s17 offen offset:2048 lds
  s_add_u32 s17, s17, 196608
  s_add_u32 m0, s38, 13312
  s_nop 0
  buffer_load_dwordx4 v107, s[8:11], s17 offen lds
  buffer_load_dwordx4 v108, s[8:11], s17 offen offset:1024 lds
  buffer_load_dwordx4 v109, s[8:11], s17 offen offset:2048 lds
  s_add_u32 s17, s17, 196608
  s_add_u32 m0, s38, 26624
  s_nop 0
  buffer_load_dwordx4 v107, s[8:11], s17 offen lds
  buffer_load_dwordx4 v108, s[8:11], s17 offen offset:1024 lds
  buffer_load_dwordx4 v109, s[8:11], s17 offen offset:2048 lds
  s_add_u32 s17, s17, 196608
L_sk_11:
  s_add_u32 s4, s20, 0x100000
  s_addc_u32 s5, s21, 0
  s_mov_b32 s6, 0x400000
  s_mov_b32 s7, 0x20000
  s_lshl_b32 s33, s30, 3
  s_lshl_b32 s35, s3, 1
  s_add_u32 s35, s35, s33
  s_lshl_b32 s35, s35, 3
  s_max_u32 s33, s33, 1
  s_sub_u32 s33, s33, 1
  s_lshl_b32 s33, s33, 3
  v_and_b32 v110, 7, v104
  v_add_u32 v110, s33, v110
  v_add_u32 v129, s35, v104
  v_cmp_lt_u32 vcc, 15, v104
  s_nop 1
  v_cndmask_b32 v129, v129, v110, vcc
  v_and_b32 v131, -8, v129
  v_lshlrev_b32 v129, 6, v129
  v_lshlrev_b32 v131, 6, v131
  s_lshl_b32 s32, s30, 13
  s_lshl_b32 s33, s3, 11
  s_add_u32 s32, s32, s33
  v_add_u32 v105, s32, v119
  s_lshl_b32 s32, s30, 3
  s_max_u32 s32, s32, 1
  s_sub_u32 s32, s32, 1
  s_lshl_b32 s32, s32, 10
  s_lshl_b32 s33, s3, 8
  s_add_u32 s32, s32, s33
  v_lshlrev_b32 v106, 2, v104
  v_add_u32 v106, s32, v106
  v_lshrrev_b32 v110, 5, v104
  v_mul_u32_u24 v110, 3072, v110
  v_bfe_u32 v111, v104, 2, 3
  v_lshl_add_u32 v110, v111, 7, v110
  v_bfe_u32 v111, v104, 3, 2
  v_lshl_add_u32 v110, v111, 5, v110
  v_and_b32 v111, 3, v104
  v_lshl_add_u32 v114, v111, 3, v110
  v_xor_b32 v115, 32, v114
  v_xor_b32 v116, 64, v114
  v_xor_b32 v117, 96, v114
  s_lshl_b32 s33, s3, 5
  v_xor_b32 v118, s33, v114
  v_and_b32 v110, 14, v104
  v_lshrrev_b32 v111, 4, v104
  v_lshlrev_b32 v111, 2, v111
  v_cmp_le_u32 s[44:45], v111, v110
  v_add_u32 v111, 2, v111
  v_cmp_le_u32 s[46:47], v111, v110
  v_and_b32 v110, 1, v104
  v_cmp_eq_u32 s[48:49], 1, v110
  s_branch L_front_4
L_lnrole_3:
  v_bfe_u32 v66, v104, 4, 1
  v_lshlrev_b32 v3, 5, v66
  v_lshrrev_b32 v66, 5, v104
  v_lshl_add_u32 v3, v66, 4, v3
  v_and_b32 v66, 15, v104
  v_lshl_add_u32 v1, v66, 11, v3
  s_lshl_b32 s35, s28, 15
  s_lshl_b32 s30, s3, 8
  s_add_u32 s35, s35, s30
  s_waitcnt lgkmcnt(0)
  s_mov_b32 s12, s96
  s_mov_b32 s13, s97
  s_mov_b32 s14, 0x400000
  s_mov_b32 s15, 0x20000
  buffer_load_dwordx4 v[8:11], v1, s[12:15], s35 offen offset:0
  buffer_load_dwordx4 v[12:15], v1, s[12:15], s35 offen offset:64
  buffer_load_dwordx4 v[16:19], v1, s[12:15], s35 offen offset:128
  buffer_load_dwordx4 v[20:23], v1, s[12:15], s35 offen offset:192
  s_mov_b32 s40, s90
  s_mov_b32 s41, s91
  s_mov_b32 s42, 0x100
  s_mov_b32 s43, 0x20000
  s_lshl_b32 s33, s2, 3
  s_add_u32 s33, s33, s3
  s_cmp_lg_u32 s33, 71
  s_cbranch_scc1 L_nopub_12
  s_add_u32 s64, s20, 0xd2d00
  s_addc_u32 s65, s21, 0
  s_mov_b32 s66, 0x40
  s_mov_b32 s67, 0x20000
  s_load_dword s33, s[64:65], 0 glc
  v_lshlrev_b32 v92, 6, v104
  s_waitcnt lgkmcnt(0)
  s_add_u32 s33, s33, 1
  s_max_u32 s33, s33, 1
  v_mov_b32 v93, s33
  buffer_store_dword v93, v92, s[40:43], 0 offen sc1
  buffer_store_dword v93, v92, s[64:67], 0 offen sc1
L_nopub_12:
  s_add_u32 s64, s20, 0xc0000
  s_addc_u32 s65, s21, 0
  s_mov_b32 s66, 0x20000
  s_mov_b32 s67, 0x20000
  s_mov_b32 s12, s20
  s_mov_b32 s13, s21
  s_mov_b32 s14, 0x18000
  s_mov_b32 s15, 0x20000
  s_add_u32 s4, s20, 0x100000
  s_addc_u32 s5, s21, 0
  s_mov_b32 s6, 0x400000
  s_mov_b32 s7, 0x20000
  s_lshl_b32 s30, s3, 9
  v_lshlrev_b32 v3, 1, v3
  v_add_u32 v3, s30, v3
  v_and_b32 v66, 31, v104
  v_lshlrev_b32 v5, 4, v66
  v_add_u32 v5, s30, v5
  v_lshrrev_b32 v66, 5, v104
  s_movk_i32 s33, 24576
  v_mul_u32_u24 v4, s33, v66
  v_add_u32 v4, v5, v4
  v_and_b32 v6, 7, v104
  v_bfe_u32 v66, v104, 3, 1
  v_lshl_add_u32 v6, v66, 6, v6
  s_lshl_b32 s33, s3, 3
  s_add_u32 s33, s33, 1024
  v_add_u32 v6, s33, v6
  v_lshlrev_b32 v6, 6, v6
  s_mov_b32 s22, 0
  s_mov_b32 s23, 49152
  s_mov_b32 s24, 4096
  s_mov_b32 s25, 53248
  s_lshl_b32 s36, s28, 3
  s_add_u32 s36, s36, s3
  s_lshl_b32 s36, s36, 6
  s_mov_b32 s52, s98
  s_mov_b32 s53, s99
  s_mov_b32 s54, 0x600000
  s_mov_b32 s55, 0x20000
  v_lshrrev_b32 v90, 4, v104
  s_movk_i32 s33, 6144
  v_mul_u32_u24 v90, s33, v90
  v_and_b32 v91, 15, v104
  v_min_u32 v91, 11, v91
  v_and_b32 v92, 3, v91
  v_lshl_add_u32 v90, v92, 7, v90
  v_lshrrev_b32 v91, 2, v91
  v_lshl_add_u32 v90, v91, 11, v90
  s_lshr_b32 s56, s2, 4
  s_lshl_b32 s33, s3, 4
  s_add_u32 s56, s56, s33
  s_mul_i32 s57, s56, 24576
  s_bfe_u32 s33, s2, 0x20001
  s_lshl_b32 s33, s33, 9
  s_add_u32 s57, s57, s33
  s_barrier
  buffer_load_dword v89, v90, s[52:55], s57 offen
  s_add_u32 s57, s57, 3145728
  buffer_load_dword v89, v90, s[52:55], s57 offen
  s_waitcnt vmcnt(2)
  buffer_load_dword v113, v100, s[40:43], s37 offen sc1
  v_lshlrev_b32 v24, 16, v8
  v_and_b32 v25, 0xffff0000, v8
  v_lshlrev_b32 v26, 16, v9
  v_and_b32 v27, 0xffff0000, v9
  v_lshlrev_b32 v28, 16, v10
  v_and_b32 v29, 0xffff0000, v10
  v_lshlrev_b32 v30, 16, v11
  v_and_b32 v31, 0xffff0000, v11
  v_lshlrev_b32 v32, 16, v12
  v_and_b32 v33, 0xffff0000, v12
  v_lshlrev_b32 v34, 16, v13
  v_and_b32 v35, 0xffff0000, v13
  v_lshlrev_b32 v36, 16, v14
  v_and_b32 v37, 0xffff0000, v14
  v_lshlrev_b32 v38, 16, v15
  v_and_b32 v39, 0xffff0000, v15
  v_lshlrev_b32 v40, 16, v16
  v_and_b32 v41, 0xffff0000, v16
  v_lshlrev_b32 v42, 16, v17
  v_and_b32 v43, 0xffff0000, v17
  v_lshlrev_b32 v44, 16, v18
  v_and_b32 v45, 0xffff0000, v18
  v_lshlrev_b32 v46, 16, v19
  v_and_b32 v47, 0xffff0000, v19
  v_lshlrev_b32 v48, 16, v20
  v_and_b32 v49, 0xffff0000, v20
  v_lshlrev_b32 v50, 16, v21
  v_and_b32 v51, 0xffff0000, v21
  v_lshlrev_b32 v52, 16, v22
  v_and_b32 v53, 0xffff0000, v22
  v_lshlrev_b32 v54, 16, v23
  v_and_b32 v55, 0xffff0000, v23
  v_pk_add_f32 v[66:67], v[24:25], v[26:27]
  v_pk_add_f32 v[68:69], v[28:29], v[30:31]
  v_pk_add_f32 v[66:67], v[66:67], v[32:33]
  v_pk_add_f32 v[68:69], v[68:69], v[34:35]
  v_pk_add_f32 v[66:67], v[66:67], v[36:37]
  v_pk_add_f32 v[68:69], v[68:69], v[38:39]
  v_pk_add_f32 v[66:67], v[66:67], v[40:41]
  v_pk_add_f32 v[68:69], v[68:69], v[42:43]
  v_pk_add_f32 v[66:67], v[66:67], v[44:45]
  v_pk_add_f32 v[68:69], v[68:69], v[46:47]
  v_pk_add_f32 v[66:67], v[66:67], v[48:49]
  v_pk_add_f32 v[68:69], v[68:69], v[50:51]
  v_pk_add_f32 v[66:67], v[66:67], v[52:53]
  v_pk_add_f32 v[68:69], v[68:69], v[54:55]
  v_pk_add_f32 v[66:67], v[66:67], v[68:69]
  v_add_f32 v66, v66, v67
  v_mov_b32 v67, v66
  s_nop 1
  v_permlane16_swap_b32 v67, v66
  s_nop 1
  v_add_f32 v66, v66, v67
  v_mov_b32 v67, v66
  s_nop 1
  v_permlane32_swap_b32 v67, v66
  s_nop 1
  v_add_f32 v66, v66, v67
  v_mul_f32 v56, 0x3c000000, v66
  v_mov_b32 v57, v56
  v_pk_add_f32 v[60:61], v[24:25], v[56:57] neg_lo:[0,1] neg_hi:[0,1]
  v_pk_mul_f32 v[66:67], v[60:61], v[60:61]
  v_pk_add_f32 v[62:63], v[26:27], v[56:57] neg_lo:[0,1] neg_hi:[0,1]
  v_pk_mul_f32 v[68:69], v[62:63], v[62:63]
  v_pk_add_f32 v[60:61], v[28:29], v[56:57] neg_lo:[0,1] neg_hi:[0,1]
  v_pk_fma_f32 v[66:67], v[60:61], v[60:61], v[66:67]
  v_pk_add_f32 v[62:63], v[30:31], v[56:57] neg_lo:[0,1] neg_hi:[0,1]
  v_pk_fma_f32 v[68:69], v[62:63], v[62:63], v[68:69]
  v_pk_add_f32 v[60:61], v[32:33], v[56:57] neg_lo:[0,1] neg_hi:[0,1]
  v_pk_fma_f32 v[66:67], v[60:61], v[60:61], v[66:67]
  v_pk_add_f32 v[62:63], v[34:35], v[56:57] neg_lo:[0,1] neg_hi:[0,1]
  v_pk_fma_f32 v[68:69], v[62:63], v[62:63], v[68:69]
  v_pk_add_f32 v[60:61], v[36:37], v[56:57] neg_lo:[0,1] neg_hi:[0,1]
  v_pk_fma_f32 v[66:67], v[60:61], v[60:61], v[66:67]
  v_pk_add_f32 v[62:63], v[38:39], v[56:57] neg_lo:[0,1] neg_hi:[0,1]
  v_pk_fma_f32 v[68:69], v[62:63], v[62:63], v[68:69]
  v_pk_add_f32 v[60:61], v[40:41], v[56:57] neg_lo:[0,1] neg_hi:[0,1]
  v_pk_fma_f32 v[66:67], v[60:61], v[60:61], v[66:67]
  v_pk_add_f32 v[62:63], v[42:43], v[56:57] neg_lo:[0,1] neg_hi:[0,1]
  v_pk_fma_f32 v[68:69], v[62:63], v[62:63], v[68:69]
  v_pk_add_f32 v[60:61], v[44:45], v[56:57] neg_lo:[0,1] neg_hi:[0,1]
  v_pk_fma_f32 v[66:67], v[60:61], v[60:61], v[66:67]
  v_pk_add_f32 v[62:63], v[46:47], v[56:57] neg_lo:[0,1] neg_hi:[0,1]
  v_pk_fma_f32 v[68:69], v[62:63], v[62:63], v[68:69]
  v_pk_add_f32 v[60:61], v[48:49], v[56:57] neg_lo:[0,1] neg_hi:[0,1]
  v_pk_fma_f32 v[66:67], v[60:61], v[60:61], v[66:67]
  v_pk_add_f32 v[62:63], v[50:51], v[56:57] neg_lo:[0,1] neg_hi:[0,1]
  v_pk_fma_f32 v[68:69], v[62:63], v[62:63], v[68:69]
  v_pk_add_f32 v[60:61], v[52:53], v[56:57] neg_lo:[0,1] neg_hi:[0,1]
  v_pk_fma_f32 v[66:67], v[60:61], v[60:61], v[66:67]
  v_pk_add_f32 v[62:63], v[54:55], v[56:57] neg_lo:[0,1] neg_hi:[0,1]
  v_pk_fma_f32 v[68:69], v[62:63], v[62:63], v[68:69]
  v_pk_add_f32 v[66:67], v[66:67], v[68:69]
  v_add_f32 v57, v66, v67
  v_mov_b32 v67, v57
  s_nop 1
  v_permlane16_swap_b32 v67, v57
  s_nop 1
  v_add_f32 v57, v57, v67
  v_mov_b32 v67, v57
  s_nop 1
  v_permlane32_swap_b32 v67, v57
  s_nop 1
  v_add_f32 v57, v57, v67
  v_and_b32 v70, 15, v104
  v_mul_u32_u24 v70, 80, v70
  s_lshl_b32 s30, s3, 3
  v_add_u32 v71, s30, v70
  ds_write_b64 v71, v[56:57] offset:62464
  buffer_load_dword v130, v6, s[64:67], 0 offen sc1
  s_waitcnt lgkmcnt(0)
  s_barrier
  ds_read_b128 v[72:75], v70 offset:62464
  ds_read_b128 v[76:79], v70 offset:62480
  ds_read_b128 v[80:83], v70 offset:62496
  ds_read_b128 v[84:87], v70 offset:62512
  s_waitcnt lgkmcnt(0)
  v_pk_add_f32 v[66:67], v[72:73], v[74:75]
  v_pk_add_f32 v[68:69], v[76:77], v[78:79]
  v_pk_add_f32 v[66:67], v[66:67], v[80:81]
  v_pk_add_f32 v[68:69], v[68:69], v[82:83]
  v_pk_add_f32 v[66:67], v[66:67], v[84:85]
  v_pk_add_f32 v[68:69], v[68:69], v[86:87]
  v_pk_add_f32 v[66:67], v[66:67], v[68:69]
  v_mul_f32 v56, 0x3e000000, v66
  v_sub_f32 v72, v72, v56
  v_sub_f32 v74, v74, v56
  v_sub_f32 v76, v76, v56
  v_sub_f32 v78, v78, v56
  v_sub_f32 v80, v80, v56
  v_sub_f32 v82, v82, v56
  v_sub_f32 v84, v84, v56
  v_sub_f32 v86, v86, v56
  v_mul_f32 v68, v72, v72
  v_fmac_f32 v68, v74, v74
  v_fmac_f32 v68, v76, v76
  v_fmac_f32 v68, v78, v78
  v_fmac_f32 v68, v80, v80
  v_fmac_f32 v68, v82, v82
  v_fmac_f32 v68, v84, v84
  v_fmac_f32 v68, v86, v86
  v_mul_f32 v60, 0x3a800000, v67
  v_fmac_f32 v60, 0x3e000000, v68
  v_cvt_pk_bf16_f32 v64, v56, v60
  v_lshlrev_b32 v56, 16, v64
  v_and_b32 v60, 0xffff0000, v64
  v_add_f32 v60, 0x3727c5ac, v60
  v_cvt_pk_bf16_f32 v64, v60, v61
  v_lshlrev_b32 v60, 16, v64
  v_and_b32 v61, 0xffff0000, v64
  v_sqrt_f32 v60, v60
  s_nop 0
  v_cvt_pk_bf16_f32 v64, v60, v61
  v_lshlrev_b32 v60, 16, v64
  v_and_b32 v61, 0xffff0000, v64
  v_rcp_f32 v60, v60
  v_mov_b32 v57, v56
  s_nop 0
  v_mov_b32 v61, v60
  s_barrier
  v_pk_add_f32 v[24:25], v[24:25], v[56:57] neg_lo:[0,1] neg_hi:[0,1]
  v_pk_add_f32 v[26:27], v[26:27], v[56:57] neg_lo:[0,1] neg_hi:[0,1]
  v_pk_add_f32 v[28:29], v[28:29], v[56:57] neg_lo:[0,1] neg_hi:[0,1]
  v_pk_add_f32 v[30:31], v[30:31], v[56:57] neg_lo:[0,1] neg_hi:[0,1]
  v_pk_add_f32 v[32:33], v[32:33], v[56:57] neg_lo:[0,1] neg_hi:[0,1]
  v_pk_add_f32 v[34:35], v[34:35], v[56:57] neg_lo:[0,1] neg_hi:[0,1]
  v_pk_add_f32 v[36:37], v[36:37], v[56:57] neg_lo:[0,1] neg_hi:[0,1]
  v_pk_add_f32 v[38:39], v[38:39], v[56:57] neg_lo:[0,1] neg_hi:[0,1]
  v_pk_add_f32 v[40:41], v[40:41], v[56:57] neg_lo:[0,1] neg_hi:[0,1]
  v_pk_add_f32 v[42:43], v[42:43], v[56:57] neg_lo:[0,1] neg_hi:[0,1]
  v_pk_add_f32 v[44:45], v[44:45], v[56:57] neg_lo:[0,1] neg_hi:[0,1]
  v_pk_add_f32 v[46:47], v[46:47], v[56:57] neg_lo:[0,1] neg_hi:[0,1]
  v_pk_add_f32 v[48:49], v[48:49], v[56:57] neg_lo:[0,1] neg_hi:[0,1]
  v_pk_add_f32 v[50:51], v[50:51], v[56:57] neg_lo:[0,1] neg_hi:[0,1]
  v_pk_add_f32 v[52:53], v[52:53], v[56:57] neg_lo:[0,1] neg_hi:[0,1]
  v_pk_add_f32 v[54:55], v[54:55], v[56:57] neg_lo:[0,1] neg_hi:[0,1]
  v_pk_mul_f32 v[24:25], v[24:25], v[60:61]
  v_pk_mul_f32 v[26:27], v[26:27], v[60:61]
  v_pk_mul_f32 v[28:29], v[28:29], v[60:61]
  v_pk_mul_f32 v[30:31], v[30:31], v[60:61]
  v_pk_mul_f32 v[32:33], v[32:33], v[60:61]
  v_pk_mul_f32 v[34:35], v[34:35], v[60:61]
  v_pk_mul_f32 v[36:37], v[36:37], v[60:61]
  v_pk_mul_f32 v[38:39], v[38:39], v[60:61]
  v_pk_mul_f32 v[40:41], v[40:41], v[60:61]
  v_pk_mul_f32 v[42:43], v[42:43], v[60:61]
  v_pk_mul_f32 v[44:45], v[44:45], v[60:61]
  v_pk_mul_f32 v[46:47], v[46:47], v[60:61]
  v_pk_mul_f32 v[48:49], v[48:49], v[60:61]
  v_pk_mul_f32 v[50:51], v[50:51], v[60:61]
  v_pk_mul_f32 v[52:53], v[52:53], v[60:61]
  v_pk_mul_f32 v[54:55], v[54:55], v[60:61]
  s_mov_b32 s33, 262144
  s_waitcnt vmcnt(1)
L_nl_13:
  v_readfirstlane_b32 s100, v113
  s_cmp_lg_u32 s100, 0
  s_cbranch_scc1 L_nok_14
  buffer_load_dword v113, v100, s[40:43], s37 offen sc1
  s_sub_u32 s33, s33, 1
  s_waitcnt vmcnt(0)
  s_cmp_lg_u32 s33, 0
  s_cbranch_scc1 L_nl_13
L_nok_14:
  s_and_b32 s32, s2, 7
  s_lshr_b32 s34, s2, 3
  s_and_b32 s30, s32, 1
  s_lshl_b32 s30, s30, 3
  s_and_b32 s31, s34, 7
  s_add_u32 s30, s30, s31
  s_lshr_b32 s31, s32, 1
  s_lshl_b32 s31, s31, 2
  s_lshr_b32 s34, s34, 3
  s_add_u32 s31, s31, s34
  v_lshrrev_b32 v110, 3, v104
  v_and_b32 v111, 6, v110
  v_and_b32 v112, 7, v104
  v_xor_b32 v111, v111, v112
  s_movk_i32 s33, 6144
  v_mul_u32_u24 v110, s33, v110
  v_lshl_add_u32 v110, v111, 4, v110
  s_mul_i32 s32, s3, 49152
  s_lshl_b32 s33, s31, 7
  s_add_u32 s32, s32, s33
  v_add_u32 v107, s32, v110
  v_add_u32 v108, 1024, v107
  v_add_u32 v109, 2048, v107
  s_mul_i32 s38, s3, 3072
  s_lshl_b32 s39, s3, 8
  s_add_u32 s39, s39, 12288
  s_mov_b32 s16, 0
  s_mov_b32 s17, 0
  s_mov_b32 s19, 0
  s_mov_b32 s8, s98
  s_mov_b32 s9, s99
  s_mov_b32 s10, 0x600000
  s_mov_b32 s11, 0x20000
  s_cmp_ge_u32 s3, 4
  s_cbranch_scc1 L_sk_15
  s_add_u32 m0, s38, 0
  s_nop 0
  buffer_load_dwordx4 v107, s[8:11], s17 offen lds
  buffer_load_dwordx4 v108, s[8:11], s17 offen offset:1024 lds
  buffer_load_dwordx4 v109, s[8:11], s17 offen offset:2048 lds
  s_add_u32 s17, s17, 196608
  s_add_u32 m0, s38, 13312
  s_nop 0
  buffer_load_dwordx4 v107, s[8:11], s17 offen lds
  buffer_load_dwordx4 v108, s[8:11], s17 offen offset:1024 lds
  buffer_load_dwordx4 v109, s[8:11], s17 offen offset:2048 lds
  s_add_u32 s17, s17, 196608
  s_add_u32 m0, s38, 26624
  s_nop 0
  buffer_load_dwordx4 v107, s[8:11], s17 offen lds
  buffer_load_dwordx4 v108, s[8:11], s17 offen offset:1024 lds
  buffer_load_dwordx4 v109, s[8:11], s17 offen offset:2048 lds
  s_add_u32 s17, s17, 196608
L_sk_15:
  s_add_u32 s4, s20, 0x100000
  s_addc_u32 s5, s21, 0
  s_mov_b32 s6, 0x400000
  s_mov_b32 s7, 0x20000
  s_lshl_b32 s33, s30, 3
  s_lshl_b32 s35, s3, 1
  s_add_u32 s35, s35, s33
  s_lshl_b32 s35, s35, 3
  s_max_u32 s33, s33, 1
  s_sub_u32 s33, s33, 1
  s_lshl_b32 s33, s33, 3
  v_and_b32 v110, 7, v104
  v_add_u32 v110, s33, v110
  v_add_u32 v129, s35, v104
  v_cmp_lt_u32 vcc, 15, v104
  s_nop 1
  v_cndmask_b32 v129, v129, v110, vcc
  v_and_b32 v131, -8, v129
  v_lshlrev_b32 v129, 6, v129
  v_lshlrev_b32 v131, 6, v131
  s_lshl_b32 s32, s30, 13
  s_lshl_b32 s33, s3, 11
  s_add_u32 s32, s32, s33
  v_add_u32 v105, s32, v119
  s_lshl_b32 s32, s30, 3
  s_max_u32 s32, s32, 1
  s_sub_u32 s32, s32, 1
  s_lshl_b32 s32, s32, 10
  s_lshl_b32 s33, s3, 8
  s_add_u32 s32, s32, s33
  v_lshlrev_b32 v106, 2, v104
  v_add_u32 v106, s32, v106
  v_lshrrev_b32 v110, 5, v104
  v_mul_u32_u24 v110, 3072, v110
  v_bfe_u32 v111, v104, 2, 3
  v_lshl_add_u32 v110, v111, 7, v110
  v_bfe_u32 v111, v104, 3, 2
  v_lshl_add_u32 v110, v111, 5, v110
  v_and_b32 v111, 3, v104
  v_lshl_add_u32 v114, v111, 3, v110
  v_xor_b32 v115, 32, v114
  v_xor_b32 v116, 64, v114
  v_xor_b32 v117, 96, v114
  s_lshl_b32 s33, s3, 5
  v_xor_b32 v118, s33, v114
  v_and_b32 v110, 14, v104
  v_lshrrev_b32 v111, 4, v104
  v_lshlrev_b32 v111, 2, v111
  v_cmp_le_u32 s[44:45], v111, v110
  v_add_u32 v111, 2, v111
  v_cmp_le_u32 s[46:47], v111, v110
  v_and_b32 v110, 1, v104
  v_cmp_eq_u32 s[48:49], 1, v110
  s_mov_b32 s33, 262144
L_cnt_16:
  s_waitcnt vmcnt(0)
  v_cmp_ne_u32 vcc, s100, v130
  s_nop 1
  s_cmp_eq_u64 vcc, 0
  s_cbranch_scc1 L_cok_17
  buffer_load_dword v130, v6, s[64:67], 0 offen sc1
  s_sub_u32 s33, s33, 1
  s_cmp_lg_u32 s33, 0
  s_cbranch_scc1 L_cnt_16
L_cok_17:
  s_mov_b32 s33, 262144
L_mod_18:
  buffer_load_dwordx4 v[72:75], v4, s[12:15], s22 offen sc1
  buffer_load_dwordx4 v[76:79], v4, s[12:15], s23 offen sc1
  buffer_load_dwordx4 v[80:83], v4, s[12:15], s24 offen sc1
  buffer_load_dwordx4 v[84:87], v4, s[12:15], s25 offen sc1
  s_waitcnt vmcnt(3)
  v_max3_u32 v66, v72, v73, v74
  v_max_u32 v66, v66, v75
  s_waitcnt vmcnt(2)
  v_max3_u32 v66, v66, v76, v77
  v_max3_u32 v66, v66, v78, v79
  s_waitcnt vmcnt(1)
  v_max3_u32 v66, v66, v80, v81
  v_max3_u32 v66, v66, v82, v83
  s_waitcnt vmcnt(0)
  v_max3_u32 v66, v66, v84, v85
  v_max3_u32 v66, v66, v86, v87
  v_cmp_eq_u32 vcc, -1, v66
  s_nop 1
  s_cmp_eq_u64 vcc, 0
  s_cbranch_scc1 L_mok_19
  s_sub_u32 s33, s33, 1
  s_cmp_lg_u32 s33, 0
  s_cbranch_scc1 L_mod_18
L_mok_19:
  v_pk_add_f32 v[72:73], v[72:73], v[76:77]
  v_pk_add_f32 v[74:75], v[74:75], v[78:79]
  v_pk_add_f32 v[76:77], v[80:81], v[84:85]
  v_pk_add_f32 v[78:79], v[82:83], v[86:87]
  v_mov_b32 v80, v72
  v_mov_b32 v81, v73
  v_mov_b32 v82, v74
  v_mov_b32 v83, v75
  v_mov_b32 v84, v76
  v_mov_b32 v85, v77
  v_mov_b32 v86, v78
  v_mov_b32 v87, v79
  s_nop 1
  v_permlane32_swap_b32 v80, v72
  v_permlane32_swap_b32 v81, v73
  v_permlane32_swap_b32 v82, v74
  v_permlane32_swap_b32 v83, v75
  v_permlane32_swap_b32 v84, v76
  v_permlane32_swap_b32 v85, v77
  v_permlane32_swap_b32 v86, v78
  v_permlane32_swap_b32 v87, v79
  s_nop 1
  v_add_f32 v72, v72, v80
  v_add_f32 v73, v73, v81
  v_add_f32 v74, v74, v82
  v_add_f32 v75, v75, v83
  v_add_f32 v76, v76, v84
  v_add_f32 v77, v77, v85
  v_add_f32 v78, v78, v86
  v_add_f32 v79, v79, v87
  v_cvt_pk_bf16_f32 v80, v72, v73
  v_lshlrev_b32 v72, 16, v80
  v_and_b32 v73, 0xffff0000, v80
  v_cvt_pk_bf16_f32 v81, v74, v75
  v_lshlrev_b32 v74, 16, v81
  v_and_b32 v75, 0xffff0000, v81
  v_cvt_pk_bf16_f32 v82, v76, v77
  v_lshlrev_b32 v76, 16, v82
  v_and_b32 v77, 0xffff0000, v82
  v_cvt_pk_bf16_f32 v83, v78, v79
  v_lshlrev_b32 v78, 16, v83
  v_and_b32 v79, 0xffff0000, v83
  v_add_f32 v76, 1.0, v76
  v_add_f32 v77, 1.0, v77
  v_add_f32 v78, 1.0, v78
  v_add_f32 v79, 1.0, v79
  v_cvt_pk_bf16_f32 v80, v76, v77
  v_lshlrev_b32 v76, 16, v80
  v_and_b32 v77, 0xffff0000, v80
  v_cvt_pk_bf16_f32 v81, v78, v79
  v_lshlrev_b32 v78, 16, v81
  v_and_b32 v79, 0xffff0000, v81
  ds_write_b128 v5, v[72:75] offset:53248
  ds_write_b128 v5, v[76:79] offset:57344
  ds_read_b128 v[132:135], v3 offset:53248
  ds_read_b128 v[164:167], v3 offset:57344
  ds_read_b128 v[136:139], v3 offset:53264
  ds_read_b128 v[168:171], v3 offset:57360
  ds_read_b128 v[140:143], v3 offset:53376
  ds_read_b128 v[172:175], v3 offset:57472
  ds_read_b128 v[144:147], v3 offset:53392
  ds_read_b128 v[176:179], v3 offset:57488
  ds_read_b128 v[148:151], v3 offset:53504
  ds_read_b128 v[180:183], v3 offset:57600
  ds_read_b128 v[152:155], v3 offset:53520
  ds_read_b128 v[184:187], v3 offset:57616
  ds_read_b128 v[156:159], v3 offset:53632
  ds_read_b128 v[188:191], v3 offset:57728
  ds_read_b128 v[160:163], v3 offset:53648
  ds_read_b128 v[192:195], v3 offset:57744
  s_lshl_b32 s22, s3, 19
  s_lshl_b32 s33, s28, 10
  s_add_u32 s22, s22, s33
  s_add_u32 s23, s22, 131072
  s_add_u32 s24, s22, 262144
  s_add_u32 s25, s22, 393216
  s_waitcnt lgkmcnt(12)
  v_pk_fma_f32 v[24:25], v[24:25], v[164:165], v[132:133]
  v_pk_fma_f32 v[26:27], v[26:27], v[166:167], v[134:135]
  v_pk_fma_f32 v[28:29], v[28:29], v[168:169], v[136:137]
  v_pk_fma_f32 v[30:31], v[30:31], v[170:171], v[138:139]
  v_cvt_pk_bf16_f32 v8, v24, v25
  v_cvt_pk_bf16_f32 v9, v26, v27
  v_cvt_pk_bf16_f32 v10, v28, v29
  v_cvt_pk_bf16_f32 v11, v30, v31
  s_nop 1
  v_permlane16_swap_b32 v8, v10
  v_permlane16_swap_b32 v9, v11
  s_nop 1
  buffer_store_dwordx4 v[8:11], v119, s[4:7], s22 offen sc1
  s_waitcnt lgkmcnt(8)
  v_pk_fma_f32 v[32:33], v[32:33], v[172:173], v[140:141]
  v_pk_fma_f32 v[34:35], v[34:35], v[174:175], v[142:143]
  v_pk_fma_f32 v[36:37], v[36:37], v[176:177], v[144:145]
  v_pk_fma_f32 v[38:39], v[38:39], v[178:179], v[146:147]
  v_cvt_pk_bf16_f32 v12, v32, v33
  v_cvt_pk_bf16_f32 v13, v34, v35
  v_cvt_pk_bf16_f32 v14, v36, v37
  v_cvt_pk_bf16_f32 v15, v38, v39
  s_nop 1
  v_permlane16_swap_b32 v12, v14
  v_permlane16_swap_b32 v13, v15
  s_nop 1
  buffer_store_dwordx4 v[12:15], v119, s[4:7], s23 offen sc1
  s_waitcnt lgkmcnt(4)
  v_pk_fma_f32 v[40:41], v[40:41], v[180:181], v[148:149]
  v_pk_fma_f32 v[42:43], v[42:43], v[182:183], v[150:151]
  v_pk_fma_f32 v[44:45], v[44:45], v[184:185], v[152:153]
  v_pk_fma_f32 v[46:47], v[46:47], v[186:187], v[154:155]
  v_cvt_pk_bf16_f32 v16, v40, v41
  v_cvt_pk_bf16_f32 v17, v42, v43
  v_cvt_pk_bf16_f32 v18, v44, v45
  v_cvt_pk_bf16_f32 v19, v46, v47
  s_nop 1
  v_permlane16_swap_b32 v16, v18
  v_permlane16_swap_b32 v17, v19
  s_nop 1
  buffer_store_dwordx4 v[16:19], v119, s[4:7], s24 offen sc1
  s_waitcnt lgkmcnt(0)
  v_pk_fma_f32 v[48:49], v[48:49], v[188:189], v[156:157]
  v_pk_fma_f32 v[50:51], v[50:51], v[190:191], v[158:159]
  v_pk_fma_f32 v[52:53], v[52:53], v[192:193], v[160:161]
  v_pk_fma_f32 v[54:55], v[54:55], v[194:195], v[162:163]
  v_cvt_pk_bf16_f32 v20, v48, v49
  v_cvt_pk_bf16_f32 v21, v50, v51
  v_cvt_pk_bf16_f32 v22, v52, v53
  v_cvt_pk_bf16_f32 v23, v54, v55
  s_nop 1
  v_permlane16_swap_b32 v20, v22
  v_permlane16_swap_b32 v21, v23
  s_nop 1
  buffer_store_dwordx4 v[20:23], v119, s[4:7], s25 offen sc1
  v_mov_b32 v7, s100
  s_waitcnt vmcnt(0)
  s_mov_b64 exec, 1
  buffer_store_dword v7, v100, s[64:67], s36 offen sc1
  s_mov_b64 exec, -1
L_front_4:
  s_cmp_ge_u32 s3, 4
  s_cbranch_scc1 L_helper_2
  s_branch L_slow_20
L_back_21:
  s_add_u32 m0, s39, 0
  s_nop 0
  buffer_load_dword v106, s[4:7], s19 offen sc1 lds
  s_add_u32 s19, s19, 131072
  buffer_load_dwordx4 v[212:215], v105, s[4:7], s16 offen sc1
  buffer_load_dwordx4 v[216:219], v105, s[4:7], s16 offen offset:1024 sc1
  s_add_u32 s16, s16, 131072
  s_add_u32 m0, s39, 13312
  s_nop 0
  buffer_load_dword v106, s[4:7], s19 offen sc1 lds
  s_add_u32 s19, s19, 131072
  buffer_load_dwordx4 v[220:223], v105, s[4:7], s16 offen sc1
  buffer_load_dwordx4 v[224:227], v105, s[4:7], s16 offen offset:1024 sc1
  s_add_u32 s16, s16, 131072
  s_add_u32 m0, s39, 26624
  s_nop 0
  buffer_load_dword v106, s[4:7], s19 offen sc1 lds
  s_add_u32 s19, s19, 131072
  s_waitcnt vmcnt(6)
  s_barrier
  ds_read_b64_tr_b16 v[180:181], v118 offset:1024
  ds_read_b64_tr_b16 v[182:183], v118 offset:7168
  ds_read_b128 v[188:191], v119 offset:12288
  ds_read_b64_tr_b16 v[184:185], v118 offset:2048
  ds_read_b64_tr_b16 v[186:187], v118 offset:8192
  ds_read_b64_tr_b16 v[132:133], v114 offset:0
  ds_read_b64_tr_b16 v[134:135], v114 offset:6144
  ds_read_b64_tr_b16 v[136:137], v115 offset:0
  ds_read_b64_tr_b16 v[138:139], v115 offset:6144
  ds_read_b64_tr_b16 v[140:141], v116 offset:0
  ds_read_b64_tr_b16 v[142:143], v116 offset:6144
  ds_read_b64_tr_b16 v[144:145], v117 offset:0
  ds_read_b64_tr_b16 v[146:147], v117 offset:6144
  ds_read_b64_tr_b16 v[148:149], v114 offset:1024
  ds_read_b64_tr_b16 v[150:151], v114 offset:7168
  ds_read_b64_tr_b16 v[152:153], v115 offset:1024
  ds_read_b64_tr_b16 v[154:155], v115 offset:7168
  ds_read_b64_tr_b16 v[156:157], v116 offset:1024
  ds_read_b64_tr_b16 v[158:159], v116 offset:7168
  ds_read_b64_tr_b16 v[160:161], v117 offset:1024
  ds_read_b64_tr_b16 v[162:163], v117 offset:7168
  ds_read_b64_tr_b16 v[164:165], v114 offset:2048
  ds_read_b64_tr_b16 v[166:167], v114 offset:8192
  ds_read_b64_tr_b16 v[168:169], v115 offset:2048
  ds_read_b64_tr_b16 v[170:171], v115 offset:8192
  ds_read_b64_tr_b16 v[172:173], v116 offset:2048
  ds_read_b64_tr_b16 v[174:175], v116 offset:8192
  ds_read_b64_tr_b16 v[176:177], v117 offset:2048
  ds_read_b64_tr_b16 v[178:179], v117 offset:8192
  s_waitcnt vmcnt(3) lgkmcnt(10)
  s_barrier
  buffer_load_dwordx4 v[228:231], v105, s[4:7], s16 offen sc1
  v_mfma_f32_16x16x32_bf16 v[96:99], v[180:183], v[188:191], 0
  ds_read_b64_tr_b16 v[180:181], v118 offset:14336
  v_mfma_f32_16x16x32_bf16 v[100:103], v[188:191], v[184:187], 0
  ds_read_b64_tr_b16 v[182:183], v118 offset:20480
  ds_read_b128 v[188:191], v119 offset:25600
  ds_read_b64_tr_b16 v[184:185], v118 offset:15360
  v_mfma_f32_16x16x32_bf16 v[0:3], v[132:135], v[212:215], 0
  ds_read_b64_tr_b16 v[186:187], v118 offset:21504
  buffer_load_dwordx4 v[232:235], v105, s[4:7], s16 offen offset:1024 sc1
  s_add_u32 s16, s16, 131072
  v_mfma_f32_16x16x32_bf16 v[48:51], v[132:135], v[216:219], 0
  ds_read_b64_tr_b16 v[132:133], v114 offset:13312
  buffer_load_dword v130, v129, s[64:67], 0 offen sc1
  v_mfma_f32_16x16x32_bf16 v[4:7], v[136:139], v[212:215], 0
  ds_read_b64_tr_b16 v[134:135], v114 offset:19456
  v_mfma_f32_16x16x32_bf16 v[52:55], v[136:139], v[216:219], 0
  ds_read_b64_tr_b16 v[136:137], v115 offset:13312
  s_add_u32 m0, s38, 39936
  s_nop 0
  buffer_load_dwordx4 v107, s[8:11], s17 offen lds
  v_mfma_f32_16x16x32_bf16 v[8:11], v[140:143], v[212:215], 0
  ds_read_b64_tr_b16 v[138:139], v115 offset:19456
  v_mfma_f32_16x16x32_bf16 v[56:59], v[140:143], v[216:219], 0
  ds_read_b64_tr_b16 v[140:141], v116 offset:13312
  v_mfma_f32_16x16x32_bf16 v[12:15], v[144:147], v[212:215], 0
  ds_read_b64_tr_b16 v[142:143], v116 offset:19456
  buffer_load_dwordx4 v108, s[8:11], s17 offen offset:1024 lds
  v_mfma_f32_16x16x32_bf16 v[60:63], v[144:147], v[216:219], 0
  ds_read_b64_tr_b16 v[144:145], v117 offset:13312
  v_mfma_f32_16x16x32_bf16 v[16:19], v[148:151], v[212:215], 0
  ds_read_b64_tr_b16 v[146:147], v117 offset:19456
  v_mfma_f32_16x16x32_bf16 v[64:67], v[148:151], v[216:219], 0
  ds_read_b64_tr_b16 v[148:149], v114 offset:14336
  v_mfma_f32_16x16x32_bf16 v[20:23], v[152:155], v[212:215], 0
  ds_read_b64_tr_b16 v[150:151], v114 offset:20480
  buffer_load_dwordx4 v109, s[8:11], s17 offen offset:2048 lds
  s_add_u32 s17, s17, 196608
  v_mfma_f32_16x16x32_bf16 v[68:71], v[152:155], v[216:219], 0
  ds_read_b64_tr_b16 v[152:153], v115 offset:14336
  v_mfma_f32_16x16x32_bf16 v[24:27], v[156:159], v[212:215], 0
  ds_read_b64_tr_b16 v[154:155], v115 offset:20480
  v_mfma_f32_16x16x32_bf16 v[72:75], v[156:159], v[216:219], 0
  ds_read_b64_tr_b16 v[156:157], v116 offset:14336
  s_add_u32 m0, s39, 39936
  s_nop 0
  buffer_load_dword v106, s[4:7], s19 offen sc1 lds
  s_add_u32 s19, s19, 131072
  s_waitcnt lgkmcnt(10)
  v_mfma_f32_16x16x32_bf16 v[28:31], v[160:163], v[212:215], 0
  ds_read_b64_tr_b16 v[158:159], v116 offset:20480
  v_mfma_f32_16x16x32_bf16 v[76:79], v[160:163], v[216:219], 0
  ds_read_b64_tr_b16 v[160:161], v117 offset:14336
  v_mfma_f32_16x16x32_bf16 v[32:35], v[212:215], v[164:167], 0
  ds_read_b64_tr_b16 v[162:163], v117 offset:20480
  buffer_load_dwordx4 v[236:239], v105, s[4:7], s16 offen sc1
  v_mfma_f32_16x16x32_bf16 v[80:83], v[216:219], v[164:167], 0
  ds_read_b64_tr_b16 v[164:165], v114 offset:15360
  v_mfma_f32_16x16x32_bf16 v[36:39], v[212:215], v[168:171], 0
  ds_read_b64_tr_b16 v[166:167], v114 offset:21504
  v_mfma_f32_16x16x32_bf16 v[84:87], v[216:219], v[168:171], 0
  ds_read_b64_tr_b16 v[168:169], v115 offset:15360
  buffer_load_dwordx4 v[240:243], v105, s[4:7], s16 offen offset:1024 sc1
  s_add_u32 s16, s16, 131072
  v_mfma_f32_16x16x32_bf16 v[40:43], v[212:215], v[172:175], 0
  ds_read_b64_tr_b16 v[170:171], v115 offset:21504
  v_mfma_f32_16x16x32_bf16 v[88:91], v[216:219], v[172:175], 0
  ds_read_b64_tr_b16 v[172:173], v116 offset:15360
  v_mfma_f32_16x16x32_bf16 v[44:47], v[212:215], v[176:179], 0
  ds_read_b64_tr_b16 v[174:175], v116 offset:21504
  v_mfma_f32_16x16x32_bf16 v[92:95], v[216:219], v[176:179], 0
  ds_read_b64_tr_b16 v[176:177], v117 offset:15360
  ds_read_b64_tr_b16 v[178:179], v117 offset:21504
  s_waitcnt vmcnt(6) lgkmcnt(10)
  s_barrier
  v_cmp_ne_u32 vcc, s100, v130
  s_nop 1
  s_cmp_lg_u64 vcc, 0
  s_cbranch_scc1 L_slow_22
  L_back_23:
  s_add_u32 m0, s38, 0
  s_nop 0
  buffer_load_dwordx4 v107, s[8:11], s17 offen lds
  v_mfma_f32_16x16x32_bf16 v[96:99], v[180:183], v[188:191], v[96:99]
  ds_read_b64_tr_b16 v[180:181], v118 offset:27648
  v_mfma_f32_16x16x32_bf16 v[100:103], v[188:191], v[184:187], v[100:103]
  ds_read_b64_tr_b16 v[182:183], v118 offset:33792
  ds_read_b128 v[188:191], v119 offset:38912
  ds_read_b64_tr_b16 v[184:185], v118 offset:28672
  v_mfma_f32_16x16x32_bf16 v[0:3], v[132:135], v[220:223], v[0:3]
  ds_read_b64_tr_b16 v[186:187], v118 offset:34816
  v_mfma_f32_16x16x32_bf16 v[48:51], v[132:135], v[224:227], v[48:51]
  ds_read_b64_tr_b16 v[132:133], v114 offset:26624
  buffer_load_dwordx4 v108, s[8:11], s17 offen offset:1024 lds
  v_mfma_f32_16x16x32_bf16 v[4:7], v[136:139], v[220:223], v[4:7]
  ds_read_b64_tr_b16 v[134:135], v114 offset:32768
  v_mfma_f32_16x16x32_bf16 v[52:55], v[136:139], v[224:227], v[52:55]
  ds_read_b64_tr_b16 v[136:137], v115 offset:26624
  v_mfma_f32_16x16x32_bf16 v[8:11], v[140:143], v[220:223], v[8:11]
  ds_read_b64_tr_b16 v[138:139], v115 offset:32768
  v_mfma_f32_16x16x32_bf16 v[56:59], v[140:143], v[224:227], v[56:59]
  ds_read_b64_tr_b16 v[140:141], v116 offset:26624
  buffer_load_dwordx4 v109, s[8:11], s17 offen offset:2048 lds
  s_add_u32 s17, s17, 196608
  v_mfma_f32_16x16x32_bf16 v[12:15], v[144:147], v[220:223], v[12:15]
  ds_read_b64_tr_b16 v[142:143], v116 offset:32768
  v_mfma_f32_16x16x32_bf16 v[60:63], v[144:147], v[224:227], v[60:63]
  ds_read_b64_tr_b16 v[144:145], v117 offset:26624
  v_mfma_f32_16x16x32_bf16 v[16:19], v[148:151], v[220:223], v[16:19]
  ds_read_b64_tr_b16 v[146:147], v117 offset:32768
  v_mfma_f32_16x16x32_bf16 v[64:67], v[148:151], v[224:227], v[64:67]
  ds_read_b64_tr_b16 v[148:149], v114 offset:27648
  v_mfma_f32_16x16x32_bf16 v[20:23], v[152:155], v[220:223], v[20:23]
  ds_read_b64_tr_b16 v[150:151], v114 offset:33792
  s_add_u32 m0, s39, 0
  s_nop 0
  buffer_load_dword v106, s[4:7], s19 offen sc1 lds
  s_add_u32 s19, s19, 131072
  v_mfma_f32_16x16x32_bf16 v[68:71], v[152:155], v[224:227], v[68:71]
  ds_read_b64_tr_b16 v[152:153], v115 offset:27648
  v_mfma_f32_16x16x32_bf16 v[24:27], v[156:159], v[220:223], v[24:27]
  ds_read_b64_tr_b16 v[154:155], v115 offset:33792
  v_mfma_f32_16x16x32_bf16 v[72:75], v[156:159], v[224:227], v[72:75]
  ds_read_b64_tr_b16 v[156:157], v116 offset:27648
  s_waitcnt lgkmcnt(10)
  v_mfma_f32_16x16x32_bf16 v[28:31], v[160:163], v[220:223], v[28:31]
  ds_read_b64_tr_b16 v[158:159], v116 offset:33792
  buffer_load_dwordx4 v[212:215], v105, s[4:7], s16 offen sc1
  v_mfma_f32_16x16x32_bf16 v[76:79], v[160:163], v[224:227], v[76:79]
  ds_read_b64_tr_b16 v[160:161], v117 offset:27648
  v_mfma_f32_16x16x32_bf16 v[32:35], v[220:223], v[164:167], v[32:35]
  ds_read_b64_tr_b16 v[162:163], v117 offset:33792
  v_mfma_f32_16x16x32_bf16 v[80:83], v[224:227], v[164:167], v[80:83]
  ds_read_b64_tr_b16 v[164:165], v114 offset:28672
  v_mfma_f32_16x16x32_bf16 v[36:39], v[220:223], v[168:171], v[36:39]
  ds_read_b64_tr_b16 v[166:167], v114 offset:34816
  buffer_load_dwordx4 v[216:219], v105, s[4:7], s16 offen offset:1024 sc1
  s_add_u32 s16, s16, 131072
  v_mfma_f32_16x16x32_bf16 v[84:87], v[224:227], v[168:171], v[84:87]
  ds_read_b64_tr_b16 v[168:169], v115 offset:28672
  v_mfma_f32_16x16x32_bf16 v[40:43], v[220:223], v[172:175], v[40:43]
  ds_read_b64_tr_b16 v[170:171], v115 offset:34816
  v_mfma_f32_16x16x32_bf16 v[88:91], v[224:227], v[172:175], v[88:91]
  ds_read_b64_tr_b16 v[172:173], v116 offset:28672
  v_mfma_f32_16x16x32_bf16 v[44:47], v[220:223], v[176:179], v[44:47]
  ds_read_b64_tr_b16 v[174:175], v116 offset:34816
  v_mfma_f32_16x16x32_bf16 v[92:95], v[224:227], v[176:179], v[92:95]
  ds_read_b64_tr_b16 v[176:177], v117 offset:28672
  ds_read_b64_tr_b16 v[178:179], v117 offset:34816
  s_mov_b32 s18, 6
  .p2align 6
L_loop_25:
  s_waitcnt vmcnt(8) lgkmcnt(10)
  s_barrier
  s_add_u32 m0, s38, 13312
  s_nop 0
  buffer_load_dwordx4 v107, s[8:11], s17 offen lds
  v_mfma_f32_16x16x32_bf16 v[96:99], v[180:183], v[188:191], v[96:99]
  ds_read_b64_tr_b16 v[180:181], v118 offset:40960
  v_mfma_f32_16x16x32_bf16 v[100:103], v[188:191], v[184:187], v[100:103]
  ds_read_b64_tr_b16 v[182:183], v118 offset:47104
  ds_read_b128 v[188:191], v119 offset:52224
  ds_read_b64_tr_b16 v[184:185], v118 offset:41984
  v_mfma_f32_16x16x32_bf16 v[0:3], v[132:135], v[228:231], v[0:3]
  ds_read_b64_tr_b16 v[186:187], v118 offset:48128
  v_mfma_f32_16x16x32_bf16 v[48:51], v[132:135], v[232:235], v[48:51]
  ds_read_b64_tr_b16 v[132:133], v114 offset:39936
  buffer_load_dwordx4 v108, s[8:11], s17 offen offset:1024 lds
  v_mfma_f32_16x16x32_bf16 v[4:7], v[136:139], v[228:231], v[4:7]
  ds_read_b64_tr_b16 v[134:135], v114 offset:46080
  v_mfma_f32_16x16x32_bf16 v[52:55], v[136:139], v[232:235], v[52:55]
  ds_read_b64_tr_b16 v[136:137], v115 offset:39936
  v_mfma_f32_16x16x32_bf16 v[8:11], v[140:143], v[228:231], v[8:11]
  ds_read_b64_tr_b16 v[138:139], v115 offset:46080
  v_mfma_f32_16x16x32_bf16 v[56:59], v[140:143], v[232:235], v[56:59]
  ds_read_b64_tr_b16 v[140:141], v116 offset:39936
  buffer_load_dwordx4 v109, s[8:11], s17 offen offset:2048 lds
  s_add_u32 s17, s17, 196608
  v_mfma_f32_16x16x32_bf16 v[12:15], v[144:147], v[228:231], v[12:15]
  ds_read_b64_tr_b16 v[142:143], v116 offset:46080
  v_mfma_f32_16x16x32_bf16 v[60:63], v[144:147], v[232:235], v[60:63]
  ds_read_b64_tr_b16 v[144:145], v117 offset:39936
  v_mfma_f32_16x16x32_bf16 v[16:19], v[148:151], v[228:231], v[16:19]
  ds_read_b64_tr_b16 v[146:147], v117 offset:46080
  v_mfma_f32_16x16x32_bf16 v[64:67], v[148:151], v[232:235], v[64:67]
  ds_read_b64_tr_b16 v[148:149], v114 offset:40960
  v_mfma_f32_16x16x32_bf16 v[20:23], v[152:155], v[228:231], v[20:23]
  ds_read_b64_tr_b16 v[150:151], v114 offset:47104
  s_add_u32 m0, s39, 13312
  s_nop 0
  buffer_load_dword v106, s[4:7], s19 offen sc1 lds
  s_add_u32 s19, s19, 131072
  v_mfma_f32_16x16x32_bf16 v[68:71], v[152:155], v[232:235], v[68:71]
  ds_read_b64_tr_b16 v[152:153], v115 offset:40960
  v_mfma_f32_16x16x32_bf16 v[24:27], v[156:159], v[228:231], v[24:27]
  ds_read_b64_tr_b16 v[154:155], v115 offset:47104
  v_mfma_f32_16x16x32_bf16 v[72:75], v[156:159], v[232:235], v[72:75]
  ds_read_b64_tr_b16 v[156:157], v116 offset:40960
  s_waitcnt lgkmcnt(10)
  v_mfma_f32_16x16x32_bf16 v[28:31], v[160:163], v[228:231], v[28:31]
  ds_read_b64_tr_b16 v[158:159], v116 offset:47104
  buffer_load_dwordx4 v[220:223], v105, s[4:7], s16 offen sc1
  v_mfma_f32_16x16x32_bf16 v[76:79], v[160:163], v[232:235], v[76:79]
  ds_read_b64_tr_b16 v[160:161], v117 offset:40960
  v_mfma_f32_16x16x32_bf16 v[32:35], v[228:231], v[164:167], v[32:35]
  ds_read_b64_tr_b16 v[162:163], v117 offset:47104
  v_mfma_f32_16x16x32_bf16 v[80:83], v[232:235], v[164:167], v[80:83]
  ds_read_b64_tr_b16 v[164:165], v114 offset:41984
  v_mfma_f32_16x16x32_bf16 v[36:39], v[228:231], v[168:171], v[36:39]
  ds_read_b64_tr_b16 v[166:167], v114 offset:48128
  buffer_load_dwordx4 v[224:227], v105, s[4:7], s16 offen offset:1024 sc1
  s_add_u32 s16, s16, 131072
  v_mfma_f32_16x16x32_bf16 v[84:87], v[232:235], v[168:171], v[84:87]
  ds_read_b64_tr_b16 v[168:169], v115 offset:41984
  v_mfma_f32_16x16x32_bf16 v[40:43], v[228:231], v[172:175], v[40:43]
  ds_read_b64_tr_b16 v[170:171], v115 offset:48128
  v_mfma_f32_16x16x32_bf16 v[88:91], v[232:235], v[172:175], v[88:91]
  ds_read_b64_tr_b16 v[172:173], v116 offset:41984
  v_mfma_f32_16x16x32_bf16 v[44:47], v[228:231], v[176:179], v[44:47]
  ds_read_b64_tr_b16 v[174:175], v116 offset:48128
  v_mfma_f32_16x16x32_bf16 v[92:95], v[232:235], v[176:179], v[92:95]
  ds_read_b64_tr_b16 v[176:177], v117 offset:41984
  ds_read_b64_tr_b16 v[178:179], v117 offset:48128
  s_waitcnt vmcnt(8) lgkmcnt(10)
  s_barrier
  s_add_u32 m0, s38, 26624
  s_nop 0
  buffer_load_dwordx4 v107, s[8:11], s17 offen lds
  v_mfma_f32_16x16x32_bf16 v[96:99], v[180:183], v[188:191], v[96:99]
  ds_read_b64_tr_b16 v[180:181], v118 offset:1024
  v_mfma_f32_16x16x32_bf16 v[100:103], v[188:191], v[184:187], v[100:103]
  ds_read_b64_tr_b16 v[182:183], v118 offset:7168
  ds_read_b128 v[188:191], v119 offset:12288
  ds_read_b64_tr_b16 v[184:185], v118 offset:2048
  v_mfma_f32_16x16x32_bf16 v[0:3], v[132:135], v[236:239], v[0:3]
  ds_read_b64_tr_b16 v[186:187], v118 offset:8192
  v_mfma_f32_16x16x32_bf16 v[48:51], v[132:135], v[240:243], v[48:51]
  ds_read_b64_tr_b16 v[132:133], v114 offset:0
  buffer_load_dwordx4 v108, s[8:11], s17 offen offset:1024 lds
  v_mfma_f32_16x16x32_bf16 v[4:7], v[136:139], v[236:239], v[4:7]
  ds_read_b64_tr_b16 v[134:135], v114 offset:6144
  v_mfma_f32_16x16x32_bf16 v[52:55], v[136:139], v[240:243], v[52:55]
  ds_read_b64_tr_b16 v[136:137], v115 offset:0
  v_mfma_f32_16x16x32_bf16 v[8:11], v[140:143], v[236:239], v[8:11]
  ds_read_b64_tr_b16 v[138:139], v115 offset:6144
  v_mfma_f32_16x16x32_bf16 v[56:59], v[140:143], v[240:243], v[56:59]
  ds_read_b64_tr_b16 v[140:141], v116 offset:0
  buffer_load_dwordx4 v109, s[8:11], s17 offen offset:2048 lds
  s_add_u32 s17, s17, 196608
  v_mfma_f32_16x16x32_bf16 v[12:15], v[144:147], v[236:239], v[12:15]
  ds_read_b64_tr_b16 v[142:143], v116 offset:6144
  v_mfma_f32_16x16x32_bf16 v[60:63], v[144:147], v[240:243], v[60:63]
  ds_read_b64_tr_b16 v[144:145], v117 offset:0
  v_mfma_f32_16x16x32_bf16 v[16:19], v[148:151], v[236:239], v[16:19]
  ds_read_b64_tr_b16 v[146:147], v117 offset:6144
  v_mfma_f32_16x16x32_bf16 v[64:67], v[148:151], v[240:243], v[64:67]
  ds_read_b64_tr_b16 v[148:149], v114 offset:1024
  v_mfma_f32_16x16x32_bf16 v[20:23], v[152:155], v[236:239], v[20:23]
  ds_read_b64_tr_b16 v[150:151], v114 offset:7168
  s_add_u32 m0, s39, 26624
  s_nop 0
  buffer_load_dword v106, s[4:7], s19 offen sc1 lds
  s_add_u32 s19, s19, 131072
  v_mfma_f32_16x16x32_bf16 v[68:71], v[152:155], v[240:243], v[68:71]
  ds_read_b64_tr_b16 v[152:153], v115 offset:1024
  v_mfma_f32_16x16x32_bf16 v[24:27], v[156:159], v[236:239], v[24:27]
  ds_read_b64_tr_b16 v[154:155], v115 offset:7168
  v_mfma_f32_16x16x32_bf16 v[72:75], v[156:159], v[240:243], v[72:75]
  ds_read_b64_tr_b16 v[156:157], v116 offset:1024
  s_waitcnt lgkmcnt(10)
  v_mfma_f32_16x16x32_bf16 v[28:31], v[160:163], v[236:239], v[28:31]
  ds_read_b64_tr_b16 v[158:159], v116 offset:7168
  buffer_load_dwordx4 v[228:231], v105, s[4:7], s16 offen sc1
  v_mfma_f32_16x16x32_bf16 v[76:79], v[160:163], v[240:243], v[76:79]
  ds_read_b64_tr_b16 v[160:161], v117 offset:1024
  v_mfma_f32_16x16x32_bf16 v[32:35], v[236:239], v[164:167], v[32:35]
  ds_read_b64_tr_b16 v[162:163], v117 offset:7168
  v_mfma_f32_16x16x32_bf16 v[80:83], v[240:243], v[164:167], v[80:83]
  ds_read_b64_tr_b16 v[164:165], v114 offset:2048
  v_mfma_f32_16x16x32_bf16 v[36:39], v[236:239], v[168:171], v[36:39]
  ds_read_b64_tr_b16 v[166:167], v114 offset:8192
  buffer_load_dwordx4 v[232:235], v105, s[4:7], s16 offen offset:1024 sc1
  s_add_u32 s16, s16, 131072
  v_mfma_f32_16x16x32_bf16 v[84:87], v[240:243], v[168:171], v[84:87]
  ds_read_b64_tr_b16 v[168:169], v115 offset:2048
  v_mfma_f32_16x16x32_bf16 v[40:43], v[236:239], v[172:175], v[40:43]
  ds_read_b64_tr_b16 v[170:171], v115 offset:8192
  v_mfma_f32_16x16x32_bf16 v[88:91], v[240:243], v[172:175], v[88:91]
  ds_read_b64_tr_b16 v[172:173], v116 offset:2048
  v_mfma_f32_16x16x32_bf16 v[44:47], v[236:239], v[176:179], v[44:47]
  ds_read_b64_tr_b16 v[174:175], v116 offset:8192
  v_mfma_f32_16x16x32_bf16 v[92:95], v[240:243], v[176:179], v[92:95]
  ds_read_b64_tr_b16 v[176:177], v117 offset:2048
  ds_read_b64_tr_b16 v[178:179], v117 offset:8192
  s_waitcnt vmcnt(8) lgkmcnt(10)
  s_barrier
  s_add_u32 m0, s38, 39936
  s_nop 0
  buffer_load_dwordx4 v107, s[8:11], s17 offen lds
  v_mfma_f32_16x16x32_bf16 v[96:99], v[180:183], v[188:191], v[96:99]
  ds_read_b64_tr_b16 v[180:181], v118 offset:14336
  v_mfma_f32_16x16x32_bf16 v[100:103], v[188:191], v[184:187], v[100:103]
  ds_read_b64_tr_b16 v[182:183], v118 offset:20480
  ds_read_b128 v[188:191], v119 offset:25600
  ds_read_b64_tr_b16 v[184:185], v118 offset:15360
  v_mfma_f32_16x16x32_bf16 v[0:3], v[132:135], v[212:215], v[0:3]
  ds_read_b64_tr_b16 v[186:187], v118 offset:21504
  v_mfma_f32_16x16x32_bf16 v[48:51], v[132:135], v[216:219], v[48:51]
  ds_read_b64_tr_b16 v[132:133], v114 offset:13312
  buffer_load_dwordx4 v108, s[8:11], s17 offen offset:1024 lds
  v_mfma_f32_16x16x32_bf16 v[4:7], v[136:139], v[212:215], v[4:7]
  ds_read_b64_tr_b16 v[134:135], v114 offset:19456
  v_mfma_f32_16x16x32_bf16 v[52:55], v[136:139], v[216:219], v[52:55]
  ds_read_b64_tr_b16 v[136:137], v115 offset:13312
  v_mfma_f32_16x16x32_bf16 v[8:11], v[140:143], v[212:215], v[8:11]
  ds_read_b64_tr_b16 v[138:139], v115 offset:19456
  v_mfma_f32_16x16x32_bf16 v[56:59], v[140:143], v[216:219], v[56:59]
  ds_read_b64_tr_b16 v[140:141], v116 offset:13312
  buffer_load_dwordx4 v109, s[8:11], s17 offen offset:2048 lds
  s_add_u32 s17, s17, 196608
  v_mfma_f32_16x16x32_bf16 v[12:15], v[144:147], v[212:215], v[12:15]
  ds_read_b64_tr_b16 v[142:143], v116 offset:19456
  v_mfma_f32_16x16x32_bf16 v[60:63], v[144:147], v[216:219], v[60:63]
  ds_read_b64_tr_b16 v[144:145], v117 offset:13312
  v_mfma_f32_16x16x32_bf16 v[16:19], v[148:151], v[212:215], v[16:19]
  ds_read_b64_tr_b16 v[146:147], v117 offset:19456
  v_mfma_f32_16x16x32_bf16 v[64:67], v[148:151], v[216:219], v[64:67]
  ds_read_b64_tr_b16 v[148:149], v114 offset:14336
  v_mfma_f32_16x16x32_bf16 v[20:23], v[152:155], v[212:215], v[20:23]
  ds_read_b64_tr_b16 v[150:151], v114 offset:20480
  s_add_u32 m0, s39, 39936
  s_nop 0
  buffer_load_dword v106, s[4:7], s19 offen sc1 lds
  s_add_u32 s19, s19, 131072
  v_mfma_f32_16x16x32_bf16 v[68:71], v[152:155], v[216:219], v[68:71]
  ds_read_b64_tr_b16 v[152:153], v115 offset:14336
  v_mfma_f32_16x16x32_bf16 v[24:27], v[156:159], v[212:215], v[24:27]
  ds_read_b64_tr_b16 v[154:155], v115 offset:20480
  v_mfma_f32_16x16x32_bf16 v[72:75], v[156:159], v[216:219], v[72:75]
  ds_read_b64_tr_b16 v[156:157], v116 offset:14336
  s_waitcnt lgkmcnt(10)
  v_mfma_f32_16x16x32_bf16 v[28:31], v[160:163], v[212:215], v[28:31]
  ds_read_b64_tr_b16 v[158:159], v116 offset:20480
  buffer_load_dwordx4 v[236:239], v105, s[4:7], s16 offen sc1
  v_mfma_f32_16x16x32_bf16 v[76:79], v[160:163], v[216:219], v[76:79]
  ds_read_b64_tr_b16 v[160:161], v117 offset:14336
  v_mfma_f32_16x16x32_bf16 v[32:35], v[212:215], v[164:167], v[32:35]
  ds_read_b64_tr_b16 v[162:163], v117 offset:20480
  v_mfma_f32_16x16x32_bf16 v[80:83], v[216:219], v[164:167], v[80:83]
  ds_read_b64_tr_b16 v[164:165], v114 offset:15360
  v_mfma_f32_16x16x32_bf16 v[36:39], v[212:215], v[168:171], v[36:39]
  ds_read_b64_tr_b16 v[166:167], v114 offset:21504
  buffer_load_dwordx4 v[240:243], v105, s[4:7], s16 offen offset:1024 sc1
  s_add_u32 s16, s16, 131072
  v_mfma_f32_16x16x32_bf16 v[84:87], v[216:219], v[168:171], v[84:87]
  ds_read_b64_tr_b16 v[168:169], v115 offset:15360
  v_mfma_f32_16x16x32_bf16 v[40:43], v[212:215], v[172:175], v[40:43]
  ds_read_b64_tr_b16 v[170:171], v115 offset:21504
  v_mfma_f32_16x16x32_bf16 v[88:91], v[216:219], v[172:175], v[88:91]
  ds_read_b64_tr_b16 v[172:173], v116 offset:15360
  v_mfma_f32_16x16x32_bf16 v[44:47], v[212:215], v[176:179], v[44:47]
  ds_read_b64_tr_b16 v[174:175], v116 offset:21504
  v_mfma_f32_16x16x32_bf16 v[92:95], v[216:219], v[176:179], v[92:95]
  ds_read_b64_tr_b16 v[176:177], v117 offset:15360
  ds_read_b64_tr_b16 v[178:179], v117 offset:21504
  s_waitcnt vmcnt(8) lgkmcnt(10)
  s_barrier
  s_add_u32 m0, s38, 0
  s_nop 0
  buffer_load_dwordx4 v107, s[8:11], s17 offen lds
  v_mfma_f32_16x16x32_bf16 v[96:99], v[180:183], v[188:191], v[96:99]
  ds_read_b64_tr_b16 v[180:181], v118 offset:27648
  v_mfma_f32_16x16x32_bf16 v[100:103], v[188:191], v[184:187], v[100:103]
  ds_read_b64_tr_b16 v[182:183], v118 offset:33792
  ds_read_b128 v[188:191], v119 offset:38912
  ds_read_b64_tr_b16 v[184:185], v118 offset:28672
  v_mfma_f32_16x16x32_bf16 v[0:3], v[132:135], v[220:223], v[0:3]
  ds_read_b64_tr_b16 v[186:187], v118 offset:34816
  v_mfma_f32_16x16x32_bf16 v[48:51], v[132:135], v[224:227], v[48:51]
  ds_read_b64_tr_b16 v[132:133], v114 offset:26624
  buffer_load_dwordx4 v108, s[8:11], s17 offen offset:1024 lds
  v_mfma_f32_16x16x32_bf16 v[4:7], v[136:139], v[220:223], v[4:7]
  ds_read_b64_tr_b16 v[134:135], v114 offset:32768
  v_mfma_f32_16x16x32_bf16 v[52:55], v[136:139], v[224:227], v[52:55]
  ds_read_b64_tr_b16 v[136:137], v115 offset:26624
  v_mfma_f32_16x16x32_bf16 v[8:11], v[140:143], v[220:223], v[8:11]
  ds_read_b64_tr_b16 v[138:139], v115 offset:32768
  v_mfma_f32_16x16x32_bf16 v[56:59], v[140:143], v[224:227], v[56:59]
  ds_read_b64_tr_b16 v[140:141], v116 offset:26624
  buffer_load_dwordx4 v109, s[8:11], s17 offen offset:2048 lds
  s_add_u32 s17, s17, 196608
  v_mfma_f32_16x16x32_bf16 v[12:15], v[144:147], v[220:223], v[12:15]
  ds_read_b64_tr_b16 v[142:143], v116 offset:32768
  v_mfma_f32_16x16x32_bf16 v[60:63], v[144:147], v[224:227], v[60:63]
  ds_read_b64_tr_b16 v[144:145], v117 offset:26624
  v_mfma_f32_16x16x32_bf16 v[16:19], v[148:151], v[220:223], v[16:19]
  ds_read_b64_tr_b16 v[146:147], v117 offset:32768
  v_mfma_f32_16x16x32_bf16 v[64:67], v[148:151], v[224:227], v[64:67]
  ds_read_b64_tr_b16 v[148:149], v114 offset:27648
  v_mfma_f32_16x16x32_bf16 v[20:23], v[152:155], v[220:223], v[20:23]
  ds_read_b64_tr_b16 v[150:151], v114 offset:33792
  s_add_u32 m0, s39, 0
  s_nop 0
  buffer_load_dword v106, s[4:7], s19 offen sc1 lds
  s_add_u32 s19, s19, 131072
  v_mfma_f32_16x16x32_bf16 v[68:71], v[152:155], v[224:227], v[68:71]
  ds_read_b64_tr_b16 v[152:153], v115 offset:27648
  v_mfma_f32_16x16x32_bf16 v[24:27], v[156:159], v[220:223], v[24:27]
  ds_read_b64_tr_b16 v[154:155], v115 offset:33792
  v_mfma_f32_16x16x32_bf16 v[72:75], v[156:159], v[224:227], v[72:75]
  ds_read_b64_tr_b16 v[156:157], v116 offset:27648
  s_waitcnt lgkmcnt(10)
  v_mfma_f32_16x16x32_bf16 v[28:31], v[160:163], v[220:223], v[28:31]
  ds_read_b64_tr_b16 v[158:159], v116 offset:33792
  buffer_load_dwordx4 v[212:215], v105, s[4:7], s16 offen sc1
  v_mfma_f32_16x16x32_bf16 v[76:79], v[160:163], v[224:227], v[76:79]
  ds_read_b64_tr_b16 v[160:161], v117 offset:27648
  v_mfma_f32_16x16x32_bf16 v[32:35], v[220:223], v[164:167], v[32:35]
  ds_read_b64_tr_b16 v[162:163], v117 offset:33792
  v_mfma_f32_16x16x32_bf16 v[80:83], v[224:227], v[164:167], v[80:83]
  ds_read_b64_tr_b16 v[164:165], v114 offset:28672
  v_mfma_f32_16x16x32_bf16 v[36:39], v[220:223], v[168:171], v[36:39]
  ds_read_b64_tr_b16 v[166:167], v114 offset:34816
  buffer_load_dwordx4 v[216:219], v105, s[4:7], s16 offen offset:1024 sc1
  s_add_u32 s16, s16, 131072
  v_mfma_f32_16x16x32_bf16 v[84:87], v[224:227], v[168:171], v[84:87]
  ds_read_b64_tr_b16 v[168:169], v115 offset:28672
  v_mfma_f32_16x16x32_bf16 v[40:43], v[220:223], v[172:175], v[40:43]
  ds_read_b64_tr_b16 v[170:171], v115 offset:34816
  v_mfma_f32_16x16x32_bf16 v[88:91], v[224:227], v[172:175], v[88:91]
  ds_read_b64_tr_b16 v[172:173], v116 offset:28672
  v_mfma_f32_16x16x32_bf16 v[44:47], v[220:223], v[176:179], v[44:47]
  ds_read_b64_tr_b16 v[174:175], v116 offset:34816
  v_mfma_f32_16x16x32_bf16 v[92:95], v[224:227], v[176:179], v[92:95]
  ds_read_b64_tr_b16 v[176:177], v117 offset:28672
  ds_read_b64_tr_b16 v[178:179], v117 offset:34816
  s_sub_u32 s18, s18, 1
  s_cmp_lg_u32 s18, 0
  s_cbranch_scc1 L_loop_25
  s_waitcnt vmcnt(8) lgkmcnt(10)
  s_barrier
  s_add_u32 m0, s38, 13312
  s_nop 0
  buffer_load_dwordx4 v107, s[8:11], s17 offen lds
  v_mfma_f32_16x16x32_bf16 v[96:99], v[180:183], v[188:191], v[96:99]
  ds_read_b64_tr_b16 v[180:181], v118 offset:40960
  v_mfma_f32_16x16x32_bf16 v[100:103], v[188:191], v[184:187], v[100:103]
  ds_read_b64_tr_b16 v[182:183], v118 offset:47104
  ds_read_b128 v[188:191], v119 offset:52224
  ds_read_b64_tr_b16 v[184:185], v118 offset:41984
  v_mfma_f32_16x16x32_bf16 v[0:3], v[132:135], v[228:231], v[0:3]
  ds_read_b64_tr_b16 v[186:187], v118 offset:48128
  v_mfma_f32_16x16x32_bf16 v[48:51], v[132:135], v[232:235], v[48:51]
  ds_read_b64_tr_b16 v[132:133], v114 offset:39936
  buffer_load_dwordx4 v108, s[8:11], s17 offen offset:1024 lds
  v_mfma_f32_16x16x32_bf16 v[4:7], v[136:139], v[228:231], v[4:7]
  ds_read_b64_tr_b16 v[134:135], v114 offset:46080
  v_mfma_f32_16x16x32_bf16 v[52:55], v[136:139], v[232:235], v[52:55]
  ds_read_b64_tr_b16 v[136:137], v115 offset:39936
  v_mfma_f32_16x16x32_bf16 v[8:11], v[140:143], v[228:231], v[8:11]
  ds_read_b64_tr_b16 v[138:139], v115 offset:46080
  v_mfma_f32_16x16x32_bf16 v[56:59], v[140:143], v[232:235], v[56:59]
  ds_read_b64_tr_b16 v[140:141], v116 offset:39936
  buffer_load_dwordx4 v109, s[8:11], s17 offen offset:2048 lds
  s_add_u32 s17, s17, 196608
  v_mfma_f32_16x16x32_bf16 v[12:15], v[144:147], v[228:231], v[12:15]
  ds_read_b64_tr_b16 v[142:143], v116 offset:46080
  v_mfma_f32_16x16x32_bf16 v[60:63], v[144:147], v[232:235], v[60:63]
  ds_read_b64_tr_b16 v[144:145], v117 offset:39936
  v_mfma_f32_16x16x32_bf16 v[16:19], v[148:151], v[228:231], v[16:19]
  ds_read_b64_tr_b16 v[146:147], v117 offset:46080
  v_mfma_f32_16x16x32_bf16 v[64:67], v[148:151], v[232:235], v[64:67]
  ds_read_b64_tr_b16 v[148:149], v114 offset:40960
  v_mfma_f32_16x16x32_bf16 v[20:23], v[152:155], v[228:231], v[20:23]
  ds_read_b64_tr_b16 v[150:151], v114 offset:47104
  s_add_u32 m0, s39, 13312
  s_nop 0
  buffer_load_dword v106, s[4:7], s19 offen sc1 lds
  s_add_u32 s19, s19, 131072
  v_mfma_f32_16x16x32_bf16 v[68:71], v[152:155], v[232:235], v[68:71]
  ds_read_b64_tr_b16 v[152:153], v115 offset:40960
  v_mfma_f32_16x16x32_bf16 v[24:27], v[156:159], v[228:231], v[24:27]
  ds_read_b64_tr_b16 v[154:155], v115 offset:47104
  v_mfma_f32_16x16x32_bf16 v[72:75], v[156:159], v[232:235], v[72:75]
  ds_read_b64_tr_b16 v[156:157], v116 offset:40960
  s_waitcnt lgkmcnt(10)
  v_mfma_f32_16x16x32_bf16 v[28:31], v[160:163], v[228:231], v[28:31]
  ds_read_b64_tr_b16 v[158:159], v116 offset:47104
  buffer_load_dwordx4 v[220:223], v105, s[4:7], s16 offen sc1
  v_mfma_f32_16x16x32_bf16 v[76:79], v[160:163], v[232:235], v[76:79]
  ds_read_b64_tr_b16 v[160:161], v117 offset:40960
  v_mfma_f32_16x16x32_bf16 v[32:35], v[228:231], v[164:167], v[32:35]
  ds_read_b64_tr_b16 v[162:163], v117 offset:47104
  v_mfma_f32_16x16x32_bf16 v[80:83], v[232:235], v[164:167], v[80:83]
  ds_read_b64_tr_b16 v[164:165], v114 offset:41984
  v_mfma_f32_16x16x32_bf16 v[36:39], v[228:231], v[168:171], v[36:39]
  ds_read_b64_tr_b16 v[166:167], v114 offset:48128
  buffer_load_dwordx4 v[224:227], v105, s[4:7], s16 offen offset:1024 sc1
  s_add_u32 s16, s16, 131072
  v_mfma_f32_16x16x32_bf16 v[84:87], v[232:235], v[168:171], v[84:87]
  ds_read_b64_tr_b16 v[168:169], v115 offset:41984
  v_mfma_f32_16x16x32_bf16 v[40:43], v[228:231], v[172:175], v[40:43]
  ds_read_b64_tr_b16 v[170:171], v115 offset:48128
  v_mfma_f32_16x16x32_bf16 v[88:91], v[232:235], v[172:175], v[88:91]
  ds_read_b64_tr_b16 v[172:173], v116 offset:41984
  v_mfma_f32_16x16x32_bf16 v[44:47], v[228:231], v[176:179], v[44:47]
  ds_read_b64_tr_b16 v[174:175], v116 offset:48128
  v_mfma_f32_16x16x32_bf16 v[92:95], v[232:235], v[176:179], v[92:95]
  ds_read_b64_tr_b16 v[176:177], v117 offset:41984
  ds_read_b64_tr_b16 v[178:179], v117 offset:48128
  s_waitcnt vmcnt(8) lgkmcnt(10)
  s_barrier
  s_add_u32 m0, s38, 26624
  s_nop 0
  buffer_load_dwordx4 v107, s[8:11], s17 offen lds
  v_mfma_f32_16x16x32_bf16 v[96:99], v[180:183], v[188:191], v[96:99]
  ds_read_b64_tr_b16 v[180:181], v118 offset:1024
  v_mfma_f32_16x16x32_bf16 v[100:103], v[188:191], v[184:187], v[100:103]
  ds_read_b64_tr_b16 v[182:183], v118 offset:7168
  ds_read_b128 v[188:191], v119 offset:12288
  ds_read_b64_tr_b16 v[184:185], v118 offset:2048
  v_mfma_f32_16x16x32_bf16 v[0:3], v[132:135], v[236:239], v[0:3]
  ds_read_b64_tr_b16 v[186:187], v118 offset:8192
  v_mfma_f32_16x16x32_bf16 v[48:51], v[132:135], v[240:243], v[48:51]
  ds_read_b64_tr_b16 v[132:133], v114 offset:0
  buffer_load_dwordx4 v108, s[8:11], s17 offen offset:1024 lds
  v_mfma_f32_16x16x32_bf16 v[4:7], v[136:139], v[236:239], v[4:7]
  ds_read_b64_tr_b16 v[134:135], v114 offset:6144
  v_mfma_f32_16x16x32_bf16 v[52:55], v[136:139], v[240:243], v[52:55]
  ds_read_b64_tr_b16 v[136:137], v115 offset:0
  v_mfma_f32_16x16x32_bf16 v[8:11], v[140:143], v[236:239], v[8:11]
  ds_read_b64_tr_b16 v[138:139], v115 offset:6144
  v_mfma_f32_16x16x32_bf16 v[56:59], v[140:143], v[240:243], v[56:59]
  ds_read_b64_tr_b16 v[140:141], v116 offset:0
  buffer_load_dwordx4 v109, s[8:11], s17 offen offset:2048 lds
  s_add_u32 s17, s17, 196608
  v_mfma_f32_16x16x32_bf16 v[12:15], v[144:147], v[236:239], v[12:15]
  ds_read_b64_tr_b16 v[142:143], v116 offset:6144
  v_mfma_f32_16x16x32_bf16 v[60:63], v[144:147], v[240:243], v[60:63]
  ds_read_b64_tr_b16 v[144:145], v117 offset:0
  v_mfma_f32_16x16x32_bf16 v[16:19], v[148:151], v[236:239], v[16:19]
  ds_read_b64_tr_b16 v[146:147], v117 offset:6144
  v_mfma_f32_16x16x32_bf16 v[64:67], v[148:151], v[240:243], v[64:67]
  ds_read_b64_tr_b16 v[148:149], v114 offset:1024
  v_mfma_f32_16x16x32_bf16 v[20:23], v[152:155], v[236:239], v[20:23]
  ds_read_b64_tr_b16 v[150:151], v114 offset:7168
  s_add_u32 m0, s39, 26624
  s_nop 0
  buffer_load_dword v106, s[4:7], s19 offen sc1 lds
  s_add_u32 s19, s19, 131072
  v_mfma_f32_16x16x32_bf16 v[68:71], v[152:155], v[240:243], v[68:71]
  ds_read_b64_tr_b16 v[152:153], v115 offset:1024
  v_mfma_f32_16x16x32_bf16 v[24:27], v[156:159], v[236:239], v[24:27]
  ds_read_b64_tr_b16 v[154:155], v115 offset:7168
  v_mfma_f32_16x16x32_bf16 v[72:75], v[156:159], v[240:243], v[72:75]
  ds_read_b64_tr_b16 v[156:157], v116 offset:1024
  s_waitcnt lgkmcnt(10)
  v_mfma_f32_16x16x32_bf16 v[28:31], v[160:163], v[236:239], v[28:31]
  ds_read_b64_tr_b16 v[158:159], v116 offset:7168
  buffer_load_dwordx4 v[228:231], v105, s[4:7], s16 offen sc1
  v_mfma_f32_16x16x32_bf16 v[76:79], v[160:163], v[240:243], v[76:79]
  ds_read_b64_tr_b16 v[160:161], v117 offset:1024
  v_mfma_f32_16x16x32_bf16 v[32:35], v[236:239], v[164:167], v[32:35]
  ds_read_b64_tr_b16 v[162:163], v117 offset:7168
  v_mfma_f32_16x16x32_bf16 v[80:83], v[240:243], v[164:167], v[80:83]
  ds_read_b64_tr_b16 v[164:165], v114 offset:2048
  v_mfma_f32_16x16x32_bf16 v[36:39], v[236:239], v[168:171], v[36:39]
  ds_read_b64_tr_b16 v[166:167], v114 offset:8192
  buffer_load_dwordx4 v[232:235], v105, s[4:7], s16 offen offset:1024 sc1
  s_add_u32 s16, s16, 131072
  v_mfma_f32_16x16x32_bf16 v[84:87], v[240:243], v[168:171], v[84:87]
  ds_read_b64_tr_b16 v[168:169], v115 offset:2048
  v_mfma_f32_16x16x32_bf16 v[40:43], v[236:239], v[172:175], v[40:43]
  ds_read_b64_tr_b16 v[170:171], v115 offset:8192
  v_mfma_f32_16x16x32_bf16 v[88:91], v[240:243], v[172:175], v[88:91]
  ds_read_b64_tr_b16 v[172:173], v116 offset:2048
  v_mfma_f32_16x16x32_bf16 v[44:47], v[236:239], v[176:179], v[44:47]
  ds_read_b64_tr_b16 v[174:175], v116 offset:8192
  v_mfma_f32_16x16x32_bf16 v[92:95], v[240:243], v[176:179], v[92:95]
  ds_read_b64_tr_b16 v[176:177], v117 offset:2048
  ds_read_b64_tr_b16 v[178:179], v117 offset:8192
  s_waitcnt vmcnt(8) lgkmcnt(10)
  s_barrier
  s_add_u32 m0, s38, 39936
  s_nop 0
  buffer_load_dwordx4 v107, s[8:11], s17 offen lds
  v_mfma_f32_16x16x32_bf16 v[96:99], v[180:183], v[188:191], v[96:99]
  ds_read_b64_tr_b16 v[180:181], v118 offset:14336
  v_mfma_f32_16x16x32_bf16 v[100:103], v[188:191], v[184:187], v[100:103]
  ds_read_b64_tr_b16 v[182:183], v118 offset:20480
  ds_read_b128 v[188:191], v119 offset:25600
  ds_read_b64_tr_b16 v[184:185], v118 offset:15360
  v_mfma_f32_16x16x32_bf16 v[0:3], v[132:135], v[212:215], v[0:3]
  ds_read_b64_tr_b16 v[186:187], v118 offset:21504
  buffer_load_dwordx4 v108, s[8:11], s17 offen offset:1024 lds
  v_mfma_f32_16x16x32_bf16 v[48:51], v[132:135], v[216:219], v[48:51]
  ds_read_b64_tr_b16 v[132:133], v114 offset:13312
  v_mfma_f32_16x16x32_bf16 v[4:7], v[136:139], v[212:215], v[4:7]
  ds_read_b64_tr_b16 v[134:135], v114 offset:19456
  v_mfma_f32_16x16x32_bf16 v[52:55], v[136:139], v[216:219], v[52:55]
  ds_read_b64_tr_b16 v[136:137], v115 offset:13312
  buffer_load_dwordx4 v109, s[8:11], s17 offen offset:2048 lds
  s_add_u32 s17, s17, 196608
  v_mfma_f32_16x16x32_bf16 v[8:11], v[140:143], v[212:215], v[8:11]
  ds_read_b64_tr_b16 v[138:139], v115 offset:19456
  v_mfma_f32_16x16x32_bf16 v[56:59], v[140:143], v[216:219], v[56:59]
  ds_read_b64_tr_b16 v[140:141], v116 offset:13312
  v_mfma_f32_16x16x32_bf16 v[12:15], v[144:147], v[212:215], v[12:15]
  ds_read_b64_tr_b16 v[142:143], v116 offset:19456
  s_add_u32 m0, s39, 39936
  s_nop 0
  buffer_load_dword v106, s[4:7], s19 offen sc1 lds
  s_add_u32 s19, s19, 131072
  v_mfma_f32_16x16x32_bf16 v[60:63], v[144:147], v[216:219], v[60:63]
  ds_read_b64_tr_b16 v[144:145], v117 offset:13312
  v_mfma_f32_16x16x32_bf16 v[16:19], v[148:151], v[212:215], v[16:19]
  ds_read_b64_tr_b16 v[146:147], v117 offset:19456
  v_mfma_f32_16x16x32_bf16 v[64:67], v[148:151], v[216:219], v[64:67]
  ds_read_b64_tr_b16 v[148:149], v114 offset:14336
  v_mfma_f32_16x16x32_bf16 v[20:23], v[152:155], v[212:215], v[20:23]
  ds_read_b64_tr_b16 v[150:151], v114 offset:20480
  buffer_load_dwordx4 v[236:239], v105, s[4:7], s16 offen sc1
  v_mfma_f32_16x16x32_bf16 v[68:71], v[152:155], v[216:219], v[68:71]
  ds_read_b64_tr_b16 v[152:153], v115 offset:14336
  v_mfma_f32_16x16x32_bf16 v[24:27], v[156:159], v[212:215], v[24:27]
  ds_read_b64_tr_b16 v[154:155], v115 offset:20480
  v_mfma_f32_16x16x32_bf16 v[72:75], v[156:159], v[216:219], v[72:75]
  ds_read_b64_tr_b16 v[156:157], v116 offset:14336
  buffer_load_dwordx4 v[240:243], v105, s[4:7], s16 offen offset:1024 sc1
  s_add_u32 s16, s16, 131072
  s_waitcnt lgkmcnt(10)
  v_mfma_f32_16x16x32_bf16 v[28:31], v[160:163], v[212:215], v[28:31]
  ds_read_b64_tr_b16 v[158:159], v116 offset:20480
  v_mfma_f32_16x16x32_bf16 v[76:79], v[160:163], v[216:219], v[76:79]
  ds_read_b64_tr_b16 v[160:161], v117 offset:14336
  v_mfma_f32_16x16x32_bf16 v[32:35], v[212:215], v[164:167], v[32:35]
  ds_read_b64_tr_b16 v[162:163], v117 offset:20480
  s_mov_b32 s8, s26
  s_mov_b32 s9, s27
  s_mov_b32 s10, 0x200000
  s_mov_b32 s11, 0x20000
  v_lshrrev_b32 v127, 3, v104
  v_lshlrev_b32 v127, 11, v127
  v_and_b32 v126, 7, v104
  v_lshl_add_u32 v127, v126, 8, v127
  s_lshr_b32 s34, s2, 3
  s_lshl_b32 s34, s34, 2
  s_add_u32 s34, s34, s3
  s_lshl_b32 s34, s34, 14
  s_and_b32 s35, s2, 1
  s_lshl_b32 s35, s35, 7
  s_add_u32 s34, s34, s35
  buffer_load_dword v113, v127, s[8:11], s34 offen
  v_mfma_f32_16x16x32_bf16 v[80:83], v[216:219], v[164:167], v[80:83]
  ds_read_b64_tr_b16 v[164:165], v114 offset:15360
  v_mfma_f32_16x16x32_bf16 v[36:39], v[212:215], v[168:171], v[36:39]
  ds_read_b64_tr_b16 v[166:167], v114 offset:21504
  v_mfma_f32_16x16x32_bf16 v[84:87], v[216:219], v[168:171], v[84:87]
  ds_read_b64_tr_b16 v[168:169], v115 offset:15360
  s_getpc_b64 s[8:9]
  L_pc_24:
  s_add_u32 s8, s8, k5_kernel-L_pc_24
  s_addc_u32 s9, s9, 0
  s_lshr_b32 s34, s2, 3
  s_lshl_b32 s34, s34, 2
  s_add_u32 s34, s34, s3
  s_lshl_b32 s34, s34, 13
  v_lshlrev_b32 v128, 7, v104
  v_add_u32 v128, s34, v128
  v_min_u32 v128, L_k56_seam-k5_kernel-4, v128
  v_mov_b32 v129, s9
  v_add_co_u32 v128, vcc, s8, v128
  s_nop 1
  v_addc_co_u32 v129, vcc, 0, v129, vcc
  global_load_dword v113, v[128:129], off
  v_mfma_f32_16x16x32_bf16 v[40:43], v[212:215], v[172:175], v[40:43]
  ds_read_b64_tr_b16 v[170:171], v115 offset:21504
  v_mfma_f32_16x16x32_bf16 v[88:91], v[216:219], v[172:175], v[88:91]
  ds_read_b64_tr_b16 v[172:173], v116 offset:15360
  v_mfma_f32_16x16x32_bf16 v[44:47], v[212:215], v[176:179], v[44:47]
  ds_read_b64_tr_b16 v[174:175], v116 offset:21504
  v_mfma_f32_16x16x32_bf16 v[92:95], v[216:219], v[176:179], v[92:95]
  ds_read_b64_tr_b16 v[176:177], v117 offset:15360
  ds_read_b64_tr_b16 v[178:179], v117 offset:21504
  s_waitcnt vmcnt(10) lgkmcnt(10)
  s_barrier
  v_mfma_f32_16x16x32_bf16 v[96:99], v[180:183], v[188:191], v[96:99]
  ds_read_b64_tr_b16 v[180:181], v118 offset:27648
  v_mfma_f32_16x16x32_bf16 v[100:103], v[188:191], v[184:187], v[100:103]
  ds_read_b64_tr_b16 v[182:183], v118 offset:33792
  ds_read_b128 v[188:191], v119 offset:38912
  ds_read_b64_tr_b16 v[184:185], v118 offset:28672
  v_mfma_f32_16x16x32_bf16 v[0:3], v[132:135], v[220:223], v[0:3]
  ds_read_b64_tr_b16 v[186:187], v118 offset:34816
  v_mfma_f32_16x16x32_bf16 v[48:51], v[132:135], v[224:227], v[48:51]
  ds_read_b64_tr_b16 v[132:133], v114 offset:26624
  v_mfma_f32_16x16x32_bf16 v[4:7], v[136:139], v[220:223], v[4:7]
  ds_read_b64_tr_b16 v[134:135], v114 offset:32768
  v_mfma_f32_16x16x32_bf16 v[52:55], v[136:139], v[224:227], v[52:55]
  ds_read_b64_tr_b16 v[136:137], v115 offset:26624
  v_mfma_f32_16x16x32_bf16 v[8:11], v[140:143], v[220:223], v[8:11]
  ds_read_b64_tr_b16 v[138:139], v115 offset:32768
  v_mfma_f32_16x16x32_bf16 v[56:59], v[140:143], v[224:227], v[56:59]
  ds_read_b64_tr_b16 v[140:141], v116 offset:26624
  v_mfma_f32_16x16x32_bf16 v[12:15], v[144:147], v[220:223], v[12:15]
  ds_read_b64_tr_b16 v[142:143], v116 offset:32768
  v_mfma_f32_16x16x32_bf16 v[60:63], v[144:147], v[224:227], v[60:63]
  ds_read_b64_tr_b16 v[144:145], v117 offset:26624
  v_mfma_f32_16x16x32_bf16 v[16:19], v[148:151], v[220:223], v[16:19]
  ds_read_b64_tr_b16 v[146:147], v117 offset:32768
  v_mfma_f32_16x16x32_bf16 v[64:67], v[148:151], v[224:227], v[64:67]
  ds_read_b64_tr_b16 v[148:149], v114 offset:27648
  v_mfma_f32_16x16x32_bf16 v[20:23], v[152:155], v[220:223], v[20:23]
  ds_read_b64_tr_b16 v[150:151], v114 offset:33792
  v_mfma_f32_16x16x32_bf16 v[68:71], v[152:155], v[224:227], v[68:71]
  ds_read_b64_tr_b16 v[152:153], v115 offset:27648
  v_mfma_f32_16x16x32_bf16 v[24:27], v[156:159], v[220:223], v[24:27]
  ds_read_b64_tr_b16 v[154:155], v115 offset:33792
  v_mfma_f32_16x16x32_bf16 v[72:75], v[156:159], v[224:227], v[72:75]
  ds_read_b64_tr_b16 v[156:157], v116 offset:27648
  s_waitcnt lgkmcnt(10)
  v_mfma_f32_16x16x32_bf16 v[28:31], v[160:163], v[220:223], v[28:31]
  ds_read_b64_tr_b16 v[158:159], v116 offset:33792
  v_mfma_f32_16x16x32_bf16 v[76:79], v[160:163], v[224:227], v[76:79]
  ds_read_b64_tr_b16 v[160:161], v117 offset:27648
  v_mfma_f32_16x16x32_bf16 v[32:35], v[220:223], v[164:167], v[32:35]
  ds_read_b64_tr_b16 v[162:163], v117 offset:33792
  v_mfma_f32_16x16x32_bf16 v[80:83], v[224:227], v[164:167], v[80:83]
  ds_read_b64_tr_b16 v[164:165], v114 offset:28672
  v_mfma_f32_16x16x32_bf16 v[36:39], v[220:223], v[168:171], v[36:39]
  ds_read_b64_tr_b16 v[166:167], v114 offset:34816
  v_mfma_f32_16x16x32_bf16 v[84:87], v[224:227], v[168:171], v[84:87]
  ds_read_b64_tr_b16 v[168:169], v115 offset:28672
  v_mfma_f32_16x16x32_bf16 v[40:43], v[220:223], v[172:175], v[40:43]
  ds_read_b64_tr_b16 v[170:171], v115 offset:34816
  v_mfma_f32_16x16x32_bf16 v[88:91], v[224:227], v[172:175], v[88:91]
  ds_read_b64_tr_b16 v[172:173], v116 offset:28672
  v_mfma_f32_16x16x32_bf16 v[44:47], v[220:223], v[176:179], v[44:47]
  ds_read_b64_tr_b16 v[174:175], v116 offset:34816
  v_mfma_f32_16x16x32_bf16 v[92:95], v[224:227], v[176:179], v[92:95]
  ds_read_b64_tr_b16 v[176:177], v117 offset:28672
  ds_read_b64_tr_b16 v[178:179], v117 offset:34816
  s_waitcnt vmcnt(4) lgkmcnt(10)
  s_barrier
  v_mfma_f32_16x16x32_bf16 v[96:99], v[180:183], v[188:191], v[96:99]
  ds_read_b64_tr_b16 v[180:181], v118 offset:40960
  v_mfma_f32_16x16x32_bf16 v[100:103], v[188:191], v[184:187], v[100:103]
  ds_read_b64_tr_b16 v[182:183], v118 offset:47104
  ds_read_b128 v[188:191], v119 offset:52224
  ds_read_b64_tr_b16 v[184:185], v118 offset:41984
  v_mfma_f32_16x16x32_bf16 v[0:3], v[132:135], v[228:231], v[0:3]
  ds_read_b64_tr_b16 v[186:187], v118 offset:48128
  v_mfma_f32_16x16x32_bf16 v[48:51], v[132:135], v[232:235], v[48:51]
  ds_read_b64_tr_b16 v[132:133], v114 offset:39936
  v_mfma_f32_16x16x32_bf16 v[4:7], v[136:139], v[228:231], v[4:7]
  ds_read_b64_tr_b16 v[134:135], v114 offset:46080
  v_mfma_f32_16x16x32_bf16 v[52:55], v[136:139], v[232:235], v[52:55]
  ds_read_b64_tr_b16 v[136:137], v115 offset:39936
  v_mfma_f32_16x16x32_bf16 v[8:11], v[140:143], v[228:231], v[8:11]
  ds_read_b64_tr_b16 v[138:139], v115 offset:46080
  v_mfma_f32_16x16x32_bf16 v[56:59], v[140:143], v[232:235], v[56:59]
  ds_read_b64_tr_b16 v[140:141], v116 offset:39936
  v_mfma_f32_16x16x32_bf16 v[12:15], v[144:147], v[228:231], v[12:15]
  ds_read_b64_tr_b16 v[142:143], v116 offset:46080
  v_mfma_f32_16x16x32_bf16 v[60:63], v[144:147], v[232:235], v[60:63]
  ds_read_b64_tr_b16 v[144:145], v117 offset:39936
  v_mfma_f32_16x16x32_bf16 v[16:19], v[148:151], v[228:231], v[16:19]
  ds_read_b64_tr_b16 v[146:147], v117 offset:46080
  v_mfma_f32_16x16x32_bf16 v[64:67], v[148:151], v[232:235], v[64:67]
  ds_read_b64_tr_b16 v[148:149], v114 offset:40960
  v_mfma_f32_16x16x32_bf16 v[20:23], v[152:155], v[228:231], v[20:23]
  ds_read_b64_tr_b16 v[150:151], v114 offset:47104
  v_mfma_f32_16x16x32_bf16 v[68:71], v[152:155], v[232:235], v[68:71]
  ds_read_b64_tr_b16 v[152:153], v115 offset:40960
  v_mfma_f32_16x16x32_bf16 v[24:27], v[156:159], v[228:231], v[24:27]
  ds_read_b64_tr_b16 v[154:155], v115 offset:47104
  v_mfma_f32_16x16x32_bf16 v[72:75], v[156:159], v[232:235], v[72:75]
  ds_read_b64_tr_b16 v[156:157], v116 offset:40960
  s_waitcnt lgkmcnt(10)
  v_mfma_f32_16x16x32_bf16 v[28:31], v[160:163], v[228:231], v[28:31]
  ds_read_b64_tr_b16 v[158:159], v116 offset:47104
  v_mfma_f32_16x16x32_bf16 v[76:79], v[160:163], v[232:235], v[76:79]
  ds_read_b64_tr_b16 v[160:161], v117 offset:40960
  v_mfma_f32_16x16x32_bf16 v[32:35], v[228:231], v[164:167], v[32:35]
  ds_read_b64_tr_b16 v[162:163], v117 offset:47104
  v_mfma_f32_16x16x32_bf16 v[80:83], v[232:235], v[164:167], v[80:83]
  ds_read_b64_tr_b16 v[164:165], v114 offset:41984
  v_mfma_f32_16x16x32_bf16 v[36:39], v[228:231], v[168:171], v[36:39]
  ds_read_b64_tr_b16 v[166:167], v114 offset:48128
  v_mfma_f32_16x16x32_bf16 v[84:87], v[232:235], v[168:171], v[84:87]
  ds_read_b64_tr_b16 v[168:169], v115 offset:41984
  v_mfma_f32_16x16x32_bf16 v[40:43], v[228:231], v[172:175], v[40:43]
  ds_read_b64_tr_b16 v[170:171], v115 offset:48128
  v_mfma_f32_16x16x32_bf16 v[88:91], v[232:235], v[172:175], v[88:91]
  ds_read_b64_tr_b16 v[172:173], v116 offset:41984
  v_mfma_f32_16x16x32_bf16 v[44:47], v[228:231], v[176:179], v[44:47]
  ds_read_b64_tr_b16 v[174:175], v116 offset:48128
  v_mfma_f32_16x16x32_bf16 v[92:95], v[232:235], v[176:179], v[92:95]
  ds_read_b64_tr_b16 v[176:177], v117 offset:41984
  ds_read_b64_tr_b16 v[178:179], v117 offset:48128
  s_waitcnt vmcnt(2) lgkmcnt(10)
  s_barrier
  v_mfma_f32_16x16x32_bf16 v[96:99], v[180:183], v[188:191], v[96:99]
  v_mfma_f32_16x16x32_bf16 v[100:103], v[188:191], v[184:187], v[100:103]
  v_mfma_f32_16x16x32_bf16 v[0:3], v[132:135], v[236:239], v[0:3]
  v_mfma_f32_16x16x32_bf16 v[48:51], v[132:135], v[240:243], v[48:51]
  v_mfma_f32_16x16x32_bf16 v[4:7], v[136:139], v[236:239], v[4:7]
  v_mfma_f32_16x16x32_bf16 v[52:55], v[136:139], v[240:243], v[52:55]
  v_mfma_f32_16x16x32_bf16 v[8:11], v[140:143], v[236:239], v[8:11]
  v_mfma_f32_16x16x32_bf16 v[56:59], v[140:143], v[240:243], v[56:59]
  v_mfma_f32_16x16x32_bf16 v[12:15], v[144:147], v[236:239], v[12:15]
  v_mfma_f32_16x16x32_bf16 v[60:63], v[144:147], v[240:243], v[60:63]
  v_mfma_f32_16x16x32_bf16 v[16:19], v[148:151], v[236:239], v[16:19]
  v_mfma_f32_16x16x32_bf16 v[64:67], v[148:151], v[240:243], v[64:67]
  v_mfma_f32_16x16x32_bf16 v[20:23], v[152:155], v[236:239], v[20:23]
  v_mfma_f32_16x16x32_bf16 v[68:71], v[152:155], v[240:243], v[68:71]
  v_mfma_f32_16x16x32_bf16 v[24:27], v[156:159], v[236:239], v[24:27]
  v_mfma_f32_16x16x32_bf16 v[72:75], v[156:159], v[240:243], v[72:75]
  s_waitcnt lgkmcnt(8)
  v_mfma_f32_16x16x32_bf16 v[28:31], v[160:163], v[236:239], v[28:31]
  v_mfma_f32_16x16x32_bf16 v[76:79], v[160:163], v[240:243], v[76:79]
  s_waitcnt lgkmcnt(6)
  v_mfma_f32_16x16x32_bf16 v[32:35], v[236:239], v[164:167], v[32:35]
  v_mfma_f32_16x16x32_bf16 v[80:83], v[240:243], v[164:167], v[80:83]
  s_waitcnt lgkmcnt(4)
  v_mfma_f32_16x16x32_bf16 v[36:39], v[236:239], v[168:171], v[36:39]
  v_mfma_f32_16x16x32_bf16 v[84:87], v[240:243], v[168:171], v[84:87]
  s_waitcnt lgkmcnt(2)
  v_mfma_f32_16x16x32_bf16 v[40:43], v[236:239], v[172:175], v[40:43]
  v_mfma_f32_16x16x32_bf16 v[88:91], v[240:243], v[172:175], v[88:91]
  s_waitcnt lgkmcnt(0)
  v_mfma_f32_16x16x32_bf16 v[44:47], v[236:239], v[176:179], v[44:47]
  v_mfma_f32_16x16x32_bf16 v[92:95], v[240:243], v[176:179], v[92:95]
  s_nop 7
  s_nop 1
  s_add_u32 s12, s20, 0x500000
  s_addc_u32 s13, s21, 0
  s_mov_b32 s14, 0x400000
  s_mov_b32 s15, 0x20000
  s_lshl_b32 s33, s3, 12
  v_add_u32 v110, s33, v119
  s_lshr_b32 s33, s3, 1
  s_lshl_b32 s33, s33, 10
  s_and_b32 s34, s3, 1
  s_lshl_b32 s34, s34, 3
  s_add_u32 s33, s33, s34
  v_add_u32 v111, s33, v119
  v_cvt_pk_bf16_f32 v196, v96, v97
  v_cvt_pk_bf16_f32 v197, v98, v99
  v_cvt_pk_bf16_f32 v198, v100, v101
  v_cvt_pk_bf16_f32 v199, v102, v103
  v_cvt_pk_bf16_f32 v164, v64, v65
  v_cvt_pk_bf16_f32 v165, v66, v67
  v_cvt_pk_bf16_f32 v176, v80, v81
  v_cvt_pk_bf16_f32 v177, v82, v83
  v_cvt_pk_bf16_f32 v166, v68, v69
  v_cvt_pk_bf16_f32 v167, v70, v71
  v_cvt_pk_bf16_f32 v182, v84, v85
  v_cvt_pk_bf16_f32 v183, v86, v87
  v_cvt_pk_bf16_f32 v168, v72, v73
  v_cvt_pk_bf16_f32 v169, v74, v75
  v_cvt_pk_bf16_f32 v188, v88, v89
  v_cvt_pk_bf16_f32 v189, v90, v91
  v_cvt_pk_bf16_f32 v170, v76, v77
  v_cvt_pk_bf16_f32 v171, v78, v79
  v_cvt_pk_bf16_f32 v194, v92, v93
  v_cvt_pk_bf16_f32 v195, v94, v95
  ds_write_b64 v111, v[196:197] offset:0
  ds_write_b64 v111, v[198:199] offset:2048
  ds_write_b128 v110, v[164:167] offset:4096
  ds_write_b64 v110, v[176:177] offset:6144
  ds_write_b64 v110, v[182:183] offset:6152
  ds_write_b128 v110, v[168:171] offset:5120
  ds_write_b64 v110, v[188:189] offset:7168
  ds_write_b64 v110, v[194:195] offset:7176
  v_cvt_pk_bf16_f32 v132, v0, v1
  v_cvt_pk_bf16_f32 v133, v2, v3
  v_cvt_pk_bf16_f32 v140, v48, v49
  v_cvt_pk_bf16_f32 v141, v50, v51
  v_cvt_pk_bf16_f32 v156, v16, v17
  v_cvt_pk_bf16_f32 v157, v18, v19
  v_cvt_pk_bf16_f32 v174, v32, v33
  v_cvt_pk_bf16_f32 v175, v34, v35
  v_cvt_pk_bf16_f32 v134, v4, v5
  v_cvt_pk_bf16_f32 v135, v6, v7
  v_cvt_pk_bf16_f32 v142, v52, v53
  v_cvt_pk_bf16_f32 v143, v54, v55
  v_cvt_pk_bf16_f32 v158, v20, v21
  v_cvt_pk_bf16_f32 v159, v22, v23
  v_cvt_pk_bf16_f32 v180, v36, v37
  v_cvt_pk_bf16_f32 v181, v38, v39
  v_cvt_pk_bf16_f32 v136, v8, v9
  v_cvt_pk_bf16_f32 v137, v10, v11
  v_cvt_pk_bf16_f32 v144, v56, v57
  v_cvt_pk_bf16_f32 v145, v58, v59
  v_cvt_pk_bf16_f32 v160, v24, v25
  v_cvt_pk_bf16_f32 v161, v26, v27
  v_cvt_pk_bf16_f32 v186, v40, v41
  v_cvt_pk_bf16_f32 v187, v42, v43
  v_cvt_pk_bf16_f32 v138, v12, v13
  v_cvt_pk_bf16_f32 v139, v14, v15
  v_cvt_pk_bf16_f32 v146, v60, v61
  v_cvt_pk_bf16_f32 v147, v62, v63
  v_cvt_pk_bf16_f32 v162, v28, v29
  v_cvt_pk_bf16_f32 v163, v30, v31
  v_cvt_pk_bf16_f32 v192, v44, v45
  v_cvt_pk_bf16_f32 v193, v46, v47
  s_waitcnt lgkmcnt(0)
  s_barrier
  ds_read_b128 v[148:151], v110 offset:0
  ds_read_b64 v[172:173], v110 offset:2048
  ds_read_b64 v[178:179], v110 offset:2056
  ds_read_b128 v[152:155], v110 offset:1024
  ds_read_b64 v[184:185], v110 offset:3072
  ds_read_b64 v[190:191], v110 offset:3080
  v_mfma_f32_16x16x32_bf16 v[200:203], v[156:159], v[140:143], 0
  v_mfma_f32_16x16x32_bf16 v[204:207], v[164:167], v[140:143], 0
  v_mfma_f32_16x16x32_bf16 v[208:211], v[160:163], v[144:147], 0
  v_mfma_f32_16x16x32_bf16 v[212:215], v[168:171], v[144:147], 0
  s_or_b32 s33, s30, s3
  s_cmp_eq_u32 s33, 0
  s_cselect_b32 s33, 0xf149f2ca, 0
  v_mov_b32 v232, s33
  v_cndmask_b32_e64 v120, v232, 0, s[44:45]
  v_cndmask_b32_e64 v121, v232, 0, s[46:47]
  v_and_b32 v122, 1, v104
  v_lshlrev_b32 v122, 4, v122
  s_waitcnt lgkmcnt(0)
  v_mfma_f32_16x16x32_bf16 v[216:219], v[148:151], v[132:135], 0
  v_mfma_f32_16x16x32_bf16 v[220:223], v[156:159], v[132:135], 0
  v_mfma_f32_16x16x32_bf16 v[224:227], v[152:155], v[136:139], 0
  v_mfma_f32_16x16x32_bf16 v[228:231], v[160:163], v[136:139], 0
  s_mov_b32 s40, 0x3e8293ee
  v_cndmask_b32_e64 v200, v200, v201, s[48:49]
  v_cndmask_b32_e64 v202, v202, v203, s[48:49]
  v_cndmask_b32_e64 v204, v204, v205, s[48:49]
  v_cndmask_b32_e64 v206, v206, v207, s[48:49]
  v_cndmask_b32_e64 v208, v208, v209, s[48:49]
  v_cndmask_b32_e64 v210, v210, v211, s[48:49]
  v_cndmask_b32_e64 v212, v212, v213, s[48:49]
  v_cndmask_b32_e64 v214, v214, v215, s[48:49]
  v_cndmask_b32_e64 v216, v216, v217, s[48:49]
  v_cndmask_b32_e64 v218, v218, v219, s[48:49]
  v_cndmask_b32_e64 v220, v220, v221, s[48:49]
  v_cndmask_b32_e64 v222, v222, v223, s[48:49]
  v_cndmask_b32_e64 v224, v224, v225, s[48:49]
  v_cndmask_b32_e64 v226, v226, v227, s[48:49]
  v_cndmask_b32_e64 v228, v228, v229, s[48:49]
  v_cndmask_b32_e64 v230, v230, v231, s[48:49]
  v_cndmask_b32_e64 v200, v200, v204, s[44:45]
  v_cndmask_b32_e64 v201, v202, v206, s[46:47]
  v_cndmask_b32_e64 v208, v208, v212, s[44:45]
  v_cndmask_b32_e64 v209, v210, v214, s[46:47]
  v_cndmask_b32_e64 v216, v216, v220, s[44:45]
  v_cndmask_b32_e64 v217, v218, v222, s[46:47]
  v_cndmask_b32_e64 v224, v224, v228, s[44:45]
  v_cndmask_b32_e64 v225, v226, v230, s[46:47]
  v_mul_f32 v200, s40, v200
  v_mul_f32 v201, s40, v201
  v_mul_f32 v208, s40, v208
  v_mul_f32 v209, s40, v209
  v_fma_f32 v216, v216, s40, v120
  v_fma_f32 v217, v217, s40, v121
  v_fma_f32 v224, v224, s40, v120
  v_fma_f32 v225, v225, s40, v121
  v_max_f32 v232, v200, v201
  v_max_f32 v233, v208, v209
  v_max_f32 v234, v216, v217
  v_max_f32 v235, v224, v225
  v_mov_b32 v236, v232
  v_mov_b32 v237, v233
  v_mov_b32 v238, v234
  v_mov_b32 v239, v235
  s_nop 1
  v_permlane16_swap_b32 v236, v232
  v_permlane16_swap_b32 v237, v233
  v_permlane16_swap_b32 v238, v234
  v_permlane16_swap_b32 v239, v235
  s_nop 1
  v_max_f32 v232, v232, v236
  v_max_f32 v233, v233, v237
  v_max_f32 v234, v234, v238
  v_max_f32 v235, v235, v239
  v_mov_b32 v236, v232
  v_mov_b32 v237, v233
  v_mov_b32 v238, v234
  v_mov_b32 v239, v235
  s_nop 1
  v_permlane32_swap_b32 v236, v232
  v_permlane32_swap_b32 v237, v233
  v_permlane32_swap_b32 v238, v234
  v_permlane32_swap_b32 v239, v235
  s_nop 1
  v_max_f32 v232, v232, v236
  v_max_f32 v233, v233, v237
  v_max_f32 v234, v234, v238
  v_max_f32 v235, v235, v239
  v_sub_f32 v200, v200, v232
  v_sub_f32 v201, v201, v232
  v_sub_f32 v208, v208, v233
  v_sub_f32 v209, v209, v233
  v_sub_f32 v216, v216, v234
  v_sub_f32 v217, v217, v234
  v_sub_f32 v224, v224, v235
  v_sub_f32 v225, v225, v235
  v_exp_f32 v200, v200
  v_exp_f32 v201, v201
  v_exp_f32 v208, v208
  v_exp_f32 v209, v209
  v_exp_f32 v216, v216
  v_exp_f32 v217, v217
  v_exp_f32 v224, v224
  v_exp_f32 v225, v225
  s_nop 0
  v_add_f32 v232, v200, v201
  v_add_f32 v233, v208, v209
  v_add_f32 v234, v216, v217
  v_add_f32 v235, v224, v225
  v_mov_b32 v236, v232
  v_mov_b32 v237, v233
  v_mov_b32 v238, v234
  v_mov_b32 v239, v235
  s_nop 1
  v_permlane16_swap_b32 v236, v232
  v_permlane16_swap_b32 v237, v233
  v_permlane16_swap_b32 v238, v234
  v_permlane16_swap_b32 v239, v235
  s_nop 1
  v_add_f32 v232, v232, v236
  v_add_f32 v233, v233, v237
  v_add_f32 v234, v234, v238
  v_add_f32 v235, v235, v239
  v_mov_b32 v236, v232
  v_mov_b32 v237, v233
  v_mov_b32 v238, v234
  v_mov_b32 v239, v235
  s_nop 1
  v_permlane32_swap_b32 v236, v232
  v_permlane32_swap_b32 v237, v233
  v_permlane32_swap_b32 v238, v234
  v_permlane32_swap_b32 v239, v235
  s_nop 1
  v_add_f32 v232, v232, v236
  v_add_f32 v233, v233, v237
  v_add_f32 v234, v234, v238
  v_add_f32 v235, v235, v239
  v_rcp_f32 v232, v232
  v_rcp_f32 v233, v233
  v_rcp_f32 v234, v234
  v_rcp_f32 v235, v235
  s_nop 0
  v_mul_f32 v200, v200, v232
  v_mul_f32 v201, v201, v232
  v_mul_f32 v208, v208, v233
  v_mul_f32 v209, v209, v233
  v_mul_f32 v216, v216, v234
  v_mul_f32 v217, v217, v234
  v_mul_f32 v224, v224, v235
  v_mul_f32 v225, v225, v235
  v_cvt_pk_bf16_f32 v200, v200, 0
  v_cvt_pk_bf16_f32 v201, v201, 0
  v_cvt_pk_bf16_f32 v208, v208, 0
  v_cvt_pk_bf16_f32 v209, v209, 0
  v_cvt_pk_bf16_f32 v216, v216, 0
  v_cvt_pk_bf16_f32 v217, v217, 0
  v_cvt_pk_bf16_f32 v224, v224, 0
  v_cvt_pk_bf16_f32 v225, v225, 0
  v_lshlrev_b32 v200, v122, v200
  v_lshlrev_b32 v201, v122, v201
  v_lshlrev_b32 v208, v122, v208
  v_lshlrev_b32 v209, v122, v209
  v_lshlrev_b32 v216, v122, v216
  v_lshlrev_b32 v217, v122, v217
  v_lshlrev_b32 v224, v122, v224
  v_lshlrev_b32 v225, v122, v225
  v_cndmask_b32_e64 v132, v200, 0, s[44:45]
  v_cndmask_b32_e64 v134, 0, v200, s[44:45]
  v_cndmask_b32_e64 v133, v201, 0, s[46:47]
  v_cndmask_b32_e64 v135, 0, v201, s[46:47]
  v_cndmask_b32_e64 v136, v208, 0, s[44:45]
  v_cndmask_b32_e64 v138, 0, v208, s[44:45]
  v_cndmask_b32_e64 v137, v209, 0, s[46:47]
  v_cndmask_b32_e64 v139, 0, v209, s[46:47]
  v_cndmask_b32_e64 v140, v216, 0, s[44:45]
  v_cndmask_b32_e64 v142, 0, v216, s[44:45]
  v_cndmask_b32_e64 v141, v217, 0, s[46:47]
  v_cndmask_b32_e64 v143, 0, v217, s[46:47]
  v_cndmask_b32_e64 v144, v224, 0, s[44:45]
  v_cndmask_b32_e64 v146, 0, v224, s[44:45]
  v_cndmask_b32_e64 v145, v225, 0, s[46:47]
  v_cndmask_b32_e64 v147, 0, v225, s[46:47]
  s_nop 1
  v_mfma_f32_16x16x32_bf16 v[200:203], v[174:177], v[132:135], 0
  v_mfma_f32_16x16x32_bf16 v[204:207], v[180:183], v[132:135], 0
  v_mfma_f32_16x16x32_bf16 v[208:211], v[186:189], v[136:139], 0
  v_mfma_f32_16x16x32_bf16 v[212:215], v[192:195], v[136:139], 0
  v_mfma_f32_16x16x32_bf16 v[216:219], v[172:175], v[140:143], 0
  v_mfma_f32_16x16x32_bf16 v[220:223], v[178:181], v[140:143], 0
  v_mfma_f32_16x16x32_bf16 v[224:227], v[184:187], v[144:147], 0
  v_mfma_f32_16x16x32_bf16 v[228:231], v[190:193], v[144:147], 0
  s_lshl_b32 s41, s31, 18
  s_add_u32 s42, s41, 131072
  s_nop 1
  v_cvt_pk_bf16_f32 v148, v200, v201
  v_cvt_pk_bf16_f32 v149, v202, v203
  v_cvt_pk_bf16_f32 v150, v204, v205
  v_cvt_pk_bf16_f32 v151, v206, v207
  buffer_store_dwordx4 v[148:151], v105, s[12:15], s41 offen offset:1024 sc1
  v_cvt_pk_bf16_f32 v152, v208, v209
  v_cvt_pk_bf16_f32 v153, v210, v211
  v_cvt_pk_bf16_f32 v154, v212, v213
  v_cvt_pk_bf16_f32 v155, v214, v215
  buffer_store_dwordx4 v[152:155], v105, s[12:15], s42 offen offset:1024 sc1
  v_cvt_pk_bf16_f32 v156, v216, v217
  v_cvt_pk_bf16_f32 v157, v218, v219
  v_cvt_pk_bf16_f32 v158, v220, v221
  v_cvt_pk_bf16_f32 v159, v222, v223
  buffer_store_dwordx4 v[156:159], v105, s[12:15], s41 offen offset:0 sc1
  s_nop 0
  v_cvt_pk_bf16_f32 v160, v224, v225
  v_cvt_pk_bf16_f32 v161, v226, v227
  v_cvt_pk_bf16_f32 v162, v228, v229
  v_cvt_pk_bf16_f32 v163, v230, v231
  buffer_store_dwordx4 v[160:163], v105, s[12:15], s42 offen offset:0 sc1
  s_endpgm
L_slow_22:
  s_mov_b32 s33, 262144
L_spin_26:
  buffer_load_dword v130, v129, s[64:67], 0 offen sc1
  s_waitcnt vmcnt(0)
  v_cmp_ne_u32 vcc, s100, v130
  s_nop 1
  s_cmp_eq_u64 vcc, 0
  s_cbranch_scc1 L_back_23
  s_sub_u32 s33, s33, 1
  s_cmp_lg_u32 s33, 0
  s_cbranch_scc1 L_spin_26
  s_branch L_back_23
L_slow_20:
  s_mov_b32 s33, 262144
L_spin_27:
  buffer_load_dword v130, v131, s[64:67], 0 offen sc1
  s_waitcnt vmcnt(0)
  v_cmp_ne_u32 vcc, s100, v130
  s_nop 1
  s_cmp_eq_u64 vcc, 0
  s_cbranch_scc1 L_back_21
  s_sub_u32 s33, s33, 1
  s_cmp_lg_u32 s33, 0
  s_cbranch_scc1 L_spin_27
  s_branch L_back_21
L_helper_2:
  s_and_b32 s39, s3, 3
  v_and_b32 v3, 255, v128
  v_mov_b32 v101, 1
  v_mov_b32 v102, 63744
  ds_write_b32 v102, v100 offset:8
  v_mov_b32 v96, -1
  v_mov_b32 v97, -1
  v_mov_b32 v98, -1
  v_mov_b32 v99, -1
  v_lshlrev_b32 v95, 2, v104
  s_mov_b32 s12, s20
  s_mov_b32 s13, s21
  s_mov_b32 s14, 0x18000
  s_mov_b32 s15, 0x20000
  s_mov_b32 s44, s92
  s_mov_b32 s45, s93
  s_mov_b32 s46, 0x800
  s_mov_b32 s47, 0x20000
  s_mov_b32 s48, s94
  s_mov_b32 s49, s95
  s_mov_b32 s50, 0xc00000
  s_mov_b32 s51, 0x20000
  s_add_u32 s52, s20, 0x40000
  s_addc_u32 s53, s21, 0
  s_mov_b32 s54, 0x0
  s_mov_b32 s55, 0x20000
  s_add_u32 s56, s20, 0x80000
  s_addc_u32 s57, s21, 0
  s_mov_b32 s58, 0x0
  s_mov_b32 s59, 0x20000
  s_cmp_eq_u32 s39, 1
  s_cselect_b32 s54, 0x40000, 0
  s_cselect_b32 s58, 262144, 0
  s_lshl_b32 s33, s2, 10
  buffer_store_dwordx4 v[96:99], v119, s[52:55], s33 offen sc1
  v_min_u32 v92, 15, v104
  v_lshlrev_b32 v92, 6, v92
  s_lshl_b32 s33, s2, 10
  buffer_store_dword v96, v92, s[56:59], s33 offen sc1
  s_and_b32 s31, s2, 3
  s_lshr_b32 s30, s2, 2
  s_lshl_b32 s33, s31, 8
  v_add_u32 v2, s33, v3
  v_and_b32 v1, -8, v2
  s_movk_i32 s33, 12288
  v_mul_u32_u24 v1, s33, v1
  v_lshlrev_b32 v2, 1, v2
  v_and_b32 v94, 7, v3
  v_lshl_add_u32 v1, v94, 4, v1
  s_mov_b32 s50, 12582912
  s_mul_i32 s34, s31, 24576
  s_lshl_b32 s33, s30, 8
  s_add_u32 s34, s34, s33
  s_add_u32 s34, s34, 8192
  s_lshl_b32 s35, s30, 7
  s_add_u32 s35, s35, 4096
  s_barrier
  s_barrier
  s_barrier
  s_bitcmp1_b32 s3, 0
  s_cselect_b32 s4, s62, s60
  s_cselect_b32 s5, s63, s61
  s_lshl_b32 s6, s2, 1
  s_bfe_u32 s7, s3, 0x10001
  s_add_u32 s6, s6, s7
  s_lshl_b32 s6, s6, 8
  s_add_u32 s4, s4, s6
  s_addc_u32 s5, s5, 0
  s_add_u32 s56, s20, 0x1800000
  s_addc_u32 s57, s21, 0
  s_mov_b32 s58, 0x800000
  s_mov_b32 s59, 0x20000
  s_lshl_b32 s36, s2, 2
  s_add_u32 s36, s36, s39
  s_lshl_b32 s36, s36, 13
  s_mov_b32 s18, 4
L_hl_28:
  s_load_dword s52, s[4:5], 0
  s_load_dword s53, s[4:5], 64
  s_load_dword s54, s[4:5], 128
  s_load_dword s55, s[4:5], 192
  s_add_u32 s4, s4, 131072
  s_addc_u32 s5, s5, 0
  s_barrier
  s_load_dword s52, s[4:5], 0
  s_load_dword s53, s[4:5], 64
  s_load_dword s54, s[4:5], 128
  s_load_dword s55, s[4:5], 192
  s_add_u32 s4, s4, 131072
  s_addc_u32 s5, s5, 0
  s_barrier
  s_load_dword s52, s[4:5], 0
  s_load_dword s53, s[4:5], 64
  s_load_dword s54, s[4:5], 128
  s_load_dword s55, s[4:5], 192
  s_add_u32 s4, s4, 131072
  s_addc_u32 s5, s5, 0
  s_barrier
  s_load_dword s52, s[4:5], 0
  s_load_dword s53, s[4:5], 64
  s_load_dword s54, s[4:5], 128
  s_load_dword s55, s[4:5], 192
  s_add_u32 s4, s4, 131072
  s_addc_u32 s5, s5, 0
  buffer_store_dwordx4 v[96:99], v119, s[56:59], s36 offen sc1
  s_add_u32 s36, s36, 1024
  s_barrier
  s_sub_u32 s18, s18, 1
  s_cmp_lg_u32 s18, 0
  s_cbranch_scc1 L_hl_28
  s_mov_b32 s18, 5
L_hl_29:
  s_load_dword s52, s[4:5], 0
  s_load_dword s53, s[4:5], 64
  s_load_dword s54, s[4:5], 128
  s_load_dword s55, s[4:5], 192
  s_add_u32 s4, s4, 131072
  s_addc_u32 s5, s5, 0
  s_barrier
  s_sub_u32 s18, s18, 1
  s_cmp_lg_u32 s18, 0
  s_cbranch_scc1 L_hl_29
  s_load_dword s52, s[4:5], 0
  s_load_dword s53, s[4:5], 64
  s_load_dword s54, s[4:5], 128
  s_load_dword s55, s[4:5], 192
  s_add_u32 s4, s4, 131072
  s_addc_u32 s5, s5, 0
  s_barrier
  s_load_dword s52, s[4:5], 0
  s_load_dword s53, s[4:5], 64
  s_load_dword s54, s[4:5], 128
  s_load_dword s55, s[4:5], 192
  s_add_u32 s4, s4, 131072
  s_addc_u32 s5, s5, 0
  s_barrier
  s_load_dword s52, s[4:5], 0
  s_load_dword s53, s[4:5], 64
  s_load_dword s54, s[4:5], 128
  s_load_dword s55, s[4:5], 192
  s_add_u32 s4, s4, 131072
  s_addc_u32 s5, s5, 0
  s_barrier
  s_load_dword s52, s[4:5], 0
  s_load_dword s53, s[4:5], 64
  s_load_dword s54, s[4:5], 128
  s_load_dword s55, s[4:5], 192
  s_add_u32 s4, s4, 131072
  s_addc_u32 s5, s5, 0
  s_barrier
  s_load_dword s52, s[4:5], 0
  s_load_dword s53, s[4:5], 64
  s_load_dword s54, s[4:5], 128
  s_load_dword s55, s[4:5], 192
  s_add_u32 s4, s4, 131072
  s_addc_u32 s5, s5, 0
  s_barrier
  s_load_dword s52, s[4:5], 0
  s_load_dword s53, s[4:5], 64
  s_load_dword s54, s[4:5], 128
  s_load_dword s55, s[4:5], 192
  s_add_u32 s4, s4, 131072
  s_addc_u32 s5, s5, 0
  s_barrier
  s_load_dword s52, s[4:5], 0
  s_load_dword s53, s[4:5], 64
  s_load_dword s54, s[4:5], 128
  s_load_dword s55, s[4:5], 192
  s_add_u32 s4, s4, 131072
  s_addc_u32 s5, s5, 0
  s_barrier
  s_barrier
  s_barrier
  s_barrier
L_end_1:
  s_endpgm
.globl k5_kernel
.p2align 8
.type k5_kernel,@function
k5_kernel:
  s_cmp_ge_u32 s2, 256
  s_cbranch_scc1 L_end_30
  s_load_dwordx2 s[4:5], s[0:1], 88
  s_load_dwordx2 s[8:9], s[0:1], 16
  s_load_dwordx2 s[48:49], s[0:1], 0
  s_load_dwordx2 s[12:13], s[0:1], 32
  s_load_dwordx2 s[16:17], s[0:1], 40
  s_load_dwordx2 s[44:45], s[0:1], 48
  s_load_dwordx2 s[52:53], s[0:1], 72
  s_load_dwordx2 s[20:21], s[0:1], 88
  v_lshrrev_b32 v80, 6, v0
  v_and_b32 v224, 63, v0
  v_readfirstlane_b32 s3, v80
  v_lshlrev_b32 v251, 4, v224
  s_and_b32 s24, s2, 1
  s_lshr_b32 s29, s2, 3
  s_bfe_u32 s25, s2, 0x20001
  s_lshl_b32 s25, s25, 2
  s_and_b32 s30, s29, 3
  s_add_u32 s25, s25, s30
  s_lshr_b32 s26, s29, 2
  s_lshl_b32 s26, s26, 1
  s_add_u32 s26, s26, s24
  s_lshl_b32 s30, s25, 13
  s_lshl_b32 s31, s3, 11
  s_add_u32 s30, s30, s31
  v_add_u32 v240, s30, v251
  v_lshrrev_b32 v80, 3, v224
  v_and_b32 v81, 6, v80
  v_and_b32 v82, 7, v224
  v_xor_b32 v81, v81, v82
  s_lshl_b32 s30, s3, 3
  v_add_u32 v80, s30, v80
  v_lshlrev_b32 v82, 11, v80
  v_lshl_add_u32 v82, v81, 4, v82
  s_lshl_b32 s30, s26, 7
  v_add_u32 v241, s30, v82
  s_lshl_b32 s42, s3, 10
  s_waitcnt lgkmcnt(0)
  s_mov_b32 s10, 0x200000
  s_mov_b32 s11, 0x20000
  s_mov_b32 s6, 0x2800000
  s_mov_b32 s7, 0x20000
  s_mov_b32 s41, 0
  s_add_u32 m0, s42, 8192
  s_nop 0
  buffer_load_dwordx4 v241, s[8:11], s41 offen lds
  s_mov_b32 s41, 65536
  s_add_u32 m0, s42, 12288
  s_nop 0
  buffer_load_dwordx4 v241, s[8:11], s41 offen lds
  s_mov_b32 s41, 131072
  s_add_u32 m0, s42, 16384
  s_nop 0
  buffer_load_dwordx4 v241, s[8:11], s41 offen lds
  s_mov_b32 s41, 196608
  s_add_u32 m0, s42, 20480
  s_nop 0
  buffer_load_dwordx4 v241, s[8:11], s41 offen lds
  s_mov_b32 s41, 262144
  s_add_u32 m0, s42, 24576
  s_nop 0
  buffer_load_dwordx4 v241, s[8:11], s41 offen lds
  s_mov_b32 s41, 327680
  s_add_u32 m0, s42, 28672
  s_nop 0
  buffer_load_dwordx4 v241, s[8:11], s41 offen lds
  s_mov_b32 s40, 5242880
  buffer_load_dwordx4 a[0:3], v240, s[4:7], s40 offen offset:0
  buffer_load_dwordx4 a[4:7], v240, s[4:7], s40 offen offset:1024
  s_mov_b32 s40, 5373952
  buffer_load_dwordx4 a[8:11], v240, s[4:7], s40 offen offset:0
  buffer_load_dwordx4 a[12:15], v240, s[4:7], s40 offen offset:1024
  s_mov_b32 s41, 393216
  s_add_u32 m0, s42, 32768
  s_nop 0
  buffer_load_dwordx4 v241, s[8:11], s41 offen lds
  s_mov_b32 s41, 458752
  s_add_u32 m0, s42, 36864
  s_nop 0
  buffer_load_dwordx4 v241, s[8:11], s41 offen lds
  s_mov_b32 s40, 5505024
  buffer_load_dwordx4 a[16:19], v240, s[4:7], s40 offen offset:0
  buffer_load_dwordx4 a[20:23], v240, s[4:7], s40 offen offset:1024
  s_mov_b32 s40, 5636096
  buffer_load_dwordx4 a[24:27], v240, s[4:7], s40 offen offset:0
  buffer_load_dwordx4 a[28:31], v240, s[4:7], s40 offen offset:1024
  s_mov_b32 s41, 524288
  s_add_u32 m0, s42, 40960
  s_nop 0
  buffer_load_dwordx4 v241, s[8:11], s41 offen lds
  s_mov_b32 s41, 589824
  s_add_u32 m0, s42, 45056
  s_nop 0
  buffer_load_dwordx4 v241, s[8:11], s41 offen lds
  s_mov_b32 s50, 0x400000
  s_mov_b32 s51, 0x20000
  s_mov_b32 s14, 0x700000
  s_mov_b32 s15, 0x20000
  s_mov_b32 s18, 0x700000
  s_mov_b32 s19, 0x20000
  s_mov_b32 s46, 0x700000
  s_mov_b32 s47, 0x20000
  s_mov_b32 s54, 0x400000
  s_mov_b32 s55, 0x20000
  s_mul_i32 s30, s24, 3670016
  v_add_u32 v253, s30, v241
  v_xor_b32 v242, 128, v253
  s_mul_i32 s30, s24, 7340032
  v_add_u32 v252, s30, v240
  s_lshl_b32 s27, s24, 2
  s_and_b32 s30, s29, 3
  s_add_u32 s27, s27, s30
  s_bfe_u32 s28, s2, 0x20001
  s_lshl_b32 s28, s28, 3
  s_lshr_b32 s30, s29, 2
  s_add_u32 s28, s28, s30
  s_lshl_b32 s30, s27, 14
  s_lshl_b32 s31, s3, 12
  s_add_u32 s30, s30, s31
  v_add_u32 v225, s30, v251
  s_movk_i32 s30, 7168
  v_mul_u32_u24 v82, s30, v80
  v_lshl_add_u32 v82, v81, 4, v82
  s_lshr_b32 s30, s28, 2
  s_mul_i32 s30, s30, 896
  s_and_b32 s31, s28, 3
  s_lshl_b32 s32, s31, 8
  s_add_u32 s32, s32, s30
  v_add_u32 v226, s32, v82
  s_lshl_b32 s31, s31, 3
  s_lshr_b32 s32, 0x160e0c04, s31
  s_and_b32 s32, s32, 255
  s_lshl_b32 s32, s32, 5
  s_add_u32 s32, s32, s30
  s_lshr_b32 s33, 0x15140706, s31
  s_and_b32 s33, s33, 255
  s_lshl_b32 s33, s33, 5
  s_add_u32 s33, s33, s30
  s_sub_u32 s33, s33, 64
  v_mov_b32 v83, s32
  v_mov_b32 v84, s33
  v_cmp_lt_u32 vcc, 3, v81
  s_nop 1
  v_cndmask_b32 v83, v83, v84, vcc
  v_mov_b32 v84, 0x40000000
  v_cmp_lt_u32 vcc, 5, v81
  s_nop 1
  v_cndmask_b32 v83, v83, v84, vcc
  v_add_u32 v227, v83, v82
  v_lshrrev_b32 v80, 2, v224
  v_lshlrev_b32 v80, 7, v80
  v_bfe_u32 v81, v224, 3, 2
  v_lshl_add_u32 v80, v81, 5, v80
  v_and_b32 v81, 3, v224
  v_lshl_add_u32 v228, v81, 3, v80
  v_xor_b32 v229, 32, v228
  v_xor_b32 v230, 64, v228
  v_xor_b32 v231, 96, v228
  v_add_u32 v232, 0x10000, v228
  v_add_u32 v233, 0x10000, v229
  v_add_u32 v234, 0x10000, v230
  v_add_u32 v235, 0x10000, v231
  v_add_u32 v236, 0x20000, v228
  v_add_u32 v237, 0x20000, v229
  v_add_u32 v238, 0x20000, v230
  v_add_u32 v239, 0x20000, v231
  s_lshr_b32 s30, s28, 4
  s_mul_i32 s30, s30, 56
  s_and_b32 s31, s28, 15
  s_add_u32 s32, s30, s31
  s_lshl_b32 s32, s32, 17
  s_add_u32 s60, s32, 1048576
  s_lshr_b32 s32, s31, 1
  s_add_u32 s32, s32, s30
  s_lshl_b32 s32, s32, 17
  s_and_b32 s33, s31, 1
  s_lshl_b32 s33, s33, 10
  s_add_u32 s32, s32, s33
  s_add_u32 s61, s32, 3145728
  s_add_u32 s62, s60, 3145728
  s_add_u32 s63, s60, 5242880
  s_lshl_b32 s30, s27, 2
  s_add_u32 s30, s30, s3
  s_lshl_b32 s30, s30, 5
  s_lshl_b32 s31, s30, 6
  s_add_u32 s93, s31, 720896
  s_add_u32 s30, s30, s28
  s_lshl_b32 s30, s30, 6
  s_add_u32 s90, s30, 524288
  s_lshl_b32 s30, s25, 1
  s_lshr_b32 s31, s3, 1
  s_add_u32 s30, s30, s31
  s_lshl_b32 s30, s30, 1
  s_add_u32 s30, s30, s24
  s_lshl_b32 s30, s30, 10
  s_add_u32 s91, s30, 524288
  s_lshl_b32 s30, s25, 2
  s_add_u32 s30, s30, s3
  s_lshl_b32 s30, s30, 4
  s_add_u32 s30, s30, s26
  s_lshl_b32 s30, s30, 6
  s_add_u32 s92, s30, 720896
  s_mov_b32 s100, 1
  v_mov_b32 v245, s100
  v_cmp_ne_u32 vcc, 0, v224
  v_mov_b32 v80, 0x40000000
  s_nop 0
  v_cndmask_b32 v246, 0, v80, vcc
  v_and_b32 v254, 31, v224
  v_and_b32 v243, 17, v254
  v_lshlrev_b32 v243, 6, v243
  v_lshlrev_b32 v254, 6, v254
  s_lshl_b32 s30, s25, 14
  s_lshl_b32 s31, s3, 8
  s_add_u32 s30, s30, s31
  s_add_u32 s94, s30, 262144
  s_lshl_b32 s31, s26, 10
  s_add_u32 s95, s94, s31
  s_lshl_b32 s30, s2, 2
  s_add_u32 s30, s30, s3
  s_xor_b32 s31, s30, 4
  s_lshl_b32 s30, s30, 13
  s_lshl_b32 s31, s31, 13
  s_add_u32 s96, s30, 25165824
  s_add_u32 s97, s31, 25165824
  s_lshl_b32 s30, s26, 18
  s_add_u32 s98, s30, 19922944
  s_add_u32 s99, s30, 20054016
  s_mov_b32 s38, 0x8000
  s_mov_b32 s43, 0xbfb8aa3b
  v_and_b32 v80, 15, v224
  v_lshlrev_b32 v249, 11, v80
  v_bfe_u32 v82, v224, 4, 1
  v_lshl_add_u32 v249, v82, 5, v249
  v_lshrrev_b32 v82, 5, v224
  v_lshl_add_u32 v249, v82, 4, v249
  s_lshl_b32 s30, s25, 18
  s_lshl_b32 s31, s3, 16
  s_add_u32 s30, s30, s31
  s_lshl_b32 s31, s26, 7
  s_add_u32 s30, s30, s31
  v_add_u32 v249, s30, v249
  v_lshrrev_b32 v250, 4, v224
  v_lshlrev_b32 v250, 4, v250
  s_bitcmp1_b32 s3, 0
  s_cselect_b32 s56, s16, s12
  s_cselect_b32 s57, s17, s13
  s_cselect_b32 s37, 3670016, 0
  s_mov_b32 s58, 0x700000
  s_mov_b32 s59, 0x20000
  s_lshr_b32 s30, s2, 6
  s_lshl_b32 s30, s30, 5
  s_and_b32 s31, s2, 31
  s_add_u32 s30, s30, s31
  s_lshl_b32 s30, s30, 1
  s_lshr_b32 s31, s3, 1
  s_add_u32 s30, s30, s31
  s_lshl_b32 s30, s30, 11
  s_add_u32 s31, s28, 1
  s_bitcmp1_b32 s31, 1
  s_cselect_b32 s30, 0x40000000, s30
  v_lshrrev_b32 v247, 2, v224
  v_lshlrev_b32 v247, 7, v247
  v_add_u32 v247, s30, v247
  s_lshl_b32 s22, s2, 2
  s_add_u32 s22, s22, s3
  s_lshl_b32 s22, s22, 7
  s_add_u32 s22, s22, 60
  s_add_u32 s22, s22, s44
  s_addc_u32 s23, s45, 0
  v_lshrrev_b32 v88, 4, v224
  s_movk_i32 s30, 24576
  v_mul_u32_u24 v88, s30, v88
  v_and_b32 v80, 15, v224
  v_lshl_add_u32 v88, v80, 4, v88
  s_lshl_b32 s30, s26, 8
  s_lshl_b32 s31, s3, 12
  s_add_u32 s30, s30, s31
  s_add_u32 s36, s30, 8192
  v_lshlrev_b32 v84, 4, v80
  s_lshl_b32 s30, s3, 8
  v_add_u32 v84, s30, v84
  v_lshlrev_b32 v89, 3, v224
  v_lshrrev_b32 v90, 4, v224
  v_lshlrev_b32 v90, 12, v90
  v_lshl_add_u32 v90, v80, 3, v90
  v_cmp_gt_u32 s[34:35], 16, v224
  s_cmp_eq_u32 s3, 2
  s_cselect_b32 s39, 1.0, 0
  s_mov_b64 vcc, 0
  s_branch L_hot
  .p2align 12
L_hot:
  s_waitcnt vmcnt(14)
  s_barrier
  ds_read_b64_tr_b16 a[192:193], v228 offset:8192
  ds_read_b64_tr_b16 a[194:195], v228 offset:10240
  ds_read_b64_tr_b16 a[196:197], v228 offset:12288
  ds_read_b64_tr_b16 a[198:199], v228 offset:14336
  ds_read_b64_tr_b16 a[200:201], v229 offset:8192
  ds_read_b64_tr_b16 a[202:203], v229 offset:10240
  ds_read_b64_tr_b16 a[204:205], v229 offset:12288
  ds_read_b64_tr_b16 a[206:207], v229 offset:14336
  ds_read_b64_tr_b16 a[208:209], v230 offset:8192
  ds_read_b64_tr_b16 a[210:211], v230 offset:10240
  ds_read_b64_tr_b16 a[212:213], v230 offset:12288
  ds_read_b64_tr_b16 a[214:215], v230 offset:14336
  ds_read_b64_tr_b16 a[216:217], v231 offset:8192
  ds_read_b64_tr_b16 a[218:219], v231 offset:10240
  ds_read_b64_tr_b16 a[220:221], v231 offset:12288
  ds_read_b64_tr_b16 a[222:223], v231 offset:14336
  ds_read_b64_tr_b16 a[224:225], v228 offset:16384
  ds_read_b64_tr_b16 a[226:227], v228 offset:18432
  ds_read_b64_tr_b16 a[228:229], v228 offset:20480
  ds_read_b64_tr_b16 a[230:231], v228 offset:22528
  ds_read_b64_tr_b16 a[232:233], v229 offset:16384
  ds_read_b64_tr_b16 a[234:235], v229 offset:18432
  ds_read_b64_tr_b16 a[236:237], v229 offset:20480
  ds_read_b64_tr_b16 a[238:239], v229 offset:22528
  s_mov_b32 s40, 5767168
  s_waitcnt vmcnt(8) lgkmcnt(10)
  v_mfma_f32_16x16x32_bf16 v[0:3], a[192:195], a[0:3], 0
  v_mfma_f32_16x16x32_bf16 v[0:3], a[196:199], a[8:11], v[0:3]
  buffer_load_dwordx4 a[32:35], v240, s[4:7], s40 offen offset:0
  v_mfma_f32_16x16x32_bf16 v[16:19], a[192:195], a[4:7], 0
  ds_read_b64_tr_b16 a[192:193], v230 offset:16384
  v_mfma_f32_16x16x32_bf16 v[16:19], a[196:199], a[12:15], v[16:19]
  buffer_load_dwordx4 a[36:39], v240, s[4:7], s40 offen offset:1024
  s_mov_b32 s40, 5898240
  v_mfma_f32_16x16x32_bf16 v[4:7], a[200:203], a[0:3], 0
  ds_read_b64_tr_b16 a[194:195], v230 offset:18432
  v_mfma_f32_16x16x32_bf16 v[4:7], a[204:207], a[8:11], v[4:7]
  buffer_load_dwordx4 a[40:43], v240, s[4:7], s40 offen offset:0
  v_mfma_f32_16x16x32_bf16 v[20:23], a[200:203], a[4:7], 0
  ds_read_b64_tr_b16 a[196:197], v230 offset:20480
  ds_read_b64_tr_b16 a[198:199], v230 offset:22528
  v_mfma_f32_16x16x32_bf16 v[20:23], a[204:207], a[12:15], v[20:23]
  buffer_load_dwordx4 a[44:47], v240, s[4:7], s40 offen offset:1024
  v_mfma_f32_16x16x32_bf16 v[8:11], a[208:211], a[0:3], 0
  ds_read_b64_tr_b16 a[200:201], v231 offset:16384
  ds_read_b64_tr_b16 a[202:203], v231 offset:18432
  s_mov_b32 s41, 655360
  v_mfma_f32_16x16x32_bf16 v[8:11], a[212:215], a[8:11], v[8:11]
  ds_read_b64_tr_b16 a[204:205], v231 offset:20480
  ds_read_b64_tr_b16 a[206:207], v231 offset:22528
  s_add_u32 m0, s42, 49152
  v_mfma_f32_16x16x32_bf16 v[24:27], a[208:211], a[4:7], 0
  buffer_load_dwordx4 v241, s[8:11], s41 offen lds
  v_mfma_f32_16x16x32_bf16 v[24:27], a[212:215], a[12:15], v[24:27]
  s_mov_b32 s41, 720896
  s_add_u32 m0, s42, 53248
  v_mfma_f32_16x16x32_bf16 v[12:15], a[216:219], a[0:3], 0
  buffer_load_dwordx4 v241, s[8:11], s41 offen lds
  s_waitcnt lgkmcnt(10)
  v_mfma_f32_16x16x32_bf16 v[12:15], a[220:223], a[8:11], v[12:15]
  s_mov_b32 s40, 6029312
  v_mfma_f32_16x16x32_bf16 v[28:31], a[216:219], a[4:7], 0
  buffer_load_dwordx4 a[48:51], v240, s[4:7], s40 offen offset:0
  v_mfma_f32_16x16x32_bf16 v[28:31], a[220:223], a[12:15], v[28:31]
  s_barrier
  ds_read_b64_tr_b16 a[208:209], v228 offset:24576
  s_waitcnt vmcnt(9)
  v_mfma_f32_16x16x32_bf16 v[0:3], a[224:227], a[16:19], v[0:3]
  buffer_load_dwordx4 a[52:55], v240, s[4:7], s40 offen offset:1024
  s_mov_b32 s40, 6160384
  v_mfma_f32_16x16x32_bf16 v[0:3], a[228:231], a[24:27], v[0:3]
  ds_read_b64_tr_b16 a[210:211], v228 offset:26624
  ds_read_b64_tr_b16 a[212:213], v228 offset:28672
  v_mfma_f32_16x16x32_bf16 v[16:19], a[224:227], a[20:23], v[16:19]
  buffer_load_dwordx4 a[56:59], v240, s[4:7], s40 offen offset:0
  v_mfma_f32_16x16x32_bf16 v[16:19], a[228:231], a[28:31], v[16:19]
  ds_read_b64_tr_b16 a[214:215], v228 offset:30720
  ds_read_b64_tr_b16 a[216:217], v229 offset:24576
  v_mfma_f32_16x16x32_bf16 v[4:7], a[232:235], a[16:19], v[4:7]
  buffer_load_dwordx4 a[60:63], v240, s[4:7], s40 offen offset:1024
  s_waitcnt lgkmcnt(10)
  v_mfma_f32_16x16x32_bf16 v[4:7], a[236:239], a[24:27], v[4:7]
  ds_read_b64_tr_b16 a[218:219], v229 offset:26624
  ds_read_b64_tr_b16 a[220:221], v229 offset:28672
  s_mov_b32 s41, 786432
  v_mfma_f32_16x16x32_bf16 v[20:23], a[232:235], a[20:23], v[20:23]
  ds_read_b64_tr_b16 a[222:223], v229 offset:30720
  ds_read_b64_tr_b16 a[224:225], v230 offset:24576
  s_add_u32 m0, s42, 57344
  v_mfma_f32_16x16x32_bf16 v[20:23], a[236:239], a[28:31], v[20:23]
  buffer_load_dwordx4 v241, s[8:11], s41 offen lds
  v_mfma_f32_16x16x32_bf16 v[8:11], a[192:195], a[16:19], v[8:11]
  ds_read_b64_tr_b16 a[226:227], v230 offset:26624
  ds_read_b64_tr_b16 a[228:229], v230 offset:28672
  s_mov_b32 s41, 851968
  s_waitcnt lgkmcnt(10)
  v_mfma_f32_16x16x32_bf16 v[8:11], a[196:199], a[24:27], v[8:11]
  ds_read_b64_tr_b16 a[230:231], v230 offset:30720
  ds_read_b64_tr_b16 a[232:233], v231 offset:24576
  s_add_u32 m0, s42, 61440
  v_mfma_f32_16x16x32_bf16 v[24:27], a[192:195], a[20:23], v[24:27]
  buffer_load_dwordx4 v241, s[8:11], s41 offen lds
  buffer_load_dwordx4 v[96:99], v88, s[4:7], s36 offen
  v_mfma_f32_16x16x32_bf16 v[24:27], a[196:199], a[28:31], v[24:27]
  ds_read_b64_tr_b16 a[234:235], v231 offset:26624
  ds_read_b64_tr_b16 a[236:237], v231 offset:28672
  s_mov_b32 s40, 6291456
  v_mfma_f32_16x16x32_bf16 v[12:15], a[200:203], a[16:19], v[12:15]
  buffer_load_dwordx4 a[64:67], v240, s[4:7], s40 offen offset:0
  v_mfma_f32_16x16x32_bf16 v[12:15], a[204:207], a[24:27], v[12:15]
  ds_read_b64_tr_b16 a[238:239], v231 offset:30720
  v_mfma_f32_16x16x32_bf16 v[28:31], a[200:203], a[20:23], v[28:31]
  buffer_load_dwordx4 a[68:71], v240, s[4:7], s40 offen offset:1024
  s_mov_b32 s40, 6422528
  v_mfma_f32_16x16x32_bf16 v[28:31], a[204:207], a[28:31], v[28:31]
  s_barrier
  ds_read_b64_tr_b16 a[192:193], v228 offset:32768
  s_waitcnt vmcnt(11) lgkmcnt(10)
  v_mfma_f32_16x16x32_bf16 v[0:3], a[208:211], a[32:35], v[0:3]
  buffer_load_dwordx4 a[72:75], v240, s[4:7], s40 offen offset:0
  v_mfma_f32_16x16x32_bf16 v[0:3], a[212:215], a[40:43], v[0:3]
  ds_read_b64_tr_b16 a[194:195], v228 offset:34816
  ds_read_b64_tr_b16 a[196:197], v228 offset:36864
  v_mfma_f32_16x16x32_bf16 v[16:19], a[208:211], a[36:39], v[16:19]
  buffer_load_dwordx4 a[76:79], v240, s[4:7], s40 offen offset:1024
  v_mfma_f32_16x16x32_bf16 v[16:19], a[212:215], a[44:47], v[16:19]
  ds_read_b64_tr_b16 a[198:199], v228 offset:38912
  ds_read_b64_tr_b16 a[200:201], v229 offset:32768
  s_mov_b32 s41, 917504
  v_mfma_f32_16x16x32_bf16 v[4:7], a[216:219], a[32:35], v[4:7]
  ds_read_b64_tr_b16 a[202:203], v229 offset:34816
  ds_read_b64_tr_b16 a[204:205], v229 offset:36864
  s_add_u32 m0, s42, 65536
  s_waitcnt lgkmcnt(10)
  v_mfma_f32_16x16x32_bf16 v[4:7], a[220:223], a[40:43], v[4:7]
  buffer_load_dwordx4 v241, s[8:11], s41 offen lds
  v_mfma_f32_16x16x32_bf16 v[20:23], a[216:219], a[36:39], v[20:23]
  ds_read_b64_tr_b16 a[206:207], v229 offset:38912
  ds_read_b64_tr_b16 a[208:209], v230 offset:32768
  s_mov_b32 s41, 983040
  v_mfma_f32_16x16x32_bf16 v[20:23], a[220:223], a[44:47], v[20:23]
  ds_read_b64_tr_b16 a[210:211], v230 offset:34816
  ds_read_b64_tr_b16 a[212:213], v230 offset:36864
  s_add_u32 m0, s42, 69632
  v_mfma_f32_16x16x32_bf16 v[8:11], a[224:227], a[32:35], v[8:11]
  buffer_load_dwordx4 v241, s[8:11], s41 offen lds
  v_mfma_f32_16x16x32_bf16 v[8:11], a[228:231], a[40:43], v[8:11]
  ds_read_b64_tr_b16 a[214:215], v230 offset:38912
  ds_read_b64_tr_b16 a[216:217], v231 offset:32768
  s_mov_b32 s40, 6553600
  v_mfma_f32_16x16x32_bf16 v[24:27], a[224:227], a[36:39], v[24:27]
  buffer_load_dwordx4 a[80:83], v240, s[4:7], s40 offen offset:0
  v_mfma_f32_16x16x32_bf16 v[24:27], a[228:231], a[44:47], v[24:27]
  ds_read_b64_tr_b16 a[218:219], v231 offset:34816
  ds_read_b64_tr_b16 a[220:221], v231 offset:36864
  s_waitcnt lgkmcnt(10)
  v_mfma_f32_16x16x32_bf16 v[12:15], a[232:235], a[32:35], v[12:15]
  buffer_load_dwordx4 a[84:87], v240, s[4:7], s40 offen offset:1024
  s_mov_b32 s40, 6684672
  v_mfma_f32_16x16x32_bf16 v[12:15], a[236:239], a[40:43], v[12:15]
  ds_read_b64_tr_b16 a[222:223], v231 offset:38912
  v_mfma_f32_16x16x32_bf16 v[28:31], a[232:235], a[36:39], v[28:31]
  buffer_load_dwordx4 a[88:91], v240, s[4:7], s40 offen offset:0
  v_mfma_f32_16x16x32_bf16 v[28:31], a[236:239], a[44:47], v[28:31]
  s_barrier
  ds_read_b64_tr_b16 a[224:225], v228 offset:40960
  s_waitcnt vmcnt(12)
  v_mfma_f32_16x16x32_bf16 v[0:3], a[192:195], a[48:51], v[0:3]
  buffer_load_dwordx4 a[92:95], v240, s[4:7], s40 offen offset:1024
  v_mfma_f32_16x16x32_bf16 v[0:3], a[196:199], a[56:59], v[0:3]
  ds_read_b64_tr_b16 a[226:227], v228 offset:43008
  ds_read_b64_tr_b16 a[228:229], v228 offset:45056
  s_mov_b32 s41, 1048576
  v_mfma_f32_16x16x32_bf16 v[16:19], a[192:195], a[52:55], v[16:19]
  ds_read_b64_tr_b16 a[230:231], v228 offset:47104
  ds_read_b64_tr_b16 a[232:233], v229 offset:40960
  s_add_u32 m0, s42, 73728
  v_mfma_f32_16x16x32_bf16 v[16:19], a[196:199], a[60:63], v[16:19]
  buffer_load_dwordx4 v241, s[8:11], s41 offen lds
  s_waitcnt lgkmcnt(10)
  v_mfma_f32_16x16x32_bf16 v[4:7], a[200:203], a[48:51], v[4:7]
  ds_read_b64_tr_b16 a[234:235], v229 offset:43008
  ds_read_b64_tr_b16 a[236:237], v229 offset:45056
  s_mov_b32 s41, 1114112
  v_mfma_f32_16x16x32_bf16 v[4:7], a[204:207], a[56:59], v[4:7]
  ds_read_b64_tr_b16 a[238:239], v229 offset:47104
  ds_read_b64_tr_b16 a[192:193], v230 offset:40960
  s_add_u32 m0, s42, 77824
  v_mfma_f32_16x16x32_bf16 v[20:23], a[200:203], a[52:55], v[20:23]
  buffer_load_dwordx4 v241, s[8:11], s41 offen lds
  v_mfma_f32_16x16x32_bf16 v[20:23], a[204:207], a[60:63], v[20:23]
  ds_read_b64_tr_b16 a[194:195], v230 offset:43008
  ds_read_b64_tr_b16 a[196:197], v230 offset:45056
  s_mov_b32 s40, 6815744
  v_mfma_f32_16x16x32_bf16 v[8:11], a[208:211], a[48:51], v[8:11]
  buffer_load_dwordx4 a[96:99], v240, s[4:7], s40 offen offset:0
  s_waitcnt lgkmcnt(10)
  v_mfma_f32_16x16x32_bf16 v[8:11], a[212:215], a[56:59], v[8:11]
  ds_read_b64_tr_b16 a[198:199], v230 offset:47104
  ds_read_b64_tr_b16 a[200:201], v231 offset:40960
  v_mfma_f32_16x16x32_bf16 v[24:27], a[208:211], a[52:55], v[24:27]
  buffer_load_dwordx4 a[100:103], v240, s[4:7], s40 offen offset:1024
  s_mov_b32 s40, 6946816
  v_mfma_f32_16x16x32_bf16 v[24:27], a[212:215], a[60:63], v[24:27]
  ds_read_b64_tr_b16 a[202:203], v231 offset:43008
  ds_read_b64_tr_b16 a[204:205], v231 offset:45056
  v_mfma_f32_16x16x32_bf16 v[12:15], a[216:219], a[48:51], v[12:15]
  buffer_load_dwordx4 a[104:107], v240, s[4:7], s40 offen offset:0
  v_mfma_f32_16x16x32_bf16 v[12:15], a[220:223], a[56:59], v[12:15]
  ds_read_b64_tr_b16 a[206:207], v231 offset:47104
  v_mfma_f32_16x16x32_bf16 v[28:31], a[216:219], a[52:55], v[28:31]
  buffer_load_dwordx4 a[108:111], v240, s[4:7], s40 offen offset:1024
  v_mfma_f32_16x16x32_bf16 v[28:31], a[220:223], a[60:63], v[28:31]
  s_barrier
  ds_read_b64_tr_b16 a[208:209], v228 offset:49152
  s_waitcnt vmcnt(12) lgkmcnt(10)
  v_mfma_f32_16x16x32_bf16 v[0:3], a[224:227], a[64:67], v[0:3]
  ds_read_b64_tr_b16 a[210:211], v228 offset:51200
  ds_read_b64_tr_b16 a[212:213], v228 offset:53248
  s_mov_b32 s41, 1179648
  v_mfma_f32_16x16x32_bf16 v[0:3], a[228:231], a[72:75], v[0:3]
  ds_read_b64_tr_b16 a[214:215], v228 offset:55296
  ds_read_b64_tr_b16 a[216:217], v229 offset:49152
  s_add_u32 m0, s42, 81920
  v_mfma_f32_16x16x32_bf16 v[16:19], a[224:227], a[68:71], v[16:19]
  buffer_load_dwordx4 v241, s[8:11], s41 offen lds
  v_mfma_f32_16x16x32_bf16 v[16:19], a[228:231], a[76:79], v[16:19]
  ds_read_b64_tr_b16 a[218:219], v229 offset:51200
  ds_read_b64_tr_b16 a[220:221], v229 offset:53248
  s_mov_b32 s41, 1245184
  v_mfma_f32_16x16x32_bf16 v[4:7], a[232:235], a[64:67], v[4:7]
  ds_read_b64_tr_b16 a[222:223], v229 offset:55296
  ds_read_b64_tr_b16 a[224:225], v230 offset:49152
  s_add_u32 m0, s42, 86016
  s_waitcnt lgkmcnt(10)
  v_mfma_f32_16x16x32_bf16 v[4:7], a[236:239], a[72:75], v[4:7]
  buffer_load_dwordx4 v241, s[8:11], s41 offen lds
  v_mfma_f32_16x16x32_bf16 v[20:23], a[232:235], a[68:71], v[20:23]
  ds_read_b64_tr_b16 a[226:227], v230 offset:51200
  ds_read_b64_tr_b16 a[228:229], v230 offset:53248
  s_mov_b32 s40, 7077888
  v_mfma_f32_16x16x32_bf16 v[20:23], a[236:239], a[76:79], v[20:23]
  buffer_load_dwordx4 a[112:115], v240, s[4:7], s40 offen offset:0
  v_mfma_f32_16x16x32_bf16 v[8:11], a[192:195], a[64:67], v[8:11]
  ds_read_b64_tr_b16 a[230:231], v230 offset:55296
  ds_read_b64_tr_b16 a[232:233], v231 offset:49152
  v_mfma_f32_16x16x32_bf16 v[8:11], a[196:199], a[72:75], v[8:11]
  buffer_load_dwordx4 a[116:119], v240, s[4:7], s40 offen offset:1024
  s_mov_b32 s40, 7208960
  v_mfma_f32_16x16x32_bf16 v[24:27], a[192:195], a[68:71], v[24:27]
  ds_read_b64_tr_b16 a[234:235], v231 offset:51200
  ds_read_b64_tr_b16 a[236:237], v231 offset:53248
  v_mov_b32 v100, v96
  v_mov_b32 v101, v97
  v_mov_b32 v102, v98
  v_mov_b32 v103, v99
  v_permlane16_swap_b32 v100, v96
  v_mfma_f32_16x16x32_bf16 v[24:27], a[196:199], a[76:79], v[24:27]
  buffer_load_dwordx4 a[120:123], v240, s[4:7], s40 offen offset:0
  v_permlane16_swap_b32 v101, v97
  v_mfma_f32_16x16x32_bf16 v[12:15], a[200:203], a[64:67], v[12:15]
  ds_read_b64_tr_b16 a[238:239], v231 offset:55296
  v_permlane16_swap_b32 v102, v98
  v_permlane16_swap_b32 v103, v99
  s_waitcnt lgkmcnt(10)
  v_mfma_f32_16x16x32_bf16 v[12:15], a[204:207], a[72:75], v[12:15]
  buffer_load_dwordx4 a[124:127], v240, s[4:7], s40 offen offset:1024
  v_add_f32 v96, v96, v100
  v_mfma_f32_16x16x32_bf16 v[28:31], a[200:203], a[68:71], v[28:31]
  s_mov_b32 s41, 1310720
  s_add_u32 m0, s42, 90112
  v_add_f32 v97, v97, v101
  v_mfma_f32_16x16x32_bf16 v[28:31], a[204:207], a[76:79], v[28:31]
  s_barrier
  ds_read_b64_tr_b16 a[192:193], v228 offset:57344
  s_waitcnt vmcnt(12)
  v_mfma_f32_16x16x32_bf16 v[0:3], a[208:211], a[80:83], v[0:3]
  buffer_load_dwordx4 v241, s[8:11], s41 offen lds
  v_add_f32 v98, v98, v102
  v_mfma_f32_16x16x32_bf16 v[0:3], a[212:215], a[88:91], v[0:3]
  ds_read_b64_tr_b16 a[194:195], v228 offset:59392
  ds_read_b64_tr_b16 a[196:197], v228 offset:61440
  s_mov_b32 s41, 1376256
  v_mfma_f32_16x16x32_bf16 v[16:19], a[208:211], a[84:87], v[16:19]
  ds_read_b64_tr_b16 a[198:199], v228 offset:63488
  ds_read_b64_tr_b16 a[200:201], v229 offset:57344
  s_add_u32 m0, s42, 94208
  v_mfma_f32_16x16x32_bf16 v[16:19], a[212:215], a[92:95], v[16:19]
  buffer_load_dwordx4 v241, s[8:11], s41 offen lds
  v_add_f32 v99, v99, v103
  v_mfma_f32_16x16x32_bf16 v[4:7], a[216:219], a[80:83], v[4:7]
  ds_read_b64_tr_b16 a[202:203], v229 offset:59392
  ds_read_b64_tr_b16 a[204:205], v229 offset:61440
  s_mov_b32 s40, 7340032
  buffer_load_dwordx4 v[48:51], v249, s[48:51], 0 offen offset:0
  s_waitcnt lgkmcnt(10)
  v_mfma_f32_16x16x32_bf16 v[4:7], a[220:223], a[88:91], v[4:7]
  ds_read_b64_tr_b16 a[206:207], v229 offset:63488
  ds_read_b64_tr_b16 a[208:209], v230 offset:57344
  v_mov_b32 v100, v96
  v_mfma_f32_16x16x32_bf16 v[20:23], a[216:219], a[84:87], v[20:23]
  buffer_load_dwordx4 a[128:131], v240, s[4:7], s40 offen offset:0
  v_mov_b32 v101, v97
  v_mfma_f32_16x16x32_bf16 v[20:23], a[220:223], a[92:95], v[20:23]
  ds_read_b64_tr_b16 a[210:211], v230 offset:59392
  ds_read_b64_tr_b16 a[212:213], v230 offset:61440
  v_mov_b32 v102, v98
  v_mfma_f32_16x16x32_bf16 v[8:11], a[224:227], a[80:83], v[8:11]
  buffer_load_dwordx4 a[132:135], v240, s[4:7], s40 offen offset:1024
  s_mov_b32 s40, 7471104
  buffer_load_dwordx4 v[52:55], v249, s[48:51], 0 offen offset:64
  v_mfma_f32_16x16x32_bf16 v[8:11], a[228:231], a[88:91], v[8:11]
  ds_read_b64_tr_b16 a[214:215], v230 offset:63488
  ds_read_b64_tr_b16 a[216:217], v231 offset:57344
  v_mov_b32 v103, v99
  v_mfma_f32_16x16x32_bf16 v[24:27], a[224:227], a[84:87], v[24:27]
  buffer_load_dwordx4 a[136:139], v240, s[4:7], s40 offen offset:0
  v_permlane32_swap_b32 v100, v96
  v_mfma_f32_16x16x32_bf16 v[24:27], a[228:231], a[92:95], v[24:27]
  ds_read_b64_tr_b16 a[218:219], v231 offset:59392
  ds_read_b64_tr_b16 a[220:221], v231 offset:61440
  v_permlane32_swap_b32 v101, v97
  s_waitcnt lgkmcnt(10)
  v_mfma_f32_16x16x32_bf16 v[12:15], a[232:235], a[80:83], v[12:15]
  buffer_load_dwordx4 a[140:143], v240, s[4:7], s40 offen offset:1024
  v_permlane32_swap_b32 v102, v98
  buffer_load_dwordx4 v[56:59], v249, s[48:51], s38 offen offset:0
  v_mfma_f32_16x16x32_bf16 v[12:15], a[236:239], a[88:91], v[12:15]
  ds_read_b64_tr_b16 a[222:223], v231 offset:63488
  s_mov_b32 s41, 1441792
  s_add_u32 m0, s42, 98304
  v_mfma_f32_16x16x32_bf16 v[28:31], a[232:235], a[84:87], v[28:31]
  buffer_load_dwordx4 v241, s[8:11], s41 offen lds
  v_permlane32_swap_b32 v103, v99
  v_mfma_f32_16x16x32_bf16 v[28:31], a[236:239], a[92:95], v[28:31]
  s_barrier
  ds_read_b64_tr_b16 a[224:225], v232 offset:0
  s_waitcnt vmcnt(16)
  v_mfma_f32_16x16x32_bf16 v[0:3], a[192:195], a[96:99], v[0:3]
  ds_read_b64_tr_b16 a[226:227], v232 offset:2048
  ds_read_b64_tr_b16 a[228:229], v232 offset:4096
  s_mov_b32 s41, 1507328
  v_add_f32 v96, v96, v100
  buffer_load_dwordx4 v[60:63], v249, s[48:51], s38 offen offset:64
  v_mfma_f32_16x16x32_bf16 v[0:3], a[196:199], a[104:107], v[0:3]
  ds_read_b64_tr_b16 a[230:231], v232 offset:6144
  ds_read_b64_tr_b16 a[232:233], v233 offset:0
  s_add_u32 m0, s42, 102400
  v_add_f32 v97, v97, v101
  v_mfma_f32_16x16x32_bf16 v[16:19], a[192:195], a[100:103], v[16:19]
  buffer_load_dwordx4 v241, s[8:11], s41 offen lds
  v_add_f32 v98, v98, v102
  v_mfma_f32_16x16x32_bf16 v[16:19], a[196:199], a[108:111], v[16:19]
  ds_read_b64_tr_b16 a[234:235], v233 offset:2048
  ds_read_b64_tr_b16 a[236:237], v233 offset:4096
  s_mov_b32 s40, 7602176
  s_waitcnt lgkmcnt(10)
  v_mfma_f32_16x16x32_bf16 v[4:7], a[200:203], a[96:99], v[4:7]
  buffer_load_dwordx4 a[144:147], v240, s[4:7], s40 offen offset:0
  v_add_f32 v99, v99, v103
  v_mfma_f32_16x16x32_bf16 v[4:7], a[204:207], a[104:107], v[4:7]
  ds_read_b64_tr_b16 a[238:239], v233 offset:6144
  ds_read_b64_tr_b16 a[192:193], v234 offset:0
  v_cvt_pk_bf16_f32 v100, v96, v97
  v_mfma_f32_16x16x32_bf16 v[20:23], a[200:203], a[100:103], v[20:23]
  buffer_load_dwordx4 a[148:151], v240, s[4:7], s40 offen offset:1024
  s_mov_b32 s40, 7733248
  v_lshlrev_b32 v96, 16, v100
  v_mfma_f32_16x16x32_bf16 v[20:23], a[204:207], a[108:111], v[20:23]
  ds_read_b64_tr_b16 a[194:195], v234 offset:2048
  ds_read_b64_tr_b16 a[196:197], v234 offset:4096
  v_and_b32 v97, 0xffff0000, v100
  v_mfma_f32_16x16x32_bf16 v[8:11], a[208:211], a[96:99], v[8:11]
  buffer_load_dwordx4 a[152:155], v240, s[4:7], s40 offen offset:0
  v_cvt_pk_bf16_f32 v101, v98, v99
  v_mfma_f32_16x16x32_bf16 v[8:11], a[212:215], a[104:107], v[8:11]
  ds_read_b64_tr_b16 a[198:199], v234 offset:6144
  ds_read_b64_tr_b16 a[200:201], v235 offset:0
  v_lshlrev_b32 v98, 16, v101
  v_mfma_f32_16x16x32_bf16 v[24:27], a[208:211], a[100:103], v[24:27]
  buffer_load_dwordx4 a[156:159], v240, s[4:7], s40 offen offset:1024
  v_and_b32 v99, 0xffff0000, v101
  v_mfma_f32_16x16x32_bf16 v[24:27], a[212:215], a[108:111], v[24:27]
  ds_read_b64_tr_b16 a[202:203], v235 offset:2048
  ds_read_b64_tr_b16 a[204:205], v235 offset:4096
  s_mov_b32 s41, 1572864
  s_waitcnt lgkmcnt(10)
  v_mfma_f32_16x16x32_bf16 v[12:15], a[216:219], a[96:99], v[12:15]
  ds_read_b64_tr_b16 a[206:207], v235 offset:6144
  s_add_u32 m0, s42, 106496
  v_add_f32 v96, s39, v96
  v_mfma_f32_16x16x32_bf16 v[12:15], a[220:223], a[104:107], v[12:15]
  buffer_load_dwordx4 v241, s[8:11], s41 offen lds
  v_add_f32 v97, s39, v97
  v_mfma_f32_16x16x32_bf16 v[28:31], a[216:219], a[100:103], v[28:31]
  s_mov_b32 s41, 1638400
  s_add_u32 m0, s42, 110592
  v_add_f32 v98, s39, v98
  v_mfma_f32_16x16x32_bf16 v[28:31], a[220:223], a[108:111], v[28:31]
  s_barrier
  ds_read_b64_tr_b16 a[208:209], v232 offset:8192
  s_waitcnt vmcnt(17)
  v_mfma_f32_16x16x32_bf16 v[0:3], a[224:227], a[112:115], v[0:3]
  buffer_load_dwordx4 v241, s[8:11], s41 offen lds
  v_add_f32 v99, s39, v99
  v_mfma_f32_16x16x32_bf16 v[0:3], a[228:231], a[120:123], v[0:3]
  ds_read_b64_tr_b16 a[210:211], v232 offset:10240
  ds_read_b64_tr_b16 a[212:213], v232 offset:12288
  s_mov_b32 s40, 7864320
  v_mfma_f32_16x16x32_bf16 v[16:19], a[224:227], a[116:119], v[16:19]
  buffer_load_dwordx4 a[160:163], v240, s[4:7], s40 offen offset:0
  v_cvt_pk_bf16_f32 v100, v96, v97
  v_mfma_f32_16x16x32_bf16 v[16:19], a[228:231], a[124:127], v[16:19]
  ds_read_b64_tr_b16 a[214:215], v232 offset:14336
  ds_read_b64_tr_b16 a[216:217], v233 offset:8192
  v_lshlrev_b32 v96, 16, v100
  s_waitcnt lgkmcnt(10)
  v_mfma_f32_16x16x32_bf16 v[4:7], a[232:235], a[112:115], v[4:7]
  buffer_load_dwordx4 a[164:167], v240, s[4:7], s40 offen offset:1024
  s_mov_b32 s40, 7995392
  v_mfma_f32_16x16x32_bf16 v[4:7], a[236:239], a[120:123], v[4:7]
  ds_read_b64_tr_b16 a[218:219], v233 offset:10240
  ds_read_b64_tr_b16 a[220:221], v233 offset:12288
  v_and_b32 v97, 0xffff0000, v100
  v_mfma_f32_16x16x32_bf16 v[20:23], a[232:235], a[116:119], v[20:23]
  buffer_load_dwordx4 a[168:171], v240, s[4:7], s40 offen offset:0
  v_cvt_pk_bf16_f32 v101, v98, v99
  v_mfma_f32_16x16x32_bf16 v[20:23], a[236:239], a[124:127], v[20:23]
  ds_read_b64_tr_b16 a[222:223], v233 offset:14336
  ds_read_b64_tr_b16 a[224:225], v234 offset:8192
  v_lshlrev_b32 v98, 16, v101
  v_mfma_f32_16x16x32_bf16 v[8:11], a[192:195], a[112:115], v[8:11]
  buffer_load_dwordx4 a[172:175], v240, s[4:7], s40 offen offset:1024
  v_and_b32 v99, 0xffff0000, v101
  s_waitcnt lgkmcnt(10)
  v_mfma_f32_16x16x32_bf16 v[8:11], a[196:199], a[120:123], v[8:11]
  ds_read_b64_tr_b16 a[226:227], v234 offset:10240
  ds_read_b64_tr_b16 a[228:229], v234 offset:12288
  s_mov_b32 s41, 1703936
  v_mfma_f32_16x16x32_bf16 v[24:27], a[192:195], a[116:119], v[24:27]
  ds_read_b64_tr_b16 a[230:231], v234 offset:14336
  ds_read_b64_tr_b16 a[232:233], v235 offset:8192
  s_add_u32 m0, s42, 114688
  ds_write_b128 v84, v[96:99] offset:0
  v_mfma_f32_16x16x32_bf16 v[24:27], a[196:199], a[124:127], v[24:27]
  buffer_load_dwordx4 v241, s[8:11], s41 offen lds
  v_mfma_f32_16x16x32_bf16 v[12:15], a[200:203], a[112:115], v[12:15]
  ds_read_b64_tr_b16 a[234:235], v235 offset:10240
  ds_read_b64_tr_b16 a[236:237], v235 offset:12288
  s_mov_b32 s41, 1769472
  s_waitcnt lgkmcnt(10)
  v_mfma_f32_16x16x32_bf16 v[12:15], a[204:207], a[120:123], v[12:15]
  ds_read_b64_tr_b16 a[238:239], v235 offset:14336
  s_add_u32 m0, s42, 118784
  v_mfma_f32_16x16x32_bf16 v[28:31], a[200:203], a[116:119], v[28:31]
  buffer_load_dwordx4 v241, s[8:11], s41 offen lds
  v_mfma_f32_16x16x32_bf16 v[28:31], a[204:207], a[124:127], v[28:31]
  s_barrier
  ds_read_b64_tr_b16 a[192:193], v232 offset:16384
  s_waitcnt vmcnt(16)
  v_mfma_f32_16x16x32_bf16 v[0:3], a[208:211], a[128:131], v[0:3]
  ds_read_b64_tr_b16 a[194:195], v232 offset:18432
  ds_read_b64_tr_b16 a[196:197], v232 offset:20480
  s_mov_b32 s40, 8126464
  v_mfma_f32_16x16x32_bf16 v[0:3], a[212:215], a[136:139], v[0:3]
  buffer_load_dwordx4 a[176:179], v240, s[4:7], s40 offen offset:0
  v_mfma_f32_16x16x32_bf16 v[16:19], a[208:211], a[132:135], v[16:19]
  ds_read_b64_tr_b16 a[198:199], v232 offset:22528
  ds_read_b64_tr_b16 a[200:201], v233 offset:16384
  s_waitcnt lgkmcnt(8)
  v_mfma_f32_16x16x32_bf16 v[16:19], a[212:215], a[140:143], v[16:19]
  buffer_load_dwordx4 a[180:183], v240, s[4:7], s40 offen offset:1024
  s_mov_b32 s40, 8257536
  v_mfma_f32_16x16x32_bf16 v[4:7], a[216:219], a[128:131], v[4:7]
  ds_read_b64_tr_b16 a[202:203], v233 offset:18432
  ds_read_b64_tr_b16 a[204:205], v233 offset:20480
  v_mfma_f32_16x16x32_bf16 v[4:7], a[220:223], a[136:139], v[4:7]
  buffer_load_dwordx4 a[184:187], v240, s[4:7], s40 offen offset:0
  v_mfma_f32_16x16x32_bf16 v[20:23], a[216:219], a[132:135], v[20:23]
  ds_read_b64_tr_b16 a[206:207], v233 offset:22528
  ds_read_b64_tr_b16 a[208:209], v234 offset:16384
  v_mfma_f32_16x16x32_bf16 v[20:23], a[220:223], a[140:143], v[20:23]
  buffer_load_dwordx4 a[188:191], v240, s[4:7], s40 offen offset:1024
  v_mfma_f32_16x16x32_bf16 v[8:11], a[224:227], a[128:131], v[8:11]
  ds_read_b64_tr_b16 a[210:211], v234 offset:18432
  ds_read_b64_tr_b16 a[212:213], v234 offset:20480
  s_mov_b32 s41, 1835008
  v_mfma_f32_16x16x32_bf16 v[8:11], a[228:231], a[136:139], v[8:11]
  ds_read_b64_tr_b16 a[214:215], v234 offset:22528
  ds_read_b64_tr_b16 a[216:217], v235 offset:16384
  s_add_u32 m0, s42, 122880
  v_mfma_f32_16x16x32_bf16 v[24:27], a[224:227], a[132:135], v[24:27]
  buffer_load_dwordx4 v241, s[8:11], s41 offen lds
  v_mfma_f32_16x16x32_bf16 v[24:27], a[228:231], a[140:143], v[24:27]
  ds_read_b64_tr_b16 a[218:219], v235 offset:18432
  ds_read_b64_tr_b16 a[220:221], v235 offset:20480
  s_mov_b32 s41, 1900544
  s_waitcnt lgkmcnt(10)
  v_mfma_f32_16x16x32_bf16 v[12:15], a[232:235], a[128:131], v[12:15]
  ds_read_b64_tr_b16 a[222:223], v235 offset:22528
  s_add_u32 m0, s42, 126976
  v_mfma_f32_16x16x32_bf16 v[12:15], a[236:239], a[136:139], v[12:15]
  buffer_load_dwordx4 v241, s[8:11], s41 offen lds
  v_mfma_f32_16x16x32_bf16 v[28:31], a[232:235], a[132:135], v[28:31]
  s_mov_b32 s40, 8388608
  v_mfma_f32_16x16x32_bf16 v[28:31], a[236:239], a[140:143], v[28:31]
  s_barrier
  ds_read_b64_tr_b16 a[224:225], v232 offset:24576
  ds_read_b128 v[64:67], v250 offset:0
  s_waitcnt vmcnt(14)
  v_mfma_f32_16x16x32_bf16 v[0:3], a[192:195], a[144:147], v[0:3]
  buffer_load_dwordx4 a[0:3], v240, s[4:7], s40 offen offset:0
  v_mfma_f32_16x16x32_bf16 v[0:3], a[196:199], a[152:155], v[0:3]
  ds_read_b64_tr_b16 a[226:227], v232 offset:26624
  ds_read_b64_tr_b16 a[228:229], v232 offset:28672
  ds_read_b128 v[68:71], v250 offset:64
  v_mfma_f32_16x16x32_bf16 v[16:19], a[192:195], a[148:151], v[16:19]
  buffer_load_dwordx4 a[4:7], v240, s[4:7], s40 offen offset:1024
  s_mov_b32 s40, 8519680
  v_mfma_f32_16x16x32_bf16 v[16:19], a[196:199], a[156:159], v[16:19]
  ds_read_b64_tr_b16 a[230:231], v232 offset:30720
  ds_read_b64_tr_b16 a[232:233], v233 offset:24576
  ds_read_b128 v[72:75], v250 offset:128
  s_waitcnt lgkmcnt(10)
  v_mfma_f32_16x16x32_bf16 v[4:7], a[200:203], a[144:147], v[4:7]
  buffer_load_dwordx4 a[8:11], v240, s[4:7], s40 offen offset:0
  v_mfma_f32_16x16x32_bf16 v[4:7], a[204:207], a[152:155], v[4:7]
  ds_read_b64_tr_b16 a[234:235], v233 offset:26624
  ds_read_b64_tr_b16 a[236:237], v233 offset:28672
  ds_read_b128 v[76:79], v250 offset:192
  v_mfma_f32_16x16x32_bf16 v[20:23], a[200:203], a[148:151], v[20:23]
  buffer_load_dwordx4 a[12:15], v240, s[4:7], s40 offen offset:1024
  v_mfma_f32_16x16x32_bf16 v[20:23], a[204:207], a[156:159], v[20:23]
  ds_read_b64_tr_b16 a[238:239], v233 offset:30720
  ds_read_b64_tr_b16 a[192:193], v234 offset:24576
  s_mov_b32 s41, 1966080
  ds_read_b128 v[96:99], v250 offset:256
  v_mfma_f32_16x16x32_bf16 v[8:11], a[208:211], a[144:147], v[8:11]
  ds_read_b64_tr_b16 a[194:195], v234 offset:26624
  ds_read_b64_tr_b16 a[196:197], v234 offset:28672
  s_add_u32 m0, s42, 131072
  v_mfma_f32_16x16x32_bf16 v[8:11], a[212:215], a[152:155], v[8:11]
  buffer_load_dwordx4 v241, s[8:11], s41 offen lds
  ds_read_b128 v[100:103], v250 offset:320
  v_mfma_f32_16x16x32_bf16 v[24:27], a[208:211], a[148:151], v[24:27]
  ds_read_b64_tr_b16 a[198:199], v234 offset:30720
  ds_read_b64_tr_b16 a[200:201], v235 offset:24576
  s_mov_b32 s41, 2031616
  v_mfma_f32_16x16x32_bf16 v[24:27], a[212:215], a[156:159], v[24:27]
  ds_read_b64_tr_b16 a[202:203], v235 offset:26624
  ds_read_b64_tr_b16 a[204:205], v235 offset:28672
  s_add_u32 m0, s42, 135168
  ds_read_b128 v[104:107], v250 offset:384
  v_mfma_f32_16x16x32_bf16 v[12:15], a[216:219], a[144:147], v[12:15]
  buffer_load_dwordx4 v241, s[8:11], s41 offen lds
  s_waitcnt lgkmcnt(10)
  v_mfma_f32_16x16x32_bf16 v[12:15], a[220:223], a[152:155], v[12:15]
  ds_read_b64_tr_b16 a[206:207], v235 offset:30720
  s_mov_b32 s40, 8650752
  ds_read_b128 v[108:111], v250 offset:448
  v_mfma_f32_16x16x32_bf16 v[28:31], a[216:219], a[148:151], v[28:31]
  buffer_load_dwordx4 a[16:19], v240, s[4:7], s40 offen offset:0
  v_mfma_f32_16x16x32_bf16 v[28:31], a[220:223], a[156:159], v[28:31]
  s_barrier
  ds_read_b64_tr_b16 a[208:209], v232 offset:32768
  ds_read_b128 v[112:115], v250 offset:512
  s_waitcnt vmcnt(15)
  v_mfma_f32_16x16x32_bf16 v[0:3], a[224:227], a[160:163], v[0:3]
  buffer_load_dwordx4 a[20:23], v240, s[4:7], s40 offen offset:1024
  s_mov_b32 s40, 8781824
  v_mfma_f32_16x16x32_bf16 v[0:3], a[228:231], a[168:171], v[0:3]
  ds_read_b64_tr_b16 a[210:211], v232 offset:34816
  ds_read_b64_tr_b16 a[212:213], v232 offset:36864
  ds_read_b128 v[116:119], v250 offset:576
  v_mfma_f32_16x16x32_bf16 v[16:19], a[224:227], a[164:167], v[16:19]
  buffer_load_dwordx4 a[24:27], v240, s[4:7], s40 offen offset:0
  v_mfma_f32_16x16x32_bf16 v[16:19], a[228:231], a[172:175], v[16:19]
  ds_read_b64_tr_b16 a[214:215], v232 offset:38912
  ds_read_b64_tr_b16 a[216:217], v233 offset:32768
  ds_read_b128 v[120:123], v250 offset:640
  v_mfma_f32_16x16x32_bf16 v[4:7], a[232:235], a[160:163], v[4:7]
  buffer_load_dwordx4 a[28:31], v240, s[4:7], s40 offen offset:1024
  v_mfma_f32_16x16x32_bf16 v[4:7], a[236:239], a[168:171], v[4:7]
  ds_read_b64_tr_b16 a[218:219], v233 offset:34816
  ds_read_b64_tr_b16 a[220:221], v233 offset:36864
  s_mov_b32 s40, 8912896
  ds_read_b128 v[124:127], v250 offset:704
  v_mfma_f32_16x16x32_bf16 v[20:23], a[232:235], a[164:167], v[20:23]
  buffer_load_dwordx4 a[32:35], v240, s[4:7], s40 offen offset:0
  v_permlane16_swap_b32 v48, v50
  v_permlane16_swap_b32 v49, v51
  v_permlane16_swap_b32 v52, v54
  v_permlane16_swap_b32 v53, v55
  v_permlane16_swap_b32 v56, v58
  v_mfma_f32_16x16x32_bf16 v[20:23], a[236:239], a[172:175], v[20:23]
  ds_read_b64_tr_b16 a[222:223], v233 offset:38912
  ds_read_b64_tr_b16 a[224:225], v234 offset:32768
  v_permlane16_swap_b32 v57, v59
  s_waitcnt lgkmcnt(10)
  v_mfma_f32_16x16x32_bf16 v[8:11], a[192:195], a[160:163], v[8:11]
  buffer_load_dwordx4 a[36:39], v240, s[4:7], s40 offen offset:1024
  s_mov_b32 s40, 9043968
  v_mfma_f32_16x16x32_bf16 v[8:11], a[196:199], a[168:171], v[8:11]
  ds_read_b64_tr_b16 a[226:227], v234 offset:34816
  ds_read_b64_tr_b16 a[228:229], v234 offset:36864
  v_permlane16_swap_b32 v60, v62
  v_mfma_f32_16x16x32_bf16 v[24:27], a[192:195], a[164:167], v[24:27]
  buffer_load_dwordx4 a[40:43], v240, s[4:7], s40 offen offset:0
  v_permlane16_swap_b32 v61, v63
  v_mfma_f32_16x16x32_bf16 v[24:27], a[196:199], a[172:175], v[24:27]
  ds_read_b64_tr_b16 a[230:231], v234 offset:38912
  ds_read_b64_tr_b16 a[232:233], v235 offset:32768
  v_lshlrev_b32 v128, 16, v48
  v_mfma_f32_16x16x32_bf16 v[12:15], a[200:203], a[160:163], v[12:15]
  buffer_load_dwordx4 a[44:47], v240, s[4:7], s40 offen offset:1024
  v_and_b32 v129, 0xffff0000, v48
  v_mfma_f32_16x16x32_bf16 v[12:15], a[204:207], a[168:171], v[12:15]
  ds_read_b64_tr_b16 a[234:235], v235 offset:34816
  ds_read_b64_tr_b16 a[236:237], v235 offset:36864
  s_mov_b32 s40, 9175040
  v_mfma_f32_16x16x32_bf16 v[28:31], a[200:203], a[164:167], v[28:31]
  buffer_load_dwordx4 a[48:51], v240, s[4:7], s40 offen offset:0
  v_lshlrev_b32 v130, 16, v49
  v_mfma_f32_16x16x32_bf16 v[28:31], a[204:207], a[172:175], v[28:31]
  s_barrier
  ds_read_b64_tr_b16 a[238:239], v235 offset:38912
  s_waitcnt vmcnt(17)
  v_mfma_f32_16x16x32_bf16 v[0:3], a[208:211], a[176:179], v[0:3]
  buffer_load_dwordx4 a[52:55], v240, s[4:7], s40 offen offset:1024
  s_mov_b32 s40, 9306112
  v_and_b32 v131, 0xffff0000, v49
  s_waitcnt lgkmcnt(10)
  v_mfma_f32_16x16x32_bf16 v[0:3], a[212:215], a[184:187], v[0:3]
  ds_read_b64_tr_b16 a[192:193], v232 offset:40960
  ds_read_b64_tr_b16 a[194:195], v232 offset:43008
  v_lshlrev_b32 v132, 16, v50
  v_mfma_f32_16x16x32_bf16 v[16:19], a[208:211], a[180:183], v[16:19]
  buffer_load_dwordx4 a[56:59], v240, s[4:7], s40 offen offset:0
  v_and_b32 v133, 0xffff0000, v50
  v_mfma_f32_16x16x32_bf16 v[16:19], a[212:215], a[188:191], v[16:19]
  ds_read_b64_tr_b16 a[196:197], v232 offset:45056
  ds_read_b64_tr_b16 a[198:199], v232 offset:47104
  v_lshlrev_b32 v134, 16, v51
  v_mfma_f32_16x16x32_bf16 v[4:7], a[216:219], a[176:179], v[4:7]
  buffer_load_dwordx4 a[60:63], v240, s[4:7], s40 offen offset:1024
  v_and_b32 v135, 0xffff0000, v51
  s_waitcnt lgkmcnt(10)
  v_mfma_f32_16x16x32_bf16 v[4:7], a[220:223], a[184:187], v[4:7]
  ds_read_b64_tr_b16 a[200:201], v233 offset:40960
  ds_read_b64_tr_b16 a[202:203], v233 offset:43008
  v_lshlrev_b32 v136, 16, v52
  v_mfma_f32_16x16x32_bf16 v[20:23], a[216:219], a[180:183], v[20:23]
  ds_read_b64_tr_b16 a[204:205], v233 offset:45056
  ds_read_b64_tr_b16 a[206:207], v233 offset:47104
  v_and_b32 v137, 0xffff0000, v52
  v_mfma_f32_16x16x32_bf16 v[20:23], a[220:223], a[188:191], v[20:23]
  ds_read_b64_tr_b16 a[208:209], v234 offset:40960
  ds_read_b64_tr_b16 a[210:211], v234 offset:43008
  v_lshlrev_b32 v138, 16, v53
  v_mfma_f32_16x16x32_bf16 v[8:11], a[224:227], a[176:179], v[8:11]
  ds_read_b64_tr_b16 a[212:213], v234 offset:45056
  ds_read_b64_tr_b16 a[214:215], v234 offset:47104
  v_and_b32 v139, 0xffff0000, v53
  s_waitcnt lgkmcnt(10)
  v_mfma_f32_16x16x32_bf16 v[8:11], a[228:231], a[184:187], v[8:11]
  ds_read_b64_tr_b16 a[216:217], v235 offset:40960
  ds_read_b64_tr_b16 a[218:219], v235 offset:43008
  v_lshlrev_b32 v140, 16, v54
  v_mfma_f32_16x16x32_bf16 v[24:27], a[224:227], a[180:183], v[24:27]
  ds_read_b64_tr_b16 a[220:221], v235 offset:45056
  ds_read_b64_tr_b16 a[222:223], v235 offset:47104
  v_and_b32 v141, 0xffff0000, v54
  v_mfma_f32_16x16x32_bf16 v[24:27], a[228:231], a[188:191], v[24:27]
  v_lshlrev_b32 v142, 16, v55
  v_and_b32 v143, 0xffff0000, v55
  v_lshlrev_b32 v144, 16, v56
  v_mfma_f32_16x16x32_bf16 v[12:15], a[232:235], a[176:179], v[12:15]
  v_and_b32 v145, 0xffff0000, v56
  v_lshlrev_b32 v146, 16, v57
  v_and_b32 v147, 0xffff0000, v57
  v_mfma_f32_16x16x32_bf16 v[12:15], a[236:239], a[184:187], v[12:15]
  v_lshlrev_b32 v148, 16, v58
  v_and_b32 v149, 0xffff0000, v58
  v_lshlrev_b32 v150, 16, v59
  v_mfma_f32_16x16x32_bf16 v[28:31], a[232:235], a[180:183], v[28:31]
  v_and_b32 v151, 0xffff0000, v59
  v_lshlrev_b32 v152, 16, v60
  v_and_b32 v153, 0xffff0000, v60
  v_mfma_f32_16x16x32_bf16 v[28:31], a[236:239], a[188:191], v[28:31]
  s_barrier
  ds_read_b64_tr_b16 a[224:225], v232 offset:49152
  s_waitcnt vmcnt(14)
  v_mfma_f32_16x16x32_bf16 v[0:3], a[192:195], a[0:3], v[0:3]
  ds_read_b64_tr_b16 a[226:227], v232 offset:51200
  ds_read_b64_tr_b16 a[228:229], v232 offset:53248
  v_lshlrev_b32 v154, 16, v61
  s_waitcnt lgkmcnt(10)
  v_mfma_f32_16x16x32_bf16 v[0:3], a[196:199], a[8:11], v[0:3]
  ds_read_b64_tr_b16 a[230:231], v232 offset:55296
  ds_read_b64_tr_b16 a[232:233], v233 offset:49152
  v_and_b32 v155, 0xffff0000, v61
  v_mfma_f32_16x16x32_bf16 v[16:19], a[192:195], a[4:7], v[16:19]
  ds_read_b64_tr_b16 a[234:235], v233 offset:51200
  ds_read_b64_tr_b16 a[236:237], v233 offset:53248
  v_lshlrev_b32 v156, 16, v62
  v_mfma_f32_16x16x32_bf16 v[16:19], a[196:199], a[12:15], v[16:19]
  ds_read_b64_tr_b16 a[238:239], v233 offset:55296
  v_and_b32 v157, 0xffff0000, v62
  v_lshlrev_b32 v158, 16, v63
  v_mfma_f32_16x16x32_bf16 v[4:7], a[200:203], a[0:3], v[4:7]
  ds_read_b64_tr_b16 a[192:193], v234 offset:49152
  ds_read_b64_tr_b16 a[194:195], v234 offset:51200
  v_and_b32 v159, 0xffff0000, v63
  v_mfma_f32_16x16x32_bf16 v[4:7], a[204:207], a[8:11], v[4:7]
  ds_read_b64_tr_b16 a[196:197], v234 offset:53248
  ds_read_b64_tr_b16 a[198:199], v234 offset:55296
  v_mfma_f32_16x16x32_bf16 v[20:23], a[200:203], a[4:7], v[20:23]
  ds_read_b64_tr_b16 a[200:201], v235 offset:49152
  v_mfma_f32_16x16x32_bf16 v[20:23], a[204:207], a[12:15], v[20:23]
  ds_read_b64_tr_b16 a[202:203], v235 offset:51200
  s_waitcnt lgkmcnt(10)
  v_mfma_f32_16x16x32_bf16 v[8:11], a[208:211], a[0:3], v[8:11]
  ds_read_b64_tr_b16 a[204:205], v235 offset:53248
  v_mfma_f32_16x16x32_bf16 v[8:11], a[212:215], a[8:11], v[8:11]
  ds_read_b64_tr_b16 a[206:207], v235 offset:55296
  v_mfma_f32_16x16x32_bf16 v[24:27], a[208:211], a[4:7], v[24:27]
  v_mfma_f32_16x16x32_bf16 v[24:27], a[212:215], a[12:15], v[24:27]
  v_mfma_f32_16x16x32_bf16 v[12:15], a[216:219], a[0:3], v[12:15]
  v_mfma_f32_16x16x32_bf16 v[12:15], a[220:223], a[8:11], v[12:15]
  v_mfma_f32_16x16x32_bf16 v[28:31], a[216:219], a[4:7], v[28:31]
  v_mfma_f32_16x16x32_bf16 v[28:31], a[220:223], a[12:15], v[28:31]
  s_barrier
  ds_read_b64_tr_b16 a[208:209], v232 offset:57344
  s_waitcnt vmcnt(8)
  v_mfma_f32_16x16x32_bf16 v[0:3], a[224:227], a[16:19], v[0:3]
  ds_read_b64_tr_b16 a[210:211], v232 offset:59392
  ds_read_b64_tr_b16 a[212:213], v232 offset:61440
  v_mfma_f32_16x16x32_bf16 v[0:3], a[228:231], a[24:27], v[0:3]
  ds_read_b64_tr_b16 a[214:215], v232 offset:63488
  ds_read_b64_tr_b16 a[216:217], v233 offset:57344
  v_mfma_f32_16x16x32_bf16 v[16:19], a[224:227], a[20:23], v[16:19]
  ds_read_b64_tr_b16 a[218:219], v233 offset:59392
  ds_read_b64_tr_b16 a[220:221], v233 offset:61440
  v_mfma_f32_16x16x32_bf16 v[16:19], a[228:231], a[28:31], v[16:19]
  ds_read_b64_tr_b16 a[222:223], v233 offset:63488
  s_waitcnt lgkmcnt(10)
  v_mfma_f32_16x16x32_bf16 v[4:7], a[232:235], a[16:19], v[4:7]
  ds_read_b64_tr_b16 a[224:225], v234 offset:57344
  ds_read_b64_tr_b16 a[226:227], v234 offset:59392
  v_mfma_f32_16x16x32_bf16 v[4:7], a[236:239], a[24:27], v[4:7]
  ds_read_b64_tr_b16 a[228:229], v234 offset:61440
  ds_read_b64_tr_b16 a[230:231], v234 offset:63488
  v_mfma_f32_16x16x32_bf16 v[20:23], a[232:235], a[20:23], v[20:23]
  ds_read_b64_tr_b16 a[232:233], v235 offset:57344
  v_mfma_f32_16x16x32_bf16 v[20:23], a[236:239], a[28:31], v[20:23]
  ds_read_b64_tr_b16 a[234:235], v235 offset:59392
  v_mfma_f32_16x16x32_bf16 v[8:11], a[192:195], a[16:19], v[8:11]
  ds_read_b64_tr_b16 a[236:237], v235 offset:61440
  v_mfma_f32_16x16x32_bf16 v[8:11], a[196:199], a[24:27], v[8:11]
  ds_read_b64_tr_b16 a[238:239], v235 offset:63488
  v_mfma_f32_16x16x32_bf16 v[24:27], a[192:195], a[20:23], v[24:27]
  v_mfma_f32_16x16x32_bf16 v[24:27], a[196:199], a[28:31], v[24:27]
  v_mfma_f32_16x16x32_bf16 v[12:15], a[200:203], a[16:19], v[12:15]
  s_waitcnt lgkmcnt(10)
  v_mfma_f32_16x16x32_bf16 v[12:15], a[204:207], a[24:27], v[12:15]
  v_mfma_f32_16x16x32_bf16 v[28:31], a[200:203], a[20:23], v[28:31]
  v_mfma_f32_16x16x32_bf16 v[28:31], a[204:207], a[28:31], v[28:31]
  s_barrier
  ds_read_b64_tr_b16 a[192:193], v236 offset:0
  s_waitcnt vmcnt(4)
  v_mfma_f32_16x16x32_bf16 v[0:3], a[208:211], a[32:35], v[0:3]
  ds_read_b64_tr_b16 a[194:195], v236 offset:2048
  ds_read_b64_tr_b16 a[196:197], v236 offset:4096
  v_mfma_f32_16x16x32_bf16 v[0:3], a[212:215], a[40:43], v[0:3]
  ds_read_b64_tr_b16 a[198:199], v236 offset:6144
  ds_read_b64_tr_b16 a[200:201], v237 offset:0
  v_mfma_f32_16x16x32_bf16 v[16:19], a[208:211], a[36:39], v[16:19]
  ds_read_b64_tr_b16 a[202:203], v237 offset:2048
  ds_read_b64_tr_b16 a[204:205], v237 offset:4096
  v_mfma_f32_16x16x32_bf16 v[16:19], a[212:215], a[44:47], v[16:19]
  ds_read_b64_tr_b16 a[206:207], v237 offset:6144
  v_mfma_f32_16x16x32_bf16 v[4:7], a[216:219], a[32:35], v[4:7]
  ds_read_b64_tr_b16 a[208:209], v238 offset:0
  ds_read_b64_tr_b16 a[210:211], v238 offset:2048
  s_waitcnt lgkmcnt(10)
  v_mfma_f32_16x16x32_bf16 v[4:7], a[220:223], a[40:43], v[4:7]
  ds_read_b64_tr_b16 a[212:213], v238 offset:4096
  ds_read_b64_tr_b16 a[214:215], v238 offset:6144
  v_mfma_f32_16x16x32_bf16 v[20:23], a[216:219], a[36:39], v[20:23]
  ds_read_b64_tr_b16 a[216:217], v239 offset:0
  v_mfma_f32_16x16x32_bf16 v[20:23], a[220:223], a[44:47], v[20:23]
  ds_read_b64_tr_b16 a[218:219], v239 offset:2048
  v_mfma_f32_16x16x32_bf16 v[8:11], a[224:227], a[32:35], v[8:11]
  ds_read_b64_tr_b16 a[220:221], v239 offset:4096
  v_mfma_f32_16x16x32_bf16 v[8:11], a[228:231], a[40:43], v[8:11]
  ds_read_b64_tr_b16 a[222:223], v239 offset:6144
  v_mfma_f32_16x16x32_bf16 v[24:27], a[224:227], a[36:39], v[24:27]
  v_mfma_f32_16x16x32_bf16 v[24:27], a[228:231], a[44:47], v[24:27]
  v_mfma_f32_16x16x32_bf16 v[12:15], a[232:235], a[32:35], v[12:15]
  v_mfma_f32_16x16x32_bf16 v[12:15], a[236:239], a[40:43], v[12:15]
  v_mfma_f32_16x16x32_bf16 v[28:31], a[232:235], a[36:39], v[28:31]
  v_mfma_f32_16x16x32_bf16 v[28:31], a[236:239], a[44:47], v[28:31]
  s_barrier
  s_waitcnt vmcnt(0) lgkmcnt(10)
  v_mfma_f32_16x16x32_bf16 v[0:3], a[192:195], a[48:51], v[0:3]
  v_mfma_f32_16x16x32_bf16 v[0:3], a[196:199], a[56:59], v[0:3]
  v_mfma_f32_16x16x32_bf16 v[16:19], a[192:195], a[52:55], v[16:19]
  v_mfma_f32_16x16x32_bf16 v[16:19], a[196:199], a[60:63], v[16:19]
  v_mfma_f32_16x16x32_bf16 v[4:7], a[200:203], a[48:51], v[4:7]
  s_waitcnt lgkmcnt(8)
  v_mfma_f32_16x16x32_bf16 v[4:7], a[204:207], a[56:59], v[4:7]
  v_mfma_f32_16x16x32_bf16 v[20:23], a[200:203], a[52:55], v[20:23]
  v_mfma_f32_16x16x32_bf16 v[20:23], a[204:207], a[60:63], v[20:23]
  s_waitcnt lgkmcnt(6)
  v_mfma_f32_16x16x32_bf16 v[8:11], a[208:211], a[48:51], v[8:11]
  s_waitcnt lgkmcnt(4)
  v_mfma_f32_16x16x32_bf16 v[8:11], a[212:215], a[56:59], v[8:11]
  v_mfma_f32_16x16x32_bf16 v[24:27], a[208:211], a[52:55], v[24:27]
  v_mfma_f32_16x16x32_bf16 v[24:27], a[212:215], a[60:63], v[24:27]
  s_waitcnt lgkmcnt(2)
  v_mfma_f32_16x16x32_bf16 v[12:15], a[216:219], a[48:51], v[12:15]
  s_waitcnt lgkmcnt(0)
  v_mfma_f32_16x16x32_bf16 v[12:15], a[220:223], a[56:59], v[12:15]
  v_mfma_f32_16x16x32_bf16 v[28:31], a[216:219], a[52:55], v[28:31]
  v_mfma_f32_16x16x32_bf16 v[28:31], a[220:223], a[60:63], v[28:31]
  v_pk_fma_f32 v[128:129], v[0:1], v[64:65], v[128:129]
  v_pk_fma_f32 v[130:131], v[2:3], v[66:67], v[130:131]
  v_pk_fma_f32 v[132:133], v[4:5], v[68:69], v[132:133]
  v_pk_fma_f32 v[134:135], v[6:7], v[70:71], v[134:135]
  v_pk_fma_f32 v[136:137], v[8:9], v[72:73], v[136:137]
  v_pk_fma_f32 v[138:139], v[10:11], v[74:75], v[138:139]
  v_pk_fma_f32 v[140:141], v[12:13], v[76:77], v[140:141]
  v_pk_fma_f32 v[142:143], v[14:15], v[78:79], v[142:143]
  v_pk_fma_f32 v[144:145], v[16:17], v[64:65], v[144:145]
  v_pk_fma_f32 v[146:147], v[18:19], v[66:67], v[146:147]
  v_pk_fma_f32 v[148:149], v[20:21], v[68:69], v[148:149]
  v_pk_fma_f32 v[150:151], v[22:23], v[70:71], v[150:151]
  v_pk_fma_f32 v[152:153], v[24:25], v[72:73], v[152:153]
  v_pk_fma_f32 v[154:155], v[26:27], v[74:75], v[154:155]
  v_pk_fma_f32 v[156:157], v[28:29], v[76:77], v[156:157]
  v_pk_fma_f32 v[158:159], v[30:31], v[78:79], v[158:159]
  v_pk_mul_f32 v[164:165], v[128:129], v[128:129]
  v_pk_mul_f32 v[166:167], v[144:145], v[144:145]
  v_pk_fma_f32 v[164:165], v[130:131], v[130:131], v[164:165]
  v_pk_add_f32 v[160:161], v[128:129], v[130:131]
  v_pk_fma_f32 v[166:167], v[146:147], v[146:147], v[166:167]
  v_pk_add_f32 v[162:163], v[144:145], v[146:147]
  v_pk_fma_f32 v[164:165], v[132:133], v[132:133], v[164:165]
  v_pk_add_f32 v[160:161], v[160:161], v[132:133]
  v_pk_fma_f32 v[166:167], v[148:149], v[148:149], v[166:167]
  v_pk_add_f32 v[162:163], v[162:163], v[148:149]
  v_pk_fma_f32 v[164:165], v[134:135], v[134:135], v[164:165]
  v_pk_add_f32 v[160:161], v[160:161], v[134:135]
  v_pk_fma_f32 v[166:167], v[150:151], v[150:151], v[166:167]
  v_pk_add_f32 v[162:163], v[162:163], v[150:151]
  v_pk_fma_f32 v[164:165], v[136:137], v[136:137], v[164:165]
  v_pk_add_f32 v[160:161], v[160:161], v[136:137]
  v_pk_fma_f32 v[166:167], v[152:153], v[152:153], v[166:167]
  v_pk_add_f32 v[162:163], v[162:163], v[152:153]
  v_pk_fma_f32 v[164:165], v[138:139], v[138:139], v[164:165]
  v_pk_add_f32 v[160:161], v[160:161], v[138:139]
  v_pk_fma_f32 v[166:167], v[154:155], v[154:155], v[166:167]
  v_pk_add_f32 v[162:163], v[162:163], v[154:155]
  v_pk_fma_f32 v[164:165], v[140:141], v[140:141], v[164:165]
  v_pk_add_f32 v[160:161], v[160:161], v[140:141]
  v_pk_fma_f32 v[166:167], v[156:157], v[156:157], v[166:167]
  v_pk_add_f32 v[162:163], v[162:163], v[156:157]
  v_pk_fma_f32 v[164:165], v[142:143], v[142:143], v[164:165]
  v_pk_add_f32 v[160:161], v[160:161], v[142:143]
  v_pk_fma_f32 v[166:167], v[158:159], v[158:159], v[166:167]
  v_pk_add_f32 v[162:163], v[162:163], v[158:159]
  v_add_f32 v160, v160, v161
  v_add_f32 v161, v164, v165
  v_add_f32 v162, v162, v163
  v_add_f32 v163, v166, v167
  v_mov_b32 v164, v160
  v_mov_b32 v165, v161
  v_mov_b32 v166, v162
  v_mov_b32 v167, v163
  v_permlane16_swap_b32 v164, v160
  v_permlane16_swap_b32 v165, v161
  v_permlane16_swap_b32 v166, v162
  v_permlane16_swap_b32 v167, v163
  v_add_f32 v160, v160, v164
  v_add_f32 v161, v161, v165
  v_add_f32 v162, v162, v166
  v_add_f32 v163, v163, v167
  v_mov_b32 v164, v160
  v_mov_b32 v165, v161
  v_mov_b32 v166, v162
  v_mov_b32 v167, v163
  v_permlane32_swap_b32 v164, v160
  v_permlane32_swap_b32 v165, v161
  v_permlane32_swap_b32 v166, v162
  v_permlane32_swap_b32 v167, v163
  v_add_f32 v160, v160, v164
  v_add_f32 v161, v161, v165
  v_add_f32 v162, v162, v166
  v_add_f32 v163, v163, v167
  v_cndmask_b32_e64 v164, v162, v160, s[34:35]
  v_cndmask_b32_e64 v165, v163, v161, s[34:35]
  v_and_b32 v164, -2, v164
  v_and_b32 v165, 0x7fffffff, v165
  s_mov_b32 exec_hi, 0
  buffer_store_dwordx2 v[164:165], v89, s[4:7], s95 offen sc1
  s_mov_b64 exec, -1
  s_mov_b32 s41, 0
  s_add_u32 m0, s42, 139264
  s_nop 0
  buffer_load_dwordx4 v227, s[12:15], s41 offen lds
  s_mov_b32 s41, 229376
  s_add_u32 m0, s42, 143360
  s_nop 0
  buffer_load_dwordx4 v227, s[12:15], s41 offen lds
  s_mov_b32 s41, 0
  s_add_u32 m0, s42, 147456
  s_nop 0
  buffer_load_dwordx4 v227, s[16:19], s41 offen lds
  s_mov_b32 s41, 229376
  s_add_u32 m0, s42, 151552
  s_nop 0
  buffer_load_dwordx4 v227, s[16:19], s41 offen lds
  s_mov_b32 s41, 0
  s_add_u32 m0, s42, 155648
  s_nop 0
  buffer_load_dwordx4 v226, s[12:15], s41 offen lds
  s_mov_b32 s41, 229376
  s_add_u32 m0, s42, 159744
  s_nop 0
  buffer_load_dwordx4 v226, s[12:15], s41 offen lds
  s_mov_b32 s41, 0
  s_add_u32 m0, s42, 8192
  s_nop 0
  buffer_load_dwordx4 v226, s[16:19], s41 offen lds
  s_mov_b32 s41, 229376
  s_add_u32 m0, s42, 12288
  s_nop 0
  buffer_load_dwordx4 v226, s[16:19], s41 offen lds
  s_mov_b32 s41, 458752
  s_add_u32 m0, s42, 16384
  s_nop 0
  buffer_load_dwordx4 v227, s[12:15], s41 offen lds
  s_mov_b32 s41, 688128
  s_add_u32 m0, s42, 20480
  s_nop 0
  buffer_load_dwordx4 v227, s[12:15], s41 offen lds
  s_mov_b32 s41, 458752
  s_add_u32 m0, s42, 24576
  s_nop 0
  buffer_load_dwordx4 v227, s[16:19], s41 offen lds
  s_mov_b32 s41, 688128
  s_add_u32 m0, s42, 28672
  s_nop 0
  buffer_load_dwordx4 v227, s[16:19], s41 offen lds
  v_cvt_pk_bf16_f32 v48, v128, v129
  v_cvt_pk_bf16_f32 v49, v130, v131
  v_cvt_pk_bf16_f32 v50, v132, v133
  v_cvt_pk_bf16_f32 v51, v134, v135
  v_cvt_pk_bf16_f32 v52, v136, v137
  v_cvt_pk_bf16_f32 v53, v138, v139
  v_cvt_pk_bf16_f32 v54, v140, v141
  v_cvt_pk_bf16_f32 v55, v142, v143
  v_cvt_pk_bf16_f32 v56, v144, v145
  v_cvt_pk_bf16_f32 v57, v146, v147
  v_cvt_pk_bf16_f32 v58, v148, v149
  v_cvt_pk_bf16_f32 v59, v150, v151
  v_cvt_pk_bf16_f32 v60, v152, v153
  v_cvt_pk_bf16_f32 v61, v154, v155
  v_cvt_pk_bf16_f32 v62, v156, v157
  v_cvt_pk_bf16_f32 v63, v158, v159
  v_accvgpr_write_b32 a240, v48
  v_lshlrev_b32 v0, 16, v48
  v_and_b32 v1, 0xffff0000, v48
  v_accvgpr_write_b32 a241, v49
  v_lshlrev_b32 v2, 16, v49
  v_and_b32 v3, 0xffff0000, v49
  v_accvgpr_write_b32 a242, v50
  v_lshlrev_b32 v4, 16, v50
  v_and_b32 v5, 0xffff0000, v50
  v_accvgpr_write_b32 a243, v51
  v_lshlrev_b32 v6, 16, v51
  v_and_b32 v7, 0xffff0000, v51
  v_accvgpr_write_b32 a244, v52
  v_lshlrev_b32 v8, 16, v52
  v_and_b32 v9, 0xffff0000, v52
  v_accvgpr_write_b32 a245, v53
  v_lshlrev_b32 v10, 16, v53
  v_and_b32 v11, 0xffff0000, v53
  v_accvgpr_write_b32 a246, v54
  v_lshlrev_b32 v12, 16, v54
  v_and_b32 v13, 0xffff0000, v54
  v_accvgpr_write_b32 a247, v55
  v_lshlrev_b32 v14, 16, v55
  v_and_b32 v15, 0xffff0000, v55
  v_accvgpr_write_b32 a248, v56
  v_lshlrev_b32 v16, 16, v56
  v_and_b32 v17, 0xffff0000, v56
  v_accvgpr_write_b32 a249, v57
  v_lshlrev_b32 v18, 16, v57
  v_and_b32 v19, 0xffff0000, v57
  v_accvgpr_write_b32 a250, v58
  v_lshlrev_b32 v20, 16, v58
  v_and_b32 v21, 0xffff0000, v58
  v_accvgpr_write_b32 a251, v59
  v_lshlrev_b32 v22, 16, v59
  v_and_b32 v23, 0xffff0000, v59
  v_accvgpr_write_b32 a252, v60
  v_lshlrev_b32 v24, 16, v60
  v_and_b32 v25, 0xffff0000, v60
  v_accvgpr_write_b32 a253, v61
  v_lshlrev_b32 v26, 16, v61
  v_and_b32 v27, 0xffff0000, v61
  v_accvgpr_write_b32 a254, v62
  v_lshlrev_b32 v28, 16, v62
  v_and_b32 v29, 0xffff0000, v62
  v_accvgpr_write_b32 a255, v63
  v_lshlrev_b32 v30, 16, v63
  v_and_b32 v31, 0xffff0000, v63
  s_mov_b64 vcc, -1
  s_cmp_eq_u32 s3, 0
  s_cbranch_scc1 L_wk0_0
  s_cmp_eq_u32 s3, 1
  s_cbranch_scc1 L_wk0_1
  s_cmp_eq_u32 s3, 2
  s_cbranch_scc1 L_wk0_2
  s_branch L_wk0_3
L_wk0_end:
  s_mov_b64 vcc, 0
  s_mov_b32 s33, 262144
L_poll_31:
  buffer_load_dwordx2 v[176:177], v90, s[4:7], s94 offen offset:0 sc1
  buffer_load_dwordx2 v[178:179], v90, s[4:7], s94 offen offset:1024 sc1
  buffer_load_dwordx2 v[180:181], v90, s[4:7], s94 offen offset:2048 sc1
  buffer_load_dwordx2 v[182:183], v90, s[4:7], s94 offen offset:3072 sc1
  buffer_load_dwordx2 v[184:185], v90, s[4:7], s94 offen offset:128 sc1
  buffer_load_dwordx2 v[186:187], v90, s[4:7], s94 offen offset:1152 sc1
  buffer_load_dwordx2 v[188:189], v90, s[4:7], s94 offen offset:2176 sc1
  buffer_load_dwordx2 v[190:191], v90, s[4:7], s94 offen offset:3200 sc1
  s_waitcnt vmcnt(0)
  v_max3_u32 v168, v176, v177, v178
  v_max3_u32 v168, v168, v179, v180
  v_max3_u32 v168, v168, v181, v182
  v_max3_u32 v168, v168, v183, v184
  v_max3_u32 v168, v168, v185, v186
  v_max3_u32 v168, v168, v187, v188
  v_max3_u32 v168, v168, v189, v190
  v_max_u32 v168, v168, v191
  v_cmp_eq_u32 s[68:69], -1, v168
  s_nop 1
  s_cmp_eq_u64 s[68:69], 0
  s_cbranch_scc1 L_ready_32
  s_sub_u32 s33, s33, 1
  s_cmp_lg_u32 s33, 0
  s_cbranch_scc1 L_poll_31
L_ready_32:
  v_pk_add_f32 v[160:161], v[176:177], v[178:179]
  v_pk_add_f32 v[164:165], v[180:181], v[182:183]
  v_pk_add_f32 v[162:163], v[184:185], v[186:187]
  v_pk_add_f32 v[166:167], v[188:189], v[190:191]
  v_pk_add_f32 v[160:161], v[160:161], v[164:165]
  v_pk_add_f32 v[162:163], v[162:163], v[166:167]
  v_mov_b32 v164, v160
  v_mov_b32 v165, v161
  v_mov_b32 v166, v162
  v_mov_b32 v167, v163
  v_permlane16_swap_b32 v164, v160
  v_permlane16_swap_b32 v165, v161
  v_permlane16_swap_b32 v166, v162
  v_permlane16_swap_b32 v167, v163
  v_add_f32 v160, v160, v164
  v_add_f32 v161, v161, v165
  v_add_f32 v162, v162, v166
  v_add_f32 v163, v163, v167
  v_mov_b32 v164, v160
  v_mov_b32 v165, v161
  v_mov_b32 v166, v162
  v_mov_b32 v167, v163
  v_permlane32_swap_b32 v164, v160
  v_permlane32_swap_b32 v165, v161
  v_permlane32_swap_b32 v166, v162
  v_permlane32_swap_b32 v167, v163
  v_add_f32 v160, v160, v164
  v_add_f32 v161, v161, v165
  v_add_f32 v162, v162, v166
  v_add_f32 v163, v163, v167
  v_mul_f32 v128, 0x3a800000, v160
  v_mul_f32 v132, 0x3a800000, v161
  v_mul_f32 v140, 0x3a800000, v162
  v_mul_f32 v144, 0x3a800000, v163
  v_fma_f32 v132, -v128, v128, v132
  v_fma_f32 v144, -v140, v140, v144
  v_max_f32 v132, 0, v132
  v_max_f32 v144, 0, v144
  v_cvt_pk_bf16_f32 v136, v128, v132
  v_cvt_pk_bf16_f32 v148, v140, v144
  v_lshlrev_b32 v128, 16, v136
  v_lshlrev_b32 v140, 16, v148
  v_and_b32 v132, 0xffff0000, v136
  v_and_b32 v144, 0xffff0000, v148
  v_add_f32 v132, 0x3727c5ac, v132
  v_add_f32 v144, 0x3727c5ac, v144
  v_cvt_pk_bf16_f32 v136, v132, v133
  v_cvt_pk_bf16_f32 v148, v144, v145
  v_lshlrev_b32 v132, 16, v136
  v_lshlrev_b32 v144, 16, v148
  v_and_b32 v133, 0xffff0000, v136
  v_and_b32 v145, 0xffff0000, v148
  v_sqrt_f32 v132, v132
  v_sqrt_f32 v144, v144
  v_cvt_pk_bf16_f32 v136, v132, v133
  v_cvt_pk_bf16_f32 v148, v144, v145
  v_lshlrev_b32 v132, 16, v136
  v_lshlrev_b32 v144, 16, v148
  v_and_b32 v133, 0xffff0000, v136
  v_and_b32 v145, 0xffff0000, v148
  v_rcp_f32 v132, v132
  v_rcp_f32 v144, v144
  v_mov_b32 v129, v128
  v_mov_b32 v141, v140
  v_mov_b32 v133, v132
  v_mov_b32 v145, v144
  v_pk_add_f32 v[0:1], v[0:1], v[128:129] neg_lo:[0,1] neg_hi:[0,1]
  v_pk_add_f32 v[2:3], v[2:3], v[128:129] neg_lo:[0,1] neg_hi:[0,1]
  v_pk_add_f32 v[4:5], v[4:5], v[128:129] neg_lo:[0,1] neg_hi:[0,1]
  v_pk_add_f32 v[6:7], v[6:7], v[128:129] neg_lo:[0,1] neg_hi:[0,1]
  v_pk_add_f32 v[8:9], v[8:9], v[128:129] neg_lo:[0,1] neg_hi:[0,1]
  v_pk_add_f32 v[10:11], v[10:11], v[128:129] neg_lo:[0,1] neg_hi:[0,1]
  v_pk_add_f32 v[12:13], v[12:13], v[128:129] neg_lo:[0,1] neg_hi:[0,1]
  v_pk_add_f32 v[14:15], v[14:15], v[128:129] neg_lo:[0,1] neg_hi:[0,1]
  v_pk_mul_f32 v[0:1], v[0:1], v[132:133]
  v_pk_mul_f32 v[2:3], v[2:3], v[132:133]
  v_pk_mul_f32 v[4:5], v[4:5], v[132:133]
  v_pk_mul_f32 v[6:7], v[6:7], v[132:133]
  v_pk_mul_f32 v[8:9], v[8:9], v[132:133]
  v_pk_mul_f32 v[10:11], v[10:11], v[132:133]
  v_pk_mul_f32 v[12:13], v[12:13], v[132:133]
  v_pk_mul_f32 v[14:15], v[14:15], v[132:133]
  v_pk_fma_f32 v[0:1], v[0:1], v[112:113], v[96:97]
  v_pk_fma_f32 v[2:3], v[2:3], v[114:115], v[98:99]
  v_pk_fma_f32 v[4:5], v[4:5], v[116:117], v[100:101]
  v_pk_fma_f32 v[6:7], v[6:7], v[118:119], v[102:103]
  v_pk_fma_f32 v[8:9], v[8:9], v[120:121], v[104:105]
  v_pk_fma_f32 v[10:11], v[10:11], v[122:123], v[106:107]
  v_pk_fma_f32 v[12:13], v[12:13], v[124:125], v[108:109]
  v_pk_fma_f32 v[14:15], v[14:15], v[126:127], v[110:111]
  v_cvt_pk_bf16_f32 v176, v0, v1
  v_cvt_pk_bf16_f32 v177, v2, v3
L_wk0_0:
  s_cbranch_vccnz L_wk0_4
  v_cvt_pk_bf16_f32 v178, v4, v5
  v_cvt_pk_bf16_f32 v179, v6, v7
  v_cvt_pk_bf16_f32 v180, v8, v9
  v_cvt_pk_bf16_f32 v181, v10, v11
  v_cvt_pk_bf16_f32 v182, v12, v13
  v_cvt_pk_bf16_f32 v183, v14, v15
  buffer_store_dwordx4 v[176:179], v240, s[4:7], s98 offen offset:0 sc1
  buffer_store_dwordx4 v[180:183], v240, s[4:7], s99 offen offset:0 sc1
  v_pk_add_f32 v[16:17], v[16:17], v[140:141] neg_lo:[0,1] neg_hi:[0,1]
  v_pk_add_f32 v[18:19], v[18:19], v[140:141] neg_lo:[0,1] neg_hi:[0,1]
  v_pk_add_f32 v[20:21], v[20:21], v[140:141] neg_lo:[0,1] neg_hi:[0,1]
  v_pk_add_f32 v[22:23], v[22:23], v[140:141] neg_lo:[0,1] neg_hi:[0,1]
  v_pk_add_f32 v[24:25], v[24:25], v[140:141] neg_lo:[0,1] neg_hi:[0,1]
  v_pk_add_f32 v[26:27], v[26:27], v[140:141] neg_lo:[0,1] neg_hi:[0,1]
  v_pk_add_f32 v[28:29], v[28:29], v[140:141] neg_lo:[0,1] neg_hi:[0,1]
  v_pk_add_f32 v[30:31], v[30:31], v[140:141] neg_lo:[0,1] neg_hi:[0,1]
  v_pk_mul_f32 v[16:17], v[16:17], v[144:145]
  v_pk_mul_f32 v[18:19], v[18:19], v[144:145]
  v_pk_mul_f32 v[20:21], v[20:21], v[144:145]
  v_pk_mul_f32 v[22:23], v[22:23], v[144:145]
  v_pk_mul_f32 v[24:25], v[24:25], v[144:145]
  v_pk_mul_f32 v[26:27], v[26:27], v[144:145]
  v_pk_mul_f32 v[28:29], v[28:29], v[144:145]
  v_pk_mul_f32 v[30:31], v[30:31], v[144:145]
  v_pk_fma_f32 v[16:17], v[16:17], v[112:113], v[96:97]
  v_pk_fma_f32 v[18:19], v[18:19], v[114:115], v[98:99]
  v_pk_fma_f32 v[20:21], v[20:21], v[116:117], v[100:101]
  v_pk_fma_f32 v[22:23], v[22:23], v[118:119], v[102:103]
  v_pk_fma_f32 v[24:25], v[24:25], v[120:121], v[104:105]
  v_pk_fma_f32 v[26:27], v[26:27], v[122:123], v[106:107]
  v_pk_fma_f32 v[28:29], v[28:29], v[124:125], v[108:109]
  v_pk_fma_f32 v[30:31], v[30:31], v[126:127], v[110:111]
  v_cvt_pk_bf16_f32 v184, v16, v17
  v_cvt_pk_bf16_f32 v185, v18, v19
  v_cvt_pk_bf16_f32 v186, v20, v21
  v_cvt_pk_bf16_f32 v187, v22, v23
  v_cvt_pk_bf16_f32 v188, v24, v25
  v_cvt_pk_bf16_f32 v189, v26, v27
  v_cvt_pk_bf16_f32 v190, v28, v29
  v_cvt_pk_bf16_f32 v191, v30, v31
  buffer_store_dwordx4 v[184:187], v240, s[4:7], s98 offen offset:1024 sc1
  buffer_store_dwordx4 v[188:191], v240, s[4:7], s99 offen offset:1024 sc1
  s_barrier
  ds_read_b64_tr_b16 a[224:225], v236 offset:8192
  ds_read_b64_tr_b16 a[226:227], v236 offset:10240
  ds_read_b64_tr_b16 a[228:229], v236 offset:12288
  ds_read_b64_tr_b16 a[230:231], v236 offset:14336
  ds_read_b64_tr_b16 a[232:233], v237 offset:8192
  ds_read_b64_tr_b16 a[234:235], v237 offset:10240
  ds_read_b64_tr_b16 a[236:237], v237 offset:12288
  ds_read_b64_tr_b16 a[238:239], v237 offset:14336
  ds_read_b64_tr_b16 a[192:193], v236 offset:16384
  ds_read_b64_tr_b16 a[194:195], v236 offset:18432
  ds_read_b64_tr_b16 a[196:197], v236 offset:20480
  ds_read_b64_tr_b16 a[198:199], v236 offset:22528
  ds_read_b64_tr_b16 a[200:201], v237 offset:16384
  ds_read_b64_tr_b16 a[202:203], v237 offset:18432
  ds_read_b64_tr_b16 a[204:205], v237 offset:20480
  ds_read_b64_tr_b16 a[206:207], v237 offset:22528
  ds_read_b64_tr_b16 a[208:209], v238 offset:8192
  ds_read_b64_tr_b16 a[210:211], v238 offset:10240
  ds_read_b64_tr_b16 a[212:213], v238 offset:12288
  ds_read_b64_tr_b16 a[214:215], v238 offset:14336
  ds_read_b64_tr_b16 a[216:217], v238 offset:16384
  ds_read_b64_tr_b16 a[218:219], v238 offset:18432
  ds_read_b64_tr_b16 a[220:221], v238 offset:20480
  ds_read_b64_tr_b16 a[222:223], v238 offset:22528
  s_waitcnt vmcnt(0)
  buffer_store_dword v245, v246, s[4:7], s92 offen sc1
  s_mov_b32 s33, 262144
L_spin_33:
  buffer_load_dword v244, v243, s[4:7], s93 offen sc1
  s_waitcnt vmcnt(0)
  v_cmp_ne_u32 s[68:69], s100, v244
  s_nop 1
  s_cmp_eq_u64 s[68:69], 0
  s_cbranch_scc1 L_rdy_34
  s_sub_u32 s33, s33, 1
  s_cmp_lg_u32 s33, 0
  s_cbranch_scc1 L_spin_33
L_rdy_34:
  s_mov_b32 s40, 19922944
  buffer_load_dwordx4 a[64:67], v225, s[4:7], s40 offen offset:0 sc1
  buffer_load_dwordx4 a[68:71], v225, s[4:7], s40 offen offset:1024 sc1
  buffer_load_dwordx4 a[72:75], v225, s[4:7], s40 offen offset:2048 sc1
  buffer_load_dwordx4 a[76:79], v225, s[4:7], s40 offen offset:3072 sc1
  s_mov_b32 s40, 20054016
  buffer_load_dwordx4 a[80:83], v225, s[4:7], s40 offen offset:0 sc1
  buffer_load_dwordx4 a[84:87], v225, s[4:7], s40 offen offset:1024 sc1
  buffer_load_dwordx4 a[88:91], v225, s[4:7], s40 offen offset:2048 sc1
  buffer_load_dwordx4 a[92:95], v225, s[4:7], s40 offen offset:3072 sc1
  s_mov_b32 s41, 458752
  s_add_u32 m0, s42, 32768
  buffer_load_dword v244, v254, s[4:7], s93 offen sc1
  s_waitcnt vmcnt(5) lgkmcnt(13)
  v_mfma_f32_16x16x32_bf16 v[0:3], a[224:227], a[64:67], 0
  s_waitcnt vmcnt(1)
  v_mfma_f32_16x16x32_bf16 v[0:3], a[228:231], a[80:83], v[0:3]
  buffer_load_dwordx4 v226, s[12:15], s41 offen lds
  v_mfma_f32_16x16x32_bf16 v[16:19], a[224:227], a[68:71], 0
  s_mov_b32 s41, 688128
  s_add_u32 m0, s42, 36864
  v_mfma_f32_16x16x32_bf16 v[16:19], a[228:231], a[84:87], v[16:19]
  v_mfma_f32_16x16x32_bf16 v[32:35], a[224:227], a[72:75], 0
  v_mfma_f32_16x16x32_bf16 v[32:35], a[228:231], a[88:91], v[32:35]
  v_mfma_f32_16x16x32_bf16 v[48:51], a[224:227], a[76:79], 0
  buffer_load_dwordx4 v226, s[12:15], s41 offen lds
  v_mfma_f32_16x16x32_bf16 v[48:51], a[228:231], a[92:95], v[48:51]
  ds_read_b64_tr_b16 a[224:225], v236 offset:24576
  s_mov_b32 s40, 20185088
  v_mfma_f32_16x16x32_bf16 v[4:7], a[232:235], a[64:67], 0
  ds_read_b64_tr_b16 a[226:227], v236 offset:26624
  v_mfma_f32_16x16x32_bf16 v[4:7], a[236:239], a[80:83], v[4:7]
  ds_read_b64_tr_b16 a[228:229], v236 offset:28672
  ds_read_b64_tr_b16 a[230:231], v236 offset:30720
  v_mfma_f32_16x16x32_bf16 v[20:23], a[232:235], a[68:71], 0
  v_mfma_f32_16x16x32_bf16 v[20:23], a[236:239], a[84:87], v[20:23]
  v_mfma_f32_16x16x32_bf16 v[36:39], a[232:235], a[72:75], 0
  buffer_load_dwordx4 a[96:99], v225, s[4:7], s40 offen offset:0 sc1
  v_mfma_f32_16x16x32_bf16 v[36:39], a[236:239], a[88:91], v[36:39]
  v_mfma_f32_16x16x32_bf16 v[52:55], a[232:235], a[76:79], 0
  ds_read_b64_tr_b16 a[232:233], v237 offset:24576
  v_mfma_f32_16x16x32_bf16 v[52:55], a[236:239], a[92:95], v[52:55]
  ds_read_b64_tr_b16 a[234:235], v237 offset:26624
  v_mfma_f32_16x16x32_bf16 v[8:11], a[192:195], a[64:67], 0
  ds_read_b64_tr_b16 a[236:237], v237 offset:28672
  s_waitcnt lgkmcnt(13)
  v_mfma_f32_16x16x32_bf16 v[8:11], a[196:199], a[80:83], v[8:11]
  s_barrier
  v_mfma_f32_16x16x32_bf16 v[24:27], a[192:195], a[68:71], 0
  buffer_load_dwordx4 a[100:103], v225, s[4:7], s40 offen offset:1024 sc1
  v_mfma_f32_16x16x32_bf16 v[24:27], a[196:199], a[84:87], v[24:27]
  ds_read_b64_tr_b16 a[238:239], v237 offset:30720
  v_mfma_f32_16x16x32_bf16 v[40:43], a[192:195], a[72:75], 0
  v_mfma_f32_16x16x32_bf16 v[40:43], a[196:199], a[88:91], v[40:43]
  v_mfma_f32_16x16x32_bf16 v[56:59], a[192:195], a[76:79], 0
  ds_read_b64_tr_b16 a[192:193], v238 offset:24576
  v_mfma_f32_16x16x32_bf16 v[56:59], a[196:199], a[92:95], v[56:59]
  ds_read_b64_tr_b16 a[194:195], v238 offset:26624
  v_mfma_f32_16x16x32_bf16 v[12:15], a[200:203], a[64:67], 0
  buffer_load_dwordx4 a[104:107], v225, s[4:7], s40 offen offset:2048 sc1
  v_mfma_f32_16x16x32_bf16 v[12:15], a[204:207], a[80:83], v[12:15]
  ds_read_b64_tr_b16 a[196:197], v238 offset:28672
  ds_read_b64_tr_b16 a[198:199], v238 offset:30720
  s_load_dwordx2 s[66:67], s[22:23], 0x0
  v_mfma_f32_16x16x32_bf16 v[28:31], a[200:203], a[68:71], 0
  v_mfma_f32_16x16x32_bf16 v[28:31], a[204:207], a[84:87], v[28:31]
  v_mfma_f32_16x16x32_bf16 v[44:47], a[200:203], a[72:75], 0
  v_mfma_f32_16x16x32_bf16 v[44:47], a[204:207], a[88:91], v[44:47]
  v_mfma_f32_16x16x32_bf16 v[60:63], a[200:203], a[76:79], 0
  buffer_load_dwordx4 a[108:111], v225, s[4:7], s40 offen offset:3072 sc1
  v_mfma_f32_16x16x32_bf16 v[60:63], a[204:207], a[92:95], v[60:63]
  ds_read_b64_tr_b16 a[200:201], v239 offset:24576
  s_mov_b32 s40, 20316160
  v_mfma_f32_16x16x32_bf16 v[64:67], a[208:211], a[64:67], 0
  ds_read_b64_tr_b16 a[202:203], v239 offset:26624
  s_waitcnt lgkmcnt(13)
  v_mfma_f32_16x16x32_bf16 v[64:67], a[212:215], a[80:83], v[64:67]
  ds_read_b64_tr_b16 a[204:205], v239 offset:28672
  ds_read_b64_tr_b16 a[206:207], v239 offset:30720
  v_mfma_f32_16x16x32_bf16 v[72:75], a[208:211], a[68:71], 0
  v_mfma_f32_16x16x32_bf16 v[72:75], a[212:215], a[84:87], v[72:75]
  v_mfma_f32_16x16x32_bf16 v[80:83], a[208:211], a[72:75], 0
  buffer_load_dwordx4 a[112:115], v225, s[4:7], s40 offen offset:0 sc1
  v_mfma_f32_16x16x32_bf16 v[80:83], a[212:215], a[88:91], v[80:83]
  v_mfma_f32_16x16x32_bf16 v[88:91], a[208:211], a[76:79], 0
  ds_read_b64_tr_b16 a[208:209], v228 offset:8192
  v_mfma_f32_16x16x32_bf16 v[88:91], a[212:215], a[92:95], v[88:91]
  ds_read_b64_tr_b16 a[210:211], v228 offset:10240
  s_waitcnt vmcnt(7)
  v_subrev_u32 v244, s100, v244
  v_cmp_lt_u32 s[68:69], 3, v244
  v_mfma_f32_16x16x32_bf16 v[68:71], a[216:219], a[64:67], 0
  ds_read_b64_tr_b16 a[212:213], v228 offset:12288
  s_cmp_lg_u64 s[68:69], 0
  s_cbranch_scc1 L_slow_35
L_back_36:
  v_and_b32 v243, 15, v224
  v_mfma_f32_16x16x32_bf16 v[68:71], a[220:223], a[80:83], v[68:71]
  ds_read_b64_tr_b16 a[214:215], v228 offset:14336
  v_lshlrev_b32 v243, 6, v243
  v_mfma_f32_16x16x32_bf16 v[76:79], a[216:219], a[68:71], 0
  buffer_load_dwordx4 a[116:119], v225, s[4:7], s40 offen offset:1024 sc1
  v_mfma_f32_16x16x32_bf16 v[76:79], a[220:223], a[84:87], v[76:79]
  v_mfma_f32_16x16x32_bf16 v[84:87], a[216:219], a[72:75], 0
  v_mfma_f32_16x16x32_bf16 v[84:87], a[220:223], a[88:91], v[84:87]
  v_mfma_f32_16x16x32_bf16 v[92:95], a[216:219], a[76:79], 0
  ds_read_b64_tr_b16 a[216:217], v229 offset:8192
  v_mfma_f32_16x16x32_bf16 v[92:95], a[220:223], a[92:95], v[92:95]
  ds_read_b64_tr_b16 a[218:219], v229 offset:10240
  s_load_dwordx2 s[66:67], s[22:23], 0x20000
  s_waitcnt lgkmcnt(13)
  v_mfma_f32_16x16x32_bf16 v[96:99], a[224:227], a[64:67], 0
  buffer_load_dwordx4 a[120:123], v225, s[4:7], s40 offen offset:2048 sc1
  v_mfma_f32_16x16x32_bf16 v[96:99], a[228:231], a[80:83], v[96:99]
  ds_read_b64_tr_b16 a[220:221], v229 offset:12288
  ds_read_b64_tr_b16 a[222:223], v229 offset:14336
  v_mfma_f32_16x16x32_bf16 v[128:131], a[224:227], a[68:71], 0
  v_mfma_f32_16x16x32_bf16 v[128:131], a[228:231], a[84:87], v[128:131]
  v_mfma_f32_16x16x32_bf16 v[160:163], a[224:227], a[72:75], 0
  v_mfma_f32_16x16x32_bf16 v[160:163], a[228:231], a[88:91], v[160:163]
  v_mfma_f32_16x16x32_bf16 v[192:195], a[224:227], a[76:79], 0
  buffer_load_dwordx4 a[124:127], v225, s[4:7], s40 offen offset:3072 sc1
  v_mfma_f32_16x16x32_bf16 v[192:195], a[228:231], a[92:95], v[192:195]
  ds_read_b64_tr_b16 a[224:225], v230 offset:8192
  s_mov_b32 s41, 458752
  v_mfma_f32_16x16x32_bf16 v[100:103], a[232:235], a[64:67], 0
  ds_read_b64_tr_b16 a[226:227], v230 offset:10240
  s_add_u32 m0, s42, 40960
  v_mfma_f32_16x16x32_bf16 v[100:103], a[236:239], a[80:83], v[100:103]
  ds_read_b64_tr_b16 a[228:229], v230 offset:12288
  ds_read_b64_tr_b16 a[230:231], v230 offset:14336
  v_mfma_f32_16x16x32_bf16 v[132:135], a[232:235], a[68:71], 0
  v_mfma_f32_16x16x32_bf16 v[132:135], a[236:239], a[84:87], v[132:135]
  s_mov_b32 s36, 3670016
  v_mfma_f32_16x16x32_bf16 v[164:167], a[232:235], a[72:75], 0
  buffer_load_dwordx4 v226, s[16:19], s41 offen lds
  v_mfma_f32_16x16x32_bf16 v[164:167], a[236:239], a[88:91], v[164:167]
  s_mov_b32 s41, 688128
  s_add_u32 m0, s42, 45056
  v_mfma_f32_16x16x32_bf16 v[196:199], a[232:235], a[76:79], 0
  ds_read_b64_tr_b16 a[232:233], v231 offset:8192
  v_mfma_f32_16x16x32_bf16 v[196:199], a[236:239], a[92:95], v[196:199]
  ds_read_b64_tr_b16 a[234:235], v231 offset:10240
  s_waitcnt lgkmcnt(13)
  v_mfma_f32_16x16x32_bf16 v[104:107], a[192:195], a[64:67], 0
  ds_read_b64_tr_b16 a[236:237], v231 offset:12288
  v_mfma_f32_16x16x32_bf16 v[104:107], a[196:199], a[80:83], v[104:107]
  ds_read_b64_tr_b16 a[238:239], v231 offset:14336
  v_mfma_f32_16x16x32_bf16 v[136:139], a[192:195], a[68:71], 0
  buffer_load_dwordx4 v226, s[16:19], s41 offen lds
  v_mfma_f32_16x16x32_bf16 v[136:139], a[196:199], a[84:87], v[136:139]
  s_mov_b32 s41, 917504
  s_add_u32 m0, s42, 49152
  v_mfma_f32_16x16x32_bf16 v[168:171], a[192:195], a[72:75], 0
  buffer_load_dword v248, v247, s[56:59], s36 offen
  v_mfma_f32_16x16x32_bf16 v[168:171], a[196:199], a[88:91], v[168:171]
  s_load_dwordx2 s[66:67], s[22:23], 0x40000
  v_mfma_f32_16x16x32_bf16 v[200:203], a[192:195], a[76:79], 0
  ds_read_b64_tr_b16 a[192:193], v228 offset:16384
  v_mfma_f32_16x16x32_bf16 v[200:203], a[196:199], a[92:95], v[200:203]
  ds_read_b64_tr_b16 a[194:195], v228 offset:18432
  v_mfma_f32_16x16x32_bf16 v[108:111], a[200:203], a[64:67], 0
  buffer_load_dwordx4 v227, s[12:15], s41 offen lds
  v_mfma_f32_16x16x32_bf16 v[108:111], a[204:207], a[80:83], v[108:111]
  s_waitcnt vmcnt(12)
  s_barrier
  v_mfma_f32_16x16x32_bf16 v[140:143], a[200:203], a[68:71], 0
  ds_read_b64_tr_b16 a[196:197], v228 offset:20480
  ds_read_b64_tr_b16 a[198:199], v228 offset:22528
  v_mfma_f32_16x16x32_bf16 v[140:143], a[204:207], a[84:87], v[140:143]
  s_mov_b32 s41, 1146880
  s_add_u32 m0, s42, 53248
  v_mfma_f32_16x16x32_bf16 v[172:175], a[200:203], a[72:75], 0
  v_mfma_f32_16x16x32_bf16 v[172:175], a[204:207], a[88:91], v[172:175]
  v_mfma_f32_16x16x32_bf16 v[204:207], a[200:203], a[76:79], 0
  buffer_load_dwordx4 v227, s[12:15], s41 offen lds
  v_mfma_f32_16x16x32_bf16 v[204:207], a[204:207], a[92:95], v[204:207]
  ds_read_b64_tr_b16 a[200:201], v229 offset:16384
  s_mov_b32 s41, 917504
  s_waitcnt lgkmcnt(13)
  v_mfma_f32_16x16x32_bf16 v[112:115], a[208:211], a[64:67], 0
  ds_read_b64_tr_b16 a[202:203], v229 offset:18432
  s_add_u32 m0, s42, 57344
  v_mfma_f32_16x16x32_bf16 v[112:115], a[212:215], a[80:83], v[112:115]
  ds_read_b64_tr_b16 a[204:205], v229 offset:20480
  ds_read_b64_tr_b16 a[206:207], v229 offset:22528
  v_mfma_f32_16x16x32_bf16 v[144:147], a[208:211], a[68:71], 0
  v_mfma_f32_16x16x32_bf16 v[144:147], a[212:215], a[84:87], v[144:147]
  v_mfma_f32_16x16x32_bf16 v[176:179], a[208:211], a[72:75], 0
  buffer_load_dwordx4 v227, s[16:19], s41 offen lds
  v_mfma_f32_16x16x32_bf16 v[176:179], a[212:215], a[88:91], v[176:179]
  s_mov_b32 s41, 1146880
  s_add_u32 m0, s42, 61440
  v_mfma_f32_16x16x32_bf16 v[208:211], a[208:211], a[76:79], 0
  ds_read_b64_tr_b16 a[208:209], v228 offset:24576
  v_mfma_f32_16x16x32_bf16 v[208:211], a[212:215], a[92:95], v[208:211]
  ds_read_b64_tr_b16 a[210:211], v228 offset:26624
  v_mfma_f32_16x16x32_bf16 v[116:119], a[216:219], a[64:67], 0
  ds_read_b64_tr_b16 a[212:213], v228 offset:28672
  v_mfma_f32_16x16x32_bf16 v[116:119], a[220:223], a[80:83], v[116:119]
  ds_read_b64_tr_b16 a[214:215], v228 offset:30720
  v_mfma_f32_16x16x32_bf16 v[148:151], a[216:219], a[68:71], 0
  buffer_load_dwordx4 v227, s[16:19], s41 offen lds
  v_mfma_f32_16x16x32_bf16 v[148:151], a[220:223], a[84:87], v[148:151]
  s_mov_b32 s41, 917504
  s_add_u32 m0, s42, 65536
  s_load_dwordx2 s[66:67], s[22:23], 0x60000
  v_mfma_f32_16x16x32_bf16 v[180:183], a[216:219], a[72:75], 0
  v_mfma_f32_16x16x32_bf16 v[180:183], a[220:223], a[88:91], v[180:183]
  v_mfma_f32_16x16x32_bf16 v[212:215], a[216:219], a[76:79], 0
  ds_read_b64_tr_b16 a[216:217], v229 offset:24576
  v_mfma_f32_16x16x32_bf16 v[212:215], a[220:223], a[92:95], v[212:215]
  ds_read_b64_tr_b16 a[218:219], v229 offset:26624
  s_waitcnt lgkmcnt(13)
  v_mfma_f32_16x16x32_bf16 v[120:123], a[224:227], a[64:67], 0
  buffer_load_dwordx4 v226, s[12:15], s41 offen lds
  v_mfma_f32_16x16x32_bf16 v[120:123], a[228:231], a[80:83], v[120:123]
  ds_read_b64_tr_b16 a[220:221], v229 offset:28672
  ds_read_b64_tr_b16 a[222:223], v229 offset:30720
  v_mfma_f32_16x16x32_bf16 v[152:155], a[224:227], a[68:71], 0
  s_mov_b32 s41, 1146880
  s_add_u32 m0, s42, 69632
  v_mfma_f32_16x16x32_bf16 v[152:155], a[228:231], a[84:87], v[152:155]
  v_mfma_f32_16x16x32_bf16 v[184:187], a[224:227], a[72:75], 0
  v_mfma_f32_16x16x32_bf16 v[184:187], a[228:231], a[88:91], v[184:187]
  v_mfma_f32_16x16x32_bf16 v[216:219], a[224:227], a[76:79], 0
  buffer_load_dwordx4 v226, s[12:15], s41 offen lds
  v_mfma_f32_16x16x32_bf16 v[216:219], a[228:231], a[92:95], v[216:219]
  ds_read_b64_tr_b16 a[224:225], v230 offset:16384
  s_mov_b32 s40, 20447232
  v_mfma_f32_16x16x32_bf16 v[124:127], a[232:235], a[64:67], 0
  ds_read_b64_tr_b16 a[226:227], v230 offset:18432
  v_mfma_f32_16x16x32_bf16 v[124:127], a[236:239], a[80:83], v[124:127]
  ds_read_b64_tr_b16 a[228:229], v230 offset:20480
  ds_read_b64_tr_b16 a[230:231], v230 offset:22528
  v_mfma_f32_16x16x32_bf16 v[156:159], a[232:235], a[68:71], 0
  v_mfma_f32_16x16x32_bf16 v[156:159], a[236:239], a[84:87], v[156:159]
  v_mfma_f32_16x16x32_bf16 v[188:191], a[232:235], a[72:75], 0
  buffer_load_dwordx4 a[128:131], v225, s[4:7], s40 offen offset:0 sc1
  v_mfma_f32_16x16x32_bf16 v[188:191], a[236:239], a[88:91], v[188:191]
  v_mfma_f32_16x16x32_bf16 v[220:223], a[232:235], a[76:79], 0
  ds_read_b64_tr_b16 a[232:233], v230 offset:24576
  v_mfma_f32_16x16x32_bf16 v[220:223], a[236:239], a[92:95], v[220:223]
  ds_read_b64_tr_b16 a[234:235], v230 offset:26624
  s_waitcnt vmcnt(14) lgkmcnt(13)
  v_mfma_f32_16x16x32_bf16 v[0:3], a[192:195], a[96:99], v[0:3]
  ds_read_b64_tr_b16 a[236:237], v230 offset:28672
  s_waitcnt vmcnt(10)
  v_mfma_f32_16x16x32_bf16 v[0:3], a[196:199], a[112:115], v[0:3]
  ds_read_b64_tr_b16 a[238:239], v230 offset:30720
  s_load_dwordx2 s[66:67], s[22:23], 0x80000
  v_mfma_f32_16x16x32_bf16 v[16:19], a[192:195], a[100:103], v[16:19]
  buffer_load_dwordx4 a[132:135], v225, s[4:7], s40 offen offset:1024 sc1
  v_mfma_f32_16x16x32_bf16 v[16:19], a[196:199], a[116:119], v[16:19]
  v_mfma_f32_16x16x32_bf16 v[32:35], a[192:195], a[104:107], v[32:35]
  v_mfma_f32_16x16x32_bf16 v[32:35], a[196:199], a[120:123], v[32:35]
  v_mfma_f32_16x16x32_bf16 v[48:51], a[192:195], a[108:111], v[48:51]
  ds_read_b64_tr_b16 a[192:193], v228 offset:32768
  v_mfma_f32_16x16x32_bf16 v[48:51], a[196:199], a[124:127], v[48:51]
  ds_read_b64_tr_b16 a[194:195], v228 offset:34816
  v_mfma_f32_16x16x32_bf16 v[4:7], a[200:203], a[96:99], v[4:7]
  buffer_load_dwordx4 a[136:139], v225, s[4:7], s40 offen offset:2048 sc1
  v_mfma_f32_16x16x32_bf16 v[4:7], a[204:207], a[112:115], v[4:7]
  ds_read_b64_tr_b16 a[196:197], v228 offset:36864
  ds_read_b64_tr_b16 a[198:199], v228 offset:38912
  v_mfma_f32_16x16x32_bf16 v[20:23], a[200:203], a[100:103], v[20:23]
  v_mfma_f32_16x16x32_bf16 v[20:23], a[204:207], a[116:119], v[20:23]
  v_mfma_f32_16x16x32_bf16 v[36:39], a[200:203], a[104:107], v[36:39]
  v_mfma_f32_16x16x32_bf16 v[36:39], a[204:207], a[120:123], v[36:39]
  v_mfma_f32_16x16x32_bf16 v[52:55], a[200:203], a[108:111], v[52:55]
  buffer_load_dwordx4 a[140:143], v225, s[4:7], s40 offen offset:3072 sc1
  v_mfma_f32_16x16x32_bf16 v[52:55], a[204:207], a[124:127], v[52:55]
  ds_read_b64_tr_b16 a[200:201], v229 offset:32768
  s_mov_b32 s40, 20578304
  s_waitcnt lgkmcnt(13)
  v_mfma_f32_16x16x32_bf16 v[8:11], a[208:211], a[96:99], v[8:11]
  ds_read_b64_tr_b16 a[202:203], v229 offset:34816
  v_mfma_f32_16x16x32_bf16 v[8:11], a[212:215], a[112:115], v[8:11]
  s_waitcnt vmcnt(11)
  s_barrier
  v_mfma_f32_16x16x32_bf16 v[24:27], a[208:211], a[100:103], v[24:27]
  ds_read_b64_tr_b16 a[204:205], v229 offset:36864
  ds_read_b64_tr_b16 a[206:207], v229 offset:38912
  v_mfma_f32_16x16x32_bf16 v[24:27], a[212:215], a[116:119], v[24:27]
  v_mfma_f32_16x16x32_bf16 v[40:43], a[208:211], a[104:107], v[40:43]
  buffer_load_dwordx4 a[144:147], v225, s[4:7], s40 offen offset:0 sc1
  v_mfma_f32_16x16x32_bf16 v[40:43], a[212:215], a[120:123], v[40:43]
  v_mfma_f32_16x16x32_bf16 v[56:59], a[208:211], a[108:111], v[56:59]
  ds_read_b64_tr_b16 a[208:209], v230 offset:32768
  v_mfma_f32_16x16x32_bf16 v[56:59], a[212:215], a[124:127], v[56:59]
  ds_read_b64_tr_b16 a[210:211], v230 offset:34816
  s_load_dwordx2 s[66:67], s[22:23], 0xa0000
  v_mfma_f32_16x16x32_bf16 v[12:15], a[216:219], a[96:99], v[12:15]
  ds_read_b64_tr_b16 a[212:213], v230 offset:36864
  v_mfma_f32_16x16x32_bf16 v[12:15], a[220:223], a[112:115], v[12:15]
  ds_read_b64_tr_b16 a[214:215], v230 offset:38912
  v_mfma_f32_16x16x32_bf16 v[28:31], a[216:219], a[100:103], v[28:31]
  buffer_load_dwordx4 a[148:151], v225, s[4:7], s40 offen offset:1024 sc1
  v_mfma_f32_16x16x32_bf16 v[28:31], a[220:223], a[116:119], v[28:31]
  v_mfma_f32_16x16x32_bf16 v[44:47], a[216:219], a[104:107], v[44:47]
  v_mfma_f32_16x16x32_bf16 v[44:47], a[220:223], a[120:123], v[44:47]
  v_mfma_f32_16x16x32_bf16 v[60:63], a[216:219], a[108:111], v[60:63]
  ds_read_b64_tr_b16 a[216:217], v231 offset:32768
  v_mfma_f32_16x16x32_bf16 v[60:63], a[220:223], a[124:127], v[60:63]
  ds_read_b64_tr_b16 a[218:219], v231 offset:34816
  s_waitcnt lgkmcnt(13)
  v_mfma_f32_16x16x32_bf16 v[64:67], a[224:227], a[96:99], v[64:67]
  buffer_load_dwordx4 a[152:155], v225, s[4:7], s40 offen offset:2048 sc1
  v_mfma_f32_16x16x32_bf16 v[64:67], a[228:231], a[112:115], v[64:67]
  ds_read_b64_tr_b16 a[220:221], v231 offset:36864
  ds_read_b64_tr_b16 a[222:223], v231 offset:38912
  v_mfma_f32_16x16x32_bf16 v[72:75], a[224:227], a[100:103], v[72:75]
  v_mfma_f32_16x16x32_bf16 v[72:75], a[228:231], a[116:119], v[72:75]
  v_mfma_f32_16x16x32_bf16 v[80:83], a[224:227], a[104:107], v[80:83]
  v_mfma_f32_16x16x32_bf16 v[80:83], a[228:231], a[120:123], v[80:83]
  v_mfma_f32_16x16x32_bf16 v[88:91], a[224:227], a[108:111], v[88:91]
  buffer_load_dwordx4 a[156:159], v225, s[4:7], s40 offen offset:3072 sc1
  v_mfma_f32_16x16x32_bf16 v[88:91], a[228:231], a[124:127], v[88:91]
  ds_read_b64_tr_b16 a[224:225], v228 offset:40960
  s_mov_b32 s41, 917504
  v_mfma_f32_16x16x32_bf16 v[68:71], a[232:235], a[96:99], v[68:71]
  ds_read_b64_tr_b16 a[226:227], v228 offset:43008
  s_add_u32 m0, s42, 73728
  v_mfma_f32_16x16x32_bf16 v[68:71], a[236:239], a[112:115], v[68:71]
  ds_read_b64_tr_b16 a[228:229], v228 offset:45056
  ds_read_b64_tr_b16 a[230:231], v228 offset:47104
  v_mfma_f32_16x16x32_bf16 v[76:79], a[232:235], a[100:103], v[76:79]
  v_mfma_f32_16x16x32_bf16 v[76:79], a[236:239], a[116:119], v[76:79]
  v_mfma_f32_16x16x32_bf16 v[84:87], a[232:235], a[104:107], v[84:87]
  buffer_load_dwordx4 v226, s[16:19], s41 offen lds
  v_mfma_f32_16x16x32_bf16 v[84:87], a[236:239], a[120:123], v[84:87]
  s_mov_b32 s41, 1146880
  s_add_u32 m0, s42, 77824
  s_load_dwordx2 s[66:67], s[22:23], 0xc0000
  v_mfma_f32_16x16x32_bf16 v[92:95], a[232:235], a[108:111], v[92:95]
  ds_read_b64_tr_b16 a[232:233], v229 offset:40960
  v_mfma_f32_16x16x32_bf16 v[92:95], a[236:239], a[124:127], v[92:95]
  ds_read_b64_tr_b16 a[234:235], v229 offset:43008
  s_waitcnt lgkmcnt(13)
  v_mfma_f32_16x16x32_bf16 v[96:99], a[192:195], a[96:99], v[96:99]
  ds_read_b64_tr_b16 a[236:237], v229 offset:45056
  v_mfma_f32_16x16x32_bf16 v[96:99], a[196:199], a[112:115], v[96:99]
  ds_read_b64_tr_b16 a[238:239], v229 offset:47104
  v_mfma_f32_16x16x32_bf16 v[128:131], a[192:195], a[100:103], v[128:131]
  buffer_load_dwordx4 v226, s[16:19], s41 offen lds
  v_mfma_f32_16x16x32_bf16 v[128:131], a[196:199], a[116:119], v[128:131]
  s_mov_b32 s41, 1376256
  s_add_u32 m0, s42, 81920
  v_mfma_f32_16x16x32_bf16 v[160:163], a[192:195], a[104:107], v[160:163]
  v_mfma_f32_16x16x32_bf16 v[160:163], a[196:199], a[120:123], v[160:163]
  v_mfma_f32_16x16x32_bf16 v[192:195], a[192:195], a[108:111], v[192:195]
  ds_read_b64_tr_b16 a[192:193], v230 offset:40960
  v_mfma_f32_16x16x32_bf16 v[192:195], a[196:199], a[124:127], v[192:195]
  ds_read_b64_tr_b16 a[194:195], v230 offset:43008
  v_mfma_f32_16x16x32_bf16 v[100:103], a[200:203], a[96:99], v[100:103]
  buffer_load_dwordx4 v227, s[12:15], s41 offen lds
  v_mfma_f32_16x16x32_bf16 v[100:103], a[204:207], a[112:115], v[100:103]
  ds_read_b64_tr_b16 a[196:197], v230 offset:45056
  ds_read_b64_tr_b16 a[198:199], v230 offset:47104
  v_mfma_f32_16x16x32_bf16 v[132:135], a[200:203], a[100:103], v[132:135]
  s_mov_b32 s41, 1605632
  s_add_u32 m0, s42, 86016
  v_mfma_f32_16x16x32_bf16 v[132:135], a[204:207], a[116:119], v[132:135]
  s_mov_b32 s36, 4194304
  v_mfma_f32_16x16x32_bf16 v[164:167], a[200:203], a[104:107], v[164:167]
  buffer_load_dword v248, v247, s[56:59], s36 offen
  v_mfma_f32_16x16x32_bf16 v[164:167], a[204:207], a[120:123], v[164:167]
  v_mfma_f32_16x16x32_bf16 v[196:199], a[200:203], a[108:111], v[196:199]
  buffer_load_dwordx4 v227, s[12:15], s41 offen lds
  v_mfma_f32_16x16x32_bf16 v[196:199], a[204:207], a[124:127], v[196:199]
  ds_read_b64_tr_b16 a[200:201], v231 offset:40960
  s_mov_b32 s41, 1376256
  s_waitcnt lgkmcnt(13)
  v_mfma_f32_16x16x32_bf16 v[104:107], a[208:211], a[96:99], v[104:107]
  ds_read_b64_tr_b16 a[202:203], v231 offset:43008
  s_add_u32 m0, s42, 90112
  v_mfma_f32_16x16x32_bf16 v[104:107], a[212:215], a[112:115], v[104:107]
  ds_read_b64_tr_b16 a[204:205], v231 offset:45056
  ds_read_b64_tr_b16 a[206:207], v231 offset:47104
  v_mfma_f32_16x16x32_bf16 v[136:139], a[208:211], a[100:103], v[136:139]
  v_mfma_f32_16x16x32_bf16 v[136:139], a[212:215], a[116:119], v[136:139]
  s_load_dwordx2 s[66:67], s[22:23], 0xe0000
  s_add_u32 s22, s22, 0x100000
  s_addc_u32 s23, s23, 0
  v_mfma_f32_16x16x32_bf16 v[168:171], a[208:211], a[104:107], v[168:171]
  buffer_load_dwordx4 v227, s[16:19], s41 offen lds
  v_mfma_f32_16x16x32_bf16 v[168:171], a[212:215], a[120:123], v[168:171]
  s_mov_b32 s41, 1605632
  s_add_u32 m0, s42, 94208
  v_mfma_f32_16x16x32_bf16 v[200:203], a[208:211], a[108:111], v[200:203]
  v_mfma_f32_16x16x32_bf16 v[200:203], a[212:215], a[124:127], v[200:203]
  v_mfma_f32_16x16x32_bf16 v[108:111], a[216:219], a[96:99], v[108:111]
  v_mfma_f32_16x16x32_bf16 v[108:111], a[220:223], a[112:115], v[108:111]
  s_waitcnt vmcnt(14)
  s_barrier
  v_mfma_f32_16x16x32_bf16 v[140:143], a[216:219], a[100:103], v[140:143]
  buffer_load_dwordx4 v227, s[16:19], s41 offen lds
  v_mfma_f32_16x16x32_bf16 v[140:143], a[220:223], a[116:119], v[140:143]
  ds_read_b64_tr_b16 a[208:209], v228 offset:49152
  ds_read_b64_tr_b16 a[210:211], v228 offset:51200
  v_mfma_f32_16x16x32_bf16 v[172:175], a[216:219], a[104:107], v[172:175]
  ds_read_b64_tr_b16 a[212:213], v228 offset:53248
  ds_read_b64_tr_b16 a[214:215], v228 offset:55296
  v_mfma_f32_16x16x32_bf16 v[172:175], a[220:223], a[120:123], v[172:175]
  s_mov_b32 s41, 1376256
  s_add_u32 m0, s42, 98304
  v_mfma_f32_16x16x32_bf16 v[204:207], a[216:219], a[108:111], v[204:207]
  ds_read_b64_tr_b16 a[216:217], v229 offset:49152
  v_mfma_f32_16x16x32_bf16 v[204:207], a[220:223], a[124:127], v[204:207]
  ds_read_b64_tr_b16 a[218:219], v229 offset:51200
  s_waitcnt lgkmcnt(13)
  v_mfma_f32_16x16x32_bf16 v[112:115], a[224:227], a[96:99], v[112:115]
  buffer_load_dwordx4 v226, s[12:15], s41 offen lds
  v_mfma_f32_16x16x32_bf16 v[112:115], a[228:231], a[112:115], v[112:115]
  ds_read_b64_tr_b16 a[220:221], v229 offset:53248
  ds_read_b64_tr_b16 a[222:223], v229 offset:55296
  v_mfma_f32_16x16x32_bf16 v[144:147], a[224:227], a[100:103], v[144:147]
  s_mov_b32 s41, 1605632
  s_add_u32 m0, s42, 102400
  v_mfma_f32_16x16x32_bf16 v[144:147], a[228:231], a[116:119], v[144:147]
  v_mfma_f32_16x16x32_bf16 v[176:179], a[224:227], a[104:107], v[176:179]
  v_mfma_f32_16x16x32_bf16 v[176:179], a[228:231], a[120:123], v[176:179]
  v_mfma_f32_16x16x32_bf16 v[208:211], a[224:227], a[108:111], v[208:211]
  buffer_load_dwordx4 v226, s[12:15], s41 offen lds
  v_mfma_f32_16x16x32_bf16 v[208:211], a[228:231], a[124:127], v[208:211]
  ds_read_b64_tr_b16 a[224:225], v228 offset:57344
  s_mov_b32 s40, 20709376
  v_mfma_f32_16x16x32_bf16 v[116:119], a[232:235], a[96:99], v[116:119]
  ds_read_b64_tr_b16 a[226:227], v228 offset:59392
  v_mfma_f32_16x16x32_bf16 v[116:119], a[236:239], a[112:115], v[116:119]
  ds_read_b64_tr_b16 a[228:229], v228 offset:61440
  ds_read_b64_tr_b16 a[230:231], v228 offset:63488
  s_load_dwordx2 s[66:67], s[22:23], 0x0
  v_mfma_f32_16x16x32_bf16 v[148:151], a[232:235], a[100:103], v[148:151]
  v_mfma_f32_16x16x32_bf16 v[148:151], a[236:239], a[116:119], v[148:151]
  v_mfma_f32_16x16x32_bf16 v[180:183], a[232:235], a[104:107], v[180:183]
  buffer_load_dwordx4 a[160:163], v225, s[4:7], s40 offen offset:0 sc1
  v_mfma_f32_16x16x32_bf16 v[180:183], a[236:239], a[120:123], v[180:183]
  v_mfma_f32_16x16x32_bf16 v[212:215], a[232:235], a[108:111], v[212:215]
  ds_read_b64_tr_b16 a[232:233], v229 offset:57344
  v_mfma_f32_16x16x32_bf16 v[212:215], a[236:239], a[124:127], v[212:215]
  ds_read_b64_tr_b16 a[234:235], v229 offset:59392
  s_waitcnt lgkmcnt(13)
  v_mfma_f32_16x16x32_bf16 v[120:123], a[192:195], a[96:99], v[120:123]
  ds_read_b64_tr_b16 a[236:237], v229 offset:61440
  v_mfma_f32_16x16x32_bf16 v[120:123], a[196:199], a[112:115], v[120:123]
  ds_read_b64_tr_b16 a[238:239], v229 offset:63488
  v_mfma_f32_16x16x32_bf16 v[152:155], a[192:195], a[100:103], v[152:155]
  buffer_load_dwordx4 a[164:167], v225, s[4:7], s40 offen offset:1024 sc1
  v_mfma_f32_16x16x32_bf16 v[152:155], a[196:199], a[116:119], v[152:155]
  v_mfma_f32_16x16x32_bf16 v[184:187], a[192:195], a[104:107], v[184:187]
  v_mfma_f32_16x16x32_bf16 v[184:187], a[196:199], a[120:123], v[184:187]
  v_mfma_f32_16x16x32_bf16 v[216:219], a[192:195], a[108:111], v[216:219]
L_wk0_1:
  s_cbranch_vccnz L_wk0_5
  ds_read_b64_tr_b16 a[192:193], v230 offset:49152
  v_mfma_f32_16x16x32_bf16 v[216:219], a[196:199], a[124:127], v[216:219]
  ds_read_b64_tr_b16 a[194:195], v230 offset:51200
  v_mfma_f32_16x16x32_bf16 v[124:127], a[200:203], a[96:99], v[124:127]
  buffer_load_dwordx4 a[168:171], v225, s[4:7], s40 offen offset:2048 sc1
  v_mfma_f32_16x16x32_bf16 v[124:127], a[204:207], a[112:115], v[124:127]
  ds_read_b64_tr_b16 a[196:197], v230 offset:53248
  ds_read_b64_tr_b16 a[198:199], v230 offset:55296
  v_mfma_f32_16x16x32_bf16 v[156:159], a[200:203], a[100:103], v[156:159]
  v_mfma_f32_16x16x32_bf16 v[156:159], a[204:207], a[116:119], v[156:159]
  v_mfma_f32_16x16x32_bf16 v[188:191], a[200:203], a[104:107], v[188:191]
  v_mfma_f32_16x16x32_bf16 v[188:191], a[204:207], a[120:123], v[188:191]
  v_mfma_f32_16x16x32_bf16 v[220:223], a[200:203], a[108:111], v[220:223]
  buffer_load_dwordx4 a[172:175], v225, s[4:7], s40 offen offset:3072 sc1
  v_mfma_f32_16x16x32_bf16 v[220:223], a[204:207], a[124:127], v[220:223]
  ds_read_b64_tr_b16 a[200:201], v230 offset:57344
  s_mov_b32 s40, 20840448
  s_load_dwordx2 s[66:67], s[22:23], 0x20000
  s_waitcnt vmcnt(17) lgkmcnt(13)
  v_mfma_f32_16x16x32_bf16 v[0:3], a[208:211], a[128:131], v[0:3]
  ds_read_b64_tr_b16 a[202:203], v230 offset:59392
  s_waitcnt vmcnt(13)
  v_mfma_f32_16x16x32_bf16 v[0:3], a[212:215], a[144:147], v[0:3]
  ds_read_b64_tr_b16 a[204:205], v230 offset:61440
  ds_read_b64_tr_b16 a[206:207], v230 offset:63488
  v_mfma_f32_16x16x32_bf16 v[16:19], a[208:211], a[132:135], v[16:19]
  v_mfma_f32_16x16x32_bf16 v[16:19], a[212:215], a[148:151], v[16:19]
  v_mfma_f32_16x16x32_bf16 v[32:35], a[208:211], a[136:139], v[32:35]
  buffer_load_dwordx4 a[176:179], v225, s[4:7], s40 offen offset:0 sc1
  v_mfma_f32_16x16x32_bf16 v[32:35], a[212:215], a[152:155], v[32:35]
  v_mfma_f32_16x16x32_bf16 v[48:51], a[208:211], a[140:143], v[48:51]
  ds_read_b64_tr_b16 a[208:209], v232 offset:0
  v_mfma_f32_16x16x32_bf16 v[48:51], a[212:215], a[156:159], v[48:51]
  ds_read_b64_tr_b16 a[210:211], v232 offset:2048
  v_mfma_f32_16x16x32_bf16 v[4:7], a[216:219], a[128:131], v[4:7]
  ds_read_b64_tr_b16 a[212:213], v232 offset:4096
  v_mfma_f32_16x16x32_bf16 v[4:7], a[220:223], a[144:147], v[4:7]
  ds_read_b64_tr_b16 a[214:215], v232 offset:6144
  v_mfma_f32_16x16x32_bf16 v[20:23], a[216:219], a[132:135], v[20:23]
  buffer_load_dwordx4 a[180:183], v225, s[4:7], s40 offen offset:1024 sc1
  v_mfma_f32_16x16x32_bf16 v[20:23], a[220:223], a[148:151], v[20:23]
  v_mfma_f32_16x16x32_bf16 v[36:39], a[216:219], a[136:139], v[36:39]
  v_mfma_f32_16x16x32_bf16 v[36:39], a[220:223], a[152:155], v[36:39]
  v_mfma_f32_16x16x32_bf16 v[52:55], a[216:219], a[140:143], v[52:55]
  ds_read_b64_tr_b16 a[216:217], v233 offset:0
  v_mfma_f32_16x16x32_bf16 v[52:55], a[220:223], a[156:159], v[52:55]
  ds_read_b64_tr_b16 a[218:219], v233 offset:2048
  s_waitcnt lgkmcnt(13)
  v_mfma_f32_16x16x32_bf16 v[8:11], a[224:227], a[128:131], v[8:11]
  buffer_load_dwordx4 a[184:187], v225, s[4:7], s40 offen offset:2048 sc1
  v_mfma_f32_16x16x32_bf16 v[8:11], a[228:231], a[144:147], v[8:11]
  s_waitcnt vmcnt(11)
  s_barrier
  v_mfma_f32_16x16x32_bf16 v[24:27], a[224:227], a[132:135], v[24:27]
  ds_read_b64_tr_b16 a[220:221], v233 offset:4096
  ds_read_b64_tr_b16 a[222:223], v233 offset:6144
  v_mfma_f32_16x16x32_bf16 v[24:27], a[228:231], a[148:151], v[24:27]
  v_mfma_f32_16x16x32_bf16 v[40:43], a[224:227], a[136:139], v[40:43]
  v_mfma_f32_16x16x32_bf16 v[40:43], a[228:231], a[152:155], v[40:43]
  s_load_dwordx2 s[66:67], s[22:23], 0x40000
  v_mfma_f32_16x16x32_bf16 v[56:59], a[224:227], a[140:143], v[56:59]
  buffer_load_dwordx4 a[188:191], v225, s[4:7], s40 offen offset:3072 sc1
  v_mfma_f32_16x16x32_bf16 v[56:59], a[228:231], a[156:159], v[56:59]
  ds_read_b64_tr_b16 a[224:225], v234 offset:0
  s_mov_b32 s41, 1376256
  v_mfma_f32_16x16x32_bf16 v[12:15], a[232:235], a[128:131], v[12:15]
  ds_read_b64_tr_b16 a[226:227], v234 offset:2048
  s_add_u32 m0, s42, 106496
  v_mfma_f32_16x16x32_bf16 v[12:15], a[236:239], a[144:147], v[12:15]
  ds_read_b64_tr_b16 a[228:229], v234 offset:4096
  ds_read_b64_tr_b16 a[230:231], v234 offset:6144
  v_mfma_f32_16x16x32_bf16 v[28:31], a[232:235], a[132:135], v[28:31]
  v_mfma_f32_16x16x32_bf16 v[28:31], a[236:239], a[148:151], v[28:31]
  v_mfma_f32_16x16x32_bf16 v[44:47], a[232:235], a[136:139], v[44:47]
  buffer_load_dwordx4 v226, s[16:19], s41 offen lds
  v_mfma_f32_16x16x32_bf16 v[44:47], a[236:239], a[152:155], v[44:47]
  s_mov_b32 s41, 1605632
  s_add_u32 m0, s42, 110592
  v_mfma_f32_16x16x32_bf16 v[60:63], a[232:235], a[140:143], v[60:63]
  ds_read_b64_tr_b16 a[232:233], v235 offset:0
  v_mfma_f32_16x16x32_bf16 v[60:63], a[236:239], a[156:159], v[60:63]
  ds_read_b64_tr_b16 a[234:235], v235 offset:2048
  s_waitcnt lgkmcnt(13)
  v_mfma_f32_16x16x32_bf16 v[64:67], a[192:195], a[128:131], v[64:67]
  ds_read_b64_tr_b16 a[236:237], v235 offset:4096
  v_mfma_f32_16x16x32_bf16 v[64:67], a[196:199], a[144:147], v[64:67]
  ds_read_b64_tr_b16 a[238:239], v235 offset:6144
  v_mfma_f32_16x16x32_bf16 v[72:75], a[192:195], a[132:135], v[72:75]
  buffer_load_dwordx4 v226, s[16:19], s41 offen lds
  v_mfma_f32_16x16x32_bf16 v[72:75], a[196:199], a[148:151], v[72:75]
  s_mov_b32 s41, 1835008
  s_add_u32 m0, s42, 114688
  v_mfma_f32_16x16x32_bf16 v[80:83], a[192:195], a[136:139], v[80:83]
  v_mfma_f32_16x16x32_bf16 v[80:83], a[196:199], a[152:155], v[80:83]
  v_mfma_f32_16x16x32_bf16 v[88:91], a[192:195], a[140:143], v[88:91]
  ds_read_b64_tr_b16 a[192:193], v232 offset:8192
  v_mfma_f32_16x16x32_bf16 v[88:91], a[196:199], a[156:159], v[88:91]
  ds_read_b64_tr_b16 a[194:195], v232 offset:10240
  v_mfma_f32_16x16x32_bf16 v[68:71], a[200:203], a[128:131], v[68:71]
  buffer_load_dwordx4 v227, s[12:15], s41 offen lds
  v_mfma_f32_16x16x32_bf16 v[68:71], a[204:207], a[144:147], v[68:71]
  ds_read_b64_tr_b16 a[196:197], v232 offset:12288
  ds_read_b64_tr_b16 a[198:199], v232 offset:14336
  v_mfma_f32_16x16x32_bf16 v[76:79], a[200:203], a[132:135], v[76:79]
  s_mov_b32 s41, 2064384
  s_add_u32 m0, s42, 118784
  v_mfma_f32_16x16x32_bf16 v[76:79], a[204:207], a[148:151], v[76:79]
  s_load_dwordx2 s[66:67], s[22:23], 0x60000
  v_mfma_f32_16x16x32_bf16 v[84:87], a[200:203], a[136:139], v[84:87]
  v_mfma_f32_16x16x32_bf16 v[84:87], a[204:207], a[152:155], v[84:87]
  v_mfma_f32_16x16x32_bf16 v[92:95], a[200:203], a[140:143], v[92:95]
  buffer_load_dwordx4 v227, s[12:15], s41 offen lds
  v_mfma_f32_16x16x32_bf16 v[92:95], a[204:207], a[156:159], v[92:95]
  ds_read_b64_tr_b16 a[200:201], v233 offset:8192
  s_mov_b32 s41, 1835008
  s_waitcnt lgkmcnt(13)
  v_mfma_f32_16x16x32_bf16 v[96:99], a[208:211], a[128:131], v[96:99]
  ds_read_b64_tr_b16 a[202:203], v233 offset:10240
  s_add_u32 m0, s42, 122880
  v_mfma_f32_16x16x32_bf16 v[96:99], a[212:215], a[144:147], v[96:99]
  ds_read_b64_tr_b16 a[204:205], v233 offset:12288
  ds_read_b64_tr_b16 a[206:207], v233 offset:14336
  v_mfma_f32_16x16x32_bf16 v[128:131], a[208:211], a[132:135], v[128:131]
  v_mfma_f32_16x16x32_bf16 v[128:131], a[212:215], a[148:151], v[128:131]
  v_mfma_f32_16x16x32_bf16 v[160:163], a[208:211], a[136:139], v[160:163]
  buffer_load_dwordx4 v227, s[16:19], s41 offen lds
  v_mfma_f32_16x16x32_bf16 v[160:163], a[212:215], a[152:155], v[160:163]
  s_mov_b32 s41, 2064384
  s_add_u32 m0, s42, 126976
  v_mfma_f32_16x16x32_bf16 v[192:195], a[208:211], a[140:143], v[192:195]
  ds_read_b64_tr_b16 a[208:209], v234 offset:8192
  v_mfma_f32_16x16x32_bf16 v[192:195], a[212:215], a[156:159], v[192:195]
  ds_read_b64_tr_b16 a[210:211], v234 offset:10240
  v_mfma_f32_16x16x32_bf16 v[100:103], a[216:219], a[128:131], v[100:103]
  ds_read_b64_tr_b16 a[212:213], v234 offset:12288
  v_mfma_f32_16x16x32_bf16 v[100:103], a[220:223], a[144:147], v[100:103]
  ds_read_b64_tr_b16 a[214:215], v234 offset:14336
  v_mfma_f32_16x16x32_bf16 v[132:135], a[216:219], a[132:135], v[132:135]
  buffer_load_dwordx4 v227, s[16:19], s41 offen lds
  v_mfma_f32_16x16x32_bf16 v[132:135], a[220:223], a[148:151], v[132:135]
  s_mov_b32 s41, 1835008
  s_add_u32 m0, s42, 131072
  v_mfma_f32_16x16x32_bf16 v[164:167], a[216:219], a[136:139], v[164:167]
  s_mov_b32 s36, 4718592
  v_mfma_f32_16x16x32_bf16 v[164:167], a[220:223], a[152:155], v[164:167]
  buffer_load_dword v248, v247, s[56:59], s36 offen
  v_mfma_f32_16x16x32_bf16 v[196:199], a[216:219], a[140:143], v[196:199]
  ds_read_b64_tr_b16 a[216:217], v235 offset:8192
  v_mfma_f32_16x16x32_bf16 v[196:199], a[220:223], a[156:159], v[196:199]
  ds_read_b64_tr_b16 a[218:219], v235 offset:10240
  s_waitcnt lgkmcnt(13)
  v_mfma_f32_16x16x32_bf16 v[104:107], a[224:227], a[128:131], v[104:107]
  buffer_load_dwordx4 v226, s[12:15], s41 offen lds
  v_mfma_f32_16x16x32_bf16 v[104:107], a[228:231], a[144:147], v[104:107]
  ds_read_b64_tr_b16 a[220:221], v235 offset:12288
  ds_read_b64_tr_b16 a[222:223], v235 offset:14336
  s_load_dwordx2 s[66:67], s[22:23], 0x80000
  v_mfma_f32_16x16x32_bf16 v[136:139], a[224:227], a[132:135], v[136:139]
  s_mov_b32 s41, 2064384
  s_add_u32 m0, s42, 135168
  v_mfma_f32_16x16x32_bf16 v[136:139], a[228:231], a[148:151], v[136:139]
  v_mfma_f32_16x16x32_bf16 v[168:171], a[224:227], a[136:139], v[168:171]
  v_mfma_f32_16x16x32_bf16 v[168:171], a[228:231], a[152:155], v[168:171]
  v_mfma_f32_16x16x32_bf16 v[200:203], a[224:227], a[140:143], v[200:203]
  buffer_load_dwordx4 v226, s[12:15], s41 offen lds
  v_mfma_f32_16x16x32_bf16 v[200:203], a[228:231], a[156:159], v[200:203]
  ds_read_b64_tr_b16 a[224:225], v232 offset:16384
  s_mov_b32 s40, 20971520
  v_mfma_f32_16x16x32_bf16 v[108:111], a[232:235], a[128:131], v[108:111]
  ds_read_b64_tr_b16 a[226:227], v232 offset:18432
  v_mfma_f32_16x16x32_bf16 v[108:111], a[236:239], a[144:147], v[108:111]
  s_waitcnt vmcnt(17)
  s_barrier
  v_mfma_f32_16x16x32_bf16 v[140:143], a[232:235], a[132:135], v[140:143]
  ds_read_b64_tr_b16 a[228:229], v232 offset:20480
  ds_read_b64_tr_b16 a[230:231], v232 offset:22528
  v_mfma_f32_16x16x32_bf16 v[140:143], a[236:239], a[148:151], v[140:143]
  v_mfma_f32_16x16x32_bf16 v[172:175], a[232:235], a[136:139], v[172:175]
  buffer_load_dwordx4 a[0:3], v225, s[4:7], s40 offen offset:0 sc1
  v_mfma_f32_16x16x32_bf16 v[172:175], a[236:239], a[152:155], v[172:175]
  v_mfma_f32_16x16x32_bf16 v[204:207], a[232:235], a[140:143], v[204:207]
  ds_read_b64_tr_b16 a[232:233], v233 offset:16384
  v_mfma_f32_16x16x32_bf16 v[204:207], a[236:239], a[156:159], v[204:207]
  ds_read_b64_tr_b16 a[234:235], v233 offset:18432
  s_waitcnt lgkmcnt(13)
  v_mfma_f32_16x16x32_bf16 v[112:115], a[192:195], a[128:131], v[112:115]
  ds_read_b64_tr_b16 a[236:237], v233 offset:20480
  v_mfma_f32_16x16x32_bf16 v[112:115], a[196:199], a[144:147], v[112:115]
  ds_read_b64_tr_b16 a[238:239], v233 offset:22528
  v_mfma_f32_16x16x32_bf16 v[144:147], a[192:195], a[132:135], v[144:147]
  buffer_load_dwordx4 a[4:7], v225, s[4:7], s40 offen offset:1024 sc1
  v_mfma_f32_16x16x32_bf16 v[144:147], a[196:199], a[148:151], v[144:147]
  v_mfma_f32_16x16x32_bf16 v[176:179], a[192:195], a[136:139], v[176:179]
  v_mfma_f32_16x16x32_bf16 v[176:179], a[196:199], a[152:155], v[176:179]
  v_mfma_f32_16x16x32_bf16 v[208:211], a[192:195], a[140:143], v[208:211]
  ds_read_b64_tr_b16 a[192:193], v232 offset:24576
  v_mfma_f32_16x16x32_bf16 v[208:211], a[196:199], a[156:159], v[208:211]
  ds_read_b64_tr_b16 a[194:195], v232 offset:26624
  s_load_dwordx2 s[66:67], s[22:23], 0xa0000
  v_mfma_f32_16x16x32_bf16 v[116:119], a[200:203], a[128:131], v[116:119]
  buffer_load_dwordx4 a[8:11], v225, s[4:7], s40 offen offset:2048 sc1
  v_mfma_f32_16x16x32_bf16 v[116:119], a[204:207], a[144:147], v[116:119]
  ds_read_b64_tr_b16 a[196:197], v232 offset:28672
  ds_read_b64_tr_b16 a[198:199], v232 offset:30720
  v_mfma_f32_16x16x32_bf16 v[148:151], a[200:203], a[132:135], v[148:151]
  v_mfma_f32_16x16x32_bf16 v[148:151], a[204:207], a[148:151], v[148:151]
  v_mfma_f32_16x16x32_bf16 v[180:183], a[200:203], a[136:139], v[180:183]
  v_mfma_f32_16x16x32_bf16 v[180:183], a[204:207], a[152:155], v[180:183]
  v_mfma_f32_16x16x32_bf16 v[212:215], a[200:203], a[140:143], v[212:215]
  buffer_load_dwordx4 a[12:15], v225, s[4:7], s40 offen offset:3072 sc1
  v_mfma_f32_16x16x32_bf16 v[212:215], a[204:207], a[156:159], v[212:215]
  ds_read_b64_tr_b16 a[200:201], v233 offset:24576
  s_mov_b32 s40, 21102592
  s_waitcnt lgkmcnt(13)
  v_mfma_f32_16x16x32_bf16 v[120:123], a[208:211], a[128:131], v[120:123]
  ds_read_b64_tr_b16 a[202:203], v233 offset:26624
  v_mfma_f32_16x16x32_bf16 v[120:123], a[212:215], a[144:147], v[120:123]
  ds_read_b64_tr_b16 a[204:205], v233 offset:28672
  ds_read_b64_tr_b16 a[206:207], v233 offset:30720
  v_mfma_f32_16x16x32_bf16 v[152:155], a[208:211], a[132:135], v[152:155]
  v_mfma_f32_16x16x32_bf16 v[152:155], a[212:215], a[148:151], v[152:155]
  v_mfma_f32_16x16x32_bf16 v[184:187], a[208:211], a[136:139], v[184:187]
  buffer_load_dwordx4 a[16:19], v225, s[4:7], s40 offen offset:0 sc1
  v_mfma_f32_16x16x32_bf16 v[184:187], a[212:215], a[152:155], v[184:187]
  v_mfma_f32_16x16x32_bf16 v[216:219], a[208:211], a[140:143], v[216:219]
  ds_read_b64_tr_b16 a[208:209], v234 offset:16384
  v_mfma_f32_16x16x32_bf16 v[216:219], a[212:215], a[156:159], v[216:219]
  ds_read_b64_tr_b16 a[210:211], v234 offset:18432
  v_mfma_f32_16x16x32_bf16 v[124:127], a[216:219], a[128:131], v[124:127]
  ds_read_b64_tr_b16 a[212:213], v234 offset:20480
  v_mfma_f32_16x16x32_bf16 v[124:127], a[220:223], a[144:147], v[124:127]
  ds_read_b64_tr_b16 a[214:215], v234 offset:22528
  v_mfma_f32_16x16x32_bf16 v[156:159], a[216:219], a[132:135], v[156:159]
  buffer_load_dwordx4 a[20:23], v225, s[4:7], s40 offen offset:1024 sc1
  v_mfma_f32_16x16x32_bf16 v[156:159], a[220:223], a[148:151], v[156:159]
  v_mfma_f32_16x16x32_bf16 v[188:191], a[216:219], a[136:139], v[188:191]
  v_mfma_f32_16x16x32_bf16 v[188:191], a[220:223], a[152:155], v[188:191]
  s_load_dwordx2 s[66:67], s[22:23], 0xc0000
  v_mfma_f32_16x16x32_bf16 v[220:223], a[216:219], a[140:143], v[220:223]
  ds_read_b64_tr_b16 a[216:217], v234 offset:24576
  v_mfma_f32_16x16x32_bf16 v[220:223], a[220:223], a[156:159], v[220:223]
  ds_read_b64_tr_b16 a[218:219], v234 offset:26624
  s_waitcnt vmcnt(19) lgkmcnt(13)
  v_mfma_f32_16x16x32_bf16 v[0:3], a[224:227], a[160:163], v[0:3]
  buffer_load_dwordx4 a[24:27], v225, s[4:7], s40 offen offset:2048 sc1
  s_waitcnt vmcnt(16)
  v_mfma_f32_16x16x32_bf16 v[0:3], a[228:231], a[176:179], v[0:3]
  ds_read_b64_tr_b16 a[220:221], v234 offset:28672
  ds_read_b64_tr_b16 a[222:223], v234 offset:30720
  v_mfma_f32_16x16x32_bf16 v[16:19], a[224:227], a[164:167], v[16:19]
  v_mfma_f32_16x16x32_bf16 v[16:19], a[228:231], a[180:183], v[16:19]
  v_mfma_f32_16x16x32_bf16 v[32:35], a[224:227], a[168:171], v[32:35]
  v_mfma_f32_16x16x32_bf16 v[32:35], a[228:231], a[184:187], v[32:35]
  v_mfma_f32_16x16x32_bf16 v[48:51], a[224:227], a[172:175], v[48:51]
  buffer_load_dwordx4 a[28:31], v225, s[4:7], s40 offen offset:3072 sc1
  v_mfma_f32_16x16x32_bf16 v[48:51], a[228:231], a[188:191], v[48:51]
  ds_read_b64_tr_b16 a[224:225], v232 offset:32768
  s_mov_b32 s41, 1835008
  v_mfma_f32_16x16x32_bf16 v[4:7], a[232:235], a[160:163], v[4:7]
  ds_read_b64_tr_b16 a[226:227], v232 offset:34816
  s_add_u32 m0, s42, 139264
  v_mfma_f32_16x16x32_bf16 v[4:7], a[236:239], a[176:179], v[4:7]
  ds_read_b64_tr_b16 a[228:229], v232 offset:36864
  ds_read_b64_tr_b16 a[230:231], v232 offset:38912
  v_mfma_f32_16x16x32_bf16 v[20:23], a[232:235], a[164:167], v[20:23]
  v_mfma_f32_16x16x32_bf16 v[20:23], a[236:239], a[180:183], v[20:23]
  v_mfma_f32_16x16x32_bf16 v[36:39], a[232:235], a[168:171], v[36:39]
  buffer_load_dwordx4 v226, s[16:19], s41 offen lds
  v_mfma_f32_16x16x32_bf16 v[36:39], a[236:239], a[184:187], v[36:39]
  s_mov_b32 s41, 2064384
  s_add_u32 m0, s42, 143360
  v_mfma_f32_16x16x32_bf16 v[52:55], a[232:235], a[172:175], v[52:55]
  ds_read_b64_tr_b16 a[232:233], v233 offset:32768
  v_mfma_f32_16x16x32_bf16 v[52:55], a[236:239], a[188:191], v[52:55]
  ds_read_b64_tr_b16 a[234:235], v233 offset:34816
  s_waitcnt lgkmcnt(13)
  v_mfma_f32_16x16x32_bf16 v[8:11], a[192:195], a[160:163], v[8:11]
  ds_read_b64_tr_b16 a[236:237], v233 offset:36864
  v_mfma_f32_16x16x32_bf16 v[8:11], a[196:199], a[176:179], v[8:11]
  s_waitcnt vmcnt(14)
  s_barrier
  v_mfma_f32_16x16x32_bf16 v[24:27], a[192:195], a[164:167], v[24:27]
  buffer_load_dwordx4 v226, s[16:19], s41 offen lds
  v_mfma_f32_16x16x32_bf16 v[24:27], a[196:199], a[180:183], v[24:27]
  ds_read_b64_tr_b16 a[238:239], v233 offset:38912
  s_mov_b32 s41, 2293760
  s_load_dwordx2 s[66:67], s[22:23], 0xe0000
  s_add_u32 s22, s22, 0x100000
  s_addc_u32 s23, s23, 0
  v_mfma_f32_16x16x32_bf16 v[40:43], a[192:195], a[168:171], v[40:43]
  s_add_u32 m0, s42, 147456
  v_mfma_f32_16x16x32_bf16 v[40:43], a[196:199], a[184:187], v[40:43]
  v_mfma_f32_16x16x32_bf16 v[56:59], a[192:195], a[172:175], v[56:59]
  ds_read_b64_tr_b16 a[192:193], v234 offset:32768
  v_mfma_f32_16x16x32_bf16 v[56:59], a[196:199], a[188:191], v[56:59]
  ds_read_b64_tr_b16 a[194:195], v234 offset:34816
  v_mfma_f32_16x16x32_bf16 v[12:15], a[200:203], a[160:163], v[12:15]
  buffer_load_dwordx4 v227, s[12:15], s41 offen lds
  v_mfma_f32_16x16x32_bf16 v[12:15], a[204:207], a[176:179], v[12:15]
  ds_read_b64_tr_b16 a[196:197], v234 offset:36864
  ds_read_b64_tr_b16 a[198:199], v234 offset:38912
  v_mfma_f32_16x16x32_bf16 v[28:31], a[200:203], a[164:167], v[28:31]
  s_mov_b32 s41, 2523136
  s_add_u32 m0, s42, 151552
  v_mfma_f32_16x16x32_bf16 v[28:31], a[204:207], a[180:183], v[28:31]
  v_mfma_f32_16x16x32_bf16 v[44:47], a[200:203], a[168:171], v[44:47]
  v_mfma_f32_16x16x32_bf16 v[44:47], a[204:207], a[184:187], v[44:47]
  v_mfma_f32_16x16x32_bf16 v[60:63], a[200:203], a[172:175], v[60:63]
  buffer_load_dwordx4 v227, s[12:15], s41 offen lds
  v_mfma_f32_16x16x32_bf16 v[60:63], a[204:207], a[188:191], v[60:63]
  ds_read_b64_tr_b16 a[200:201], v235 offset:32768
  s_mov_b32 s41, 2293760
  s_waitcnt lgkmcnt(13)
  v_mfma_f32_16x16x32_bf16 v[64:67], a[208:211], a[160:163], v[64:67]
  ds_read_b64_tr_b16 a[202:203], v235 offset:34816
  s_add_u32 m0, s42, 155648
  v_mfma_f32_16x16x32_bf16 v[64:67], a[212:215], a[176:179], v[64:67]
  ds_read_b64_tr_b16 a[204:205], v235 offset:36864
  ds_read_b64_tr_b16 a[206:207], v235 offset:38912
  v_mfma_f32_16x16x32_bf16 v[72:75], a[208:211], a[164:167], v[72:75]
  v_mfma_f32_16x16x32_bf16 v[72:75], a[212:215], a[180:183], v[72:75]
  v_mfma_f32_16x16x32_bf16 v[80:83], a[208:211], a[168:171], v[80:83]
  buffer_load_dwordx4 v227, s[16:19], s41 offen lds
  v_mfma_f32_16x16x32_bf16 v[80:83], a[212:215], a[184:187], v[80:83]
  s_mov_b32 s41, 2523136
  s_add_u32 m0, s42, 159744
  v_mfma_f32_16x16x32_bf16 v[88:91], a[208:211], a[172:175], v[88:91]
  ds_read_b64_tr_b16 a[208:209], v232 offset:40960
  v_mfma_f32_16x16x32_bf16 v[88:91], a[212:215], a[188:191], v[88:91]
  ds_read_b64_tr_b16 a[210:211], v232 offset:43008
  v_mfma_f32_16x16x32_bf16 v[68:71], a[216:219], a[160:163], v[68:71]
  ds_read_b64_tr_b16 a[212:213], v232 offset:45056
  v_mfma_f32_16x16x32_bf16 v[68:71], a[220:223], a[176:179], v[68:71]
  ds_read_b64_tr_b16 a[214:215], v232 offset:47104
  s_load_dwordx2 s[66:67], s[22:23], 0x0
  v_mfma_f32_16x16x32_bf16 v[76:79], a[216:219], a[164:167], v[76:79]
  buffer_load_dwordx4 v227, s[16:19], s41 offen lds
  v_mfma_f32_16x16x32_bf16 v[76:79], a[220:223], a[180:183], v[76:79]
  s_mov_b32 s41, 2293760
  s_add_u32 m0, s42, 8192
  v_mfma_f32_16x16x32_bf16 v[84:87], a[216:219], a[168:171], v[84:87]
  v_mfma_f32_16x16x32_bf16 v[84:87], a[220:223], a[184:187], v[84:87]
  v_mfma_f32_16x16x32_bf16 v[92:95], a[216:219], a[172:175], v[92:95]
  ds_read_b64_tr_b16 a[216:217], v233 offset:40960
  v_mfma_f32_16x16x32_bf16 v[92:95], a[220:223], a[188:191], v[92:95]
  ds_read_b64_tr_b16 a[218:219], v233 offset:43008
  s_waitcnt lgkmcnt(13)
  v_mfma_f32_16x16x32_bf16 v[96:99], a[224:227], a[160:163], v[96:99]
  buffer_load_dwordx4 v226, s[12:15], s41 offen lds
  v_mfma_f32_16x16x32_bf16 v[96:99], a[228:231], a[176:179], v[96:99]
  ds_read_b64_tr_b16 a[220:221], v233 offset:45056
  ds_read_b64_tr_b16 a[222:223], v233 offset:47104
  v_mfma_f32_16x16x32_bf16 v[128:131], a[224:227], a[164:167], v[128:131]
  s_mov_b32 s41, 2523136
  s_add_u32 m0, s42, 12288
  v_mfma_f32_16x16x32_bf16 v[128:131], a[228:231], a[180:183], v[128:131]
  v_mfma_f32_16x16x32_bf16 v[160:163], a[224:227], a[168:171], v[160:163]
  v_mfma_f32_16x16x32_bf16 v[160:163], a[228:231], a[184:187], v[160:163]
  v_mfma_f32_16x16x32_bf16 v[192:195], a[224:227], a[172:175], v[192:195]
  buffer_load_dwordx4 v226, s[12:15], s41 offen lds
  v_mfma_f32_16x16x32_bf16 v[192:195], a[228:231], a[188:191], v[192:195]
  ds_read_b64_tr_b16 a[224:225], v234 offset:40960
  s_mov_b32 s40, 21233664
  v_mfma_f32_16x16x32_bf16 v[100:103], a[232:235], a[160:163], v[100:103]
  ds_read_b64_tr_b16 a[226:227], v234 offset:43008
  v_mfma_f32_16x16x32_bf16 v[100:103], a[236:239], a[176:179], v[100:103]
  ds_read_b64_tr_b16 a[228:229], v234 offset:45056
  ds_read_b64_tr_b16 a[230:231], v234 offset:47104
  v_mfma_f32_16x16x32_bf16 v[132:135], a[232:235], a[164:167], v[132:135]
  v_mfma_f32_16x16x32_bf16 v[132:135], a[236:239], a[180:183], v[132:135]
  s_mov_b32 s36, 5242880
  v_mfma_f32_16x16x32_bf16 v[164:167], a[232:235], a[168:171], v[164:167]
  buffer_load_dwordx4 a[32:35], v225, s[4:7], s40 offen offset:0 sc1
  v_mfma_f32_16x16x32_bf16 v[164:167], a[236:239], a[184:187], v[164:167]
  buffer_load_dword v248, v247, s[56:59], s36 offen
  v_mfma_f32_16x16x32_bf16 v[196:199], a[232:235], a[172:175], v[196:199]
  ds_read_b64_tr_b16 a[232:233], v235 offset:40960
  v_mfma_f32_16x16x32_bf16 v[196:199], a[236:239], a[188:191], v[196:199]
  ds_read_b64_tr_b16 a[234:235], v235 offset:43008
  s_load_dwordx2 s[66:67], s[22:23], 0x20000
  s_waitcnt lgkmcnt(13)
  v_mfma_f32_16x16x32_bf16 v[104:107], a[192:195], a[160:163], v[104:107]
  ds_read_b64_tr_b16 a[236:237], v235 offset:45056
  v_mfma_f32_16x16x32_bf16 v[104:107], a[196:199], a[176:179], v[104:107]
  ds_read_b64_tr_b16 a[238:239], v235 offset:47104
  v_mfma_f32_16x16x32_bf16 v[136:139], a[192:195], a[164:167], v[136:139]
  buffer_load_dwordx4 a[36:39], v225, s[4:7], s40 offen offset:1024 sc1
  v_mfma_f32_16x16x32_bf16 v[136:139], a[196:199], a[180:183], v[136:139]
  v_mfma_f32_16x16x32_bf16 v[168:171], a[192:195], a[168:171], v[168:171]
  v_mfma_f32_16x16x32_bf16 v[168:171], a[196:199], a[184:187], v[168:171]
  v_mfma_f32_16x16x32_bf16 v[200:203], a[192:195], a[172:175], v[200:203]
  ds_read_b64_tr_b16 a[192:193], v232 offset:49152
  v_mfma_f32_16x16x32_bf16 v[200:203], a[196:199], a[188:191], v[200:203]
  ds_read_b64_tr_b16 a[194:195], v232 offset:51200
  v_mfma_f32_16x16x32_bf16 v[108:111], a[200:203], a[160:163], v[108:111]
  buffer_load_dwordx4 a[40:43], v225, s[4:7], s40 offen offset:2048 sc1
  v_mfma_f32_16x16x32_bf16 v[108:111], a[204:207], a[176:179], v[108:111]
  s_waitcnt vmcnt(20)
  s_barrier
  v_mfma_f32_16x16x32_bf16 v[140:143], a[200:203], a[164:167], v[140:143]
  ds_read_b64_tr_b16 a[196:197], v232 offset:53248
  ds_read_b64_tr_b16 a[198:199], v232 offset:55296
  v_mfma_f32_16x16x32_bf16 v[140:143], a[204:207], a[180:183], v[140:143]
  v_mfma_f32_16x16x32_bf16 v[172:175], a[200:203], a[168:171], v[172:175]
  v_mfma_f32_16x16x32_bf16 v[172:175], a[204:207], a[184:187], v[172:175]
  v_mfma_f32_16x16x32_bf16 v[204:207], a[200:203], a[172:175], v[204:207]
  buffer_load_dwordx4 a[44:47], v225, s[4:7], s40 offen offset:3072 sc1
  v_mfma_f32_16x16x32_bf16 v[204:207], a[204:207], a[188:191], v[204:207]
  ds_read_b64_tr_b16 a[200:201], v233 offset:49152
  s_mov_b32 s40, 21364736
  s_waitcnt lgkmcnt(13)
  v_mfma_f32_16x16x32_bf16 v[112:115], a[208:211], a[160:163], v[112:115]
  ds_read_b64_tr_b16 a[202:203], v233 offset:51200
  v_mfma_f32_16x16x32_bf16 v[112:115], a[212:215], a[176:179], v[112:115]
  ds_read_b64_tr_b16 a[204:205], v233 offset:53248
  ds_read_b64_tr_b16 a[206:207], v233 offset:55296
  v_mfma_f32_16x16x32_bf16 v[144:147], a[208:211], a[164:167], v[144:147]
  v_mfma_f32_16x16x32_bf16 v[144:147], a[212:215], a[180:183], v[144:147]
  v_mfma_f32_16x16x32_bf16 v[176:179], a[208:211], a[168:171], v[176:179]
  buffer_load_dwordx4 a[48:51], v225, s[4:7], s40 offen offset:0 sc1
  v_mfma_f32_16x16x32_bf16 v[176:179], a[212:215], a[184:187], v[176:179]
  s_load_dwordx2 s[66:67], s[22:23], 0x40000
  v_mfma_f32_16x16x32_bf16 v[208:211], a[208:211], a[172:175], v[208:211]
  ds_read_b64_tr_b16 a[208:209], v232 offset:57344
  v_mfma_f32_16x16x32_bf16 v[208:211], a[212:215], a[188:191], v[208:211]
  ds_read_b64_tr_b16 a[210:211], v232 offset:59392
  v_mfma_f32_16x16x32_bf16 v[116:119], a[216:219], a[160:163], v[116:119]
  ds_read_b64_tr_b16 a[212:213], v232 offset:61440
  v_mfma_f32_16x16x32_bf16 v[116:119], a[220:223], a[176:179], v[116:119]
  ds_read_b64_tr_b16 a[214:215], v232 offset:63488
  v_mfma_f32_16x16x32_bf16 v[148:151], a[216:219], a[164:167], v[148:151]
  buffer_load_dwordx4 a[52:55], v225, s[4:7], s40 offen offset:1024 sc1
  v_mfma_f32_16x16x32_bf16 v[148:151], a[220:223], a[180:183], v[148:151]
  v_mfma_f32_16x16x32_bf16 v[180:183], a[216:219], a[168:171], v[180:183]
  v_mfma_f32_16x16x32_bf16 v[180:183], a[220:223], a[184:187], v[180:183]
  v_mfma_f32_16x16x32_bf16 v[212:215], a[216:219], a[172:175], v[212:215]
  ds_read_b64_tr_b16 a[216:217], v233 offset:57344
  v_mfma_f32_16x16x32_bf16 v[212:215], a[220:223], a[188:191], v[212:215]
  ds_read_b64_tr_b16 a[218:219], v233 offset:59392
  s_waitcnt lgkmcnt(13)
  v_mfma_f32_16x16x32_bf16 v[120:123], a[224:227], a[160:163], v[120:123]
  buffer_load_dwordx4 a[56:59], v225, s[4:7], s40 offen offset:2048 sc1
  v_mfma_f32_16x16x32_bf16 v[120:123], a[228:231], a[176:179], v[120:123]
  ds_read_b64_tr_b16 a[220:221], v233 offset:61440
  ds_read_b64_tr_b16 a[222:223], v233 offset:63488
  v_mfma_f32_16x16x32_bf16 v[152:155], a[224:227], a[164:167], v[152:155]
  v_mfma_f32_16x16x32_bf16 v[152:155], a[228:231], a[180:183], v[152:155]
  v_mfma_f32_16x16x32_bf16 v[184:187], a[224:227], a[168:171], v[184:187]
  v_mfma_f32_16x16x32_bf16 v[184:187], a[228:231], a[184:187], v[184:187]
  v_mfma_f32_16x16x32_bf16 v[216:219], a[224:227], a[172:175], v[216:219]
  buffer_load_dwordx4 a[60:63], v225, s[4:7], s40 offen offset:3072 sc1
  v_mfma_f32_16x16x32_bf16 v[216:219], a[228:231], a[188:191], v[216:219]
  ds_read_b64_tr_b16 a[224:225], v234 offset:49152
  s_mov_b32 s41, 2293760
  v_mfma_f32_16x16x32_bf16 v[124:127], a[232:235], a[160:163], v[124:127]
  ds_read_b64_tr_b16 a[226:227], v234 offset:51200
  s_add_u32 m0, s42, 16384
  v_mfma_f32_16x16x32_bf16 v[124:127], a[236:239], a[176:179], v[124:127]
  ds_read_b64_tr_b16 a[228:229], v234 offset:53248
  ds_read_b64_tr_b16 a[230:231], v234 offset:55296
  v_mfma_f32_16x16x32_bf16 v[156:159], a[232:235], a[164:167], v[156:159]
  v_mfma_f32_16x16x32_bf16 v[156:159], a[236:239], a[180:183], v[156:159]
  s_load_dwordx2 s[66:67], s[22:23], 0x60000
  v_mfma_f32_16x16x32_bf16 v[188:191], a[232:235], a[168:171], v[188:191]
  buffer_load_dwordx4 v226, s[16:19], s41 offen lds
  v_mfma_f32_16x16x32_bf16 v[188:191], a[236:239], a[184:187], v[188:191]
  s_mov_b32 s41, 2523136
  s_add_u32 m0, s42, 20480
  v_mfma_f32_16x16x32_bf16 v[220:223], a[232:235], a[172:175], v[220:223]
  ds_read_b64_tr_b16 a[232:233], v234 offset:57344
  v_mfma_f32_16x16x32_bf16 v[220:223], a[236:239], a[188:191], v[220:223]
  ds_read_b64_tr_b16 a[234:235], v234 offset:59392
  s_waitcnt vmcnt(22) lgkmcnt(13)
  v_mfma_f32_16x16x32_bf16 v[0:3], a[192:195], a[0:3], v[0:3]
  ds_read_b64_tr_b16 a[236:237], v234 offset:61440
  s_waitcnt vmcnt(18)
  v_mfma_f32_16x16x32_bf16 v[0:3], a[196:199], a[16:19], v[0:3]
  ds_read_b64_tr_b16 a[238:239], v234 offset:63488
  v_mfma_f32_16x16x32_bf16 v[16:19], a[192:195], a[4:7], v[16:19]
  buffer_load_dwordx4 v226, s[16:19], s41 offen lds
  v_mfma_f32_16x16x32_bf16 v[16:19], a[196:199], a[20:23], v[16:19]
  s_mov_b32 s41, 2752512
  s_add_u32 m0, s42, 24576
  v_mfma_f32_16x16x32_bf16 v[32:35], a[192:195], a[8:11], v[32:35]
  v_mfma_f32_16x16x32_bf16 v[32:35], a[196:199], a[24:27], v[32:35]
  v_mfma_f32_16x16x32_bf16 v[48:51], a[192:195], a[12:15], v[48:51]
  ds_read_b64_tr_b16 a[192:193], v236 offset:0
  v_mfma_f32_16x16x32_bf16 v[48:51], a[196:199], a[28:31], v[48:51]
  ds_read_b64_tr_b16 a[194:195], v236 offset:2048
  v_mfma_f32_16x16x32_bf16 v[4:7], a[200:203], a[0:3], v[4:7]
  buffer_load_dwordx4 v227, s[12:15], s41 offen lds
  v_mfma_f32_16x16x32_bf16 v[4:7], a[204:207], a[16:19], v[4:7]
  ds_read_b64_tr_b16 a[196:197], v236 offset:4096
  ds_read_b64_tr_b16 a[198:199], v236 offset:6144
  v_mfma_f32_16x16x32_bf16 v[20:23], a[200:203], a[4:7], v[20:23]
  s_mov_b32 s41, 2981888
  s_add_u32 m0, s42, 28672
  v_mfma_f32_16x16x32_bf16 v[20:23], a[204:207], a[20:23], v[20:23]
  v_mfma_f32_16x16x32_bf16 v[36:39], a[200:203], a[8:11], v[36:39]
  v_mfma_f32_16x16x32_bf16 v[36:39], a[204:207], a[24:27], v[36:39]
  v_mfma_f32_16x16x32_bf16 v[52:55], a[200:203], a[12:15], v[52:55]
  buffer_load_dwordx4 v227, s[12:15], s41 offen lds
  v_mfma_f32_16x16x32_bf16 v[52:55], a[204:207], a[28:31], v[52:55]
  ds_read_b64_tr_b16 a[200:201], v237 offset:0
  s_mov_b32 s41, 2752512
  s_waitcnt lgkmcnt(13)
  v_mfma_f32_16x16x32_bf16 v[8:11], a[208:211], a[0:3], v[8:11]
  ds_read_b64_tr_b16 a[202:203], v237 offset:2048
  s_add_u32 m0, s42, 32768
  v_mfma_f32_16x16x32_bf16 v[8:11], a[212:215], a[16:19], v[8:11]
  s_waitcnt vmcnt(17)
  s_barrier
  s_load_dwordx2 s[66:67], s[22:23], 0x80000
  v_mfma_f32_16x16x32_bf16 v[24:27], a[208:211], a[4:7], v[24:27]
  ds_read_b64_tr_b16 a[204:205], v237 offset:4096
  ds_read_b64_tr_b16 a[206:207], v237 offset:6144
  v_mfma_f32_16x16x32_bf16 v[24:27], a[212:215], a[20:23], v[24:27]
  v_mfma_f32_16x16x32_bf16 v[40:43], a[208:211], a[8:11], v[40:43]
  buffer_load_dwordx4 v227, s[16:19], s41 offen lds
  v_mfma_f32_16x16x32_bf16 v[40:43], a[212:215], a[24:27], v[40:43]
  s_mov_b32 s41, 2981888
  s_add_u32 m0, s42, 36864
  v_mfma_f32_16x16x32_bf16 v[56:59], a[208:211], a[12:15], v[56:59]
  ds_read_b64_tr_b16 a[208:209], v238 offset:0
  v_mfma_f32_16x16x32_bf16 v[56:59], a[212:215], a[28:31], v[56:59]
  ds_read_b64_tr_b16 a[210:211], v238 offset:2048
L_wk0_2:
  s_cbranch_vccnz L_wk0_6
  v_mfma_f32_16x16x32_bf16 v[12:15], a[216:219], a[0:3], v[12:15]
  ds_read_b64_tr_b16 a[212:213], v238 offset:4096
  v_mfma_f32_16x16x32_bf16 v[12:15], a[220:223], a[16:19], v[12:15]
  ds_read_b64_tr_b16 a[214:215], v238 offset:6144
  v_mfma_f32_16x16x32_bf16 v[28:31], a[216:219], a[4:7], v[28:31]
  buffer_load_dwordx4 v227, s[16:19], s41 offen lds
  v_mfma_f32_16x16x32_bf16 v[28:31], a[220:223], a[20:23], v[28:31]
  s_mov_b32 s41, 2752512
  s_add_u32 m0, s42, 40960
  v_mfma_f32_16x16x32_bf16 v[44:47], a[216:219], a[8:11], v[44:47]
  v_mfma_f32_16x16x32_bf16 v[44:47], a[220:223], a[24:27], v[44:47]
  v_mfma_f32_16x16x32_bf16 v[60:63], a[216:219], a[12:15], v[60:63]
  ds_read_b64_tr_b16 a[216:217], v239 offset:0
  v_mfma_f32_16x16x32_bf16 v[60:63], a[220:223], a[28:31], v[60:63]
  ds_read_b64_tr_b16 a[218:219], v239 offset:2048
  s_waitcnt lgkmcnt(13)
  v_mfma_f32_16x16x32_bf16 v[64:67], a[224:227], a[0:3], v[64:67]
  buffer_load_dwordx4 v226, s[12:15], s41 offen lds
  v_mfma_f32_16x16x32_bf16 v[64:67], a[228:231], a[16:19], v[64:67]
  ds_read_b64_tr_b16 a[220:221], v239 offset:4096
  ds_read_b64_tr_b16 a[222:223], v239 offset:6144
  v_mfma_f32_16x16x32_bf16 v[72:75], a[224:227], a[4:7], v[72:75]
  s_mov_b32 s41, 2981888
  s_add_u32 m0, s42, 45056
  v_mfma_f32_16x16x32_bf16 v[72:75], a[228:231], a[20:23], v[72:75]
  v_mfma_f32_16x16x32_bf16 v[80:83], a[224:227], a[8:11], v[80:83]
  v_mfma_f32_16x16x32_bf16 v[80:83], a[228:231], a[24:27], v[80:83]
  v_mfma_f32_16x16x32_bf16 v[88:91], a[224:227], a[12:15], v[88:91]
  buffer_load_dwordx4 v226, s[12:15], s41 offen lds
  v_mfma_f32_16x16x32_bf16 v[88:91], a[228:231], a[28:31], v[88:91]
  ds_read_b64_tr_b16 a[224:225], v236 offset:8192
  s_mov_b32 s40, 21495808
  s_load_dwordx2 s[66:67], s[22:23], 0xa0000
  v_mfma_f32_16x16x32_bf16 v[68:71], a[232:235], a[0:3], v[68:71]
  ds_read_b64_tr_b16 a[226:227], v236 offset:10240
  v_mfma_f32_16x16x32_bf16 v[68:71], a[236:239], a[16:19], v[68:71]
  ds_read_b64_tr_b16 a[228:229], v236 offset:12288
  ds_read_b64_tr_b16 a[230:231], v236 offset:14336
  v_mfma_f32_16x16x32_bf16 v[76:79], a[232:235], a[4:7], v[76:79]
  v_mfma_f32_16x16x32_bf16 v[76:79], a[236:239], a[20:23], v[76:79]
  v_mfma_f32_16x16x32_bf16 v[84:87], a[232:235], a[8:11], v[84:87]
  buffer_load_dwordx4 a[64:67], v225, s[4:7], s40 offen offset:0 sc1
  v_mfma_f32_16x16x32_bf16 v[84:87], a[236:239], a[24:27], v[84:87]
  v_mfma_f32_16x16x32_bf16 v[92:95], a[232:235], a[12:15], v[92:95]
  ds_read_b64_tr_b16 a[232:233], v237 offset:8192
  v_mfma_f32_16x16x32_bf16 v[92:95], a[236:239], a[28:31], v[92:95]
  ds_read_b64_tr_b16 a[234:235], v237 offset:10240
  s_waitcnt lgkmcnt(13)
  v_mfma_f32_16x16x32_bf16 v[96:99], a[192:195], a[0:3], v[96:99]
  ds_read_b64_tr_b16 a[236:237], v237 offset:12288
  v_mfma_f32_16x16x32_bf16 v[96:99], a[196:199], a[16:19], v[96:99]
  ds_read_b64_tr_b16 a[238:239], v237 offset:14336
  v_mfma_f32_16x16x32_bf16 v[128:131], a[192:195], a[4:7], v[128:131]
  buffer_load_dwordx4 a[68:71], v225, s[4:7], s40 offen offset:1024 sc1
  v_mfma_f32_16x16x32_bf16 v[128:131], a[196:199], a[20:23], v[128:131]
  v_mfma_f32_16x16x32_bf16 v[160:163], a[192:195], a[8:11], v[160:163]
  v_mfma_f32_16x16x32_bf16 v[160:163], a[196:199], a[24:27], v[160:163]
  v_mfma_f32_16x16x32_bf16 v[192:195], a[192:195], a[12:15], v[192:195]
  ds_read_b64_tr_b16 a[192:193], v238 offset:8192
  v_mfma_f32_16x16x32_bf16 v[192:195], a[196:199], a[28:31], v[192:195]
  ds_read_b64_tr_b16 a[194:195], v238 offset:10240
  v_mfma_f32_16x16x32_bf16 v[100:103], a[200:203], a[0:3], v[100:103]
  buffer_load_dwordx4 a[72:75], v225, s[4:7], s40 offen offset:2048 sc1
  v_mfma_f32_16x16x32_bf16 v[100:103], a[204:207], a[16:19], v[100:103]
  ds_read_b64_tr_b16 a[196:197], v238 offset:12288
  ds_read_b64_tr_b16 a[198:199], v238 offset:14336
  v_mfma_f32_16x16x32_bf16 v[132:135], a[200:203], a[4:7], v[132:135]
  v_mfma_f32_16x16x32_bf16 v[132:135], a[204:207], a[20:23], v[132:135]
  s_mov_b32 s36, 5767168
  v_mfma_f32_16x16x32_bf16 v[164:167], a[200:203], a[8:11], v[164:167]
  buffer_load_dword v248, v247, s[56:59], s36 offen
  v_mfma_f32_16x16x32_bf16 v[164:167], a[204:207], a[24:27], v[164:167]
  s_load_dwordx2 s[66:67], s[22:23], 0xc0000
  v_mfma_f32_16x16x32_bf16 v[196:199], a[200:203], a[12:15], v[196:199]
  buffer_load_dwordx4 a[76:79], v225, s[4:7], s40 offen offset:3072 sc1
  v_mfma_f32_16x16x32_bf16 v[196:199], a[204:207], a[28:31], v[196:199]
  ds_read_b64_tr_b16 a[200:201], v239 offset:8192
  s_mov_b32 s40, 21626880
  s_waitcnt lgkmcnt(13)
  v_mfma_f32_16x16x32_bf16 v[104:107], a[208:211], a[0:3], v[104:107]
  ds_read_b64_tr_b16 a[202:203], v239 offset:10240
  v_mfma_f32_16x16x32_bf16 v[104:107], a[212:215], a[16:19], v[104:107]
  ds_read_b64_tr_b16 a[204:205], v239 offset:12288
  ds_read_b64_tr_b16 a[206:207], v239 offset:14336
  v_mfma_f32_16x16x32_bf16 v[136:139], a[208:211], a[4:7], v[136:139]
  v_mfma_f32_16x16x32_bf16 v[136:139], a[212:215], a[20:23], v[136:139]
  v_mfma_f32_16x16x32_bf16 v[168:171], a[208:211], a[8:11], v[168:171]
  buffer_load_dwordx4 a[80:83], v225, s[4:7], s40 offen offset:0 sc1
  v_mfma_f32_16x16x32_bf16 v[168:171], a[212:215], a[24:27], v[168:171]
  v_mfma_f32_16x16x32_bf16 v[200:203], a[208:211], a[12:15], v[200:203]
  ds_read_b64_tr_b16 a[208:209], v236 offset:16384
  v_mfma_f32_16x16x32_bf16 v[200:203], a[212:215], a[28:31], v[200:203]
  ds_read_b64_tr_b16 a[210:211], v236 offset:18432
  v_mfma_f32_16x16x32_bf16 v[108:111], a[216:219], a[0:3], v[108:111]
  ds_read_b64_tr_b16 a[212:213], v236 offset:20480
  v_mfma_f32_16x16x32_bf16 v[108:111], a[220:223], a[16:19], v[108:111]
  s_waitcnt vmcnt(23)
  s_barrier
  v_mfma_f32_16x16x32_bf16 v[140:143], a[216:219], a[4:7], v[140:143]
  buffer_load_dwordx4 a[84:87], v225, s[4:7], s40 offen offset:1024 sc1
  v_mfma_f32_16x16x32_bf16 v[140:143], a[220:223], a[20:23], v[140:143]
  ds_read_b64_tr_b16 a[214:215], v236 offset:22528
  v_mfma_f32_16x16x32_bf16 v[172:175], a[216:219], a[8:11], v[172:175]
  v_mfma_f32_16x16x32_bf16 v[172:175], a[220:223], a[24:27], v[172:175]
  v_mfma_f32_16x16x32_bf16 v[204:207], a[216:219], a[12:15], v[204:207]
  ds_read_b64_tr_b16 a[216:217], v237 offset:16384
  v_mfma_f32_16x16x32_bf16 v[204:207], a[220:223], a[28:31], v[204:207]
  ds_read_b64_tr_b16 a[218:219], v237 offset:18432
  s_waitcnt lgkmcnt(13)
  v_mfma_f32_16x16x32_bf16 v[112:115], a[224:227], a[0:3], v[112:115]
  buffer_load_dwordx4 a[88:91], v225, s[4:7], s40 offen offset:2048 sc1
  v_mfma_f32_16x16x32_bf16 v[112:115], a[228:231], a[16:19], v[112:115]
  ds_read_b64_tr_b16 a[220:221], v237 offset:20480
  ds_read_b64_tr_b16 a[222:223], v237 offset:22528
  v_mfma_f32_16x16x32_bf16 v[144:147], a[224:227], a[4:7], v[144:147]
  v_mfma_f32_16x16x32_bf16 v[144:147], a[228:231], a[20:23], v[144:147]
  s_load_dwordx2 s[66:67], s[22:23], 0xe0000
  s_add_u32 s22, s22, 0x100000
  s_addc_u32 s23, s23, 0
  v_mfma_f32_16x16x32_bf16 v[176:179], a[224:227], a[8:11], v[176:179]
  v_mfma_f32_16x16x32_bf16 v[176:179], a[228:231], a[24:27], v[176:179]
  v_mfma_f32_16x16x32_bf16 v[208:211], a[224:227], a[12:15], v[208:211]
  buffer_load_dwordx4 a[92:95], v225, s[4:7], s40 offen offset:3072 sc1
  v_mfma_f32_16x16x32_bf16 v[208:211], a[228:231], a[28:31], v[208:211]
  ds_read_b64_tr_b16 a[224:225], v236 offset:24576
  s_mov_b32 s41, 2752512
  v_mfma_f32_16x16x32_bf16 v[116:119], a[232:235], a[0:3], v[116:119]
  ds_read_b64_tr_b16 a[226:227], v236 offset:26624
  s_add_u32 m0, s42, 49152
  v_mfma_f32_16x16x32_bf16 v[116:119], a[236:239], a[16:19], v[116:119]
  ds_read_b64_tr_b16 a[228:229], v236 offset:28672
  ds_read_b64_tr_b16 a[230:231], v236 offset:30720
  v_mfma_f32_16x16x32_bf16 v[148:151], a[232:235], a[4:7], v[148:151]
  v_mfma_f32_16x16x32_bf16 v[148:151], a[236:239], a[20:23], v[148:151]
  v_mfma_f32_16x16x32_bf16 v[180:183], a[232:235], a[8:11], v[180:183]
  buffer_load_dwordx4 v226, s[16:19], s41 offen lds
  v_mfma_f32_16x16x32_bf16 v[180:183], a[236:239], a[24:27], v[180:183]
  s_mov_b32 s41, 2981888
  s_add_u32 m0, s42, 53248
  v_mfma_f32_16x16x32_bf16 v[212:215], a[232:235], a[12:15], v[212:215]
  ds_read_b64_tr_b16 a[232:233], v237 offset:24576
  v_mfma_f32_16x16x32_bf16 v[212:215], a[236:239], a[28:31], v[212:215]
  ds_read_b64_tr_b16 a[234:235], v237 offset:26624
  s_waitcnt lgkmcnt(13)
  v_mfma_f32_16x16x32_bf16 v[120:123], a[192:195], a[0:3], v[120:123]
  ds_read_b64_tr_b16 a[236:237], v237 offset:28672
  v_mfma_f32_16x16x32_bf16 v[120:123], a[196:199], a[16:19], v[120:123]
  ds_read_b64_tr_b16 a[238:239], v237 offset:30720
  v_mfma_f32_16x16x32_bf16 v[152:155], a[192:195], a[4:7], v[152:155]
  buffer_load_dwordx4 v226, s[16:19], s41 offen lds
  v_mfma_f32_16x16x32_bf16 v[152:155], a[196:199], a[20:23], v[152:155]
  s_mov_b32 s41, 3211264
  s_add_u32 m0, s42, 57344
  v_mfma_f32_16x16x32_bf16 v[184:187], a[192:195], a[8:11], v[184:187]
  v_mfma_f32_16x16x32_bf16 v[184:187], a[196:199], a[24:27], v[184:187]
  v_mfma_f32_16x16x32_bf16 v[216:219], a[192:195], a[12:15], v[216:219]
  ds_read_b64_tr_b16 a[192:193], v238 offset:16384
  v_mfma_f32_16x16x32_bf16 v[216:219], a[196:199], a[28:31], v[216:219]
  ds_read_b64_tr_b16 a[194:195], v238 offset:18432
  v_mfma_f32_16x16x32_bf16 v[124:127], a[200:203], a[0:3], v[124:127]
  buffer_load_dwordx4 v227, s[12:15], s41 offen lds
  v_mfma_f32_16x16x32_bf16 v[124:127], a[204:207], a[16:19], v[124:127]
  ds_read_b64_tr_b16 a[196:197], v238 offset:20480
  ds_read_b64_tr_b16 a[198:199], v238 offset:22528
  s_load_dwordx2 s[66:67], s[22:23], 0x0
  v_mfma_f32_16x16x32_bf16 v[156:159], a[200:203], a[4:7], v[156:159]
  s_mov_b32 s41, 3440640
  s_add_u32 m0, s42, 61440
  v_mfma_f32_16x16x32_bf16 v[156:159], a[204:207], a[20:23], v[156:159]
  v_mfma_f32_16x16x32_bf16 v[188:191], a[200:203], a[8:11], v[188:191]
  v_mfma_f32_16x16x32_bf16 v[188:191], a[204:207], a[24:27], v[188:191]
  v_mfma_f32_16x16x32_bf16 v[220:223], a[200:203], a[12:15], v[220:223]
  buffer_load_dwordx4 v227, s[12:15], s41 offen lds
  v_mfma_f32_16x16x32_bf16 v[220:223], a[204:207], a[28:31], v[220:223]
  ds_read_b64_tr_b16 a[200:201], v238 offset:24576
  s_mov_b32 s41, 3211264
  s_waitcnt vmcnt(25) lgkmcnt(13)
  v_mfma_f32_16x16x32_bf16 v[0:3], a[208:211], a[32:35], v[0:3]
  ds_read_b64_tr_b16 a[202:203], v238 offset:26624
  s_add_u32 m0, s42, 65536
  s_waitcnt vmcnt(21)
  v_mfma_f32_16x16x32_bf16 v[0:3], a[212:215], a[48:51], v[0:3]
  ds_read_b64_tr_b16 a[204:205], v238 offset:28672
  ds_read_b64_tr_b16 a[206:207], v238 offset:30720
  v_mfma_f32_16x16x32_bf16 v[16:19], a[208:211], a[36:39], v[16:19]
  v_mfma_f32_16x16x32_bf16 v[16:19], a[212:215], a[52:55], v[16:19]
  v_mfma_f32_16x16x32_bf16 v[32:35], a[208:211], a[40:43], v[32:35]
  buffer_load_dwordx4 v227, s[16:19], s41 offen lds
  v_mfma_f32_16x16x32_bf16 v[32:35], a[212:215], a[56:59], v[32:35]
  s_mov_b32 s41, 3440640
  s_add_u32 m0, s42, 69632
  v_mfma_f32_16x16x32_bf16 v[48:51], a[208:211], a[44:47], v[48:51]
  ds_read_b64_tr_b16 a[208:209], v228 offset:8192
  v_mfma_f32_16x16x32_bf16 v[48:51], a[212:215], a[60:63], v[48:51]
  ds_read_b64_tr_b16 a[210:211], v228 offset:10240
  v_mfma_f32_16x16x32_bf16 v[4:7], a[216:219], a[32:35], v[4:7]
  ds_read_b64_tr_b16 a[212:213], v228 offset:12288
  v_mfma_f32_16x16x32_bf16 v[4:7], a[220:223], a[48:51], v[4:7]
  ds_read_b64_tr_b16 a[214:215], v228 offset:14336
  v_mfma_f32_16x16x32_bf16 v[20:23], a[216:219], a[36:39], v[20:23]
  buffer_load_dwordx4 v227, s[16:19], s41 offen lds
  v_mfma_f32_16x16x32_bf16 v[20:23], a[220:223], a[52:55], v[20:23]
  s_mov_b32 s41, 3211264
  s_add_u32 m0, s42, 73728
  v_mfma_f32_16x16x32_bf16 v[36:39], a[216:219], a[40:43], v[36:39]
  v_mfma_f32_16x16x32_bf16 v[36:39], a[220:223], a[56:59], v[36:39]
  v_mfma_f32_16x16x32_bf16 v[52:55], a[216:219], a[44:47], v[52:55]
  ds_read_b64_tr_b16 a[216:217], v229 offset:8192
  v_mfma_f32_16x16x32_bf16 v[52:55], a[220:223], a[60:63], v[52:55]
  ds_read_b64_tr_b16 a[218:219], v229 offset:10240
  s_load_dwordx2 s[66:67], s[22:23], 0x20000
  s_waitcnt lgkmcnt(13)
  v_mfma_f32_16x16x32_bf16 v[8:11], a[224:227], a[32:35], v[8:11]
  buffer_load_dwordx4 v226, s[12:15], s41 offen lds
  v_mfma_f32_16x16x32_bf16 v[8:11], a[228:231], a[48:51], v[8:11]
  s_waitcnt vmcnt(20)
  s_barrier
  v_mfma_f32_16x16x32_bf16 v[24:27], a[224:227], a[36:39], v[24:27]
  ds_read_b64_tr_b16 a[220:221], v229 offset:12288
  ds_read_b64_tr_b16 a[222:223], v229 offset:14336
  v_mfma_f32_16x16x32_bf16 v[24:27], a[228:231], a[52:55], v[24:27]
  s_mov_b32 s41, 3440640
  s_add_u32 m0, s42, 77824
  v_mfma_f32_16x16x32_bf16 v[40:43], a[224:227], a[40:43], v[40:43]
  v_mfma_f32_16x16x32_bf16 v[40:43], a[228:231], a[56:59], v[40:43]
  v_mfma_f32_16x16x32_bf16 v[56:59], a[224:227], a[44:47], v[56:59]
  buffer_load_dwordx4 v226, s[12:15], s41 offen lds
  v_mfma_f32_16x16x32_bf16 v[56:59], a[228:231], a[60:63], v[56:59]
  ds_read_b64_tr_b16 a[224:225], v230 offset:8192
  s_mov_b32 s40, 21757952
  v_mfma_f32_16x16x32_bf16 v[12:15], a[232:235], a[32:35], v[12:15]
  ds_read_b64_tr_b16 a[226:227], v230 offset:10240
  v_mfma_f32_16x16x32_bf16 v[12:15], a[236:239], a[48:51], v[12:15]
  ds_read_b64_tr_b16 a[228:229], v230 offset:12288
  ds_read_b64_tr_b16 a[230:231], v230 offset:14336
  v_mfma_f32_16x16x32_bf16 v[28:31], a[232:235], a[36:39], v[28:31]
  v_mfma_f32_16x16x32_bf16 v[28:31], a[236:239], a[52:55], v[28:31]
  v_mfma_f32_16x16x32_bf16 v[44:47], a[232:235], a[40:43], v[44:47]
  buffer_load_dwordx4 a[96:99], v225, s[4:7], s40 offen offset:0 sc1
  v_mfma_f32_16x16x32_bf16 v[44:47], a[236:239], a[56:59], v[44:47]
  v_mfma_f32_16x16x32_bf16 v[60:63], a[232:235], a[44:47], v[60:63]
  ds_read_b64_tr_b16 a[232:233], v231 offset:8192
  v_mfma_f32_16x16x32_bf16 v[60:63], a[236:239], a[60:63], v[60:63]
  ds_read_b64_tr_b16 a[234:235], v231 offset:10240
  s_waitcnt lgkmcnt(13)
  v_mfma_f32_16x16x32_bf16 v[64:67], a[192:195], a[32:35], v[64:67]
  ds_read_b64_tr_b16 a[236:237], v231 offset:12288
  v_mfma_f32_16x16x32_bf16 v[64:67], a[196:199], a[48:51], v[64:67]
  ds_read_b64_tr_b16 a[238:239], v231 offset:14336
  v_mfma_f32_16x16x32_bf16 v[72:75], a[192:195], a[36:39], v[72:75]
  buffer_load_dwordx4 a[100:103], v225, s[4:7], s40 offen offset:1024 sc1
  v_mfma_f32_16x16x32_bf16 v[72:75], a[196:199], a[52:55], v[72:75]
  v_mfma_f32_16x16x32_bf16 v[80:83], a[192:195], a[40:43], v[80:83]
  v_mfma_f32_16x16x32_bf16 v[80:83], a[196:199], a[56:59], v[80:83]
  s_load_dwordx2 s[66:67], s[22:23], 0x40000
  v_mfma_f32_16x16x32_bf16 v[88:91], a[192:195], a[44:47], v[88:91]
  ds_read_b64_tr_b16 a[192:193], v228 offset:16384
  v_mfma_f32_16x16x32_bf16 v[88:91], a[196:199], a[60:63], v[88:91]
  ds_read_b64_tr_b16 a[194:195], v228 offset:18432
  v_mfma_f32_16x16x32_bf16 v[68:71], a[200:203], a[32:35], v[68:71]
  buffer_load_dwordx4 a[104:107], v225, s[4:7], s40 offen offset:2048 sc1
  v_mfma_f32_16x16x32_bf16 v[68:71], a[204:207], a[48:51], v[68:71]
  ds_read_b64_tr_b16 a[196:197], v228 offset:20480
  ds_read_b64_tr_b16 a[198:199], v228 offset:22528
  v_mfma_f32_16x16x32_bf16 v[76:79], a[200:203], a[36:39], v[76:79]
  v_mfma_f32_16x16x32_bf16 v[76:79], a[204:207], a[52:55], v[76:79]
  v_mfma_f32_16x16x32_bf16 v[84:87], a[200:203], a[40:43], v[84:87]
  v_mfma_f32_16x16x32_bf16 v[84:87], a[204:207], a[56:59], v[84:87]
  v_mfma_f32_16x16x32_bf16 v[92:95], a[200:203], a[44:47], v[92:95]
  buffer_load_dwordx4 a[108:111], v225, s[4:7], s40 offen offset:3072 sc1
  v_mfma_f32_16x16x32_bf16 v[92:95], a[204:207], a[60:63], v[92:95]
  ds_read_b64_tr_b16 a[200:201], v229 offset:16384
  s_mov_b32 s40, 21889024
  s_waitcnt lgkmcnt(13)
  v_mfma_f32_16x16x32_bf16 v[96:99], a[208:211], a[32:35], v[96:99]
  ds_read_b64_tr_b16 a[202:203], v229 offset:18432
  v_mfma_f32_16x16x32_bf16 v[96:99], a[212:215], a[48:51], v[96:99]
  ds_read_b64_tr_b16 a[204:205], v229 offset:20480
  ds_read_b64_tr_b16 a[206:207], v229 offset:22528
  v_mfma_f32_16x16x32_bf16 v[128:131], a[208:211], a[36:39], v[128:131]
  v_mfma_f32_16x16x32_bf16 v[128:131], a[212:215], a[52:55], v[128:131]
  v_mfma_f32_16x16x32_bf16 v[160:163], a[208:211], a[40:43], v[160:163]
  buffer_load_dwordx4 a[112:115], v225, s[4:7], s40 offen offset:0 sc1
  v_mfma_f32_16x16x32_bf16 v[160:163], a[212:215], a[56:59], v[160:163]
  v_mfma_f32_16x16x32_bf16 v[192:195], a[208:211], a[44:47], v[192:195]
  ds_read_b64_tr_b16 a[208:209], v230 offset:16384
  v_mfma_f32_16x16x32_bf16 v[192:195], a[212:215], a[60:63], v[192:195]
  ds_read_b64_tr_b16 a[210:211], v230 offset:18432
  v_mfma_f32_16x16x32_bf16 v[100:103], a[216:219], a[32:35], v[100:103]
  ds_read_b64_tr_b16 a[212:213], v230 offset:20480
  v_mfma_f32_16x16x32_bf16 v[100:103], a[220:223], a[48:51], v[100:103]
  ds_read_b64_tr_b16 a[214:215], v230 offset:22528
  v_mfma_f32_16x16x32_bf16 v[132:135], a[216:219], a[36:39], v[132:135]
  buffer_load_dwordx4 a[116:119], v225, s[4:7], s40 offen offset:1024 sc1
  v_mfma_f32_16x16x32_bf16 v[132:135], a[220:223], a[52:55], v[132:135]
  s_mov_b32 s36, 6291456
  s_load_dwordx2 s[66:67], s[22:23], 0x60000
  v_mfma_f32_16x16x32_bf16 v[164:167], a[216:219], a[40:43], v[164:167]
  buffer_load_dword v248, v247, s[56:59], s36 offen
  v_mfma_f32_16x16x32_bf16 v[164:167], a[220:223], a[56:59], v[164:167]
  v_mfma_f32_16x16x32_bf16 v[196:199], a[216:219], a[44:47], v[196:199]
  ds_read_b64_tr_b16 a[216:217], v231 offset:16384
  v_mfma_f32_16x16x32_bf16 v[196:199], a[220:223], a[60:63], v[196:199]
  ds_read_b64_tr_b16 a[218:219], v231 offset:18432
  s_waitcnt lgkmcnt(13)
  v_mfma_f32_16x16x32_bf16 v[104:107], a[224:227], a[32:35], v[104:107]
  buffer_load_dwordx4 a[120:123], v225, s[4:7], s40 offen offset:2048 sc1
  v_mfma_f32_16x16x32_bf16 v[104:107], a[228:231], a[48:51], v[104:107]
  ds_read_b64_tr_b16 a[220:221], v231 offset:20480
  ds_read_b64_tr_b16 a[222:223], v231 offset:22528
  v_mfma_f32_16x16x32_bf16 v[136:139], a[224:227], a[36:39], v[136:139]
  v_mfma_f32_16x16x32_bf16 v[136:139], a[228:231], a[52:55], v[136:139]
  v_mfma_f32_16x16x32_bf16 v[168:171], a[224:227], a[40:43], v[168:171]
  v_mfma_f32_16x16x32_bf16 v[168:171], a[228:231], a[56:59], v[168:171]
  v_mfma_f32_16x16x32_bf16 v[200:203], a[224:227], a[44:47], v[200:203]
  buffer_load_dwordx4 a[124:127], v225, s[4:7], s40 offen offset:3072 sc1
  v_mfma_f32_16x16x32_bf16 v[200:203], a[228:231], a[60:63], v[200:203]
  ds_read_b64_tr_b16 a[224:225], v228 offset:24576
  s_mov_b32 s41, 3211264
  v_mfma_f32_16x16x32_bf16 v[108:111], a[232:235], a[32:35], v[108:111]
  ds_read_b64_tr_b16 a[226:227], v228 offset:26624
  s_add_u32 m0, s42, 81920
  v_mfma_f32_16x16x32_bf16 v[108:111], a[236:239], a[48:51], v[108:111]
  s_waitcnt vmcnt(26)
  s_barrier
  v_mfma_f32_16x16x32_bf16 v[140:143], a[232:235], a[36:39], v[140:143]
  ds_read_b64_tr_b16 a[228:229], v228 offset:28672
  ds_read_b64_tr_b16 a[230:231], v228 offset:30720
  v_mfma_f32_16x16x32_bf16 v[140:143], a[236:239], a[52:55], v[140:143]
  v_mfma_f32_16x16x32_bf16 v[172:175], a[232:235], a[40:43], v[172:175]
  buffer_load_dwordx4 v226, s[16:19], s41 offen lds
  v_mfma_f32_16x16x32_bf16 v[172:175], a[236:239], a[56:59], v[172:175]
  s_mov_b32 s41, 3440640
  s_add_u32 m0, s42, 86016
  v_mfma_f32_16x16x32_bf16 v[204:207], a[232:235], a[44:47], v[204:207]
  ds_read_b64_tr_b16 a[232:233], v229 offset:24576
  v_mfma_f32_16x16x32_bf16 v[204:207], a[236:239], a[60:63], v[204:207]
  ds_read_b64_tr_b16 a[234:235], v229 offset:26624
  s_waitcnt lgkmcnt(13)
  v_mfma_f32_16x16x32_bf16 v[112:115], a[192:195], a[32:35], v[112:115]
  ds_read_b64_tr_b16 a[236:237], v229 offset:28672
  v_mfma_f32_16x16x32_bf16 v[112:115], a[196:199], a[48:51], v[112:115]
  ds_read_b64_tr_b16 a[238:239], v229 offset:30720
  s_load_dwordx2 s[66:67], s[22:23], 0x80000
  v_mfma_f32_16x16x32_bf16 v[144:147], a[192:195], a[36:39], v[144:147]
  buffer_load_dwordx4 v226, s[16:19], s41 offen lds
  v_mfma_f32_16x16x32_bf16 v[144:147], a[196:199], a[52:55], v[144:147]
  s_mov_b32 s41, 3670016
  s_add_u32 m0, s42, 90112
  v_mfma_f32_16x16x32_bf16 v[176:179], a[192:195], a[40:43], v[176:179]
  v_mfma_f32_16x16x32_bf16 v[176:179], a[196:199], a[56:59], v[176:179]
  v_mfma_f32_16x16x32_bf16 v[208:211], a[192:195], a[44:47], v[208:211]
  ds_read_b64_tr_b16 a[192:193], v228 offset:32768
  v_mfma_f32_16x16x32_bf16 v[208:211], a[196:199], a[60:63], v[208:211]
  ds_read_b64_tr_b16 a[194:195], v228 offset:34816
  v_mfma_f32_16x16x32_bf16 v[116:119], a[200:203], a[32:35], v[116:119]
  buffer_load_dwordx4 v227, s[12:15], s41 offen lds
  v_mfma_f32_16x16x32_bf16 v[116:119], a[204:207], a[48:51], v[116:119]
  ds_read_b64_tr_b16 a[196:197], v228 offset:36864
  ds_read_b64_tr_b16 a[198:199], v228 offset:38912
  v_mfma_f32_16x16x32_bf16 v[148:151], a[200:203], a[36:39], v[148:151]
  s_mov_b32 s41, 3899392
  s_add_u32 m0, s42, 94208
  v_mfma_f32_16x16x32_bf16 v[148:151], a[204:207], a[52:55], v[148:151]
  v_mfma_f32_16x16x32_bf16 v[180:183], a[200:203], a[40:43], v[180:183]
  v_mfma_f32_16x16x32_bf16 v[180:183], a[204:207], a[56:59], v[180:183]
  v_mfma_f32_16x16x32_bf16 v[212:215], a[200:203], a[44:47], v[212:215]
  buffer_load_dwordx4 v227, s[12:15], s41 offen lds
  v_mfma_f32_16x16x32_bf16 v[212:215], a[204:207], a[60:63], v[212:215]
  ds_read_b64_tr_b16 a[200:201], v229 offset:32768
  s_mov_b32 s41, 3670016
  s_waitcnt lgkmcnt(13)
  v_mfma_f32_16x16x32_bf16 v[120:123], a[208:211], a[32:35], v[120:123]
  ds_read_b64_tr_b16 a[202:203], v229 offset:34816
  s_add_u32 m0, s42, 98304
  v_mfma_f32_16x16x32_bf16 v[120:123], a[212:215], a[48:51], v[120:123]
  ds_read_b64_tr_b16 a[204:205], v229 offset:36864
  ds_read_b64_tr_b16 a[206:207], v229 offset:38912
  v_mfma_f32_16x16x32_bf16 v[152:155], a[208:211], a[36:39], v[152:155]
  v_mfma_f32_16x16x32_bf16 v[152:155], a[212:215], a[52:55], v[152:155]
  v_mfma_f32_16x16x32_bf16 v[184:187], a[208:211], a[40:43], v[184:187]
  buffer_load_dwordx4 v227, s[16:19], s41 offen lds
  v_mfma_f32_16x16x32_bf16 v[184:187], a[212:215], a[56:59], v[184:187]
  s_mov_b32 s41, 3899392
  s_add_u32 m0, s42, 102400
  v_mfma_f32_16x16x32_bf16 v[216:219], a[208:211], a[44:47], v[216:219]
  ds_read_b64_tr_b16 a[208:209], v230 offset:24576
  v_mfma_f32_16x16x32_bf16 v[216:219], a[212:215], a[60:63], v[216:219]
  ds_read_b64_tr_b16 a[210:211], v230 offset:26624
  s_load_dwordx2 s[66:67], s[22:23], 0xa0000
  v_mfma_f32_16x16x32_bf16 v[124:127], a[216:219], a[32:35], v[124:127]
  ds_read_b64_tr_b16 a[212:213], v230 offset:28672
  v_mfma_f32_16x16x32_bf16 v[124:127], a[220:223], a[48:51], v[124:127]
  ds_read_b64_tr_b16 a[214:215], v230 offset:30720
  v_mfma_f32_16x16x32_bf16 v[156:159], a[216:219], a[36:39], v[156:159]
  buffer_load_dwordx4 v227, s[16:19], s41 offen lds
  v_mfma_f32_16x16x32_bf16 v[156:159], a[220:223], a[52:55], v[156:159]
  v_mfma_f32_16x16x32_bf16 v[188:191], a[216:219], a[40:43], v[188:191]
  v_mfma_f32_16x16x32_bf16 v[188:191], a[220:223], a[56:59], v[188:191]
  v_mfma_f32_16x16x32_bf16 v[220:223], a[216:219], a[44:47], v[220:223]
  ds_read_b64_tr_b16 a[216:217], v230 offset:32768
  v_mfma_f32_16x16x32_bf16 v[220:223], a[220:223], a[60:63], v[220:223]
  ds_read_b64_tr_b16 a[218:219], v230 offset:34816
  s_mov_b32 s40, 22020096
  s_waitcnt vmcnt(27) lgkmcnt(13)
  v_mfma_f32_16x16x32_bf16 v[0:3], a[224:227], a[64:67], v[0:3]
  buffer_load_dwordx4 a[128:131], v225, s[4:7], s40 offen offset:0 sc1
  s_waitcnt vmcnt(24)
  v_mfma_f32_16x16x32_bf16 v[0:3], a[228:231], a[80:83], v[0:3]
  ds_read_b64_tr_b16 a[220:221], v230 offset:36864
  ds_read_b64_tr_b16 a[222:223], v230 offset:38912
  v_mfma_f32_16x16x32_bf16 v[16:19], a[224:227], a[68:71], v[16:19]
  v_mfma_f32_16x16x32_bf16 v[16:19], a[228:231], a[84:87], v[16:19]
  v_mfma_f32_16x16x32_bf16 v[32:35], a[224:227], a[72:75], v[32:35]
  v_mfma_f32_16x16x32_bf16 v[32:35], a[228:231], a[88:91], v[32:35]
  v_mfma_f32_16x16x32_bf16 v[48:51], a[224:227], a[76:79], v[48:51]
  buffer_load_dwordx4 a[132:135], v225, s[4:7], s40 offen offset:1024 sc1
  v_mfma_f32_16x16x32_bf16 v[48:51], a[228:231], a[92:95], v[48:51]
  ds_read_b64_tr_b16 a[224:225], v228 offset:40960
  v_mfma_f32_16x16x32_bf16 v[4:7], a[232:235], a[64:67], v[4:7]
  ds_read_b64_tr_b16 a[226:227], v228 offset:43008
  v_mfma_f32_16x16x32_bf16 v[4:7], a[236:239], a[80:83], v[4:7]
  ds_read_b64_tr_b16 a[228:229], v228 offset:45056
  ds_read_b64_tr_b16 a[230:231], v228 offset:47104
  v_mfma_f32_16x16x32_bf16 v[20:23], a[232:235], a[68:71], v[20:23]
  v_mfma_f32_16x16x32_bf16 v[20:23], a[236:239], a[84:87], v[20:23]
  v_mfma_f32_16x16x32_bf16 v[36:39], a[232:235], a[72:75], v[36:39]
  buffer_load_dwordx4 a[136:139], v225, s[4:7], s40 offen offset:2048 sc1
  v_mfma_f32_16x16x32_bf16 v[36:39], a[236:239], a[88:91], v[36:39]
  s_load_dwordx2 s[66:67], s[22:23], 0xc0000
  v_mfma_f32_16x16x32_bf16 v[52:55], a[232:235], a[76:79], v[52:55]
  ds_read_b64_tr_b16 a[232:233], v229 offset:40960
  v_mfma_f32_16x16x32_bf16 v[52:55], a[236:239], a[92:95], v[52:55]
  ds_read_b64_tr_b16 a[234:235], v229 offset:43008
  s_waitcnt lgkmcnt(13)
  v_mfma_f32_16x16x32_bf16 v[8:11], a[192:195], a[64:67], v[8:11]
  ds_read_b64_tr_b16 a[236:237], v229 offset:45056
  v_mfma_f32_16x16x32_bf16 v[8:11], a[196:199], a[80:83], v[8:11]
  s_waitcnt vmcnt(22)
  s_barrier
  v_mfma_f32_16x16x32_bf16 v[24:27], a[192:195], a[68:71], v[24:27]
  buffer_load_dwordx4 a[140:143], v225, s[4:7], s40 offen offset:3072 sc1
  v_mfma_f32_16x16x32_bf16 v[24:27], a[196:199], a[84:87], v[24:27]
  ds_read_b64_tr_b16 a[238:239], v229 offset:47104
  s_mov_b32 s41, 3670016
  v_mfma_f32_16x16x32_bf16 v[40:43], a[192:195], a[72:75], v[40:43]
  s_add_u32 m0, s42, 106496
  v_mfma_f32_16x16x32_bf16 v[40:43], a[196:199], a[88:91], v[40:43]
  v_mfma_f32_16x16x32_bf16 v[56:59], a[192:195], a[76:79], v[56:59]
  ds_read_b64_tr_b16 a[192:193], v230 offset:40960
  v_mfma_f32_16x16x32_bf16 v[56:59], a[196:199], a[92:95], v[56:59]
  ds_read_b64_tr_b16 a[194:195], v230 offset:43008
  v_mfma_f32_16x16x32_bf16 v[12:15], a[200:203], a[64:67], v[12:15]
  buffer_load_dwordx4 v226, s[12:15], s41 offen lds
  v_mfma_f32_16x16x32_bf16 v[12:15], a[204:207], a[80:83], v[12:15]
  ds_read_b64_tr_b16 a[196:197], v230 offset:45056
  ds_read_b64_tr_b16 a[198:199], v230 offset:47104
  v_mfma_f32_16x16x32_bf16 v[28:31], a[200:203], a[68:71], v[28:31]
  s_mov_b32 s41, 3899392
  s_add_u32 m0, s42, 110592
  v_mfma_f32_16x16x32_bf16 v[28:31], a[204:207], a[84:87], v[28:31]
  v_mfma_f32_16x16x32_bf16 v[44:47], a[200:203], a[72:75], v[44:47]
  v_mfma_f32_16x16x32_bf16 v[44:47], a[204:207], a[88:91], v[44:47]
  v_mfma_f32_16x16x32_bf16 v[60:63], a[200:203], a[76:79], v[60:63]
  buffer_load_dwordx4 v226, s[12:15], s41 offen lds
  v_mfma_f32_16x16x32_bf16 v[60:63], a[204:207], a[92:95], v[60:63]
  ds_read_b64_tr_b16 a[200:201], v231 offset:40960
  s_mov_b32 s40, 22151168
  s_waitcnt lgkmcnt(13)
  v_mfma_f32_16x16x32_bf16 v[64:67], a[208:211], a[64:67], v[64:67]
  ds_read_b64_tr_b16 a[202:203], v231 offset:43008
  v_mfma_f32_16x16x32_bf16 v[64:67], a[212:215], a[80:83], v[64:67]
  ds_read_b64_tr_b16 a[204:205], v231 offset:45056
  ds_read_b64_tr_b16 a[206:207], v231 offset:47104
  v_mfma_f32_16x16x32_bf16 v[72:75], a[208:211], a[68:71], v[72:75]
  v_mfma_f32_16x16x32_bf16 v[72:75], a[212:215], a[84:87], v[72:75]
  s_load_dwordx2 s[66:67], s[22:23], 0xe0000
  s_add_u32 s22, s22, 0x100000
  s_addc_u32 s23, s23, 0
  v_mfma_f32_16x16x32_bf16 v[80:83], a[208:211], a[72:75], v[80:83]
  buffer_load_dwordx4 a[144:147], v225, s[4:7], s40 offen offset:0 sc1
  v_mfma_f32_16x16x32_bf16 v[80:83], a[212:215], a[88:91], v[80:83]
  v_mfma_f32_16x16x32_bf16 v[88:91], a[208:211], a[76:79], v[88:91]
  ds_read_b64_tr_b16 a[208:209], v228 offset:49152
  v_mfma_f32_16x16x32_bf16 v[88:91], a[212:215], a[92:95], v[88:91]
  ds_read_b64_tr_b16 a[210:211], v228 offset:51200
  v_mfma_f32_16x16x32_bf16 v[68:71], a[216:219], a[64:67], v[68:71]
  ds_read_b64_tr_b16 a[212:213], v228 offset:53248
  v_mfma_f32_16x16x32_bf16 v[68:71], a[220:223], a[80:83], v[68:71]
  ds_read_b64_tr_b16 a[214:215], v228 offset:55296
  v_mfma_f32_16x16x32_bf16 v[76:79], a[216:219], a[68:71], v[76:79]
  buffer_load_dwordx4 a[148:151], v225, s[4:7], s40 offen offset:1024 sc1
  v_mfma_f32_16x16x32_bf16 v[76:79], a[220:223], a[84:87], v[76:79]
  v_mfma_f32_16x16x32_bf16 v[84:87], a[216:219], a[72:75], v[84:87]
  v_mfma_f32_16x16x32_bf16 v[84:87], a[220:223], a[88:91], v[84:87]
  v_mfma_f32_16x16x32_bf16 v[92:95], a[216:219], a[76:79], v[92:95]
  ds_read_b64_tr_b16 a[216:217], v229 offset:49152
  v_mfma_f32_16x16x32_bf16 v[92:95], a[220:223], a[92:95], v[92:95]
  ds_read_b64_tr_b16 a[218:219], v229 offset:51200
  s_waitcnt lgkmcnt(13)
  v_mfma_f32_16x16x32_bf16 v[96:99], a[224:227], a[64:67], v[96:99]
  buffer_load_dwordx4 a[152:155], v225, s[4:7], s40 offen offset:2048 sc1
  v_mfma_f32_16x16x32_bf16 v[96:99], a[228:231], a[80:83], v[96:99]
  ds_read_b64_tr_b16 a[220:221], v229 offset:53248
  ds_read_b64_tr_b16 a[222:223], v229 offset:55296
  v_mfma_f32_16x16x32_bf16 v[128:131], a[224:227], a[68:71], v[128:131]
  v_mfma_f32_16x16x32_bf16 v[128:131], a[228:231], a[84:87], v[128:131]
  v_mfma_f32_16x16x32_bf16 v[160:163], a[224:227], a[72:75], v[160:163]
  v_mfma_f32_16x16x32_bf16 v[160:163], a[228:231], a[88:91], v[160:163]
  v_mfma_f32_16x16x32_bf16 v[192:195], a[224:227], a[76:79], v[192:195]
  buffer_load_dwordx4 a[156:159], v225, s[4:7], s40 offen offset:3072 sc1
  v_mfma_f32_16x16x32_bf16 v[192:195], a[228:231], a[92:95], v[192:195]
  ds_read_b64_tr_b16 a[224:225], v230 offset:49152
  s_mov_b32 s41, 3670016
  v_mfma_f32_16x16x32_bf16 v[100:103], a[232:235], a[64:67], v[100:103]
  ds_read_b64_tr_b16 a[226:227], v230 offset:51200
  s_add_u32 m0, s42, 114688
  v_mfma_f32_16x16x32_bf16 v[100:103], a[236:239], a[80:83], v[100:103]
  ds_read_b64_tr_b16 a[228:229], v230 offset:53248
  ds_read_b64_tr_b16 a[230:231], v230 offset:55296
  s_load_dwordx2 s[66:67], s[22:23], 0x0
  v_mfma_f32_16x16x32_bf16 v[132:135], a[232:235], a[68:71], v[132:135]
  v_mfma_f32_16x16x32_bf16 v[132:135], a[236:239], a[84:87], v[132:135]
  s_mov_b32 s36, 6815744
  v_mfma_f32_16x16x32_bf16 v[164:167], a[232:235], a[72:75], v[164:167]
  buffer_load_dwordx4 v226, s[16:19], s41 offen lds
L_wk0_3:
  s_cbranch_vccnz L_wk0_7
  v_mfma_f32_16x16x32_bf16 v[164:167], a[236:239], a[88:91], v[164:167]
  s_mov_b32 s41, 3899392
  s_add_u32 m0, s42, 118784
  v_mfma_f32_16x16x32_bf16 v[196:199], a[232:235], a[76:79], v[196:199]
  ds_read_b64_tr_b16 a[232:233], v231 offset:49152
  v_mfma_f32_16x16x32_bf16 v[196:199], a[236:239], a[92:95], v[196:199]
  ds_read_b64_tr_b16 a[234:235], v231 offset:51200
  s_waitcnt lgkmcnt(13)
  v_mfma_f32_16x16x32_bf16 v[104:107], a[192:195], a[64:67], v[104:107]
  ds_read_b64_tr_b16 a[236:237], v231 offset:53248
  v_mfma_f32_16x16x32_bf16 v[104:107], a[196:199], a[80:83], v[104:107]
  ds_read_b64_tr_b16 a[238:239], v231 offset:55296
  v_mfma_f32_16x16x32_bf16 v[136:139], a[192:195], a[68:71], v[136:139]
  buffer_load_dwordx4 v226, s[16:19], s41 offen lds
  v_mfma_f32_16x16x32_bf16 v[136:139], a[196:199], a[84:87], v[136:139]
  buffer_load_dword v248, v247, s[56:59], s36 offen
  v_mfma_f32_16x16x32_bf16 v[168:171], a[192:195], a[72:75], v[168:171]
  v_mfma_f32_16x16x32_bf16 v[168:171], a[196:199], a[88:91], v[168:171]
  v_mfma_f32_16x16x32_bf16 v[200:203], a[192:195], a[76:79], v[200:203]
  ds_read_b64_tr_b16 a[192:193], v228 offset:57344
  s_mov_b32 s41, 4128768
  v_mfma_f32_16x16x32_bf16 v[200:203], a[196:199], a[92:95], v[200:203]
  ds_read_b64_tr_b16 a[194:195], v228 offset:59392
  s_add_u32 m0, s42, 122880
  v_mfma_f32_16x16x32_bf16 v[108:111], a[200:203], a[64:67], v[108:111]
  buffer_load_dwordx4 v227, s[12:15], s41 offen lds
  v_mfma_f32_16x16x32_bf16 v[108:111], a[204:207], a[80:83], v[108:111]
  s_waitcnt vmcnt(29)
  s_barrier
  v_mfma_f32_16x16x32_bf16 v[140:143], a[200:203], a[68:71], v[140:143]
  ds_read_b64_tr_b16 a[196:197], v228 offset:61440
  ds_read_b64_tr_b16 a[198:199], v228 offset:63488
  v_mfma_f32_16x16x32_bf16 v[140:143], a[204:207], a[84:87], v[140:143]
  s_mov_b32 s41, 4358144
  s_add_u32 m0, s42, 126976
  v_mfma_f32_16x16x32_bf16 v[172:175], a[200:203], a[72:75], v[172:175]
  v_mfma_f32_16x16x32_bf16 v[172:175], a[204:207], a[88:91], v[172:175]
  v_mfma_f32_16x16x32_bf16 v[204:207], a[200:203], a[76:79], v[204:207]
  buffer_load_dwordx4 v227, s[12:15], s41 offen lds
  v_mfma_f32_16x16x32_bf16 v[204:207], a[204:207], a[92:95], v[204:207]
  ds_read_b64_tr_b16 a[200:201], v229 offset:57344
  s_load_dwordx2 s[66:67], s[22:23], 0x20000
  s_waitcnt lgkmcnt(13)
  v_mfma_f32_16x16x32_bf16 v[112:115], a[208:211], a[64:67], v[112:115]
  ds_read_b64_tr_b16 a[202:203], v229 offset:59392
  v_mfma_f32_16x16x32_bf16 v[112:115], a[212:215], a[80:83], v[112:115]
  ds_read_b64_tr_b16 a[204:205], v229 offset:61440
  ds_read_b64_tr_b16 a[206:207], v229 offset:63488
  v_mfma_f32_16x16x32_bf16 v[144:147], a[208:211], a[68:71], v[144:147]
  v_mfma_f32_16x16x32_bf16 v[144:147], a[212:215], a[84:87], v[144:147]
  v_mfma_f32_16x16x32_bf16 v[176:179], a[208:211], a[72:75], v[176:179]
  v_mfma_f32_16x16x32_bf16 v[176:179], a[212:215], a[88:91], v[176:179]
  v_mfma_f32_16x16x32_bf16 v[208:211], a[208:211], a[76:79], v[208:211]
  ds_read_b64_tr_b16 a[208:209], v232 offset:0
  s_mov_b32 s41, 4128768
  v_mfma_f32_16x16x32_bf16 v[208:211], a[212:215], a[92:95], v[208:211]
  ds_read_b64_tr_b16 a[210:211], v232 offset:2048
  s_add_u32 m0, s42, 131072
  v_mfma_f32_16x16x32_bf16 v[116:119], a[216:219], a[64:67], v[116:119]
  buffer_load_dwordx4 v227, s[16:19], s41 offen lds
  v_mfma_f32_16x16x32_bf16 v[116:119], a[220:223], a[80:83], v[116:119]
  ds_read_b64_tr_b16 a[212:213], v232 offset:4096
  ds_read_b64_tr_b16 a[214:215], v232 offset:6144
  v_mfma_f32_16x16x32_bf16 v[148:151], a[216:219], a[68:71], v[148:151]
  s_mov_b32 s41, 4358144
  s_add_u32 m0, s42, 135168
  v_mfma_f32_16x16x32_bf16 v[148:151], a[220:223], a[84:87], v[148:151]
  s_getpc_b64 s[30:31]
L_pc_45:
  s_lshr_b32 s32, s2, 3
  v_mfma_f32_16x16x32_bf16 v[180:183], a[216:219], a[72:75], v[180:183]
  s_lshl_b32 s32, s32, 2
  s_add_u32 s32, s32, s3
  v_mfma_f32_16x16x32_bf16 v[180:183], a[220:223], a[88:91], v[180:183]
  buffer_load_dwordx4 v227, s[16:19], s41 offen lds
  v_mfma_f32_16x16x32_bf16 v[212:215], a[216:219], a[76:79], v[212:215]
  ds_read_b64_tr_b16 a[216:217], v233 offset:0
  s_lshl_b32 s32, s32, 13
  v_mfma_f32_16x16x32_bf16 v[212:215], a[220:223], a[92:95], v[212:215]
  ds_read_b64_tr_b16 a[218:219], v233 offset:2048
  v_lshlrev_b32 v244, 7, v224
  s_waitcnt lgkmcnt(13)
  v_mfma_f32_16x16x32_bf16 v[120:123], a[224:227], a[64:67], v[120:123]
  ds_read_b64_tr_b16 a[220:221], v233 offset:4096
  v_add_u32 v244, s32, v244
  v_mfma_f32_16x16x32_bf16 v[120:123], a[228:231], a[80:83], v[120:123]
  ds_read_b64_tr_b16 a[222:223], v233 offset:6144
  v_min_u32 v244, L_code_end-L_pc_45-4, v244
  v_mfma_f32_16x16x32_bf16 v[152:155], a[224:227], a[68:71], v[152:155]
  global_load_dword v248, v244, s[30:31]
  v_mfma_f32_16x16x32_bf16 v[152:155], a[228:231], a[84:87], v[152:155]
  v_mfma_f32_16x16x32_bf16 v[184:187], a[224:227], a[72:75], v[184:187]
  v_mfma_f32_16x16x32_bf16 v[184:187], a[228:231], a[88:91], v[184:187]
  s_load_dwordx2 s[66:67], s[22:23], 0x40000
  v_mfma_f32_16x16x32_bf16 v[216:219], a[224:227], a[76:79], v[216:219]
  ds_read_b64_tr_b16 a[224:225], v230 offset:57344
  v_mfma_f32_16x16x32_bf16 v[216:219], a[228:231], a[92:95], v[216:219]
  ds_read_b64_tr_b16 a[226:227], v230 offset:59392
  v_mfma_f32_16x16x32_bf16 v[124:127], a[232:235], a[64:67], v[124:127]
  ds_read_b64_tr_b16 a[228:229], v230 offset:61440
  v_mfma_f32_16x16x32_bf16 v[124:127], a[236:239], a[80:83], v[124:127]
  ds_read_b64_tr_b16 a[230:231], v230 offset:63488
  v_mfma_f32_16x16x32_bf16 v[156:159], a[232:235], a[68:71], v[156:159]
  v_mfma_f32_16x16x32_bf16 v[156:159], a[236:239], a[84:87], v[156:159]
  v_mfma_f32_16x16x32_bf16 v[188:191], a[232:235], a[72:75], v[188:191]
  v_mfma_f32_16x16x32_bf16 v[188:191], a[236:239], a[88:91], v[188:191]
  v_mfma_f32_16x16x32_bf16 v[220:223], a[232:235], a[76:79], v[220:223]
  ds_read_b64_tr_b16 a[232:233], v234 offset:0
  v_mfma_f32_16x16x32_bf16 v[220:223], a[236:239], a[92:95], v[220:223]
  ds_read_b64_tr_b16 a[234:235], v234 offset:2048
  s_mov_b32 s40, 22282240
  s_waitcnt vmcnt(29) lgkmcnt(13)
  v_mfma_f32_16x16x32_bf16 v[0:3], a[192:195], a[96:99], v[0:3]
  buffer_load_dwordx4 a[160:163], v225, s[4:7], s40 offen offset:0 sc1
  s_waitcnt vmcnt(25)
  v_mfma_f32_16x16x32_bf16 v[0:3], a[196:199], a[112:115], v[0:3]
  ds_read_b64_tr_b16 a[236:237], v234 offset:4096
  ds_read_b64_tr_b16 a[238:239], v234 offset:6144
  v_mfma_f32_16x16x32_bf16 v[16:19], a[192:195], a[100:103], v[16:19]
  v_mfma_f32_16x16x32_bf16 v[16:19], a[196:199], a[116:119], v[16:19]
  v_mfma_f32_16x16x32_bf16 v[32:35], a[192:195], a[104:107], v[32:35]
  v_mfma_f32_16x16x32_bf16 v[32:35], a[196:199], a[120:123], v[32:35]
  buffer_load_dwordx4 a[164:167], v225, s[4:7], s40 offen offset:1024 sc1
  v_mfma_f32_16x16x32_bf16 v[48:51], a[192:195], a[108:111], v[48:51]
  ds_read_b64_tr_b16 a[192:193], v232 offset:8192
  v_mfma_f32_16x16x32_bf16 v[48:51], a[196:199], a[124:127], v[48:51]
  ds_read_b64_tr_b16 a[194:195], v232 offset:10240
  v_mfma_f32_16x16x32_bf16 v[4:7], a[200:203], a[96:99], v[4:7]
  ds_read_b64_tr_b16 a[196:197], v232 offset:12288
  v_mfma_f32_16x16x32_bf16 v[4:7], a[204:207], a[112:115], v[4:7]
  ds_read_b64_tr_b16 a[198:199], v232 offset:14336
  v_mfma_f32_16x16x32_bf16 v[20:23], a[200:203], a[100:103], v[20:23]
  v_mfma_f32_16x16x32_bf16 v[20:23], a[204:207], a[116:119], v[20:23]
  buffer_load_dwordx4 a[168:171], v225, s[4:7], s40 offen offset:2048 sc1
  s_load_dwordx2 s[66:67], s[22:23], 0x60000
  v_mfma_f32_16x16x32_bf16 v[36:39], a[200:203], a[104:107], v[36:39]
  v_mfma_f32_16x16x32_bf16 v[36:39], a[204:207], a[120:123], v[36:39]
  v_mfma_f32_16x16x32_bf16 v[52:55], a[200:203], a[108:111], v[52:55]
  ds_read_b64_tr_b16 a[200:201], v233 offset:8192
  v_mfma_f32_16x16x32_bf16 v[52:55], a[204:207], a[124:127], v[52:55]
  ds_read_b64_tr_b16 a[202:203], v233 offset:10240
  s_waitcnt lgkmcnt(13)
  v_mfma_f32_16x16x32_bf16 v[8:11], a[208:211], a[96:99], v[8:11]
  ds_read_b64_tr_b16 a[204:205], v233 offset:12288
  v_mfma_f32_16x16x32_bf16 v[8:11], a[212:215], a[112:115], v[8:11]
  s_waitcnt vmcnt(23)
  s_barrier
  v_mfma_f32_16x16x32_bf16 v[24:27], a[208:211], a[100:103], v[24:27]
  buffer_load_dwordx4 a[172:175], v225, s[4:7], s40 offen offset:3072 sc1
  v_mfma_f32_16x16x32_bf16 v[24:27], a[212:215], a[116:119], v[24:27]
  ds_read_b64_tr_b16 a[206:207], v233 offset:14336
  s_mov_b32 s41, 4128768
  v_mfma_f32_16x16x32_bf16 v[40:43], a[208:211], a[104:107], v[40:43]
  s_add_u32 m0, s42, 139264
  v_mfma_f32_16x16x32_bf16 v[40:43], a[212:215], a[120:123], v[40:43]
  v_mfma_f32_16x16x32_bf16 v[56:59], a[208:211], a[108:111], v[56:59]
  ds_read_b64_tr_b16 a[208:209], v234 offset:8192
  v_mfma_f32_16x16x32_bf16 v[56:59], a[212:215], a[124:127], v[56:59]
  buffer_load_dwordx4 v226, s[12:15], s41 offen lds
  v_mfma_f32_16x16x32_bf16 v[12:15], a[216:219], a[96:99], v[12:15]
  ds_read_b64_tr_b16 a[210:211], v234 offset:10240
  s_mov_b32 s41, 4358144
  v_mfma_f32_16x16x32_bf16 v[12:15], a[220:223], a[112:115], v[12:15]
  ds_read_b64_tr_b16 a[212:213], v234 offset:12288
  ds_read_b64_tr_b16 a[214:215], v234 offset:14336
  v_mfma_f32_16x16x32_bf16 v[28:31], a[216:219], a[100:103], v[28:31]
  s_add_u32 m0, s42, 143360
  v_mfma_f32_16x16x32_bf16 v[28:31], a[220:223], a[116:119], v[28:31]
  v_mfma_f32_16x16x32_bf16 v[44:47], a[216:219], a[104:107], v[44:47]
  v_mfma_f32_16x16x32_bf16 v[44:47], a[220:223], a[120:123], v[44:47]
  buffer_load_dwordx4 v226, s[12:15], s41 offen lds
  v_mfma_f32_16x16x32_bf16 v[60:63], a[216:219], a[108:111], v[60:63]
  ds_read_b64_tr_b16 a[216:217], v235 offset:8192
  s_mov_b32 s40, 22413312
  v_mfma_f32_16x16x32_bf16 v[60:63], a[220:223], a[124:127], v[60:63]
  ds_read_b64_tr_b16 a[218:219], v235 offset:10240
  s_waitcnt lgkmcnt(13)
  v_mfma_f32_16x16x32_bf16 v[64:67], a[224:227], a[96:99], v[64:67]
  ds_read_b64_tr_b16 a[220:221], v235 offset:12288
  v_mfma_f32_16x16x32_bf16 v[64:67], a[228:231], a[112:115], v[64:67]
  ds_read_b64_tr_b16 a[222:223], v235 offset:14336
  s_load_dwordx2 s[66:67], s[22:23], 0x80000
  v_mfma_f32_16x16x32_bf16 v[72:75], a[224:227], a[100:103], v[72:75]
  v_mfma_f32_16x16x32_bf16 v[72:75], a[228:231], a[116:119], v[72:75]
  buffer_load_dwordx4 a[176:179], v225, s[4:7], s40 offen offset:0 sc1
  v_mfma_f32_16x16x32_bf16 v[80:83], a[224:227], a[104:107], v[80:83]
  v_mfma_f32_16x16x32_bf16 v[80:83], a[228:231], a[120:123], v[80:83]
  v_mfma_f32_16x16x32_bf16 v[88:91], a[224:227], a[108:111], v[88:91]
  ds_read_b64_tr_b16 a[224:225], v232 offset:16384
  v_mfma_f32_16x16x32_bf16 v[88:91], a[228:231], a[124:127], v[88:91]
  ds_read_b64_tr_b16 a[226:227], v232 offset:18432
  v_mfma_f32_16x16x32_bf16 v[68:71], a[232:235], a[96:99], v[68:71]
  ds_read_b64_tr_b16 a[228:229], v232 offset:20480
  v_mfma_f32_16x16x32_bf16 v[68:71], a[236:239], a[112:115], v[68:71]
  buffer_load_dwordx4 a[180:183], v225, s[4:7], s40 offen offset:1024 sc1
  v_mfma_f32_16x16x32_bf16 v[76:79], a[232:235], a[100:103], v[76:79]
  ds_read_b64_tr_b16 a[230:231], v232 offset:22528
  v_mfma_f32_16x16x32_bf16 v[76:79], a[236:239], a[116:119], v[76:79]
  v_mfma_f32_16x16x32_bf16 v[84:87], a[232:235], a[104:107], v[84:87]
  v_mfma_f32_16x16x32_bf16 v[84:87], a[236:239], a[120:123], v[84:87]
  v_mfma_f32_16x16x32_bf16 v[92:95], a[232:235], a[108:111], v[92:95]
  ds_read_b64_tr_b16 a[232:233], v233 offset:16384
  v_mfma_f32_16x16x32_bf16 v[92:95], a[236:239], a[124:127], v[92:95]
  buffer_load_dwordx4 a[184:187], v225, s[4:7], s40 offen offset:2048 sc1
  s_waitcnt lgkmcnt(13)
  v_mfma_f32_16x16x32_bf16 v[96:99], a[192:195], a[96:99], v[96:99]
  ds_read_b64_tr_b16 a[234:235], v233 offset:18432
  v_mfma_f32_16x16x32_bf16 v[96:99], a[196:199], a[112:115], v[96:99]
  ds_read_b64_tr_b16 a[236:237], v233 offset:20480
  ds_read_b64_tr_b16 a[238:239], v233 offset:22528
  v_mfma_f32_16x16x32_bf16 v[128:131], a[192:195], a[100:103], v[128:131]
  v_mfma_f32_16x16x32_bf16 v[128:131], a[196:199], a[116:119], v[128:131]
  v_mfma_f32_16x16x32_bf16 v[160:163], a[192:195], a[104:107], v[160:163]
  v_mfma_f32_16x16x32_bf16 v[160:163], a[196:199], a[120:123], v[160:163]
  buffer_load_dwordx4 a[188:191], v225, s[4:7], s40 offen offset:3072 sc1
  v_mfma_f32_16x16x32_bf16 v[192:195], a[192:195], a[108:111], v[192:195]
  ds_read_b64_tr_b16 a[192:193], v234 offset:16384
  s_mov_b32 s41, 4128768
  v_mfma_f32_16x16x32_bf16 v[192:195], a[196:199], a[124:127], v[192:195]
  ds_read_b64_tr_b16 a[194:195], v234 offset:18432
  s_add_u32 m0, s42, 147456
  s_load_dwordx2 s[66:67], s[22:23], 0xa0000
  v_mfma_f32_16x16x32_bf16 v[100:103], a[200:203], a[96:99], v[100:103]
  ds_read_b64_tr_b16 a[196:197], v234 offset:20480
  v_mfma_f32_16x16x32_bf16 v[100:103], a[204:207], a[112:115], v[100:103]
  ds_read_b64_tr_b16 a[198:199], v234 offset:22528
  v_mfma_f32_16x16x32_bf16 v[132:135], a[200:203], a[100:103], v[132:135]
  v_mfma_f32_16x16x32_bf16 v[132:135], a[204:207], a[116:119], v[132:135]
  buffer_load_dwordx4 v226, s[16:19], s41 offen lds
  v_mfma_f32_16x16x32_bf16 v[164:167], a[200:203], a[104:107], v[164:167]
  s_mov_b32 s41, 4358144
  s_add_u32 m0, s42, 151552
  v_mfma_f32_16x16x32_bf16 v[164:167], a[204:207], a[120:123], v[164:167]
  v_mfma_f32_16x16x32_bf16 v[196:199], a[200:203], a[108:111], v[196:199]
  ds_read_b64_tr_b16 a[200:201], v235 offset:16384
  v_mfma_f32_16x16x32_bf16 v[196:199], a[204:207], a[124:127], v[196:199]
  ds_read_b64_tr_b16 a[202:203], v235 offset:18432
  s_waitcnt lgkmcnt(13)
  v_mfma_f32_16x16x32_bf16 v[104:107], a[208:211], a[96:99], v[104:107]
  ds_read_b64_tr_b16 a[204:205], v235 offset:20480
  v_mfma_f32_16x16x32_bf16 v[104:107], a[212:215], a[112:115], v[104:107]
  buffer_load_dwordx4 v226, s[16:19], s41 offen lds
  v_mfma_f32_16x16x32_bf16 v[136:139], a[208:211], a[100:103], v[136:139]
  ds_read_b64_tr_b16 a[206:207], v235 offset:22528
  v_mfma_f32_16x16x32_bf16 v[136:139], a[212:215], a[116:119], v[136:139]
  v_mfma_f32_16x16x32_bf16 v[168:171], a[208:211], a[104:107], v[168:171]
  v_mfma_f32_16x16x32_bf16 v[168:171], a[212:215], a[120:123], v[168:171]
  v_mfma_f32_16x16x32_bf16 v[200:203], a[208:211], a[108:111], v[200:203]
  ds_read_b64_tr_b16 a[208:209], v232 offset:24576
  s_mov_b32 s41, 4587520
  v_mfma_f32_16x16x32_bf16 v[200:203], a[212:215], a[124:127], v[200:203]
  ds_read_b64_tr_b16 a[210:211], v232 offset:26624
  s_add_u32 m0, s42, 155648
  v_mfma_f32_16x16x32_bf16 v[108:111], a[216:219], a[96:99], v[108:111]
  buffer_load_dwordx4 v227, s[12:15], s41 offen lds
  v_mfma_f32_16x16x32_bf16 v[108:111], a[220:223], a[112:115], v[108:111]
  s_waitcnt vmcnt(25)
  s_barrier
  v_mfma_f32_16x16x32_bf16 v[140:143], a[216:219], a[100:103], v[140:143]
  ds_read_b64_tr_b16 a[212:213], v232 offset:28672
  ds_read_b64_tr_b16 a[214:215], v232 offset:30720
  v_mfma_f32_16x16x32_bf16 v[140:143], a[220:223], a[116:119], v[140:143]
  s_mov_b32 s41, 4816896
  s_add_u32 m0, s42, 159744
  v_mfma_f32_16x16x32_bf16 v[172:175], a[216:219], a[104:107], v[172:175]
  v_mfma_f32_16x16x32_bf16 v[172:175], a[220:223], a[120:123], v[172:175]
  buffer_load_dwordx4 v227, s[12:15], s41 offen lds
  s_load_dwordx2 s[66:67], s[22:23], 0xc0000
  v_mfma_f32_16x16x32_bf16 v[204:207], a[216:219], a[108:111], v[204:207]
  ds_read_b64_tr_b16 a[216:217], v233 offset:24576
  v_mfma_f32_16x16x32_bf16 v[204:207], a[220:223], a[124:127], v[204:207]
  ds_read_b64_tr_b16 a[218:219], v233 offset:26624
  s_waitcnt lgkmcnt(13)
  v_mfma_f32_16x16x32_bf16 v[112:115], a[224:227], a[96:99], v[112:115]
  ds_read_b64_tr_b16 a[220:221], v233 offset:28672
  v_mfma_f32_16x16x32_bf16 v[112:115], a[228:231], a[112:115], v[112:115]
  ds_read_b64_tr_b16 a[222:223], v233 offset:30720
  v_mfma_f32_16x16x32_bf16 v[144:147], a[224:227], a[100:103], v[144:147]
  v_mfma_f32_16x16x32_bf16 v[144:147], a[228:231], a[116:119], v[144:147]
  v_mfma_f32_16x16x32_bf16 v[176:179], a[224:227], a[104:107], v[176:179]
  v_mfma_f32_16x16x32_bf16 v[176:179], a[228:231], a[120:123], v[176:179]
  v_mfma_f32_16x16x32_bf16 v[208:211], a[224:227], a[108:111], v[208:211]
  ds_read_b64_tr_b16 a[224:225], v232 offset:32768
  s_mov_b32 s41, 4587520
  v_mfma_f32_16x16x32_bf16 v[208:211], a[228:231], a[124:127], v[208:211]
  ds_read_b64_tr_b16 a[226:227], v232 offset:34816
  s_add_u32 m0, s42, 8192
  v_mfma_f32_16x16x32_bf16 v[116:119], a[232:235], a[96:99], v[116:119]
  buffer_load_dwordx4 v227, s[16:19], s41 offen lds
  v_mfma_f32_16x16x32_bf16 v[116:119], a[236:239], a[112:115], v[116:119]
  ds_read_b64_tr_b16 a[228:229], v232 offset:36864
  ds_read_b64_tr_b16 a[230:231], v232 offset:38912
  v_mfma_f32_16x16x32_bf16 v[148:151], a[232:235], a[100:103], v[148:151]
  s_mov_b32 s41, 4816896
  s_add_u32 m0, s42, 12288
  v_mfma_f32_16x16x32_bf16 v[148:151], a[236:239], a[116:119], v[148:151]
  v_mfma_f32_16x16x32_bf16 v[180:183], a[232:235], a[104:107], v[180:183]
  v_mfma_f32_16x16x32_bf16 v[180:183], a[236:239], a[120:123], v[180:183]
  buffer_load_dwordx4 v227, s[16:19], s41 offen lds
  v_mfma_f32_16x16x32_bf16 v[212:215], a[232:235], a[108:111], v[212:215]
  ds_read_b64_tr_b16 a[232:233], v233 offset:32768
  v_mfma_f32_16x16x32_bf16 v[212:215], a[236:239], a[124:127], v[212:215]
  ds_read_b64_tr_b16 a[234:235], v233 offset:34816
  s_waitcnt lgkmcnt(13)
  v_mfma_f32_16x16x32_bf16 v[120:123], a[192:195], a[96:99], v[120:123]
  ds_read_b64_tr_b16 a[236:237], v233 offset:36864
  v_mfma_f32_16x16x32_bf16 v[120:123], a[196:199], a[112:115], v[120:123]
  ds_read_b64_tr_b16 a[238:239], v233 offset:38912
  v_mfma_f32_16x16x32_bf16 v[152:155], a[192:195], a[100:103], v[152:155]
  v_mfma_f32_16x16x32_bf16 v[152:155], a[196:199], a[116:119], v[152:155]
  s_load_dwordx2 s[66:67], s[22:23], 0xe0000
  s_add_u32 s22, s22, 0x100000
  s_addc_u32 s23, s23, 0
  v_mfma_f32_16x16x32_bf16 v[184:187], a[192:195], a[104:107], v[184:187]
  v_mfma_f32_16x16x32_bf16 v[184:187], a[196:199], a[120:123], v[184:187]
  v_mfma_f32_16x16x32_bf16 v[216:219], a[192:195], a[108:111], v[216:219]
  ds_read_b64_tr_b16 a[192:193], v234 offset:24576
  v_mfma_f32_16x16x32_bf16 v[216:219], a[196:199], a[124:127], v[216:219]
  ds_read_b64_tr_b16 a[194:195], v234 offset:26624
  v_mfma_f32_16x16x32_bf16 v[124:127], a[200:203], a[96:99], v[124:127]
  ds_read_b64_tr_b16 a[196:197], v234 offset:28672
  v_mfma_f32_16x16x32_bf16 v[124:127], a[204:207], a[112:115], v[124:127]
  ds_read_b64_tr_b16 a[198:199], v234 offset:30720
  v_mfma_f32_16x16x32_bf16 v[156:159], a[200:203], a[100:103], v[156:159]
  v_mfma_f32_16x16x32_bf16 v[156:159], a[204:207], a[116:119], v[156:159]
  v_mfma_f32_16x16x32_bf16 v[188:191], a[200:203], a[104:107], v[188:191]
  v_mfma_f32_16x16x32_bf16 v[188:191], a[204:207], a[120:123], v[188:191]
  v_mfma_f32_16x16x32_bf16 v[220:223], a[200:203], a[108:111], v[220:223]
  ds_read_b64_tr_b16 a[200:201], v234 offset:32768
  v_mfma_f32_16x16x32_bf16 v[220:223], a[204:207], a[124:127], v[220:223]
  ds_read_b64_tr_b16 a[202:203], v234 offset:34816
  s_mov_b32 s40, 22544384
  s_waitcnt lgkmcnt(13)
  v_mfma_f32_16x16x32_bf16 v[0:3], a[208:211], a[128:131], v[0:3]
  buffer_load_dwordx4 a[0:3], v225, s[4:7], s40 offen offset:0 sc1
  s_waitcnt vmcnt(25)
  v_mfma_f32_16x16x32_bf16 v[0:3], a[212:215], a[144:147], v[0:3]
  ds_read_b64_tr_b16 a[204:205], v234 offset:36864
  ds_read_b64_tr_b16 a[206:207], v234 offset:38912
  v_mfma_f32_16x16x32_bf16 v[16:19], a[208:211], a[132:135], v[16:19]
  v_mfma_f32_16x16x32_bf16 v[16:19], a[212:215], a[148:151], v[16:19]
  v_mfma_f32_16x16x32_bf16 v[32:35], a[208:211], a[136:139], v[32:35]
  v_mfma_f32_16x16x32_bf16 v[32:35], a[212:215], a[152:155], v[32:35]
  buffer_load_dwordx4 a[4:7], v225, s[4:7], s40 offen offset:1024 sc1
  v_mfma_f32_16x16x32_bf16 v[48:51], a[208:211], a[140:143], v[48:51]
  ds_read_b64_tr_b16 a[208:209], v232 offset:40960
  v_mfma_f32_16x16x32_bf16 v[48:51], a[212:215], a[156:159], v[48:51]
  ds_read_b64_tr_b16 a[210:211], v232 offset:43008
  v_mfma_f32_16x16x32_bf16 v[4:7], a[216:219], a[128:131], v[4:7]
  ds_read_b64_tr_b16 a[212:213], v232 offset:45056
  v_mfma_f32_16x16x32_bf16 v[4:7], a[220:223], a[144:147], v[4:7]
  ds_read_b64_tr_b16 a[214:215], v232 offset:47104
  s_load_dwordx2 s[66:67], s[22:23], 0x0
  v_mfma_f32_16x16x32_bf16 v[20:23], a[216:219], a[132:135], v[20:23]
  v_mfma_f32_16x16x32_bf16 v[20:23], a[220:223], a[148:151], v[20:23]
  buffer_load_dwordx4 a[8:11], v225, s[4:7], s40 offen offset:2048 sc1
  v_mfma_f32_16x16x32_bf16 v[36:39], a[216:219], a[136:139], v[36:39]
  v_mfma_f32_16x16x32_bf16 v[36:39], a[220:223], a[152:155], v[36:39]
  v_mfma_f32_16x16x32_bf16 v[52:55], a[216:219], a[140:143], v[52:55]
  ds_read_b64_tr_b16 a[216:217], v233 offset:40960
  v_mfma_f32_16x16x32_bf16 v[52:55], a[220:223], a[156:159], v[52:55]
  ds_read_b64_tr_b16 a[218:219], v233 offset:43008
  s_waitcnt lgkmcnt(13)
  v_mfma_f32_16x16x32_bf16 v[8:11], a[224:227], a[128:131], v[8:11]
  ds_read_b64_tr_b16 a[220:221], v233 offset:45056
  v_mfma_f32_16x16x32_bf16 v[8:11], a[228:231], a[144:147], v[8:11]
  s_waitcnt vmcnt(22)
  s_barrier
  v_mfma_f32_16x16x32_bf16 v[24:27], a[224:227], a[132:135], v[24:27]
  buffer_load_dwordx4 a[12:15], v225, s[4:7], s40 offen offset:3072 sc1
  v_mfma_f32_16x16x32_bf16 v[24:27], a[228:231], a[148:151], v[24:27]
  ds_read_b64_tr_b16 a[222:223], v233 offset:47104
  s_mov_b32 s41, 4587520
  v_mfma_f32_16x16x32_bf16 v[40:43], a[224:227], a[136:139], v[40:43]
  s_add_u32 m0, s42, 16384
  v_mfma_f32_16x16x32_bf16 v[40:43], a[228:231], a[152:155], v[40:43]
  v_mfma_f32_16x16x32_bf16 v[56:59], a[224:227], a[140:143], v[56:59]
  ds_read_b64_tr_b16 a[224:225], v234 offset:40960
  v_mfma_f32_16x16x32_bf16 v[56:59], a[228:231], a[156:159], v[56:59]
  buffer_load_dwordx4 v226, s[12:15], s41 offen lds
  v_mfma_f32_16x16x32_bf16 v[12:15], a[232:235], a[128:131], v[12:15]
  ds_read_b64_tr_b16 a[226:227], v234 offset:43008
  s_mov_b32 s41, 4816896
  v_mfma_f32_16x16x32_bf16 v[12:15], a[236:239], a[144:147], v[12:15]
  ds_read_b64_tr_b16 a[228:229], v234 offset:45056
  ds_read_b64_tr_b16 a[230:231], v234 offset:47104
  v_mfma_f32_16x16x32_bf16 v[28:31], a[232:235], a[132:135], v[28:31]
  s_add_u32 m0, s42, 20480
  v_mfma_f32_16x16x32_bf16 v[28:31], a[236:239], a[148:151], v[28:31]
  v_mfma_f32_16x16x32_bf16 v[44:47], a[232:235], a[136:139], v[44:47]
  v_mfma_f32_16x16x32_bf16 v[44:47], a[236:239], a[152:155], v[44:47]
  buffer_load_dwordx4 v226, s[12:15], s41 offen lds
  v_mfma_f32_16x16x32_bf16 v[60:63], a[232:235], a[140:143], v[60:63]
  ds_read_b64_tr_b16 a[232:233], v235 offset:40960
  s_mov_b32 s40, 22675456
  v_mfma_f32_16x16x32_bf16 v[60:63], a[236:239], a[156:159], v[60:63]
  ds_read_b64_tr_b16 a[234:235], v235 offset:43008
  s_load_dwordx2 s[66:67], s[22:23], 0x20000
  s_waitcnt lgkmcnt(13)
  v_mfma_f32_16x16x32_bf16 v[64:67], a[192:195], a[128:131], v[64:67]
  ds_read_b64_tr_b16 a[236:237], v235 offset:45056
  v_mfma_f32_16x16x32_bf16 v[64:67], a[196:199], a[144:147], v[64:67]
  ds_read_b64_tr_b16 a[238:239], v235 offset:47104
  v_mfma_f32_16x16x32_bf16 v[72:75], a[192:195], a[132:135], v[72:75]
  v_mfma_f32_16x16x32_bf16 v[72:75], a[196:199], a[148:151], v[72:75]
  buffer_load_dwordx4 a[16:19], v225, s[4:7], s40 offen offset:0 sc1
  v_mfma_f32_16x16x32_bf16 v[80:83], a[192:195], a[136:139], v[80:83]
  v_mfma_f32_16x16x32_bf16 v[80:83], a[196:199], a[152:155], v[80:83]
  v_mfma_f32_16x16x32_bf16 v[88:91], a[192:195], a[140:143], v[88:91]
  ds_read_b64_tr_b16 a[192:193], v232 offset:49152
  v_mfma_f32_16x16x32_bf16 v[88:91], a[196:199], a[156:159], v[88:91]
  ds_read_b64_tr_b16 a[194:195], v232 offset:51200
  v_mfma_f32_16x16x32_bf16 v[68:71], a[200:203], a[128:131], v[68:71]
  ds_read_b64_tr_b16 a[196:197], v232 offset:53248
  v_mfma_f32_16x16x32_bf16 v[68:71], a[204:207], a[144:147], v[68:71]
  buffer_load_dwordx4 a[20:23], v225, s[4:7], s40 offen offset:1024 sc1
  v_mfma_f32_16x16x32_bf16 v[76:79], a[200:203], a[132:135], v[76:79]
  ds_read_b64_tr_b16 a[198:199], v232 offset:55296
  v_mfma_f32_16x16x32_bf16 v[76:79], a[204:207], a[148:151], v[76:79]
  v_mfma_f32_16x16x32_bf16 v[84:87], a[200:203], a[136:139], v[84:87]
  v_mfma_f32_16x16x32_bf16 v[84:87], a[204:207], a[152:155], v[84:87]
  v_mfma_f32_16x16x32_bf16 v[92:95], a[200:203], a[140:143], v[92:95]
  ds_read_b64_tr_b16 a[200:201], v233 offset:49152
  v_mfma_f32_16x16x32_bf16 v[92:95], a[204:207], a[156:159], v[92:95]
  buffer_load_dwordx4 a[24:27], v225, s[4:7], s40 offen offset:2048 sc1
  s_waitcnt lgkmcnt(13)
  v_mfma_f32_16x16x32_bf16 v[96:99], a[208:211], a[128:131], v[96:99]
  ds_read_b64_tr_b16 a[202:203], v233 offset:51200
  v_mfma_f32_16x16x32_bf16 v[96:99], a[212:215], a[144:147], v[96:99]
  ds_read_b64_tr_b16 a[204:205], v233 offset:53248
  ds_read_b64_tr_b16 a[206:207], v233 offset:55296
  v_mfma_f32_16x16x32_bf16 v[128:131], a[208:211], a[132:135], v[128:131]
  v_mfma_f32_16x16x32_bf16 v[128:131], a[212:215], a[148:151], v[128:131]
  v_mfma_f32_16x16x32_bf16 v[160:163], a[208:211], a[136:139], v[160:163]
  v_mfma_f32_16x16x32_bf16 v[160:163], a[212:215], a[152:155], v[160:163]
  buffer_load_dwordx4 a[28:31], v225, s[4:7], s40 offen offset:3072 sc1
  s_load_dwordx2 s[66:67], s[22:23], 0x40000
  v_mfma_f32_16x16x32_bf16 v[192:195], a[208:211], a[140:143], v[192:195]
  ds_read_b64_tr_b16 a[208:209], v234 offset:49152
  s_mov_b32 s41, 4587520
  v_mfma_f32_16x16x32_bf16 v[192:195], a[212:215], a[156:159], v[192:195]
  ds_read_b64_tr_b16 a[210:211], v234 offset:51200
  s_add_u32 m0, s42, 24576
  v_mfma_f32_16x16x32_bf16 v[100:103], a[216:219], a[128:131], v[100:103]
  ds_read_b64_tr_b16 a[212:213], v234 offset:53248
  v_mfma_f32_16x16x32_bf16 v[100:103], a[220:223], a[144:147], v[100:103]
  ds_read_b64_tr_b16 a[214:215], v234 offset:55296
  v_mfma_f32_16x16x32_bf16 v[132:135], a[216:219], a[132:135], v[132:135]
  v_mfma_f32_16x16x32_bf16 v[132:135], a[220:223], a[148:151], v[132:135]
  buffer_load_dwordx4 v226, s[16:19], s41 offen lds
  v_mfma_f32_16x16x32_bf16 v[164:167], a[216:219], a[136:139], v[164:167]
  s_mov_b32 s41, 4816896
  s_add_u32 m0, s42, 28672
  v_mfma_f32_16x16x32_bf16 v[164:167], a[220:223], a[152:155], v[164:167]
  v_mfma_f32_16x16x32_bf16 v[196:199], a[216:219], a[140:143], v[196:199]
  ds_read_b64_tr_b16 a[216:217], v235 offset:49152
  v_mfma_f32_16x16x32_bf16 v[196:199], a[220:223], a[156:159], v[196:199]
  ds_read_b64_tr_b16 a[218:219], v235 offset:51200
  s_waitcnt lgkmcnt(13)
  v_mfma_f32_16x16x32_bf16 v[104:107], a[224:227], a[128:131], v[104:107]
  ds_read_b64_tr_b16 a[220:221], v235 offset:53248
  v_mfma_f32_16x16x32_bf16 v[104:107], a[228:231], a[144:147], v[104:107]
  buffer_load_dwordx4 v226, s[16:19], s41 offen lds
  v_mfma_f32_16x16x32_bf16 v[136:139], a[224:227], a[132:135], v[136:139]
  ds_read_b64_tr_b16 a[222:223], v235 offset:55296
  s_mov_b32 s40, 22806528
  v_mfma_f32_16x16x32_bf16 v[136:139], a[228:231], a[148:151], v[136:139]
  v_mfma_f32_16x16x32_bf16 v[168:171], a[224:227], a[136:139], v[168:171]
  v_mfma_f32_16x16x32_bf16 v[168:171], a[228:231], a[152:155], v[168:171]
  v_mfma_f32_16x16x32_bf16 v[200:203], a[224:227], a[140:143], v[200:203]
  ds_read_b64_tr_b16 a[224:225], v232 offset:57344
  v_mfma_f32_16x16x32_bf16 v[200:203], a[228:231], a[156:159], v[200:203]
  buffer_load_dwordx4 a[32:35], v225, s[4:7], s40 offen offset:0 sc1
  v_mfma_f32_16x16x32_bf16 v[108:111], a[232:235], a[128:131], v[108:111]
  ds_read_b64_tr_b16 a[226:227], v232 offset:59392
  v_mfma_f32_16x16x32_bf16 v[108:111], a[236:239], a[144:147], v[108:111]
  s_waitcnt vmcnt(23)
  s_barrier
  v_mfma_f32_16x16x32_bf16 v[140:143], a[232:235], a[132:135], v[140:143]
  ds_read_b64_tr_b16 a[228:229], v232 offset:61440
  ds_read_b64_tr_b16 a[230:231], v232 offset:63488
  v_mfma_f32_16x16x32_bf16 v[140:143], a[236:239], a[148:151], v[140:143]
  s_load_dwordx2 s[66:67], s[22:23], 0x60000
  v_mfma_f32_16x16x32_bf16 v[172:175], a[232:235], a[136:139], v[172:175]
  v_mfma_f32_16x16x32_bf16 v[172:175], a[236:239], a[152:155], v[172:175]
  buffer_load_dwordx4 a[36:39], v225, s[4:7], s40 offen offset:1024 sc1
  v_mfma_f32_16x16x32_bf16 v[204:207], a[232:235], a[140:143], v[204:207]
  ds_read_b64_tr_b16 a[232:233], v233 offset:57344
  v_mfma_f32_16x16x32_bf16 v[204:207], a[236:239], a[156:159], v[204:207]
  ds_read_b64_tr_b16 a[234:235], v233 offset:59392
  s_waitcnt lgkmcnt(13)
  v_mfma_f32_16x16x32_bf16 v[112:115], a[192:195], a[128:131], v[112:115]
  ds_read_b64_tr_b16 a[236:237], v233 offset:61440
  v_mfma_f32_16x16x32_bf16 v[112:115], a[196:199], a[144:147], v[112:115]
  ds_read_b64_tr_b16 a[238:239], v233 offset:63488
  v_mfma_f32_16x16x32_bf16 v[144:147], a[192:195], a[132:135], v[144:147]
  v_mfma_f32_16x16x32_bf16 v[144:147], a[196:199], a[148:151], v[144:147]
  buffer_load_dwordx4 a[40:43], v225, s[4:7], s40 offen offset:2048 sc1
  v_mfma_f32_16x16x32_bf16 v[176:179], a[192:195], a[136:139], v[176:179]
  v_mfma_f32_16x16x32_bf16 v[176:179], a[196:199], a[152:155], v[176:179]
  v_mfma_f32_16x16x32_bf16 v[208:211], a[192:195], a[140:143], v[208:211]
  ds_read_b64_tr_b16 a[192:193], v236 offset:0
  v_mfma_f32_16x16x32_bf16 v[208:211], a[196:199], a[156:159], v[208:211]
  ds_read_b64_tr_b16 a[194:195], v236 offset:2048
  v_mfma_f32_16x16x32_bf16 v[116:119], a[200:203], a[128:131], v[116:119]
  ds_read_b64_tr_b16 a[196:197], v236 offset:4096
  v_mfma_f32_16x16x32_bf16 v[116:119], a[204:207], a[144:147], v[116:119]
  buffer_load_dwordx4 a[44:47], v225, s[4:7], s40 offen offset:3072 sc1
  v_mfma_f32_16x16x32_bf16 v[148:151], a[200:203], a[132:135], v[148:151]
  ds_read_b64_tr_b16 a[198:199], v236 offset:6144
  s_mov_b32 s41, 5046272
  v_mfma_f32_16x16x32_bf16 v[148:151], a[204:207], a[148:151], v[148:151]
  s_add_u32 m0, s42, 32768
  v_mfma_f32_16x16x32_bf16 v[180:183], a[200:203], a[136:139], v[180:183]
  v_mfma_f32_16x16x32_bf16 v[180:183], a[204:207], a[152:155], v[180:183]
  v_mfma_f32_16x16x32_bf16 v[212:215], a[200:203], a[140:143], v[212:215]
  ds_read_b64_tr_b16 a[200:201], v237 offset:0
  v_mfma_f32_16x16x32_bf16 v[212:215], a[204:207], a[156:159], v[212:215]
  buffer_load_dwordx4 v227, s[12:15], s41 offen lds
  s_waitcnt lgkmcnt(13)
  v_mfma_f32_16x16x32_bf16 v[120:123], a[208:211], a[128:131], v[120:123]
  ds_read_b64_tr_b16 a[202:203], v237 offset:2048
  s_mov_b32 s41, 5275648
  v_mfma_f32_16x16x32_bf16 v[120:123], a[212:215], a[144:147], v[120:123]
  ds_read_b64_tr_b16 a[204:205], v237 offset:4096
  ds_read_b64_tr_b16 a[206:207], v237 offset:6144
  s_load_dwordx2 s[66:67], s[22:23], 0x80000
  v_mfma_f32_16x16x32_bf16 v[152:155], a[208:211], a[132:135], v[152:155]
  s_add_u32 m0, s42, 36864
  v_mfma_f32_16x16x32_bf16 v[152:155], a[212:215], a[148:151], v[152:155]
  v_mfma_f32_16x16x32_bf16 v[184:187], a[208:211], a[136:139], v[184:187]
L_wk0_4:
  s_cbranch_vccnz L_wk0_8
  v_mfma_f32_16x16x32_bf16 v[184:187], a[212:215], a[152:155], v[184:187]
  buffer_load_dwordx4 v227, s[12:15], s41 offen lds
  v_mfma_f32_16x16x32_bf16 v[216:219], a[208:211], a[140:143], v[216:219]
  ds_read_b64_tr_b16 a[208:209], v234 offset:57344
  s_mov_b32 s41, 5046272
  v_mfma_f32_16x16x32_bf16 v[216:219], a[212:215], a[156:159], v[216:219]
  ds_read_b64_tr_b16 a[210:211], v234 offset:59392
  s_add_u32 m0, s42, 40960
  v_mfma_f32_16x16x32_bf16 v[124:127], a[216:219], a[128:131], v[124:127]
  ds_read_b64_tr_b16 a[212:213], v234 offset:61440
  v_mfma_f32_16x16x32_bf16 v[124:127], a[220:223], a[144:147], v[124:127]
  ds_read_b64_tr_b16 a[214:215], v234 offset:63488
  v_mfma_f32_16x16x32_bf16 v[156:159], a[216:219], a[132:135], v[156:159]
  v_mfma_f32_16x16x32_bf16 v[156:159], a[220:223], a[148:151], v[156:159]
  buffer_load_dwordx4 v227, s[16:19], s41 offen lds
  v_mfma_f32_16x16x32_bf16 v[188:191], a[216:219], a[136:139], v[188:191]
  s_mov_b32 s41, 5275648
  s_add_u32 m0, s42, 45056
  v_mfma_f32_16x16x32_bf16 v[188:191], a[220:223], a[152:155], v[188:191]
  v_mfma_f32_16x16x32_bf16 v[220:223], a[216:219], a[140:143], v[220:223]
  ds_read_b64_tr_b16 a[216:217], v238 offset:0
  v_mfma_f32_16x16x32_bf16 v[220:223], a[220:223], a[156:159], v[220:223]
  ds_read_b64_tr_b16 a[218:219], v238 offset:2048
  s_waitcnt lgkmcnt(13)
  v_mfma_f32_16x16x32_bf16 v[0:3], a[224:227], a[160:163], v[0:3]
  ds_read_b64_tr_b16 a[220:221], v238 offset:4096
  s_waitcnt vmcnt(25)
  v_mfma_f32_16x16x32_bf16 v[0:3], a[228:231], a[176:179], v[0:3]
  buffer_load_dwordx4 v227, s[16:19], s41 offen lds
  v_mfma_f32_16x16x32_bf16 v[16:19], a[224:227], a[164:167], v[16:19]
  ds_read_b64_tr_b16 a[222:223], v238 offset:6144
  s_mov_b32 s41, 5505024
  v_mfma_f32_16x16x32_bf16 v[16:19], a[228:231], a[180:183], v[16:19]
  s_add_u32 m0, s42, 49152
  v_mfma_f32_16x16x32_bf16 v[32:35], a[224:227], a[168:171], v[32:35]
  v_mfma_f32_16x16x32_bf16 v[32:35], a[228:231], a[184:187], v[32:35]
  v_mfma_f32_16x16x32_bf16 v[48:51], a[224:227], a[172:175], v[48:51]
  ds_read_b64_tr_b16 a[224:225], v236 offset:8192
  v_mfma_f32_16x16x32_bf16 v[48:51], a[228:231], a[188:191], v[48:51]
  buffer_load_dwordx4 v227, s[12:15], s41 offen lds
  s_load_dwordx2 s[66:67], s[22:23], 0xa0000
  v_mfma_f32_16x16x32_bf16 v[4:7], a[232:235], a[160:163], v[4:7]
  ds_read_b64_tr_b16 a[226:227], v236 offset:10240
  s_mov_b32 s41, 5734400
  v_mfma_f32_16x16x32_bf16 v[4:7], a[236:239], a[176:179], v[4:7]
  ds_read_b64_tr_b16 a[228:229], v236 offset:12288
  ds_read_b64_tr_b16 a[230:231], v236 offset:14336
  v_mfma_f32_16x16x32_bf16 v[20:23], a[232:235], a[164:167], v[20:23]
  s_add_u32 m0, s42, 53248
  v_mfma_f32_16x16x32_bf16 v[20:23], a[236:239], a[180:183], v[20:23]
  v_mfma_f32_16x16x32_bf16 v[36:39], a[232:235], a[168:171], v[36:39]
  v_mfma_f32_16x16x32_bf16 v[36:39], a[236:239], a[184:187], v[36:39]
  buffer_load_dwordx4 v227, s[12:15], s41 offen lds
  v_mfma_f32_16x16x32_bf16 v[52:55], a[232:235], a[172:175], v[52:55]
  ds_read_b64_tr_b16 a[232:233], v237 offset:8192
  s_mov_b32 s40, 22937600
  v_mfma_f32_16x16x32_bf16 v[52:55], a[236:239], a[188:191], v[52:55]
  ds_read_b64_tr_b16 a[234:235], v237 offset:10240
  s_waitcnt lgkmcnt(13)
  v_mfma_f32_16x16x32_bf16 v[8:11], a[192:195], a[160:163], v[8:11]
  ds_read_b64_tr_b16 a[236:237], v237 offset:12288
  v_mfma_f32_16x16x32_bf16 v[8:11], a[196:199], a[176:179], v[8:11]
  s_waitcnt vmcnt(24)
  s_barrier
  v_mfma_f32_16x16x32_bf16 v[24:27], a[192:195], a[164:167], v[24:27]
  ds_read_b64_tr_b16 a[238:239], v237 offset:14336
  v_mfma_f32_16x16x32_bf16 v[24:27], a[196:199], a[180:183], v[24:27]
  buffer_load_dwordx4 a[48:51], v225, s[4:7], s40 offen offset:0 sc1
  v_mfma_f32_16x16x32_bf16 v[40:43], a[192:195], a[168:171], v[40:43]
  v_mfma_f32_16x16x32_bf16 v[40:43], a[196:199], a[184:187], v[40:43]
  v_mfma_f32_16x16x32_bf16 v[56:59], a[192:195], a[172:175], v[56:59]
  ds_read_b64_tr_b16 a[192:193], v238 offset:8192
  v_mfma_f32_16x16x32_bf16 v[56:59], a[196:199], a[188:191], v[56:59]
  ds_read_b64_tr_b16 a[194:195], v238 offset:10240
  v_mfma_f32_16x16x32_bf16 v[12:15], a[200:203], a[160:163], v[12:15]
  ds_read_b64_tr_b16 a[196:197], v238 offset:12288
  v_mfma_f32_16x16x32_bf16 v[12:15], a[204:207], a[176:179], v[12:15]
  buffer_load_dwordx4 a[52:55], v225, s[4:7], s40 offen offset:1024 sc1
  v_mfma_f32_16x16x32_bf16 v[28:31], a[200:203], a[164:167], v[28:31]
  ds_read_b64_tr_b16 a[198:199], v238 offset:14336
  v_mfma_f32_16x16x32_bf16 v[28:31], a[204:207], a[180:183], v[28:31]
  v_mfma_f32_16x16x32_bf16 v[44:47], a[200:203], a[168:171], v[44:47]
  v_mfma_f32_16x16x32_bf16 v[44:47], a[204:207], a[184:187], v[44:47]
  s_load_dwordx2 s[66:67], s[22:23], 0xc0000
  v_mfma_f32_16x16x32_bf16 v[60:63], a[200:203], a[172:175], v[60:63]
  ds_read_b64_tr_b16 a[200:201], v239 offset:8192
  v_mfma_f32_16x16x32_bf16 v[60:63], a[204:207], a[188:191], v[60:63]
  buffer_load_dwordx4 a[56:59], v225, s[4:7], s40 offen offset:2048 sc1
  s_waitcnt lgkmcnt(13)
  v_mfma_f32_16x16x32_bf16 v[64:67], a[208:211], a[160:163], v[64:67]
  ds_read_b64_tr_b16 a[202:203], v239 offset:10240
  v_mfma_f32_16x16x32_bf16 v[64:67], a[212:215], a[176:179], v[64:67]
  ds_read_b64_tr_b16 a[204:205], v239 offset:12288
  ds_read_b64_tr_b16 a[206:207], v239 offset:14336
  v_mfma_f32_16x16x32_bf16 v[72:75], a[208:211], a[164:167], v[72:75]
  v_mfma_f32_16x16x32_bf16 v[72:75], a[212:215], a[180:183], v[72:75]
  v_mfma_f32_16x16x32_bf16 v[80:83], a[208:211], a[168:171], v[80:83]
  v_mfma_f32_16x16x32_bf16 v[80:83], a[212:215], a[184:187], v[80:83]
  buffer_load_dwordx4 a[60:63], v225, s[4:7], s40 offen offset:3072 sc1
  v_mfma_f32_16x16x32_bf16 v[88:91], a[208:211], a[172:175], v[88:91]
  ds_read_b64_tr_b16 a[208:209], v236 offset:16384
  s_mov_b32 s41, 5505024
  v_mfma_f32_16x16x32_bf16 v[88:91], a[212:215], a[188:191], v[88:91]
  ds_read_b64_tr_b16 a[210:211], v236 offset:18432
  s_add_u32 m0, s42, 57344
  v_mfma_f32_16x16x32_bf16 v[68:71], a[216:219], a[160:163], v[68:71]
  ds_read_b64_tr_b16 a[212:213], v236 offset:20480
  v_mfma_f32_16x16x32_bf16 v[68:71], a[220:223], a[176:179], v[68:71]
  ds_read_b64_tr_b16 a[214:215], v236 offset:22528
  v_mfma_f32_16x16x32_bf16 v[76:79], a[216:219], a[164:167], v[76:79]
  v_mfma_f32_16x16x32_bf16 v[76:79], a[220:223], a[180:183], v[76:79]
  buffer_load_dwordx4 v227, s[16:19], s41 offen lds
  v_mfma_f32_16x16x32_bf16 v[84:87], a[216:219], a[168:171], v[84:87]
  s_mov_b32 s41, 5734400
  s_add_u32 m0, s42, 61440
  v_mfma_f32_16x16x32_bf16 v[84:87], a[220:223], a[184:187], v[84:87]
  v_mfma_f32_16x16x32_bf16 v[92:95], a[216:219], a[172:175], v[92:95]
  ds_read_b64_tr_b16 a[216:217], v237 offset:16384
  v_mfma_f32_16x16x32_bf16 v[92:95], a[220:223], a[188:191], v[92:95]
  ds_read_b64_tr_b16 a[218:219], v237 offset:18432
  s_waitcnt lgkmcnt(13)
  v_mfma_f32_16x16x32_bf16 v[96:99], a[224:227], a[160:163], v[96:99]
  ds_read_b64_tr_b16 a[220:221], v237 offset:20480
  v_mfma_f32_16x16x32_bf16 v[96:99], a[228:231], a[176:179], v[96:99]
  buffer_load_dwordx4 v227, s[16:19], s41 offen lds
  v_mfma_f32_16x16x32_bf16 v[128:131], a[224:227], a[164:167], v[128:131]
  ds_read_b64_tr_b16 a[222:223], v237 offset:22528
  s_mov_b32 s41, 5963776
  v_mfma_f32_16x16x32_bf16 v[128:131], a[228:231], a[180:183], v[128:131]
  s_add_u32 m0, s42, 65536
  s_load_dwordx2 s[66:67], s[22:23], 0xe0000
  s_add_u32 s22, s22, 0x100000
  s_addc_u32 s23, s23, 0
  v_mfma_f32_16x16x32_bf16 v[160:163], a[224:227], a[168:171], v[160:163]
  v_mfma_f32_16x16x32_bf16 v[160:163], a[228:231], a[184:187], v[160:163]
  v_mfma_f32_16x16x32_bf16 v[192:195], a[224:227], a[172:175], v[192:195]
  ds_read_b64_tr_b16 a[224:225], v238 offset:16384
  v_mfma_f32_16x16x32_bf16 v[192:195], a[228:231], a[188:191], v[192:195]
  buffer_load_dwordx4 v227, s[12:15], s41 offen lds
  v_mfma_f32_16x16x32_bf16 v[100:103], a[232:235], a[160:163], v[100:103]
  ds_read_b64_tr_b16 a[226:227], v238 offset:18432
  s_mov_b32 s41, 6193152
  v_mfma_f32_16x16x32_bf16 v[100:103], a[236:239], a[176:179], v[100:103]
  ds_read_b64_tr_b16 a[228:229], v238 offset:20480
  ds_read_b64_tr_b16 a[230:231], v238 offset:22528
  v_mfma_f32_16x16x32_bf16 v[132:135], a[232:235], a[164:167], v[132:135]
  s_add_u32 m0, s42, 69632
  v_mfma_f32_16x16x32_bf16 v[132:135], a[236:239], a[180:183], v[132:135]
  v_mfma_f32_16x16x32_bf16 v[164:167], a[232:235], a[168:171], v[164:167]
  v_mfma_f32_16x16x32_bf16 v[164:167], a[236:239], a[184:187], v[164:167]
  buffer_load_dwordx4 v227, s[12:15], s41 offen lds
  v_mfma_f32_16x16x32_bf16 v[196:199], a[232:235], a[172:175], v[196:199]
  ds_read_b64_tr_b16 a[232:233], v239 offset:16384
  s_mov_b32 s41, 5963776
  v_mfma_f32_16x16x32_bf16 v[196:199], a[236:239], a[188:191], v[196:199]
  ds_read_b64_tr_b16 a[234:235], v239 offset:18432
  s_add_u32 m0, s42, 73728
  s_waitcnt lgkmcnt(13)
  v_mfma_f32_16x16x32_bf16 v[104:107], a[192:195], a[160:163], v[104:107]
  ds_read_b64_tr_b16 a[236:237], v239 offset:20480
  v_mfma_f32_16x16x32_bf16 v[104:107], a[196:199], a[176:179], v[104:107]
  ds_read_b64_tr_b16 a[238:239], v239 offset:22528
  v_mfma_f32_16x16x32_bf16 v[136:139], a[192:195], a[164:167], v[136:139]
  v_mfma_f32_16x16x32_bf16 v[136:139], a[196:199], a[180:183], v[136:139]
  buffer_load_dwordx4 v227, s[16:19], s41 offen lds
  v_mfma_f32_16x16x32_bf16 v[168:171], a[192:195], a[168:171], v[168:171]
  s_mov_b32 s41, 6193152
  s_add_u32 m0, s42, 77824
  v_mfma_f32_16x16x32_bf16 v[168:171], a[196:199], a[184:187], v[168:171]
  v_mfma_f32_16x16x32_bf16 v[200:203], a[192:195], a[172:175], v[200:203]
  ds_read_b64_tr_b16 a[192:193], v236 offset:24576
  v_mfma_f32_16x16x32_bf16 v[200:203], a[196:199], a[188:191], v[200:203]
  ds_read_b64_tr_b16 a[194:195], v236 offset:26624
  v_mfma_f32_16x16x32_bf16 v[108:111], a[200:203], a[160:163], v[108:111]
  ds_read_b64_tr_b16 a[196:197], v236 offset:28672
  v_mfma_f32_16x16x32_bf16 v[108:111], a[204:207], a[176:179], v[108:111]
  s_waitcnt vmcnt(25)
  s_barrier
  s_load_dwordx2 s[66:67], s[22:23], 0x0
  v_mfma_f32_16x16x32_bf16 v[140:143], a[200:203], a[164:167], v[140:143]
  buffer_load_dwordx4 v227, s[16:19], s41 offen lds
  v_mfma_f32_16x16x32_bf16 v[140:143], a[204:207], a[180:183], v[140:143]
  ds_read_b64_tr_b16 a[198:199], v236 offset:30720
  s_mov_b32 s40, 23068672
  v_mfma_f32_16x16x32_bf16 v[172:175], a[200:203], a[168:171], v[172:175]
  v_mfma_f32_16x16x32_bf16 v[172:175], a[204:207], a[184:187], v[172:175]
  v_mfma_f32_16x16x32_bf16 v[204:207], a[200:203], a[172:175], v[204:207]
  ds_read_b64_tr_b16 a[200:201], v237 offset:24576
  v_mfma_f32_16x16x32_bf16 v[204:207], a[204:207], a[188:191], v[204:207]
  buffer_load_dwordx4 a[64:67], v225, s[4:7], s40 offen offset:0 sc1
  s_waitcnt lgkmcnt(13)
  v_mfma_f32_16x16x32_bf16 v[112:115], a[208:211], a[160:163], v[112:115]
  ds_read_b64_tr_b16 a[202:203], v237 offset:26624
  v_mfma_f32_16x16x32_bf16 v[112:115], a[212:215], a[176:179], v[112:115]
  ds_read_b64_tr_b16 a[204:205], v237 offset:28672
  ds_read_b64_tr_b16 a[206:207], v237 offset:30720
  v_mfma_f32_16x16x32_bf16 v[144:147], a[208:211], a[164:167], v[144:147]
  v_mfma_f32_16x16x32_bf16 v[144:147], a[212:215], a[180:183], v[144:147]
  v_mfma_f32_16x16x32_bf16 v[176:179], a[208:211], a[168:171], v[176:179]
  v_mfma_f32_16x16x32_bf16 v[176:179], a[212:215], a[184:187], v[176:179]
  buffer_load_dwordx4 a[68:71], v225, s[4:7], s40 offen offset:1024 sc1
  v_mfma_f32_16x16x32_bf16 v[208:211], a[208:211], a[172:175], v[208:211]
  ds_read_b64_tr_b16 a[208:209], v228 offset:8192
  v_mfma_f32_16x16x32_bf16 v[208:211], a[212:215], a[188:191], v[208:211]
  ds_read_b64_tr_b16 a[210:211], v228 offset:10240
  v_mfma_f32_16x16x32_bf16 v[116:119], a[216:219], a[160:163], v[116:119]
  ds_read_b64_tr_b16 a[212:213], v228 offset:12288
  v_mfma_f32_16x16x32_bf16 v[116:119], a[220:223], a[176:179], v[116:119]
  ds_read_b64_tr_b16 a[214:215], v228 offset:14336
  v_mfma_f32_16x16x32_bf16 v[148:151], a[216:219], a[164:167], v[148:151]
  v_mfma_f32_16x16x32_bf16 v[148:151], a[220:223], a[180:183], v[148:151]
  buffer_load_dwordx4 a[72:75], v225, s[4:7], s40 offen offset:2048 sc1
  v_mfma_f32_16x16x32_bf16 v[180:183], a[216:219], a[168:171], v[180:183]
  v_mfma_f32_16x16x32_bf16 v[180:183], a[220:223], a[184:187], v[180:183]
  v_mfma_f32_16x16x32_bf16 v[212:215], a[216:219], a[172:175], v[212:215]
  ds_read_b64_tr_b16 a[216:217], v229 offset:8192
  v_mfma_f32_16x16x32_bf16 v[212:215], a[220:223], a[188:191], v[212:215]
  ds_read_b64_tr_b16 a[218:219], v229 offset:10240
  s_load_dwordx2 s[66:67], s[22:23], 0x20000
  s_waitcnt lgkmcnt(13)
  v_mfma_f32_16x16x32_bf16 v[120:123], a[224:227], a[160:163], v[120:123]
  ds_read_b64_tr_b16 a[220:221], v229 offset:12288
  v_mfma_f32_16x16x32_bf16 v[120:123], a[228:231], a[176:179], v[120:123]
  buffer_load_dwordx4 a[76:79], v225, s[4:7], s40 offen offset:3072 sc1
  v_mfma_f32_16x16x32_bf16 v[152:155], a[224:227], a[164:167], v[152:155]
  ds_read_b64_tr_b16 a[222:223], v229 offset:14336
  s_mov_b32 s40, 23199744
  v_mfma_f32_16x16x32_bf16 v[152:155], a[228:231], a[180:183], v[152:155]
  v_mfma_f32_16x16x32_bf16 v[184:187], a[224:227], a[168:171], v[184:187]
  v_mfma_f32_16x16x32_bf16 v[184:187], a[228:231], a[184:187], v[184:187]
  v_mfma_f32_16x16x32_bf16 v[216:219], a[224:227], a[172:175], v[216:219]
  ds_read_b64_tr_b16 a[224:225], v238 offset:24576
  v_mfma_f32_16x16x32_bf16 v[216:219], a[228:231], a[188:191], v[216:219]
  buffer_load_dwordx4 a[80:83], v225, s[4:7], s40 offen offset:0 sc1
  v_mfma_f32_16x16x32_bf16 v[124:127], a[232:235], a[160:163], v[124:127]
  ds_read_b64_tr_b16 a[226:227], v238 offset:26624
  v_mfma_f32_16x16x32_bf16 v[124:127], a[236:239], a[176:179], v[124:127]
  ds_read_b64_tr_b16 a[228:229], v238 offset:28672
  ds_read_b64_tr_b16 a[230:231], v238 offset:30720
  v_mfma_f32_16x16x32_bf16 v[156:159], a[232:235], a[164:167], v[156:159]
  v_mfma_f32_16x16x32_bf16 v[156:159], a[236:239], a[180:183], v[156:159]
  v_mfma_f32_16x16x32_bf16 v[188:191], a[232:235], a[168:171], v[188:191]
  v_mfma_f32_16x16x32_bf16 v[188:191], a[236:239], a[184:187], v[188:191]
  buffer_load_dwordx4 a[84:87], v225, s[4:7], s40 offen offset:1024 sc1
  v_mfma_f32_16x16x32_bf16 v[220:223], a[232:235], a[172:175], v[220:223]
  ds_read_b64_tr_b16 a[232:233], v230 offset:8192
  v_mfma_f32_16x16x32_bf16 v[220:223], a[236:239], a[188:191], v[220:223]
  ds_read_b64_tr_b16 a[234:235], v230 offset:10240
  s_waitcnt lgkmcnt(13)
  v_mfma_f32_16x16x32_bf16 v[0:3], a[192:195], a[0:3], v[0:3]
  ds_read_b64_tr_b16 a[236:237], v230 offset:12288
  s_waitcnt vmcnt(28)
  v_mfma_f32_16x16x32_bf16 v[0:3], a[196:199], a[16:19], v[0:3]
  ds_read_b64_tr_b16 a[238:239], v230 offset:14336
  v_mfma_f32_16x16x32_bf16 v[16:19], a[192:195], a[4:7], v[16:19]
  v_mfma_f32_16x16x32_bf16 v[16:19], a[196:199], a[20:23], v[16:19]
  buffer_load_dwordx4 a[88:91], v225, s[4:7], s40 offen offset:2048 sc1
  v_mfma_f32_16x16x32_bf16 v[32:35], a[192:195], a[8:11], v[32:35]
  v_mfma_f32_16x16x32_bf16 v[32:35], a[196:199], a[24:27], v[32:35]
  s_load_dwordx2 s[66:67], s[22:23], 0x40000
  v_mfma_f32_16x16x32_bf16 v[48:51], a[192:195], a[12:15], v[48:51]
  ds_read_b64_tr_b16 a[192:193], v228 offset:16384
  v_mfma_f32_16x16x32_bf16 v[48:51], a[196:199], a[28:31], v[48:51]
  ds_read_b64_tr_b16 a[194:195], v228 offset:18432
  v_mfma_f32_16x16x32_bf16 v[4:7], a[200:203], a[0:3], v[4:7]
  ds_read_b64_tr_b16 a[196:197], v228 offset:20480
  v_mfma_f32_16x16x32_bf16 v[4:7], a[204:207], a[16:19], v[4:7]
  buffer_load_dwordx4 a[92:95], v225, s[4:7], s40 offen offset:3072 sc1
  v_mfma_f32_16x16x32_bf16 v[20:23], a[200:203], a[4:7], v[20:23]
  ds_read_b64_tr_b16 a[198:199], v228 offset:22528
  s_mov_b32 s41, 6422528
  v_mfma_f32_16x16x32_bf16 v[20:23], a[204:207], a[20:23], v[20:23]
  s_add_u32 m0, s42, 81920
  v_mfma_f32_16x16x32_bf16 v[36:39], a[200:203], a[8:11], v[36:39]
  v_mfma_f32_16x16x32_bf16 v[36:39], a[204:207], a[24:27], v[36:39]
  v_mfma_f32_16x16x32_bf16 v[52:55], a[200:203], a[12:15], v[52:55]
  ds_read_b64_tr_b16 a[200:201], v229 offset:16384
  v_mfma_f32_16x16x32_bf16 v[52:55], a[204:207], a[28:31], v[52:55]
  buffer_load_dwordx4 v227, s[12:15], s41 offen lds
  s_waitcnt lgkmcnt(13)
  v_mfma_f32_16x16x32_bf16 v[8:11], a[208:211], a[0:3], v[8:11]
  ds_read_b64_tr_b16 a[202:203], v229 offset:18432
  s_mov_b32 s41, 6651904
  v_mfma_f32_16x16x32_bf16 v[8:11], a[212:215], a[16:19], v[8:11]
  s_waitcnt vmcnt(23)
  s_barrier
  v_mfma_f32_16x16x32_bf16 v[24:27], a[208:211], a[4:7], v[24:27]
  ds_read_b64_tr_b16 a[204:205], v229 offset:20480
  ds_read_b64_tr_b16 a[206:207], v229 offset:22528
  v_mfma_f32_16x16x32_bf16 v[24:27], a[212:215], a[20:23], v[24:27]
  s_add_u32 m0, s42, 86016
  v_mfma_f32_16x16x32_bf16 v[40:43], a[208:211], a[8:11], v[40:43]
  v_mfma_f32_16x16x32_bf16 v[40:43], a[212:215], a[24:27], v[40:43]
  buffer_load_dwordx4 v227, s[12:15], s41 offen lds
  v_mfma_f32_16x16x32_bf16 v[56:59], a[208:211], a[12:15], v[56:59]
  ds_read_b64_tr_b16 a[208:209], v230 offset:16384
  s_mov_b32 s41, 6422528
  v_mfma_f32_16x16x32_bf16 v[56:59], a[212:215], a[28:31], v[56:59]
  ds_read_b64_tr_b16 a[210:211], v230 offset:18432
  s_add_u32 m0, s42, 90112
  v_mfma_f32_16x16x32_bf16 v[12:15], a[216:219], a[0:3], v[12:15]
  ds_read_b64_tr_b16 a[212:213], v230 offset:20480
  v_mfma_f32_16x16x32_bf16 v[12:15], a[220:223], a[16:19], v[12:15]
  ds_read_b64_tr_b16 a[214:215], v230 offset:22528
  v_mfma_f32_16x16x32_bf16 v[28:31], a[216:219], a[4:7], v[28:31]
  v_mfma_f32_16x16x32_bf16 v[28:31], a[220:223], a[20:23], v[28:31]
  buffer_load_dwordx4 v227, s[16:19], s41 offen lds
  s_load_dwordx2 s[66:67], s[22:23], 0x60000
  v_mfma_f32_16x16x32_bf16 v[44:47], a[216:219], a[8:11], v[44:47]
  s_mov_b32 s41, 6651904
  s_add_u32 m0, s42, 94208
  v_mfma_f32_16x16x32_bf16 v[44:47], a[220:223], a[24:27], v[44:47]
  v_mfma_f32_16x16x32_bf16 v[60:63], a[216:219], a[12:15], v[60:63]
  ds_read_b64_tr_b16 a[216:217], v231 offset:16384
  v_mfma_f32_16x16x32_bf16 v[60:63], a[220:223], a[28:31], v[60:63]
  ds_read_b64_tr_b16 a[218:219], v231 offset:18432
  s_waitcnt lgkmcnt(13)
  v_mfma_f32_16x16x32_bf16 v[64:67], a[224:227], a[0:3], v[64:67]
  ds_read_b64_tr_b16 a[220:221], v231 offset:20480
  v_mfma_f32_16x16x32_bf16 v[64:67], a[228:231], a[16:19], v[64:67]
  buffer_load_dwordx4 v227, s[16:19], s41 offen lds
  v_mfma_f32_16x16x32_bf16 v[72:75], a[224:227], a[4:7], v[72:75]
  ds_read_b64_tr_b16 a[222:223], v231 offset:22528
  s_mov_b32 s40, 23330816
  v_mfma_f32_16x16x32_bf16 v[72:75], a[228:231], a[20:23], v[72:75]
  v_mfma_f32_16x16x32_bf16 v[80:83], a[224:227], a[8:11], v[80:83]
  v_mfma_f32_16x16x32_bf16 v[80:83], a[228:231], a[24:27], v[80:83]
  v_mfma_f32_16x16x32_bf16 v[88:91], a[224:227], a[12:15], v[88:91]
  ds_read_b64_tr_b16 a[224:225], v228 offset:24576
  v_mfma_f32_16x16x32_bf16 v[88:91], a[228:231], a[28:31], v[88:91]
  buffer_load_dwordx4 a[96:99], v225, s[4:7], s40 offen offset:0 sc1
  v_mfma_f32_16x16x32_bf16 v[68:71], a[232:235], a[0:3], v[68:71]
  ds_read_b64_tr_b16 a[226:227], v228 offset:26624
  v_mfma_f32_16x16x32_bf16 v[68:71], a[236:239], a[16:19], v[68:71]
  ds_read_b64_tr_b16 a[228:229], v228 offset:28672
  ds_read_b64_tr_b16 a[230:231], v228 offset:30720
  v_mfma_f32_16x16x32_bf16 v[76:79], a[232:235], a[4:7], v[76:79]
  v_mfma_f32_16x16x32_bf16 v[76:79], a[236:239], a[20:23], v[76:79]
  v_mfma_f32_16x16x32_bf16 v[84:87], a[232:235], a[8:11], v[84:87]
  v_mfma_f32_16x16x32_bf16 v[84:87], a[236:239], a[24:27], v[84:87]
  buffer_load_dwordx4 a[100:103], v225, s[4:7], s40 offen offset:1024 sc1
  v_mfma_f32_16x16x32_bf16 v[92:95], a[232:235], a[12:15], v[92:95]
  ds_read_b64_tr_b16 a[232:233], v229 offset:24576
  v_mfma_f32_16x16x32_bf16 v[92:95], a[236:239], a[28:31], v[92:95]
  ds_read_b64_tr_b16 a[234:235], v229 offset:26624
  s_waitcnt lgkmcnt(13)
  v_mfma_f32_16x16x32_bf16 v[96:99], a[192:195], a[0:3], v[96:99]
  ds_read_b64_tr_b16 a[236:237], v229 offset:28672
  v_mfma_f32_16x16x32_bf16 v[96:99], a[196:199], a[16:19], v[96:99]
  ds_read_b64_tr_b16 a[238:239], v229 offset:30720
  s_load_dwordx2 s[66:67], s[22:23], 0x80000
  v_mfma_f32_16x16x32_bf16 v[128:131], a[192:195], a[4:7], v[128:131]
  v_mfma_f32_16x16x32_bf16 v[128:131], a[196:199], a[20:23], v[128:131]
  buffer_load_dwordx4 a[104:107], v225, s[4:7], s40 offen offset:2048 sc1
  v_mfma_f32_16x16x32_bf16 v[160:163], a[192:195], a[8:11], v[160:163]
  v_mfma_f32_16x16x32_bf16 v[160:163], a[196:199], a[24:27], v[160:163]
  v_mfma_f32_16x16x32_bf16 v[192:195], a[192:195], a[12:15], v[192:195]
  ds_read_b64_tr_b16 a[192:193], v230 offset:24576
  v_mfma_f32_16x16x32_bf16 v[192:195], a[196:199], a[28:31], v[192:195]
  ds_read_b64_tr_b16 a[194:195], v230 offset:26624
  v_mfma_f32_16x16x32_bf16 v[100:103], a[200:203], a[0:3], v[100:103]
  ds_read_b64_tr_b16 a[196:197], v230 offset:28672
  v_mfma_f32_16x16x32_bf16 v[100:103], a[204:207], a[16:19], v[100:103]
  buffer_load_dwordx4 a[108:111], v225, s[4:7], s40 offen offset:3072 sc1
  v_mfma_f32_16x16x32_bf16 v[132:135], a[200:203], a[4:7], v[132:135]
  ds_read_b64_tr_b16 a[198:199], v230 offset:30720
  s_mov_b32 s40, 23461888
  v_mfma_f32_16x16x32_bf16 v[132:135], a[204:207], a[20:23], v[132:135]
  v_mfma_f32_16x16x32_bf16 v[164:167], a[200:203], a[8:11], v[164:167]
  v_mfma_f32_16x16x32_bf16 v[164:167], a[204:207], a[24:27], v[164:167]
  v_mfma_f32_16x16x32_bf16 v[196:199], a[200:203], a[12:15], v[196:199]
  ds_read_b64_tr_b16 a[200:201], v231 offset:24576
  v_mfma_f32_16x16x32_bf16 v[196:199], a[204:207], a[28:31], v[196:199]
  buffer_load_dwordx4 a[112:115], v225, s[4:7], s40 offen offset:0 sc1
  s_waitcnt lgkmcnt(13)
  v_mfma_f32_16x16x32_bf16 v[104:107], a[208:211], a[0:3], v[104:107]
  ds_read_b64_tr_b16 a[202:203], v231 offset:26624
  v_mfma_f32_16x16x32_bf16 v[104:107], a[212:215], a[16:19], v[104:107]
  ds_read_b64_tr_b16 a[204:205], v231 offset:28672
  ds_read_b64_tr_b16 a[206:207], v231 offset:30720
  v_mfma_f32_16x16x32_bf16 v[136:139], a[208:211], a[4:7], v[136:139]
  v_mfma_f32_16x16x32_bf16 v[136:139], a[212:215], a[20:23], v[136:139]
  v_mfma_f32_16x16x32_bf16 v[168:171], a[208:211], a[8:11], v[168:171]
  v_mfma_f32_16x16x32_bf16 v[168:171], a[212:215], a[24:27], v[168:171]
  buffer_load_dwordx4 a[116:119], v225, s[4:7], s40 offen offset:1024 sc1
  v_mfma_f32_16x16x32_bf16 v[200:203], a[208:211], a[12:15], v[200:203]
  ds_read_b64_tr_b16 a[208:209], v228 offset:32768
  v_mfma_f32_16x16x32_bf16 v[200:203], a[212:215], a[28:31], v[200:203]
  ds_read_b64_tr_b16 a[210:211], v228 offset:34816
  s_load_dwordx2 s[66:67], s[22:23], 0xa0000
  v_mfma_f32_16x16x32_bf16 v[108:111], a[216:219], a[0:3], v[108:111]
  ds_read_b64_tr_b16 a[212:213], v228 offset:36864
  v_mfma_f32_16x16x32_bf16 v[108:111], a[220:223], a[16:19], v[108:111]
  s_waitcnt vmcnt(28)
  s_barrier
  v_mfma_f32_16x16x32_bf16 v[140:143], a[216:219], a[4:7], v[140:143]
  ds_read_b64_tr_b16 a[214:215], v228 offset:38912
  v_mfma_f32_16x16x32_bf16 v[140:143], a[220:223], a[20:23], v[140:143]
  buffer_load_dwordx4 a[120:123], v225, s[4:7], s40 offen offset:2048 sc1
  v_mfma_f32_16x16x32_bf16 v[172:175], a[216:219], a[8:11], v[172:175]
  v_mfma_f32_16x16x32_bf16 v[172:175], a[220:223], a[24:27], v[172:175]
  v_mfma_f32_16x16x32_bf16 v[204:207], a[216:219], a[12:15], v[204:207]
  ds_read_b64_tr_b16 a[216:217], v229 offset:32768
  v_mfma_f32_16x16x32_bf16 v[204:207], a[220:223], a[28:31], v[204:207]
  ds_read_b64_tr_b16 a[218:219], v229 offset:34816
  s_waitcnt lgkmcnt(13)
  v_mfma_f32_16x16x32_bf16 v[112:115], a[224:227], a[0:3], v[112:115]
  ds_read_b64_tr_b16 a[220:221], v229 offset:36864
  v_mfma_f32_16x16x32_bf16 v[112:115], a[228:231], a[16:19], v[112:115]
  buffer_load_dwordx4 a[124:127], v225, s[4:7], s40 offen offset:3072 sc1
  v_mfma_f32_16x16x32_bf16 v[144:147], a[224:227], a[4:7], v[144:147]
  ds_read_b64_tr_b16 a[222:223], v229 offset:38912
  s_mov_b32 s41, 6881280
  v_mfma_f32_16x16x32_bf16 v[144:147], a[228:231], a[20:23], v[144:147]
  s_add_u32 m0, s42, 98304
  v_mfma_f32_16x16x32_bf16 v[176:179], a[224:227], a[8:11], v[176:179]
  v_mfma_f32_16x16x32_bf16 v[176:179], a[228:231], a[24:27], v[176:179]
  v_mfma_f32_16x16x32_bf16 v[208:211], a[224:227], a[12:15], v[208:211]
  ds_read_b64_tr_b16 a[224:225], v228 offset:40960
  v_mfma_f32_16x16x32_bf16 v[208:211], a[228:231], a[28:31], v[208:211]
  buffer_load_dwordx4 v227, s[12:15], s41 offen lds
  v_mfma_f32_16x16x32_bf16 v[116:119], a[232:235], a[0:3], v[116:119]
  ds_read_b64_tr_b16 a[226:227], v228 offset:43008
  s_mov_b32 s41, 7110656
  v_mfma_f32_16x16x32_bf16 v[116:119], a[236:239], a[16:19], v[116:119]
  ds_read_b64_tr_b16 a[228:229], v228 offset:45056
  ds_read_b64_tr_b16 a[230:231], v228 offset:47104
  v_mfma_f32_16x16x32_bf16 v[148:151], a[232:235], a[4:7], v[148:151]
  s_add_u32 m0, s42, 102400
  v_mfma_f32_16x16x32_bf16 v[148:151], a[236:239], a[20:23], v[148:151]
  v_mfma_f32_16x16x32_bf16 v[180:183], a[232:235], a[8:11], v[180:183]
  v_mfma_f32_16x16x32_bf16 v[180:183], a[236:239], a[24:27], v[180:183]
  buffer_load_dwordx4 v227, s[12:15], s41 offen lds
  s_load_dwordx2 s[66:67], s[22:23], 0xc0000
  v_mfma_f32_16x16x32_bf16 v[212:215], a[232:235], a[12:15], v[212:215]
  ds_read_b64_tr_b16 a[232:233], v229 offset:40960
  s_mov_b32 s41, 6881280
  v_mfma_f32_16x16x32_bf16 v[212:215], a[236:239], a[28:31], v[212:215]
  ds_read_b64_tr_b16 a[234:235], v229 offset:43008
  s_add_u32 m0, s42, 106496
  s_waitcnt lgkmcnt(13)
  v_mfma_f32_16x16x32_bf16 v[120:123], a[192:195], a[0:3], v[120:123]
  ds_read_b64_tr_b16 a[236:237], v229 offset:45056
  v_mfma_f32_16x16x32_bf16 v[120:123], a[196:199], a[16:19], v[120:123]
  ds_read_b64_tr_b16 a[238:239], v229 offset:47104
  v_mfma_f32_16x16x32_bf16 v[152:155], a[192:195], a[4:7], v[152:155]
  v_mfma_f32_16x16x32_bf16 v[152:155], a[196:199], a[20:23], v[152:155]
  buffer_load_dwordx4 v227, s[16:19], s41 offen lds
  v_mfma_f32_16x16x32_bf16 v[184:187], a[192:195], a[8:11], v[184:187]
  s_mov_b32 s41, 7110656
  s_add_u32 m0, s42, 110592
  v_mfma_f32_16x16x32_bf16 v[184:187], a[196:199], a[24:27], v[184:187]
  v_mfma_f32_16x16x32_bf16 v[216:219], a[192:195], a[12:15], v[216:219]
  ds_read_b64_tr_b16 a[192:193], v230 offset:32768
  v_mfma_f32_16x16x32_bf16 v[216:219], a[196:199], a[28:31], v[216:219]
  ds_read_b64_tr_b16 a[194:195], v230 offset:34816
  v_mfma_f32_16x16x32_bf16 v[124:127], a[200:203], a[0:3], v[124:127]
  ds_read_b64_tr_b16 a[196:197], v230 offset:36864
  v_mfma_f32_16x16x32_bf16 v[124:127], a[204:207], a[16:19], v[124:127]
  buffer_load_dwordx4 v227, s[16:19], s41 offen lds
  v_mfma_f32_16x16x32_bf16 v[156:159], a[200:203], a[4:7], v[156:159]
  ds_read_b64_tr_b16 a[198:199], v230 offset:38912
  s_mov_b32 s40, 23592960
  v_mfma_f32_16x16x32_bf16 v[156:159], a[204:207], a[20:23], v[156:159]
  v_mfma_f32_16x16x32_bf16 v[188:191], a[200:203], a[8:11], v[188:191]
  v_mfma_f32_16x16x32_bf16 v[188:191], a[204:207], a[24:27], v[188:191]
  v_mfma_f32_16x16x32_bf16 v[220:223], a[200:203], a[12:15], v[220:223]
  ds_read_b64_tr_b16 a[200:201], v230 offset:40960
  v_mfma_f32_16x16x32_bf16 v[220:223], a[204:207], a[28:31], v[220:223]
  buffer_load_dwordx4 a[128:131], v225, s[4:7], s40 offen offset:0 sc1
  s_waitcnt lgkmcnt(13)
  v_mfma_f32_16x16x32_bf16 v[0:3], a[208:211], a[32:35], v[0:3]
  ds_read_b64_tr_b16 a[202:203], v230 offset:43008
  s_waitcnt vmcnt(31)
  v_mfma_f32_16x16x32_bf16 v[0:3], a[212:215], a[48:51], v[0:3]
  ds_read_b64_tr_b16 a[204:205], v230 offset:45056
  ds_read_b64_tr_b16 a[206:207], v230 offset:47104
  v_mfma_f32_16x16x32_bf16 v[16:19], a[208:211], a[36:39], v[16:19]
  v_mfma_f32_16x16x32_bf16 v[16:19], a[212:215], a[52:55], v[16:19]
  s_load_dwordx2 s[66:67], s[22:23], 0xe0000
  v_mfma_f32_16x16x32_bf16 v[32:35], a[208:211], a[40:43], v[32:35]
  v_mfma_f32_16x16x32_bf16 v[32:35], a[212:215], a[56:59], v[32:35]
  buffer_load_dwordx4 a[132:135], v225, s[4:7], s40 offen offset:1024 sc1
  v_mfma_f32_16x16x32_bf16 v[48:51], a[208:211], a[44:47], v[48:51]
  ds_read_b64_tr_b16 a[208:209], v228 offset:49152
  v_mfma_f32_16x16x32_bf16 v[48:51], a[212:215], a[60:63], v[48:51]
  ds_read_b64_tr_b16 a[210:211], v228 offset:51200
  v_mfma_f32_16x16x32_bf16 v[4:7], a[216:219], a[32:35], v[4:7]
  ds_read_b64_tr_b16 a[212:213], v228 offset:53248
  v_mfma_f32_16x16x32_bf16 v[4:7], a[220:223], a[48:51], v[4:7]
  ds_read_b64_tr_b16 a[214:215], v228 offset:55296
  v_mfma_f32_16x16x32_bf16 v[20:23], a[216:219], a[36:39], v[20:23]
  v_mfma_f32_16x16x32_bf16 v[20:23], a[220:223], a[52:55], v[20:23]
  buffer_load_dwordx4 a[136:139], v225, s[4:7], s40 offen offset:2048 sc1
  v_mfma_f32_16x16x32_bf16 v[36:39], a[216:219], a[40:43], v[36:39]
  v_mfma_f32_16x16x32_bf16 v[36:39], a[220:223], a[56:59], v[36:39]
  v_mfma_f32_16x16x32_bf16 v[52:55], a[216:219], a[44:47], v[52:55]
  ds_read_b64_tr_b16 a[216:217], v229 offset:49152
  v_mfma_f32_16x16x32_bf16 v[52:55], a[220:223], a[60:63], v[52:55]
  ds_read_b64_tr_b16 a[218:219], v229 offset:51200
  s_waitcnt lgkmcnt(13)
  v_mfma_f32_16x16x32_bf16 v[8:11], a[224:227], a[32:35], v[8:11]
  ds_read_b64_tr_b16 a[220:221], v229 offset:53248
  v_mfma_f32_16x16x32_bf16 v[8:11], a[228:231], a[48:51], v[8:11]
  s_waitcnt vmcnt(27)
  s_barrier
  v_mfma_f32_16x16x32_bf16 v[24:27], a[224:227], a[36:39], v[24:27]
  buffer_load_dwordx4 a[140:143], v225, s[4:7], s40 offen offset:3072 sc1
  v_mfma_f32_16x16x32_bf16 v[24:27], a[228:231], a[52:55], v[24:27]
  ds_read_b64_tr_b16 a[222:223], v229 offset:55296
  s_mov_b32 s40, 23724032
  v_mfma_f32_16x16x32_bf16 v[40:43], a[224:227], a[40:43], v[40:43]
  v_mfma_f32_16x16x32_bf16 v[40:43], a[228:231], a[56:59], v[40:43]
  v_mfma_f32_16x16x32_bf16 v[56:59], a[224:227], a[44:47], v[56:59]
  ds_read_b64_tr_b16 a[224:225], v228 offset:57344
  v_mfma_f32_16x16x32_bf16 v[56:59], a[228:231], a[60:63], v[56:59]
  buffer_load_dwordx4 a[144:147], v225, s[4:7], s40 offen offset:0 sc1
  v_mfma_f32_16x16x32_bf16 v[12:15], a[232:235], a[32:35], v[12:15]
  ds_read_b64_tr_b16 a[226:227], v228 offset:59392
  v_mfma_f32_16x16x32_bf16 v[12:15], a[236:239], a[48:51], v[12:15]
  ds_read_b64_tr_b16 a[228:229], v228 offset:61440
  ds_read_b64_tr_b16 a[230:231], v228 offset:63488
  v_mfma_f32_16x16x32_bf16 v[28:31], a[232:235], a[36:39], v[28:31]
  v_mfma_f32_16x16x32_bf16 v[28:31], a[236:239], a[52:55], v[28:31]
  v_mfma_f32_16x16x32_bf16 v[44:47], a[232:235], a[40:43], v[44:47]
  v_mfma_f32_16x16x32_bf16 v[44:47], a[236:239], a[56:59], v[44:47]
L_wk0_5:
  s_cbranch_vccnz L_wk0_9
  buffer_load_dwordx4 a[148:151], v225, s[4:7], s40 offen offset:1024 sc1
  v_mfma_f32_16x16x32_bf16 v[60:63], a[232:235], a[44:47], v[60:63]
  ds_read_b64_tr_b16 a[232:233], v229 offset:57344
  v_mfma_f32_16x16x32_bf16 v[60:63], a[236:239], a[60:63], v[60:63]
  ds_read_b64_tr_b16 a[234:235], v229 offset:59392
  s_waitcnt lgkmcnt(13)
  v_mfma_f32_16x16x32_bf16 v[64:67], a[192:195], a[32:35], v[64:67]
  ds_read_b64_tr_b16 a[236:237], v229 offset:61440
  v_mfma_f32_16x16x32_bf16 v[64:67], a[196:199], a[48:51], v[64:67]
  ds_read_b64_tr_b16 a[238:239], v229 offset:63488
  v_mfma_f32_16x16x32_bf16 v[72:75], a[192:195], a[36:39], v[72:75]
  v_mfma_f32_16x16x32_bf16 v[72:75], a[196:199], a[52:55], v[72:75]
  buffer_load_dwordx4 a[152:155], v225, s[4:7], s40 offen offset:2048 sc1
  v_mfma_f32_16x16x32_bf16 v[80:83], a[192:195], a[40:43], v[80:83]
  v_mfma_f32_16x16x32_bf16 v[80:83], a[196:199], a[56:59], v[80:83]
  v_mfma_f32_16x16x32_bf16 v[88:91], a[192:195], a[44:47], v[88:91]
  ds_read_b64_tr_b16 a[192:193], v230 offset:49152
  v_mfma_f32_16x16x32_bf16 v[88:91], a[196:199], a[60:63], v[88:91]
  ds_read_b64_tr_b16 a[194:195], v230 offset:51200
  v_mfma_f32_16x16x32_bf16 v[68:71], a[200:203], a[32:35], v[68:71]
  ds_read_b64_tr_b16 a[196:197], v230 offset:53248
  v_mfma_f32_16x16x32_bf16 v[68:71], a[204:207], a[48:51], v[68:71]
  buffer_load_dwordx4 a[156:159], v225, s[4:7], s40 offen offset:3072 sc1
  v_mfma_f32_16x16x32_bf16 v[76:79], a[200:203], a[36:39], v[76:79]
  ds_read_b64_tr_b16 a[198:199], v230 offset:55296
  s_mov_b32 s41, 5046272
  v_mfma_f32_16x16x32_bf16 v[76:79], a[204:207], a[52:55], v[76:79]
  s_add_u32 m0, s42, 114688
  v_mfma_f32_16x16x32_bf16 v[84:87], a[200:203], a[40:43], v[84:87]
  v_mfma_f32_16x16x32_bf16 v[84:87], a[204:207], a[56:59], v[84:87]
  v_mfma_f32_16x16x32_bf16 v[92:95], a[200:203], a[44:47], v[92:95]
  ds_read_b64_tr_b16 a[200:201], v230 offset:57344
  v_mfma_f32_16x16x32_bf16 v[92:95], a[204:207], a[60:63], v[92:95]
  buffer_load_dwordx4 v226, s[12:15], s41 offen lds
  s_waitcnt vmcnt(29) lgkmcnt(13)
  v_mfma_f32_16x16x32_bf16 v[0:3], a[208:211], a[64:67], v[0:3]
  ds_read_b64_tr_b16 a[202:203], v230 offset:59392
  s_mov_b32 s41, 5275648
  s_waitcnt vmcnt(25)
  v_mfma_f32_16x16x32_bf16 v[0:3], a[212:215], a[80:83], v[0:3]
  ds_read_b64_tr_b16 a[204:205], v230 offset:61440
  ds_read_b64_tr_b16 a[206:207], v230 offset:63488
  v_mfma_f32_16x16x32_bf16 v[16:19], a[208:211], a[68:71], v[16:19]
  s_add_u32 m0, s42, 118784
  v_mfma_f32_16x16x32_bf16 v[16:19], a[212:215], a[84:87], v[16:19]
  v_mfma_f32_16x16x32_bf16 v[32:35], a[208:211], a[72:75], v[32:35]
  v_mfma_f32_16x16x32_bf16 v[32:35], a[212:215], a[88:91], v[32:35]
  buffer_load_dwordx4 v226, s[12:15], s41 offen lds
  v_mfma_f32_16x16x32_bf16 v[48:51], a[208:211], a[76:79], v[48:51]
  ds_read_b64_tr_b16 a[208:209], v232 offset:0
  s_mov_b32 s41, 5046272
  v_mfma_f32_16x16x32_bf16 v[48:51], a[212:215], a[92:95], v[48:51]
  ds_read_b64_tr_b16 a[210:211], v232 offset:2048
  s_add_u32 m0, s42, 122880
  v_mfma_f32_16x16x32_bf16 v[4:7], a[216:219], a[64:67], v[4:7]
  ds_read_b64_tr_b16 a[212:213], v232 offset:4096
  v_mfma_f32_16x16x32_bf16 v[4:7], a[220:223], a[80:83], v[4:7]
  ds_read_b64_tr_b16 a[214:215], v232 offset:6144
  v_mfma_f32_16x16x32_bf16 v[20:23], a[216:219], a[68:71], v[20:23]
  v_mfma_f32_16x16x32_bf16 v[20:23], a[220:223], a[84:87], v[20:23]
  buffer_load_dwordx4 v226, s[16:19], s41 offen lds
  v_mfma_f32_16x16x32_bf16 v[36:39], a[216:219], a[72:75], v[36:39]
  s_mov_b32 s41, 5275648
  s_add_u32 m0, s42, 126976
  v_mfma_f32_16x16x32_bf16 v[36:39], a[220:223], a[88:91], v[36:39]
  v_mfma_f32_16x16x32_bf16 v[52:55], a[216:219], a[76:79], v[52:55]
  ds_read_b64_tr_b16 a[216:217], v233 offset:0
  v_mfma_f32_16x16x32_bf16 v[52:55], a[220:223], a[92:95], v[52:55]
  ds_read_b64_tr_b16 a[218:219], v233 offset:2048
  s_waitcnt lgkmcnt(13)
  v_mfma_f32_16x16x32_bf16 v[8:11], a[224:227], a[64:67], v[8:11]
  ds_read_b64_tr_b16 a[220:221], v233 offset:4096
  v_mfma_f32_16x16x32_bf16 v[8:11], a[228:231], a[80:83], v[8:11]
  buffer_load_dwordx4 v226, s[16:19], s41 offen lds
  v_mfma_f32_16x16x32_bf16 v[24:27], a[224:227], a[68:71], v[24:27]
  ds_read_b64_tr_b16 a[222:223], v233 offset:6144
  s_mov_b32 s41, 5505024
  v_mfma_f32_16x16x32_bf16 v[24:27], a[228:231], a[84:87], v[24:27]
  s_add_u32 m0, s42, 131072
  v_mfma_f32_16x16x32_bf16 v[40:43], a[224:227], a[72:75], v[40:43]
  v_mfma_f32_16x16x32_bf16 v[40:43], a[228:231], a[88:91], v[40:43]
  v_mfma_f32_16x16x32_bf16 v[56:59], a[224:227], a[76:79], v[56:59]
  ds_read_b64_tr_b16 a[224:225], v232 offset:8192
  v_mfma_f32_16x16x32_bf16 v[56:59], a[228:231], a[92:95], v[56:59]
  buffer_load_dwordx4 v226, s[12:15], s41 offen lds
  v_mfma_f32_16x16x32_bf16 v[12:15], a[232:235], a[64:67], v[12:15]
  ds_read_b64_tr_b16 a[226:227], v232 offset:10240
  s_mov_b32 s41, 5734400
  v_mfma_f32_16x16x32_bf16 v[12:15], a[236:239], a[80:83], v[12:15]
  s_waitcnt vmcnt(25)
  s_barrier
  v_mfma_f32_16x16x32_bf16 v[28:31], a[232:235], a[68:71], v[28:31]
  ds_read_b64_tr_b16 a[228:229], v232 offset:12288
  ds_read_b64_tr_b16 a[230:231], v232 offset:14336
  v_mfma_f32_16x16x32_bf16 v[28:31], a[236:239], a[84:87], v[28:31]
  s_add_u32 m0, s42, 135168
  v_mfma_f32_16x16x32_bf16 v[44:47], a[232:235], a[72:75], v[44:47]
  v_mfma_f32_16x16x32_bf16 v[44:47], a[236:239], a[88:91], v[44:47]
  buffer_load_dwordx4 v226, s[12:15], s41 offen lds
  v_mfma_f32_16x16x32_bf16 v[60:63], a[232:235], a[76:79], v[60:63]
  ds_read_b64_tr_b16 a[232:233], v233 offset:8192
  s_mov_b32 s40, 23855104
  v_mfma_f32_16x16x32_bf16 v[60:63], a[236:239], a[92:95], v[60:63]
  ds_read_b64_tr_b16 a[234:235], v233 offset:10240
  s_waitcnt lgkmcnt(13)
  v_mfma_f32_16x16x32_bf16 v[64:67], a[192:195], a[64:67], v[64:67]
  ds_read_b64_tr_b16 a[236:237], v233 offset:12288
  v_mfma_f32_16x16x32_bf16 v[64:67], a[196:199], a[80:83], v[64:67]
  ds_read_b64_tr_b16 a[238:239], v233 offset:14336
  v_mfma_f32_16x16x32_bf16 v[72:75], a[192:195], a[68:71], v[72:75]
  v_mfma_f32_16x16x32_bf16 v[72:75], a[196:199], a[84:87], v[72:75]
  buffer_load_dwordx4 a[160:163], v225, s[4:7], s40 offen offset:0 sc1
  v_mfma_f32_16x16x32_bf16 v[80:83], a[192:195], a[72:75], v[80:83]
  v_mfma_f32_16x16x32_bf16 v[80:83], a[196:199], a[88:91], v[80:83]
  v_mfma_f32_16x16x32_bf16 v[88:91], a[192:195], a[76:79], v[88:91]
  ds_read_b64_tr_b16 a[192:193], v234 offset:0
  v_mfma_f32_16x16x32_bf16 v[88:91], a[196:199], a[92:95], v[88:91]
  ds_read_b64_tr_b16 a[194:195], v234 offset:2048
  v_mfma_f32_16x16x32_bf16 v[68:71], a[200:203], a[64:67], v[68:71]
  ds_read_b64_tr_b16 a[196:197], v234 offset:4096
  v_mfma_f32_16x16x32_bf16 v[68:71], a[204:207], a[80:83], v[68:71]
  buffer_load_dwordx4 a[164:167], v225, s[4:7], s40 offen offset:1024 sc1
  v_mfma_f32_16x16x32_bf16 v[76:79], a[200:203], a[68:71], v[76:79]
  ds_read_b64_tr_b16 a[198:199], v234 offset:6144
  v_mfma_f32_16x16x32_bf16 v[76:79], a[204:207], a[84:87], v[76:79]
  v_mfma_f32_16x16x32_bf16 v[84:87], a[200:203], a[72:75], v[84:87]
  v_mfma_f32_16x16x32_bf16 v[84:87], a[204:207], a[88:91], v[84:87]
  v_mfma_f32_16x16x32_bf16 v[92:95], a[200:203], a[76:79], v[92:95]
  ds_read_b64_tr_b16 a[200:201], v234 offset:8192
  v_mfma_f32_16x16x32_bf16 v[92:95], a[204:207], a[92:95], v[92:95]
  buffer_load_dwordx4 a[168:171], v225, s[4:7], s40 offen offset:2048 sc1
  s_waitcnt vmcnt(25) lgkmcnt(13)
  v_mfma_f32_16x16x32_bf16 v[0:3], a[208:211], a[96:99], v[0:3]
  ds_read_b64_tr_b16 a[202:203], v234 offset:10240
  s_waitcnt vmcnt(21)
  v_mfma_f32_16x16x32_bf16 v[0:3], a[212:215], a[112:115], v[0:3]
  ds_read_b64_tr_b16 a[204:205], v234 offset:12288
  ds_read_b64_tr_b16 a[206:207], v234 offset:14336
  v_mfma_f32_16x16x32_bf16 v[16:19], a[208:211], a[100:103], v[16:19]
  v_mfma_f32_16x16x32_bf16 v[16:19], a[212:215], a[116:119], v[16:19]
  v_mfma_f32_16x16x32_bf16 v[32:35], a[208:211], a[104:107], v[32:35]
  v_mfma_f32_16x16x32_bf16 v[32:35], a[212:215], a[120:123], v[32:35]
  buffer_load_dwordx4 a[172:175], v225, s[4:7], s40 offen offset:3072 sc1
  v_mfma_f32_16x16x32_bf16 v[48:51], a[208:211], a[108:111], v[48:51]
  ds_read_b64_tr_b16 a[208:209], v232 offset:16384
  s_mov_b32 s40, 23986176
  v_mfma_f32_16x16x32_bf16 v[48:51], a[212:215], a[124:127], v[48:51]
  ds_read_b64_tr_b16 a[210:211], v232 offset:18432
  v_mfma_f32_16x16x32_bf16 v[4:7], a[216:219], a[96:99], v[4:7]
  ds_read_b64_tr_b16 a[212:213], v232 offset:20480
  v_mfma_f32_16x16x32_bf16 v[4:7], a[220:223], a[112:115], v[4:7]
  ds_read_b64_tr_b16 a[214:215], v232 offset:22528
  v_mfma_f32_16x16x32_bf16 v[20:23], a[216:219], a[100:103], v[20:23]
  v_mfma_f32_16x16x32_bf16 v[20:23], a[220:223], a[116:119], v[20:23]
  buffer_load_dwordx4 a[176:179], v225, s[4:7], s40 offen offset:0 sc1
  v_mfma_f32_16x16x32_bf16 v[36:39], a[216:219], a[104:107], v[36:39]
  v_mfma_f32_16x16x32_bf16 v[36:39], a[220:223], a[120:123], v[36:39]
  v_mfma_f32_16x16x32_bf16 v[52:55], a[216:219], a[108:111], v[52:55]
  ds_read_b64_tr_b16 a[216:217], v233 offset:16384
  v_mfma_f32_16x16x32_bf16 v[52:55], a[220:223], a[124:127], v[52:55]
  ds_read_b64_tr_b16 a[218:219], v233 offset:18432
  s_waitcnt lgkmcnt(13)
  v_mfma_f32_16x16x32_bf16 v[8:11], a[224:227], a[96:99], v[8:11]
  ds_read_b64_tr_b16 a[220:221], v233 offset:20480
  v_mfma_f32_16x16x32_bf16 v[8:11], a[228:231], a[112:115], v[8:11]
  buffer_load_dwordx4 a[180:183], v225, s[4:7], s40 offen offset:1024 sc1
  v_mfma_f32_16x16x32_bf16 v[24:27], a[224:227], a[100:103], v[24:27]
L_k56_seam:
  ds_read_b64_tr_b16 a[222:223], v233 offset:22528
  v_mfma_f32_16x16x32_bf16 v[24:27], a[228:231], a[116:119], v[24:27]
  v_mfma_f32_16x16x32_bf16 v[40:43], a[224:227], a[104:107], v[40:43]
  v_mfma_f32_16x16x32_bf16 v[40:43], a[228:231], a[120:123], v[40:43]
  v_mfma_f32_16x16x32_bf16 v[56:59], a[224:227], a[108:111], v[56:59]
  ds_read_b64_tr_b16 a[224:225], v232 offset:24576
  v_mfma_f32_16x16x32_bf16 v[56:59], a[228:231], a[124:127], v[56:59]
  buffer_load_dwordx4 a[184:187], v225, s[4:7], s40 offen offset:2048 sc1
  v_mfma_f32_16x16x32_bf16 v[12:15], a[232:235], a[96:99], v[12:15]
  ds_read_b64_tr_b16 a[226:227], v232 offset:26624
  v_mfma_f32_16x16x32_bf16 v[12:15], a[236:239], a[112:115], v[12:15]
  ds_read_b64_tr_b16 a[228:229], v232 offset:28672
  ds_read_b64_tr_b16 a[230:231], v232 offset:30720
  v_mfma_f32_16x16x32_bf16 v[28:31], a[232:235], a[100:103], v[28:31]
  v_mfma_f32_16x16x32_bf16 v[28:31], a[236:239], a[116:119], v[28:31]
  v_mfma_f32_16x16x32_bf16 v[44:47], a[232:235], a[104:107], v[44:47]
  v_mfma_f32_16x16x32_bf16 v[44:47], a[236:239], a[120:123], v[44:47]
  buffer_load_dwordx4 a[188:191], v225, s[4:7], s40 offen offset:3072 sc1
  v_mfma_f32_16x16x32_bf16 v[60:63], a[232:235], a[108:111], v[60:63]
  ds_read_b64_tr_b16 a[232:233], v233 offset:24576
  s_mov_b32 s41, 5505024
  v_mfma_f32_16x16x32_bf16 v[60:63], a[236:239], a[124:127], v[60:63]
  ds_read_b64_tr_b16 a[234:235], v233 offset:26624
  s_add_u32 m0, s42, 139264
  s_waitcnt lgkmcnt(13)
  v_mfma_f32_16x16x32_bf16 v[64:67], a[192:195], a[96:99], v[64:67]
  ds_read_b64_tr_b16 a[236:237], v233 offset:28672
  v_mfma_f32_16x16x32_bf16 v[64:67], a[196:199], a[112:115], v[64:67]
  s_waitcnt vmcnt(22)
  s_barrier
  v_mfma_f32_16x16x32_bf16 v[72:75], a[192:195], a[100:103], v[72:75]
  ds_read_b64_tr_b16 a[238:239], v233 offset:30720
  v_mfma_f32_16x16x32_bf16 v[72:75], a[196:199], a[116:119], v[72:75]
  buffer_load_dwordx4 v226, s[16:19], s41 offen lds
  v_mfma_f32_16x16x32_bf16 v[80:83], a[192:195], a[104:107], v[80:83]
  s_mov_b32 s41, 5734400
  s_add_u32 m0, s42, 143360
  v_mfma_f32_16x16x32_bf16 v[80:83], a[196:199], a[120:123], v[80:83]
  v_mfma_f32_16x16x32_bf16 v[88:91], a[192:195], a[108:111], v[88:91]
  ds_read_b64_tr_b16 a[192:193], v234 offset:16384
  v_mfma_f32_16x16x32_bf16 v[88:91], a[196:199], a[124:127], v[88:91]
  ds_read_b64_tr_b16 a[194:195], v234 offset:18432
  v_mfma_f32_16x16x32_bf16 v[68:71], a[200:203], a[96:99], v[68:71]
  ds_read_b64_tr_b16 a[196:197], v234 offset:20480
  v_mfma_f32_16x16x32_bf16 v[68:71], a[204:207], a[112:115], v[68:71]
  buffer_load_dwordx4 v226, s[16:19], s41 offen lds
  v_mfma_f32_16x16x32_bf16 v[76:79], a[200:203], a[100:103], v[76:79]
  ds_read_b64_tr_b16 a[198:199], v234 offset:22528
  s_mov_b32 s41, 5963776
  v_mfma_f32_16x16x32_bf16 v[76:79], a[204:207], a[116:119], v[76:79]
  s_add_u32 m0, s42, 147456
  v_mfma_f32_16x16x32_bf16 v[84:87], a[200:203], a[104:107], v[84:87]
  v_mfma_f32_16x16x32_bf16 v[84:87], a[204:207], a[120:123], v[84:87]
  v_mfma_f32_16x16x32_bf16 v[92:95], a[200:203], a[108:111], v[92:95]
  ds_read_b64_tr_b16 a[200:201], v234 offset:24576
  v_mfma_f32_16x16x32_bf16 v[92:95], a[204:207], a[124:127], v[92:95]
  buffer_load_dwordx4 v226, s[12:15], s41 offen lds
  s_waitcnt vmcnt(21) lgkmcnt(13)
  v_mfma_f32_16x16x32_bf16 v[0:3], a[208:211], a[128:131], v[0:3]
  ds_read_b64_tr_b16 a[202:203], v234 offset:26624
  s_mov_b32 s41, 6193152
  s_waitcnt vmcnt(17)
  v_mfma_f32_16x16x32_bf16 v[0:3], a[212:215], a[144:147], v[0:3]
  ds_read_b64_tr_b16 a[204:205], v234 offset:28672
  ds_read_b64_tr_b16 a[206:207], v234 offset:30720
  v_mfma_f32_16x16x32_bf16 v[16:19], a[208:211], a[132:135], v[16:19]
  s_add_u32 m0, s42, 151552
  v_mfma_f32_16x16x32_bf16 v[16:19], a[212:215], a[148:151], v[16:19]
  v_mfma_f32_16x16x32_bf16 v[32:35], a[208:211], a[136:139], v[32:35]
  v_mfma_f32_16x16x32_bf16 v[32:35], a[212:215], a[152:155], v[32:35]
  buffer_load_dwordx4 v226, s[12:15], s41 offen lds
  v_mfma_f32_16x16x32_bf16 v[48:51], a[208:211], a[140:143], v[48:51]
  ds_read_b64_tr_b16 a[208:209], v232 offset:32768
  s_mov_b32 s41, 5963776
  v_mfma_f32_16x16x32_bf16 v[48:51], a[212:215], a[156:159], v[48:51]
  ds_read_b64_tr_b16 a[210:211], v232 offset:34816
  s_add_u32 m0, s42, 155648
  v_mfma_f32_16x16x32_bf16 v[4:7], a[216:219], a[128:131], v[4:7]
  ds_read_b64_tr_b16 a[212:213], v232 offset:36864
  v_mfma_f32_16x16x32_bf16 v[4:7], a[220:223], a[144:147], v[4:7]
  ds_read_b64_tr_b16 a[214:215], v232 offset:38912
  v_mfma_f32_16x16x32_bf16 v[20:23], a[216:219], a[132:135], v[20:23]
  v_mfma_f32_16x16x32_bf16 v[20:23], a[220:223], a[148:151], v[20:23]
  buffer_load_dwordx4 v226, s[16:19], s41 offen lds
  v_mfma_f32_16x16x32_bf16 v[36:39], a[216:219], a[136:139], v[36:39]
  s_mov_b32 s41, 6193152
  s_add_u32 m0, s42, 159744
  v_mfma_f32_16x16x32_bf16 v[36:39], a[220:223], a[152:155], v[36:39]
  v_mfma_f32_16x16x32_bf16 v[52:55], a[216:219], a[140:143], v[52:55]
  ds_read_b64_tr_b16 a[216:217], v233 offset:32768
  v_mfma_f32_16x16x32_bf16 v[52:55], a[220:223], a[156:159], v[52:55]
  ds_read_b64_tr_b16 a[218:219], v233 offset:34816
  s_waitcnt lgkmcnt(13)
  v_mfma_f32_16x16x32_bf16 v[8:11], a[224:227], a[128:131], v[8:11]
  ds_read_b64_tr_b16 a[220:221], v233 offset:36864
  v_mfma_f32_16x16x32_bf16 v[8:11], a[228:231], a[144:147], v[8:11]
  buffer_load_dwordx4 v226, s[16:19], s41 offen lds
  v_mfma_f32_16x16x32_bf16 v[24:27], a[224:227], a[132:135], v[24:27]
  ds_read_b64_tr_b16 a[222:223], v233 offset:38912
  s_mov_b32 s41, 6422528
  v_mfma_f32_16x16x32_bf16 v[24:27], a[228:231], a[148:151], v[24:27]
  s_add_u32 m0, s42, 8192
  v_mfma_f32_16x16x32_bf16 v[40:43], a[224:227], a[136:139], v[40:43]
  v_mfma_f32_16x16x32_bf16 v[40:43], a[228:231], a[152:155], v[40:43]
  v_mfma_f32_16x16x32_bf16 v[56:59], a[224:227], a[140:143], v[56:59]
  ds_read_b64_tr_b16 a[224:225], v232 offset:40960
  v_mfma_f32_16x16x32_bf16 v[56:59], a[228:231], a[156:159], v[56:59]
  buffer_load_dwordx4 v226, s[12:15], s41 offen lds
  v_mfma_f32_16x16x32_bf16 v[12:15], a[232:235], a[128:131], v[12:15]
  ds_read_b64_tr_b16 a[226:227], v232 offset:43008
  s_mov_b32 s41, 6651904
  v_mfma_f32_16x16x32_bf16 v[12:15], a[236:239], a[144:147], v[12:15]
  ds_read_b64_tr_b16 a[228:229], v232 offset:45056
  ds_read_b64_tr_b16 a[230:231], v232 offset:47104
  v_mfma_f32_16x16x32_bf16 v[28:31], a[232:235], a[132:135], v[28:31]
  s_add_u32 m0, s42, 12288
  v_mfma_f32_16x16x32_bf16 v[28:31], a[236:239], a[148:151], v[28:31]
  v_mfma_f32_16x16x32_bf16 v[44:47], a[232:235], a[136:139], v[44:47]
  v_mfma_f32_16x16x32_bf16 v[44:47], a[236:239], a[152:155], v[44:47]
  buffer_load_dwordx4 v226, s[12:15], s41 offen lds
  v_mfma_f32_16x16x32_bf16 v[60:63], a[232:235], a[140:143], v[60:63]
  ds_read_b64_tr_b16 a[232:233], v233 offset:40960
  s_mov_b32 s41, 6422528
  v_mfma_f32_16x16x32_bf16 v[60:63], a[236:239], a[156:159], v[60:63]
  ds_read_b64_tr_b16 a[234:235], v233 offset:43008
  s_add_u32 m0, s42, 16384
  s_waitcnt lgkmcnt(13)
  v_mfma_f32_16x16x32_bf16 v[64:67], a[192:195], a[128:131], v[64:67]
  ds_read_b64_tr_b16 a[236:237], v233 offset:45056
  v_mfma_f32_16x16x32_bf16 v[64:67], a[196:199], a[144:147], v[64:67]
  ds_read_b64_tr_b16 a[238:239], v233 offset:47104
  v_mfma_f32_16x16x32_bf16 v[72:75], a[192:195], a[132:135], v[72:75]
  v_mfma_f32_16x16x32_bf16 v[72:75], a[196:199], a[148:151], v[72:75]
  buffer_load_dwordx4 v226, s[16:19], s41 offen lds
  v_mfma_f32_16x16x32_bf16 v[80:83], a[192:195], a[136:139], v[80:83]
  s_mov_b32 s41, 6651904
  s_add_u32 m0, s42, 20480
  v_mfma_f32_16x16x32_bf16 v[80:83], a[196:199], a[152:155], v[80:83]
  v_mfma_f32_16x16x32_bf16 v[88:91], a[192:195], a[140:143], v[88:91]
  ds_read_b64_tr_b16 a[192:193], v234 offset:32768
  v_mfma_f32_16x16x32_bf16 v[88:91], a[196:199], a[156:159], v[88:91]
  ds_read_b64_tr_b16 a[194:195], v234 offset:34816
  v_mfma_f32_16x16x32_bf16 v[68:71], a[200:203], a[128:131], v[68:71]
  ds_read_b64_tr_b16 a[196:197], v234 offset:36864
  v_mfma_f32_16x16x32_bf16 v[68:71], a[204:207], a[144:147], v[68:71]
  s_waitcnt vmcnt(17)
  s_barrier
  v_mfma_f32_16x16x32_bf16 v[76:79], a[200:203], a[132:135], v[76:79]
  buffer_load_dwordx4 v226, s[16:19], s41 offen lds
  v_mfma_f32_16x16x32_bf16 v[76:79], a[204:207], a[148:151], v[76:79]
  ds_read_b64_tr_b16 a[198:199], v234 offset:38912
  s_mov_b32 s41, 6881280
  v_mfma_f32_16x16x32_bf16 v[84:87], a[200:203], a[136:139], v[84:87]
  s_add_u32 m0, s42, 24576
  v_mfma_f32_16x16x32_bf16 v[84:87], a[204:207], a[152:155], v[84:87]
  v_mfma_f32_16x16x32_bf16 v[92:95], a[200:203], a[140:143], v[92:95]
  ds_read_b64_tr_b16 a[200:201], v234 offset:40960
  v_mfma_f32_16x16x32_bf16 v[92:95], a[204:207], a[156:159], v[92:95]
  buffer_load_dwordx4 v226, s[12:15], s41 offen lds
  s_waitcnt vmcnt(15) lgkmcnt(13)
  v_mfma_f32_16x16x32_bf16 v[0:3], a[208:211], a[160:163], v[0:3]
  ds_read_b64_tr_b16 a[202:203], v234 offset:43008
  s_mov_b32 s41, 7110656
  s_waitcnt vmcnt(11)
  v_mfma_f32_16x16x32_bf16 v[0:3], a[212:215], a[176:179], v[0:3]
  ds_read_b64_tr_b16 a[204:205], v234 offset:45056
  ds_read_b64_tr_b16 a[206:207], v234 offset:47104
  v_mfma_f32_16x16x32_bf16 v[16:19], a[208:211], a[164:167], v[16:19]
  s_add_u32 m0, s42, 28672
  v_mfma_f32_16x16x32_bf16 v[16:19], a[212:215], a[180:183], v[16:19]
  v_mfma_f32_16x16x32_bf16 v[32:35], a[208:211], a[168:171], v[32:35]
  v_mfma_f32_16x16x32_bf16 v[32:35], a[212:215], a[184:187], v[32:35]
  buffer_load_dwordx4 v226, s[12:15], s41 offen lds
  v_mfma_f32_16x16x32_bf16 v[48:51], a[208:211], a[172:175], v[48:51]
  ds_read_b64_tr_b16 a[208:209], v232 offset:49152
  s_mov_b32 s41, 6881280
  v_mfma_f32_16x16x32_bf16 v[48:51], a[212:215], a[188:191], v[48:51]
  ds_read_b64_tr_b16 a[210:211], v232 offset:51200
  s_add_u32 m0, s42, 32768
  v_mfma_f32_16x16x32_bf16 v[4:7], a[216:219], a[160:163], v[4:7]
  ds_read_b64_tr_b16 a[212:213], v232 offset:53248
  v_mfma_f32_16x16x32_bf16 v[4:7], a[220:223], a[176:179], v[4:7]
  ds_read_b64_tr_b16 a[214:215], v232 offset:55296
  v_mfma_f32_16x16x32_bf16 v[20:23], a[216:219], a[164:167], v[20:23]
  v_mfma_f32_16x16x32_bf16 v[20:23], a[220:223], a[180:183], v[20:23]
  buffer_load_dwordx4 v226, s[16:19], s41 offen lds
  v_mfma_f32_16x16x32_bf16 v[36:39], a[216:219], a[168:171], v[36:39]
  s_mov_b32 s41, 7110656
  s_add_u32 m0, s42, 36864
  v_mfma_f32_16x16x32_bf16 v[36:39], a[220:223], a[184:187], v[36:39]
  v_mfma_f32_16x16x32_bf16 v[52:55], a[216:219], a[172:175], v[52:55]
  ds_read_b64_tr_b16 a[216:217], v233 offset:49152
  v_mfma_f32_16x16x32_bf16 v[52:55], a[220:223], a[188:191], v[52:55]
  ds_read_b64_tr_b16 a[218:219], v233 offset:51200
  s_waitcnt lgkmcnt(13)
  v_mfma_f32_16x16x32_bf16 v[8:11], a[224:227], a[160:163], v[8:11]
  ds_read_b64_tr_b16 a[220:221], v233 offset:53248
  v_mfma_f32_16x16x32_bf16 v[8:11], a[228:231], a[176:179], v[8:11]
  buffer_load_dwordx4 v226, s[16:19], s41 offen lds
  v_mfma_f32_16x16x32_bf16 v[24:27], a[224:227], a[164:167], v[24:27]
  ds_read_b64_tr_b16 a[222:223], v233 offset:55296
  s_mov_b32 s41, 131072
  v_mfma_f32_16x16x32_bf16 v[24:27], a[228:231], a[180:183], v[24:27]
  s_add_u32 m0, s42, 40960
  v_mfma_f32_16x16x32_bf16 v[40:43], a[224:227], a[168:171], v[40:43]
  v_mfma_f32_16x16x32_bf16 v[40:43], a[228:231], a[184:187], v[40:43]
  v_mfma_f32_16x16x32_bf16 v[56:59], a[224:227], a[172:175], v[56:59]
  ds_read_b64_tr_b16 a[224:225], v232 offset:57344
  v_mfma_f32_16x16x32_bf16 v[56:59], a[228:231], a[188:191], v[56:59]
  buffer_load_dwordx4 v242, s[44:47], s41 offen lds
  v_mfma_f32_16x16x32_bf16 v[12:15], a[232:235], a[160:163], v[12:15]
  ds_read_b64_tr_b16 a[226:227], v232 offset:59392
  s_mov_b32 s41, 393216
  v_mfma_f32_16x16x32_bf16 v[12:15], a[236:239], a[176:179], v[12:15]
  ds_read_b64_tr_b16 a[228:229], v232 offset:61440
  ds_read_b64_tr_b16 a[230:231], v232 offset:63488
  v_mfma_f32_16x16x32_bf16 v[28:31], a[232:235], a[164:167], v[28:31]
  s_add_u32 m0, s42, 45056
  v_mfma_f32_16x16x32_bf16 v[28:31], a[236:239], a[180:183], v[28:31]
  v_mfma_f32_16x16x32_bf16 v[44:47], a[232:235], a[168:171], v[44:47]
  v_mfma_f32_16x16x32_bf16 v[44:47], a[236:239], a[184:187], v[44:47]
  buffer_load_dwordx4 v242, s[44:47], s41 offen lds
  v_mfma_f32_16x16x32_bf16 v[60:63], a[232:235], a[172:175], v[60:63]
  ds_read_b64_tr_b16 a[232:233], v233 offset:57344
  s_mov_b32 s41, 131072
  v_mfma_f32_16x16x32_bf16 v[60:63], a[236:239], a[188:191], v[60:63]
  ds_read_b64_tr_b16 a[234:235], v233 offset:59392
  ds_read_b64_tr_b16 a[236:237], v233 offset:61440
  v_mul_f32 v0, s43, v0
  v_mul_f32 v1, s43, v1
  v_mul_f32 v2, s43, v2
  s_waitcnt lgkmcnt(13)
  v_mfma_f32_16x16x32_bf16 v[64:67], a[192:195], a[160:163], v[64:67]
  ds_read_b64_tr_b16 a[238:239], v233 offset:63488
  s_add_u32 m0, s42, 49152
  v_mul_f32 v3, s43, v3
  v_mul_f32 v4, s43, v4
  v_mul_f32 v5, s43, v5
  v_mul_f32 v6, s43, v6
  v_mfma_f32_16x16x32_bf16 v[64:67], a[196:199], a[176:179], v[64:67]
  v_mul_f32 v7, s43, v7
  v_exp_f32 v0, v0
  v_mfma_f32_16x16x32_bf16 v[72:75], a[192:195], a[164:167], v[72:75]
  v_exp_f32 v1, v1
  v_exp_f32 v2, v2
  v_mfma_f32_16x16x32_bf16 v[72:75], a[196:199], a[180:183], v[72:75]
  buffer_load_dwordx4 v253, s[44:47], s41 offen lds
  v_exp_f32 v3, v3
  v_exp_f32 v4, v4
  v_mfma_f32_16x16x32_bf16 v[80:83], a[192:195], a[168:171], v[80:83]
  s_mov_b32 s41, 393216
  s_add_u32 m0, s42, 53248
  v_exp_f32 v5, v5
  v_exp_f32 v6, v6
  v_mfma_f32_16x16x32_bf16 v[80:83], a[196:199], a[184:187], v[80:83]
  v_exp_f32 v7, v7
  v_add_f32 v0, 1.0, v0
  v_add_f32 v1, 1.0, v1
  v_add_f32 v2, 1.0, v2
  v_mfma_f32_16x16x32_bf16 v[88:91], a[192:195], a[172:175], v[88:91]
  ds_read_b64_tr_b16 a[192:193], v236 offset:0
  ds_read_b64_tr_b16 a[194:195], v236 offset:2048
  v_add_f32 v3, 1.0, v3
  v_add_f32 v4, 1.0, v4
  v_add_f32 v5, 1.0, v5
  v_add_f32 v6, 1.0, v6
  v_mfma_f32_16x16x32_bf16 v[88:91], a[196:199], a[188:191], v[88:91]
  ds_read_b64_tr_b16 a[196:197], v236 offset:4096
  ds_read_b64_tr_b16 a[198:199], v236 offset:6144
  v_add_f32 v7, 1.0, v7
  v_rcp_f32 v0, v0
  v_mfma_f32_16x16x32_bf16 v[68:71], a[200:203], a[160:163], v[68:71]
  v_rcp_f32 v1, v1
  v_rcp_f32 v2, v2
  v_mfma_f32_16x16x32_bf16 v[68:71], a[204:207], a[176:179], v[68:71]
  buffer_load_dwordx4 v253, s[44:47], s41 offen lds
  v_rcp_f32 v3, v3
  v_rcp_f32 v4, v4
  v_mfma_f32_16x16x32_bf16 v[76:79], a[200:203], a[164:167], v[76:79]
  s_mov_b32 s41, 458752
  s_add_u32 m0, s42, 57344
  v_rcp_f32 v5, v5
  v_rcp_f32 v6, v6
  v_mfma_f32_16x16x32_bf16 v[76:79], a[204:207], a[180:183], v[76:79]
  v_rcp_f32 v7, v7
  v_mul_f32 v0, v0, v8
  v_mul_f32 v1, v1, v9
  v_mul_f32 v2, v2, v10
  v_mfma_f32_16x16x32_bf16 v[84:87], a[200:203], a[168:171], v[84:87]
  v_mul_f32 v3, v3, v11
  v_mul_f32 v4, v4, v12
  v_mul_f32 v5, v5, v13
  v_mul_f32 v6, v6, v14
  v_mfma_f32_16x16x32_bf16 v[84:87], a[204:207], a[184:187], v[84:87]
  v_mul_f32 v7, v7, v15
  v_cvt_pk_bf16_f32 v0, v0, v1
  v_cvt_pk_bf16_f32 v1, v2, v3
  v_cvt_pk_bf16_f32 v2, v4, v5
  v_mfma_f32_16x16x32_bf16 v[92:95], a[200:203], a[172:175], v[92:95]
  ds_read_b64_tr_b16 a[200:201], v237 offset:0
  ds_read_b64_tr_b16 a[202:203], v237 offset:2048
  v_cvt_pk_bf16_f32 v3, v6, v7
  buffer_store_dwordx4 v[0:3], v225, s[4:7], s60 offen offset:0 sc1
  v_mul_f32 v16, s43, v16
  v_mfma_f32_16x16x32_bf16 v[92:95], a[204:207], a[188:191], v[92:95]
  ds_read_b64_tr_b16 a[204:205], v237 offset:4096
  ds_read_b64_tr_b16 a[206:207], v237 offset:6144
  v_mul_f32 v17, s43, v17
  v_mul_f32 v18, s43, v18
  v_mul_f32 v19, s43, v19
  v_mul_f32 v20, s43, v20
  v_mfma_f32_16x16x32_bf16 v[96:99], a[208:211], a[32:35], v[96:99]
  buffer_load_dwordx4 v242, s[44:47], s41 offen lds
  v_mul_f32 v21, s43, v21
  v_mul_f32 v22, s43, v22
  v_mul_f32 v23, s43, v23
  s_waitcnt lgkmcnt(13)
  v_mfma_f32_16x16x32_bf16 v[96:99], a[212:215], a[48:51], v[96:99]
  s_waitcnt vmcnt(12)
  s_barrier
  v_exp_f32 v16, v16
  v_exp_f32 v17, v17
  v_mfma_f32_16x16x32_bf16 v[128:131], a[208:211], a[36:39], v[128:131]
  s_mov_b32 s41, 720896
  s_add_u32 m0, s42, 61440
  v_exp_f32 v18, v18
  v_exp_f32 v19, v19
  v_mfma_f32_16x16x32_bf16 v[128:131], a[212:215], a[52:55], v[128:131]
  v_exp_f32 v20, v20
  v_exp_f32 v21, v21
  v_mfma_f32_16x16x32_bf16 v[160:163], a[208:211], a[40:43], v[160:163]
  v_exp_f32 v22, v22
  v_exp_f32 v23, v23
  v_add_f32 v16, 1.0, v16
  v_mfma_f32_16x16x32_bf16 v[160:163], a[212:215], a[56:59], v[160:163]
  buffer_load_dwordx4 v242, s[44:47], s41 offen lds
  v_add_f32 v17, 1.0, v17
  v_add_f32 v18, 1.0, v18
  v_add_f32 v19, 1.0, v19
  v_add_f32 v20, 1.0, v20
  v_mfma_f32_16x16x32_bf16 v[192:195], a[208:211], a[44:47], v[192:195]
  ds_read_b64_tr_b16 a[208:209], v236 offset:8192
  ds_read_b64_tr_b16 a[210:211], v236 offset:10240
  v_add_f32 v21, 1.0, v21
  v_add_f32 v22, 1.0, v22
  v_add_f32 v23, 1.0, v23
  v_mfma_f32_16x16x32_bf16 v[192:195], a[212:215], a[60:63], v[192:195]
  ds_read_b64_tr_b16 a[212:213], v236 offset:12288
  ds_read_b64_tr_b16 a[214:215], v236 offset:14336
  v_rcp_f32 v16, v16
  v_rcp_f32 v17, v17
  v_mfma_f32_16x16x32_bf16 v[100:103], a[216:219], a[32:35], v[100:103]
  s_mov_b32 s41, 458752
  s_add_u32 m0, s42, 65536
  v_rcp_f32 v18, v18
  v_rcp_f32 v19, v19
  v_mfma_f32_16x16x32_bf16 v[100:103], a[220:223], a[48:51], v[100:103]
  v_rcp_f32 v20, v20
  v_rcp_f32 v21, v21
  v_mfma_f32_16x16x32_bf16 v[132:135], a[216:219], a[36:39], v[132:135]
  v_rcp_f32 v22, v22
  v_rcp_f32 v23, v23
  v_mul_f32 v16, v16, v24
  v_mfma_f32_16x16x32_bf16 v[132:135], a[220:223], a[52:55], v[132:135]
  buffer_load_dwordx4 v253, s[44:47], s41 offen lds
  v_mul_f32 v17, v17, v25
  v_mul_f32 v18, v18, v26
  v_mul_f32 v19, v19, v27
  v_mul_f32 v20, v20, v28
  v_mfma_f32_16x16x32_bf16 v[164:167], a[216:219], a[40:43], v[164:167]
  s_mov_b32 s41, 720896
  s_add_u32 m0, s42, 69632
  v_mul_f32 v21, v21, v29
  v_mul_f32 v22, v22, v30
  v_mul_f32 v23, v23, v31
  v_cvt_pk_bf16_f32 v16, v16, v17
  v_mfma_f32_16x16x32_bf16 v[164:167], a[220:223], a[56:59], v[164:167]
  v_cvt_pk_bf16_f32 v17, v18, v19
  v_cvt_pk_bf16_f32 v18, v20, v21
  v_cvt_pk_bf16_f32 v19, v22, v23
  v_mfma_f32_16x16x32_bf16 v[196:199], a[216:219], a[44:47], v[196:199]
  ds_read_b64_tr_b16 a[216:217], v237 offset:8192
  ds_read_b64_tr_b16 a[218:219], v237 offset:10240
  buffer_store_dwordx4 v[16:19], v225, s[4:7], s60 offen offset:1024 sc1
  v_mul_f32 v32, s43, v32
  v_mul_f32 v33, s43, v33
  v_mul_f32 v34, s43, v34
  v_mfma_f32_16x16x32_bf16 v[196:199], a[220:223], a[60:63], v[196:199]
  ds_read_b64_tr_b16 a[220:221], v237 offset:12288
  ds_read_b64_tr_b16 a[222:223], v237 offset:14336
  v_mul_f32 v35, s43, v35
  v_mul_f32 v36, s43, v36
  v_mul_f32 v37, s43, v37
  v_mul_f32 v38, s43, v38
  v_mfma_f32_16x16x32_bf16 v[112:115], a[224:227], a[32:35], v[112:115]
  v_mul_f32 v39, s43, v39
  v_exp_f32 v32, v32
  s_waitcnt lgkmcnt(13)
  v_mfma_f32_16x16x32_bf16 v[112:115], a[228:231], a[48:51], v[112:115]
  buffer_load_dwordx4 v253, s[44:47], s41 offen lds
  v_exp_f32 v33, v33
  v_exp_f32 v34, v34
  v_mfma_f32_16x16x32_bf16 v[144:147], a[224:227], a[36:39], v[144:147]
  s_mov_b32 s41, 1048576
L_wk0_6:
  s_cbranch_vccnz L_wk0_10
  s_add_u32 m0, s42, 73728
  v_exp_f32 v35, v35
  v_exp_f32 v36, v36
  v_mfma_f32_16x16x32_bf16 v[144:147], a[228:231], a[52:55], v[144:147]
  v_exp_f32 v37, v37
  v_exp_f32 v38, v38
  v_mfma_f32_16x16x32_bf16 v[176:179], a[224:227], a[40:43], v[176:179]
  v_exp_f32 v39, v39
  v_add_f32 v32, 1.0, v32
  v_add_f32 v33, 1.0, v33
  v_add_f32 v34, 1.0, v34
  v_mfma_f32_16x16x32_bf16 v[176:179], a[228:231], a[56:59], v[176:179]
  v_add_f32 v35, 1.0, v35
  v_add_f32 v36, 1.0, v36
  v_add_f32 v37, 1.0, v37
  v_add_f32 v38, 1.0, v38
  v_mfma_f32_16x16x32_bf16 v[208:211], a[224:227], a[44:47], v[208:211]
  ds_read_b64_tr_b16 a[224:225], v236 offset:16384
  ds_read_b64_tr_b16 a[226:227], v236 offset:18432
  v_add_f32 v39, 1.0, v39
  v_rcp_f32 v32, v32
  v_mfma_f32_16x16x32_bf16 v[208:211], a[228:231], a[60:63], v[208:211]
  buffer_load_dwordx4 v242, s[44:47], s41 offen lds
  v_rcp_f32 v33, v33
  v_rcp_f32 v34, v34
  v_mfma_f32_16x16x32_bf16 v[116:119], a[232:235], a[32:35], v[116:119]
  ds_read_b64_tr_b16 a[228:229], v236 offset:20480
  ds_read_b64_tr_b16 a[230:231], v236 offset:22528
  v_rcp_f32 v35, v35
  v_rcp_f32 v36, v36
  v_mfma_f32_16x16x32_bf16 v[116:119], a[236:239], a[48:51], v[116:119]
  s_mov_b32 s41, 1310720
  s_add_u32 m0, s42, 77824
  v_rcp_f32 v37, v37
  v_rcp_f32 v38, v38
  v_mfma_f32_16x16x32_bf16 v[148:151], a[232:235], a[36:39], v[148:151]
  v_rcp_f32 v39, v39
  v_mul_f32 v32, v32, v40
  v_mul_f32 v33, v33, v41
  v_mul_f32 v34, v34, v42
  v_mfma_f32_16x16x32_bf16 v[148:151], a[236:239], a[52:55], v[148:151]
  v_mul_f32 v35, v35, v43
  v_mul_f32 v36, v36, v44
  v_mul_f32 v37, v37, v45
  v_mul_f32 v38, v38, v46
  v_mfma_f32_16x16x32_bf16 v[180:183], a[232:235], a[40:43], v[180:183]
  v_mul_f32 v39, v39, v47
  v_cvt_pk_bf16_f32 v32, v32, v33
  v_cvt_pk_bf16_f32 v33, v34, v35
  v_cvt_pk_bf16_f32 v34, v36, v37
  v_mfma_f32_16x16x32_bf16 v[180:183], a[236:239], a[56:59], v[180:183]
  buffer_load_dwordx4 v242, s[44:47], s41 offen lds
  v_cvt_pk_bf16_f32 v35, v38, v39
  buffer_store_dwordx4 v[32:35], v225, s[4:7], s60 offen offset:2048 sc1
  v_mul_f32 v48, s43, v48
  v_mfma_f32_16x16x32_bf16 v[212:215], a[232:235], a[44:47], v[212:215]
  ds_read_b64_tr_b16 a[232:233], v237 offset:16384
  ds_read_b64_tr_b16 a[234:235], v237 offset:18432
  v_mul_f32 v49, s43, v49
  v_mul_f32 v50, s43, v50
  v_mul_f32 v51, s43, v51
  v_mul_f32 v52, s43, v52
  v_mfma_f32_16x16x32_bf16 v[212:215], a[236:239], a[60:63], v[212:215]
  ds_read_b64_tr_b16 a[236:237], v237 offset:20480
  ds_read_b64_tr_b16 a[238:239], v237 offset:22528
  v_mul_f32 v53, s43, v53
  v_mul_f32 v54, s43, v54
  v_mul_f32 v55, s43, v55
  v_mfma_f32_16x16x32_bf16 v[96:99], a[192:195], a[64:67], v[96:99]
  s_mov_b32 s41, 1048576
  s_add_u32 m0, s42, 81920
  v_exp_f32 v48, v48
  v_exp_f32 v49, v49
  s_waitcnt lgkmcnt(13)
  v_mfma_f32_16x16x32_bf16 v[96:99], a[196:199], a[80:83], v[96:99]
  v_exp_f32 v50, v50
  v_exp_f32 v51, v51
  v_mfma_f32_16x16x32_bf16 v[128:131], a[192:195], a[68:71], v[128:131]
  v_exp_f32 v52, v52
  v_exp_f32 v53, v53
  v_mfma_f32_16x16x32_bf16 v[128:131], a[196:199], a[84:87], v[128:131]
  buffer_load_dwordx4 v253, s[44:47], s41 offen lds
  v_exp_f32 v54, v54
  v_exp_f32 v55, v55
  v_add_f32 v48, 1.0, v48
  v_mfma_f32_16x16x32_bf16 v[160:163], a[192:195], a[72:75], v[160:163]
  s_mov_b32 s41, 1310720
  s_add_u32 m0, s42, 86016
  v_add_f32 v49, 1.0, v49
  v_add_f32 v50, 1.0, v50
  v_add_f32 v51, 1.0, v51
  v_add_f32 v52, 1.0, v52
  v_mfma_f32_16x16x32_bf16 v[160:163], a[196:199], a[88:91], v[160:163]
  v_add_f32 v53, 1.0, v53
  v_add_f32 v54, 1.0, v54
  v_add_f32 v55, 1.0, v55
  v_mfma_f32_16x16x32_bf16 v[192:195], a[192:195], a[76:79], v[192:195]
  ds_read_b64_tr_b16 a[192:193], v236 offset:24576
  ds_read_b64_tr_b16 a[194:195], v236 offset:26624
  v_rcp_f32 v48, v48
  v_rcp_f32 v49, v49
  v_mfma_f32_16x16x32_bf16 v[192:195], a[196:199], a[92:95], v[192:195]
  ds_read_b64_tr_b16 a[196:197], v236 offset:28672
  ds_read_b64_tr_b16 a[198:199], v236 offset:30720
  v_rcp_f32 v50, v50
  v_rcp_f32 v51, v51
  v_mfma_f32_16x16x32_bf16 v[100:103], a[200:203], a[64:67], v[100:103]
  v_rcp_f32 v52, v52
  v_rcp_f32 v53, v53
  v_mfma_f32_16x16x32_bf16 v[100:103], a[204:207], a[80:83], v[100:103]
  buffer_load_dwordx4 v253, s[44:47], s41 offen lds
  v_rcp_f32 v54, v54
  v_rcp_f32 v55, v55
  v_mul_f32 v48, v48, v56
  v_mfma_f32_16x16x32_bf16 v[132:135], a[200:203], a[68:71], v[132:135]
  s_mov_b32 s41, 1376256
  s_add_u32 m0, s42, 90112
  v_mul_f32 v49, v49, v57
  v_mul_f32 v50, v50, v58
  v_mul_f32 v51, v51, v59
  v_mul_f32 v52, v52, v60
  v_mfma_f32_16x16x32_bf16 v[132:135], a[204:207], a[84:87], v[132:135]
  v_mul_f32 v53, v53, v61
  v_mul_f32 v54, v54, v62
  v_mul_f32 v55, v55, v63
  v_cvt_pk_bf16_f32 v48, v48, v49
  v_mfma_f32_16x16x32_bf16 v[164:167], a[200:203], a[72:75], v[164:167]
  v_cvt_pk_bf16_f32 v49, v50, v51
  v_cvt_pk_bf16_f32 v50, v52, v53
  v_cvt_pk_bf16_f32 v51, v54, v55
  v_mfma_f32_16x16x32_bf16 v[164:167], a[204:207], a[88:91], v[164:167]
  buffer_store_dwordx4 v[48:51], v225, s[4:7], s60 offen offset:3072 sc1
  v_mul_f32 v64, s43, v64
  v_mul_f32 v65, s43, v65
  v_mul_f32 v66, s43, v66
  v_mfma_f32_16x16x32_bf16 v[196:199], a[200:203], a[76:79], v[196:199]
  ds_read_b64_tr_b16 a[200:201], v237 offset:24576
  ds_read_b64_tr_b16 a[202:203], v237 offset:26624
  v_mul_f32 v67, s43, v67
  v_mfma_f32_16x16x32_bf16 v[196:199], a[204:207], a[92:95], v[196:199]
  buffer_load_dwordx4 v242, s[44:47], s41 offen lds
  v_mfma_f32_16x16x32_bf16 v[112:115], a[208:211], a[64:67], v[112:115]
  ds_read_b64_tr_b16 a[204:205], v237 offset:28672
  ds_read_b64_tr_b16 a[206:207], v237 offset:30720
  v_exp_f32 v64, v64
  s_waitcnt lgkmcnt(13)
  v_mfma_f32_16x16x32_bf16 v[112:115], a[212:215], a[80:83], v[112:115]
  s_mov_b32 s41, 1638400
  s_add_u32 m0, s42, 94208
  v_exp_f32 v65, v65
  v_mfma_f32_16x16x32_bf16 v[144:147], a[208:211], a[68:71], v[144:147]
  v_exp_f32 v66, v66
  v_mfma_f32_16x16x32_bf16 v[144:147], a[212:215], a[84:87], v[144:147]
  v_exp_f32 v67, v67
  v_mfma_f32_16x16x32_bf16 v[176:179], a[208:211], a[72:75], v[176:179]
  v_add_f32 v64, 1.0, v64
  v_add_f32 v65, 1.0, v65
  v_mfma_f32_16x16x32_bf16 v[176:179], a[212:215], a[88:91], v[176:179]
  buffer_load_dwordx4 v242, s[44:47], s41 offen lds
  v_add_f32 v66, 1.0, v66
  v_mfma_f32_16x16x32_bf16 v[208:211], a[208:211], a[76:79], v[208:211]
  ds_read_b64_tr_b16 a[208:209], v228 offset:8192
  ds_read_b64_tr_b16 a[210:211], v228 offset:10240
  v_add_f32 v67, 1.0, v67
  v_mfma_f32_16x16x32_bf16 v[208:211], a[212:215], a[92:95], v[208:211]
  ds_read_b64_tr_b16 a[212:213], v228 offset:12288
  ds_read_b64_tr_b16 a[214:215], v228 offset:14336
  v_mfma_f32_16x16x32_bf16 v[116:119], a[216:219], a[64:67], v[116:119]
  s_mov_b32 s41, 1376256
  s_add_u32 m0, s42, 98304
  v_rcp_f32 v64, v64
  v_mfma_f32_16x16x32_bf16 v[116:119], a[220:223], a[80:83], v[116:119]
  s_waitcnt vmcnt(18)
  s_barrier
  v_rcp_f32 v65, v65
  v_mfma_f32_16x16x32_bf16 v[148:151], a[216:219], a[68:71], v[148:151]
  v_rcp_f32 v66, v66
  v_mfma_f32_16x16x32_bf16 v[148:151], a[220:223], a[84:87], v[148:151]
  buffer_load_dwordx4 v253, s[44:47], s41 offen lds
  v_mfma_f32_16x16x32_bf16 v[180:183], a[216:219], a[72:75], v[180:183]
  s_mov_b32 s41, 1638400
  s_add_u32 m0, s42, 102400
  v_rcp_f32 v67, v67
  v_mul_f32 v64, v64, v68
  v_mfma_f32_16x16x32_bf16 v[180:183], a[220:223], a[88:91], v[180:183]
  v_mul_f32 v65, v65, v69
  v_mul_f32 v66, v66, v70
  v_mfma_f32_16x16x32_bf16 v[212:215], a[216:219], a[76:79], v[212:215]
  ds_read_b64_tr_b16 a[216:217], v229 offset:8192
  ds_read_b64_tr_b16 a[218:219], v229 offset:10240
  v_mul_f32 v67, v67, v71
  v_mfma_f32_16x16x32_bf16 v[212:215], a[220:223], a[92:95], v[212:215]
  ds_read_b64_tr_b16 a[220:221], v229 offset:12288
  ds_read_b64_tr_b16 a[222:223], v229 offset:14336
  v_cvt_pk_bf16_f32 v64, v64, v65
  v_cvt_pk_bf16_f32 v65, v66, v67
  v_mfma_f32_16x16x32_bf16 v[96:99], a[224:227], a[96:99], v[96:99]
  v_mul_f32 v72, s43, v72
  v_mul_f32 v73, s43, v73
  s_waitcnt lgkmcnt(13)
  v_mfma_f32_16x16x32_bf16 v[96:99], a[228:231], a[112:115], v[96:99]
  buffer_load_dwordx4 v253, s[44:47], s41 offen lds
  v_mul_f32 v74, s43, v74
  v_mfma_f32_16x16x32_bf16 v[128:131], a[224:227], a[100:103], v[128:131]
  s_mov_b32 s41, 1966080
  s_add_u32 m0, s42, 106496
  v_mul_f32 v75, s43, v75
  v_mfma_f32_16x16x32_bf16 v[128:131], a[228:231], a[116:119], v[128:131]
  v_exp_f32 v72, v72
  v_mfma_f32_16x16x32_bf16 v[160:163], a[224:227], a[104:107], v[160:163]
  v_exp_f32 v73, v73
  v_mfma_f32_16x16x32_bf16 v[160:163], a[228:231], a[120:123], v[160:163]
  v_exp_f32 v74, v74
  v_mfma_f32_16x16x32_bf16 v[192:195], a[224:227], a[108:111], v[192:195]
  ds_read_b64_tr_b16 a[224:225], v228 offset:16384
  ds_read_b64_tr_b16 a[226:227], v228 offset:18432
  v_mfma_f32_16x16x32_bf16 v[192:195], a[228:231], a[124:127], v[192:195]
  buffer_load_dwordx4 v242, s[44:47], s41 offen lds
  v_mfma_f32_16x16x32_bf16 v[100:103], a[232:235], a[96:99], v[100:103]
  ds_read_b64_tr_b16 a[228:229], v228 offset:20480
  ds_read_b64_tr_b16 a[230:231], v228 offset:22528
  v_exp_f32 v75, v75
  v_add_f32 v72, 1.0, v72
  v_mfma_f32_16x16x32_bf16 v[100:103], a[236:239], a[112:115], v[100:103]
  s_mov_b32 s41, 2228224
  s_add_u32 m0, s42, 110592
  v_add_f32 v73, 1.0, v73
  v_add_f32 v74, 1.0, v74
  v_mfma_f32_16x16x32_bf16 v[132:135], a[232:235], a[100:103], v[132:135]
  v_add_f32 v75, 1.0, v75
  v_mfma_f32_16x16x32_bf16 v[132:135], a[236:239], a[116:119], v[132:135]
  v_rcp_f32 v72, v72
  v_mfma_f32_16x16x32_bf16 v[164:167], a[232:235], a[104:107], v[164:167]
  v_rcp_f32 v73, v73
  v_mfma_f32_16x16x32_bf16 v[164:167], a[236:239], a[120:123], v[164:167]
  buffer_load_dwordx4 v242, s[44:47], s41 offen lds
  v_mfma_f32_16x16x32_bf16 v[196:199], a[232:235], a[108:111], v[196:199]
  ds_read_b64_tr_b16 a[232:233], v229 offset:16384
  ds_read_b64_tr_b16 a[234:235], v229 offset:18432
  v_mfma_f32_16x16x32_bf16 v[196:199], a[236:239], a[124:127], v[196:199]
  ds_read_b64_tr_b16 a[236:237], v229 offset:20480
  ds_read_b64_tr_b16 a[238:239], v229 offset:22528
  v_rcp_f32 v74, v74
  v_mfma_f32_16x16x32_bf16 v[112:115], a[192:195], a[96:99], v[112:115]
  v_rcp_f32 v75, v75
  v_mul_f32 v72, v72, v76
  s_waitcnt lgkmcnt(13)
  v_mfma_f32_16x16x32_bf16 v[112:115], a[196:199], a[112:115], v[112:115]
  v_mul_f32 v73, v73, v77
  v_mul_f32 v74, v74, v78
  v_mfma_f32_16x16x32_bf16 v[144:147], a[192:195], a[100:103], v[144:147]
  v_mul_f32 v75, v75, v79
  v_cvt_pk_bf16_f32 v66, v72, v73
  v_mfma_f32_16x16x32_bf16 v[144:147], a[196:199], a[116:119], v[144:147]
  v_cvt_pk_bf16_f32 v67, v74, v75
  v_mfma_f32_16x16x32_bf16 v[176:179], a[192:195], a[104:107], v[176:179]
  buffer_store_dwordx4 v[64:67], v225, s[4:7], s61 offen offset:0 sc1
  v_mfma_f32_16x16x32_bf16 v[176:179], a[196:199], a[120:123], v[176:179]
  v_mul_f32 v80, s43, v80
  v_mul_f32 v81, s43, v81
  v_mfma_f32_16x16x32_bf16 v[208:211], a[192:195], a[108:111], v[208:211]
  ds_read_b64_tr_b16 a[192:193], v228 offset:24576
  ds_read_b64_tr_b16 a[194:195], v228 offset:26624
  v_mfma_f32_16x16x32_bf16 v[208:211], a[196:199], a[124:127], v[208:211]
  ds_read_b64_tr_b16 a[196:197], v228 offset:28672
  ds_read_b64_tr_b16 a[198:199], v228 offset:30720
  v_mul_f32 v82, s43, v82
  v_mul_f32 v83, s43, v83
  v_mfma_f32_16x16x32_bf16 v[116:119], a[200:203], a[96:99], v[116:119]
  v_exp_f32 v80, v80
  v_mfma_f32_16x16x32_bf16 v[116:119], a[204:207], a[112:115], v[116:119]
  v_exp_f32 v81, v81
  v_mfma_f32_16x16x32_bf16 v[148:151], a[200:203], a[100:103], v[148:151]
  v_exp_f32 v82, v82
  v_mfma_f32_16x16x32_bf16 v[148:151], a[204:207], a[116:119], v[148:151]
  v_exp_f32 v83, v83
  v_mfma_f32_16x16x32_bf16 v[180:183], a[200:203], a[104:107], v[180:183]
  v_add_f32 v80, 1.0, v80
  v_add_f32 v81, 1.0, v81
  v_mfma_f32_16x16x32_bf16 v[180:183], a[204:207], a[120:123], v[180:183]
  v_add_f32 v82, 1.0, v82
  v_add_f32 v83, 1.0, v83
  v_mfma_f32_16x16x32_bf16 v[212:215], a[200:203], a[108:111], v[212:215]
  ds_read_b64_tr_b16 a[200:201], v229 offset:24576
  ds_read_b64_tr_b16 a[202:203], v229 offset:26624
  s_waitcnt vmcnt(7)
  buffer_store_dword v245, v246, s[4:7], s90 offen sc1
  v_mfma_f32_16x16x32_bf16 v[212:215], a[204:207], a[124:127], v[212:215]
  ds_read_b64_tr_b16 a[204:205], v229 offset:28672
  ds_read_b64_tr_b16 a[206:207], v229 offset:30720
  v_add_u32 v245, 1, v245
  v_mfma_f32_16x16x32_bf16 v[96:99], a[208:211], a[128:131], v[96:99]
  v_rcp_f32 v80, v80
  s_waitcnt lgkmcnt(13)
  v_mfma_f32_16x16x32_bf16 v[96:99], a[212:215], a[144:147], v[96:99]
  v_rcp_f32 v81, v81
  v_mfma_f32_16x16x32_bf16 v[128:131], a[208:211], a[132:135], v[128:131]
  v_rcp_f32 v82, v82
  v_mfma_f32_16x16x32_bf16 v[128:131], a[212:215], a[148:151], v[128:131]
  v_rcp_f32 v83, v83
  v_mfma_f32_16x16x32_bf16 v[160:163], a[208:211], a[136:139], v[160:163]
  v_mul_f32 v80, v80, v84
  v_mul_f32 v81, v81, v85
  v_mfma_f32_16x16x32_bf16 v[160:163], a[212:215], a[152:155], v[160:163]
  v_mul_f32 v82, v82, v86
  v_mul_f32 v83, v83, v87
  v_mfma_f32_16x16x32_bf16 v[192:195], a[208:211], a[140:143], v[192:195]
  ds_read_b64_tr_b16 a[208:209], v228 offset:32768
  ds_read_b64_tr_b16 a[210:211], v228 offset:34816
  v_mfma_f32_16x16x32_bf16 v[192:195], a[212:215], a[156:159], v[192:195]
  ds_read_b64_tr_b16 a[212:213], v228 offset:36864
  ds_read_b64_tr_b16 a[214:215], v228 offset:38912
  v_mfma_f32_16x16x32_bf16 v[100:103], a[216:219], a[128:131], v[100:103]
  v_cvt_pk_bf16_f32 v80, v80, v81
  v_cvt_pk_bf16_f32 v81, v82, v83
  v_mfma_f32_16x16x32_bf16 v[100:103], a[220:223], a[144:147], v[100:103]
  v_mul_f32 v88, s43, v88
  v_mul_f32 v89, s43, v89
  v_mfma_f32_16x16x32_bf16 v[132:135], a[216:219], a[132:135], v[132:135]
  v_mul_f32 v90, s43, v90
  v_mul_f32 v91, s43, v91
  v_mfma_f32_16x16x32_bf16 v[132:135], a[220:223], a[148:151], v[132:135]
  v_exp_f32 v88, v88
  v_mfma_f32_16x16x32_bf16 v[164:167], a[216:219], a[136:139], v[164:167]
  v_exp_f32 v89, v89
  v_mfma_f32_16x16x32_bf16 v[164:167], a[220:223], a[152:155], v[164:167]
  v_exp_f32 v90, v90
  v_mfma_f32_16x16x32_bf16 v[196:199], a[216:219], a[140:143], v[196:199]
  ds_read_b64_tr_b16 a[216:217], v229 offset:32768
  ds_read_b64_tr_b16 a[218:219], v229 offset:34816
  v_mfma_f32_16x16x32_bf16 v[196:199], a[220:223], a[156:159], v[196:199]
  ds_read_b64_tr_b16 a[220:221], v229 offset:36864
  ds_read_b64_tr_b16 a[222:223], v229 offset:38912
  v_mfma_f32_16x16x32_bf16 v[112:115], a[224:227], a[128:131], v[112:115]
  v_exp_f32 v91, v91
  s_waitcnt lgkmcnt(13)
  v_mfma_f32_16x16x32_bf16 v[112:115], a[228:231], a[144:147], v[112:115]
  s_barrier
  v_add_f32 v88, 1.0, v88
  v_mfma_f32_16x16x32_bf16 v[144:147], a[224:227], a[132:135], v[144:147]
  v_add_f32 v89, 1.0, v89
  v_add_f32 v90, 1.0, v90
  v_mfma_f32_16x16x32_bf16 v[144:147], a[228:231], a[148:151], v[144:147]
  v_add_f32 v91, 1.0, v91
  v_mfma_f32_16x16x32_bf16 v[176:179], a[224:227], a[136:139], v[176:179]
  v_rcp_f32 v88, v88
  v_mfma_f32_16x16x32_bf16 v[176:179], a[228:231], a[152:155], v[176:179]
  v_rcp_f32 v89, v89
  v_mfma_f32_16x16x32_bf16 v[208:211], a[224:227], a[140:143], v[208:211]
  ds_read_b64_tr_b16 a[224:225], v234 offset:49152
  ds_read_b64_tr_b16 a[226:227], v234 offset:51200
  v_mfma_f32_16x16x32_bf16 v[208:211], a[228:231], a[156:159], v[208:211]
  ds_read_b64_tr_b16 a[228:229], v234 offset:53248
  ds_read_b64_tr_b16 a[230:231], v234 offset:55296
  v_mfma_f32_16x16x32_bf16 v[116:119], a[232:235], a[128:131], v[116:119]
  v_rcp_f32 v90, v90
  v_mfma_f32_16x16x32_bf16 v[116:119], a[236:239], a[144:147], v[116:119]
  v_rcp_f32 v91, v91
  v_mul_f32 v88, v88, v92
  v_mfma_f32_16x16x32_bf16 v[148:151], a[232:235], a[132:135], v[148:151]
  v_mul_f32 v89, v89, v93
  v_mul_f32 v90, v90, v94
  v_mfma_f32_16x16x32_bf16 v[148:151], a[236:239], a[148:151], v[148:151]
  v_mul_f32 v91, v91, v95
  v_cvt_pk_bf16_f32 v82, v88, v89
  v_mfma_f32_16x16x32_bf16 v[180:183], a[232:235], a[136:139], v[180:183]
  v_cvt_pk_bf16_f32 v83, v90, v91
  v_mfma_f32_16x16x32_bf16 v[180:183], a[236:239], a[152:155], v[180:183]
  buffer_store_dwordx4 v[80:83], v225, s[4:7], s61 offen offset:2048 sc1
  v_mfma_f32_16x16x32_bf16 v[212:215], a[232:235], a[140:143], v[212:215]
  ds_read_b64_tr_b16 a[232:233], v235 offset:49152
  ds_read_b64_tr_b16 a[234:235], v235 offset:51200
  v_mfma_f32_16x16x32_bf16 v[212:215], a[236:239], a[156:159], v[212:215]
  ds_read_b64_tr_b16 a[236:237], v235 offset:53248
  ds_read_b64_tr_b16 a[238:239], v235 offset:55296
  v_mfma_f32_16x16x32_bf16 v[96:99], a[192:195], a[160:163], v[96:99]
  s_waitcnt lgkmcnt(13)
  v_mfma_f32_16x16x32_bf16 v[96:99], a[196:199], a[176:179], v[96:99]
  v_mfma_f32_16x16x32_bf16 v[128:131], a[192:195], a[164:167], v[128:131]
  v_mfma_f32_16x16x32_bf16 v[128:131], a[196:199], a[180:183], v[128:131]
  v_mfma_f32_16x16x32_bf16 v[160:163], a[192:195], a[168:171], v[160:163]
  v_mfma_f32_16x16x32_bf16 v[160:163], a[196:199], a[184:187], v[160:163]
  v_mfma_f32_16x16x32_bf16 v[192:195], a[192:195], a[172:175], v[192:195]
  ds_read_b64_tr_b16 a[192:193], v234 offset:57344
  ds_read_b64_tr_b16 a[194:195], v234 offset:59392
  v_mfma_f32_16x16x32_bf16 v[192:195], a[196:199], a[188:191], v[192:195]
  ds_read_b64_tr_b16 a[196:197], v234 offset:61440
  ds_read_b64_tr_b16 a[198:199], v234 offset:63488
  v_mfma_f32_16x16x32_bf16 v[100:103], a[200:203], a[160:163], v[100:103]
  v_mfma_f32_16x16x32_bf16 v[100:103], a[204:207], a[176:179], v[100:103]
  v_mfma_f32_16x16x32_bf16 v[132:135], a[200:203], a[164:167], v[132:135]
  v_mfma_f32_16x16x32_bf16 v[132:135], a[204:207], a[180:183], v[132:135]
  v_mfma_f32_16x16x32_bf16 v[164:167], a[200:203], a[168:171], v[164:167]
  v_mfma_f32_16x16x32_bf16 v[164:167], a[204:207], a[184:187], v[164:167]
  v_mfma_f32_16x16x32_bf16 v[196:199], a[200:203], a[172:175], v[196:199]
  ds_read_b64_tr_b16 a[200:201], v235 offset:57344
  ds_read_b64_tr_b16 a[202:203], v235 offset:59392
  v_mfma_f32_16x16x32_bf16 v[196:199], a[204:207], a[188:191], v[196:199]
  ds_read_b64_tr_b16 a[204:205], v235 offset:61440
  ds_read_b64_tr_b16 a[206:207], v235 offset:63488
  v_mfma_f32_16x16x32_bf16 v[112:115], a[208:211], a[160:163], v[112:115]
  s_waitcnt lgkmcnt(13)
  v_mfma_f32_16x16x32_bf16 v[112:115], a[212:215], a[176:179], v[112:115]
  v_mfma_f32_16x16x32_bf16 v[144:147], a[208:211], a[164:167], v[144:147]
  v_mfma_f32_16x16x32_bf16 v[144:147], a[212:215], a[180:183], v[144:147]
  v_mfma_f32_16x16x32_bf16 v[176:179], a[208:211], a[168:171], v[176:179]
  v_mfma_f32_16x16x32_bf16 v[176:179], a[212:215], a[184:187], v[176:179]
  v_mfma_f32_16x16x32_bf16 v[208:211], a[208:211], a[172:175], v[208:211]
  ds_read_b64_tr_b16 a[208:209], v238 offset:0
  ds_read_b64_tr_b16 a[210:211], v238 offset:2048
  v_mfma_f32_16x16x32_bf16 v[208:211], a[212:215], a[188:191], v[208:211]
  ds_read_b64_tr_b16 a[212:213], v238 offset:4096
  ds_read_b64_tr_b16 a[214:215], v238 offset:6144
  v_mfma_f32_16x16x32_bf16 v[116:119], a[216:219], a[160:163], v[116:119]
  v_mfma_f32_16x16x32_bf16 v[116:119], a[220:223], a[176:179], v[116:119]
  v_mfma_f32_16x16x32_bf16 v[148:151], a[216:219], a[164:167], v[148:151]
  v_mfma_f32_16x16x32_bf16 v[148:151], a[220:223], a[180:183], v[148:151]
  v_mfma_f32_16x16x32_bf16 v[180:183], a[216:219], a[168:171], v[180:183]
  v_mfma_f32_16x16x32_bf16 v[180:183], a[220:223], a[184:187], v[180:183]
  v_mfma_f32_16x16x32_bf16 v[212:215], a[216:219], a[172:175], v[212:215]
  ds_read_b64_tr_b16 a[216:217], v239 offset:0
  ds_read_b64_tr_b16 a[218:219], v239 offset:2048
  v_mfma_f32_16x16x32_bf16 v[212:215], a[220:223], a[188:191], v[212:215]
  ds_read_b64_tr_b16 a[220:221], v239 offset:4096
  ds_read_b64_tr_b16 a[222:223], v239 offset:6144
  v_mfma_f32_16x16x32_bf16 v[104:107], a[224:227], a[32:35], v[104:107]
  v_mul_f32 v96, s43, v96
  v_mul_f32 v97, s43, v97
  s_waitcnt lgkmcnt(13)
  v_mfma_f32_16x16x32_bf16 v[104:107], a[228:231], a[48:51], v[104:107]
  v_mul_f32 v98, s43, v98
  v_mul_f32 v99, s43, v99
  v_mfma_f32_16x16x32_bf16 v[136:139], a[224:227], a[36:39], v[136:139]
  v_mul_f32 v100, s43, v100
  v_mul_f32 v101, s43, v101
  v_mfma_f32_16x16x32_bf16 v[136:139], a[228:231], a[52:55], v[136:139]
  v_mul_f32 v102, s43, v102
  v_mul_f32 v103, s43, v103
  v_mfma_f32_16x16x32_bf16 v[168:171], a[224:227], a[40:43], v[168:171]
  v_exp_f32 v96, v96
  v_mfma_f32_16x16x32_bf16 v[168:171], a[228:231], a[56:59], v[168:171]
  v_exp_f32 v97, v97
  v_mfma_f32_16x16x32_bf16 v[200:203], a[224:227], a[44:47], v[200:203]
  ds_read_b64_tr_b16 a[224:225], v238 offset:8192
  ds_read_b64_tr_b16 a[226:227], v238 offset:10240
  v_mfma_f32_16x16x32_bf16 v[200:203], a[228:231], a[60:63], v[200:203]
  ds_read_b64_tr_b16 a[228:229], v238 offset:12288
  ds_read_b64_tr_b16 a[230:231], v238 offset:14336
  v_mfma_f32_16x16x32_bf16 v[108:111], a[232:235], a[32:35], v[108:111]
  v_exp_f32 v98, v98
  v_mfma_f32_16x16x32_bf16 v[108:111], a[236:239], a[48:51], v[108:111]
  s_barrier
  v_exp_f32 v99, v99
  v_mfma_f32_16x16x32_bf16 v[140:143], a[232:235], a[36:39], v[140:143]
  s_mov_b32 s41, 1966080
  s_add_u32 m0, s42, 114688
  v_exp_f32 v100, v100
  v_mfma_f32_16x16x32_bf16 v[140:143], a[236:239], a[52:55], v[140:143]
  buffer_load_dwordx4 v253, s[44:47], s41 offen lds
  v_exp_f32 v101, v101
  v_mfma_f32_16x16x32_bf16 v[172:175], a[232:235], a[40:43], v[172:175]
  s_mov_b32 s41, 2228224
  s_add_u32 m0, s42, 118784
  v_exp_f32 v102, v102
  v_mfma_f32_16x16x32_bf16 v[172:175], a[236:239], a[56:59], v[172:175]
  v_exp_f32 v103, v103
  v_add_f32 v96, 1.0, v96
  v_mfma_f32_16x16x32_bf16 v[204:207], a[232:235], a[44:47], v[204:207]
  ds_read_b64_tr_b16 a[232:233], v239 offset:8192
  ds_read_b64_tr_b16 a[234:235], v239 offset:10240
  v_add_f32 v97, 1.0, v97
  v_add_f32 v98, 1.0, v98
  v_mfma_f32_16x16x32_bf16 v[204:207], a[236:239], a[60:63], v[204:207]
  ds_read_b64_tr_b16 a[236:237], v239 offset:12288
  ds_read_b64_tr_b16 a[238:239], v239 offset:14336
  v_add_f32 v99, 1.0, v99
  v_mfma_f32_16x16x32_bf16 v[120:123], a[192:195], a[32:35], v[120:123]
  buffer_load_dwordx4 v253, s[44:47], s41 offen lds
  v_add_f32 v100, 1.0, v100
  v_add_f32 v101, 1.0, v101
  s_waitcnt lgkmcnt(13)
  v_mfma_f32_16x16x32_bf16 v[120:123], a[196:199], a[48:51], v[120:123]
  v_add_f32 v102, 1.0, v102
  v_add_f32 v103, 1.0, v103
  v_mfma_f32_16x16x32_bf16 v[152:155], a[192:195], a[36:39], v[152:155]
  v_rcp_f32 v96, v96
  v_mfma_f32_16x16x32_bf16 v[152:155], a[196:199], a[52:55], v[152:155]
  v_rcp_f32 v97, v97
  v_mfma_f32_16x16x32_bf16 v[184:187], a[192:195], a[40:43], v[184:187]
  v_rcp_f32 v98, v98
  v_mfma_f32_16x16x32_bf16 v[184:187], a[196:199], a[56:59], v[184:187]
  v_rcp_f32 v99, v99
  v_mfma_f32_16x16x32_bf16 v[216:219], a[192:195], a[44:47], v[216:219]
  ds_read_b64_tr_b16 a[192:193], v238 offset:16384
  ds_read_b64_tr_b16 a[194:195], v238 offset:18432
  v_mfma_f32_16x16x32_bf16 v[216:219], a[196:199], a[60:63], v[216:219]
  ds_read_b64_tr_b16 a[196:197], v238 offset:20480
  ds_read_b64_tr_b16 a[198:199], v238 offset:22528
  v_mfma_f32_16x16x32_bf16 v[124:127], a[200:203], a[32:35], v[124:127]
  v_rcp_f32 v100, v100
  v_mfma_f32_16x16x32_bf16 v[124:127], a[204:207], a[48:51], v[124:127]
  v_rcp_f32 v101, v101
  v_mfma_f32_16x16x32_bf16 v[156:159], a[200:203], a[36:39], v[156:159]
  s_waitcnt vmcnt(2)
  buffer_store_dword v245, v246, s[4:7], s90 offen sc1
  v_rcp_f32 v102, v102
  v_mfma_f32_16x16x32_bf16 v[156:159], a[204:207], a[52:55], v[156:159]
  v_add_u32 v245, 1, v245
  v_rcp_f32 v103, v103
  v_mul_f32 v96, v96, v112
  v_mfma_f32_16x16x32_bf16 v[188:191], a[200:203], a[40:43], v[188:191]
  v_mul_f32 v97, v97, v113
  v_mul_f32 v98, v98, v114
  v_mfma_f32_16x16x32_bf16 v[188:191], a[204:207], a[56:59], v[188:191]
  v_mul_f32 v99, v99, v115
  v_mul_f32 v100, v100, v116
  v_mfma_f32_16x16x32_bf16 v[220:223], a[200:203], a[44:47], v[220:223]
  ds_read_b64_tr_b16 a[200:201], v239 offset:16384
  ds_read_b64_tr_b16 a[202:203], v239 offset:18432
  v_mul_f32 v101, v101, v117
  v_mul_f32 v102, v102, v118
  v_mfma_f32_16x16x32_bf16 v[220:223], a[204:207], a[60:63], v[220:223]
  ds_read_b64_tr_b16 a[204:205], v239 offset:20480
  ds_read_b64_tr_b16 a[206:207], v239 offset:22528
  v_mul_f32 v103, v103, v119
  v_mfma_f32_16x16x32_bf16 v[104:107], a[208:211], a[64:67], v[104:107]
  v_cvt_pk_bf16_f32 v96, v96, v97
  v_cvt_pk_bf16_f32 v97, v98, v99
  s_waitcnt lgkmcnt(13)
  v_mfma_f32_16x16x32_bf16 v[104:107], a[212:215], a[80:83], v[104:107]
  v_cvt_pk_bf16_f32 v98, v100, v101
  v_cvt_pk_bf16_f32 v99, v102, v103
  v_mfma_f32_16x16x32_bf16 v[136:139], a[208:211], a[68:71], v[136:139]
  buffer_store_dwordx4 v[96:99], v225, s[4:7], s62 offen offset:0 sc1
  v_mfma_f32_16x16x32_bf16 v[136:139], a[212:215], a[84:87], v[136:139]
  v_mul_f32 v128, s43, v128
  v_mul_f32 v129, s43, v129
  v_mfma_f32_16x16x32_bf16 v[168:171], a[208:211], a[72:75], v[168:171]
  v_mul_f32 v130, s43, v130
  v_mul_f32 v131, s43, v131
  v_mfma_f32_16x16x32_bf16 v[168:171], a[212:215], a[88:91], v[168:171]
  v_mul_f32 v132, s43, v132
  v_mul_f32 v133, s43, v133
  v_mfma_f32_16x16x32_bf16 v[200:203], a[208:211], a[76:79], v[200:203]
  ds_read_b64_tr_b16 a[208:209], v238 offset:24576
  ds_read_b64_tr_b16 a[210:211], v238 offset:26624
  v_mul_f32 v134, s43, v134
  v_mfma_f32_16x16x32_bf16 v[200:203], a[212:215], a[92:95], v[200:203]
  ds_read_b64_tr_b16 a[212:213], v238 offset:28672
  ds_read_b64_tr_b16 a[214:215], v238 offset:30720
  v_mul_f32 v135, s43, v135
  v_mfma_f32_16x16x32_bf16 v[108:111], a[216:219], a[64:67], v[108:111]
  v_exp_f32 v128, v128
  v_mfma_f32_16x16x32_bf16 v[108:111], a[220:223], a[80:83], v[108:111]
  v_exp_f32 v129, v129
  v_mfma_f32_16x16x32_bf16 v[140:143], a[216:219], a[68:71], v[140:143]
  v_exp_f32 v130, v130
  v_mfma_f32_16x16x32_bf16 v[140:143], a[220:223], a[84:87], v[140:143]
  v_exp_f32 v131, v131
  v_mfma_f32_16x16x32_bf16 v[172:175], a[216:219], a[72:75], v[172:175]
  v_exp_f32 v132, v132
  v_mfma_f32_16x16x32_bf16 v[172:175], a[220:223], a[88:91], v[172:175]
  v_exp_f32 v133, v133
  v_mfma_f32_16x16x32_bf16 v[204:207], a[216:219], a[76:79], v[204:207]
  ds_read_b64_tr_b16 a[216:217], v239 offset:24576
  ds_read_b64_tr_b16 a[218:219], v239 offset:26624
  v_mfma_f32_16x16x32_bf16 v[204:207], a[220:223], a[92:95], v[204:207]
  ds_read_b64_tr_b16 a[220:221], v239 offset:28672
  ds_read_b64_tr_b16 a[222:223], v239 offset:30720
  v_mfma_f32_16x16x32_bf16 v[120:123], a[224:227], a[64:67], v[120:123]
  v_exp_f32 v134, v134
  s_waitcnt lgkmcnt(13)
  v_mfma_f32_16x16x32_bf16 v[120:123], a[228:231], a[80:83], v[120:123]
  v_exp_f32 v135, v135
  v_add_f32 v128, 1.0, v128
  v_add_f32 v129, 1.0, v129
  v_mfma_f32_16x16x32_bf16 v[152:155], a[224:227], a[68:71], v[152:155]
  v_add_f32 v130, 1.0, v130
  v_add_f32 v131, 1.0, v131
  v_mfma_f32_16x16x32_bf16 v[152:155], a[228:231], a[84:87], v[152:155]
  v_add_f32 v132, 1.0, v132
  v_add_f32 v133, 1.0, v133
  v_mfma_f32_16x16x32_bf16 v[184:187], a[224:227], a[72:75], v[184:187]
  v_add_f32 v134, 1.0, v134
  v_add_f32 v135, 1.0, v135
  v_mfma_f32_16x16x32_bf16 v[184:187], a[228:231], a[88:91], v[184:187]
  v_rcp_f32 v128, v128
  v_mfma_f32_16x16x32_bf16 v[216:219], a[224:227], a[76:79], v[216:219]
  ds_read_b64_tr_b16 a[224:225], v230 offset:8192
  ds_read_b64_tr_b16 a[226:227], v230 offset:10240
  v_mfma_f32_16x16x32_bf16 v[216:219], a[228:231], a[92:95], v[216:219]
  ds_read_b64_tr_b16 a[228:229], v230 offset:12288
  ds_read_b64_tr_b16 a[230:231], v230 offset:14336
  v_mfma_f32_16x16x32_bf16 v[124:127], a[232:235], a[64:67], v[124:127]
  v_rcp_f32 v129, v129
  v_mfma_f32_16x16x32_bf16 v[124:127], a[236:239], a[80:83], v[124:127]
  v_rcp_f32 v130, v130
  v_mfma_f32_16x16x32_bf16 v[156:159], a[232:235], a[68:71], v[156:159]
  v_rcp_f32 v131, v131
  v_mfma_f32_16x16x32_bf16 v[156:159], a[236:239], a[84:87], v[156:159]
  v_rcp_f32 v132, v132
  v_mfma_f32_16x16x32_bf16 v[188:191], a[232:235], a[72:75], v[188:191]
  v_rcp_f32 v133, v133
  v_mfma_f32_16x16x32_bf16 v[188:191], a[236:239], a[88:91], v[188:191]
  v_rcp_f32 v134, v134
  v_mfma_f32_16x16x32_bf16 v[220:223], a[232:235], a[76:79], v[220:223]
  ds_read_b64_tr_b16 a[232:233], v231 offset:8192
  ds_read_b64_tr_b16 a[234:235], v231 offset:10240
  v_rcp_f32 v135, v135
  v_mul_f32 v128, v128, v144
  v_mfma_f32_16x16x32_bf16 v[220:223], a[236:239], a[92:95], v[220:223]
  ds_read_b64_tr_b16 a[236:237], v231 offset:12288
  ds_read_b64_tr_b16 a[238:239], v231 offset:14336
  v_mul_f32 v129, v129, v145
  v_mfma_f32_16x16x32_bf16 v[104:107], a[192:195], a[96:99], v[104:107]
  v_mul_f32 v130, v130, v146
  v_mul_f32 v131, v131, v147
  s_waitcnt lgkmcnt(13)
  v_mfma_f32_16x16x32_bf16 v[104:107], a[196:199], a[112:115], v[104:107]
  s_barrier
  v_mul_f32 v132, v132, v148
  v_mul_f32 v133, v133, v149
  v_mfma_f32_16x16x32_bf16 v[136:139], a[192:195], a[100:103], v[136:139]
  s_mov_b32 s41, 2293760
  s_add_u32 m0, s42, 122880
  v_mul_f32 v134, v134, v150
  v_mul_f32 v135, v135, v151
  v_mfma_f32_16x16x32_bf16 v[136:139], a[196:199], a[116:119], v[136:139]
  buffer_load_dwordx4 v242, s[44:47], s41 offen lds
  v_cvt_pk_bf16_f32 v128, v128, v129
  v_mfma_f32_16x16x32_bf16 v[168:171], a[192:195], a[104:107], v[168:171]
  s_mov_b32 s41, 2555904
  s_add_u32 m0, s42, 126976
  v_cvt_pk_bf16_f32 v129, v130, v131
  v_cvt_pk_bf16_f32 v130, v132, v133
  v_mfma_f32_16x16x32_bf16 v[168:171], a[196:199], a[120:123], v[168:171]
  buffer_load_dword v244, v243, s[4:7], s91 offen sc1
L_wk0_7:
  s_cbranch_vccnz L_wk0_11
  v_cvt_pk_bf16_f32 v131, v134, v135
  v_mfma_f32_16x16x32_bf16 v[200:203], a[192:195], a[108:111], v[200:203]
  ds_read_b64_tr_b16 a[192:193], v230 offset:16384
  ds_read_b64_tr_b16 a[194:195], v230 offset:18432
  buffer_store_dwordx4 v[128:131], v225, s[4:7], s62 offen offset:1024 sc1
  v_mul_f32 v160, s43, v160
  v_mfma_f32_16x16x32_bf16 v[200:203], a[196:199], a[124:127], v[200:203]
  ds_read_b64_tr_b16 a[196:197], v230 offset:20480
  ds_read_b64_tr_b16 a[198:199], v230 offset:22528
  v_mul_f32 v161, s43, v161
  v_mfma_f32_16x16x32_bf16 v[108:111], a[200:203], a[96:99], v[108:111]
  buffer_load_dwordx4 v242, s[44:47], s41 offen lds
  v_mul_f32 v162, s43, v162
  v_mul_f32 v163, s43, v163
  v_mfma_f32_16x16x32_bf16 v[108:111], a[204:207], a[112:115], v[108:111]
  s_mov_b32 s41, 2293760
  s_add_u32 m0, s42, 131072
  v_mul_f32 v164, s43, v164
  v_mul_f32 v165, s43, v165
  v_mfma_f32_16x16x32_bf16 v[140:143], a[200:203], a[100:103], v[140:143]
  v_mul_f32 v166, s43, v166
  v_mul_f32 v167, s43, v167
  v_mfma_f32_16x16x32_bf16 v[140:143], a[204:207], a[116:119], v[140:143]
  v_exp_f32 v160, v160
  v_mfma_f32_16x16x32_bf16 v[172:175], a[200:203], a[104:107], v[172:175]
  v_exp_f32 v161, v161
  v_mfma_f32_16x16x32_bf16 v[172:175], a[204:207], a[120:123], v[172:175]
  v_exp_f32 v162, v162
  v_mfma_f32_16x16x32_bf16 v[204:207], a[200:203], a[108:111], v[204:207]
  buffer_load_dwordx4 v253, s[44:47], s41 offen lds
  v_mfma_f32_16x16x32_bf16 v[204:207], a[204:207], a[124:127], v[204:207]
  ds_read_b64_tr_b16 a[200:201], v231 offset:16384
  ds_read_b64_tr_b16 a[202:203], v231 offset:18432
  v_mfma_f32_16x16x32_bf16 v[120:123], a[208:211], a[96:99], v[120:123]
  ds_read_b64_tr_b16 a[204:205], v231 offset:20480
  ds_read_b64_tr_b16 a[206:207], v231 offset:22528
  v_exp_f32 v163, v163
  s_waitcnt lgkmcnt(13)
  v_mfma_f32_16x16x32_bf16 v[120:123], a[212:215], a[112:115], v[120:123]
  s_mov_b32 s41, 2555904
  s_add_u32 m0, s42, 135168
  v_exp_f32 v164, v164
  v_mfma_f32_16x16x32_bf16 v[152:155], a[208:211], a[100:103], v[152:155]
  v_exp_f32 v165, v165
  v_mfma_f32_16x16x32_bf16 v[152:155], a[212:215], a[116:119], v[152:155]
  v_exp_f32 v166, v166
  v_mfma_f32_16x16x32_bf16 v[184:187], a[208:211], a[104:107], v[184:187]
  buffer_load_dwordx4 v253, s[44:47], s41 offen lds
  v_exp_f32 v167, v167
  v_add_f32 v160, 1.0, v160
  v_mfma_f32_16x16x32_bf16 v[184:187], a[212:215], a[120:123], v[184:187]
  s_mov_b32 s41, 2883584
  s_add_u32 m0, s42, 139264
  v_add_f32 v161, 1.0, v161
  v_add_f32 v162, 1.0, v162
  v_mfma_f32_16x16x32_bf16 v[216:219], a[208:211], a[108:111], v[216:219]
  ds_read_b64_tr_b16 a[208:209], v230 offset:24576
  ds_read_b64_tr_b16 a[210:211], v230 offset:26624
  v_add_f32 v163, 1.0, v163
  v_add_f32 v164, 1.0, v164
  v_mfma_f32_16x16x32_bf16 v[216:219], a[212:215], a[124:127], v[216:219]
  ds_read_b64_tr_b16 a[212:213], v230 offset:28672
  ds_read_b64_tr_b16 a[214:215], v230 offset:30720
  v_add_f32 v165, 1.0, v165
  v_mfma_f32_16x16x32_bf16 v[124:127], a[216:219], a[96:99], v[124:127]
  v_add_f32 v166, 1.0, v166
  v_add_f32 v167, 1.0, v167
  v_mfma_f32_16x16x32_bf16 v[124:127], a[220:223], a[112:115], v[124:127]
  v_rcp_f32 v160, v160
  v_mfma_f32_16x16x32_bf16 v[156:159], a[216:219], a[100:103], v[156:159]
  buffer_load_dwordx4 v242, s[44:47], s41 offen lds
  v_mfma_f32_16x16x32_bf16 v[156:159], a[220:223], a[116:119], v[156:159]
  s_mov_b32 s41, 3145728
  s_add_u32 m0, s42, 143360
  v_rcp_f32 v161, v161
  v_mfma_f32_16x16x32_bf16 v[188:191], a[216:219], a[104:107], v[188:191]
  v_rcp_f32 v162, v162
  v_mfma_f32_16x16x32_bf16 v[188:191], a[220:223], a[120:123], v[188:191]
  v_rcp_f32 v163, v163
  v_mfma_f32_16x16x32_bf16 v[220:223], a[216:219], a[108:111], v[220:223]
  ds_read_b64_tr_b16 a[216:217], v231 offset:24576
  ds_read_b64_tr_b16 a[218:219], v231 offset:26624
  v_rcp_f32 v164, v164
  v_mfma_f32_16x16x32_bf16 v[220:223], a[220:223], a[124:127], v[220:223]
  ds_read_b64_tr_b16 a[220:221], v231 offset:28672
  ds_read_b64_tr_b16 a[222:223], v231 offset:30720
  v_mfma_f32_16x16x32_bf16 v[104:107], a[224:227], a[128:131], v[104:107]
  buffer_load_dwordx4 v242, s[44:47], s41 offen lds
  v_rcp_f32 v165, v165
  s_waitcnt lgkmcnt(13)
  v_mfma_f32_16x16x32_bf16 v[104:107], a[228:231], a[144:147], v[104:107]
  s_mov_b32 s41, 2883584
  s_add_u32 m0, s42, 147456
  v_rcp_f32 v166, v166
  v_mfma_f32_16x16x32_bf16 v[136:139], a[224:227], a[132:135], v[136:139]
  v_rcp_f32 v167, v167
  v_mul_f32 v160, v160, v176
  v_mul_f32 v161, v161, v177
  v_mfma_f32_16x16x32_bf16 v[136:139], a[228:231], a[148:151], v[136:139]
  v_mul_f32 v162, v162, v178
  v_mul_f32 v163, v163, v179
  v_mfma_f32_16x16x32_bf16 v[168:171], a[224:227], a[136:139], v[168:171]
  v_mul_f32 v164, v164, v180
  v_mul_f32 v165, v165, v181
  v_mfma_f32_16x16x32_bf16 v[168:171], a[228:231], a[152:155], v[168:171]
  v_mul_f32 v166, v166, v182
  v_mul_f32 v167, v167, v183
  v_mfma_f32_16x16x32_bf16 v[200:203], a[224:227], a[140:143], v[200:203]
  buffer_load_dwordx4 v253, s[44:47], s41 offen lds
  v_cvt_pk_bf16_f32 v160, v160, v161
  v_mfma_f32_16x16x32_bf16 v[200:203], a[228:231], a[156:159], v[200:203]
  ds_read_b64_tr_b16 a[224:225], v230 offset:32768
  ds_read_b64_tr_b16 a[226:227], v230 offset:34816
  v_cvt_pk_bf16_f32 v161, v162, v163
  v_mfma_f32_16x16x32_bf16 v[108:111], a[232:235], a[128:131], v[108:111]
  ds_read_b64_tr_b16 a[228:229], v230 offset:36864
  ds_read_b64_tr_b16 a[230:231], v230 offset:38912
  v_cvt_pk_bf16_f32 v162, v164, v165
  v_cvt_pk_bf16_f32 v163, v166, v167
  v_mfma_f32_16x16x32_bf16 v[108:111], a[236:239], a[144:147], v[108:111]
  s_mov_b32 s41, 3145728
  s_add_u32 m0, s42, 151552
  v_mfma_f32_16x16x32_bf16 v[140:143], a[232:235], a[132:135], v[140:143]
  buffer_store_dwordx4 v[160:163], v225, s[4:7], s62 offen offset:2048 sc1
  v_mul_f32 v192, s43, v192
  v_mul_f32 v193, s43, v193
  v_mfma_f32_16x16x32_bf16 v[140:143], a[236:239], a[148:151], v[140:143]
  v_mul_f32 v194, s43, v194
  v_mul_f32 v195, s43, v195
  v_mfma_f32_16x16x32_bf16 v[172:175], a[232:235], a[136:139], v[172:175]
  buffer_load_dwordx4 v253, s[44:47], s41 offen lds
  v_mul_f32 v196, s43, v196
  v_mfma_f32_16x16x32_bf16 v[172:175], a[236:239], a[152:155], v[172:175]
  s_waitcnt vmcnt(9)
  v_subrev_u32 v244, s100, v244
  v_cmp_lt_u32 s[68:69], 3, v244
  v_mul_f32 v197, s43, v197
  v_mul_f32 v198, s43, v198
  v_mfma_f32_16x16x32_bf16 v[204:207], a[232:235], a[140:143], v[204:207]
  ds_read_b64_tr_b16 a[232:233], v231 offset:32768
  ds_read_b64_tr_b16 a[234:235], v231 offset:34816
  s_cmp_lg_u64 s[68:69], 0
  s_cbranch_scc1 L_slow_37
L_back_38:
  v_mul_f32 v199, s43, v199
  v_mfma_f32_16x16x32_bf16 v[204:207], a[236:239], a[156:159], v[204:207]
  ds_read_b64_tr_b16 a[236:237], v231 offset:36864
  ds_read_b64_tr_b16 a[238:239], v231 offset:38912
  s_add_u32 s100, s100, 1
  v_mfma_f32_16x16x32_bf16 v[120:123], a[192:195], a[128:131], v[120:123]
  s_mov_b32 s40, 1048576
  v_exp_f32 v192, v192
  s_waitcnt lgkmcnt(13)
  v_mfma_f32_16x16x32_bf16 v[120:123], a[196:199], a[144:147], v[120:123]
  v_exp_f32 v193, v193
  v_mfma_f32_16x16x32_bf16 v[152:155], a[192:195], a[132:135], v[152:155]
  buffer_load_dwordx4 a[0:3], v252, s[4:7], s40 offen offset:0 sc1
  v_exp_f32 v194, v194
  v_mfma_f32_16x16x32_bf16 v[152:155], a[196:199], a[148:151], v[152:155]
  v_exp_f32 v195, v195
  v_mfma_f32_16x16x32_bf16 v[184:187], a[192:195], a[136:139], v[184:187]
  v_exp_f32 v196, v196
  v_mfma_f32_16x16x32_bf16 v[184:187], a[196:199], a[152:155], v[184:187]
  v_exp_f32 v197, v197
  v_mfma_f32_16x16x32_bf16 v[216:219], a[192:195], a[140:143], v[216:219]
  ds_read_b64_tr_b16 a[192:193], v228 offset:40960
  ds_read_b64_tr_b16 a[194:195], v228 offset:43008
  v_exp_f32 v198, v198
  v_mfma_f32_16x16x32_bf16 v[216:219], a[196:199], a[156:159], v[216:219]
  ds_read_b64_tr_b16 a[196:197], v228 offset:45056
  ds_read_b64_tr_b16 a[198:199], v228 offset:47104
  v_mfma_f32_16x16x32_bf16 v[124:127], a[200:203], a[128:131], v[124:127]
  buffer_load_dwordx4 a[4:7], v252, s[4:7], s40 offen offset:1024 sc1
  v_exp_f32 v199, v199
  v_add_f32 v192, 1.0, v192
  v_add_f32 v193, 1.0, v193
  v_mfma_f32_16x16x32_bf16 v[124:127], a[204:207], a[144:147], v[124:127]
  s_barrier
  v_add_f32 v194, 1.0, v194
  v_add_f32 v195, 1.0, v195
  v_mfma_f32_16x16x32_bf16 v[156:159], a[200:203], a[132:135], v[156:159]
  s_mov_b32 s40, 1179648
  v_add_f32 v196, 1.0, v196
  v_add_f32 v197, 1.0, v197
  v_mfma_f32_16x16x32_bf16 v[156:159], a[204:207], a[148:151], v[156:159]
  v_add_f32 v198, 1.0, v198
  v_add_f32 v199, 1.0, v199
  v_mfma_f32_16x16x32_bf16 v[188:191], a[200:203], a[136:139], v[188:191]
  v_rcp_f32 v192, v192
  v_mfma_f32_16x16x32_bf16 v[188:191], a[204:207], a[152:155], v[188:191]
  v_rcp_f32 v193, v193
  v_mfma_f32_16x16x32_bf16 v[220:223], a[200:203], a[140:143], v[220:223]
  buffer_load_dwordx4 a[8:11], v252, s[4:7], s40 offen offset:0 sc1
  v_mfma_f32_16x16x32_bf16 v[220:223], a[204:207], a[156:159], v[220:223]
  ds_read_b64_tr_b16 a[200:201], v229 offset:40960
  ds_read_b64_tr_b16 a[202:203], v229 offset:43008
  v_mfma_f32_16x16x32_bf16 v[104:107], a[208:211], a[160:163], v[104:107]
  ds_read_b64_tr_b16 a[204:205], v229 offset:45056
  ds_read_b64_tr_b16 a[206:207], v229 offset:47104
  v_rcp_f32 v194, v194
  s_waitcnt lgkmcnt(13)
  v_mfma_f32_16x16x32_bf16 v[104:107], a[212:215], a[176:179], v[104:107]
  v_rcp_f32 v195, v195
  v_mfma_f32_16x16x32_bf16 v[136:139], a[208:211], a[164:167], v[136:139]
  v_rcp_f32 v196, v196
  v_mfma_f32_16x16x32_bf16 v[136:139], a[212:215], a[180:183], v[136:139]
  v_rcp_f32 v197, v197
  v_mfma_f32_16x16x32_bf16 v[168:171], a[208:211], a[168:171], v[168:171]
  buffer_load_dwordx4 a[12:15], v252, s[4:7], s40 offen offset:1024 sc1
  v_rcp_f32 v198, v198
  v_mfma_f32_16x16x32_bf16 v[168:171], a[212:215], a[184:187], v[168:171]
  s_mov_b32 s40, 1310720
  v_rcp_f32 v199, v199
  v_mul_f32 v192, v192, v208
  v_mfma_f32_16x16x32_bf16 v[200:203], a[208:211], a[172:175], v[200:203]
  ds_read_b64_tr_b16 a[208:209], v230 offset:40960
  ds_read_b64_tr_b16 a[210:211], v230 offset:43008
  v_mul_f32 v193, v193, v209
  v_mul_f32 v194, v194, v210
  v_mfma_f32_16x16x32_bf16 v[200:203], a[212:215], a[188:191], v[200:203]
  ds_read_b64_tr_b16 a[212:213], v230 offset:45056
  ds_read_b64_tr_b16 a[214:215], v230 offset:47104
  v_mul_f32 v195, v195, v211
  v_mfma_f32_16x16x32_bf16 v[108:111], a[216:219], a[160:163], v[108:111]
  v_mul_f32 v196, v196, v212
  v_mul_f32 v197, v197, v213
  v_mfma_f32_16x16x32_bf16 v[108:111], a[220:223], a[176:179], v[108:111]
  v_mul_f32 v198, v198, v214
  v_mul_f32 v199, v199, v215
  v_mfma_f32_16x16x32_bf16 v[140:143], a[216:219], a[164:167], v[140:143]
  buffer_load_dwordx4 a[16:19], v252, s[4:7], s40 offen offset:0 sc1
  v_cvt_pk_bf16_f32 v192, v192, v193
  v_cvt_pk_bf16_f32 v193, v194, v195
  v_mfma_f32_16x16x32_bf16 v[140:143], a[220:223], a[180:183], v[140:143]
  v_cvt_pk_bf16_f32 v194, v196, v197
  v_cvt_pk_bf16_f32 v195, v198, v199
  v_mfma_f32_16x16x32_bf16 v[172:175], a[216:219], a[168:171], v[172:175]
  buffer_store_dwordx4 v[192:195], v225, s[4:7], s62 offen offset:3072 sc1
  v_mfma_f32_16x16x32_bf16 v[172:175], a[220:223], a[184:187], v[172:175]
  v_mfma_f32_16x16x32_bf16 v[204:207], a[216:219], a[172:175], v[204:207]
  ds_read_b64_tr_b16 a[216:217], v231 offset:40960
  ds_read_b64_tr_b16 a[218:219], v231 offset:43008
  v_mfma_f32_16x16x32_bf16 v[204:207], a[220:223], a[188:191], v[204:207]
  ds_read_b64_tr_b16 a[220:221], v231 offset:45056
  ds_read_b64_tr_b16 a[222:223], v231 offset:47104
  v_mfma_f32_16x16x32_bf16 v[120:123], a[224:227], a[160:163], v[120:123]
  buffer_load_dwordx4 a[20:23], v252, s[4:7], s40 offen offset:1024 sc1
  s_waitcnt lgkmcnt(13)
  v_mfma_f32_16x16x32_bf16 v[120:123], a[228:231], a[176:179], v[120:123]
  s_mov_b32 s40, 1441792
  v_mfma_f32_16x16x32_bf16 v[152:155], a[224:227], a[164:167], v[152:155]
  v_mfma_f32_16x16x32_bf16 v[152:155], a[228:231], a[180:183], v[152:155]
  v_mfma_f32_16x16x32_bf16 v[184:187], a[224:227], a[168:171], v[184:187]
  v_mfma_f32_16x16x32_bf16 v[184:187], a[228:231], a[184:187], v[184:187]
  v_mfma_f32_16x16x32_bf16 v[216:219], a[224:227], a[172:175], v[216:219]
  buffer_load_dwordx4 a[24:27], v252, s[4:7], s40 offen offset:0 sc1
  v_mfma_f32_16x16x32_bf16 v[216:219], a[228:231], a[188:191], v[216:219]
  ds_read_b64_tr_b16 a[224:225], v228 offset:49152
  ds_read_b64_tr_b16 a[226:227], v228 offset:51200
  v_mfma_f32_16x16x32_bf16 v[124:127], a[232:235], a[160:163], v[124:127]
  ds_read_b64_tr_b16 a[228:229], v228 offset:53248
  ds_read_b64_tr_b16 a[230:231], v228 offset:55296
  v_mfma_f32_16x16x32_bf16 v[124:127], a[236:239], a[176:179], v[124:127]
  v_mfma_f32_16x16x32_bf16 v[156:159], a[232:235], a[164:167], v[156:159]
  v_mfma_f32_16x16x32_bf16 v[156:159], a[236:239], a[180:183], v[156:159]
  v_mfma_f32_16x16x32_bf16 v[188:191], a[232:235], a[168:171], v[188:191]
  buffer_load_dwordx4 a[28:31], v252, s[4:7], s40 offen offset:1024 sc1
  v_mfma_f32_16x16x32_bf16 v[188:191], a[236:239], a[184:187], v[188:191]
  s_mov_b32 s40, 1572864
  v_mfma_f32_16x16x32_bf16 v[220:223], a[232:235], a[172:175], v[220:223]
  ds_read_b64_tr_b16 a[232:233], v229 offset:49152
  ds_read_b64_tr_b16 a[234:235], v229 offset:51200
  v_mfma_f32_16x16x32_bf16 v[220:223], a[236:239], a[188:191], v[220:223]
  ds_read_b64_tr_b16 a[236:237], v229 offset:53248
  ds_read_b64_tr_b16 a[238:239], v229 offset:55296
  s_waitcnt vmcnt(5)
  v_mfma_f32_16x16x32_bf16 v[32:35], a[192:195], a[0:3], 0
  v_mul_f32 v104, s43, v104
  v_mul_f32 v105, s43, v105
  s_waitcnt lgkmcnt(13)
  v_mfma_f32_16x16x32_bf16 v[32:35], a[196:199], a[8:11], v[32:35]
  s_barrier
  v_mfma_f32_16x16x32_bf16 v[48:51], a[192:195], a[4:7], 0
  buffer_load_dwordx4 a[32:35], v252, s[4:7], s40 offen offset:0 sc1
  v_mfma_f32_16x16x32_bf16 v[48:51], a[196:199], a[12:15], v[48:51]
  ds_read_b64_tr_b16 a[192:193], v230 offset:49152
  ds_read_b64_tr_b16 a[194:195], v230 offset:51200
  v_mul_f32 v106, s43, v106
  v_mfma_f32_16x16x32_bf16 v[36:39], a[200:203], a[0:3], 0
  ds_read_b64_tr_b16 a[196:197], v230 offset:53248
  ds_read_b64_tr_b16 a[198:199], v230 offset:55296
  v_mul_f32 v107, s43, v107
  v_mfma_f32_16x16x32_bf16 v[36:39], a[204:207], a[8:11], v[36:39]
  v_mul_f32 v108, s43, v108
  v_mul_f32 v109, s43, v109
  v_mfma_f32_16x16x32_bf16 v[52:55], a[200:203], a[4:7], 0
  buffer_load_dwordx4 a[36:39], v252, s[4:7], s40 offen offset:1024 sc1
  v_mfma_f32_16x16x32_bf16 v[52:55], a[204:207], a[12:15], v[52:55]
  ds_read_b64_tr_b16 a[200:201], v231 offset:49152
  ds_read_b64_tr_b16 a[202:203], v231 offset:51200
  v_mfma_f32_16x16x32_bf16 v[40:43], a[208:211], a[0:3], 0
  ds_read_b64_tr_b16 a[204:205], v231 offset:53248
  ds_read_b64_tr_b16 a[206:207], v231 offset:55296
  v_mul_f32 v110, s43, v110
  s_waitcnt lgkmcnt(13)
  v_mfma_f32_16x16x32_bf16 v[40:43], a[212:215], a[8:11], v[40:43]
  s_mov_b32 s40, 1703936
  v_mul_f32 v111, s43, v111
  v_mfma_f32_16x16x32_bf16 v[56:59], a[208:211], a[4:7], 0
  buffer_load_dwordx4 a[40:43], v252, s[4:7], s40 offen offset:0 sc1
  v_mfma_f32_16x16x32_bf16 v[56:59], a[212:215], a[12:15], v[56:59]
  ds_read_b64_tr_b16 a[208:209], v228 offset:57344
  ds_read_b64_tr_b16 a[210:211], v228 offset:59392
  v_mfma_f32_16x16x32_bf16 v[44:47], a[216:219], a[0:3], 0
  ds_read_b64_tr_b16 a[212:213], v228 offset:61440
  ds_read_b64_tr_b16 a[214:215], v228 offset:63488
  v_mfma_f32_16x16x32_bf16 v[44:47], a[220:223], a[8:11], v[44:47]
  v_exp_f32 v104, v104
  v_mfma_f32_16x16x32_bf16 v[60:63], a[216:219], a[4:7], 0
  buffer_load_dwordx4 a[44:47], v252, s[4:7], s40 offen offset:1024 sc1
  v_mfma_f32_16x16x32_bf16 v[60:63], a[220:223], a[12:15], v[60:63]
  ds_read_b64_tr_b16 a[216:217], v229 offset:57344
  ds_read_b64_tr_b16 a[218:219], v229 offset:59392
  v_mfma_f32_16x16x32_bf16 v[0:3], a[224:227], a[0:3], 0
  ds_read_b64_tr_b16 a[220:221], v229 offset:61440
  ds_read_b64_tr_b16 a[222:223], v229 offset:63488
  v_exp_f32 v105, v105
  s_waitcnt lgkmcnt(13)
  v_mfma_f32_16x16x32_bf16 v[0:3], a[228:231], a[8:11], v[0:3]
  s_mov_b32 s40, 1835008
  v_mfma_f32_16x16x32_bf16 v[16:19], a[224:227], a[4:7], 0
  buffer_load_dwordx4 a[48:51], v252, s[4:7], s40 offen offset:0 sc1
  v_mfma_f32_16x16x32_bf16 v[16:19], a[228:231], a[12:15], v[16:19]
  ds_read_b64_tr_b16 a[224:225], v230 offset:57344
  ds_read_b64_tr_b16 a[226:227], v230 offset:59392
  v_exp_f32 v106, v106
  v_mfma_f32_16x16x32_bf16 v[4:7], a[232:235], a[0:3], 0
  ds_read_b64_tr_b16 a[228:229], v230 offset:61440
  ds_read_b64_tr_b16 a[230:231], v230 offset:63488
  v_mfma_f32_16x16x32_bf16 v[4:7], a[236:239], a[8:11], v[4:7]
  v_exp_f32 v107, v107
  v_mfma_f32_16x16x32_bf16 v[20:23], a[232:235], a[4:7], 0
  buffer_load_dwordx4 a[52:55], v252, s[4:7], s40 offen offset:1024 sc1
  v_mfma_f32_16x16x32_bf16 v[20:23], a[236:239], a[12:15], v[20:23]
  ds_read_b64_tr_b16 a[232:233], v231 offset:57344
  ds_read_b64_tr_b16 a[234:235], v231 offset:59392
  v_mfma_f32_16x16x32_bf16 v[8:11], a[192:195], a[0:3], 0
  ds_read_b64_tr_b16 a[236:237], v231 offset:61440
  ds_read_b64_tr_b16 a[238:239], v231 offset:63488
  v_exp_f32 v108, v108
  s_waitcnt lgkmcnt(13)
  v_mfma_f32_16x16x32_bf16 v[8:11], a[196:199], a[8:11], v[8:11]
  s_mov_b32 s40, 1966080
  v_mfma_f32_16x16x32_bf16 v[24:27], a[192:195], a[4:7], 0
  buffer_load_dwordx4 a[56:59], v252, s[4:7], s40 offen offset:0 sc1
  v_mfma_f32_16x16x32_bf16 v[24:27], a[196:199], a[12:15], v[24:27]
  ds_read_b64_tr_b16 a[192:193], v232 offset:0
  ds_read_b64_tr_b16 a[194:195], v232 offset:2048
  v_exp_f32 v109, v109
  v_mfma_f32_16x16x32_bf16 v[12:15], a[200:203], a[0:3], 0
  ds_read_b64_tr_b16 a[196:197], v232 offset:4096
  ds_read_b64_tr_b16 a[198:199], v232 offset:6144
  v_mfma_f32_16x16x32_bf16 v[12:15], a[204:207], a[8:11], v[12:15]
  v_exp_f32 v110, v110
  v_mfma_f32_16x16x32_bf16 v[28:31], a[200:203], a[4:7], 0
  buffer_load_dwordx4 a[60:63], v252, s[4:7], s40 offen offset:1024 sc1
  v_mfma_f32_16x16x32_bf16 v[28:31], a[204:207], a[12:15], v[28:31]
  ds_read_b64_tr_b16 a[200:201], v233 offset:0
  ds_read_b64_tr_b16 a[202:203], v233 offset:2048
  s_waitcnt vmcnt(8)
  v_mfma_f32_16x16x32_bf16 v[32:35], a[208:211], a[16:19], v[32:35]
  ds_read_b64_tr_b16 a[204:205], v233 offset:4096
  ds_read_b64_tr_b16 a[206:207], v233 offset:6144
  v_exp_f32 v111, v111
  v_add_f32 v104, 1.0, v104
  s_waitcnt lgkmcnt(13)
  v_mfma_f32_16x16x32_bf16 v[32:35], a[212:215], a[24:27], v[32:35]
  s_barrier
  v_mfma_f32_16x16x32_bf16 v[48:51], a[208:211], a[20:23], v[48:51]
  ds_read_b64_tr_b16 a[208:209], v234 offset:0
  ds_read_b64_tr_b16 a[210:211], v234 offset:2048
  v_add_f32 v105, 1.0, v105
  v_mfma_f32_16x16x32_bf16 v[48:51], a[212:215], a[28:31], v[48:51]
  ds_read_b64_tr_b16 a[212:213], v234 offset:4096
  ds_read_b64_tr_b16 a[214:215], v234 offset:6144
  v_add_f32 v106, 1.0, v106
  v_mfma_f32_16x16x32_bf16 v[36:39], a[216:219], a[16:19], v[36:39]
  s_mov_b32 s40, 2097152
  v_add_f32 v107, 1.0, v107
  v_mfma_f32_16x16x32_bf16 v[36:39], a[220:223], a[24:27], v[36:39]
  buffer_load_dwordx4 a[64:67], v252, s[4:7], s40 offen offset:0 sc1
  v_mfma_f32_16x16x32_bf16 v[52:55], a[216:219], a[20:23], v[52:55]
  ds_read_b64_tr_b16 a[216:217], v235 offset:0
  ds_read_b64_tr_b16 a[218:219], v235 offset:2048
  v_add_f32 v108, 1.0, v108
  v_mfma_f32_16x16x32_bf16 v[52:55], a[220:223], a[28:31], v[52:55]
  ds_read_b64_tr_b16 a[220:221], v235 offset:4096
  ds_read_b64_tr_b16 a[222:223], v235 offset:6144
  v_add_f32 v109, 1.0, v109
  v_mfma_f32_16x16x32_bf16 v[40:43], a[224:227], a[16:19], v[40:43]
  buffer_load_dwordx4 a[68:71], v252, s[4:7], s40 offen offset:1024 sc1
  v_add_f32 v110, 1.0, v110
  s_waitcnt lgkmcnt(13)
  v_mfma_f32_16x16x32_bf16 v[40:43], a[228:231], a[24:27], v[40:43]
  s_mov_b32 s40, 2228224
  buffer_store_dword v245, v246, s[4:7], s90 offen sc1
  v_mfma_f32_16x16x32_bf16 v[56:59], a[224:227], a[20:23], v[56:59]
  ds_read_b64_tr_b16 a[224:225], v232 offset:8192
  ds_read_b64_tr_b16 a[226:227], v232 offset:10240
  v_add_u32 v245, 1, v245
  v_add_f32 v111, 1.0, v111
  v_mfma_f32_16x16x32_bf16 v[56:59], a[228:231], a[28:31], v[56:59]
  ds_read_b64_tr_b16 a[228:229], v232 offset:12288
  ds_read_b64_tr_b16 a[230:231], v232 offset:14336
  v_mfma_f32_16x16x32_bf16 v[44:47], a[232:235], a[16:19], v[44:47]
  buffer_load_dwordx4 a[72:75], v252, s[4:7], s40 offen offset:0 sc1
  v_mfma_f32_16x16x32_bf16 v[44:47], a[236:239], a[24:27], v[44:47]
  v_rcp_f32 v104, v104
  v_mfma_f32_16x16x32_bf16 v[60:63], a[232:235], a[20:23], v[60:63]
  ds_read_b64_tr_b16 a[232:233], v233 offset:8192
  ds_read_b64_tr_b16 a[234:235], v233 offset:10240
  v_mfma_f32_16x16x32_bf16 v[60:63], a[236:239], a[28:31], v[60:63]
  ds_read_b64_tr_b16 a[236:237], v233 offset:12288
  ds_read_b64_tr_b16 a[238:239], v233 offset:14336
  v_mfma_f32_16x16x32_bf16 v[0:3], a[192:195], a[16:19], v[0:3]
  buffer_load_dwordx4 a[76:79], v252, s[4:7], s40 offen offset:1024 sc1
  v_rcp_f32 v105, v105
  s_waitcnt lgkmcnt(13)
  v_mfma_f32_16x16x32_bf16 v[0:3], a[196:199], a[24:27], v[0:3]
  s_mov_b32 s40, 2359296
  v_mfma_f32_16x16x32_bf16 v[16:19], a[192:195], a[20:23], v[16:19]
  ds_read_b64_tr_b16 a[192:193], v234 offset:8192
  ds_read_b64_tr_b16 a[194:195], v234 offset:10240
  v_mfma_f32_16x16x32_bf16 v[16:19], a[196:199], a[28:31], v[16:19]
  ds_read_b64_tr_b16 a[196:197], v234 offset:12288
  ds_read_b64_tr_b16 a[198:199], v234 offset:14336
  v_rcp_f32 v106, v106
  v_mfma_f32_16x16x32_bf16 v[4:7], a[200:203], a[16:19], v[4:7]
  buffer_load_dwordx4 a[80:83], v252, s[4:7], s40 offen offset:0 sc1
  v_mfma_f32_16x16x32_bf16 v[4:7], a[204:207], a[24:27], v[4:7]
  v_rcp_f32 v107, v107
  v_mfma_f32_16x16x32_bf16 v[20:23], a[200:203], a[20:23], v[20:23]
  ds_read_b64_tr_b16 a[200:201], v235 offset:8192
  ds_read_b64_tr_b16 a[202:203], v235 offset:10240
  v_mfma_f32_16x16x32_bf16 v[20:23], a[204:207], a[28:31], v[20:23]
  ds_read_b64_tr_b16 a[204:205], v235 offset:12288
  ds_read_b64_tr_b16 a[206:207], v235 offset:14336
  v_mfma_f32_16x16x32_bf16 v[8:11], a[208:211], a[16:19], v[8:11]
  buffer_load_dwordx4 a[84:87], v252, s[4:7], s40 offen offset:1024 sc1
  v_rcp_f32 v108, v108
  s_waitcnt lgkmcnt(13)
  v_mfma_f32_16x16x32_bf16 v[8:11], a[212:215], a[24:27], v[8:11]
  s_mov_b32 s40, 2490368
  v_mfma_f32_16x16x32_bf16 v[24:27], a[208:211], a[20:23], v[24:27]
  ds_read_b64_tr_b16 a[208:209], v232 offset:16384
  ds_read_b64_tr_b16 a[210:211], v232 offset:18432
  v_mfma_f32_16x16x32_bf16 v[24:27], a[212:215], a[28:31], v[24:27]
  ds_read_b64_tr_b16 a[212:213], v232 offset:20480
  ds_read_b64_tr_b16 a[214:215], v232 offset:22528
  v_rcp_f32 v109, v109
  v_mfma_f32_16x16x32_bf16 v[12:15], a[216:219], a[16:19], v[12:15]
  buffer_load_dwordx4 a[88:91], v252, s[4:7], s40 offen offset:0 sc1
  v_mfma_f32_16x16x32_bf16 v[12:15], a[220:223], a[24:27], v[12:15]
  v_rcp_f32 v110, v110
  v_mfma_f32_16x16x32_bf16 v[28:31], a[216:219], a[20:23], v[28:31]
  ds_read_b64_tr_b16 a[216:217], v233 offset:16384
  ds_read_b64_tr_b16 a[218:219], v233 offset:18432
  v_mfma_f32_16x16x32_bf16 v[28:31], a[220:223], a[28:31], v[28:31]
  ds_read_b64_tr_b16 a[220:221], v233 offset:20480
  ds_read_b64_tr_b16 a[222:223], v233 offset:22528
  s_waitcnt vmcnt(12)
  v_mfma_f32_16x16x32_bf16 v[32:35], a[224:227], a[32:35], v[32:35]
  buffer_load_dwordx4 a[92:95], v252, s[4:7], s40 offen offset:1024 sc1
  v_rcp_f32 v111, v111
  v_mul_f32 v104, v104, v120
  s_waitcnt lgkmcnt(13)
  v_mfma_f32_16x16x32_bf16 v[32:35], a[228:231], a[40:43], v[32:35]
  s_barrier
  v_mfma_f32_16x16x32_bf16 v[48:51], a[224:227], a[36:39], v[48:51]
  ds_read_b64_tr_b16 a[224:225], v234 offset:16384
  ds_read_b64_tr_b16 a[226:227], v234 offset:18432
  v_mul_f32 v105, v105, v121
  v_mfma_f32_16x16x32_bf16 v[48:51], a[228:231], a[44:47], v[48:51]
  ds_read_b64_tr_b16 a[228:229], v234 offset:20480
  ds_read_b64_tr_b16 a[230:231], v234 offset:22528
  v_mul_f32 v106, v106, v122
  v_mfma_f32_16x16x32_bf16 v[36:39], a[232:235], a[32:35], v[36:39]
  s_mov_b32 s40, 2621440
  v_mul_f32 v107, v107, v123
  v_mfma_f32_16x16x32_bf16 v[36:39], a[236:239], a[40:43], v[36:39]
  buffer_load_dwordx4 a[96:99], v252, s[4:7], s40 offen offset:0 sc1
  v_mfma_f32_16x16x32_bf16 v[52:55], a[232:235], a[36:39], v[52:55]
  ds_read_b64_tr_b16 a[232:233], v235 offset:16384
  ds_read_b64_tr_b16 a[234:235], v235 offset:18432
  v_mul_f32 v108, v108, v124
  v_mfma_f32_16x16x32_bf16 v[52:55], a[236:239], a[44:47], v[52:55]
  ds_read_b64_tr_b16 a[236:237], v235 offset:20480
  ds_read_b64_tr_b16 a[238:239], v235 offset:22528
  v_mul_f32 v109, v109, v125
  v_mfma_f32_16x16x32_bf16 v[40:43], a[192:195], a[32:35], v[40:43]
  buffer_load_dwordx4 a[100:103], v252, s[4:7], s40 offen offset:1024 sc1
  v_mul_f32 v110, v110, v126
  s_waitcnt lgkmcnt(13)
  v_mfma_f32_16x16x32_bf16 v[40:43], a[196:199], a[40:43], v[40:43]
  s_mov_b32 s40, 2752512
  v_mul_f32 v111, v111, v127
  v_mfma_f32_16x16x32_bf16 v[56:59], a[192:195], a[36:39], v[56:59]
  ds_read_b64_tr_b16 a[192:193], v232 offset:24576
  ds_read_b64_tr_b16 a[194:195], v232 offset:26624
  v_mfma_f32_16x16x32_bf16 v[56:59], a[196:199], a[44:47], v[56:59]
  ds_read_b64_tr_b16 a[196:197], v232 offset:28672
  ds_read_b64_tr_b16 a[198:199], v232 offset:30720
  v_cvt_pk_bf16_f32 v104, v104, v105
  v_mfma_f32_16x16x32_bf16 v[44:47], a[200:203], a[32:35], v[44:47]
  buffer_load_dwordx4 a[104:107], v252, s[4:7], s40 offen offset:0 sc1
  v_cvt_pk_bf16_f32 v105, v106, v107
  v_mfma_f32_16x16x32_bf16 v[44:47], a[204:207], a[40:43], v[44:47]
  v_cvt_pk_bf16_f32 v106, v108, v109
  v_cvt_pk_bf16_f32 v107, v110, v111
  v_mfma_f32_16x16x32_bf16 v[60:63], a[200:203], a[36:39], v[60:63]
  ds_read_b64_tr_b16 a[200:201], v233 offset:24576
  ds_read_b64_tr_b16 a[202:203], v233 offset:26624
  v_mfma_f32_16x16x32_bf16 v[60:63], a[204:207], a[44:47], v[60:63]
  ds_read_b64_tr_b16 a[204:205], v233 offset:28672
  ds_read_b64_tr_b16 a[206:207], v233 offset:30720
  v_mfma_f32_16x16x32_bf16 v[0:3], a[208:211], a[32:35], v[0:3]
  buffer_load_dwordx4 a[108:111], v252, s[4:7], s40 offen offset:1024 sc1
  s_waitcnt lgkmcnt(13)
  v_mfma_f32_16x16x32_bf16 v[0:3], a[212:215], a[40:43], v[0:3]
  s_mov_b32 s41, 3211264
  s_add_u32 m0, s42, 155648
  v_mfma_f32_16x16x32_bf16 v[16:19], a[208:211], a[36:39], v[16:19]
  ds_read_b64_tr_b16 a[208:209], v234 offset:24576
  ds_read_b64_tr_b16 a[210:211], v234 offset:26624
  v_mfma_f32_16x16x32_bf16 v[16:19], a[212:215], a[44:47], v[16:19]
  ds_read_b64_tr_b16 a[212:213], v234 offset:28672
  ds_read_b64_tr_b16 a[214:215], v234 offset:30720
  buffer_store_dwordx4 v[104:107], v225, s[4:7], s63 offen offset:0 sc1
  v_mul_f32 v136, s43, v136
  v_mfma_f32_16x16x32_bf16 v[4:7], a[216:219], a[32:35], v[4:7]
  v_mul_f32 v137, s43, v137
  v_mul_f32 v138, s43, v138
  v_mfma_f32_16x16x32_bf16 v[4:7], a[220:223], a[40:43], v[4:7]
  buffer_load_dwordx4 v242, s[44:47], s41 offen lds
  v_mfma_f32_16x16x32_bf16 v[20:23], a[216:219], a[36:39], v[20:23]
  ds_read_b64_tr_b16 a[216:217], v235 offset:24576
  ds_read_b64_tr_b16 a[218:219], v235 offset:26624
  v_mfma_f32_16x16x32_bf16 v[20:23], a[220:223], a[44:47], v[20:23]
  ds_read_b64_tr_b16 a[220:221], v235 offset:28672
  ds_read_b64_tr_b16 a[222:223], v235 offset:30720
  v_mul_f32 v139, s43, v139
  v_mfma_f32_16x16x32_bf16 v[8:11], a[224:227], a[32:35], v[8:11]
  s_mov_b32 s41, 3473408
  s_add_u32 m0, s42, 159744
  v_mul_f32 v140, s43, v140
  s_waitcnt lgkmcnt(13)
  v_mfma_f32_16x16x32_bf16 v[8:11], a[228:231], a[40:43], v[8:11]
  buffer_load_dwordx4 v242, s[44:47], s41 offen lds
  v_mfma_f32_16x16x32_bf16 v[24:27], a[224:227], a[36:39], v[24:27]
  ds_read_b64_tr_b16 a[224:225], v232 offset:32768
  ds_read_b64_tr_b16 a[226:227], v232 offset:34816
  v_mul_f32 v141, s43, v141
  v_mfma_f32_16x16x32_bf16 v[24:27], a[228:231], a[44:47], v[24:27]
  ds_read_b64_tr_b16 a[228:229], v232 offset:36864
  ds_read_b64_tr_b16 a[230:231], v232 offset:38912
  v_mul_f32 v142, s43, v142
  v_mfma_f32_16x16x32_bf16 v[12:15], a[232:235], a[32:35], v[12:15]
  s_mov_b32 s41, 3211264
  s_add_u32 m0, s42, 8192
  v_mul_f32 v143, s43, v143
  v_mfma_f32_16x16x32_bf16 v[12:15], a[236:239], a[40:43], v[12:15]
  buffer_load_dwordx4 v253, s[44:47], s41 offen lds
  v_mfma_f32_16x16x32_bf16 v[28:31], a[232:235], a[36:39], v[28:31]
  ds_read_b64_tr_b16 a[232:233], v233 offset:32768
  ds_read_b64_tr_b16 a[234:235], v233 offset:34816
  v_mfma_f32_16x16x32_bf16 v[28:31], a[236:239], a[44:47], v[28:31]
  ds_read_b64_tr_b16 a[236:237], v233 offset:36864
  ds_read_b64_tr_b16 a[238:239], v233 offset:38912
  s_waitcnt vmcnt(17)
  v_mfma_f32_16x16x32_bf16 v[32:35], a[192:195], a[48:51], v[32:35]
  s_mov_b32 s41, 3473408
  s_add_u32 m0, s42, 12288
  v_exp_f32 v136, v136
  s_waitcnt lgkmcnt(13)
  v_mfma_f32_16x16x32_bf16 v[32:35], a[196:199], a[56:59], v[32:35]
  s_barrier
  v_mfma_f32_16x16x32_bf16 v[48:51], a[192:195], a[52:55], v[48:51]
  buffer_load_dwordx4 v253, s[44:47], s41 offen lds
  v_mfma_f32_16x16x32_bf16 v[48:51], a[196:199], a[60:63], v[48:51]
  ds_read_b64_tr_b16 a[192:193], v234 offset:32768
  ds_read_b64_tr_b16 a[194:195], v234 offset:34816
  v_exp_f32 v137, v137
  v_mfma_f32_16x16x32_bf16 v[36:39], a[200:203], a[48:51], v[36:39]
  ds_read_b64_tr_b16 a[196:197], v234 offset:36864
L_wk0_8:
  s_cbranch_vccnz L_wk0_12
  ds_read_b64_tr_b16 a[198:199], v234 offset:38912
  v_mfma_f32_16x16x32_bf16 v[36:39], a[204:207], a[56:59], v[36:39]
  s_mov_b32 s40, 2883584
  v_exp_f32 v138, v138
  v_mfma_f32_16x16x32_bf16 v[52:55], a[200:203], a[52:55], v[52:55]
  buffer_load_dwordx4 a[112:115], v252, s[4:7], s40 offen offset:0 sc1
  v_mfma_f32_16x16x32_bf16 v[52:55], a[204:207], a[60:63], v[52:55]
  ds_read_b64_tr_b16 a[200:201], v235 offset:32768
  ds_read_b64_tr_b16 a[202:203], v235 offset:34816
  v_mfma_f32_16x16x32_bf16 v[40:43], a[208:211], a[48:51], v[40:43]
  ds_read_b64_tr_b16 a[204:205], v235 offset:36864
  ds_read_b64_tr_b16 a[206:207], v235 offset:38912
  v_exp_f32 v139, v139
  s_waitcnt lgkmcnt(13)
  v_mfma_f32_16x16x32_bf16 v[40:43], a[212:215], a[56:59], v[40:43]
  buffer_load_dwordx4 a[116:119], v252, s[4:7], s40 offen offset:1024 sc1
  v_mfma_f32_16x16x32_bf16 v[56:59], a[208:211], a[52:55], v[56:59]
  ds_read_b64_tr_b16 a[208:209], v232 offset:40960
  ds_read_b64_tr_b16 a[210:211], v232 offset:43008
  v_mfma_f32_16x16x32_bf16 v[56:59], a[212:215], a[60:63], v[56:59]
  ds_read_b64_tr_b16 a[212:213], v232 offset:45056
  ds_read_b64_tr_b16 a[214:215], v232 offset:47104
  v_exp_f32 v140, v140
  v_mfma_f32_16x16x32_bf16 v[44:47], a[216:219], a[48:51], v[44:47]
  s_mov_b32 s40, 3014656
  v_exp_f32 v141, v141
  v_mfma_f32_16x16x32_bf16 v[44:47], a[220:223], a[56:59], v[44:47]
  buffer_load_dwordx4 a[120:123], v252, s[4:7], s40 offen offset:0 sc1
  v_mfma_f32_16x16x32_bf16 v[60:63], a[216:219], a[52:55], v[60:63]
  ds_read_b64_tr_b16 a[216:217], v233 offset:40960
  ds_read_b64_tr_b16 a[218:219], v233 offset:43008
  v_mfma_f32_16x16x32_bf16 v[60:63], a[220:223], a[60:63], v[60:63]
  ds_read_b64_tr_b16 a[220:221], v233 offset:45056
  ds_read_b64_tr_b16 a[222:223], v233 offset:47104
  v_mfma_f32_16x16x32_bf16 v[0:3], a[224:227], a[48:51], v[0:3]
  v_exp_f32 v142, v142
  s_waitcnt lgkmcnt(13)
  v_mfma_f32_16x16x32_bf16 v[0:3], a[228:231], a[56:59], v[0:3]
  buffer_load_dwordx4 a[124:127], v252, s[4:7], s40 offen offset:1024 sc1
  v_mfma_f32_16x16x32_bf16 v[16:19], a[224:227], a[52:55], v[16:19]
  ds_read_b64_tr_b16 a[224:225], v234 offset:40960
  ds_read_b64_tr_b16 a[226:227], v234 offset:43008
  v_mfma_f32_16x16x32_bf16 v[16:19], a[228:231], a[60:63], v[16:19]
  ds_read_b64_tr_b16 a[228:229], v234 offset:45056
  ds_read_b64_tr_b16 a[230:231], v234 offset:47104
  v_exp_f32 v143, v143
  v_add_f32 v136, 1.0, v136
  v_mfma_f32_16x16x32_bf16 v[4:7], a[232:235], a[48:51], v[4:7]
  s_mov_b32 s41, 196608
  s_add_u32 m0, s42, 16384
  v_add_f32 v137, 1.0, v137
  v_mfma_f32_16x16x32_bf16 v[4:7], a[236:239], a[56:59], v[4:7]
  buffer_load_dwordx4 v242, s[44:47], s41 offen lds
  v_mfma_f32_16x16x32_bf16 v[20:23], a[232:235], a[52:55], v[20:23]
  ds_read_b64_tr_b16 a[232:233], v235 offset:40960
  ds_read_b64_tr_b16 a[234:235], v235 offset:43008
  v_add_f32 v138, 1.0, v138
  v_mfma_f32_16x16x32_bf16 v[20:23], a[236:239], a[60:63], v[20:23]
  ds_read_b64_tr_b16 a[236:237], v235 offset:45056
  ds_read_b64_tr_b16 a[238:239], v235 offset:47104
  v_add_f32 v139, 1.0, v139
  v_mfma_f32_16x16x32_bf16 v[8:11], a[192:195], a[48:51], v[8:11]
  s_mov_b32 s41, 655360
  s_add_u32 m0, s42, 20480
  v_add_f32 v140, 1.0, v140
  s_waitcnt lgkmcnt(13)
  v_mfma_f32_16x16x32_bf16 v[8:11], a[196:199], a[56:59], v[8:11]
  buffer_load_dwordx4 v242, s[44:47], s41 offen lds
  v_mfma_f32_16x16x32_bf16 v[24:27], a[192:195], a[52:55], v[24:27]
  ds_read_b64_tr_b16 a[192:193], v232 offset:49152
  ds_read_b64_tr_b16 a[194:195], v232 offset:51200
  v_add_f32 v141, 1.0, v141
  v_mfma_f32_16x16x32_bf16 v[24:27], a[196:199], a[60:63], v[24:27]
  ds_read_b64_tr_b16 a[196:197], v232 offset:53248
  ds_read_b64_tr_b16 a[198:199], v232 offset:55296
  v_add_f32 v142, 1.0, v142
  v_mfma_f32_16x16x32_bf16 v[12:15], a[200:203], a[48:51], v[12:15]
  s_mov_b32 s41, 196608
  s_add_u32 m0, s42, 24576
  v_add_f32 v143, 1.0, v143
  v_mfma_f32_16x16x32_bf16 v[12:15], a[204:207], a[56:59], v[12:15]
  buffer_load_dwordx4 v253, s[44:47], s41 offen lds
  v_mfma_f32_16x16x32_bf16 v[28:31], a[200:203], a[52:55], v[28:31]
  ds_read_b64_tr_b16 a[200:201], v233 offset:49152
  ds_read_b64_tr_b16 a[202:203], v233 offset:51200
  v_mfma_f32_16x16x32_bf16 v[28:31], a[204:207], a[60:63], v[28:31]
  ds_read_b64_tr_b16 a[204:205], v233 offset:53248
  ds_read_b64_tr_b16 a[206:207], v233 offset:55296
  s_waitcnt vmcnt(20)
  v_mfma_f32_16x16x32_bf16 v[32:35], a[208:211], a[64:67], v[32:35]
  s_mov_b32 s41, 655360
  s_add_u32 m0, s42, 28672
  v_rcp_f32 v136, v136
  s_waitcnt lgkmcnt(13)
  v_mfma_f32_16x16x32_bf16 v[32:35], a[212:215], a[72:75], v[32:35]
  s_barrier
  v_mfma_f32_16x16x32_bf16 v[48:51], a[208:211], a[68:71], v[48:51]
  buffer_load_dwordx4 v253, s[44:47], s41 offen lds
  v_mfma_f32_16x16x32_bf16 v[48:51], a[212:215], a[76:79], v[48:51]
  ds_read_b64_tr_b16 a[208:209], v234 offset:49152
  ds_read_b64_tr_b16 a[210:211], v234 offset:51200
  v_rcp_f32 v137, v137
  v_mfma_f32_16x16x32_bf16 v[36:39], a[216:219], a[64:67], v[36:39]
  ds_read_b64_tr_b16 a[212:213], v234 offset:53248
  ds_read_b64_tr_b16 a[214:215], v234 offset:55296
  v_mfma_f32_16x16x32_bf16 v[36:39], a[220:223], a[72:75], v[36:39]
  s_mov_b32 s41, 1114112
  s_add_u32 m0, s42, 32768
  v_mfma_f32_16x16x32_bf16 v[52:55], a[216:219], a[68:71], v[52:55]
  buffer_load_dwordx4 v242, s[44:47], s41 offen lds
  v_rcp_f32 v138, v138
  v_mfma_f32_16x16x32_bf16 v[52:55], a[220:223], a[76:79], v[52:55]
  ds_read_b64_tr_b16 a[216:217], v235 offset:49152
  ds_read_b64_tr_b16 a[218:219], v235 offset:51200
  v_mfma_f32_16x16x32_bf16 v[40:43], a[224:227], a[64:67], v[40:43]
  ds_read_b64_tr_b16 a[220:221], v235 offset:53248
  ds_read_b64_tr_b16 a[222:223], v235 offset:55296
  v_rcp_f32 v139, v139
  s_waitcnt lgkmcnt(13)
  v_mfma_f32_16x16x32_bf16 v[40:43], a[228:231], a[72:75], v[40:43]
  s_mov_b32 s41, 1572864
  s_add_u32 m0, s42, 36864
  v_mfma_f32_16x16x32_bf16 v[56:59], a[224:227], a[68:71], v[56:59]
  buffer_load_dwordx4 v242, s[44:47], s41 offen lds
  v_mfma_f32_16x16x32_bf16 v[56:59], a[228:231], a[76:79], v[56:59]
  ds_read_b64_tr_b16 a[224:225], v232 offset:57344
  ds_read_b64_tr_b16 a[226:227], v232 offset:59392
  v_rcp_f32 v140, v140
  v_mfma_f32_16x16x32_bf16 v[44:47], a[232:235], a[64:67], v[44:47]
  ds_read_b64_tr_b16 a[228:229], v232 offset:61440
  ds_read_b64_tr_b16 a[230:231], v232 offset:63488
  v_mfma_f32_16x16x32_bf16 v[44:47], a[236:239], a[72:75], v[44:47]
  s_mov_b32 s41, 1114112
  s_add_u32 m0, s42, 40960
  v_mfma_f32_16x16x32_bf16 v[60:63], a[232:235], a[68:71], v[60:63]
  buffer_load_dwordx4 v253, s[44:47], s41 offen lds
  v_rcp_f32 v141, v141
  v_mfma_f32_16x16x32_bf16 v[60:63], a[236:239], a[76:79], v[60:63]
  ds_read_b64_tr_b16 a[232:233], v233 offset:57344
  ds_read_b64_tr_b16 a[234:235], v233 offset:59392
  v_mfma_f32_16x16x32_bf16 v[0:3], a[192:195], a[64:67], v[0:3]
  ds_read_b64_tr_b16 a[236:237], v233 offset:61440
  ds_read_b64_tr_b16 a[238:239], v233 offset:63488
  v_rcp_f32 v142, v142
  s_waitcnt lgkmcnt(13)
  v_mfma_f32_16x16x32_bf16 v[0:3], a[196:199], a[72:75], v[0:3]
  s_mov_b32 s41, 1572864
  s_add_u32 m0, s42, 45056
  v_mfma_f32_16x16x32_bf16 v[16:19], a[192:195], a[68:71], v[16:19]
  buffer_load_dwordx4 v253, s[44:47], s41 offen lds
  v_mfma_f32_16x16x32_bf16 v[16:19], a[196:199], a[76:79], v[16:19]
  ds_read_b64_tr_b16 a[192:193], v234 offset:57344
  ds_read_b64_tr_b16 a[194:195], v234 offset:59392
  v_rcp_f32 v143, v143
  v_mul_f32 v136, v136, v152
  v_mfma_f32_16x16x32_bf16 v[4:7], a[200:203], a[64:67], v[4:7]
  ds_read_b64_tr_b16 a[196:197], v234 offset:61440
  ds_read_b64_tr_b16 a[198:199], v234 offset:63488
  v_mul_f32 v137, v137, v153
  v_mfma_f32_16x16x32_bf16 v[4:7], a[204:207], a[72:75], v[4:7]
  s_mov_b32 s41, 2031616
  s_add_u32 m0, s42, 49152
  v_mfma_f32_16x16x32_bf16 v[20:23], a[200:203], a[68:71], v[20:23]
  buffer_load_dwordx4 v242, s[44:47], s41 offen lds
  v_mul_f32 v138, v138, v154
  v_mfma_f32_16x16x32_bf16 v[20:23], a[204:207], a[76:79], v[20:23]
  ds_read_b64_tr_b16 a[200:201], v235 offset:57344
  ds_read_b64_tr_b16 a[202:203], v235 offset:59392
  buffer_load_dword v244, v243, s[4:7], s91 offen sc1
  v_mul_f32 v139, v139, v155
  v_mfma_f32_16x16x32_bf16 v[8:11], a[208:211], a[64:67], v[8:11]
  ds_read_b64_tr_b16 a[204:205], v235 offset:61440
  ds_read_b64_tr_b16 a[206:207], v235 offset:63488
  v_mul_f32 v140, v140, v156
  s_waitcnt lgkmcnt(13)
  v_mfma_f32_16x16x32_bf16 v[8:11], a[212:215], a[72:75], v[8:11]
  s_mov_b32 s41, 2490368
  s_add_u32 m0, s42, 53248
  v_mfma_f32_16x16x32_bf16 v[24:27], a[208:211], a[68:71], v[24:27]
  buffer_load_dwordx4 v242, s[44:47], s41 offen lds
  v_mul_f32 v141, v141, v157
  v_mfma_f32_16x16x32_bf16 v[24:27], a[212:215], a[76:79], v[24:27]
  ds_read_b64_tr_b16 a[208:209], v236 offset:0
  ds_read_b64_tr_b16 a[210:211], v236 offset:2048
  v_mul_f32 v142, v142, v158
  v_mfma_f32_16x16x32_bf16 v[12:15], a[216:219], a[64:67], v[12:15]
  ds_read_b64_tr_b16 a[212:213], v236 offset:4096
  ds_read_b64_tr_b16 a[214:215], v236 offset:6144
  v_mul_f32 v143, v143, v159
  v_mfma_f32_16x16x32_bf16 v[12:15], a[220:223], a[72:75], v[12:15]
  s_mov_b32 s41, 2031616
  s_add_u32 m0, s42, 57344
  v_mfma_f32_16x16x32_bf16 v[28:31], a[216:219], a[68:71], v[28:31]
  buffer_load_dwordx4 v253, s[44:47], s41 offen lds
  v_cvt_pk_bf16_f32 v136, v136, v137
  v_mfma_f32_16x16x32_bf16 v[28:31], a[220:223], a[76:79], v[28:31]
  ds_read_b64_tr_b16 a[216:217], v237 offset:0
  ds_read_b64_tr_b16 a[218:219], v237 offset:2048
  v_cvt_pk_bf16_f32 v137, v138, v139
  s_waitcnt vmcnt(25)
  v_mfma_f32_16x16x32_bf16 v[32:35], a[224:227], a[80:83], v[32:35]
  ds_read_b64_tr_b16 a[220:221], v237 offset:4096
  ds_read_b64_tr_b16 a[222:223], v237 offset:6144
  v_cvt_pk_bf16_f32 v138, v140, v141
  s_waitcnt lgkmcnt(13)
  v_mfma_f32_16x16x32_bf16 v[32:35], a[228:231], a[88:91], v[32:35]
  s_barrier
  v_mfma_f32_16x16x32_bf16 v[48:51], a[224:227], a[84:87], v[48:51]
  ds_read_b64_tr_b16 a[224:225], v238 offset:0
  ds_read_b64_tr_b16 a[226:227], v238 offset:2048
  v_cvt_pk_bf16_f32 v139, v142, v143
  v_mfma_f32_16x16x32_bf16 v[48:51], a[228:231], a[92:95], v[48:51]
  ds_read_b64_tr_b16 a[228:229], v238 offset:4096
  ds_read_b64_tr_b16 a[230:231], v238 offset:6144
  v_mfma_f32_16x16x32_bf16 v[36:39], a[232:235], a[80:83], v[36:39]
  s_mov_b32 s41, 2490368
  s_add_u32 m0, s42, 61440
  v_mfma_f32_16x16x32_bf16 v[36:39], a[236:239], a[88:91], v[36:39]
  buffer_load_dwordx4 v253, s[44:47], s41 offen lds
  v_mfma_f32_16x16x32_bf16 v[52:55], a[232:235], a[84:87], v[52:55]
  ds_read_b64_tr_b16 a[232:233], v239 offset:0
  ds_read_b64_tr_b16 a[234:235], v239 offset:2048
  buffer_store_dwordx4 v[136:139], v225, s[4:7], s63 offen offset:1024 sc1
  v_mul_f32 v168, s43, v168
  v_mfma_f32_16x16x32_bf16 v[52:55], a[236:239], a[92:95], v[52:55]
  ds_read_b64_tr_b16 a[236:237], v239 offset:4096
  ds_read_b64_tr_b16 a[238:239], v239 offset:6144
  v_mul_f32 v169, s43, v169
  v_mfma_f32_16x16x32_bf16 v[40:43], a[192:195], a[80:83], v[40:43]
  s_mov_b32 s41, 2949120
  s_add_u32 m0, s42, 65536
  v_mul_f32 v170, s43, v170
  s_waitcnt lgkmcnt(13)
  v_mfma_f32_16x16x32_bf16 v[40:43], a[196:199], a[88:91], v[40:43]
  buffer_load_dwordx4 v242, s[44:47], s41 offen lds
  v_mfma_f32_16x16x32_bf16 v[56:59], a[192:195], a[84:87], v[56:59]
  ds_read_b64_tr_b16 a[192:193], v236 offset:8192
  ds_read_b64_tr_b16 a[194:195], v236 offset:10240
  v_mul_f32 v171, s43, v171
  v_mfma_f32_16x16x32_bf16 v[56:59], a[196:199], a[92:95], v[56:59]
  ds_read_b64_tr_b16 a[196:197], v236 offset:12288
  ds_read_b64_tr_b16 a[198:199], v236 offset:14336
  v_mul_f32 v172, s43, v172
  v_mfma_f32_16x16x32_bf16 v[44:47], a[200:203], a[80:83], v[44:47]
  s_mov_b32 s41, 3407872
  s_add_u32 m0, s42, 69632
  v_mul_f32 v173, s43, v173
  v_mfma_f32_16x16x32_bf16 v[44:47], a[204:207], a[88:91], v[44:47]
  buffer_load_dwordx4 v242, s[44:47], s41 offen lds
  v_mfma_f32_16x16x32_bf16 v[60:63], a[200:203], a[84:87], v[60:63]
  ds_read_b64_tr_b16 a[200:201], v237 offset:8192
  ds_read_b64_tr_b16 a[202:203], v237 offset:10240
  v_mul_f32 v174, s43, v174
  v_mfma_f32_16x16x32_bf16 v[60:63], a[204:207], a[92:95], v[60:63]
  ds_read_b64_tr_b16 a[204:205], v237 offset:12288
  ds_read_b64_tr_b16 a[206:207], v237 offset:14336
  v_mul_f32 v175, s43, v175
  v_mfma_f32_16x16x32_bf16 v[0:3], a[208:211], a[80:83], v[0:3]
  s_mov_b32 s41, 2949120
  s_add_u32 m0, s42, 73728
  s_waitcnt lgkmcnt(13)
  v_mfma_f32_16x16x32_bf16 v[0:3], a[212:215], a[88:91], v[0:3]
  buffer_load_dwordx4 v253, s[44:47], s41 offen lds
  v_mfma_f32_16x16x32_bf16 v[16:19], a[208:211], a[84:87], v[16:19]
  ds_read_b64_tr_b16 a[208:209], v238 offset:8192
  ds_read_b64_tr_b16 a[210:211], v238 offset:10240
  v_mfma_f32_16x16x32_bf16 v[16:19], a[212:215], a[92:95], v[16:19]
  ds_read_b64_tr_b16 a[212:213], v238 offset:12288
  ds_read_b64_tr_b16 a[214:215], v238 offset:14336
  v_exp_f32 v168, v168
  v_mfma_f32_16x16x32_bf16 v[4:7], a[216:219], a[80:83], v[4:7]
  s_mov_b32 s41, 3407872
  s_add_u32 m0, s42, 77824
  v_mfma_f32_16x16x32_bf16 v[4:7], a[220:223], a[88:91], v[4:7]
  buffer_load_dwordx4 v253, s[44:47], s41 offen lds
  v_mfma_f32_16x16x32_bf16 v[20:23], a[216:219], a[84:87], v[20:23]
  ds_read_b64_tr_b16 a[216:217], v239 offset:8192
  ds_read_b64_tr_b16 a[218:219], v239 offset:10240
  v_exp_f32 v169, v169
  v_mfma_f32_16x16x32_bf16 v[20:23], a[220:223], a[92:95], v[20:23]
  ds_read_b64_tr_b16 a[220:221], v239 offset:12288
  ds_read_b64_tr_b16 a[222:223], v239 offset:14336
  v_mfma_f32_16x16x32_bf16 v[8:11], a[224:227], a[80:83], v[8:11]
  s_mov_b32 s41, 0
  s_add_u32 m0, s42, 81920
  v_exp_f32 v170, v170
  s_waitcnt lgkmcnt(13)
  v_mfma_f32_16x16x32_bf16 v[8:11], a[228:231], a[88:91], v[8:11]
  buffer_load_dwordx4 v242, s[44:47], s41 offen lds
  v_mfma_f32_16x16x32_bf16 v[24:27], a[224:227], a[84:87], v[24:27]
  ds_read_b64_tr_b16 a[224:225], v236 offset:16384
  ds_read_b64_tr_b16 a[226:227], v236 offset:18432
  v_mfma_f32_16x16x32_bf16 v[24:27], a[228:231], a[92:95], v[24:27]
  ds_read_b64_tr_b16 a[228:229], v236 offset:20480
  ds_read_b64_tr_b16 a[230:231], v236 offset:22528
  v_exp_f32 v171, v171
  v_mfma_f32_16x16x32_bf16 v[12:15], a[232:235], a[80:83], v[12:15]
  s_mov_b32 s41, 262144
  s_add_u32 m0, s42, 86016
  v_mfma_f32_16x16x32_bf16 v[12:15], a[236:239], a[88:91], v[12:15]
  buffer_load_dwordx4 v242, s[44:47], s41 offen lds
  v_mfma_f32_16x16x32_bf16 v[28:31], a[232:235], a[84:87], v[28:31]
  ds_read_b64_tr_b16 a[232:233], v237 offset:16384
  ds_read_b64_tr_b16 a[234:235], v237 offset:18432
  v_exp_f32 v172, v172
  v_mfma_f32_16x16x32_bf16 v[28:31], a[236:239], a[92:95], v[28:31]
  ds_read_b64_tr_b16 a[236:237], v237 offset:20480
  ds_read_b64_tr_b16 a[238:239], v237 offset:22528
  s_waitcnt vmcnt(10)
  v_subrev_u32 v244, s100, v244
  v_mfma_f32_16x16x32_bf16 v[32:35], a[192:195], a[96:99], v[32:35]
  s_mov_b32 s41, 0
  s_add_u32 m0, s42, 90112
  v_cmp_lt_u32 s[68:69], 3, v244
  v_exp_f32 v173, v173
  s_waitcnt lgkmcnt(13)
  v_mfma_f32_16x16x32_bf16 v[32:35], a[196:199], a[104:107], v[32:35]
  s_barrier
  s_cmp_lg_u64 s[68:69], 0
  s_cbranch_scc1 L_slow_39
L_back_40:
  v_mfma_f32_16x16x32_bf16 v[48:51], a[192:195], a[100:103], v[48:51]
  buffer_load_dwordx4 v253, s[44:47], s41 offen lds
  s_add_u32 s100, s100, 1
  v_mfma_f32_16x16x32_bf16 v[48:51], a[196:199], a[108:111], v[48:51]
  ds_read_b64_tr_b16 a[192:193], v238 offset:16384
  ds_read_b64_tr_b16 a[194:195], v238 offset:18432
  v_exp_f32 v174, v174
  v_mfma_f32_16x16x32_bf16 v[36:39], a[200:203], a[96:99], v[36:39]
  ds_read_b64_tr_b16 a[196:197], v238 offset:20480
  ds_read_b64_tr_b16 a[198:199], v238 offset:22528
  v_mfma_f32_16x16x32_bf16 v[36:39], a[204:207], a[104:107], v[36:39]
  s_mov_b32 s40, 3145728
  v_exp_f32 v175, v175
  v_mfma_f32_16x16x32_bf16 v[52:55], a[200:203], a[100:103], v[52:55]
  buffer_load_dwordx4 v[96:99], v252, s[4:7], s40 offen offset:0 sc1
  v_add_f32 v168, 1.0, v168
  v_mfma_f32_16x16x32_bf16 v[52:55], a[204:207], a[108:111], v[52:55]
  ds_read_b64_tr_b16 a[200:201], v239 offset:16384
  ds_read_b64_tr_b16 a[202:203], v239 offset:18432
  v_add_f32 v169, 1.0, v169
  v_mfma_f32_16x16x32_bf16 v[40:43], a[208:211], a[96:99], v[40:43]
  ds_read_b64_tr_b16 a[204:205], v239 offset:20480
  ds_read_b64_tr_b16 a[206:207], v239 offset:22528
  v_add_f32 v170, 1.0, v170
  s_waitcnt lgkmcnt(13)
  v_mfma_f32_16x16x32_bf16 v[40:43], a[212:215], a[104:107], v[40:43]
  buffer_load_dwordx4 v[100:103], v252, s[4:7], s40 offen offset:1024 sc1
  v_mfma_f32_16x16x32_bf16 v[56:59], a[208:211], a[100:103], v[56:59]
  ds_read_b64_tr_b16 a[208:209], v236 offset:24576
  ds_read_b64_tr_b16 a[210:211], v236 offset:26624
  v_add_f32 v171, 1.0, v171
  v_mfma_f32_16x16x32_bf16 v[56:59], a[212:215], a[108:111], v[56:59]
  ds_read_b64_tr_b16 a[212:213], v236 offset:28672
  ds_read_b64_tr_b16 a[214:215], v236 offset:30720
  v_add_f32 v172, 1.0, v172
  v_mfma_f32_16x16x32_bf16 v[44:47], a[216:219], a[96:99], v[44:47]
  s_mov_b32 s40, 3276800
  v_add_f32 v173, 1.0, v173
  v_mfma_f32_16x16x32_bf16 v[44:47], a[220:223], a[104:107], v[44:47]
  buffer_load_dwordx4 v[112:115], v252, s[4:7], s40 offen offset:0 sc1
  v_mfma_f32_16x16x32_bf16 v[60:63], a[216:219], a[100:103], v[60:63]
  ds_read_b64_tr_b16 a[216:217], v237 offset:24576
  ds_read_b64_tr_b16 a[218:219], v237 offset:26624
  v_add_f32 v174, 1.0, v174
  v_mfma_f32_16x16x32_bf16 v[60:63], a[220:223], a[108:111], v[60:63]
  ds_read_b64_tr_b16 a[220:221], v237 offset:28672
  ds_read_b64_tr_b16 a[222:223], v237 offset:30720
  v_add_f32 v175, 1.0, v175
  v_mfma_f32_16x16x32_bf16 v[0:3], a[224:227], a[96:99], v[0:3]
  v_rcp_f32 v168, v168
  s_waitcnt lgkmcnt(13)
  v_mfma_f32_16x16x32_bf16 v[0:3], a[228:231], a[104:107], v[0:3]
  buffer_load_dwordx4 v[116:119], v252, s[4:7], s40 offen offset:1024 sc1
  v_mfma_f32_16x16x32_bf16 v[16:19], a[224:227], a[100:103], v[16:19]
  ds_read_b64_tr_b16 a[224:225], v238 offset:24576
  ds_read_b64_tr_b16 a[226:227], v238 offset:26624
  v_mfma_f32_16x16x32_bf16 v[16:19], a[228:231], a[108:111], v[16:19]
  ds_read_b64_tr_b16 a[228:229], v238 offset:28672
  ds_read_b64_tr_b16 a[230:231], v238 offset:30720
  v_mfma_f32_16x16x32_bf16 v[4:7], a[232:235], a[96:99], v[4:7]
  s_mov_b32 s40, 3407872
  v_rcp_f32 v169, v169
  v_mfma_f32_16x16x32_bf16 v[4:7], a[236:239], a[104:107], v[4:7]
  buffer_load_dwordx4 v[128:131], v252, s[4:7], s40 offen offset:0 sc1
  v_mfma_f32_16x16x32_bf16 v[20:23], a[232:235], a[100:103], v[20:23]
  ds_read_b64_tr_b16 a[232:233], v239 offset:24576
  ds_read_b64_tr_b16 a[234:235], v239 offset:26624
  v_mfma_f32_16x16x32_bf16 v[20:23], a[236:239], a[108:111], v[20:23]
  ds_read_b64_tr_b16 a[236:237], v239 offset:28672
  ds_read_b64_tr_b16 a[238:239], v239 offset:30720
  v_mfma_f32_16x16x32_bf16 v[8:11], a[192:195], a[96:99], v[8:11]
  v_rcp_f32 v170, v170
  s_waitcnt lgkmcnt(13)
  v_mfma_f32_16x16x32_bf16 v[8:11], a[196:199], a[104:107], v[8:11]
  buffer_load_dwordx4 v[132:135], v252, s[4:7], s40 offen offset:1024 sc1
  v_mfma_f32_16x16x32_bf16 v[24:27], a[192:195], a[100:103], v[24:27]
  ds_read_b64_tr_b16 a[192:193], v228 offset:8192
  ds_read_b64_tr_b16 a[194:195], v228 offset:10240
  v_mfma_f32_16x16x32_bf16 v[24:27], a[196:199], a[108:111], v[24:27]
  ds_read_b64_tr_b16 a[196:197], v228 offset:12288
  ds_read_b64_tr_b16 a[198:199], v228 offset:14336
  v_rcp_f32 v171, v171
  v_mfma_f32_16x16x32_bf16 v[12:15], a[200:203], a[96:99], v[12:15]
  s_mov_b32 s40, 3538944
  v_rcp_f32 v172, v172
  v_mfma_f32_16x16x32_bf16 v[12:15], a[204:207], a[104:107], v[12:15]
  buffer_load_dwordx4 v[144:147], v252, s[4:7], s40 offen offset:0 sc1
  v_mfma_f32_16x16x32_bf16 v[28:31], a[200:203], a[100:103], v[28:31]
  ds_read_b64_tr_b16 a[200:201], v229 offset:8192
  ds_read_b64_tr_b16 a[202:203], v229 offset:10240
  v_mfma_f32_16x16x32_bf16 v[28:31], a[204:207], a[108:111], v[28:31]
  ds_read_b64_tr_b16 a[204:205], v229 offset:12288
  ds_read_b64_tr_b16 a[206:207], v229 offset:14336
  v_mfma_f32_16x16x32_bf16 v[32:35], a[208:211], a[112:115], v[32:35]
  v_rcp_f32 v173, v173
  s_waitcnt lgkmcnt(13)
  v_mfma_f32_16x16x32_bf16 v[32:35], a[212:215], a[120:123], v[32:35]
  s_barrier
  v_mfma_f32_16x16x32_bf16 v[48:51], a[208:211], a[116:119], v[48:51]
  buffer_load_dwordx4 v[148:151], v252, s[4:7], s40 offen offset:1024 sc1
  v_mfma_f32_16x16x32_bf16 v[48:51], a[212:215], a[124:127], v[48:51]
  ds_read_b64_tr_b16 a[208:209], v230 offset:8192
  ds_read_b64_tr_b16 a[210:211], v230 offset:10240
  v_rcp_f32 v174, v174
  v_mfma_f32_16x16x32_bf16 v[36:39], a[216:219], a[112:115], v[36:39]
  ds_read_b64_tr_b16 a[212:213], v230 offset:12288
  ds_read_b64_tr_b16 a[214:215], v230 offset:14336
  v_mfma_f32_16x16x32_bf16 v[36:39], a[220:223], a[120:123], v[36:39]
  s_mov_b32 s40, 3670016
  v_rcp_f32 v175, v175
  v_mfma_f32_16x16x32_bf16 v[52:55], a[216:219], a[116:119], v[52:55]
  buffer_load_dwordx4 v[160:163], v252, s[4:7], s40 offen offset:0 sc1
  v_mul_f32 v168, v168, v184
  v_mfma_f32_16x16x32_bf16 v[52:55], a[220:223], a[124:127], v[52:55]
  ds_read_b64_tr_b16 a[216:217], v231 offset:8192
  ds_read_b64_tr_b16 a[218:219], v231 offset:10240
  v_mul_f32 v169, v169, v185
  v_mfma_f32_16x16x32_bf16 v[40:43], a[224:227], a[112:115], v[40:43]
  ds_read_b64_tr_b16 a[220:221], v231 offset:12288
  ds_read_b64_tr_b16 a[222:223], v231 offset:14336
  v_mul_f32 v170, v170, v186
  s_waitcnt lgkmcnt(13)
  v_mfma_f32_16x16x32_bf16 v[40:43], a[228:231], a[120:123], v[40:43]
  buffer_load_dwordx4 v[164:167], v252, s[4:7], s40 offen offset:1024 sc1
  v_mfma_f32_16x16x32_bf16 v[56:59], a[224:227], a[116:119], v[56:59]
  ds_read_b64_tr_b16 a[224:225], v228 offset:16384
  ds_read_b64_tr_b16 a[226:227], v228 offset:18432
  v_mul_f32 v171, v171, v187
  v_mfma_f32_16x16x32_bf16 v[56:59], a[228:231], a[124:127], v[56:59]
  ds_read_b64_tr_b16 a[228:229], v228 offset:20480
  ds_read_b64_tr_b16 a[230:231], v228 offset:22528
  v_mul_f32 v172, v172, v188
  v_mfma_f32_16x16x32_bf16 v[44:47], a[232:235], a[112:115], v[44:47]
  s_mov_b32 s40, 3801088
  v_mul_f32 v173, v173, v189
  v_mfma_f32_16x16x32_bf16 v[44:47], a[236:239], a[120:123], v[44:47]
  buffer_load_dwordx4 v[176:179], v252, s[4:7], s40 offen offset:0 sc1
  v_mfma_f32_16x16x32_bf16 v[60:63], a[232:235], a[116:119], v[60:63]
  ds_read_b64_tr_b16 a[232:233], v229 offset:16384
  ds_read_b64_tr_b16 a[234:235], v229 offset:18432
  v_mul_f32 v174, v174, v190
  v_mfma_f32_16x16x32_bf16 v[60:63], a[236:239], a[124:127], v[60:63]
  ds_read_b64_tr_b16 a[236:237], v229 offset:20480
  ds_read_b64_tr_b16 a[238:239], v229 offset:22528
  v_mul_f32 v175, v175, v191
  v_mfma_f32_16x16x32_bf16 v[0:3], a[192:195], a[112:115], v[0:3]
  v_cvt_pk_bf16_f32 v168, v168, v169
  v_cvt_pk_bf16_f32 v169, v170, v171
  s_waitcnt lgkmcnt(13)
  v_mfma_f32_16x16x32_bf16 v[0:3], a[196:199], a[120:123], v[0:3]
  buffer_load_dwordx4 v[180:183], v252, s[4:7], s40 offen offset:1024 sc1
  v_mfma_f32_16x16x32_bf16 v[16:19], a[192:195], a[116:119], v[16:19]
  ds_read_b64_tr_b16 a[192:193], v230 offset:16384
  ds_read_b64_tr_b16 a[194:195], v230 offset:18432
  v_mfma_f32_16x16x32_bf16 v[16:19], a[196:199], a[124:127], v[16:19]
  ds_read_b64_tr_b16 a[196:197], v230 offset:20480
  ds_read_b64_tr_b16 a[198:199], v230 offset:22528
  v_cvt_pk_bf16_f32 v170, v172, v173
  v_mfma_f32_16x16x32_bf16 v[4:7], a[200:203], a[112:115], v[4:7]
  s_mov_b32 s40, 3932160
  v_cvt_pk_bf16_f32 v171, v174, v175
  v_mfma_f32_16x16x32_bf16 v[4:7], a[204:207], a[120:123], v[4:7]
  buffer_load_dwordx4 v[192:195], v252, s[4:7], s40 offen offset:0 sc1
  v_mfma_f32_16x16x32_bf16 v[20:23], a[200:203], a[116:119], v[20:23]
  ds_read_b64_tr_b16 a[200:201], v231 offset:16384
  ds_read_b64_tr_b16 a[202:203], v231 offset:18432
  v_mfma_f32_16x16x32_bf16 v[20:23], a[204:207], a[124:127], v[20:23]
  ds_read_b64_tr_b16 a[204:205], v231 offset:20480
  ds_read_b64_tr_b16 a[206:207], v231 offset:22528
  v_mfma_f32_16x16x32_bf16 v[8:11], a[208:211], a[112:115], v[8:11]
  buffer_store_dwordx4 v[168:171], v225, s[4:7], s63 offen offset:2048 sc1
  v_mul_f32 v200, s43, v200
  s_waitcnt lgkmcnt(13)
  v_mfma_f32_16x16x32_bf16 v[8:11], a[212:215], a[120:123], v[8:11]
  v_mul_f32 v201, s43, v201
  v_mul_f32 v202, s43, v202
  v_mfma_f32_16x16x32_bf16 v[24:27], a[208:211], a[116:119], v[24:27]
  buffer_load_dwordx4 v[196:199], v252, s[4:7], s40 offen offset:1024 sc1
  v_mfma_f32_16x16x32_bf16 v[24:27], a[212:215], a[124:127], v[24:27]
  ds_read_b64_tr_b16 a[208:209], v228 offset:24576
  ds_read_b64_tr_b16 a[210:211], v228 offset:26624
  v_mfma_f32_16x16x32_bf16 v[12:15], a[216:219], a[112:115], v[12:15]
  s_waitcnt vmcnt(11)
  v_swap_b32 v98, v100
  v_swap_b32 v99, v101
  v_swap_b32 v114, v116
  v_swap_b32 v115, v117
  ds_read_b64_tr_b16 a[212:213], v228 offset:28672
  ds_read_b64_tr_b16 a[214:215], v228 offset:30720
  v_mul_f32 v203, s43, v203
  v_mfma_f32_16x16x32_bf16 v[12:15], a[220:223], a[120:123], v[12:15]
  s_mov_b32 s40, 4063232
  v_mul_f32 v204, s43, v204
  v_mfma_f32_16x16x32_bf16 v[28:31], a[216:219], a[116:119], v[28:31]
  buffer_load_dwordx4 v[208:211], v252, s[4:7], s40 offen offset:0 sc1
  v_mfma_f32_16x16x32_bf16 v[28:31], a[220:223], a[124:127], v[28:31]
  ds_read_b64_tr_b16 a[216:217], v229 offset:24576
  ds_read_b64_tr_b16 a[218:219], v229 offset:26624
  v_mul_f32 v205, s43, v205
  v_mfma_f32_16x16x32_bf16 v[32:35], a[224:227], v[96:99], v[32:35]
  ds_read_b64_tr_b16 a[220:221], v229 offset:28672
  ds_read_b64_tr_b16 a[222:223], v229 offset:30720
  v_mul_f32 v206, s43, v206
  s_waitcnt lgkmcnt(13)
  v_mfma_f32_16x16x32_bf16 v[32:35], a[228:231], v[112:115], v[32:35]
  s_barrier
  v_mfma_f32_16x16x32_bf16 v[48:51], a[224:227], v[100:103], v[48:51]
  buffer_load_dwordx4 v[212:215], v252, s[4:7], s40 offen offset:1024 sc1
  v_mul_f32 v207, s43, v207
  v_mfma_f32_16x16x32_bf16 v[48:51], a[228:231], v[116:119], v[48:51]
  ds_read_b64_tr_b16 a[224:225], v230 offset:24576
  ds_read_b64_tr_b16 a[226:227], v230 offset:26624
  v_mfma_f32_16x16x32_bf16 v[36:39], a[232:235], v[96:99], v[36:39]
  ds_read_b64_tr_b16 a[228:229], v230 offset:28672
  ds_read_b64_tr_b16 a[230:231], v230 offset:30720
  v_mfma_f32_16x16x32_bf16 v[36:39], a[236:239], v[112:115], v[36:39]
  s_mov_b32 s41, 262144
  s_add_u32 m0, s42, 94208
  v_mfma_f32_16x16x32_bf16 v[52:55], a[232:235], v[100:103], v[52:55]
  buffer_load_dwordx4 v253, s[44:47], s41 offen lds
  v_exp_f32 v200, v200
  v_mfma_f32_16x16x32_bf16 v[52:55], a[236:239], v[116:119], v[52:55]
  ds_read_b64_tr_b16 a[232:233], v231 offset:24576
  ds_read_b64_tr_b16 a[234:235], v231 offset:26624
  v_mfma_f32_16x16x32_bf16 v[40:43], a[192:195], v[96:99], v[40:43]
  ds_read_b64_tr_b16 a[236:237], v231 offset:28672
  ds_read_b64_tr_b16 a[238:239], v231 offset:30720
  v_exp_f32 v201, v201
  s_waitcnt lgkmcnt(13)
  v_mfma_f32_16x16x32_bf16 v[40:43], a[196:199], v[112:115], v[40:43]
  s_mov_b32 s41, 524288
  s_add_u32 m0, s42, 98304
  v_mfma_f32_16x16x32_bf16 v[56:59], a[192:195], v[100:103], v[56:59]
  buffer_load_dwordx4 v242, s[44:47], s41 offen lds
  v_mfma_f32_16x16x32_bf16 v[56:59], a[196:199], v[116:119], v[56:59]
  ds_read_b64_tr_b16 a[192:193], v228 offset:32768
  ds_read_b64_tr_b16 a[194:195], v228 offset:34816
  v_exp_f32 v202, v202
  v_mfma_f32_16x16x32_bf16 v[44:47], a[200:203], v[96:99], v[44:47]
  ds_read_b64_tr_b16 a[196:197], v228 offset:36864
  ds_read_b64_tr_b16 a[198:199], v228 offset:38912
  v_mfma_f32_16x16x32_bf16 v[44:47], a[204:207], v[112:115], v[44:47]
  s_mov_b32 s41, 786432
  s_add_u32 m0, s42, 102400
  v_mfma_f32_16x16x32_bf16 v[60:63], a[200:203], v[100:103], v[60:63]
  buffer_load_dwordx4 v242, s[44:47], s41 offen lds
  v_exp_f32 v203, v203
  v_mfma_f32_16x16x32_bf16 v[60:63], a[204:207], v[116:119], v[60:63]
  ds_read_b64_tr_b16 a[200:201], v229 offset:32768
  ds_read_b64_tr_b16 a[202:203], v229 offset:34816
  v_mfma_f32_16x16x32_bf16 v[0:3], a[208:211], v[96:99], v[0:3]
  ds_read_b64_tr_b16 a[204:205], v229 offset:36864
L_wk0_9:
  s_cbranch_vccnz L_wk0_end
  ds_read_b64_tr_b16 a[206:207], v229 offset:38912
  v_exp_f32 v204, v204
  s_waitcnt lgkmcnt(13)
  v_mfma_f32_16x16x32_bf16 v[0:3], a[212:215], v[112:115], v[0:3]
  s_mov_b32 s41, 524288
  s_add_u32 m0, s42, 106496
  v_mfma_f32_16x16x32_bf16 v[16:19], a[208:211], v[100:103], v[16:19]
  buffer_load_dwordx4 v253, s[44:47], s41 offen lds
  v_mfma_f32_16x16x32_bf16 v[16:19], a[212:215], v[116:119], v[16:19]
  ds_read_b64_tr_b16 a[208:209], v230 offset:32768
  ds_read_b64_tr_b16 a[210:211], v230 offset:34816
  v_exp_f32 v205, v205
  v_mfma_f32_16x16x32_bf16 v[4:7], a[216:219], v[96:99], v[4:7]
  ds_read_b64_tr_b16 a[212:213], v230 offset:36864
  ds_read_b64_tr_b16 a[214:215], v230 offset:38912
  v_mfma_f32_16x16x32_bf16 v[4:7], a[220:223], v[112:115], v[4:7]
  s_mov_b32 s41, 786432
  s_add_u32 m0, s42, 110592
  v_mfma_f32_16x16x32_bf16 v[20:23], a[216:219], v[100:103], v[20:23]
  buffer_load_dwordx4 v253, s[44:47], s41 offen lds
  v_exp_f32 v206, v206
  v_mfma_f32_16x16x32_bf16 v[20:23], a[220:223], v[116:119], v[20:23]
  ds_read_b64_tr_b16 a[216:217], v231 offset:32768
  ds_read_b64_tr_b16 a[218:219], v231 offset:34816
  buffer_load_dword v244, v243, s[4:7], s91 offen sc1
  v_mfma_f32_16x16x32_bf16 v[8:11], a[224:227], v[96:99], v[8:11]
  ds_read_b64_tr_b16 a[220:221], v231 offset:36864
  ds_read_b64_tr_b16 a[222:223], v231 offset:38912
  v_exp_f32 v207, v207
  v_add_f32 v200, 1.0, v200
  s_waitcnt lgkmcnt(13)
  v_mfma_f32_16x16x32_bf16 v[8:11], a[228:231], v[112:115], v[8:11]
  s_mov_b32 s41, 917504
  s_add_u32 m0, s42, 114688
  v_mfma_f32_16x16x32_bf16 v[24:27], a[224:227], v[100:103], v[24:27]
  buffer_load_dwordx4 v242, s[44:47], s41 offen lds
  v_add_f32 v201, 1.0, v201
  v_mfma_f32_16x16x32_bf16 v[24:27], a[228:231], v[116:119], v[24:27]
  ds_read_b64_tr_b16 a[224:225], v228 offset:40960
  ds_read_b64_tr_b16 a[226:227], v228 offset:43008
  v_add_f32 v202, 1.0, v202
  v_mfma_f32_16x16x32_bf16 v[12:15], a[232:235], v[96:99], v[12:15]
  s_waitcnt vmcnt(16)
  v_swap_b32 v130, v132
  v_swap_b32 v131, v133
  v_swap_b32 v146, v148
  v_swap_b32 v147, v149
  ds_read_b64_tr_b16 a[228:229], v228 offset:45056
  ds_read_b64_tr_b16 a[230:231], v228 offset:47104
  v_add_f32 v203, 1.0, v203
  v_mfma_f32_16x16x32_bf16 v[12:15], a[236:239], v[112:115], v[12:15]
  s_mov_b32 s41, 1179648
  s_add_u32 m0, s42, 118784
  v_mfma_f32_16x16x32_bf16 v[28:31], a[232:235], v[100:103], v[28:31]
  buffer_load_dwordx4 v242, s[44:47], s41 offen lds
  v_add_f32 v204, 1.0, v204
  v_mfma_f32_16x16x32_bf16 v[28:31], a[236:239], v[116:119], v[28:31]
  ds_read_b64_tr_b16 a[232:233], v229 offset:40960
  ds_read_b64_tr_b16 a[234:235], v229 offset:43008
  v_add_f32 v205, 1.0, v205
  v_mfma_f32_16x16x32_bf16 v[32:35], a[192:195], v[128:131], v[32:35]
  ds_read_b64_tr_b16 a[236:237], v229 offset:45056
  ds_read_b64_tr_b16 a[238:239], v229 offset:47104
  v_add_f32 v206, 1.0, v206
  s_waitcnt lgkmcnt(13)
  v_mfma_f32_16x16x32_bf16 v[32:35], a[196:199], v[144:147], v[32:35]
  s_barrier
  v_mfma_f32_16x16x32_bf16 v[48:51], a[192:195], v[132:135], v[48:51]
  ds_read_b64_tr_b16 a[192:193], v230 offset:40960
  ds_read_b64_tr_b16 a[194:195], v230 offset:43008
  v_add_f32 v207, 1.0, v207
  v_mfma_f32_16x16x32_bf16 v[48:51], a[196:199], v[148:151], v[48:51]
  ds_read_b64_tr_b16 a[196:197], v230 offset:45056
  ds_read_b64_tr_b16 a[198:199], v230 offset:47104
  v_mfma_f32_16x16x32_bf16 v[36:39], a[200:203], v[128:131], v[36:39]
  s_mov_b32 s41, 917504
  s_add_u32 m0, s42, 122880
  v_mfma_f32_16x16x32_bf16 v[36:39], a[204:207], v[144:147], v[36:39]
  buffer_load_dwordx4 v253, s[44:47], s41 offen lds
  v_mfma_f32_16x16x32_bf16 v[52:55], a[200:203], v[132:135], v[52:55]
  ds_read_b64_tr_b16 a[200:201], v231 offset:40960
  ds_read_b64_tr_b16 a[202:203], v231 offset:43008
  v_rcp_f32 v200, v200
  v_mfma_f32_16x16x32_bf16 v[52:55], a[204:207], v[148:151], v[52:55]
  ds_read_b64_tr_b16 a[204:205], v231 offset:45056
  ds_read_b64_tr_b16 a[206:207], v231 offset:47104
  v_mfma_f32_16x16x32_bf16 v[40:43], a[208:211], v[128:131], v[40:43]
  s_mov_b32 s41, 1179648
  s_add_u32 m0, s42, 126976
  v_rcp_f32 v201, v201
  s_waitcnt lgkmcnt(13)
  v_mfma_f32_16x16x32_bf16 v[40:43], a[212:215], v[144:147], v[40:43]
  buffer_load_dwordx4 v253, s[44:47], s41 offen lds
  v_mfma_f32_16x16x32_bf16 v[56:59], a[208:211], v[132:135], v[56:59]
  ds_read_b64_tr_b16 a[208:209], v228 offset:49152
  ds_read_b64_tr_b16 a[210:211], v228 offset:51200
  v_mfma_f32_16x16x32_bf16 v[56:59], a[212:215], v[148:151], v[56:59]
  ds_read_b64_tr_b16 a[212:213], v228 offset:53248
  ds_read_b64_tr_b16 a[214:215], v228 offset:55296
  v_rcp_f32 v202, v202
  v_mfma_f32_16x16x32_bf16 v[44:47], a[216:219], v[128:131], v[44:47]
  s_mov_b32 s41, 1441792
  s_add_u32 m0, s42, 131072
  v_mfma_f32_16x16x32_bf16 v[44:47], a[220:223], v[144:147], v[44:47]
  buffer_load_dwordx4 v242, s[44:47], s41 offen lds
  v_mfma_f32_16x16x32_bf16 v[60:63], a[216:219], v[132:135], v[60:63]
  ds_read_b64_tr_b16 a[216:217], v229 offset:49152
  ds_read_b64_tr_b16 a[218:219], v229 offset:51200
  v_rcp_f32 v203, v203
  v_mfma_f32_16x16x32_bf16 v[60:63], a[220:223], v[148:151], v[60:63]
  ds_read_b64_tr_b16 a[220:221], v229 offset:53248
  ds_read_b64_tr_b16 a[222:223], v229 offset:55296
  v_mfma_f32_16x16x32_bf16 v[0:3], a[224:227], v[128:131], v[0:3]
  s_mov_b32 s41, 1703936
  s_add_u32 m0, s42, 135168
  v_rcp_f32 v204, v204
  s_waitcnt lgkmcnt(13)
  v_mfma_f32_16x16x32_bf16 v[0:3], a[228:231], v[144:147], v[0:3]
  buffer_load_dwordx4 v242, s[44:47], s41 offen lds
  v_mfma_f32_16x16x32_bf16 v[16:19], a[224:227], v[132:135], v[16:19]
  ds_read_b64_tr_b16 a[224:225], v230 offset:49152
  ds_read_b64_tr_b16 a[226:227], v230 offset:51200
  v_mfma_f32_16x16x32_bf16 v[16:19], a[228:231], v[148:151], v[16:19]
  ds_read_b64_tr_b16 a[228:229], v230 offset:53248
  ds_read_b64_tr_b16 a[230:231], v230 offset:55296
  v_rcp_f32 v205, v205
  v_mfma_f32_16x16x32_bf16 v[4:7], a[232:235], v[128:131], v[4:7]
  s_mov_b32 s41, 1441792
  s_add_u32 m0, s42, 139264
  v_mfma_f32_16x16x32_bf16 v[4:7], a[236:239], v[144:147], v[4:7]
  buffer_load_dwordx4 v253, s[44:47], s41 offen lds
  v_mfma_f32_16x16x32_bf16 v[20:23], a[232:235], v[132:135], v[20:23]
  ds_read_b64_tr_b16 a[232:233], v231 offset:49152
  ds_read_b64_tr_b16 a[234:235], v231 offset:51200
  v_rcp_f32 v206, v206
  v_mfma_f32_16x16x32_bf16 v[20:23], a[236:239], v[148:151], v[20:23]
  ds_read_b64_tr_b16 a[236:237], v231 offset:53248
  ds_read_b64_tr_b16 a[238:239], v231 offset:55296
  v_mfma_f32_16x16x32_bf16 v[8:11], a[192:195], v[128:131], v[8:11]
  s_mov_b32 s41, 1703936
  s_add_u32 m0, s42, 143360
  v_rcp_f32 v207, v207
  v_mul_f32 v200, v200, v216
  s_waitcnt lgkmcnt(13)
  v_mfma_f32_16x16x32_bf16 v[8:11], a[196:199], v[144:147], v[8:11]
  buffer_load_dwordx4 v253, s[44:47], s41 offen lds
  v_mfma_f32_16x16x32_bf16 v[24:27], a[192:195], v[132:135], v[24:27]
  ds_read_b64_tr_b16 a[192:193], v228 offset:57344
  ds_read_b64_tr_b16 a[194:195], v228 offset:59392
  v_mul_f32 v201, v201, v217
  v_mfma_f32_16x16x32_bf16 v[24:27], a[196:199], v[148:151], v[24:27]
  ds_read_b64_tr_b16 a[196:197], v228 offset:61440
  ds_read_b64_tr_b16 a[198:199], v228 offset:63488
  v_mul_f32 v202, v202, v218
  v_mfma_f32_16x16x32_bf16 v[12:15], a[200:203], v[128:131], v[12:15]
  s_waitcnt vmcnt(19)
  v_swap_b32 v162, v164
  v_swap_b32 v163, v165
  v_swap_b32 v178, v180
  v_swap_b32 v179, v181
  s_mov_b32 s41, 1835008
  s_add_u32 m0, s42, 147456
  v_mul_f32 v203, v203, v219
  v_mfma_f32_16x16x32_bf16 v[12:15], a[204:207], v[144:147], v[12:15]
  buffer_load_dwordx4 v242, s[44:47], s41 offen lds
  v_mfma_f32_16x16x32_bf16 v[28:31], a[200:203], v[132:135], v[28:31]
  ds_read_b64_tr_b16 a[200:201], v229 offset:57344
  ds_read_b64_tr_b16 a[202:203], v229 offset:59392
  v_mul_f32 v204, v204, v220
  v_mfma_f32_16x16x32_bf16 v[28:31], a[204:207], v[148:151], v[28:31]
  ds_read_b64_tr_b16 a[204:205], v229 offset:61440
  ds_read_b64_tr_b16 a[206:207], v229 offset:63488
  s_waitcnt vmcnt(9)
  v_subrev_u32 v244, s100, v244
  v_mul_f32 v205, v205, v221
  v_mfma_f32_16x16x32_bf16 v[32:35], a[208:211], v[160:163], v[32:35]
  s_mov_b32 s41, 2097152
  s_add_u32 m0, s42, 151552
  v_cmp_lt_u32 s[68:69], 3, v244
  v_mul_f32 v206, v206, v222
  s_waitcnt lgkmcnt(13)
  v_mfma_f32_16x16x32_bf16 v[32:35], a[212:215], v[176:179], v[32:35]
  s_barrier
  s_cmp_lg_u64 s[68:69], 0
  s_cbranch_scc1 L_slow_41
L_back_42:
  v_mfma_f32_16x16x32_bf16 v[48:51], a[208:211], v[164:167], v[48:51]
  buffer_load_dwordx4 v242, s[44:47], s41 offen lds
  s_add_u32 s100, s100, 1
  v_mul_f32 v207, v207, v223
  v_mfma_f32_16x16x32_bf16 v[48:51], a[212:215], v[180:183], v[48:51]
  ds_read_b64_tr_b16 a[208:209], v230 offset:57344
  ds_read_b64_tr_b16 a[210:211], v230 offset:59392
  v_cvt_pk_bf16_f32 v200, v200, v201
  v_mfma_f32_16x16x32_bf16 v[36:39], a[216:219], v[160:163], v[36:39]
  ds_read_b64_tr_b16 a[212:213], v230 offset:61440
  ds_read_b64_tr_b16 a[214:215], v230 offset:63488
  v_cvt_pk_bf16_f32 v201, v202, v203
  v_mfma_f32_16x16x32_bf16 v[36:39], a[220:223], v[176:179], v[36:39]
  s_mov_b32 s40, 4194304
  v_cvt_pk_bf16_f32 v202, v204, v205
  v_mfma_f32_16x16x32_bf16 v[52:55], a[216:219], v[164:167], v[52:55]
  buffer_load_dwordx4 a[0:3], v252, s[4:7], s40 offen offset:0 sc1
  v_mfma_f32_16x16x32_bf16 v[52:55], a[220:223], v[180:183], v[52:55]
  ds_read_b64_tr_b16 a[216:217], v231 offset:57344
  ds_read_b64_tr_b16 a[218:219], v231 offset:59392
  v_cvt_pk_bf16_f32 v203, v206, v207
  v_mfma_f32_16x16x32_bf16 v[40:43], a[224:227], v[160:163], v[40:43]
  ds_read_b64_tr_b16 a[220:221], v231 offset:61440
  ds_read_b64_tr_b16 a[222:223], v231 offset:63488
  s_waitcnt lgkmcnt(13)
  v_mfma_f32_16x16x32_bf16 v[40:43], a[228:231], v[176:179], v[40:43]
  buffer_load_dwordx4 a[4:7], v252, s[4:7], s40 offen offset:1024 sc1
  v_mfma_f32_16x16x32_bf16 v[56:59], a[224:227], v[164:167], v[56:59]
  ds_read_b64_tr_b16 a[224:225], v232 offset:0
  ds_read_b64_tr_b16 a[226:227], v232 offset:2048
  v_mfma_f32_16x16x32_bf16 v[56:59], a[228:231], v[180:183], v[56:59]
  ds_read_b64_tr_b16 a[228:229], v232 offset:4096
  ds_read_b64_tr_b16 a[230:231], v232 offset:6144
  buffer_store_dwordx4 v[200:203], v225, s[4:7], s63 offen offset:3072 sc1
  v_mfma_f32_16x16x32_bf16 v[44:47], a[232:235], v[160:163], v[44:47]
  s_mov_b32 s40, 4325376
  v_mfma_f32_16x16x32_bf16 v[44:47], a[236:239], v[176:179], v[44:47]
  buffer_load_dwordx4 a[8:11], v252, s[4:7], s40 offen offset:0 sc1
  v_mfma_f32_16x16x32_bf16 v[60:63], a[232:235], v[164:167], v[60:63]
  ds_read_b64_tr_b16 a[232:233], v233 offset:0
  ds_read_b64_tr_b16 a[234:235], v233 offset:2048
  v_mfma_f32_16x16x32_bf16 v[60:63], a[236:239], v[180:183], v[60:63]
  ds_read_b64_tr_b16 a[236:237], v233 offset:4096
  ds_read_b64_tr_b16 a[238:239], v233 offset:6144
  v_mfma_f32_16x16x32_bf16 v[0:3], a[192:195], v[160:163], v[0:3]
  s_waitcnt lgkmcnt(13)
  v_mfma_f32_16x16x32_bf16 v[0:3], a[196:199], v[176:179], v[0:3]
  buffer_load_dwordx4 a[12:15], v252, s[4:7], s40 offen offset:1024 sc1
  v_mfma_f32_16x16x32_bf16 v[16:19], a[192:195], v[164:167], v[16:19]
  ds_read_b64_tr_b16 a[192:193], v234 offset:0
  ds_read_b64_tr_b16 a[194:195], v234 offset:2048
  v_mfma_f32_16x16x32_bf16 v[16:19], a[196:199], v[180:183], v[16:19]
  ds_read_b64_tr_b16 a[196:197], v234 offset:4096
  ds_read_b64_tr_b16 a[198:199], v234 offset:6144
  v_mfma_f32_16x16x32_bf16 v[4:7], a[200:203], v[160:163], v[4:7]
  s_mov_b32 s40, 4456448
  v_mfma_f32_16x16x32_bf16 v[4:7], a[204:207], v[176:179], v[4:7]
  buffer_load_dwordx4 a[16:19], v252, s[4:7], s40 offen offset:0 sc1
  v_mfma_f32_16x16x32_bf16 v[20:23], a[200:203], v[164:167], v[20:23]
  ds_read_b64_tr_b16 a[200:201], v235 offset:0
  ds_read_b64_tr_b16 a[202:203], v235 offset:2048
  v_mfma_f32_16x16x32_bf16 v[20:23], a[204:207], v[180:183], v[20:23]
  ds_read_b64_tr_b16 a[204:205], v235 offset:4096
  ds_read_b64_tr_b16 a[206:207], v235 offset:6144
  v_mfma_f32_16x16x32_bf16 v[8:11], a[208:211], v[160:163], v[8:11]
  s_waitcnt lgkmcnt(13)
  v_mfma_f32_16x16x32_bf16 v[8:11], a[212:215], v[176:179], v[8:11]
  buffer_load_dwordx4 a[20:23], v252, s[4:7], s40 offen offset:1024 sc1
  v_mfma_f32_16x16x32_bf16 v[24:27], a[208:211], v[164:167], v[24:27]
  ds_read_b64_tr_b16 a[208:209], v232 offset:8192
  ds_read_b64_tr_b16 a[210:211], v232 offset:10240
  v_mfma_f32_16x16x32_bf16 v[24:27], a[212:215], v[180:183], v[24:27]
  ds_read_b64_tr_b16 a[212:213], v232 offset:12288
  ds_read_b64_tr_b16 a[214:215], v232 offset:14336
  v_mfma_f32_16x16x32_bf16 v[12:15], a[216:219], v[160:163], v[12:15]
  v_swap_b32 v194, v196
  v_swap_b32 v195, v197
  v_swap_b32 v210, v212
  v_swap_b32 v211, v213
  s_mov_b32 s40, 4587520
  v_mfma_f32_16x16x32_bf16 v[12:15], a[220:223], v[176:179], v[12:15]
  buffer_load_dwordx4 a[24:27], v252, s[4:7], s40 offen offset:0 sc1
  v_mfma_f32_16x16x32_bf16 v[28:31], a[216:219], v[164:167], v[28:31]
  ds_read_b64_tr_b16 a[216:217], v233 offset:8192
  ds_read_b64_tr_b16 a[218:219], v233 offset:10240
  v_mfma_f32_16x16x32_bf16 v[28:31], a[220:223], v[180:183], v[28:31]
  ds_read_b64_tr_b16 a[220:221], v233 offset:12288
  ds_read_b64_tr_b16 a[222:223], v233 offset:14336
  v_mfma_f32_16x16x32_bf16 v[32:35], a[224:227], v[192:195], v[32:35]
  s_waitcnt lgkmcnt(13)
  v_mfma_f32_16x16x32_bf16 v[32:35], a[228:231], v[208:211], v[32:35]
  s_barrier
  v_mfma_f32_16x16x32_bf16 v[48:51], a[224:227], v[196:199], v[48:51]
  buffer_load_dwordx4 a[28:31], v252, s[4:7], s40 offen offset:1024 sc1
  v_mfma_f32_16x16x32_bf16 v[48:51], a[228:231], v[212:215], v[48:51]
  ds_read_b64_tr_b16 a[224:225], v234 offset:8192
  ds_read_b64_tr_b16 a[226:227], v234 offset:10240
  v_mfma_f32_16x16x32_bf16 v[36:39], a[232:235], v[192:195], v[36:39]
  ds_read_b64_tr_b16 a[228:229], v234 offset:12288
  ds_read_b64_tr_b16 a[230:231], v234 offset:14336
  v_mfma_f32_16x16x32_bf16 v[36:39], a[236:239], v[208:211], v[36:39]
  s_mov_b32 s40, 4718592
  v_mfma_f32_16x16x32_bf16 v[52:55], a[232:235], v[196:199], v[52:55]
  buffer_load_dwordx4 a[32:35], v252, s[4:7], s40 offen offset:0 sc1
  v_mfma_f32_16x16x32_bf16 v[52:55], a[236:239], v[212:215], v[52:55]
  ds_read_b64_tr_b16 a[232:233], v235 offset:8192
  ds_read_b64_tr_b16 a[234:235], v235 offset:10240
  v_mfma_f32_16x16x32_bf16 v[40:43], a[192:195], v[192:195], v[40:43]
  ds_read_b64_tr_b16 a[236:237], v235 offset:12288
  ds_read_b64_tr_b16 a[238:239], v235 offset:14336
  s_waitcnt lgkmcnt(13)
  v_mfma_f32_16x16x32_bf16 v[40:43], a[196:199], v[208:211], v[40:43]
  buffer_load_dwordx4 a[36:39], v252, s[4:7], s40 offen offset:1024 sc1
  v_mfma_f32_16x16x32_bf16 v[56:59], a[192:195], v[196:199], v[56:59]
  ds_read_b64_tr_b16 a[192:193], v232 offset:16384
  ds_read_b64_tr_b16 a[194:195], v232 offset:18432
  v_mfma_f32_16x16x32_bf16 v[56:59], a[196:199], v[212:215], v[56:59]
  ds_read_b64_tr_b16 a[196:197], v232 offset:20480
  ds_read_b64_tr_b16 a[198:199], v232 offset:22528
  v_mfma_f32_16x16x32_bf16 v[44:47], a[200:203], v[192:195], v[44:47]
  s_mov_b32 s40, 4849664
  v_mfma_f32_16x16x32_bf16 v[44:47], a[204:207], v[208:211], v[44:47]
  buffer_load_dwordx4 a[40:43], v252, s[4:7], s40 offen offset:0 sc1
  v_mfma_f32_16x16x32_bf16 v[60:63], a[200:203], v[196:199], v[60:63]
  ds_read_b64_tr_b16 a[200:201], v233 offset:16384
  ds_read_b64_tr_b16 a[202:203], v233 offset:18432
  v_mfma_f32_16x16x32_bf16 v[60:63], a[204:207], v[212:215], v[60:63]
  ds_read_b64_tr_b16 a[204:205], v233 offset:20480
  ds_read_b64_tr_b16 a[206:207], v233 offset:22528
  v_mfma_f32_16x16x32_bf16 v[0:3], a[208:211], v[192:195], v[0:3]
  s_waitcnt lgkmcnt(13)
  v_mfma_f32_16x16x32_bf16 v[0:3], a[212:215], v[208:211], v[0:3]
  buffer_load_dwordx4 a[44:47], v252, s[4:7], s40 offen offset:1024 sc1
  v_mfma_f32_16x16x32_bf16 v[16:19], a[208:211], v[196:199], v[16:19]
  ds_read_b64_tr_b16 a[208:209], v234 offset:16384
  ds_read_b64_tr_b16 a[210:211], v234 offset:18432
  v_mfma_f32_16x16x32_bf16 v[16:19], a[212:215], v[212:215], v[16:19]
  ds_read_b64_tr_b16 a[212:213], v234 offset:20480
  ds_read_b64_tr_b16 a[214:215], v234 offset:22528
  v_mfma_f32_16x16x32_bf16 v[4:7], a[216:219], v[192:195], v[4:7]
  s_mov_b32 s40, 4980736
  v_mfma_f32_16x16x32_bf16 v[4:7], a[220:223], v[208:211], v[4:7]
  buffer_load_dwordx4 a[48:51], v252, s[4:7], s40 offen offset:0 sc1
  v_mfma_f32_16x16x32_bf16 v[20:23], a[216:219], v[196:199], v[20:23]
  ds_read_b64_tr_b16 a[216:217], v235 offset:16384
  ds_read_b64_tr_b16 a[218:219], v235 offset:18432
  v_mfma_f32_16x16x32_bf16 v[20:23], a[220:223], v[212:215], v[20:23]
  ds_read_b64_tr_b16 a[220:221], v235 offset:20480
  ds_read_b64_tr_b16 a[222:223], v235 offset:22528
  v_mfma_f32_16x16x32_bf16 v[8:11], a[224:227], v[192:195], v[8:11]
  s_waitcnt lgkmcnt(13)
  v_mfma_f32_16x16x32_bf16 v[8:11], a[228:231], v[208:211], v[8:11]
  buffer_load_dwordx4 a[52:55], v252, s[4:7], s40 offen offset:1024 sc1
  v_mfma_f32_16x16x32_bf16 v[24:27], a[224:227], v[196:199], v[24:27]
  ds_read_b64_tr_b16 a[224:225], v232 offset:24576
  ds_read_b64_tr_b16 a[226:227], v232 offset:26624
  v_mfma_f32_16x16x32_bf16 v[24:27], a[228:231], v[212:215], v[24:27]
  ds_read_b64_tr_b16 a[228:229], v232 offset:28672
  ds_read_b64_tr_b16 a[230:231], v232 offset:30720
  v_mfma_f32_16x16x32_bf16 v[12:15], a[232:235], v[192:195], v[12:15]
  s_mov_b32 s40, 5111808
  v_mfma_f32_16x16x32_bf16 v[12:15], a[236:239], v[208:211], v[12:15]
  buffer_load_dwordx4 a[56:59], v252, s[4:7], s40 offen offset:0 sc1
  v_mfma_f32_16x16x32_bf16 v[28:31], a[232:235], v[196:199], v[28:31]
  ds_read_b64_tr_b16 a[232:233], v233 offset:24576
  ds_read_b64_tr_b16 a[234:235], v233 offset:26624
  v_mfma_f32_16x16x32_bf16 v[28:31], a[236:239], v[212:215], v[28:31]
  ds_read_b64_tr_b16 a[236:237], v233 offset:28672
  ds_read_b64_tr_b16 a[238:239], v233 offset:30720
  s_waitcnt vmcnt(11)
  v_mfma_f32_16x16x32_bf16 v[32:35], a[192:195], a[0:3], v[32:35]
  s_waitcnt lgkmcnt(13)
  v_mfma_f32_16x16x32_bf16 v[32:35], a[196:199], a[8:11], v[32:35]
  s_barrier
  v_mfma_f32_16x16x32_bf16 v[48:51], a[192:195], a[4:7], v[48:51]
  buffer_load_dwordx4 a[60:63], v252, s[4:7], s40 offen offset:1024 sc1
  v_mfma_f32_16x16x32_bf16 v[48:51], a[196:199], a[12:15], v[48:51]
  ds_read_b64_tr_b16 a[192:193], v234 offset:24576
  ds_read_b64_tr_b16 a[194:195], v234 offset:26624
  v_mfma_f32_16x16x32_bf16 v[36:39], a[200:203], a[0:3], v[36:39]
  ds_read_b64_tr_b16 a[196:197], v234 offset:28672
  ds_read_b64_tr_b16 a[198:199], v234 offset:30720
  v_mfma_f32_16x16x32_bf16 v[36:39], a[204:207], a[8:11], v[36:39]
  s_mov_b32 s41, 1835008
  s_add_u32 m0, s42, 155648
  v_mfma_f32_16x16x32_bf16 v[52:55], a[200:203], a[4:7], v[52:55]
  buffer_load_dwordx4 v253, s[44:47], s41 offen lds
  v_mfma_f32_16x16x32_bf16 v[52:55], a[204:207], a[12:15], v[52:55]
  ds_read_b64_tr_b16 a[200:201], v235 offset:24576
  ds_read_b64_tr_b16 a[202:203], v235 offset:26624
  v_mfma_f32_16x16x32_bf16 v[40:43], a[208:211], a[0:3], v[40:43]
  ds_read_b64_tr_b16 a[204:205], v235 offset:28672
  ds_read_b64_tr_b16 a[206:207], v235 offset:30720
  buffer_store_dword v245, v246, s[4:7], s90 offen sc1
  s_waitcnt lgkmcnt(13)
  v_mfma_f32_16x16x32_bf16 v[40:43], a[212:215], a[8:11], v[40:43]
  s_mov_b32 s41, 2097152
  s_add_u32 m0, s42, 159744
  v_add_u32 v245, 1, v245
  v_mfma_f32_16x16x32_bf16 v[56:59], a[208:211], a[4:7], v[56:59]
  buffer_load_dwordx4 v253, s[44:47], s41 offen lds
  v_mfma_f32_16x16x32_bf16 v[56:59], a[212:215], a[12:15], v[56:59]
  ds_read_b64_tr_b16 a[208:209], v232 offset:32768
  ds_read_b64_tr_b16 a[210:211], v232 offset:34816
  v_mfma_f32_16x16x32_bf16 v[44:47], a[216:219], a[0:3], v[44:47]
  ds_read_b64_tr_b16 a[212:213], v232 offset:36864
  ds_read_b64_tr_b16 a[214:215], v232 offset:38912
  v_mfma_f32_16x16x32_bf16 v[44:47], a[220:223], a[8:11], v[44:47]
  s_mov_b32 s40, 5242880
  v_mfma_f32_16x16x32_bf16 v[60:63], a[216:219], a[4:7], v[60:63]
  buffer_load_dwordx4 a[64:67], v252, s[4:7], s40 offen offset:0 sc1
  v_mfma_f32_16x16x32_bf16 v[60:63], a[220:223], a[12:15], v[60:63]
  ds_read_b64_tr_b16 a[216:217], v233 offset:32768
  ds_read_b64_tr_b16 a[218:219], v233 offset:34816
  v_mfma_f32_16x16x32_bf16 v[0:3], a[224:227], a[0:3], v[0:3]
  ds_read_b64_tr_b16 a[220:221], v233 offset:36864
  ds_read_b64_tr_b16 a[222:223], v233 offset:38912
  s_waitcnt lgkmcnt(13)
  v_mfma_f32_16x16x32_bf16 v[0:3], a[228:231], a[8:11], v[0:3]
  buffer_load_dwordx4 a[68:71], v252, s[4:7], s40 offen offset:1024 sc1
  v_mfma_f32_16x16x32_bf16 v[16:19], a[224:227], a[4:7], v[16:19]
  ds_read_b64_tr_b16 a[224:225], v234 offset:32768
  ds_read_b64_tr_b16 a[226:227], v234 offset:34816
  v_mfma_f32_16x16x32_bf16 v[16:19], a[228:231], a[12:15], v[16:19]
  ds_read_b64_tr_b16 a[228:229], v234 offset:36864
  ds_read_b64_tr_b16 a[230:231], v234 offset:38912
  v_mfma_f32_16x16x32_bf16 v[4:7], a[232:235], a[0:3], v[4:7]
  s_mov_b32 s40, 5373952
  v_mfma_f32_16x16x32_bf16 v[4:7], a[236:239], a[8:11], v[4:7]
  buffer_load_dwordx4 a[72:75], v252, s[4:7], s40 offen offset:0 sc1
  v_mfma_f32_16x16x32_bf16 v[20:23], a[232:235], a[4:7], v[20:23]
  ds_read_b64_tr_b16 a[232:233], v235 offset:32768
  ds_read_b64_tr_b16 a[234:235], v235 offset:34816
  v_mfma_f32_16x16x32_bf16 v[20:23], a[236:239], a[12:15], v[20:23]
  ds_read_b64_tr_b16 a[236:237], v235 offset:36864
  ds_read_b64_tr_b16 a[238:239], v235 offset:38912
  v_mfma_f32_16x16x32_bf16 v[8:11], a[192:195], a[0:3], v[8:11]
  s_waitcnt lgkmcnt(13)
  v_mfma_f32_16x16x32_bf16 v[8:11], a[196:199], a[8:11], v[8:11]
  buffer_load_dwordx4 a[76:79], v252, s[4:7], s40 offen offset:1024 sc1
  v_mfma_f32_16x16x32_bf16 v[24:27], a[192:195], a[4:7], v[24:27]
  ds_read_b64_tr_b16 a[192:193], v232 offset:40960
  ds_read_b64_tr_b16 a[194:195], v232 offset:43008
  v_mfma_f32_16x16x32_bf16 v[24:27], a[196:199], a[12:15], v[24:27]
  ds_read_b64_tr_b16 a[196:197], v232 offset:45056
  ds_read_b64_tr_b16 a[198:199], v232 offset:47104
  v_mfma_f32_16x16x32_bf16 v[12:15], a[200:203], a[0:3], v[12:15]
  s_mov_b32 s41, 2359296
  s_add_u32 m0, s42, 8192
  v_mfma_f32_16x16x32_bf16 v[12:15], a[204:207], a[8:11], v[12:15]
  buffer_load_dwordx4 v242, s[44:47], s41 offen lds
  v_mfma_f32_16x16x32_bf16 v[28:31], a[200:203], a[4:7], v[28:31]
  ds_read_b64_tr_b16 a[200:201], v233 offset:40960
  ds_read_b64_tr_b16 a[202:203], v233 offset:43008
  v_mfma_f32_16x16x32_bf16 v[28:31], a[204:207], a[12:15], v[28:31]
  ds_read_b64_tr_b16 a[204:205], v233 offset:45056
  ds_read_b64_tr_b16 a[206:207], v233 offset:47104
  s_waitcnt vmcnt(16)
  v_mfma_f32_16x16x32_bf16 v[32:35], a[208:211], a[16:19], v[32:35]
  s_mov_b32 s41, 2621440
  s_add_u32 m0, s42, 12288
  s_waitcnt lgkmcnt(13)
  v_mfma_f32_16x16x32_bf16 v[32:35], a[212:215], a[24:27], v[32:35]
  s_barrier
  v_mfma_f32_16x16x32_bf16 v[48:51], a[208:211], a[20:23], v[48:51]
  buffer_load_dwordx4 v242, s[44:47], s41 offen lds
  v_mfma_f32_16x16x32_bf16 v[48:51], a[212:215], a[28:31], v[48:51]
  ds_read_b64_tr_b16 a[208:209], v234 offset:40960
  ds_read_b64_tr_b16 a[210:211], v234 offset:43008
  v_mfma_f32_16x16x32_bf16 v[36:39], a[216:219], a[16:19], v[36:39]
  ds_read_b64_tr_b16 a[212:213], v234 offset:45056
  ds_read_b64_tr_b16 a[214:215], v234 offset:47104
  v_mfma_f32_16x16x32_bf16 v[36:39], a[220:223], a[24:27], v[36:39]
  s_mov_b32 s41, 2359296
  s_add_u32 m0, s42, 16384
  v_mfma_f32_16x16x32_bf16 v[52:55], a[216:219], a[20:23], v[52:55]
  buffer_load_dwordx4 v253, s[44:47], s41 offen lds
  v_mfma_f32_16x16x32_bf16 v[52:55], a[220:223], a[28:31], v[52:55]
  ds_read_b64_tr_b16 a[216:217], v235 offset:40960
  ds_read_b64_tr_b16 a[218:219], v235 offset:43008
  v_mfma_f32_16x16x32_bf16 v[40:43], a[224:227], a[16:19], v[40:43]
  ds_read_b64_tr_b16 a[220:221], v235 offset:45056
  ds_read_b64_tr_b16 a[222:223], v235 offset:47104
  s_waitcnt lgkmcnt(13)
  v_mfma_f32_16x16x32_bf16 v[40:43], a[228:231], a[24:27], v[40:43]
  s_mov_b32 s41, 2621440
  s_add_u32 m0, s42, 20480
  v_mfma_f32_16x16x32_bf16 v[56:59], a[224:227], a[20:23], v[56:59]
  buffer_load_dwordx4 v253, s[44:47], s41 offen lds
  v_mfma_f32_16x16x32_bf16 v[56:59], a[228:231], a[28:31], v[56:59]
  ds_read_b64_tr_b16 a[224:225], v232 offset:49152
  ds_read_b64_tr_b16 a[226:227], v232 offset:51200
  v_mfma_f32_16x16x32_bf16 v[44:47], a[232:235], a[16:19], v[44:47]
  ds_read_b64_tr_b16 a[228:229], v232 offset:53248
  ds_read_b64_tr_b16 a[230:231], v232 offset:55296
  v_mfma_f32_16x16x32_bf16 v[44:47], a[236:239], a[24:27], v[44:47]
  s_mov_b32 s40, 5505024
  v_mfma_f32_16x16x32_bf16 v[60:63], a[232:235], a[20:23], v[60:63]
  buffer_load_dwordx4 a[80:83], v252, s[4:7], s40 offen offset:0 sc1
  v_mfma_f32_16x16x32_bf16 v[60:63], a[236:239], a[28:31], v[60:63]
  ds_read_b64_tr_b16 a[232:233], v233 offset:49152
  ds_read_b64_tr_b16 a[234:235], v233 offset:51200
  v_mfma_f32_16x16x32_bf16 v[0:3], a[192:195], a[16:19], v[0:3]
  ds_read_b64_tr_b16 a[236:237], v233 offset:53248
  ds_read_b64_tr_b16 a[238:239], v233 offset:55296
  s_waitcnt lgkmcnt(13)
  v_mfma_f32_16x16x32_bf16 v[0:3], a[196:199], a[24:27], v[0:3]
  buffer_load_dwordx4 a[84:87], v252, s[4:7], s40 offen offset:1024 sc1
  v_mfma_f32_16x16x32_bf16 v[16:19], a[192:195], a[20:23], v[16:19]
  ds_read_b64_tr_b16 a[192:193], v234 offset:49152
  ds_read_b64_tr_b16 a[194:195], v234 offset:51200
  v_mfma_f32_16x16x32_bf16 v[16:19], a[196:199], a[28:31], v[16:19]
  ds_read_b64_tr_b16 a[196:197], v234 offset:53248
  ds_read_b64_tr_b16 a[198:199], v234 offset:55296
  v_mfma_f32_16x16x32_bf16 v[4:7], a[200:203], a[16:19], v[4:7]
  s_mov_b32 s40, 5636096
  v_mfma_f32_16x16x32_bf16 v[4:7], a[204:207], a[24:27], v[4:7]
  buffer_load_dwordx4 a[88:91], v252, s[4:7], s40 offen offset:0 sc1
  v_mfma_f32_16x16x32_bf16 v[20:23], a[200:203], a[20:23], v[20:23]
  ds_read_b64_tr_b16 a[200:201], v235 offset:49152
  ds_read_b64_tr_b16 a[202:203], v235 offset:51200
  v_mfma_f32_16x16x32_bf16 v[20:23], a[204:207], a[28:31], v[20:23]
  ds_read_b64_tr_b16 a[204:205], v235 offset:53248
  ds_read_b64_tr_b16 a[206:207], v235 offset:55296
  v_mfma_f32_16x16x32_bf16 v[8:11], a[208:211], a[16:19], v[8:11]
  s_waitcnt lgkmcnt(13)
  v_mfma_f32_16x16x32_bf16 v[8:11], a[212:215], a[24:27], v[8:11]
  buffer_load_dwordx4 a[92:95], v252, s[4:7], s40 offen offset:1024 sc1
  v_mfma_f32_16x16x32_bf16 v[24:27], a[208:211], a[20:23], v[24:27]
  ds_read_b64_tr_b16 a[208:209], v232 offset:57344
  ds_read_b64_tr_b16 a[210:211], v232 offset:59392
  v_mfma_f32_16x16x32_bf16 v[24:27], a[212:215], a[28:31], v[24:27]
  ds_read_b64_tr_b16 a[212:213], v232 offset:61440
  ds_read_b64_tr_b16 a[214:215], v232 offset:63488
  v_mfma_f32_16x16x32_bf16 v[12:15], a[216:219], a[16:19], v[12:15]
  s_mov_b32 s41, 2752512
  s_add_u32 m0, s42, 24576
  v_mfma_f32_16x16x32_bf16 v[12:15], a[220:223], a[24:27], v[12:15]
  buffer_load_dwordx4 v242, s[44:47], s41 offen lds
  v_mfma_f32_16x16x32_bf16 v[28:31], a[216:219], a[20:23], v[28:31]
  ds_read_b64_tr_b16 a[216:217], v233 offset:57344
  ds_read_b64_tr_b16 a[218:219], v233 offset:59392
  v_mfma_f32_16x16x32_bf16 v[28:31], a[220:223], a[28:31], v[28:31]
  ds_read_b64_tr_b16 a[220:221], v233 offset:61440
  ds_read_b64_tr_b16 a[222:223], v233 offset:63488
  s_waitcnt vmcnt(20)
  v_mfma_f32_16x16x32_bf16 v[32:35], a[224:227], a[32:35], v[32:35]
  s_mov_b32 s41, 3014656
  s_add_u32 m0, s42, 28672
  s_waitcnt lgkmcnt(13)
  v_mfma_f32_16x16x32_bf16 v[32:35], a[228:231], a[40:43], v[32:35]
  s_barrier
  v_mfma_f32_16x16x32_bf16 v[48:51], a[224:227], a[36:39], v[48:51]
  buffer_load_dwordx4 v242, s[44:47], s41 offen lds
  v_mfma_f32_16x16x32_bf16 v[48:51], a[228:231], a[44:47], v[48:51]
  ds_read_b64_tr_b16 a[224:225], v234 offset:57344
  ds_read_b64_tr_b16 a[226:227], v234 offset:59392
  v_mfma_f32_16x16x32_bf16 v[36:39], a[232:235], a[32:35], v[36:39]
  ds_read_b64_tr_b16 a[228:229], v234 offset:61440
  ds_read_b64_tr_b16 a[230:231], v234 offset:63488
  v_mfma_f32_16x16x32_bf16 v[36:39], a[236:239], a[40:43], v[36:39]
  s_mov_b32 s41, 2752512
  s_add_u32 m0, s42, 32768
  v_mfma_f32_16x16x32_bf16 v[52:55], a[232:235], a[36:39], v[52:55]
  buffer_load_dwordx4 v253, s[44:47], s41 offen lds
  v_mfma_f32_16x16x32_bf16 v[52:55], a[236:239], a[44:47], v[52:55]
  ds_read_b64_tr_b16 a[232:233], v235 offset:57344
L_wk0_10:
  s_cbranch_vccnz L_wk0_end
  ds_read_b64_tr_b16 a[234:235], v235 offset:59392
  v_mfma_f32_16x16x32_bf16 v[40:43], a[192:195], a[32:35], v[40:43]
  ds_read_b64_tr_b16 a[236:237], v235 offset:61440
  ds_read_b64_tr_b16 a[238:239], v235 offset:63488
  s_waitcnt lgkmcnt(13)
  v_mfma_f32_16x16x32_bf16 v[40:43], a[196:199], a[40:43], v[40:43]
  s_mov_b32 s41, 3014656
  s_add_u32 m0, s42, 36864
  v_mfma_f32_16x16x32_bf16 v[56:59], a[192:195], a[36:39], v[56:59]
  buffer_load_dwordx4 v253, s[44:47], s41 offen lds
  v_mfma_f32_16x16x32_bf16 v[56:59], a[196:199], a[44:47], v[56:59]
  ds_read_b64_tr_b16 a[192:193], v236 offset:0
  ds_read_b64_tr_b16 a[194:195], v236 offset:2048
  v_mfma_f32_16x16x32_bf16 v[44:47], a[200:203], a[32:35], v[44:47]
  ds_read_b64_tr_b16 a[196:197], v236 offset:4096
  ds_read_b64_tr_b16 a[198:199], v236 offset:6144
  v_mfma_f32_16x16x32_bf16 v[44:47], a[204:207], a[40:43], v[44:47]
  s_mov_b32 s40, 5767168
  v_mfma_f32_16x16x32_bf16 v[60:63], a[200:203], a[36:39], v[60:63]
  buffer_load_dwordx4 a[96:99], v252, s[4:7], s40 offen offset:0 sc1
  v_mfma_f32_16x16x32_bf16 v[60:63], a[204:207], a[44:47], v[60:63]
  ds_read_b64_tr_b16 a[200:201], v237 offset:0
  ds_read_b64_tr_b16 a[202:203], v237 offset:2048
  v_mfma_f32_16x16x32_bf16 v[0:3], a[208:211], a[32:35], v[0:3]
  ds_read_b64_tr_b16 a[204:205], v237 offset:4096
  ds_read_b64_tr_b16 a[206:207], v237 offset:6144
  s_waitcnt lgkmcnt(13)
  v_mfma_f32_16x16x32_bf16 v[0:3], a[212:215], a[40:43], v[0:3]
  buffer_load_dwordx4 a[100:103], v252, s[4:7], s40 offen offset:1024 sc1
  v_mfma_f32_16x16x32_bf16 v[16:19], a[208:211], a[36:39], v[16:19]
  ds_read_b64_tr_b16 a[208:209], v238 offset:0
  ds_read_b64_tr_b16 a[210:211], v238 offset:2048
  v_mfma_f32_16x16x32_bf16 v[16:19], a[212:215], a[44:47], v[16:19]
  ds_read_b64_tr_b16 a[212:213], v238 offset:4096
  ds_read_b64_tr_b16 a[214:215], v238 offset:6144
  v_mfma_f32_16x16x32_bf16 v[4:7], a[216:219], a[32:35], v[4:7]
  s_mov_b32 s40, 5898240
  v_mfma_f32_16x16x32_bf16 v[4:7], a[220:223], a[40:43], v[4:7]
  buffer_load_dwordx4 a[104:107], v252, s[4:7], s40 offen offset:0 sc1
  v_mfma_f32_16x16x32_bf16 v[20:23], a[216:219], a[36:39], v[20:23]
  ds_read_b64_tr_b16 a[216:217], v239 offset:0
  ds_read_b64_tr_b16 a[218:219], v239 offset:2048
  v_mfma_f32_16x16x32_bf16 v[20:23], a[220:223], a[44:47], v[20:23]
  ds_read_b64_tr_b16 a[220:221], v239 offset:4096
  ds_read_b64_tr_b16 a[222:223], v239 offset:6144
  v_mfma_f32_16x16x32_bf16 v[8:11], a[224:227], a[32:35], v[8:11]
  s_waitcnt lgkmcnt(13)
  v_mfma_f32_16x16x32_bf16 v[8:11], a[228:231], a[40:43], v[8:11]
  buffer_load_dwordx4 a[108:111], v252, s[4:7], s40 offen offset:1024 sc1
  v_mfma_f32_16x16x32_bf16 v[24:27], a[224:227], a[36:39], v[24:27]
  ds_read_b64_tr_b16 a[224:225], v236 offset:8192
  ds_read_b64_tr_b16 a[226:227], v236 offset:10240
  v_mfma_f32_16x16x32_bf16 v[24:27], a[228:231], a[44:47], v[24:27]
  ds_read_b64_tr_b16 a[228:229], v236 offset:12288
  ds_read_b64_tr_b16 a[230:231], v236 offset:14336
  v_mfma_f32_16x16x32_bf16 v[12:15], a[232:235], a[32:35], v[12:15]
  s_mov_b32 s41, 3276800
  s_add_u32 m0, s42, 40960
  v_mfma_f32_16x16x32_bf16 v[12:15], a[236:239], a[40:43], v[12:15]
  buffer_load_dwordx4 v242, s[44:47], s41 offen lds
  v_mfma_f32_16x16x32_bf16 v[28:31], a[232:235], a[36:39], v[28:31]
  ds_read_b64_tr_b16 a[232:233], v237 offset:8192
  ds_read_b64_tr_b16 a[234:235], v237 offset:10240
  v_mfma_f32_16x16x32_bf16 v[28:31], a[236:239], a[44:47], v[28:31]
  ds_read_b64_tr_b16 a[236:237], v237 offset:12288
  ds_read_b64_tr_b16 a[238:239], v237 offset:14336
  s_waitcnt vmcnt(24)
  v_mfma_f32_16x16x32_bf16 v[32:35], a[192:195], a[48:51], v[32:35]
  s_mov_b32 s41, 3538944
  s_add_u32 m0, s42, 45056
  s_waitcnt lgkmcnt(13)
  v_mfma_f32_16x16x32_bf16 v[32:35], a[196:199], a[56:59], v[32:35]
  s_waitcnt vmcnt(21)
  s_barrier
  v_mfma_f32_16x16x32_bf16 v[48:51], a[192:195], a[52:55], v[48:51]
  buffer_load_dwordx4 v242, s[44:47], s41 offen lds
  v_mfma_f32_16x16x32_bf16 v[48:51], a[196:199], a[60:63], v[48:51]
  ds_read_b64_tr_b16 a[192:193], v238 offset:8192
  ds_read_b64_tr_b16 a[194:195], v238 offset:10240
  v_mfma_f32_16x16x32_bf16 v[36:39], a[200:203], a[48:51], v[36:39]
  ds_read_b64_tr_b16 a[196:197], v238 offset:12288
  ds_read_b64_tr_b16 a[198:199], v238 offset:14336
  v_mfma_f32_16x16x32_bf16 v[36:39], a[204:207], a[56:59], v[36:39]
  s_mov_b32 s41, 3276800
  s_add_u32 m0, s42, 49152
  v_mfma_f32_16x16x32_bf16 v[52:55], a[200:203], a[52:55], v[52:55]
  buffer_load_dwordx4 v253, s[44:47], s41 offen lds
  v_mfma_f32_16x16x32_bf16 v[52:55], a[204:207], a[60:63], v[52:55]
  ds_read_b64_tr_b16 a[200:201], v239 offset:8192
  ds_read_b64_tr_b16 a[202:203], v239 offset:10240
  v_mfma_f32_16x16x32_bf16 v[40:43], a[208:211], a[48:51], v[40:43]
  ds_read_b64_tr_b16 a[204:205], v239 offset:12288
  ds_read_b64_tr_b16 a[206:207], v239 offset:14336
  s_waitcnt lgkmcnt(13)
  v_mfma_f32_16x16x32_bf16 v[40:43], a[212:215], a[56:59], v[40:43]
  s_mov_b32 s41, 3538944
  s_add_u32 m0, s42, 53248
  v_mfma_f32_16x16x32_bf16 v[56:59], a[208:211], a[52:55], v[56:59]
  buffer_load_dwordx4 v253, s[44:47], s41 offen lds
  v_mfma_f32_16x16x32_bf16 v[56:59], a[212:215], a[60:63], v[56:59]
  ds_read_b64_tr_b16 a[208:209], v236 offset:16384
  ds_read_b64_tr_b16 a[210:211], v236 offset:18432
  v_mfma_f32_16x16x32_bf16 v[44:47], a[216:219], a[48:51], v[44:47]
  ds_read_b64_tr_b16 a[212:213], v236 offset:20480
  ds_read_b64_tr_b16 a[214:215], v236 offset:22528
  v_mfma_f32_16x16x32_bf16 v[44:47], a[220:223], a[56:59], v[44:47]
  s_mov_b32 s40, 6029312
  v_mfma_f32_16x16x32_bf16 v[60:63], a[216:219], a[52:55], v[60:63]
  buffer_load_dwordx4 a[112:115], v252, s[4:7], s40 offen offset:0 sc1
  v_mfma_f32_16x16x32_bf16 v[60:63], a[220:223], a[60:63], v[60:63]
  ds_read_b64_tr_b16 a[216:217], v237 offset:16384
  ds_read_b64_tr_b16 a[218:219], v237 offset:18432
  v_mfma_f32_16x16x32_bf16 v[0:3], a[224:227], a[48:51], v[0:3]
  ds_read_b64_tr_b16 a[220:221], v237 offset:20480
  ds_read_b64_tr_b16 a[222:223], v237 offset:22528
  s_waitcnt lgkmcnt(13)
  v_mfma_f32_16x16x32_bf16 v[0:3], a[228:231], a[56:59], v[0:3]
  buffer_load_dwordx4 a[116:119], v252, s[4:7], s40 offen offset:1024 sc1
  v_mfma_f32_16x16x32_bf16 v[16:19], a[224:227], a[52:55], v[16:19]
  ds_read_b64_tr_b16 a[224:225], v238 offset:16384
  ds_read_b64_tr_b16 a[226:227], v238 offset:18432
  v_mfma_f32_16x16x32_bf16 v[16:19], a[228:231], a[60:63], v[16:19]
  ds_read_b64_tr_b16 a[228:229], v238 offset:20480
  ds_read_b64_tr_b16 a[230:231], v238 offset:22528
  v_mfma_f32_16x16x32_bf16 v[4:7], a[232:235], a[48:51], v[4:7]
  s_mov_b32 s40, 6160384
  v_mfma_f32_16x16x32_bf16 v[4:7], a[236:239], a[56:59], v[4:7]
  buffer_load_dwordx4 a[120:123], v252, s[4:7], s40 offen offset:0 sc1
  v_mfma_f32_16x16x32_bf16 v[20:23], a[232:235], a[52:55], v[20:23]
  ds_read_b64_tr_b16 a[232:233], v239 offset:16384
  ds_read_b64_tr_b16 a[234:235], v239 offset:18432
  v_mfma_f32_16x16x32_bf16 v[20:23], a[236:239], a[60:63], v[20:23]
  ds_read_b64_tr_b16 a[236:237], v239 offset:20480
  ds_read_b64_tr_b16 a[238:239], v239 offset:22528
  v_mfma_f32_16x16x32_bf16 v[8:11], a[192:195], a[48:51], v[8:11]
  s_waitcnt lgkmcnt(13)
  v_mfma_f32_16x16x32_bf16 v[8:11], a[196:199], a[56:59], v[8:11]
  buffer_load_dwordx4 a[124:127], v252, s[4:7], s40 offen offset:1024 sc1
  v_mfma_f32_16x16x32_bf16 v[24:27], a[192:195], a[52:55], v[24:27]
  ds_read_b64_tr_b16 a[192:193], v236 offset:24576
  ds_read_b64_tr_b16 a[194:195], v236 offset:26624
  v_mfma_f32_16x16x32_bf16 v[24:27], a[196:199], a[60:63], v[24:27]
  ds_read_b64_tr_b16 a[196:197], v236 offset:28672
  ds_read_b64_tr_b16 a[198:199], v236 offset:30720
  v_mfma_f32_16x16x32_bf16 v[12:15], a[200:203], a[48:51], v[12:15]
  s_mov_b32 s41, 65536
  s_add_u32 m0, s42, 57344
  v_mfma_f32_16x16x32_bf16 v[12:15], a[204:207], a[56:59], v[12:15]
  buffer_load_dwordx4 v242, s[44:47], s41 offen lds
  v_mfma_f32_16x16x32_bf16 v[28:31], a[200:203], a[52:55], v[28:31]
  ds_read_b64_tr_b16 a[200:201], v237 offset:24576
  ds_read_b64_tr_b16 a[202:203], v237 offset:26624
  v_mfma_f32_16x16x32_bf16 v[28:31], a[204:207], a[60:63], v[28:31]
  ds_read_b64_tr_b16 a[204:205], v237 offset:28672
  ds_read_b64_tr_b16 a[206:207], v237 offset:30720
  s_waitcnt vmcnt(25)
  v_mfma_f32_16x16x32_bf16 v[32:35], a[208:211], a[64:67], v[32:35]
  s_mov_b32 s41, 327680
  s_add_u32 m0, s42, 61440
  s_waitcnt lgkmcnt(13)
  v_mfma_f32_16x16x32_bf16 v[32:35], a[212:215], a[72:75], v[32:35]
  s_waitcnt vmcnt(21)
  s_barrier
  v_mfma_f32_16x16x32_bf16 v[48:51], a[208:211], a[68:71], v[48:51]
  buffer_load_dwordx4 v242, s[44:47], s41 offen lds
  v_mfma_f32_16x16x32_bf16 v[48:51], a[212:215], a[76:79], v[48:51]
  ds_read_b64_tr_b16 a[208:209], v238 offset:24576
  ds_read_b64_tr_b16 a[210:211], v238 offset:26624
  v_mfma_f32_16x16x32_bf16 v[36:39], a[216:219], a[64:67], v[36:39]
  ds_read_b64_tr_b16 a[212:213], v238 offset:28672
  ds_read_b64_tr_b16 a[214:215], v238 offset:30720
  v_mfma_f32_16x16x32_bf16 v[36:39], a[220:223], a[72:75], v[36:39]
  s_mov_b32 s41, 65536
  s_add_u32 m0, s42, 65536
  v_mfma_f32_16x16x32_bf16 v[52:55], a[216:219], a[68:71], v[52:55]
  buffer_load_dwordx4 v253, s[44:47], s41 offen lds
  v_mfma_f32_16x16x32_bf16 v[52:55], a[220:223], a[76:79], v[52:55]
  ds_read_b64_tr_b16 a[216:217], v239 offset:24576
  ds_read_b64_tr_b16 a[218:219], v239 offset:26624
  v_mfma_f32_16x16x32_bf16 v[40:43], a[224:227], a[64:67], v[40:43]
  ds_read_b64_tr_b16 a[220:221], v239 offset:28672
  ds_read_b64_tr_b16 a[222:223], v239 offset:30720
  s_waitcnt lgkmcnt(13)
  v_mfma_f32_16x16x32_bf16 v[40:43], a[228:231], a[72:75], v[40:43]
  s_mov_b32 s41, 327680
  s_add_u32 m0, s42, 69632
  v_mfma_f32_16x16x32_bf16 v[56:59], a[224:227], a[68:71], v[56:59]
  buffer_load_dwordx4 v253, s[44:47], s41 offen lds
  v_mfma_f32_16x16x32_bf16 v[56:59], a[228:231], a[76:79], v[56:59]
  ds_read_b64_tr_b16 a[224:225], v228 offset:8192
  ds_read_b64_tr_b16 a[226:227], v228 offset:10240
  v_mfma_f32_16x16x32_bf16 v[44:47], a[232:235], a[64:67], v[44:47]
  ds_read_b64_tr_b16 a[228:229], v228 offset:12288
  ds_read_b64_tr_b16 a[230:231], v228 offset:14336
  v_mfma_f32_16x16x32_bf16 v[44:47], a[236:239], a[72:75], v[44:47]
  s_mov_b32 s41, 589824
  s_add_u32 m0, s42, 73728
  v_mfma_f32_16x16x32_bf16 v[60:63], a[232:235], a[68:71], v[60:63]
  buffer_load_dwordx4 v242, s[44:47], s41 offen lds
  v_mfma_f32_16x16x32_bf16 v[60:63], a[236:239], a[76:79], v[60:63]
  ds_read_b64_tr_b16 a[232:233], v229 offset:8192
  ds_read_b64_tr_b16 a[234:235], v229 offset:10240
  v_mfma_f32_16x16x32_bf16 v[0:3], a[192:195], a[64:67], v[0:3]
  ds_read_b64_tr_b16 a[236:237], v229 offset:12288
  ds_read_b64_tr_b16 a[238:239], v229 offset:14336
  s_waitcnt lgkmcnt(13)
  v_mfma_f32_16x16x32_bf16 v[0:3], a[196:199], a[72:75], v[0:3]
  s_mov_b32 s41, 851968
  s_add_u32 m0, s42, 77824
  v_mfma_f32_16x16x32_bf16 v[16:19], a[192:195], a[68:71], v[16:19]
  buffer_load_dwordx4 v242, s[44:47], s41 offen lds
  v_mfma_f32_16x16x32_bf16 v[16:19], a[196:199], a[76:79], v[16:19]
  ds_read_b64_tr_b16 a[192:193], v230 offset:8192
  ds_read_b64_tr_b16 a[194:195], v230 offset:10240
  v_mfma_f32_16x16x32_bf16 v[4:7], a[200:203], a[64:67], v[4:7]
  ds_read_b64_tr_b16 a[196:197], v230 offset:12288
  ds_read_b64_tr_b16 a[198:199], v230 offset:14336
  v_mfma_f32_16x16x32_bf16 v[4:7], a[204:207], a[72:75], v[4:7]
  s_mov_b32 s41, 589824
  s_add_u32 m0, s42, 81920
  v_mfma_f32_16x16x32_bf16 v[20:23], a[200:203], a[68:71], v[20:23]
  buffer_load_dwordx4 v253, s[44:47], s41 offen lds
  v_mfma_f32_16x16x32_bf16 v[20:23], a[204:207], a[76:79], v[20:23]
  ds_read_b64_tr_b16 a[200:201], v231 offset:8192
  ds_read_b64_tr_b16 a[202:203], v231 offset:10240
  buffer_load_dword v244, v243, s[4:7], s91 offen sc1
  v_mfma_f32_16x16x32_bf16 v[8:11], a[208:211], a[64:67], v[8:11]
  ds_read_b64_tr_b16 a[204:205], v231 offset:12288
  ds_read_b64_tr_b16 a[206:207], v231 offset:14336
  s_waitcnt lgkmcnt(13)
  v_mfma_f32_16x16x32_bf16 v[8:11], a[212:215], a[72:75], v[8:11]
  s_mov_b32 s41, 851968
  s_add_u32 m0, s42, 86016
  v_mfma_f32_16x16x32_bf16 v[24:27], a[208:211], a[68:71], v[24:27]
  buffer_load_dwordx4 v253, s[44:47], s41 offen lds
  v_mfma_f32_16x16x32_bf16 v[24:27], a[212:215], a[76:79], v[24:27]
  ds_read_b64_tr_b16 a[208:209], v228 offset:16384
  ds_read_b64_tr_b16 a[210:211], v228 offset:18432
  v_mfma_f32_16x16x32_bf16 v[12:15], a[216:219], a[64:67], v[12:15]
  ds_read_b64_tr_b16 a[212:213], v228 offset:20480
  ds_read_b64_tr_b16 a[214:215], v228 offset:22528
  v_mfma_f32_16x16x32_bf16 v[12:15], a[220:223], a[72:75], v[12:15]
  s_mov_b32 s41, 983040
  s_add_u32 m0, s42, 90112
  v_mfma_f32_16x16x32_bf16 v[28:31], a[216:219], a[68:71], v[28:31]
  buffer_load_dwordx4 v242, s[44:47], s41 offen lds
  v_mfma_f32_16x16x32_bf16 v[28:31], a[220:223], a[76:79], v[28:31]
  ds_read_b64_tr_b16 a[216:217], v229 offset:16384
  ds_read_b64_tr_b16 a[218:219], v229 offset:18432
  s_waitcnt vmcnt(26)
  v_mfma_f32_16x16x32_bf16 v[32:35], a[224:227], a[80:83], v[32:35]
  ds_read_b64_tr_b16 a[220:221], v229 offset:20480
  ds_read_b64_tr_b16 a[222:223], v229 offset:22528
  s_waitcnt lgkmcnt(13)
  v_mfma_f32_16x16x32_bf16 v[32:35], a[228:231], a[88:91], v[32:35]
  s_waitcnt vmcnt(22)
  s_barrier
  v_mfma_f32_16x16x32_bf16 v[48:51], a[224:227], a[84:87], v[48:51]
  ds_read_b64_tr_b16 a[224:225], v230 offset:16384
  ds_read_b64_tr_b16 a[226:227], v230 offset:18432
  v_mfma_f32_16x16x32_bf16 v[48:51], a[228:231], a[92:95], v[48:51]
  ds_read_b64_tr_b16 a[228:229], v230 offset:20480
  ds_read_b64_tr_b16 a[230:231], v230 offset:22528
  v_mfma_f32_16x16x32_bf16 v[36:39], a[232:235], a[80:83], v[36:39]
  s_mov_b32 s41, 1245184
  s_add_u32 m0, s42, 94208
  v_mfma_f32_16x16x32_bf16 v[36:39], a[236:239], a[88:91], v[36:39]
  buffer_load_dwordx4 v242, s[44:47], s41 offen lds
  v_mfma_f32_16x16x32_bf16 v[52:55], a[232:235], a[84:87], v[52:55]
  ds_read_b64_tr_b16 a[232:233], v231 offset:16384
  ds_read_b64_tr_b16 a[234:235], v231 offset:18432
  v_mfma_f32_16x16x32_bf16 v[52:55], a[236:239], a[92:95], v[52:55]
  ds_read_b64_tr_b16 a[236:237], v231 offset:20480
  ds_read_b64_tr_b16 a[238:239], v231 offset:22528
  v_mfma_f32_16x16x32_bf16 v[40:43], a[192:195], a[80:83], v[40:43]
  s_mov_b32 s41, 983040
  s_add_u32 m0, s42, 98304
  s_waitcnt lgkmcnt(13)
  v_mfma_f32_16x16x32_bf16 v[40:43], a[196:199], a[88:91], v[40:43]
  buffer_load_dwordx4 v253, s[44:47], s41 offen lds
  v_mfma_f32_16x16x32_bf16 v[56:59], a[192:195], a[84:87], v[56:59]
  ds_read_b64_tr_b16 a[192:193], v228 offset:24576
  ds_read_b64_tr_b16 a[194:195], v228 offset:26624
  v_mfma_f32_16x16x32_bf16 v[56:59], a[196:199], a[92:95], v[56:59]
  ds_read_b64_tr_b16 a[196:197], v228 offset:28672
  ds_read_b64_tr_b16 a[198:199], v228 offset:30720
  v_mfma_f32_16x16x32_bf16 v[44:47], a[200:203], a[80:83], v[44:47]
  s_mov_b32 s41, 1245184
  s_add_u32 m0, s42, 102400
  v_mfma_f32_16x16x32_bf16 v[44:47], a[204:207], a[88:91], v[44:47]
  buffer_load_dwordx4 v253, s[44:47], s41 offen lds
  v_mfma_f32_16x16x32_bf16 v[60:63], a[200:203], a[84:87], v[60:63]
  ds_read_b64_tr_b16 a[200:201], v229 offset:24576
  ds_read_b64_tr_b16 a[202:203], v229 offset:26624
  v_mfma_f32_16x16x32_bf16 v[60:63], a[204:207], a[92:95], v[60:63]
  ds_read_b64_tr_b16 a[204:205], v229 offset:28672
  ds_read_b64_tr_b16 a[206:207], v229 offset:30720
  v_mfma_f32_16x16x32_bf16 v[0:3], a[208:211], a[80:83], v[0:3]
  s_mov_b32 s41, 1507328
  s_add_u32 m0, s42, 106496
  s_waitcnt lgkmcnt(13)
  v_mfma_f32_16x16x32_bf16 v[0:3], a[212:215], a[88:91], v[0:3]
  buffer_load_dwordx4 v242, s[44:47], s41 offen lds
  v_mfma_f32_16x16x32_bf16 v[16:19], a[208:211], a[84:87], v[16:19]
  ds_read_b64_tr_b16 a[208:209], v230 offset:24576
  ds_read_b64_tr_b16 a[210:211], v230 offset:26624
  v_mfma_f32_16x16x32_bf16 v[16:19], a[212:215], a[92:95], v[16:19]
  ds_read_b64_tr_b16 a[212:213], v230 offset:28672
  ds_read_b64_tr_b16 a[214:215], v230 offset:30720
  v_mfma_f32_16x16x32_bf16 v[4:7], a[216:219], a[80:83], v[4:7]
  s_mov_b32 s41, 1769472
  s_add_u32 m0, s42, 110592
  v_mfma_f32_16x16x32_bf16 v[4:7], a[220:223], a[88:91], v[4:7]
  buffer_load_dwordx4 v242, s[44:47], s41 offen lds
  v_mfma_f32_16x16x32_bf16 v[20:23], a[216:219], a[84:87], v[20:23]
  ds_read_b64_tr_b16 a[216:217], v231 offset:24576
  ds_read_b64_tr_b16 a[218:219], v231 offset:26624
  v_mfma_f32_16x16x32_bf16 v[20:23], a[220:223], a[92:95], v[20:23]
  ds_read_b64_tr_b16 a[220:221], v231 offset:28672
  ds_read_b64_tr_b16 a[222:223], v231 offset:30720
  v_mfma_f32_16x16x32_bf16 v[8:11], a[224:227], a[80:83], v[8:11]
  s_mov_b32 s41, 1507328
  s_add_u32 m0, s42, 114688
  s_waitcnt lgkmcnt(13)
  v_mfma_f32_16x16x32_bf16 v[8:11], a[228:231], a[88:91], v[8:11]
  buffer_load_dwordx4 v253, s[44:47], s41 offen lds
  v_mfma_f32_16x16x32_bf16 v[24:27], a[224:227], a[84:87], v[24:27]
  ds_read_b64_tr_b16 a[224:225], v228 offset:32768
  ds_read_b64_tr_b16 a[226:227], v228 offset:34816
  v_mfma_f32_16x16x32_bf16 v[24:27], a[228:231], a[92:95], v[24:27]
  ds_read_b64_tr_b16 a[228:229], v228 offset:36864
  ds_read_b64_tr_b16 a[230:231], v228 offset:38912
  v_mfma_f32_16x16x32_bf16 v[12:15], a[232:235], a[80:83], v[12:15]
  s_mov_b32 s41, 1769472
  s_add_u32 m0, s42, 118784
  v_mfma_f32_16x16x32_bf16 v[12:15], a[236:239], a[88:91], v[12:15]
  buffer_load_dwordx4 v253, s[44:47], s41 offen lds
  v_mfma_f32_16x16x32_bf16 v[28:31], a[232:235], a[84:87], v[28:31]
  ds_read_b64_tr_b16 a[232:233], v229 offset:32768
  ds_read_b64_tr_b16 a[234:235], v229 offset:34816
  v_mfma_f32_16x16x32_bf16 v[28:31], a[236:239], a[92:95], v[28:31]
  ds_read_b64_tr_b16 a[236:237], v229 offset:36864
  ds_read_b64_tr_b16 a[238:239], v229 offset:38912
  s_waitcnt vmcnt(9)
  v_subrev_u32 v244, s100, v244
  v_mfma_f32_16x16x32_bf16 v[32:35], a[192:195], a[96:99], v[32:35]
  s_mov_b32 s41, 1900544
  s_add_u32 m0, s42, 122880
  v_cmp_lt_u32 s[68:69], 3, v244
  s_waitcnt lgkmcnt(13)
  v_mfma_f32_16x16x32_bf16 v[32:35], a[196:199], a[104:107], v[32:35]
  s_barrier
  s_cmp_lg_u64 s[68:69], 0
  s_cbranch_scc1 L_slow_43
L_back_44:
  v_mfma_f32_16x16x32_bf16 v[48:51], a[192:195], a[100:103], v[48:51]
  buffer_load_dwordx4 v242, s[44:47], s41 offen lds
  s_add_u32 s100, s100, 1
  v_mfma_f32_16x16x32_bf16 v[48:51], a[196:199], a[108:111], v[48:51]
  ds_read_b64_tr_b16 a[192:193], v230 offset:32768
  ds_read_b64_tr_b16 a[194:195], v230 offset:34816
  v_mfma_f32_16x16x32_bf16 v[36:39], a[200:203], a[96:99], v[36:39]
  ds_read_b64_tr_b16 a[196:197], v230 offset:36864
  ds_read_b64_tr_b16 a[198:199], v230 offset:38912
  v_mfma_f32_16x16x32_bf16 v[36:39], a[204:207], a[104:107], v[36:39]
  s_mov_b32 s40, 6291456
  v_mfma_f32_16x16x32_bf16 v[52:55], a[200:203], a[100:103], v[52:55]
  buffer_load_dwordx4 a[128:131], v252, s[4:7], s40 offen offset:0 sc1
  v_mfma_f32_16x16x32_bf16 v[52:55], a[204:207], a[108:111], v[52:55]
  ds_read_b64_tr_b16 a[200:201], v231 offset:32768
  ds_read_b64_tr_b16 a[202:203], v231 offset:34816
  v_mfma_f32_16x16x32_bf16 v[40:43], a[208:211], a[96:99], v[40:43]
  ds_read_b64_tr_b16 a[204:205], v231 offset:36864
  ds_read_b64_tr_b16 a[206:207], v231 offset:38912
  s_waitcnt lgkmcnt(13)
  v_mfma_f32_16x16x32_bf16 v[40:43], a[212:215], a[104:107], v[40:43]
  buffer_load_dwordx4 a[132:135], v252, s[4:7], s40 offen offset:1024 sc1
  v_mfma_f32_16x16x32_bf16 v[56:59], a[208:211], a[100:103], v[56:59]
  ds_read_b64_tr_b16 a[208:209], v228 offset:40960
  ds_read_b64_tr_b16 a[210:211], v228 offset:43008
  v_mfma_f32_16x16x32_bf16 v[56:59], a[212:215], a[108:111], v[56:59]
  ds_read_b64_tr_b16 a[212:213], v228 offset:45056
  ds_read_b64_tr_b16 a[214:215], v228 offset:47104
  v_mfma_f32_16x16x32_bf16 v[44:47], a[216:219], a[96:99], v[44:47]
  s_mov_b32 s40, 6422528
  v_mfma_f32_16x16x32_bf16 v[44:47], a[220:223], a[104:107], v[44:47]
  buffer_load_dwordx4 a[136:139], v252, s[4:7], s40 offen offset:0 sc1
  v_mfma_f32_16x16x32_bf16 v[60:63], a[216:219], a[100:103], v[60:63]
  ds_read_b64_tr_b16 a[216:217], v229 offset:40960
  ds_read_b64_tr_b16 a[218:219], v229 offset:43008
  v_mfma_f32_16x16x32_bf16 v[60:63], a[220:223], a[108:111], v[60:63]
  ds_read_b64_tr_b16 a[220:221], v229 offset:45056
  ds_read_b64_tr_b16 a[222:223], v229 offset:47104
  v_mfma_f32_16x16x32_bf16 v[0:3], a[224:227], a[96:99], v[0:3]
  s_waitcnt lgkmcnt(13)
  v_mfma_f32_16x16x32_bf16 v[0:3], a[228:231], a[104:107], v[0:3]
  buffer_load_dwordx4 a[140:143], v252, s[4:7], s40 offen offset:1024 sc1
  v_mfma_f32_16x16x32_bf16 v[16:19], a[224:227], a[100:103], v[16:19]
  ds_read_b64_tr_b16 a[224:225], v230 offset:40960
  ds_read_b64_tr_b16 a[226:227], v230 offset:43008
  v_mfma_f32_16x16x32_bf16 v[16:19], a[228:231], a[108:111], v[16:19]
  ds_read_b64_tr_b16 a[228:229], v230 offset:45056
  ds_read_b64_tr_b16 a[230:231], v230 offset:47104
  v_mfma_f32_16x16x32_bf16 v[4:7], a[232:235], a[96:99], v[4:7]
  s_mov_b32 s40, 6553600
  v_mfma_f32_16x16x32_bf16 v[4:7], a[236:239], a[104:107], v[4:7]
  buffer_load_dwordx4 a[144:147], v252, s[4:7], s40 offen offset:0 sc1
  v_mfma_f32_16x16x32_bf16 v[20:23], a[232:235], a[100:103], v[20:23]
  ds_read_b64_tr_b16 a[232:233], v231 offset:40960
  ds_read_b64_tr_b16 a[234:235], v231 offset:43008
  v_mfma_f32_16x16x32_bf16 v[20:23], a[236:239], a[108:111], v[20:23]
  ds_read_b64_tr_b16 a[236:237], v231 offset:45056
  ds_read_b64_tr_b16 a[238:239], v231 offset:47104
  v_mfma_f32_16x16x32_bf16 v[8:11], a[192:195], a[96:99], v[8:11]
  s_waitcnt lgkmcnt(13)
  v_mfma_f32_16x16x32_bf16 v[8:11], a[196:199], a[104:107], v[8:11]
  buffer_load_dwordx4 a[148:151], v252, s[4:7], s40 offen offset:1024 sc1
  v_mfma_f32_16x16x32_bf16 v[24:27], a[192:195], a[100:103], v[24:27]
  ds_read_b64_tr_b16 a[192:193], v228 offset:49152
  ds_read_b64_tr_b16 a[194:195], v228 offset:51200
  v_mfma_f32_16x16x32_bf16 v[24:27], a[196:199], a[108:111], v[24:27]
  ds_read_b64_tr_b16 a[196:197], v228 offset:53248
  ds_read_b64_tr_b16 a[198:199], v228 offset:55296
  v_mfma_f32_16x16x32_bf16 v[12:15], a[200:203], a[96:99], v[12:15]
  s_mov_b32 s40, 6684672
  v_mfma_f32_16x16x32_bf16 v[12:15], a[204:207], a[104:107], v[12:15]
  buffer_load_dwordx4 a[152:155], v252, s[4:7], s40 offen offset:0 sc1
  v_mfma_f32_16x16x32_bf16 v[28:31], a[200:203], a[100:103], v[28:31]
  ds_read_b64_tr_b16 a[200:201], v229 offset:49152
  ds_read_b64_tr_b16 a[202:203], v229 offset:51200
  v_mfma_f32_16x16x32_bf16 v[28:31], a[204:207], a[108:111], v[28:31]
  ds_read_b64_tr_b16 a[204:205], v229 offset:53248
  ds_read_b64_tr_b16 a[206:207], v229 offset:55296
  v_mfma_f32_16x16x32_bf16 v[32:35], a[208:211], a[112:115], v[32:35]
  s_waitcnt lgkmcnt(13)
  v_mfma_f32_16x16x32_bf16 v[32:35], a[212:215], a[120:123], v[32:35]
  s_barrier
  v_mfma_f32_16x16x32_bf16 v[48:51], a[208:211], a[116:119], v[48:51]
  buffer_load_dwordx4 a[156:159], v252, s[4:7], s40 offen offset:1024 sc1
  v_mfma_f32_16x16x32_bf16 v[48:51], a[212:215], a[124:127], v[48:51]
  ds_read_b64_tr_b16 a[208:209], v230 offset:49152
  ds_read_b64_tr_b16 a[210:211], v230 offset:51200
  v_mfma_f32_16x16x32_bf16 v[36:39], a[216:219], a[112:115], v[36:39]
  ds_read_b64_tr_b16 a[212:213], v230 offset:53248
  ds_read_b64_tr_b16 a[214:215], v230 offset:55296
  v_mfma_f32_16x16x32_bf16 v[36:39], a[220:223], a[120:123], v[36:39]
  s_mov_b32 s40, 6815744
  v_mfma_f32_16x16x32_bf16 v[52:55], a[216:219], a[116:119], v[52:55]
  buffer_load_dwordx4 a[160:163], v252, s[4:7], s40 offen offset:0 sc1
  v_mfma_f32_16x16x32_bf16 v[52:55], a[220:223], a[124:127], v[52:55]
  ds_read_b64_tr_b16 a[216:217], v231 offset:49152
  ds_read_b64_tr_b16 a[218:219], v231 offset:51200
  v_mfma_f32_16x16x32_bf16 v[40:43], a[224:227], a[112:115], v[40:43]
  ds_read_b64_tr_b16 a[220:221], v231 offset:53248
  ds_read_b64_tr_b16 a[222:223], v231 offset:55296
  s_waitcnt lgkmcnt(13)
  v_mfma_f32_16x16x32_bf16 v[40:43], a[228:231], a[120:123], v[40:43]
  buffer_load_dwordx4 a[164:167], v252, s[4:7], s40 offen offset:1024 sc1
  v_mfma_f32_16x16x32_bf16 v[56:59], a[224:227], a[116:119], v[56:59]
  ds_read_b64_tr_b16 a[224:225], v228 offset:57344
  ds_read_b64_tr_b16 a[226:227], v228 offset:59392
  v_mfma_f32_16x16x32_bf16 v[56:59], a[228:231], a[124:127], v[56:59]
  ds_read_b64_tr_b16 a[228:229], v228 offset:61440
  ds_read_b64_tr_b16 a[230:231], v228 offset:63488
  v_mfma_f32_16x16x32_bf16 v[44:47], a[232:235], a[112:115], v[44:47]
  s_mov_b32 s40, 6946816
  v_mfma_f32_16x16x32_bf16 v[44:47], a[236:239], a[120:123], v[44:47]
  buffer_load_dwordx4 a[168:171], v252, s[4:7], s40 offen offset:0 sc1
  v_mfma_f32_16x16x32_bf16 v[60:63], a[232:235], a[116:119], v[60:63]
  ds_read_b64_tr_b16 a[232:233], v229 offset:57344
  ds_read_b64_tr_b16 a[234:235], v229 offset:59392
  v_mfma_f32_16x16x32_bf16 v[60:63], a[236:239], a[124:127], v[60:63]
  ds_read_b64_tr_b16 a[236:237], v229 offset:61440
  ds_read_b64_tr_b16 a[238:239], v229 offset:63488
  v_mfma_f32_16x16x32_bf16 v[0:3], a[192:195], a[112:115], v[0:3]
  s_waitcnt lgkmcnt(13)
  v_mfma_f32_16x16x32_bf16 v[0:3], a[196:199], a[120:123], v[0:3]
  buffer_load_dwordx4 a[172:175], v252, s[4:7], s40 offen offset:1024 sc1
  v_mfma_f32_16x16x32_bf16 v[16:19], a[192:195], a[116:119], v[16:19]
  ds_read_b64_tr_b16 a[192:193], v230 offset:57344
  ds_read_b64_tr_b16 a[194:195], v230 offset:59392
  v_mfma_f32_16x16x32_bf16 v[16:19], a[196:199], a[124:127], v[16:19]
  ds_read_b64_tr_b16 a[196:197], v230 offset:61440
  ds_read_b64_tr_b16 a[198:199], v230 offset:63488
  v_mfma_f32_16x16x32_bf16 v[4:7], a[200:203], a[112:115], v[4:7]
  s_mov_b32 s40, 7077888
  v_mfma_f32_16x16x32_bf16 v[4:7], a[204:207], a[120:123], v[4:7]
  buffer_load_dwordx4 a[176:179], v252, s[4:7], s40 offen offset:0 sc1
  v_mfma_f32_16x16x32_bf16 v[20:23], a[200:203], a[116:119], v[20:23]
  ds_read_b64_tr_b16 a[200:201], v231 offset:57344
  ds_read_b64_tr_b16 a[202:203], v231 offset:59392
  v_mfma_f32_16x16x32_bf16 v[20:23], a[204:207], a[124:127], v[20:23]
  ds_read_b64_tr_b16 a[204:205], v231 offset:61440
  ds_read_b64_tr_b16 a[206:207], v231 offset:63488
  v_mfma_f32_16x16x32_bf16 v[8:11], a[208:211], a[112:115], v[8:11]
  s_waitcnt lgkmcnt(13)
  v_mfma_f32_16x16x32_bf16 v[8:11], a[212:215], a[120:123], v[8:11]
  buffer_load_dwordx4 a[180:183], v252, s[4:7], s40 offen offset:1024 sc1
  v_mfma_f32_16x16x32_bf16 v[24:27], a[208:211], a[116:119], v[24:27]
  ds_read_b64_tr_b16 a[208:209], v232 offset:0
  ds_read_b64_tr_b16 a[210:211], v232 offset:2048
  v_mfma_f32_16x16x32_bf16 v[24:27], a[212:215], a[124:127], v[24:27]
  ds_read_b64_tr_b16 a[212:213], v232 offset:4096
  ds_read_b64_tr_b16 a[214:215], v232 offset:6144
  v_mfma_f32_16x16x32_bf16 v[12:15], a[216:219], a[112:115], v[12:15]
  s_mov_b32 s40, 7208960
  v_mfma_f32_16x16x32_bf16 v[12:15], a[220:223], a[120:123], v[12:15]
  buffer_load_dwordx4 a[184:187], v252, s[4:7], s40 offen offset:0 sc1
  v_mfma_f32_16x16x32_bf16 v[28:31], a[216:219], a[116:119], v[28:31]
  ds_read_b64_tr_b16 a[216:217], v233 offset:0
  ds_read_b64_tr_b16 a[218:219], v233 offset:2048
  v_mfma_f32_16x16x32_bf16 v[28:31], a[220:223], a[124:127], v[28:31]
  ds_read_b64_tr_b16 a[220:221], v233 offset:4096
  ds_read_b64_tr_b16 a[222:223], v233 offset:6144
  s_waitcnt vmcnt(11)
  v_mfma_f32_16x16x32_bf16 v[32:35], a[224:227], a[128:131], v[32:35]
  s_waitcnt lgkmcnt(13)
  v_mfma_f32_16x16x32_bf16 v[32:35], a[228:231], a[136:139], v[32:35]
  s_barrier
  v_mfma_f32_16x16x32_bf16 v[48:51], a[224:227], a[132:135], v[48:51]
  buffer_load_dwordx4 a[188:191], v252, s[4:7], s40 offen offset:1024 sc1
  v_mfma_f32_16x16x32_bf16 v[48:51], a[228:231], a[140:143], v[48:51]
  ds_read_b64_tr_b16 a[224:225], v234 offset:0
  ds_read_b64_tr_b16 a[226:227], v234 offset:2048
  v_mfma_f32_16x16x32_bf16 v[36:39], a[232:235], a[128:131], v[36:39]
  ds_read_b64_tr_b16 a[228:229], v234 offset:4096
  ds_read_b64_tr_b16 a[230:231], v234 offset:6144
  v_mfma_f32_16x16x32_bf16 v[36:39], a[236:239], a[136:139], v[36:39]
  s_mov_b32 s41, 2162688
  s_add_u32 m0, s42, 126976
  v_mfma_f32_16x16x32_bf16 v[52:55], a[232:235], a[132:135], v[52:55]
  buffer_load_dwordx4 v242, s[44:47], s41 offen lds
  v_mfma_f32_16x16x32_bf16 v[52:55], a[236:239], a[140:143], v[52:55]
L_wk0_11:
  s_cbranch_vccnz L_wk0_end
  ds_read_b64_tr_b16 a[232:233], v235 offset:0
  ds_read_b64_tr_b16 a[234:235], v235 offset:2048
  v_mfma_f32_16x16x32_bf16 v[40:43], a[192:195], a[128:131], v[40:43]
  ds_read_b64_tr_b16 a[236:237], v235 offset:4096
  ds_read_b64_tr_b16 a[238:239], v235 offset:6144
  s_waitcnt lgkmcnt(13)
  v_mfma_f32_16x16x32_bf16 v[40:43], a[196:199], a[136:139], v[40:43]
  s_mov_b32 s41, 2424832
  s_add_u32 m0, s42, 131072
  v_mfma_f32_16x16x32_bf16 v[56:59], a[192:195], a[132:135], v[56:59]
  buffer_load_dwordx4 v242, s[44:47], s41 offen lds
  v_mfma_f32_16x16x32_bf16 v[56:59], a[196:199], a[140:143], v[56:59]
  ds_read_b64_tr_b16 a[192:193], v232 offset:8192
  ds_read_b64_tr_b16 a[194:195], v232 offset:10240
  v_mfma_f32_16x16x32_bf16 v[44:47], a[200:203], a[128:131], v[44:47]
  ds_read_b64_tr_b16 a[196:197], v232 offset:12288
  ds_read_b64_tr_b16 a[198:199], v232 offset:14336
  v_mfma_f32_16x16x32_bf16 v[44:47], a[204:207], a[136:139], v[44:47]
  s_mov_b32 s41, 2686976
  s_add_u32 m0, s42, 135168
  v_mfma_f32_16x16x32_bf16 v[60:63], a[200:203], a[132:135], v[60:63]
  buffer_load_dwordx4 v242, s[44:47], s41 offen lds
  v_mfma_f32_16x16x32_bf16 v[60:63], a[204:207], a[140:143], v[60:63]
  ds_read_b64_tr_b16 a[200:201], v233 offset:8192
  ds_read_b64_tr_b16 a[202:203], v233 offset:10240
  v_mfma_f32_16x16x32_bf16 v[0:3], a[208:211], a[128:131], v[0:3]
  ds_read_b64_tr_b16 a[204:205], v233 offset:12288
  ds_read_b64_tr_b16 a[206:207], v233 offset:14336
  s_waitcnt lgkmcnt(13)
  v_mfma_f32_16x16x32_bf16 v[0:3], a[212:215], a[136:139], v[0:3]
  s_mov_b32 s40, 7340032
  v_mfma_f32_16x16x32_bf16 v[16:19], a[208:211], a[132:135], v[16:19]
  buffer_load_dwordx4 a[0:3], v252, s[4:7], s40 offen offset:0 sc1
  v_mfma_f32_16x16x32_bf16 v[16:19], a[212:215], a[140:143], v[16:19]
  ds_read_b64_tr_b16 a[208:209], v234 offset:8192
  ds_read_b64_tr_b16 a[210:211], v234 offset:10240
  v_mfma_f32_16x16x32_bf16 v[4:7], a[216:219], a[128:131], v[4:7]
  ds_read_b64_tr_b16 a[212:213], v234 offset:12288
  ds_read_b64_tr_b16 a[214:215], v234 offset:14336
  v_mfma_f32_16x16x32_bf16 v[4:7], a[220:223], a[136:139], v[4:7]
  buffer_load_dwordx4 a[4:7], v252, s[4:7], s40 offen offset:1024 sc1
  v_mfma_f32_16x16x32_bf16 v[20:23], a[216:219], a[132:135], v[20:23]
  ds_read_b64_tr_b16 a[216:217], v235 offset:8192
  ds_read_b64_tr_b16 a[218:219], v235 offset:10240
  v_mfma_f32_16x16x32_bf16 v[20:23], a[220:223], a[140:143], v[20:23]
  ds_read_b64_tr_b16 a[220:221], v235 offset:12288
  ds_read_b64_tr_b16 a[222:223], v235 offset:14336
  v_mfma_f32_16x16x32_bf16 v[8:11], a[224:227], a[128:131], v[8:11]
  s_mov_b32 s40, 7471104
  s_waitcnt lgkmcnt(13)
  v_mfma_f32_16x16x32_bf16 v[8:11], a[228:231], a[136:139], v[8:11]
  buffer_load_dwordx4 a[8:11], v252, s[4:7], s40 offen offset:0 sc1
  v_mfma_f32_16x16x32_bf16 v[24:27], a[224:227], a[132:135], v[24:27]
  ds_read_b64_tr_b16 a[224:225], v232 offset:16384
  ds_read_b64_tr_b16 a[226:227], v232 offset:18432
  v_mfma_f32_16x16x32_bf16 v[24:27], a[228:231], a[140:143], v[24:27]
  ds_read_b64_tr_b16 a[228:229], v232 offset:20480
  ds_read_b64_tr_b16 a[230:231], v232 offset:22528
  v_mfma_f32_16x16x32_bf16 v[12:15], a[232:235], a[128:131], v[12:15]
  v_mfma_f32_16x16x32_bf16 v[12:15], a[236:239], a[136:139], v[12:15]
  buffer_load_dwordx4 a[12:15], v252, s[4:7], s40 offen offset:1024 sc1
  v_mfma_f32_16x16x32_bf16 v[28:31], a[232:235], a[132:135], v[28:31]
  ds_read_b64_tr_b16 a[232:233], v233 offset:16384
  ds_read_b64_tr_b16 a[234:235], v233 offset:18432
  v_mfma_f32_16x16x32_bf16 v[28:31], a[236:239], a[140:143], v[28:31]
  ds_read_b64_tr_b16 a[236:237], v233 offset:20480
  ds_read_b64_tr_b16 a[238:239], v233 offset:22528
  s_waitcnt vmcnt(15)
  v_mfma_f32_16x16x32_bf16 v[32:35], a[192:195], a[144:147], v[32:35]
  s_mov_b32 s41, 2818048
  s_add_u32 m0, s42, 139264
  s_waitcnt lgkmcnt(13)
  v_mfma_f32_16x16x32_bf16 v[32:35], a[196:199], a[152:155], v[32:35]
  s_barrier
  v_mfma_f32_16x16x32_bf16 v[48:51], a[192:195], a[148:151], v[48:51]
  buffer_load_dwordx4 v242, s[44:47], s41 offen lds
  v_mfma_f32_16x16x32_bf16 v[48:51], a[196:199], a[156:159], v[48:51]
  ds_read_b64_tr_b16 a[192:193], v234 offset:16384
  ds_read_b64_tr_b16 a[194:195], v234 offset:18432
  v_mfma_f32_16x16x32_bf16 v[36:39], a[200:203], a[144:147], v[36:39]
  ds_read_b64_tr_b16 a[196:197], v234 offset:20480
  ds_read_b64_tr_b16 a[198:199], v234 offset:22528
  v_mfma_f32_16x16x32_bf16 v[36:39], a[204:207], a[152:155], v[36:39]
  s_mov_b32 s41, 3080192
  s_add_u32 m0, s42, 143360
  v_mfma_f32_16x16x32_bf16 v[52:55], a[200:203], a[148:151], v[52:55]
  buffer_load_dwordx4 v242, s[44:47], s41 offen lds
  v_mfma_f32_16x16x32_bf16 v[52:55], a[204:207], a[156:159], v[52:55]
  ds_read_b64_tr_b16 a[200:201], v235 offset:16384
  ds_read_b64_tr_b16 a[202:203], v235 offset:18432
  v_mfma_f32_16x16x32_bf16 v[40:43], a[208:211], a[144:147], v[40:43]
  ds_read_b64_tr_b16 a[204:205], v235 offset:20480
  ds_read_b64_tr_b16 a[206:207], v235 offset:22528
  s_waitcnt lgkmcnt(13)
  v_mfma_f32_16x16x32_bf16 v[40:43], a[212:215], a[152:155], v[40:43]
  s_mov_b32 s41, 3342336
  s_add_u32 m0, s42, 147456
  v_mfma_f32_16x16x32_bf16 v[56:59], a[208:211], a[148:151], v[56:59]
  buffer_load_dwordx4 v242, s[44:47], s41 offen lds
  v_mfma_f32_16x16x32_bf16 v[56:59], a[212:215], a[156:159], v[56:59]
  ds_read_b64_tr_b16 a[208:209], v232 offset:24576
  ds_read_b64_tr_b16 a[210:211], v232 offset:26624
  v_mfma_f32_16x16x32_bf16 v[44:47], a[216:219], a[144:147], v[44:47]
  ds_read_b64_tr_b16 a[212:213], v232 offset:28672
  ds_read_b64_tr_b16 a[214:215], v232 offset:30720
  v_mfma_f32_16x16x32_bf16 v[44:47], a[220:223], a[152:155], v[44:47]
  s_mov_b32 s41, 3604480
  s_add_u32 m0, s42, 151552
  v_mfma_f32_16x16x32_bf16 v[60:63], a[216:219], a[148:151], v[60:63]
  buffer_load_dwordx4 v242, s[44:47], s41 offen lds
  v_mfma_f32_16x16x32_bf16 v[60:63], a[220:223], a[156:159], v[60:63]
  ds_read_b64_tr_b16 a[216:217], v233 offset:24576
  ds_read_b64_tr_b16 a[218:219], v233 offset:26624
  v_mfma_f32_16x16x32_bf16 v[0:3], a[224:227], a[144:147], v[0:3]
  ds_read_b64_tr_b16 a[220:221], v233 offset:28672
  ds_read_b64_tr_b16 a[222:223], v233 offset:30720
  s_waitcnt lgkmcnt(13)
  v_mfma_f32_16x16x32_bf16 v[0:3], a[228:231], a[152:155], v[0:3]
  s_mov_b32 s40, 7602176
  v_mfma_f32_16x16x32_bf16 v[16:19], a[224:227], a[148:151], v[16:19]
  buffer_load_dwordx4 a[16:19], v252, s[4:7], s40 offen offset:0 sc1
  v_mfma_f32_16x16x32_bf16 v[16:19], a[228:231], a[156:159], v[16:19]
  ds_read_b64_tr_b16 a[224:225], v234 offset:24576
  ds_read_b64_tr_b16 a[226:227], v234 offset:26624
  v_mfma_f32_16x16x32_bf16 v[4:7], a[232:235], a[144:147], v[4:7]
  ds_read_b64_tr_b16 a[228:229], v234 offset:28672
  ds_read_b64_tr_b16 a[230:231], v234 offset:30720
  v_mfma_f32_16x16x32_bf16 v[4:7], a[236:239], a[152:155], v[4:7]
  buffer_load_dwordx4 a[20:23], v252, s[4:7], s40 offen offset:1024 sc1
  v_mfma_f32_16x16x32_bf16 v[20:23], a[232:235], a[148:151], v[20:23]
  ds_read_b64_tr_b16 a[232:233], v235 offset:24576
  ds_read_b64_tr_b16 a[234:235], v235 offset:26624
  v_mfma_f32_16x16x32_bf16 v[20:23], a[236:239], a[156:159], v[20:23]
  ds_read_b64_tr_b16 a[236:237], v235 offset:28672
  ds_read_b64_tr_b16 a[238:239], v235 offset:30720
  v_mfma_f32_16x16x32_bf16 v[8:11], a[192:195], a[144:147], v[8:11]
  s_mov_b32 s40, 7733248
  s_waitcnt lgkmcnt(13)
  v_mfma_f32_16x16x32_bf16 v[8:11], a[196:199], a[152:155], v[8:11]
  buffer_load_dwordx4 a[24:27], v252, s[4:7], s40 offen offset:0 sc1
  v_mfma_f32_16x16x32_bf16 v[24:27], a[192:195], a[148:151], v[24:27]
  ds_read_b64_tr_b16 a[192:193], v232 offset:32768
  ds_read_b64_tr_b16 a[194:195], v232 offset:34816
  v_mfma_f32_16x16x32_bf16 v[24:27], a[196:199], a[156:159], v[24:27]
  ds_read_b64_tr_b16 a[196:197], v232 offset:36864
  ds_read_b64_tr_b16 a[198:199], v232 offset:38912
  v_mfma_f32_16x16x32_bf16 v[12:15], a[200:203], a[144:147], v[12:15]
  v_mfma_f32_16x16x32_bf16 v[12:15], a[204:207], a[152:155], v[12:15]
  buffer_load_dwordx4 a[28:31], v252, s[4:7], s40 offen offset:1024 sc1
  v_mfma_f32_16x16x32_bf16 v[28:31], a[200:203], a[148:151], v[28:31]
  ds_read_b64_tr_b16 a[200:201], v233 offset:32768
  ds_read_b64_tr_b16 a[202:203], v233 offset:34816
  v_mfma_f32_16x16x32_bf16 v[28:31], a[204:207], a[156:159], v[28:31]
  ds_read_b64_tr_b16 a[204:205], v233 offset:36864
  ds_read_b64_tr_b16 a[206:207], v233 offset:38912
  s_waitcnt vmcnt(19)
  v_mfma_f32_16x16x32_bf16 v[32:35], a[208:211], a[160:163], v[32:35]
  s_mov_b32 s40, 7864320
  s_waitcnt lgkmcnt(13)
  v_mfma_f32_16x16x32_bf16 v[32:35], a[212:215], a[168:171], v[32:35]
  s_barrier
  v_mfma_f32_16x16x32_bf16 v[48:51], a[208:211], a[164:167], v[48:51]
  buffer_load_dwordx4 a[32:35], v252, s[4:7], s40 offen offset:0 sc1
  v_mfma_f32_16x16x32_bf16 v[48:51], a[212:215], a[172:175], v[48:51]
  ds_read_b64_tr_b16 a[208:209], v234 offset:32768
  ds_read_b64_tr_b16 a[210:211], v234 offset:34816
  v_mfma_f32_16x16x32_bf16 v[36:39], a[216:219], a[160:163], v[36:39]
  ds_read_b64_tr_b16 a[212:213], v234 offset:36864
  ds_read_b64_tr_b16 a[214:215], v234 offset:38912
  v_mfma_f32_16x16x32_bf16 v[36:39], a[220:223], a[168:171], v[36:39]
  buffer_load_dwordx4 a[36:39], v252, s[4:7], s40 offen offset:1024 sc1
  v_mfma_f32_16x16x32_bf16 v[52:55], a[216:219], a[164:167], v[52:55]
  ds_read_b64_tr_b16 a[216:217], v235 offset:32768
  ds_read_b64_tr_b16 a[218:219], v235 offset:34816
  v_mfma_f32_16x16x32_bf16 v[52:55], a[220:223], a[172:175], v[52:55]
  ds_read_b64_tr_b16 a[220:221], v235 offset:36864
  ds_read_b64_tr_b16 a[222:223], v235 offset:38912
  v_mfma_f32_16x16x32_bf16 v[40:43], a[224:227], a[160:163], v[40:43]
  s_mov_b32 s40, 7995392
  s_waitcnt lgkmcnt(13)
  v_mfma_f32_16x16x32_bf16 v[40:43], a[228:231], a[168:171], v[40:43]
  buffer_load_dwordx4 a[40:43], v252, s[4:7], s40 offen offset:0 sc1
  v_mfma_f32_16x16x32_bf16 v[56:59], a[224:227], a[164:167], v[56:59]
  ds_read_b64_tr_b16 a[224:225], v232 offset:40960
  ds_read_b64_tr_b16 a[226:227], v232 offset:43008
  v_mfma_f32_16x16x32_bf16 v[56:59], a[228:231], a[172:175], v[56:59]
  ds_read_b64_tr_b16 a[228:229], v232 offset:45056
  ds_read_b64_tr_b16 a[230:231], v232 offset:47104
  v_mfma_f32_16x16x32_bf16 v[44:47], a[232:235], a[160:163], v[44:47]
  v_mfma_f32_16x16x32_bf16 v[44:47], a[236:239], a[168:171], v[44:47]
  buffer_load_dwordx4 a[44:47], v252, s[4:7], s40 offen offset:1024 sc1
  v_mfma_f32_16x16x32_bf16 v[60:63], a[232:235], a[164:167], v[60:63]
  ds_read_b64_tr_b16 a[232:233], v233 offset:40960
  ds_read_b64_tr_b16 a[234:235], v233 offset:43008
  v_mfma_f32_16x16x32_bf16 v[60:63], a[236:239], a[172:175], v[60:63]
  ds_read_b64_tr_b16 a[236:237], v233 offset:45056
  ds_read_b64_tr_b16 a[238:239], v233 offset:47104
  v_mfma_f32_16x16x32_bf16 v[0:3], a[192:195], a[160:163], v[0:3]
  s_mov_b32 s41, 1900544
  s_add_u32 m0, s42, 155648
  s_waitcnt lgkmcnt(13)
  v_mfma_f32_16x16x32_bf16 v[0:3], a[196:199], a[168:171], v[0:3]
  buffer_load_dwordx4 v253, s[44:47], s41 offen lds
  v_mfma_f32_16x16x32_bf16 v[16:19], a[192:195], a[164:167], v[16:19]
  ds_read_b64_tr_b16 a[192:193], v234 offset:40960
  ds_read_b64_tr_b16 a[194:195], v234 offset:43008
  v_mfma_f32_16x16x32_bf16 v[16:19], a[196:199], a[172:175], v[16:19]
  ds_read_b64_tr_b16 a[196:197], v234 offset:45056
  ds_read_b64_tr_b16 a[198:199], v234 offset:47104
  v_mfma_f32_16x16x32_bf16 v[4:7], a[200:203], a[160:163], v[4:7]
  s_mov_b32 s41, 2162688
  s_add_u32 m0, s42, 159744
  v_mfma_f32_16x16x32_bf16 v[4:7], a[204:207], a[168:171], v[4:7]
  buffer_load_dwordx4 v253, s[44:47], s41 offen lds
  v_mfma_f32_16x16x32_bf16 v[20:23], a[200:203], a[164:167], v[20:23]
  ds_read_b64_tr_b16 a[200:201], v235 offset:40960
  ds_read_b64_tr_b16 a[202:203], v235 offset:43008
  v_mfma_f32_16x16x32_bf16 v[20:23], a[204:207], a[172:175], v[20:23]
  ds_read_b64_tr_b16 a[204:205], v235 offset:45056
  ds_read_b64_tr_b16 a[206:207], v235 offset:47104
  v_mfma_f32_16x16x32_bf16 v[8:11], a[208:211], a[160:163], v[8:11]
  s_mov_b32 s41, 2424832
  s_add_u32 m0, s42, 8192
  s_waitcnt lgkmcnt(13)
  v_mfma_f32_16x16x32_bf16 v[8:11], a[212:215], a[168:171], v[8:11]
  buffer_load_dwordx4 v253, s[44:47], s41 offen lds
  v_mfma_f32_16x16x32_bf16 v[24:27], a[208:211], a[164:167], v[24:27]
  ds_read_b64_tr_b16 a[208:209], v232 offset:49152
  ds_read_b64_tr_b16 a[210:211], v232 offset:51200
  v_mfma_f32_16x16x32_bf16 v[24:27], a[212:215], a[172:175], v[24:27]
  ds_read_b64_tr_b16 a[212:213], v232 offset:53248
  ds_read_b64_tr_b16 a[214:215], v232 offset:55296
  v_mfma_f32_16x16x32_bf16 v[12:15], a[216:219], a[160:163], v[12:15]
  s_mov_b32 s41, 2686976
  s_add_u32 m0, s42, 12288
  v_mfma_f32_16x16x32_bf16 v[12:15], a[220:223], a[168:171], v[12:15]
  buffer_load_dwordx4 v253, s[44:47], s41 offen lds
  v_mfma_f32_16x16x32_bf16 v[28:31], a[216:219], a[164:167], v[28:31]
  ds_read_b64_tr_b16 a[216:217], v233 offset:49152
  ds_read_b64_tr_b16 a[218:219], v233 offset:51200
  v_mfma_f32_16x16x32_bf16 v[28:31], a[220:223], a[172:175], v[28:31]
  ds_read_b64_tr_b16 a[220:221], v233 offset:53248
  ds_read_b64_tr_b16 a[222:223], v233 offset:55296
  s_waitcnt vmcnt(23)
  v_mfma_f32_16x16x32_bf16 v[32:35], a[224:227], a[176:179], v[32:35]
  s_mov_b32 s40, 8126464
  s_waitcnt lgkmcnt(13)
  v_mfma_f32_16x16x32_bf16 v[32:35], a[228:231], a[184:187], v[32:35]
  s_waitcnt vmcnt(20)
  s_barrier
  v_mfma_f32_16x16x32_bf16 v[48:51], a[224:227], a[180:183], v[48:51]
  buffer_load_dwordx4 a[48:51], v252, s[4:7], s40 offen offset:0 sc1
  v_mfma_f32_16x16x32_bf16 v[48:51], a[228:231], a[188:191], v[48:51]
  ds_read_b64_tr_b16 a[224:225], v234 offset:49152
  ds_read_b64_tr_b16 a[226:227], v234 offset:51200
  v_mfma_f32_16x16x32_bf16 v[36:39], a[232:235], a[176:179], v[36:39]
  ds_read_b64_tr_b16 a[228:229], v234 offset:53248
  ds_read_b64_tr_b16 a[230:231], v234 offset:55296
  v_mfma_f32_16x16x32_bf16 v[36:39], a[236:239], a[184:187], v[36:39]
  buffer_load_dwordx4 a[52:55], v252, s[4:7], s40 offen offset:1024 sc1
  v_mfma_f32_16x16x32_bf16 v[52:55], a[232:235], a[180:183], v[52:55]
  ds_read_b64_tr_b16 a[232:233], v235 offset:49152
  ds_read_b64_tr_b16 a[234:235], v235 offset:51200
  v_mfma_f32_16x16x32_bf16 v[52:55], a[236:239], a[188:191], v[52:55]
  ds_read_b64_tr_b16 a[236:237], v235 offset:53248
  ds_read_b64_tr_b16 a[238:239], v235 offset:55296
  v_mfma_f32_16x16x32_bf16 v[40:43], a[192:195], a[176:179], v[40:43]
  s_mov_b32 s40, 8257536
  s_waitcnt lgkmcnt(13)
  v_mfma_f32_16x16x32_bf16 v[40:43], a[196:199], a[184:187], v[40:43]
  buffer_load_dwordx4 a[56:59], v252, s[4:7], s40 offen offset:0 sc1
  v_mfma_f32_16x16x32_bf16 v[56:59], a[192:195], a[180:183], v[56:59]
  ds_read_b64_tr_b16 a[192:193], v232 offset:57344
  ds_read_b64_tr_b16 a[194:195], v232 offset:59392
  v_mfma_f32_16x16x32_bf16 v[56:59], a[196:199], a[188:191], v[56:59]
  ds_read_b64_tr_b16 a[196:197], v232 offset:61440
  ds_read_b64_tr_b16 a[198:199], v232 offset:63488
  v_mfma_f32_16x16x32_bf16 v[44:47], a[200:203], a[176:179], v[44:47]
  v_mfma_f32_16x16x32_bf16 v[44:47], a[204:207], a[184:187], v[44:47]
  buffer_load_dwordx4 a[60:63], v252, s[4:7], s40 offen offset:1024 sc1
  v_mfma_f32_16x16x32_bf16 v[60:63], a[200:203], a[180:183], v[60:63]
  ds_read_b64_tr_b16 a[200:201], v233 offset:57344
  ds_read_b64_tr_b16 a[202:203], v233 offset:59392
  v_mfma_f32_16x16x32_bf16 v[60:63], a[204:207], a[188:191], v[60:63]
  ds_read_b64_tr_b16 a[204:205], v233 offset:61440
  ds_read_b64_tr_b16 a[206:207], v233 offset:63488
  v_mfma_f32_16x16x32_bf16 v[0:3], a[208:211], a[176:179], v[0:3]
  s_mov_b32 s41, 2818048
  s_add_u32 m0, s42, 16384
  s_waitcnt lgkmcnt(13)
  v_mfma_f32_16x16x32_bf16 v[0:3], a[212:215], a[184:187], v[0:3]
  buffer_load_dwordx4 v253, s[44:47], s41 offen lds
  v_mfma_f32_16x16x32_bf16 v[16:19], a[208:211], a[180:183], v[16:19]
  ds_read_b64_tr_b16 a[208:209], v234 offset:57344
  ds_read_b64_tr_b16 a[210:211], v234 offset:59392
  v_mfma_f32_16x16x32_bf16 v[16:19], a[212:215], a[188:191], v[16:19]
  ds_read_b64_tr_b16 a[212:213], v234 offset:61440
  ds_read_b64_tr_b16 a[214:215], v234 offset:63488
  v_mfma_f32_16x16x32_bf16 v[4:7], a[216:219], a[176:179], v[4:7]
  s_mov_b32 s41, 3080192
  s_add_u32 m0, s42, 20480
  v_mfma_f32_16x16x32_bf16 v[4:7], a[220:223], a[184:187], v[4:7]
  buffer_load_dwordx4 v253, s[44:47], s41 offen lds
  v_mfma_f32_16x16x32_bf16 v[20:23], a[216:219], a[180:183], v[20:23]
  ds_read_b64_tr_b16 a[216:217], v235 offset:57344
  ds_read_b64_tr_b16 a[218:219], v235 offset:59392
  v_mfma_f32_16x16x32_bf16 v[20:23], a[220:223], a[188:191], v[20:23]
  ds_read_b64_tr_b16 a[220:221], v235 offset:61440
  ds_read_b64_tr_b16 a[222:223], v235 offset:63488
  v_mfma_f32_16x16x32_bf16 v[8:11], a[224:227], a[176:179], v[8:11]
  s_mov_b32 s41, 3342336
  s_add_u32 m0, s42, 24576
  s_waitcnt lgkmcnt(13)
  v_mfma_f32_16x16x32_bf16 v[8:11], a[228:231], a[184:187], v[8:11]
  buffer_load_dwordx4 v253, s[44:47], s41 offen lds
  v_mfma_f32_16x16x32_bf16 v[24:27], a[224:227], a[180:183], v[24:27]
  ds_read_b64_tr_b16 a[224:225], v236 offset:0
  ds_read_b64_tr_b16 a[226:227], v236 offset:2048
  v_mfma_f32_16x16x32_bf16 v[24:27], a[228:231], a[188:191], v[24:27]
  ds_read_b64_tr_b16 a[228:229], v236 offset:4096
  ds_read_b64_tr_b16 a[230:231], v236 offset:6144
  v_mfma_f32_16x16x32_bf16 v[12:15], a[232:235], a[176:179], v[12:15]
  s_mov_b32 s41, 3604480
  s_add_u32 m0, s42, 28672
  v_mfma_f32_16x16x32_bf16 v[12:15], a[236:239], a[184:187], v[12:15]
  buffer_load_dwordx4 v253, s[44:47], s41 offen lds
  v_mfma_f32_16x16x32_bf16 v[28:31], a[232:235], a[180:183], v[28:31]
  ds_read_b64_tr_b16 a[232:233], v237 offset:0
  ds_read_b64_tr_b16 a[234:235], v237 offset:2048
  v_mfma_f32_16x16x32_bf16 v[28:31], a[236:239], a[188:191], v[28:31]
  ds_read_b64_tr_b16 a[236:237], v237 offset:4096
  ds_read_b64_tr_b16 a[238:239], v237 offset:6144
  s_waitcnt vmcnt(24)
  v_mfma_f32_16x16x32_bf16 v[32:35], a[192:195], a[0:3], v[32:35]
  s_waitcnt lgkmcnt(13)
  v_mfma_f32_16x16x32_bf16 v[32:35], a[196:199], a[8:11], v[32:35]
  s_waitcnt vmcnt(20)
  s_barrier
  v_mfma_f32_16x16x32_bf16 v[48:51], a[192:195], a[4:7], v[48:51]
  ds_read_b64_tr_b16 a[192:193], v238 offset:0
  ds_read_b64_tr_b16 a[194:195], v238 offset:2048
  v_mfma_f32_16x16x32_bf16 v[48:51], a[196:199], a[12:15], v[48:51]
  ds_read_b64_tr_b16 a[196:197], v238 offset:4096
  ds_read_b64_tr_b16 a[198:199], v238 offset:6144
  v_mfma_f32_16x16x32_bf16 v[36:39], a[200:203], a[0:3], v[36:39]
  v_mfma_f32_16x16x32_bf16 v[36:39], a[204:207], a[8:11], v[36:39]
  v_mfma_f32_16x16x32_bf16 v[52:55], a[200:203], a[4:7], v[52:55]
  ds_read_b64_tr_b16 a[200:201], v239 offset:0
  ds_read_b64_tr_b16 a[202:203], v239 offset:2048
  v_mfma_f32_16x16x32_bf16 v[52:55], a[204:207], a[12:15], v[52:55]
  ds_read_b64_tr_b16 a[204:205], v239 offset:4096
  ds_read_b64_tr_b16 a[206:207], v239 offset:6144
  v_mfma_f32_16x16x32_bf16 v[40:43], a[208:211], a[0:3], v[40:43]
  s_waitcnt lgkmcnt(13)
  v_mfma_f32_16x16x32_bf16 v[40:43], a[212:215], a[8:11], v[40:43]
  v_mfma_f32_16x16x32_bf16 v[56:59], a[208:211], a[4:7], v[56:59]
  ds_read_b64_tr_b16 a[208:209], v236 offset:8192
  ds_read_b64_tr_b16 a[210:211], v236 offset:10240
  v_mfma_f32_16x16x32_bf16 v[56:59], a[212:215], a[12:15], v[56:59]
  ds_read_b64_tr_b16 a[212:213], v236 offset:12288
  ds_read_b64_tr_b16 a[214:215], v236 offset:14336
  v_mfma_f32_16x16x32_bf16 v[44:47], a[216:219], a[0:3], v[44:47]
  v_mfma_f32_16x16x32_bf16 v[44:47], a[220:223], a[8:11], v[44:47]
  v_mfma_f32_16x16x32_bf16 v[60:63], a[216:219], a[4:7], v[60:63]
  ds_read_b64_tr_b16 a[216:217], v237 offset:8192
  ds_read_b64_tr_b16 a[218:219], v237 offset:10240
  v_mfma_f32_16x16x32_bf16 v[60:63], a[220:223], a[12:15], v[60:63]
  ds_read_b64_tr_b16 a[220:221], v237 offset:12288
  ds_read_b64_tr_b16 a[222:223], v237 offset:14336
  s_waitcnt vmcnt(16)
  v_mfma_f32_16x16x32_bf16 v[32:35], a[224:227], a[16:19], v[32:35]
  s_waitcnt lgkmcnt(13)
  v_mfma_f32_16x16x32_bf16 v[32:35], a[228:231], a[24:27], v[32:35]
  v_mfma_f32_16x16x32_bf16 v[48:51], a[224:227], a[20:23], v[48:51]
  ds_read_b64_tr_b16 a[224:225], v238 offset:8192
  ds_read_b64_tr_b16 a[226:227], v238 offset:10240
  v_mfma_f32_16x16x32_bf16 v[48:51], a[228:231], a[28:31], v[48:51]
  ds_read_b64_tr_b16 a[228:229], v238 offset:12288
  ds_read_b64_tr_b16 a[230:231], v238 offset:14336
  v_mfma_f32_16x16x32_bf16 v[36:39], a[232:235], a[16:19], v[36:39]
  v_mfma_f32_16x16x32_bf16 v[36:39], a[236:239], a[24:27], v[36:39]
  v_mfma_f32_16x16x32_bf16 v[52:55], a[232:235], a[20:23], v[52:55]
  ds_read_b64_tr_b16 a[232:233], v239 offset:8192
  ds_read_b64_tr_b16 a[234:235], v239 offset:10240
  v_mfma_f32_16x16x32_bf16 v[52:55], a[236:239], a[28:31], v[52:55]
  ds_read_b64_tr_b16 a[236:237], v239 offset:12288
  ds_read_b64_tr_b16 a[238:239], v239 offset:14336
  v_mfma_f32_16x16x32_bf16 v[40:43], a[192:195], a[16:19], v[40:43]
  s_waitcnt lgkmcnt(13)
  v_mfma_f32_16x16x32_bf16 v[40:43], a[196:199], a[24:27], v[40:43]
  v_mfma_f32_16x16x32_bf16 v[56:59], a[192:195], a[20:23], v[56:59]
  ds_read_b64_tr_b16 a[192:193], v236 offset:16384
  ds_read_b64_tr_b16 a[194:195], v236 offset:18432
  v_mfma_f32_16x16x32_bf16 v[56:59], a[196:199], a[28:31], v[56:59]
  ds_read_b64_tr_b16 a[196:197], v236 offset:20480
  ds_read_b64_tr_b16 a[198:199], v236 offset:22528
  v_mfma_f32_16x16x32_bf16 v[44:47], a[200:203], a[16:19], v[44:47]
  v_mfma_f32_16x16x32_bf16 v[44:47], a[204:207], a[24:27], v[44:47]
  v_mfma_f32_16x16x32_bf16 v[60:63], a[200:203], a[20:23], v[60:63]
  ds_read_b64_tr_b16 a[200:201], v237 offset:16384
  ds_read_b64_tr_b16 a[202:203], v237 offset:18432
  v_mfma_f32_16x16x32_bf16 v[60:63], a[204:207], a[28:31], v[60:63]
  ds_read_b64_tr_b16 a[204:205], v237 offset:20480
  ds_read_b64_tr_b16 a[206:207], v237 offset:22528
  s_waitcnt vmcnt(12)
  v_mfma_f32_16x16x32_bf16 v[32:35], a[208:211], a[32:35], v[32:35]
  s_waitcnt lgkmcnt(13)
  v_mfma_f32_16x16x32_bf16 v[32:35], a[212:215], a[40:43], v[32:35]
  s_waitcnt vmcnt(8)
  s_barrier
  v_mfma_f32_16x16x32_bf16 v[48:51], a[208:211], a[36:39], v[48:51]
  ds_read_b64_tr_b16 a[208:209], v238 offset:16384
  ds_read_b64_tr_b16 a[210:211], v238 offset:18432
  v_mfma_f32_16x16x32_bf16 v[48:51], a[212:215], a[44:47], v[48:51]
  ds_read_b64_tr_b16 a[212:213], v238 offset:20480
  ds_read_b64_tr_b16 a[214:215], v238 offset:22528
  v_mfma_f32_16x16x32_bf16 v[36:39], a[216:219], a[32:35], v[36:39]
  v_mfma_f32_16x16x32_bf16 v[36:39], a[220:223], a[40:43], v[36:39]
  v_mfma_f32_16x16x32_bf16 v[52:55], a[216:219], a[36:39], v[52:55]
  ds_read_b64_tr_b16 a[216:217], v239 offset:16384
  ds_read_b64_tr_b16 a[218:219], v239 offset:18432
  v_mfma_f32_16x16x32_bf16 v[52:55], a[220:223], a[44:47], v[52:55]
  ds_read_b64_tr_b16 a[220:221], v239 offset:20480
  ds_read_b64_tr_b16 a[222:223], v239 offset:22528
  v_mfma_f32_16x16x32_bf16 v[40:43], a[224:227], a[32:35], v[40:43]
  s_waitcnt lgkmcnt(13)
  v_mfma_f32_16x16x32_bf16 v[40:43], a[228:231], a[40:43], v[40:43]
  v_mfma_f32_16x16x32_bf16 v[56:59], a[224:227], a[36:39], v[56:59]
  ds_read_b64_tr_b16 a[224:225], v236 offset:24576
  ds_read_b64_tr_b16 a[226:227], v236 offset:26624
  v_mfma_f32_16x16x32_bf16 v[56:59], a[228:231], a[44:47], v[56:59]
  ds_read_b64_tr_b16 a[228:229], v236 offset:28672
  ds_read_b64_tr_b16 a[230:231], v236 offset:30720
  v_mfma_f32_16x16x32_bf16 v[44:47], a[232:235], a[32:35], v[44:47]
  v_mfma_f32_16x16x32_bf16 v[44:47], a[236:239], a[40:43], v[44:47]
  v_mfma_f32_16x16x32_bf16 v[60:63], a[232:235], a[36:39], v[60:63]
  ds_read_b64_tr_b16 a[232:233], v237 offset:24576
  ds_read_b64_tr_b16 a[234:235], v237 offset:26624
  v_mfma_f32_16x16x32_bf16 v[60:63], a[236:239], a[44:47], v[60:63]
  ds_read_b64_tr_b16 a[236:237], v237 offset:28672
  ds_read_b64_tr_b16 a[238:239], v237 offset:30720
  s_waitcnt vmcnt(4)
  v_mfma_f32_16x16x32_bf16 v[32:35], a[192:195], a[48:51], v[32:35]
  s_waitcnt lgkmcnt(13)
  v_mfma_f32_16x16x32_bf16 v[32:35], a[196:199], a[56:59], v[32:35]
  v_mfma_f32_16x16x32_bf16 v[48:51], a[192:195], a[52:55], v[48:51]
  ds_read_b64_tr_b16 a[192:193], v238 offset:24576
  ds_read_b64_tr_b16 a[194:195], v238 offset:26624
  v_mfma_f32_16x16x32_bf16 v[48:51], a[196:199], a[60:63], v[48:51]
  ds_read_b64_tr_b16 a[196:197], v238 offset:28672
  ds_read_b64_tr_b16 a[198:199], v238 offset:30720
  v_mfma_f32_16x16x32_bf16 v[36:39], a[200:203], a[48:51], v[36:39]
  v_mfma_f32_16x16x32_bf16 v[36:39], a[204:207], a[56:59], v[36:39]
  v_mfma_f32_16x16x32_bf16 v[52:55], a[200:203], a[52:55], v[52:55]
  ds_read_b64_tr_b16 a[200:201], v239 offset:24576
  ds_read_b64_tr_b16 a[202:203], v239 offset:26624
  v_mfma_f32_16x16x32_bf16 v[52:55], a[204:207], a[60:63], v[52:55]
  ds_read_b64_tr_b16 a[204:205], v239 offset:28672
  ds_read_b64_tr_b16 a[206:207], v239 offset:30720
  v_cvt_pk_bf16_f32 v64, v32, v33
  v_cvt_pk_bf16_f32 v65, v34, v35
  v_mfma_f32_16x16x32_bf16 v[40:43], a[208:211], a[48:51], v[40:43]
  v_cvt_pk_bf16_f32 v66, v36, v37
  v_cvt_pk_bf16_f32 v67, v38, v39
  buffer_store_dwordx4 v[64:67], v251, s[4:7], s97 offen offset:0 sc1
  s_waitcnt lgkmcnt(13)
  v_mfma_f32_16x16x32_bf16 v[40:43], a[212:215], a[56:59], v[40:43]
  v_cvt_pk_bf16_f32 v72, v48, v49
  v_cvt_pk_bf16_f32 v73, v50, v51
  v_cvt_pk_bf16_f32 v74, v52, v53
  v_cvt_pk_bf16_f32 v75, v54, v55
  v_mfma_f32_16x16x32_bf16 v[56:59], a[208:211], a[52:55], v[56:59]
  ds_read_b64_tr_b16 a[208:209], v228 offset:8192
  ds_read_b64_tr_b16 a[210:211], v228 offset:10240
  buffer_store_dwordx4 v[72:75], v251, s[4:7], s97 offen offset:2048 sc1
  v_mfma_f32_16x16x32_bf16 v[56:59], a[212:215], a[60:63], v[56:59]
  ds_read_b64_tr_b16 a[212:213], v228 offset:12288
  ds_read_b64_tr_b16 a[214:215], v228 offset:14336
  v_mfma_f32_16x16x32_bf16 v[44:47], a[216:219], a[48:51], v[44:47]
  v_mfma_f32_16x16x32_bf16 v[44:47], a[220:223], a[56:59], v[44:47]
  v_mfma_f32_16x16x32_bf16 v[60:63], a[216:219], a[52:55], v[60:63]
  ds_read_b64_tr_b16 a[216:217], v229 offset:8192
  ds_read_b64_tr_b16 a[218:219], v229 offset:10240
  v_mfma_f32_16x16x32_bf16 v[60:63], a[220:223], a[60:63], v[60:63]
  ds_read_b64_tr_b16 a[220:221], v229 offset:12288
  ds_read_b64_tr_b16 a[222:223], v229 offset:14336
  v_cvt_pk_bf16_f32 v68, v40, v41
  v_cvt_pk_bf16_f32 v69, v42, v43
  v_mfma_f32_16x16x32_bf16 v[0:3], a[224:227], a[0:3], v[0:3]
  v_cvt_pk_bf16_f32 v70, v44, v45
  v_cvt_pk_bf16_f32 v71, v46, v47
  buffer_store_dwordx4 v[68:71], v251, s[4:7], s97 offen offset:1024 sc1
  s_waitcnt lgkmcnt(13)
  v_mfma_f32_16x16x32_bf16 v[0:3], a[228:231], a[8:11], v[0:3]
  s_waitcnt vmcnt(3)
  s_barrier
  v_cvt_pk_bf16_f32 v76, v56, v57
  v_cvt_pk_bf16_f32 v77, v58, v59
  v_mfma_f32_16x16x32_bf16 v[16:19], a[224:227], a[4:7], v[16:19]
  ds_read_b64_tr_b16 a[224:225], v230 offset:8192
  ds_read_b64_tr_b16 a[226:227], v230 offset:10240
  v_cvt_pk_bf16_f32 v78, v60, v61
  v_cvt_pk_bf16_f32 v79, v62, v63
  v_mfma_f32_16x16x32_bf16 v[16:19], a[228:231], a[12:15], v[16:19]
  ds_read_b64_tr_b16 a[228:229], v230 offset:12288
  ds_read_b64_tr_b16 a[230:231], v230 offset:14336
  buffer_store_dwordx4 v[76:79], v251, s[4:7], s97 offen offset:3072 sc1
  v_mfma_f32_16x16x32_bf16 v[4:7], a[232:235], a[0:3], v[4:7]
  v_accvgpr_read_b32 v80, a240
  v_accvgpr_read_b32 v81, a241
  v_accvgpr_read_b32 v82, a242
  v_accvgpr_read_b32 v83, a243
  v_mfma_f32_16x16x32_bf16 v[4:7], a[236:239], a[8:11], v[4:7]
  v_accvgpr_read_b32 v84, a244
  v_accvgpr_read_b32 v85, a245
  v_accvgpr_read_b32 v86, a246
  v_accvgpr_read_b32 v87, a247
  v_mfma_f32_16x16x32_bf16 v[20:23], a[232:235], a[4:7], v[20:23]
  ds_read_b64_tr_b16 a[232:233], v231 offset:8192
  ds_read_b64_tr_b16 a[234:235], v231 offset:10240
  v_accvgpr_read_b32 v88, a248
  v_accvgpr_read_b32 v89, a249
  v_mfma_f32_16x16x32_bf16 v[20:23], a[236:239], a[12:15], v[20:23]
  ds_read_b64_tr_b16 a[236:237], v231 offset:12288
  ds_read_b64_tr_b16 a[238:239], v231 offset:14336
  v_accvgpr_read_b32 v90, a250
  v_accvgpr_read_b32 v91, a251
  v_mfma_f32_16x16x32_bf16 v[8:11], a[192:195], a[0:3], v[8:11]
  v_accvgpr_read_b32 v92, a252
  v_accvgpr_read_b32 v93, a253
  v_accvgpr_read_b32 v94, a254
  v_accvgpr_read_b32 v95, a255
L_wk0_12:
  s_cbranch_vccnz L_wk0_end
  s_waitcnt lgkmcnt(13)
  v_mfma_f32_16x16x32_bf16 v[8:11], a[196:199], a[8:11], v[8:11]
  v_lshlrev_b32 v96, 16, v80
  v_and_b32 v97, 0xffff0000, v80
  v_lshlrev_b32 v98, 16, v81
  v_and_b32 v99, 0xffff0000, v81
  v_mfma_f32_16x16x32_bf16 v[24:27], a[192:195], a[4:7], v[24:27]
  ds_read_b64_tr_b16 a[192:193], v228 offset:16384
  ds_read_b64_tr_b16 a[194:195], v228 offset:18432
  v_lshlrev_b32 v100, 16, v82
  v_and_b32 v101, 0xffff0000, v82
  v_mfma_f32_16x16x32_bf16 v[24:27], a[196:199], a[12:15], v[24:27]
  ds_read_b64_tr_b16 a[196:197], v228 offset:20480
  ds_read_b64_tr_b16 a[198:199], v228 offset:22528
  v_lshlrev_b32 v102, 16, v83
  v_and_b32 v103, 0xffff0000, v83
  v_mfma_f32_16x16x32_bf16 v[12:15], a[200:203], a[0:3], v[12:15]
  v_lshlrev_b32 v104, 16, v84
  v_and_b32 v105, 0xffff0000, v84
  v_lshlrev_b32 v106, 16, v85
  v_and_b32 v107, 0xffff0000, v85
  v_mfma_f32_16x16x32_bf16 v[12:15], a[204:207], a[8:11], v[12:15]
  v_lshlrev_b32 v108, 16, v86
  v_and_b32 v109, 0xffff0000, v86
  v_lshlrev_b32 v110, 16, v87
  v_and_b32 v111, 0xffff0000, v87
  v_mfma_f32_16x16x32_bf16 v[28:31], a[200:203], a[4:7], v[28:31]
  ds_read_b64_tr_b16 a[200:201], v229 offset:16384
  ds_read_b64_tr_b16 a[202:203], v229 offset:18432
  v_lshlrev_b32 v112, 16, v88
  v_and_b32 v113, 0xffff0000, v88
  v_mfma_f32_16x16x32_bf16 v[28:31], a[204:207], a[12:15], v[28:31]
  ds_read_b64_tr_b16 a[204:205], v229 offset:20480
  ds_read_b64_tr_b16 a[206:207], v229 offset:22528
  v_lshlrev_b32 v114, 16, v89
  v_and_b32 v115, 0xffff0000, v89
  v_mfma_f32_16x16x32_bf16 v[0:3], a[208:211], a[16:19], v[0:3]
  v_lshlrev_b32 v116, 16, v90
  v_and_b32 v117, 0xffff0000, v90
  v_lshlrev_b32 v118, 16, v91
  v_and_b32 v119, 0xffff0000, v91
  s_waitcnt lgkmcnt(13)
  v_mfma_f32_16x16x32_bf16 v[0:3], a[212:215], a[24:27], v[0:3]
  v_lshlrev_b32 v120, 16, v92
  v_and_b32 v121, 0xffff0000, v92
  v_lshlrev_b32 v122, 16, v93
  v_and_b32 v123, 0xffff0000, v93
  v_mfma_f32_16x16x32_bf16 v[16:19], a[208:211], a[20:23], v[16:19]
  ds_read_b64_tr_b16 a[208:209], v230 offset:16384
  ds_read_b64_tr_b16 a[210:211], v230 offset:18432
  v_lshlrev_b32 v124, 16, v94
  v_and_b32 v125, 0xffff0000, v94
  v_mfma_f32_16x16x32_bf16 v[16:19], a[212:215], a[28:31], v[16:19]
  ds_read_b64_tr_b16 a[212:213], v230 offset:20480
  ds_read_b64_tr_b16 a[214:215], v230 offset:22528
  v_lshlrev_b32 v126, 16, v95
  v_and_b32 v127, 0xffff0000, v95
  v_mfma_f32_16x16x32_bf16 v[4:7], a[216:219], a[16:19], v[4:7]
  ds_read_b128 v[128:131], v250 offset:768
  ds_read_b128 v[132:135], v250 offset:832
  ds_read_b128 v[136:139], v250 offset:896
  ds_read_b128 v[140:143], v250 offset:960
  v_mfma_f32_16x16x32_bf16 v[4:7], a[220:223], a[24:27], v[4:7]
  v_mfma_f32_16x16x32_bf16 v[20:23], a[216:219], a[20:23], v[20:23]
  ds_read_b64_tr_b16 a[216:217], v231 offset:16384
  ds_read_b64_tr_b16 a[218:219], v231 offset:18432
  v_mfma_f32_16x16x32_bf16 v[20:23], a[220:223], a[28:31], v[20:23]
  ds_read_b64_tr_b16 a[220:221], v231 offset:20480
  ds_read_b64_tr_b16 a[222:223], v231 offset:22528
  v_mfma_f32_16x16x32_bf16 v[8:11], a[224:227], a[16:19], v[8:11]
  s_waitcnt lgkmcnt(13)
  v_mfma_f32_16x16x32_bf16 v[8:11], a[228:231], a[24:27], v[8:11]
  v_mfma_f32_16x16x32_bf16 v[24:27], a[224:227], a[20:23], v[24:27]
  ds_read_b64_tr_b16 a[224:225], v228 offset:24576
  ds_read_b64_tr_b16 a[226:227], v228 offset:26624
  v_mfma_f32_16x16x32_bf16 v[24:27], a[228:231], a[28:31], v[24:27]
  ds_read_b64_tr_b16 a[228:229], v228 offset:28672
  ds_read_b64_tr_b16 a[230:231], v228 offset:30720
  v_mfma_f32_16x16x32_bf16 v[12:15], a[232:235], a[16:19], v[12:15]
  v_mfma_f32_16x16x32_bf16 v[12:15], a[236:239], a[24:27], v[12:15]
  v_mfma_f32_16x16x32_bf16 v[28:31], a[232:235], a[20:23], v[28:31]
  ds_read_b64_tr_b16 a[232:233], v229 offset:24576
  ds_read_b64_tr_b16 a[234:235], v229 offset:26624
  v_mfma_f32_16x16x32_bf16 v[28:31], a[236:239], a[28:31], v[28:31]
  ds_read_b64_tr_b16 a[236:237], v229 offset:28672
  ds_read_b64_tr_b16 a[238:239], v229 offset:30720
  v_mfma_f32_16x16x32_bf16 v[0:3], a[192:195], a[32:35], v[0:3]
  v_mfma_f32_16x16x32_bf16 v[0:3], a[196:199], a[40:43], v[0:3]
  s_barrier
  v_mfma_f32_16x16x32_bf16 v[16:19], a[192:195], a[36:39], v[16:19]
  ds_read_b64_tr_b16 a[192:193], v230 offset:24576
  ds_read_b64_tr_b16 a[194:195], v230 offset:26624
  v_mfma_f32_16x16x32_bf16 v[16:19], a[196:199], a[44:47], v[16:19]
  ds_read_b64_tr_b16 a[196:197], v230 offset:28672
  ds_read_b64_tr_b16 a[198:199], v230 offset:30720
  v_mfma_f32_16x16x32_bf16 v[4:7], a[200:203], a[32:35], v[4:7]
  s_waitcnt lgkmcnt(13)
  v_mfma_f32_16x16x32_bf16 v[4:7], a[204:207], a[40:43], v[4:7]
  v_mfma_f32_16x16x32_bf16 v[20:23], a[200:203], a[36:39], v[20:23]
  ds_read_b64_tr_b16 a[200:201], v231 offset:24576
  ds_read_b64_tr_b16 a[202:203], v231 offset:26624
  v_mfma_f32_16x16x32_bf16 v[20:23], a[204:207], a[44:47], v[20:23]
  ds_read_b64_tr_b16 a[204:205], v231 offset:28672
  ds_read_b64_tr_b16 a[206:207], v231 offset:30720
  v_mfma_f32_16x16x32_bf16 v[8:11], a[208:211], a[32:35], v[8:11]
  v_mfma_f32_16x16x32_bf16 v[8:11], a[212:215], a[40:43], v[8:11]
  v_mfma_f32_16x16x32_bf16 v[24:27], a[208:211], a[36:39], v[24:27]
  v_mfma_f32_16x16x32_bf16 v[24:27], a[212:215], a[44:47], v[24:27]
  v_mfma_f32_16x16x32_bf16 v[12:15], a[216:219], a[32:35], v[12:15]
  s_waitcnt lgkmcnt(13)
  v_mfma_f32_16x16x32_bf16 v[12:15], a[220:223], a[40:43], v[12:15]
  v_mfma_f32_16x16x32_bf16 v[28:31], a[216:219], a[36:39], v[28:31]
  v_mfma_f32_16x16x32_bf16 v[28:31], a[220:223], a[44:47], v[28:31]
  v_mfma_f32_16x16x32_bf16 v[0:3], a[224:227], a[48:51], v[0:3]
  s_waitcnt lgkmcnt(12)
  v_mfma_f32_16x16x32_bf16 v[0:3], a[228:231], a[56:59], v[0:3]
  v_mfma_f32_16x16x32_bf16 v[16:19], a[224:227], a[52:55], v[16:19]
  v_mfma_f32_16x16x32_bf16 v[16:19], a[228:231], a[60:63], v[16:19]
  buffer_load_dwordx4 v[64:67], v251, s[4:7], s96 offen offset:0 sc1
  s_waitcnt lgkmcnt(10)
  v_mfma_f32_16x16x32_bf16 v[4:7], a[232:235], a[48:51], v[4:7]
  s_waitcnt lgkmcnt(8)
  v_mfma_f32_16x16x32_bf16 v[4:7], a[236:239], a[56:59], v[4:7]
  buffer_load_dwordx4 v[68:71], v251, s[4:7], s96 offen offset:1024 sc1
  v_mfma_f32_16x16x32_bf16 v[20:23], a[232:235], a[52:55], v[20:23]
  v_mfma_f32_16x16x32_bf16 v[20:23], a[236:239], a[60:63], v[20:23]
  buffer_load_dwordx4 v[72:75], v251, s[4:7], s96 offen offset:2048 sc1
  s_waitcnt lgkmcnt(6)
  v_mfma_f32_16x16x32_bf16 v[8:11], a[192:195], a[48:51], v[8:11]
  s_waitcnt lgkmcnt(4)
  v_mfma_f32_16x16x32_bf16 v[8:11], a[196:199], a[56:59], v[8:11]
  buffer_load_dwordx4 v[76:79], v251, s[4:7], s96 offen offset:3072 sc1
  v_mfma_f32_16x16x32_bf16 v[24:27], a[192:195], a[52:55], v[24:27]
  v_mfma_f32_16x16x32_bf16 v[24:27], a[196:199], a[60:63], v[24:27]
  s_waitcnt lgkmcnt(2)
  v_mfma_f32_16x16x32_bf16 v[12:15], a[200:203], a[48:51], v[12:15]
  s_waitcnt lgkmcnt(0)
  v_mfma_f32_16x16x32_bf16 v[12:15], a[204:207], a[56:59], v[12:15]
  v_mfma_f32_16x16x32_bf16 v[28:31], a[200:203], a[52:55], v[28:31]
  v_mfma_f32_16x16x32_bf16 v[28:31], a[204:207], a[60:63], v[28:31]
  v_pk_fma_f32 v[96:97], v[0:1], v[128:129], v[96:97]
  v_pk_fma_f32 v[98:99], v[2:3], v[130:131], v[98:99]
  v_pk_fma_f32 v[100:101], v[4:5], v[132:133], v[100:101]
  v_pk_fma_f32 v[102:103], v[6:7], v[134:135], v[102:103]
  v_pk_fma_f32 v[104:105], v[8:9], v[136:137], v[104:105]
  v_pk_fma_f32 v[106:107], v[10:11], v[138:139], v[106:107]
  v_pk_fma_f32 v[108:109], v[12:13], v[140:141], v[108:109]
  v_pk_fma_f32 v[110:111], v[14:15], v[142:143], v[110:111]
  v_pk_fma_f32 v[112:113], v[16:17], v[128:129], v[112:113]
  v_pk_fma_f32 v[114:115], v[18:19], v[130:131], v[114:115]
  v_pk_fma_f32 v[116:117], v[20:21], v[132:133], v[116:117]
  v_pk_fma_f32 v[118:119], v[22:23], v[134:135], v[118:119]
  v_pk_fma_f32 v[120:121], v[24:25], v[136:137], v[120:121]
  v_pk_fma_f32 v[122:123], v[26:27], v[138:139], v[122:123]
  v_pk_fma_f32 v[124:125], v[28:29], v[140:141], v[124:125]
  v_pk_fma_f32 v[126:127], v[30:31], v[142:143], v[126:127]
  s_mov_b32 s33, 262144
  s_branch L_chk_48
L_poll_46:
  buffer_load_dwordx4 v[64:67], v251, s[4:7], s96 offen offset:0 sc1
  buffer_load_dwordx4 v[68:71], v251, s[4:7], s96 offen offset:1024 sc1
  buffer_load_dwordx4 v[72:75], v251, s[4:7], s96 offen offset:2048 sc1
  buffer_load_dwordx4 v[76:79], v251, s[4:7], s96 offen offset:3072 sc1
L_chk_48:
  s_waitcnt vmcnt(3)
  v_max3_u32 v32, v64, v65, v66
  v_max_u32 v32, v32, v67
  s_waitcnt vmcnt(2)
  v_max3_u32 v32, v32, v68, v69
  v_max3_u32 v32, v32, v70, v71
  s_waitcnt vmcnt(1)
  v_max3_u32 v32, v32, v72, v73
  v_max3_u32 v32, v32, v74, v75
  s_waitcnt vmcnt(0)
  v_max3_u32 v32, v32, v76, v77
  v_max3_u32 v32, v32, v78, v79
  v_cmp_eq_u32 s[68:69], -1, v32
  s_nop 1
  s_cmp_eq_u64 s[68:69], 0
  s_cbranch_scc1 L_ready_47
  s_sub_u32 s33, s33, 1
  s_cmp_lg_u32 s33, 0
  s_cbranch_scc1 L_poll_46
L_ready_47:
  v_lshlrev_b32 v144, 16, v64
  v_and_b32 v145, 0xffff0000, v64
  v_lshlrev_b32 v146, 16, v65
  v_and_b32 v147, 0xffff0000, v65
  v_pk_fma_f32 v[96:97], v[144:145], v[128:129], v[96:97]
  v_pk_fma_f32 v[98:99], v[146:147], v[130:131], v[98:99]
  v_cvt_pk_bf16_f32 v80, v96, v97
  v_cvt_pk_bf16_f32 v81, v98, v99
  v_lshlrev_b32 v148, 16, v66
  v_and_b32 v149, 0xffff0000, v66
  v_lshlrev_b32 v150, 16, v67
  v_and_b32 v151, 0xffff0000, v67
  v_pk_fma_f32 v[100:101], v[148:149], v[132:133], v[100:101]
  v_pk_fma_f32 v[102:103], v[150:151], v[134:135], v[102:103]
  v_cvt_pk_bf16_f32 v82, v100, v101
  v_cvt_pk_bf16_f32 v83, v102, v103
  s_nop 0
  v_permlane16_swap_b32 v80, v82
  v_permlane16_swap_b32 v81, v83
  s_nop 1
  buffer_store_dwordx4 v[80:83], v249, s[52:55], 0 offen offset:0 sc1
  v_lshlrev_b32 v152, 16, v68
  v_and_b32 v153, 0xffff0000, v68
  v_lshlrev_b32 v154, 16, v69
  v_and_b32 v155, 0xffff0000, v69
  v_pk_fma_f32 v[104:105], v[152:153], v[136:137], v[104:105]
  v_pk_fma_f32 v[106:107], v[154:155], v[138:139], v[106:107]
  v_cvt_pk_bf16_f32 v84, v104, v105
  v_cvt_pk_bf16_f32 v85, v106, v107
  v_lshlrev_b32 v156, 16, v70
  v_and_b32 v157, 0xffff0000, v70
  v_lshlrev_b32 v158, 16, v71
  v_and_b32 v159, 0xffff0000, v71
  v_pk_fma_f32 v[108:109], v[156:157], v[140:141], v[108:109]
  v_pk_fma_f32 v[110:111], v[158:159], v[142:143], v[110:111]
  v_cvt_pk_bf16_f32 v86, v108, v109
  v_cvt_pk_bf16_f32 v87, v110, v111
  s_nop 0
  v_permlane16_swap_b32 v84, v86
  v_permlane16_swap_b32 v85, v87
  s_nop 1
  buffer_store_dwordx4 v[84:87], v249, s[52:55], 0 offen offset:64 sc1
  v_lshlrev_b32 v160, 16, v72
  v_and_b32 v161, 0xffff0000, v72
  v_lshlrev_b32 v162, 16, v73
  v_and_b32 v163, 0xffff0000, v73
  v_pk_fma_f32 v[112:113], v[160:161], v[128:129], v[112:113]
  v_pk_fma_f32 v[114:115], v[162:163], v[130:131], v[114:115]
  v_cvt_pk_bf16_f32 v88, v112, v113
  v_cvt_pk_bf16_f32 v89, v114, v115
  v_lshlrev_b32 v164, 16, v74
  v_and_b32 v165, 0xffff0000, v74
  v_lshlrev_b32 v166, 16, v75
  v_and_b32 v167, 0xffff0000, v75
  v_pk_fma_f32 v[116:117], v[164:165], v[132:133], v[116:117]
  v_pk_fma_f32 v[118:119], v[166:167], v[134:135], v[118:119]
  v_cvt_pk_bf16_f32 v90, v116, v117
  v_cvt_pk_bf16_f32 v91, v118, v119
  s_nop 0
  v_permlane16_swap_b32 v88, v90
  v_permlane16_swap_b32 v89, v91
  s_nop 1
  buffer_store_dwordx4 v[88:91], v249, s[52:55], s38 offen offset:0 sc1
  v_lshlrev_b32 v168, 16, v76
  v_and_b32 v169, 0xffff0000, v76
  v_lshlrev_b32 v170, 16, v77
  v_and_b32 v171, 0xffff0000, v77
  v_pk_fma_f32 v[120:121], v[168:169], v[136:137], v[120:121]
  v_pk_fma_f32 v[122:123], v[170:171], v[138:139], v[122:123]
  v_cvt_pk_bf16_f32 v92, v120, v121
  v_cvt_pk_bf16_f32 v93, v122, v123
  v_lshlrev_b32 v172, 16, v78
  v_and_b32 v173, 0xffff0000, v78
  v_lshlrev_b32 v174, 16, v79
  v_and_b32 v175, 0xffff0000, v79
  v_pk_fma_f32 v[124:125], v[172:173], v[140:141], v[124:125]
  v_pk_fma_f32 v[126:127], v[174:175], v[142:143], v[126:127]
  v_cvt_pk_bf16_f32 v94, v124, v125
  v_cvt_pk_bf16_f32 v95, v126, v127
  s_nop 0
  v_permlane16_swap_b32 v92, v94
  v_permlane16_swap_b32 v93, v95
  s_nop 1
  buffer_store_dwordx4 v[92:95], v249, s[52:55], s38 offen offset:64 sc1
L_hot_end:
  s_endpgm
L_slow_35:
  s_mov_b32 s33, 262144
L_spin_49:
  buffer_load_dword v244, v254, s[4:7], s93 offen sc1
  s_waitcnt vmcnt(0)
  v_subrev_u32 v244, s100, v244
  v_cmp_lt_u32 s[68:69], 3, v244
  s_nop 1
  s_cmp_eq_u64 s[68:69], 0
  s_cbranch_scc1 L_back_36
  s_sub_u32 s33, s33, 1
  s_cmp_lg_u32 s33, 0
  s_cbranch_scc1 L_spin_49
  s_branch L_back_36
L_slow_37:
  s_mov_b32 s33, 262144
L_spin_50:
  buffer_load_dword v244, v243, s[4:7], s91 offen sc1
  s_waitcnt vmcnt(0)
  v_subrev_u32 v244, s100, v244
  v_cmp_lt_u32 s[68:69], 3, v244
  s_nop 1
  s_cmp_eq_u64 s[68:69], 0
  s_cbranch_scc1 L_back_38
  s_sub_u32 s33, s33, 1
  s_cmp_lg_u32 s33, 0
  s_cbranch_scc1 L_spin_50
  s_branch L_back_38
L_slow_39:
  s_mov_b32 s33, 262144
L_spin_51:
  buffer_load_dword v244, v243, s[4:7], s91 offen sc1
  s_waitcnt vmcnt(0)
  v_subrev_u32 v244, s100, v244
  v_cmp_lt_u32 s[68:69], 3, v244
  s_nop 1
  s_cmp_eq_u64 s[68:69], 0
  s_cbranch_scc1 L_back_40
  s_sub_u32 s33, s33, 1
  s_cmp_lg_u32 s33, 0
  s_cbranch_scc1 L_spin_51
  s_branch L_back_40
L_slow_41:
  s_mov_b32 s33, 262144
L_spin_52:
  buffer_load_dword v244, v243, s[4:7], s91 offen sc1
  s_waitcnt vmcnt(0)
  v_subrev_u32 v244, s100, v244
  v_cmp_lt_u32 s[68:69], 3, v244
  s_nop 1
  s_cmp_eq_u64 s[68:69], 0
  s_cbranch_scc1 L_back_42
  s_sub_u32 s33, s33, 1
  s_cmp_lg_u32 s33, 0
  s_cbranch_scc1 L_spin_52
  s_branch L_back_42
L_slow_43:
  s_mov_b32 s33, 262144
L_spin_53:
  buffer_load_dword v244, v243, s[4:7], s91 offen sc1
  s_waitcnt vmcnt(0)
  v_subrev_u32 v244, s100, v244
  v_cmp_lt_u32 s[68:69], 3, v244
  s_nop 1
  s_cmp_eq_u64 s[68:69], 0
  s_cbranch_scc1 L_back_44
  s_sub_u32 s33, s33, 1
  s_cmp_lg_u32 s33, 0
  s_cbranch_scc1 L_spin_53
  s_branch L_back_44
L_end_30:
  s_endpgm
L_code_end:
  s_endpgm
  .fill 2048, 4, 0xbf810000
.section .rodata,"a"
.p2align 6
.amdhsa_kernel k2_kernel
  .amdhsa_next_free_vgpr 256
  .amdhsa_next_free_sgpr 102
  .amdhsa_accum_offset 256
  .amdhsa_group_segment_fixed_size 0
  .amdhsa_kernarg_size 96
  .amdhsa_user_sgpr_count 2
  .amdhsa_user_sgpr_kernarg_segment_ptr 1
  .amdhsa_system_sgpr_workgroup_id_x 1
  .amdhsa_float_denorm_mode_32 3
.end_amdhsa_kernel
.p2align 6
.amdhsa_kernel k5_kernel
  .amdhsa_next_free_vgpr 512
  .amdhsa_next_free_sgpr 102
  .amdhsa_accum_offset 256
  .amdhsa_group_segment_fixed_size 0
  .amdhsa_kernarg_size 96
  .amdhsa_user_sgpr_count 2
  .amdhsa_user_sgpr_kernarg_segment_ptr 1
  .amdhsa_system_sgpr_workgroup_id_x 1
  .amdhsa_float_denorm_mode_32 3
.end_amdhsa_kernel
```

```asm
; @launch kernel=blk_kernel grid=(256,1,1) block=(256,1,1) lds=163840
.amdgcn_target "amdgcn-amd-amdhsa--gfx950"
.text
.globl blk_kernel
.p2align 8
.type blk_kernel,@function
blk_kernel:
  s_cmp_ge_u32 s2, 256
  s_cbranch_scc1 L_end_1
  s_load_dwordx2 s[4:5], s[0:1], 88
  s_load_dwordx2 s[48:49], s[0:1], 0
  s_load_dwordx2 s[64:65], s[0:1], 56
  s_load_dwordx2 s[60:61], s[0:1], 64
  v_lshrrev_b32 v200, 6, v0
  v_and_b32 v224, 63, v0
  v_readfirstlane_b32 s3, v200
  s_getpc_b64 s[30:31]
L_pc_6:
  s_lshr_b32 s32, s2, 4
  s_lshl_b32 s32, s32, 2
  s_add_u32 s32, s32, s3
  s_lshl_b32 s32, s32, 13
  v_lshlrev_b32 v200, 7, v224
  v_add_u32 v200, s32, v200
  v_min_u32 v200, L_code_end-L_pc_6-4, v200
  global_load_dword v223, v200, s[30:31]
  v_lshlrev_b32 v251, 4, v224
  s_lshr_b32 s36, s2, 4
  s_lshl_b32 s36, s36, 3
  s_and_b32 s30, s2, 7
  s_add_u32 s36, s36, s30
  s_lshl_b32 s42, s3, 10
  v_lshrrev_b32 v206, 3, v0
  v_and_b32 v207, 6, v206
  v_and_b32 v202, 7, v224
  v_xor_b32 v207, v207, v202
  s_and_b32 s35, s2, 3
  s_movk_i32 s30, 12288
  v_mul_u32_u24 v217, s30, v206
  v_lshl_add_u32 v217, v207, 4, v217
  s_mul_i32 s30, s35, 3145728
  v_add_u32 v217, s30, v217
  s_lshr_b32 s34, s36, 2
  s_lshl_b32 s31, s34, 7
  v_lshlrev_b32 v220, 1, v0
  s_lshl_b32 s30, s35, 9
  v_bfe_u32 v114, v224, 4, 1
  v_lshlrev_b32 v222, 5, v114
  v_lshrrev_b32 v114, 5, v224
  v_lshl_add_u32 v222, v114, 4, v222
  v_and_b32 v114, 15, v224
  v_lshl_add_u32 v1, v114, 11, v222
  s_lshl_b32 s33, s36, 15
  s_lshl_b32 s32, s3, 7
  s_add_u32 s33, s33, s32
  s_mov_b32 s66, 0x800
  s_mov_b32 s67, 0x20000
  s_mov_b32 s62, 0xc00000
  s_mov_b32 s63, 0x20000
  s_mov_b32 s50, 0x400000
  s_mov_b32 s51, 0x20000
  s_mov_b32 s6, 0x2800000
  s_mov_b32 s7, 0x20000
  s_bitcmp1_b32 s2, 3
  s_waitcnt lgkmcnt(0)
  buffer_load_ushort v196, v220, s[64:67], s30 offen
  s_cbranch_scc1 L_l1_2
  s_add_u32 m0, s42, 131072
  s_nop 0
  buffer_load_dwordx4 v217, s[60:63], s31 offen nt lds
  s_add_u32 m0, s42, 135168
  s_add_u32 s31, s31, 393216
  buffer_load_dwordx4 v217, s[60:63], s31 offen nt lds
  s_add_u32 m0, s42, 139264
  s_add_u32 s31, s31, 393216
  buffer_load_dwordx4 v217, s[60:63], s31 offen nt lds
  s_add_u32 m0, s42, 143360
  s_add_u32 s31, s31, 393216
  buffer_load_dwordx4 v217, s[60:63], s31 offen nt lds
  s_add_u32 m0, s42, 147456
  s_add_u32 s31, s31, 393216
  buffer_load_dwordx4 v217, s[60:63], s31 offen nt lds
  s_add_u32 m0, s42, 151552
  s_add_u32 s31, s31, 393216
  buffer_load_dwordx4 v217, s[60:63], s31 offen nt lds
  s_add_u32 m0, s42, 155648
  s_add_u32 s31, s31, 393216
  buffer_load_dwordx4 v217, s[60:63], s31 offen nt lds
  s_add_u32 m0, s42, 159744
  s_add_u32 s31, s31, 393216
  buffer_load_dwordx4 v217, s[60:63], s31 offen nt lds
  s_branch L_j1_3
L_l1_2:
  buffer_load_dwordx4 v[8:11], v1, s[48:51], s33 offen offset:0
  buffer_load_dwordx4 v[12:15], v1, s[48:51], s33 offen offset:64
  buffer_load_dwordx4 v[16:19], v1, s[48:51], s33 offen offset:512
  buffer_load_dwordx4 v[20:23], v1, s[48:51], s33 offen offset:576
  buffer_load_dwordx4 v[24:27], v1, s[48:51], s33 offen offset:1024
  buffer_load_dwordx4 v[28:31], v1, s[48:51], s33 offen offset:1088
  buffer_load_dwordx4 v[32:35], v1, s[48:51], s33 offen offset:1536
  buffer_load_dwordx4 v[36:39], v1, s[48:51], s33 offen offset:1600
L_j1_3:
  s_load_dword s100, s[4:5], 0xd2d00
  s_load_dwordx2 s[80:81], s[0:1], 8
  s_load_dwordx2 s[8:9], s[0:1], 16
  s_load_dwordx2 s[12:13], s[0:1], 32
  s_load_dwordx2 s[16:17], s[0:1], 40
  s_load_dwordx2 s[44:45], s[0:1], 48
  s_load_dwordx2 s[52:53], s[0:1], 72
  v_lshrrev_b32 v199, 4, v224
  s_movk_i32 s30, 6144
  v_mul_u32_u24 v199, s30, v199
  v_and_b32 v200, 15, v224
  v_min_u32 v200, 11, v200
  v_and_b32 v201, 3, v200
  v_lshl_add_u32 v199, v201, 7, v199
  v_lshrrev_b32 v200, 2, v200
  v_lshl_add_u32 v199, v200, 11, v199
  s_lshr_b32 s32, s2, 4
  s_lshl_b32 s30, s3, 4
  s_add_u32 s32, s32, s30
  s_mul_i32 s32, s32, 24576
  s_bfe_u32 s30, s2, 0x20001
  s_lshl_b32 s30, s30, 9
  s_add_u32 s32, s32, s30
  v_add_u32 v199, s32, v199
  s_and_b32 s22, s2, 1
  s_lshl_b32 s22, s22, 3
  s_bfe_u32 s30, s2, 0x30003
  s_add_u32 s22, s22, s30
  s_bfe_u32 s23, s2, 0x20001
  s_lshl_b32 s23, s23, 2
  s_lshr_b32 s30, s2, 6
  s_add_u32 s23, s23, s30
  v_lshrrev_b32 v200, 2, v0
  s_movk_i32 s30, 6144
  v_mul_u32_u24 v200, s30, v200
  v_bfe_u32 v201, v224, 4, 1
  v_lshlrev_b32 v202, 1, v201
  v_and_b32 v203, 3, v224
  v_xor_b32 v202, v202, v203
  v_lshl_add_u32 v200, v202, 4, v200
  s_lshl_b32 s30, s23, 7
  v_add_u32 v185, s30, v200
  v_add_u32 v186, 4096, v185
  v_lshrrev_b32 v200, 2, v224
  v_lshlrev_b32 v200, 6, v200
  v_lshl_add_u32 v200, v201, 5, v200
  v_lshl_add_u32 v176, v203, 3, v200
  v_xor_b32 v177, 32, v176
  s_and_b32 s30, s3, 1
  s_lshl_b32 s30, s30, 5
  v_xor_b32 v182, s30, v176
  s_lshr_b32 s31, s3, 1
  s_lshl_b32 s30, s31, 11
  v_add_u32 v182, s30, v182
  v_add_u32 v178, 0x10000, v176
  v_add_u32 v179, 0x10000, v177
  v_add_u32 v183, 0x10000, v182
  v_add_u32 v180, 0x20000, v176
  v_add_u32 v181, 0x20000, v177
  v_add_u32 v184, 0x20000, v182
  s_lshl_b32 s30, s22, 13
  s_lshl_b32 s32, s3, 11
  s_add_u32 s30, s30, s32
  v_add_u32 v187, s30, v251
  s_lshl_b32 s32, s22, 3
  s_max_u32 s32, s32, 1
  s_sub_u32 s32, s32, 1
  s_lshl_b32 s30, s32, 10
  s_lshl_b32 s31, s31, 17
  s_add_u32 s30, s30, s31
  v_add_u32 v188, s30, v251
  s_lshl_b32 s30, s22, 3
  s_lshl_b32 s31, s3, 1
  s_add_u32 s30, s30, s31
  s_lshl_b32 s30, s30, 2
  s_lshl_b32 s32, s32, 2
  v_add_u32 v200, s32, v203
  v_add_u32 v189, s30, v224
  v_cmp_lt_u32 vcc, 7, v224
  s_nop 1
  v_cndmask_b32 v189, v189, v200, vcc
  v_lshlrev_b32 v189, 6, v189
  v_add_u32 v189, 0xc0000, v189
  v_cmp_ne_u32 vcc, 0, v224
  v_mov_b32 v200, 0x40000000
  s_nop 0
  v_cndmask_b32 v246, 0, v200, vcc
  v_lshrrev_b32 v200, 2, v224
  v_lshlrev_b32 v200, 7, v200
  v_bfe_u32 v201, v224, 3, 2
  v_lshl_add_u32 v200, v201, 5, v200
  v_lshl_add_u32 v228, v203, 3, v200
  s_waitcnt lgkmcnt(0)
  s_add_u32 s100, s100, 0x9e3779b8
  s_and_b32 s100, s100, -8
  v_mov_b32 v245, s100
  s_mov_b32 s82, 0x600000
  s_mov_b32 s83, 0x20000
  s_bfe_u32 s84, s100, 0x80000
  s_bfe_u32 s85, s100, 0x80008
  s_bfe_u32 s86, s100, 0x80010
  s_bfe_u32 s87, s100, 0x80018
  s_bitcmp1_b32 s2, 3
  s_cselect_b32 s30, 0, 0x40000000
  buffer_load_dword v223, v199, s[80:83], s30 offen
  s_mul_i32 s35, s35, 24576
  s_lshl_b32 s30, s3, 6
  s_add_u32 s35, s35, s30
  s_lshl_b32 s30, s34, 8
  s_add_u32 s66, s35, s30
  s_lshr_b32 s30, s2, 2
  s_lshl_b32 s31, s30, 8
  s_add_u32 s35, s35, s31
  s_add_u32 s35, s35, 8192
  s_lshl_b32 s30, s30, 7
  s_add_u32 s30, s30, 4096
  v_add_u32 v217, s30, v217
  v_lshrrev_b32 v201, 4, v224
  v_lshlrev_b32 v250, 4, v201
  v_and_b32 v202, 15, v224
  v_cmp_ne_u32 vcc, 0, v202
  v_mov_b32 v6, 0x40000000
  s_nop 0
  v_cndmask_b32 v6, v250, v6, vcc
  v_add_u32 v218, s35, v6
  s_lshl_b32 s30, s3, 5
  v_xor_b32 v214, s30, v228
  v_add_u32 v215, 0x10000, v214
  v_add_u32 v216, 0x20000, v214
  s_lshl_b32 s0, s36, 2
  s_add_u32 s0, s0, s3
  s_lshl_b32 s0, s0, 6
  s_add_u32 s0, s0, 0xc0000
  s_lshl_b32 s1, s3, 18
  s_lshl_b32 s30, s36, 10
  s_add_u32 s1, s1, s30
  s_add_u32 s1, s1, 0x100000
  v_lshrrev_b32 v200, 5, v0
  v_lshlrev_b32 v200, 6, v200
  v_bfe_u32 v201, v0, 2, 2
  v_lshl_add_u32 v200, v201, 4, v200
  v_bfe_u32 v201, v0, 4, 1
  v_lshl_add_u32 v200, v201, 3, v200
  v_lshl_add_u32 v200, v203, 1, v200
  s_waitcnt vmcnt(9)
  v_lshlrev_b32 v196, 16, v196
  v_mul_f32 v197, 0xbfb8aa3b, v196
  v_exp_f32 v197, v197
  s_nop 0
  v_add_f32 v197, 1.0, v197
  v_rcp_f32 v197, v197
  s_nop 0
  v_mul_f32 v196, v196, v197
  v_cvt_pk_bf16_f32 v196, v196, v196
  ds_write_b16 v200, v196 offset:11264
  s_mov_b32 s10, 0x200000
  s_mov_b32 s11, 0x20000
  s_mov_b32 s14, 0x700000
  s_mov_b32 s15, 0x20000
  s_mov_b32 s18, 0x700000
  s_mov_b32 s19, 0x20000
  s_mov_b32 s46, 0x700000
  s_mov_b32 s47, 0x20000
  s_mov_b32 s54, 0x400000
  s_mov_b32 s55, 0x20000
  s_lshl_b32 s30, s23, 17
  s_add_u32 s78, s30, 0x500000
  s_lshl_b32 s30, s22, 2
  s_add_u32 s30, s30, s3
  s_lshl_b32 s30, s30, 4
  s_add_u32 s30, s30, s23
  s_lshl_b32 s30, s30, 6
  s_add_u32 s79, s30, 0x90000
  s_lshl_b32 s30, s22, 14
  s_lshl_b32 s31, s23, 10
  s_add_u32 s30, s30, s31
  s_lshl_b32 s31, s3, 8
  s_add_u32 s30, s30, s31
  s_add_u32 s89, s30, 0x40000
  s_xor_b32 s30, s3, 2
  s_lshl_b32 s30, s30, 11
  v_add_u32 v191, s30, v251
  v_xor_b32 v192, 0x1000, v191
  s_and_b32 s30, s3, 1
  s_lshl_b32 s30, s30, 3
  s_add_u32 s30, s30, 8192
  v_add_u32 v208, s30, v251
  s_sub_u32 s30, s3, 1
  s_xor_b32 s30, s30, 2
  s_lshl_b32 s30, s30, 11
  s_cmp_eq_u32 s3, 0
  s_cselect_b32 s30, 8192, s30
  v_add_u32 v209, s30, v251
  s_or_b32 s33, s22, s3
  s_and_b32 s24, s2, 1
  s_lshr_b32 s29, s2, 3
  s_bfe_u32 s25, s2, 0x20001
  s_lshl_b32 s25, s25, 2
  s_and_b32 s30, s29, 3
  s_add_u32 s25, s25, s30
  s_lshr_b32 s26, s29, 2
  s_lshl_b32 s26, s26, 1
  s_add_u32 s26, s26, s24
  s_lshl_b32 s30, s25, 13
  s_lshl_b32 s31, s3, 11
  s_add_u32 s30, s30, s31
  v_add_u32 v240, s30, v251
  v_lshlrev_b32 v202, 11, v206
  v_lshl_add_u32 v202, v207, 4, v202
  s_lshl_b32 s30, s26, 7
  v_add_u32 v241, s30, v202
  s_mul_i32 s30, s24, 3670016
  v_add_u32 v253, s30, v241
  v_xor_b32 v242, 128, v253
  s_mul_i32 s30, s24, 7340032
  v_add_u32 v252, s30, v240
  s_lshl_b32 s27, s24, 2
  s_and_b32 s30, s29, 3
  s_add_u32 s27, s27, s30
  s_bfe_u32 s28, s2, 0x20001
  s_lshl_b32 s28, s28, 3
  s_lshr_b32 s30, s29, 2
  s_add_u32 s28, s28, s30
  s_lshl_b32 s30, s27, 14
  s_lshl_b32 s31, s3, 12
  s_add_u32 s30, s30, s31
  v_add_u32 v225, s30, v251
  s_movk_i32 s30, 7168
  v_mul_u32_u24 v202, s30, v206
  v_lshl_add_u32 v202, v207, 4, v202
  s_lshr_b32 s30, s28, 2
  s_mul_i32 s30, s30, 896
  s_and_b32 s31, s28, 3
  s_lshl_b32 s32, s31, 8
  s_add_u32 s32, s32, s30
  v_add_u32 v226, s32, v202
  s_lshl_b32 s31, s31, 3
  s_lshr_b32 s32, 0x160e0c04, s31
  s_and_b32 s32, s32, 255
  s_lshl_b32 s32, s32, 5
  s_add_u32 s32, s32, s30
  v_mov_b32 v203, s32
  s_lshr_b32 s32, 0x15140706, s31
  s_and_b32 s32, s32, 255
  s_lshl_b32 s32, s32, 5
  s_add_u32 s32, s32, s30
  s_sub_u32 s32, s32, 64
  v_mov_b32 v204, s32
  v_cmp_lt_u32 vcc, 3, v207
  s_nop 1
  v_cndmask_b32 v203, v203, v204, vcc
  v_mov_b32 v204, 0x40000000
  v_cmp_lt_u32 vcc, 5, v207
  s_nop 1
  v_cndmask_b32 v203, v203, v204, vcc
  v_add_u32 v227, v203, v202
  v_xor_b32 v229, 32, v228
  v_xor_b32 v230, 64, v228
  v_xor_b32 v231, 96, v228
  v_add_u32 v232, 0x10000, v228
  v_add_u32 v233, 0x10000, v229
  v_add_u32 v234, 0x10000, v230
  v_add_u32 v235, 0x10000, v231
  v_add_u32 v236, 0x20000, v228
  v_add_u32 v237, 0x20000, v229
  v_add_u32 v238, 0x20000, v230
  v_add_u32 v239, 0x20000, v231
  s_lshr_b32 s30, s28, 4
  s_mul_i32 s30, s30, 56
  s_and_b32 s31, s28, 15
  s_add_u32 s32, s30, s31
  s_lshl_b32 s32, s32, 17
  s_add_u32 s64, s32, 17825792
  s_lshr_b32 s32, s31, 1
  s_add_u32 s32, s32, s30
  s_lshl_b32 s32, s32, 17
  s_and_b32 s31, s31, 1
  s_lshl_b32 s31, s31, 10
  s_add_u32 s32, s32, s31
  s_add_u32 s65, s32, 19922944
  s_add_u32 s20, s64, 3145728
  s_add_u32 s21, s64, 5242880
  s_lshl_b32 s30, s27, 2
  s_add_u32 s30, s30, s3
  s_lshl_b32 s30, s30, 5
  s_lshl_b32 s31, s30, 6
  s_add_u32 s93, s31, 720896
  s_add_u32 s30, s30, s28
  s_lshl_b32 s30, s30, 6
  s_add_u32 s90, s30, 524288
  s_lshl_b32 s30, s25, 1
  s_lshr_b32 s31, s3, 1
  s_add_u32 s30, s30, s31
  s_lshl_b32 s30, s30, 1
  s_add_u32 s30, s30, s24
  s_lshl_b32 s30, s30, 10
  s_add_u32 s91, s30, 524288
  s_lshl_b32 s30, s25, 2
  s_add_u32 s30, s30, s3
  s_lshl_b32 s30, s30, 10
  s_add_u32 s88, s30, 589824
  s_lshl_b32 s31, s26, 6
  s_add_u32 s30, s30, s31
  s_add_u32 s92, s30, 720896
  v_and_b32 v254, 31, v224
  v_lshlrev_b32 v254, 6, v254
  v_and_b32 v243, 960, v254
  s_lshl_b32 s30, s25, 14
  s_lshl_b32 s31, s3, 8
  s_add_u32 s30, s30, s31
  s_add_u32 s94, s30, 262144
  s_lshl_b32 s31, s26, 10
  s_add_u32 s95, s94, s31
  s_lshl_b32 s30, s2, 2
  s_add_u32 s30, s30, s3
  s_lshl_b32 s22, s30, 7
  s_xor_b32 s31, s30, 4
  s_lshl_b32 s30, s30, 12
  s_lshl_b32 s31, s31, 12
  s_add_u32 s96, s30, 13631488
  s_add_u32 s97, s31, 13631488
  s_lshl_b32 s30, s26, 18
  s_add_u32 s98, s30, 9437184
  s_add_u32 s99, s30, 9568256
  s_mov_b32 s38, 0x8000
  s_mov_b32 s43, 0xbfb8aa3b
  v_and_b32 v200, 15, v224
  v_lshlrev_b32 v249, 11, v200
  v_bfe_u32 v202, v224, 4, 1
  v_lshl_add_u32 v249, v202, 5, v249
  v_lshrrev_b32 v202, 5, v224
  v_lshl_add_u32 v249, v202, 4, v249
  s_lshl_b32 s30, s25, 18
  s_lshl_b32 s31, s3, 16
  s_add_u32 s30, s30, s31
  s_lshl_b32 s31, s26, 7
  s_add_u32 s30, s30, s31
  v_add_u32 v249, s30, v249
  v_lshrrev_b32 v201, 4, v224
  v_lshlrev_b32 v250, 4, v201
  s_bitcmp1_b32 s3, 0
  s_cselect_b32 s56, s16, s12
  s_cselect_b32 s57, s17, s13
  s_mov_b32 s58, 0x700000
  s_mov_b32 s59, 0x20000
  s_lshr_b32 s30, s2, 6
  s_lshl_b32 s30, s30, 5
  s_and_b32 s31, s2, 31
  s_add_u32 s30, s30, s31
  s_lshl_b32 s30, s30, 1
  s_lshr_b32 s31, s3, 1
  s_add_u32 s30, s30, s31
  s_lshl_b32 s30, s30, 11
  s_add_u32 s31, s28, 1
  s_bitcmp1_b32 s31, 1
  s_cselect_b32 s30, 0x40000000, s30
  v_lshrrev_b32 v247, 2, v224
  v_lshlrev_b32 v247, 7, v247
  v_add_u32 v247, s30, v247
  s_movk_i32 s30, 24576
  v_mul_u32_u24 v210, s30, v201
  v_lshl_add_u32 v210, v200, 4, v210
  s_lshl_b32 s30, s26, 8
  s_lshl_b32 s31, s3, 12
  s_add_u32 s30, s30, s31
  s_add_u32 s101, s30, 8192
  v_lshlrev_b32 v213, 4, v200
  s_lshl_b32 s30, s3, 8
  v_add_u32 v213, s30, v213
  v_lshlrev_b32 v211, 3, v224
  v_lshlrev_b32 v212, 12, v201
  v_lshl_add_u32 v212, v200, 3, v212
  v_cmp_gt_u32 s[34:35], 16, v224
  s_cmp_eq_u32 s3, 2
  s_cselect_b32 s39, 1.0, 0
  v_and_b32 v202, 14, v224
  v_lshlrev_b32 v201, 2, v201
  v_cmp_le_u32 s[24:25], v201, v202
  v_add_u32 v201, 2, v201
  v_cmp_le_u32 s[26:27], v201, v202
  v_and_b32 v202, 1, v224
  v_cmp_eq_u32 s[28:29], 1, v202
  v_lshlrev_b32 v195, 4, v202
  s_cmp_eq_u32 s33, 0
  s_cselect_b32 s33, 0xf149f2ca, 0
  v_mov_b32 v200, s33
  v_cndmask_b32_e64 v193, v200, 0, s[24:25]
  v_cndmask_b32_e64 v194, v200, 0, s[26:27]
  s_add_u32 s23, s22, 60
  s_add_u32 s36, s23, s8
  s_addc_u32 s37, s9, 0
  s_bitcmp1_b32 s2, 3
  s_cbranch_scc1 L_l2_4
  v_add_u32 v5, 0x20000, v214
  v_mov_b32 v7, 0xff
  s_waitcnt lgkmcnt(0)
  s_barrier
  ds_read_b128 v[16:19], v250 offset:11264
  ds_read_b128 v[20:23], v250 offset:11328
  ds_read_b128 v[24:27], v250 offset:11392
  ds_read_b128 v[28:31], v250 offset:11456
  ds_read_b128 v[32:35], v250 offset:11520
  ds_read_b128 v[36:39], v250 offset:11584
  ds_read_b128 v[40:43], v250 offset:11648
  ds_read_b128 v[44:47], v250 offset:11712
  s_waitcnt vmcnt(1)
  s_barrier
  ds_read_b64_tr_b16 v[48:49], v5 offset:0
  ds_read_b64_tr_b16 v[50:51], v5 offset:2048
  ds_read_b64_tr_b16 v[52:53], v5 offset:4096
  ds_read_b64_tr_b16 v[54:55], v5 offset:6144
  ds_read_b64_tr_b16 v[56:57], v5 offset:8192
  ds_read_b64_tr_b16 v[58:59], v5 offset:10240
  ds_read_b64_tr_b16 v[60:61], v5 offset:12288
  ds_read_b64_tr_b16 v[62:63], v5 offset:14336
  ds_read_b64_tr_b16 v[64:65], v5 offset:16384
  ds_read_b64_tr_b16 v[66:67], v5 offset:18432
  ds_read_b64_tr_b16 v[68:69], v5 offset:20480
  ds_read_b64_tr_b16 v[70:71], v5 offset:22528
  ds_read_b64_tr_b16 v[72:73], v5 offset:24576
  ds_read_b64_tr_b16 v[74:75], v5 offset:26624
  ds_read_b64_tr_b16 v[76:77], v5 offset:28672
  ds_read_b64_tr_b16 v[78:79], v5 offset:30720
  s_waitcnt lgkmcnt(14)
  v_mfma_f32_16x16x32_bf16 v[80:83], v[48:51], v[16:19], 0
  s_waitcnt lgkmcnt(12)
  v_mfma_f32_16x16x32_bf16 v[80:83], v[52:55], v[20:23], v[80:83]
  s_waitcnt lgkmcnt(10)
  v_mfma_f32_16x16x32_bf16 v[80:83], v[56:59], v[24:27], v[80:83]
  s_waitcnt lgkmcnt(8)
  v_mfma_f32_16x16x32_bf16 v[80:83], v[60:63], v[28:31], v[80:83]
  s_waitcnt lgkmcnt(6)
  v_mfma_f32_16x16x32_bf16 v[80:83], v[64:67], v[32:35], v[80:83]
  s_waitcnt lgkmcnt(4)
  v_mfma_f32_16x16x32_bf16 v[80:83], v[68:71], v[36:39], v[80:83]
  s_waitcnt lgkmcnt(2)
  v_mfma_f32_16x16x32_bf16 v[80:83], v[72:75], v[40:43], v[80:83]
  s_waitcnt lgkmcnt(0)
  v_mfma_f32_16x16x32_bf16 v[80:83], v[76:79], v[44:47], v[80:83]
  s_nop 7
  v_bfi_b32 v80, v7, s84, v80
  v_bfi_b32 v81, v7, s85, v81
  v_bfi_b32 v82, v7, s86, v82
  v_bfi_b32 v83, v7, s87, v83
  buffer_store_dwordx4 v[80:83], v6, s[4:7], s66 offen sc1
  s_mov_b32 s30, 1572864
  buffer_load_dword v223, v199, s[80:83], s30 offen
  s_mov_b32 s30, 3145728
  buffer_load_dword v223, v199, s[80:83], s30 offen
  s_mov_b32 s30, 4718592
  buffer_load_dword v223, v199, s[80:83], s30 offen
  s_mov_b32 s41, 0
  s_add_u32 m0, s42, 10240
  s_nop 0
  buffer_load_dwordx4 v185, s[80:83], s41 offen offset:2048 lds
  s_mov_b32 s41, 0
  s_add_u32 m0, s42, 14272
  s_nop 0
  buffer_load_dwordx4 v185, s[80:83], s41 offen offset:2112 lds
  s_mov_b32 s41, 0
  s_add_u32 m0, s42, 20480
  s_nop 0
  buffer_load_dwordx4 v186, s[80:83], s41 offen offset:0 lds
  s_mov_b32 s41, 0
  s_add_u32 m0, s42, 24512
  s_nop 0
  buffer_load_dwordx4 v186, s[80:83], s41 offen offset:64 lds
  s_mov_b32 s41, 0
  s_add_u32 m0, s42, 28672
  s_nop 0
  buffer_load_dwordx4 v185, s[80:83], s41 offen offset:0 lds
  s_mov_b32 s41, 0
  s_add_u32 m0, s42, 32704
  s_nop 0
  buffer_load_dwordx4 v185, s[80:83], s41 offen offset:64 lds
  s_mov_b32 s41, 393216
  s_add_u32 m0, s42, 34816
  s_nop 0
  buffer_load_dwordx4 v185, s[80:83], s41 offen offset:2048 lds
  s_mov_b32 s41, 393216
  s_add_u32 m0, s42, 38848
  s_nop 0
  buffer_load_dwordx4 v185, s[80:83], s41 offen offset:2112 lds
  s_mov_b32 s41, 393216
  s_add_u32 m0, s42, 45056
  s_nop 0
  buffer_load_dwordx4 v186, s[80:83], s41 offen offset:0 lds
  s_mov_b32 s41, 393216
  s_add_u32 m0, s42, 49088
  s_nop 0
  buffer_load_dwordx4 v186, s[80:83], s41 offen offset:64 lds
  s_mov_b32 s41, 393216
  s_add_u32 m0, s42, 53248
  s_nop 0
  buffer_load_dwordx4 v185, s[80:83], s41 offen offset:0 lds
  s_mov_b32 s41, 393216
  s_add_u32 m0, s42, 57280
  s_nop 0
  buffer_load_dwordx4 v185, s[80:83], s41 offen offset:64 lds
  s_mov_b32 s41, 786432
  s_add_u32 m0, s42, 59392
  s_nop 0
  buffer_load_dwordx4 v185, s[80:83], s41 offen offset:2048 lds
  s_mov_b32 s41, 786432
  s_add_u32 m0, s42, 63424
  s_nop 0
  buffer_load_dwordx4 v185, s[80:83], s41 offen offset:2112 lds
  s_mov_b32 s41, 786432
  s_add_u32 m0, s42, 69632
  s_nop 0
  buffer_load_dwordx4 v186, s[80:83], s41 offen offset:0 lds
  s_mov_b32 s41, 786432
  s_add_u32 m0, s42, 73664
  s_nop 0
  buffer_load_dwordx4 v186, s[80:83], s41 offen offset:64 lds
  s_mov_b32 s41, 786432
  s_add_u32 m0, s42, 77824
  s_nop 0
  buffer_load_dwordx4 v185, s[80:83], s41 offen offset:0 lds
  s_mov_b32 s41, 786432
  s_add_u32 m0, s42, 81856
  s_nop 0
  buffer_load_dwordx4 v185, s[80:83], s41 offen offset:64 lds
  s_mov_b32 s41, 1179648
  s_add_u32 m0, s42, 83968
  s_nop 0
  buffer_load_dwordx4 v185, s[80:83], s41 offen offset:2048 lds
  s_mov_b32 s41, 1179648
  s_add_u32 m0, s42, 88000
  s_nop 0
  buffer_load_dwordx4 v185, s[80:83], s41 offen offset:2112 lds
  s_mov_b32 s41, 1179648
  s_add_u32 m0, s42, 94208
  s_nop 0
  buffer_load_dwordx4 v186, s[80:83], s41 offen offset:0 lds
  s_mov_b32 s41, 1179648
  s_add_u32 m0, s42, 98240
  s_nop 0
  buffer_load_dwordx4 v186, s[80:83], s41 offen offset:64 lds
  s_mov_b32 s41, 1179648
  s_add_u32 m0, s42, 102400
  s_nop 0
  buffer_load_dwordx4 v185, s[80:83], s41 offen offset:0 lds
  s_mov_b32 s41, 1179648
  s_add_u32 m0, s42, 106432
  s_nop 0
  buffer_load_dwordx4 v185, s[80:83], s41 offen offset:64 lds
  s_mov_b32 s41, 1572864
  s_add_u32 m0, s42, 108544
  s_nop 0
  buffer_load_dwordx4 v185, s[80:83], s41 offen offset:2048 lds
  s_mov_b32 s41, 1572864
  s_add_u32 m0, s42, 112576
  s_nop 0
  buffer_load_dwordx4 v185, s[80:83], s41 offen offset:2112 lds
  s_mov_b32 s41, 1572864
  s_add_u32 m0, s42, 118784
  s_nop 0
  buffer_load_dwordx4 v186, s[80:83], s41 offen offset:0 lds
  s_mov_b32 s41, 1572864
  s_add_u32 m0, s42, 122816
  s_nop 0
  buffer_load_dwordx4 v186, s[80:83], s41 offen offset:64 lds
  s_mov_b32 s41, 1572864
  s_add_u32 m0, s42, 126976
  s_nop 0
  buffer_load_dwordx4 v185, s[80:83], s41 offen offset:0 lds
  s_barrier
  s_mov_b32 s41, 1572864
  s_add_u32 m0, s42, 131008
  s_nop 0
  buffer_load_dwordx4 v185, s[80:83], s41 offen offset:64 lds
  s_mov_b32 s41, 1966080
  s_add_u32 m0, s42, 133120
  s_nop 0
  buffer_load_dwordx4 v185, s[80:83], s41 offen offset:2048 lds
  s_mov_b32 s41, 1966080
  s_add_u32 m0, s42, 137152
  s_nop 0
  buffer_load_dwordx4 v185, s[80:83], s41 offen offset:2112 lds
  s_mov_b32 s41, 1966080
  s_add_u32 m0, s42, 143360
  s_nop 0
  buffer_load_dwordx4 v186, s[80:83], s41 offen offset:0 lds
  s_mov_b32 s41, 1966080
  s_add_u32 m0, s42, 147392
  s_nop 0
  buffer_load_dwordx4 v186, s[80:83], s41 offen offset:64 lds
  s_mov_b32 s41, 1966080
  s_add_u32 m0, s42, 151552
  s_nop 0
  buffer_load_dwordx4 v185, s[80:83], s41 offen offset:0 lds
  s_mov_b32 s41, 1966080
  s_add_u32 m0, s42, 155584
  s_nop 0
  buffer_load_dwordx4 v185, s[80:83], s41 offen offset:64 lds
  s_branch L_j2_5
L_l2_4:
  s_lshl_b32 s33, s3, 11
  v_lshlrev_b32 v222, 1, v222
  v_add_u32 v222, s33, v222
  v_add_u32 v3, s33, v251
  v_lshrrev_b32 v4, 4, v224
  v_lshlrev_b32 v4, 10, v4
  v_and_b32 v114, 15, v224
  v_lshl_add_u32 v4, v114, 4, v4
  s_lshl_b32 s33, s3, 8
  v_add_u32 v4, s33, v4
  v_add_u32 v5, 4096, v4
  v_mul_u32_u24 v6, 48, v114
  s_lshl_b32 s33, s3, 3
  v_add_u32 v7, s33, v6
  s_waitcnt vmcnt(8)
  v_lshlrev_b32 v40, 16, v8
  v_and_b32 v41, 0xffff0000, v8
  v_lshlrev_b32 v42, 16, v9
  v_and_b32 v43, 0xffff0000, v9
  v_lshlrev_b32 v44, 16, v10
  v_and_b32 v45, 0xffff0000, v10
  v_lshlrev_b32 v46, 16, v11
  v_and_b32 v47, 0xffff0000, v11
  v_pk_add_f32 v[114:115], v[40:41], v[42:43]
  v_pk_add_f32 v[116:117], v[44:45], v[46:47]
  s_waitcnt vmcnt(7)
  v_lshlrev_b32 v48, 16, v12
  v_and_b32 v49, 0xffff0000, v12
  v_lshlrev_b32 v50, 16, v13
  v_and_b32 v51, 0xffff0000, v13
  v_lshlrev_b32 v52, 16, v14
  v_and_b32 v53, 0xffff0000, v14
  v_lshlrev_b32 v54, 16, v15
  v_and_b32 v55, 0xffff0000, v15
  v_pk_add_f32 v[114:115], v[114:115], v[48:49]
  v_pk_add_f32 v[116:117], v[116:117], v[50:51]
  v_pk_add_f32 v[114:115], v[114:115], v[52:53]
  v_pk_add_f32 v[116:117], v[116:117], v[54:55]
  s_waitcnt vmcnt(6)
  v_lshlrev_b32 v56, 16, v16
  v_and_b32 v57, 0xffff0000, v16
  v_lshlrev_b32 v58, 16, v17
  v_and_b32 v59, 0xffff0000, v17
  v_lshlrev_b32 v60, 16, v18
  v_and_b32 v61, 0xffff0000, v18
  v_lshlrev_b32 v62, 16, v19
  v_and_b32 v63, 0xffff0000, v19
  v_pk_add_f32 v[114:115], v[114:115], v[56:57]
  v_pk_add_f32 v[116:117], v[116:117], v[58:59]
  v_pk_add_f32 v[114:115], v[114:115], v[60:61]
  v_pk_add_f32 v[116:117], v[116:117], v[62:63]
  s_waitcnt vmcnt(5)
  v_lshlrev_b32 v64, 16, v20
  v_and_b32 v65, 0xffff0000, v20
  v_lshlrev_b32 v66, 16, v21
  v_and_b32 v67, 0xffff0000, v21
  v_lshlrev_b32 v68, 16, v22
  v_and_b32 v69, 0xffff0000, v22
  v_lshlrev_b32 v70, 16, v23
  v_and_b32 v71, 0xffff0000, v23
  v_pk_add_f32 v[114:115], v[114:115], v[64:65]
  v_pk_add_f32 v[116:117], v[116:117], v[66:67]
  v_pk_add_f32 v[114:115], v[114:115], v[68:69]
  v_pk_add_f32 v[116:117], v[116:117], v[70:71]
  s_waitcnt vmcnt(4)
  v_lshlrev_b32 v72, 16, v24
  v_and_b32 v73, 0xffff0000, v24
  v_lshlrev_b32 v74, 16, v25
  v_and_b32 v75, 0xffff0000, v25
  v_lshlrev_b32 v76, 16, v26
  v_and_b32 v77, 0xffff0000, v26
  v_lshlrev_b32 v78, 16, v27
  v_and_b32 v79, 0xffff0000, v27
  v_pk_add_f32 v[114:115], v[114:115], v[72:73]
  v_pk_add_f32 v[116:117], v[116:117], v[74:75]
  v_pk_add_f32 v[114:115], v[114:115], v[76:77]
  v_pk_add_f32 v[116:117], v[116:117], v[78:79]
  s_waitcnt vmcnt(3)
  v_lshlrev_b32 v80, 16, v28
  v_and_b32 v81, 0xffff0000, v28
  v_lshlrev_b32 v82, 16, v29
  v_and_b32 v83, 0xffff0000, v29
  v_lshlrev_b32 v84, 16, v30
  v_and_b32 v85, 0xffff0000, v30
  v_lshlrev_b32 v86, 16, v31
  v_and_b32 v87, 0xffff0000, v31
  v_pk_add_f32 v[114:115], v[114:115], v[80:81]
  v_pk_add_f32 v[116:117], v[116:117], v[82:83]
  v_pk_add_f32 v[114:115], v[114:115], v[84:85]
  v_pk_add_f32 v[116:117], v[116:117], v[86:87]
  s_waitcnt vmcnt(2)
  v_lshlrev_b32 v88, 16, v32
  v_and_b32 v89, 0xffff0000, v32
  v_lshlrev_b32 v90, 16, v33
  v_and_b32 v91, 0xffff0000, v33
  v_lshlrev_b32 v92, 16, v34
  v_and_b32 v93, 0xffff0000, v34
  v_lshlrev_b32 v94, 16, v35
  v_and_b32 v95, 0xffff0000, v35
  v_pk_add_f32 v[114:115], v[114:115], v[88:89]
  v_pk_add_f32 v[116:117], v[116:117], v[90:91]
  v_pk_add_f32 v[114:115], v[114:115], v[92:93]
  v_pk_add_f32 v[116:117], v[116:117], v[94:95]
  s_waitcnt vmcnt(1)
  v_lshlrev_b32 v96, 16, v36
  v_and_b32 v97, 0xffff0000, v36
  v_lshlrev_b32 v98, 16, v37
  v_and_b32 v99, 0xffff0000, v37
  v_lshlrev_b32 v100, 16, v38
  v_and_b32 v101, 0xffff0000, v38
  v_lshlrev_b32 v102, 16, v39
  v_and_b32 v103, 0xffff0000, v39
  v_pk_add_f32 v[114:115], v[114:115], v[96:97]
  v_pk_add_f32 v[116:117], v[116:117], v[98:99]
  v_pk_add_f32 v[114:115], v[114:115], v[100:101]
  v_pk_add_f32 v[116:117], v[116:117], v[102:103]
  s_mov_b32 s41, 0
  s_add_u32 m0, s42, 10240
  s_nop 0
  buffer_load_dwordx4 v185, s[80:83], s41 offen offset:2048 lds
  s_mov_b32 s41, 0
  s_add_u32 m0, s42, 14272
  s_nop 0
  buffer_load_dwordx4 v185, s[80:83], s41 offen offset:2112 lds
  s_mov_b32 s41, 0
  s_add_u32 m0, s42, 20480
  s_nop 0
  buffer_load_dwordx4 v186, s[80:83], s41 offen offset:0 lds
  s_mov_b32 s41, 0
  s_add_u32 m0, s42, 24512
  s_nop 0
  buffer_load_dwordx4 v186, s[80:83], s41 offen offset:64 lds
  s_mov_b32 s41, 0
  s_add_u32 m0, s42, 28672
  s_nop 0
  buffer_load_dwordx4 v185, s[80:83], s41 offen offset:0 lds
  s_mov_b32 s41, 0
  s_add_u32 m0, s42, 32704
  s_nop 0
  buffer_load_dwordx4 v185, s[80:83], s41 offen offset:64 lds
  s_mov_b32 s41, 393216
  s_add_u32 m0, s42, 34816
  s_nop 0
  buffer_load_dwordx4 v185, s[80:83], s41 offen offset:2048 lds
  s_mov_b32 s41, 393216
  s_add_u32 m0, s42, 38848
  s_nop 0
  buffer_load_dwordx4 v185, s[80:83], s41 offen offset:2112 lds
  s_mov_b32 s41, 393216
  s_add_u32 m0, s42, 45056
  s_nop 0
  buffer_load_dwordx4 v186, s[80:83], s41 offen offset:0 lds
  s_mov_b32 s41, 393216
  s_add_u32 m0, s42, 49088
  s_nop 0
  buffer_load_dwordx4 v186, s[80:83], s41 offen offset:64 lds
  s_mov_b32 s41, 393216
  s_add_u32 m0, s42, 53248
  s_nop 0
  buffer_load_dwordx4 v185, s[80:83], s41 offen offset:0 lds
  s_mov_b32 s41, 393216
  s_add_u32 m0, s42, 57280
  s_nop 0
  buffer_load_dwordx4 v185, s[80:83], s41 offen offset:64 lds
  s_mov_b32 s41, 786432
  s_add_u32 m0, s42, 59392
  s_nop 0
  buffer_load_dwordx4 v185, s[80:83], s41 offen offset:2048 lds
  s_mov_b32 s41, 786432
  s_add_u32 m0, s42, 63424
  s_nop 0
  buffer_load_dwordx4 v185, s[80:83], s41 offen offset:2112 lds
  s_mov_b32 s41, 786432
  s_add_u32 m0, s42, 69632
  s_nop 0
  buffer_load_dwordx4 v186, s[80:83], s41 offen offset:0 lds
  s_mov_b32 s41, 786432
  s_add_u32 m0, s42, 73664
  s_nop 0
  buffer_load_dwordx4 v186, s[80:83], s41 offen offset:64 lds
  s_mov_b32 s41, 786432
  s_add_u32 m0, s42, 77824
  s_nop 0
  buffer_load_dwordx4 v185, s[80:83], s41 offen offset:0 lds
  s_mov_b32 s41, 786432
  s_add_u32 m0, s42, 81856
  s_nop 0
  buffer_load_dwordx4 v185, s[80:83], s41 offen offset:64 lds
  s_mov_b32 s41, 1179648
  s_add_u32 m0, s42, 83968
  s_nop 0
  buffer_load_dwordx4 v185, s[80:83], s41 offen offset:2048 lds
  s_mov_b32 s41, 1179648
  s_add_u32 m0, s42, 88000
  s_nop 0
  buffer_load_dwordx4 v185, s[80:83], s41 offen offset:2112 lds
  s_mov_b32 s41, 1179648
  s_add_u32 m0, s42, 94208
  s_nop 0
  buffer_load_dwordx4 v186, s[80:83], s41 offen offset:0 lds
  s_mov_b32 s41, 1179648
  s_add_u32 m0, s42, 98240
  s_nop 0
  buffer_load_dwordx4 v186, s[80:83], s41 offen offset:64 lds
  s_mov_b32 s41, 1179648
  s_add_u32 m0, s42, 102400
  s_nop 0
  buffer_load_dwordx4 v185, s[80:83], s41 offen offset:0 lds
  s_mov_b32 s41, 1179648
  s_add_u32 m0, s42, 106432
  s_nop 0
  buffer_load_dwordx4 v185, s[80:83], s41 offen offset:64 lds
  v_pk_add_f32 v[114:115], v[114:115], v[116:117]
  v_add_f32 v114, v114, v115
  v_mov_b32 v115, v114
  s_nop 1
  v_permlane16_swap_b32 v115, v114
  s_nop 1
  v_add_f32 v114, v114, v115
  v_mov_b32 v115, v114
  s_nop 1
  v_permlane32_swap_b32 v115, v114
  s_nop 1
  v_add_f32 v114, v114, v115
  v_mul_f32 v104, 0x3b800000, v114
  v_mov_b32 v105, v104
  v_pk_add_f32 v[108:109], v[40:41], v[104:105] neg_lo:[0,1] neg_hi:[0,1]
  v_pk_mul_f32 v[114:115], v[108:109], v[108:109]
  v_pk_add_f32 v[110:111], v[42:43], v[104:105] neg_lo:[0,1] neg_hi:[0,1]
  v_pk_mul_f32 v[116:117], v[110:111], v[110:111]
  v_pk_add_f32 v[108:109], v[44:45], v[104:105] neg_lo:[0,1] neg_hi:[0,1]
  v_pk_fma_f32 v[114:115], v[108:109], v[108:109], v[114:115]
  v_pk_add_f32 v[110:111], v[46:47], v[104:105] neg_lo:[0,1] neg_hi:[0,1]
  v_pk_fma_f32 v[116:117], v[110:111], v[110:111], v[116:117]
  v_pk_add_f32 v[108:109], v[48:49], v[104:105] neg_lo:[0,1] neg_hi:[0,1]
  v_pk_fma_f32 v[114:115], v[108:109], v[108:109], v[114:115]
  v_pk_add_f32 v[110:111], v[50:51], v[104:105] neg_lo:[0,1] neg_hi:[0,1]
  v_pk_fma_f32 v[116:117], v[110:111], v[110:111], v[116:117]
  v_pk_add_f32 v[108:109], v[52:53], v[104:105] neg_lo:[0,1] neg_hi:[0,1]
  v_pk_fma_f32 v[114:115], v[108:109], v[108:109], v[114:115]
  v_pk_add_f32 v[110:111], v[54:55], v[104:105] neg_lo:[0,1] neg_hi:[0,1]
  v_pk_fma_f32 v[116:117], v[110:111], v[110:111], v[116:117]
  v_pk_add_f32 v[108:109], v[56:57], v[104:105] neg_lo:[0,1] neg_hi:[0,1]
  v_pk_fma_f32 v[114:115], v[108:109], v[108:109], v[114:115]
  v_pk_add_f32 v[110:111], v[58:59], v[104:105] neg_lo:[0,1] neg_hi:[0,1]
  v_pk_fma_f32 v[116:117], v[110:111], v[110:111], v[116:117]
  v_pk_add_f32 v[108:109], v[60:61], v[104:105] neg_lo:[0,1] neg_hi:[0,1]
  v_pk_fma_f32 v[114:115], v[108:109], v[108:109], v[114:115]
  v_pk_add_f32 v[110:111], v[62:63], v[104:105] neg_lo:[0,1] neg_hi:[0,1]
  v_pk_fma_f32 v[116:117], v[110:111], v[110:111], v[116:117]
  v_pk_add_f32 v[108:109], v[64:65], v[104:105] neg_lo:[0,1] neg_hi:[0,1]
  v_pk_fma_f32 v[114:115], v[108:109], v[108:109], v[114:115]
  v_pk_add_f32 v[110:111], v[66:67], v[104:105] neg_lo:[0,1] neg_hi:[0,1]
  v_pk_fma_f32 v[116:117], v[110:111], v[110:111], v[116:117]
  v_pk_add_f32 v[108:109], v[68:69], v[104:105] neg_lo:[0,1] neg_hi:[0,1]
  v_pk_fma_f32 v[114:115], v[108:109], v[108:109], v[114:115]
  v_pk_add_f32 v[110:111], v[70:71], v[104:105] neg_lo:[0,1] neg_hi:[0,1]
  v_pk_fma_f32 v[116:117], v[110:111], v[110:111], v[116:117]
  v_pk_add_f32 v[108:109], v[72:73], v[104:105] neg_lo:[0,1] neg_hi:[0,1]
  v_pk_fma_f32 v[114:115], v[108:109], v[108:109], v[114:115]
  v_pk_add_f32 v[110:111], v[74:75], v[104:105] neg_lo:[0,1] neg_hi:[0,1]
  v_pk_fma_f32 v[116:117], v[110:111], v[110:111], v[116:117]
  v_pk_add_f32 v[108:109], v[76:77], v[104:105] neg_lo:[0,1] neg_hi:[0,1]
  v_pk_fma_f32 v[114:115], v[108:109], v[108:109], v[114:115]
  v_pk_add_f32 v[110:111], v[78:79], v[104:105] neg_lo:[0,1] neg_hi:[0,1]
  v_pk_fma_f32 v[116:117], v[110:111], v[110:111], v[116:117]
  v_pk_add_f32 v[108:109], v[80:81], v[104:105] neg_lo:[0,1] neg_hi:[0,1]
  v_pk_fma_f32 v[114:115], v[108:109], v[108:109], v[114:115]
  v_pk_add_f32 v[110:111], v[82:83], v[104:105] neg_lo:[0,1] neg_hi:[0,1]
  v_pk_fma_f32 v[116:117], v[110:111], v[110:111], v[116:117]
  v_pk_add_f32 v[108:109], v[84:85], v[104:105] neg_lo:[0,1] neg_hi:[0,1]
  v_pk_fma_f32 v[114:115], v[108:109], v[108:109], v[114:115]
  v_pk_add_f32 v[110:111], v[86:87], v[104:105] neg_lo:[0,1] neg_hi:[0,1]
  v_pk_fma_f32 v[116:117], v[110:111], v[110:111], v[116:117]
  v_pk_add_f32 v[108:109], v[88:89], v[104:105] neg_lo:[0,1] neg_hi:[0,1]
  v_pk_fma_f32 v[114:115], v[108:109], v[108:109], v[114:115]
  v_pk_add_f32 v[110:111], v[90:91], v[104:105] neg_lo:[0,1] neg_hi:[0,1]
  v_pk_fma_f32 v[116:117], v[110:111], v[110:111], v[116:117]
  v_pk_add_f32 v[108:109], v[92:93], v[104:105] neg_lo:[0,1] neg_hi:[0,1]
  v_pk_fma_f32 v[114:115], v[108:109], v[108:109], v[114:115]
  v_pk_add_f32 v[110:111], v[94:95], v[104:105] neg_lo:[0,1] neg_hi:[0,1]
  v_pk_fma_f32 v[116:117], v[110:111], v[110:111], v[116:117]
  v_pk_add_f32 v[108:109], v[96:97], v[104:105] neg_lo:[0,1] neg_hi:[0,1]
  v_pk_fma_f32 v[114:115], v[108:109], v[108:109], v[114:115]
  v_pk_add_f32 v[110:111], v[98:99], v[104:105] neg_lo:[0,1] neg_hi:[0,1]
  v_pk_fma_f32 v[116:117], v[110:111], v[110:111], v[116:117]
  v_pk_add_f32 v[108:109], v[100:101], v[104:105] neg_lo:[0,1] neg_hi:[0,1]
  v_pk_fma_f32 v[114:115], v[108:109], v[108:109], v[114:115]
  v_pk_add_f32 v[110:111], v[102:103], v[104:105] neg_lo:[0,1] neg_hi:[0,1]
  v_pk_fma_f32 v[116:117], v[110:111], v[110:111], v[116:117]
  v_pk_add_f32 v[114:115], v[114:115], v[116:117]
  v_add_f32 v105, v114, v115
  v_mov_b32 v115, v105
  s_nop 1
  v_permlane16_swap_b32 v115, v105
  s_nop 1
  v_add_f32 v105, v105, v115
  v_mov_b32 v115, v105
  s_nop 1
  v_permlane32_swap_b32 v115, v105
  s_nop 1
  v_add_f32 v105, v105, v115
  ds_write_b64 v7, v[104:105] offset:8192
  s_waitcnt lgkmcnt(0)
  s_barrier
  ds_read_b128 v[120:123], v6 offset:8192
  ds_read_b128 v[124:127], v6 offset:8208
  s_waitcnt lgkmcnt(0)
  v_pk_add_f32 v[114:115], v[120:121], v[122:123]
  v_pk_add_f32 v[116:117], v[124:125], v[126:127]
  v_pk_add_f32 v[114:115], v[114:115], v[116:117]
  v_mul_f32 v104, 0x3e800000, v114
  v_sub_f32 v120, v120, v104
  v_sub_f32 v122, v122, v104
  v_sub_f32 v124, v124, v104
  v_sub_f32 v126, v126, v104
  v_mul_f32 v116, v120, v120
  v_fmac_f32 v116, v122, v122
  v_fmac_f32 v116, v124, v124
  v_fmac_f32 v116, v126, v126
  v_mul_f32 v108, 0x3a800000, v115
  v_fmac_f32 v108, 0x3e800000, v116
  s_mov_b32 s30, 0
  buffer_load_dwordx4 v[120:123], v4, s[4:7], s30 offen sc1
  buffer_load_dwordx4 v[136:139], v5, s[4:7], s30 offen sc1
  s_mov_b32 s30, 24576
  buffer_load_dwordx4 v[124:127], v4, s[4:7], s30 offen sc1
  buffer_load_dwordx4 v[140:143], v5, s[4:7], s30 offen sc1
  s_mov_b32 s30, 49152
  buffer_load_dwordx4 v[128:131], v4, s[4:7], s30 offen sc1
  buffer_load_dwordx4 v[144:147], v5, s[4:7], s30 offen sc1
  s_mov_b32 s30, 73728
  buffer_load_dwordx4 v[132:135], v4, s[4:7], s30 offen sc1
  buffer_load_dwordx4 v[148:151], v5, s[4:7], s30 offen sc1
  v_cvt_pk_bf16_f32 v112, v104, v108
  v_lshlrev_b32 v104, 16, v112
  v_and_b32 v108, 0xffff0000, v112
  v_add_f32 v108, 0x3727c5ac, v108
  v_cvt_pk_bf16_f32 v112, v108, v109
  v_lshlrev_b32 v108, 16, v112
  v_and_b32 v109, 0xffff0000, v112
  v_sqrt_f32 v108, v108
  s_nop 0
  v_cvt_pk_bf16_f32 v112, v108, v109
  v_lshlrev_b32 v108, 16, v112
  v_and_b32 v109, 0xffff0000, v112
  v_rcp_f32 v108, v108
  v_mov_b32 v105, v104
  v_mov_b32 v109, v108
  v_pk_add_f32 v[40:41], v[40:41], v[104:105] neg_lo:[0,1] neg_hi:[0,1]
  v_pk_add_f32 v[42:43], v[42:43], v[104:105] neg_lo:[0,1] neg_hi:[0,1]
  v_pk_add_f32 v[44:45], v[44:45], v[104:105] neg_lo:[0,1] neg_hi:[0,1]
  v_pk_add_f32 v[46:47], v[46:47], v[104:105] neg_lo:[0,1] neg_hi:[0,1]
  v_pk_add_f32 v[48:49], v[48:49], v[104:105] neg_lo:[0,1] neg_hi:[0,1]
  v_pk_add_f32 v[50:51], v[50:51], v[104:105] neg_lo:[0,1] neg_hi:[0,1]
  v_pk_add_f32 v[52:53], v[52:53], v[104:105] neg_lo:[0,1] neg_hi:[0,1]
  v_pk_add_f32 v[54:55], v[54:55], v[104:105] neg_lo:[0,1] neg_hi:[0,1]
  v_pk_add_f32 v[56:57], v[56:57], v[104:105] neg_lo:[0,1] neg_hi:[0,1]
  v_pk_add_f32 v[58:59], v[58:59], v[104:105] neg_lo:[0,1] neg_hi:[0,1]
  v_pk_add_f32 v[60:61], v[60:61], v[104:105] neg_lo:[0,1] neg_hi:[0,1]
  v_pk_add_f32 v[62:63], v[62:63], v[104:105] neg_lo:[0,1] neg_hi:[0,1]
  v_pk_add_f32 v[64:65], v[64:65], v[104:105] neg_lo:[0,1] neg_hi:[0,1]
  v_pk_add_f32 v[66:67], v[66:67], v[104:105] neg_lo:[0,1] neg_hi:[0,1]
  v_pk_add_f32 v[68:69], v[68:69], v[104:105] neg_lo:[0,1] neg_hi:[0,1]
  v_pk_add_f32 v[70:71], v[70:71], v[104:105] neg_lo:[0,1] neg_hi:[0,1]
  v_pk_add_f32 v[72:73], v[72:73], v[104:105] neg_lo:[0,1] neg_hi:[0,1]
  v_pk_add_f32 v[74:75], v[74:75], v[104:105] neg_lo:[0,1] neg_hi:[0,1]
  v_pk_add_f32 v[76:77], v[76:77], v[104:105] neg_lo:[0,1] neg_hi:[0,1]
  v_pk_add_f32 v[78:79], v[78:79], v[104:105] neg_lo:[0,1] neg_hi:[0,1]
  v_pk_add_f32 v[80:81], v[80:81], v[104:105] neg_lo:[0,1] neg_hi:[0,1]
  v_pk_add_f32 v[82:83], v[82:83], v[104:105] neg_lo:[0,1] neg_hi:[0,1]
  v_pk_add_f32 v[84:85], v[84:85], v[104:105] neg_lo:[0,1] neg_hi:[0,1]
  v_pk_add_f32 v[86:87], v[86:87], v[104:105] neg_lo:[0,1] neg_hi:[0,1]
  v_pk_add_f32 v[88:89], v[88:89], v[104:105] neg_lo:[0,1] neg_hi:[0,1]
  v_pk_add_f32 v[90:91], v[90:91], v[104:105] neg_lo:[0,1] neg_hi:[0,1]
  v_pk_add_f32 v[92:93], v[92:93], v[104:105] neg_lo:[0,1] neg_hi:[0,1]
  v_pk_add_f32 v[94:95], v[94:95], v[104:105] neg_lo:[0,1] neg_hi:[0,1]
  v_pk_add_f32 v[96:97], v[96:97], v[104:105] neg_lo:[0,1] neg_hi:[0,1]
  v_pk_add_f32 v[98:99], v[98:99], v[104:105] neg_lo:[0,1] neg_hi:[0,1]
  v_pk_add_f32 v[100:101], v[100:101], v[104:105] neg_lo:[0,1] neg_hi:[0,1]
  v_pk_add_f32 v[102:103], v[102:103], v[104:105] neg_lo:[0,1] neg_hi:[0,1]
  v_pk_mul_f32 v[40:41], v[40:41], v[108:109]
  v_pk_mul_f32 v[42:43], v[42:43], v[108:109]
  v_pk_mul_f32 v[44:45], v[44:45], v[108:109]
  v_pk_mul_f32 v[46:47], v[46:47], v[108:109]
  v_pk_mul_f32 v[48:49], v[48:49], v[108:109]
  v_pk_mul_f32 v[50:51], v[50:51], v[108:109]
  v_pk_mul_f32 v[52:53], v[52:53], v[108:109]
  v_pk_mul_f32 v[54:55], v[54:55], v[108:109]
  v_pk_mul_f32 v[56:57], v[56:57], v[108:109]
  v_pk_mul_f32 v[58:59], v[58:59], v[108:109]
  v_pk_mul_f32 v[60:61], v[60:61], v[108:109]
  v_pk_mul_f32 v[62:63], v[62:63], v[108:109]
  v_pk_mul_f32 v[64:65], v[64:65], v[108:109]
  v_pk_mul_f32 v[66:67], v[66:67], v[108:109]
  v_pk_mul_f32 v[68:69], v[68:69], v[108:109]
  v_pk_mul_f32 v[70:71], v[70:71], v[108:109]
  v_pk_mul_f32 v[72:73], v[72:73], v[108:109]
  v_pk_mul_f32 v[74:75], v[74:75], v[108:109]
  v_pk_mul_f32 v[76:77], v[76:77], v[108:109]
  v_pk_mul_f32 v[78:79], v[78:79], v[108:109]
  v_pk_mul_f32 v[80:81], v[80:81], v[108:109]
  v_pk_mul_f32 v[82:83], v[82:83], v[108:109]
  v_pk_mul_f32 v[84:85], v[84:85], v[108:109]
  v_pk_mul_f32 v[86:87], v[86:87], v[108:109]
  v_pk_mul_f32 v[88:89], v[88:89], v[108:109]
  v_pk_mul_f32 v[90:91], v[90:91], v[108:109]
  v_pk_mul_f32 v[92:93], v[92:93], v[108:109]
  v_pk_mul_f32 v[94:95], v[94:95], v[108:109]
  v_pk_mul_f32 v[96:97], v[96:97], v[108:109]
  v_pk_mul_f32 v[98:99], v[98:99], v[108:109]
  v_pk_mul_f32 v[100:101], v[100:101], v[108:109]
  v_pk_mul_f32 v[102:103], v[102:103], v[108:109]
  s_mov_b32 s33, 262144
  s_branch L_mchk_9
L_mod_7:
  s_mov_b32 s30, 0
  buffer_load_dwordx4 v[120:123], v4, s[4:7], s30 offen sc1
  buffer_load_dwordx4 v[136:139], v5, s[4:7], s30 offen sc1
  s_mov_b32 s30, 24576
  buffer_load_dwordx4 v[124:127], v4, s[4:7], s30 offen sc1
  buffer_load_dwordx4 v[140:143], v5, s[4:7], s30 offen sc1
  s_mov_b32 s30, 49152
  buffer_load_dwordx4 v[128:131], v4, s[4:7], s30 offen sc1
  buffer_load_dwordx4 v[144:147], v5, s[4:7], s30 offen sc1
  s_mov_b32 s30, 73728
  buffer_load_dwordx4 v[132:135], v4, s[4:7], s30 offen sc1
  buffer_load_dwordx4 v[148:151], v5, s[4:7], s30 offen sc1
L_mchk_9:
  s_waitcnt vmcnt(0)
  v_xor_b32 v120, s84, v120
  v_xor_b32 v121, s85, v121
  v_or_b32 v114, v120, v121
  v_xor_b32 v122, s86, v122
  v_xor_b32 v123, s87, v123
  v_or3_b32 v114, v114, v122, v123
  v_xor_b32 v124, s84, v124
  v_xor_b32 v125, s85, v125
  v_or3_b32 v114, v114, v124, v125
  v_xor_b32 v126, s86, v126
  v_xor_b32 v127, s87, v127
  v_or3_b32 v114, v114, v126, v127
  v_xor_b32 v128, s84, v128
  v_xor_b32 v129, s85, v129
  v_or3_b32 v114, v114, v128, v129
  v_xor_b32 v130, s86, v130
  v_xor_b32 v131, s87, v131
  v_or3_b32 v114, v114, v130, v131
  v_xor_b32 v132, s84, v132
  v_xor_b32 v133, s85, v133
  v_or3_b32 v114, v114, v132, v133
  v_xor_b32 v134, s86, v134
  v_xor_b32 v135, s87, v135
  v_or3_b32 v114, v114, v134, v135
  v_xor_b32 v136, s84, v136
  v_xor_b32 v137, s85, v137
  v_or3_b32 v114, v114, v136, v137
  v_xor_b32 v138, s86, v138
  v_xor_b32 v139, s87, v139
  v_or3_b32 v114, v114, v138, v139
  v_xor_b32 v140, s84, v140
  v_xor_b32 v141, s85, v141
  v_or3_b32 v114, v114, v140, v141
  v_xor_b32 v142, s86, v142
  v_xor_b32 v143, s87, v143
  v_or3_b32 v114, v114, v142, v143
  v_xor_b32 v144, s84, v144
  v_xor_b32 v145, s85, v145
  v_or3_b32 v114, v114, v144, v145
  v_xor_b32 v146, s86, v146
  v_xor_b32 v147, s87, v147
  v_or3_b32 v114, v114, v146, v147
  v_xor_b32 v148, s84, v148
  v_xor_b32 v149, s85, v149
  v_or3_b32 v114, v114, v148, v149
  v_xor_b32 v150, s86, v150
  v_xor_b32 v151, s87, v151
  v_or3_b32 v114, v114, v150, v151
  v_and_b32 v114, 0xff, v114
  v_cmp_ne_u32 s[68:69], 0, v114
  s_nop 1
  s_cmp_eq_u64 s[68:69], 0
  s_cbranch_scc1 L_mok_8
  s_sub_u32 s33, s33, 1
  s_cmp_lg_u32 s33, 0
  s_cbranch_scc1 L_mod_7
L_mok_8:
  v_pk_add_f32 v[120:121], v[120:121], v[124:125]
  v_pk_add_f32 v[128:129], v[128:129], v[132:133]
  v_pk_add_f32 v[122:123], v[122:123], v[126:127]
  v_pk_add_f32 v[130:131], v[130:131], v[134:135]
  v_pk_add_f32 v[136:137], v[136:137], v[140:141]
  v_pk_add_f32 v[144:145], v[144:145], v[148:149]
  v_pk_add_f32 v[138:139], v[138:139], v[142:143]
  v_pk_add_f32 v[146:147], v[146:147], v[150:151]
  v_pk_add_f32 v[120:121], v[120:121], v[128:129]
  v_pk_add_f32 v[122:123], v[122:123], v[130:131]
  v_pk_add_f32 v[136:137], v[136:137], v[144:145]
  v_pk_add_f32 v[138:139], v[138:139], v[146:147]
  v_cvt_pk_bf16_f32 v124, v120, v121
  v_lshlrev_b32 v120, 16, v124
  v_and_b32 v121, 0xffff0000, v124
  v_cvt_pk_bf16_f32 v126, v122, v123
  v_lshlrev_b32 v122, 16, v126
  v_and_b32 v123, 0xffff0000, v126
  v_cvt_pk_bf16_f32 v140, v136, v137
  v_lshlrev_b32 v136, 16, v140
  v_and_b32 v137, 0xffff0000, v140
  v_cvt_pk_bf16_f32 v142, v138, v139
  v_lshlrev_b32 v138, 16, v142
  v_and_b32 v139, 0xffff0000, v142
  ds_write_b128 v3, v[120:123]
  v_add_f32 v136, 1.0, v136
  v_add_f32 v137, 1.0, v137
  v_add_f32 v138, 1.0, v138
  v_add_f32 v139, 1.0, v139
  v_cvt_pk_bf16_f32 v140, v136, v137
  v_lshlrev_b32 v136, 16, v140
  v_and_b32 v137, 0xffff0000, v140
  v_cvt_pk_bf16_f32 v142, v138, v139
  v_lshlrev_b32 v138, 16, v142
  v_and_b32 v139, 0xffff0000, v142
  ds_write_b128 v3, v[136:139] offset:1024
  ds_read_b128 v[144:147], v222 offset:0
  ds_read_b128 v[148:151], v222 offset:16
  ds_read_b128 v[152:155], v222 offset:1024
  ds_read_b128 v[156:159], v222 offset:1040
  ds_read_b128 v[160:163], v222 offset:128
  ds_read_b128 v[164:167], v222 offset:144
  ds_read_b128 v[168:171], v222 offset:1152
  ds_read_b128 v[172:175], v222 offset:1168
  ds_read_b128 v[128:131], v222 offset:256
  ds_read_b128 v[132:135], v222 offset:272
  ds_read_b128 v[136:139], v222 offset:1280
  ds_read_b128 v[140:143], v222 offset:1296
  s_waitcnt lgkmcnt(8)
  v_pk_fma_f32 v[40:41], v[40:41], v[152:153], v[144:145]
  v_pk_fma_f32 v[42:43], v[42:43], v[154:155], v[146:147]
  v_pk_fma_f32 v[44:45], v[44:45], v[156:157], v[148:149]
  v_pk_fma_f32 v[46:47], v[46:47], v[158:159], v[150:151]
  v_cvt_pk_bf16_f32 v8, v40, v41
  v_cvt_pk_bf16_f32 v9, v42, v43
  v_cvt_pk_bf16_f32 v10, v44, v45
  v_cvt_pk_bf16_f32 v11, v46, v47
  s_add_u32 s33, s1, 0
  v_permlane16_swap_b32 v8, v10
  v_permlane16_swap_b32 v9, v11
  s_nop 1
  buffer_store_dwordx4 v[8:11], v251, s[4:7], s33 offen sc1
  ds_read_b128 v[144:147], v222 offset:384
  ds_read_b128 v[148:151], v222 offset:400
  ds_read_b128 v[152:155], v222 offset:1408
  ds_read_b128 v[156:159], v222 offset:1424
  s_waitcnt lgkmcnt(8)
  v_pk_fma_f32 v[48:49], v[48:49], v[168:169], v[160:161]
  v_pk_fma_f32 v[50:51], v[50:51], v[170:171], v[162:163]
  v_pk_fma_f32 v[52:53], v[52:53], v[172:173], v[164:165]
  v_pk_fma_f32 v[54:55], v[54:55], v[174:175], v[166:167]
  v_cvt_pk_bf16_f32 v12, v48, v49
  v_cvt_pk_bf16_f32 v13, v50, v51
  v_cvt_pk_bf16_f32 v14, v52, v53
  v_cvt_pk_bf16_f32 v15, v54, v55
  s_add_u32 s33, s1, 131072
  v_permlane16_swap_b32 v12, v14
  v_permlane16_swap_b32 v13, v15
  s_nop 1
  buffer_store_dwordx4 v[12:15], v251, s[4:7], s33 offen sc1
  ds_read_b128 v[160:163], v222 offset:512
  ds_read_b128 v[164:167], v222 offset:528
  ds_read_b128 v[168:171], v222 offset:1536
  ds_read_b128 v[172:175], v222 offset:1552
  s_waitcnt lgkmcnt(8)
  v_pk_fma_f32 v[56:57], v[56:57], v[136:137], v[128:129]
  v_pk_fma_f32 v[58:59], v[58:59], v[138:139], v[130:131]
  v_pk_fma_f32 v[60:61], v[60:61], v[140:141], v[132:133]
  v_pk_fma_f32 v[62:63], v[62:63], v[142:143], v[134:135]
  v_cvt_pk_bf16_f32 v16, v56, v57
  v_cvt_pk_bf16_f32 v17, v58, v59
  v_cvt_pk_bf16_f32 v18, v60, v61
  v_cvt_pk_bf16_f32 v19, v62, v63
  s_add_u32 s33, s1, 1048576
  v_permlane16_swap_b32 v16, v18
  v_permlane16_swap_b32 v17, v19
  s_nop 1
  buffer_store_dwordx4 v[16:19], v251, s[4:7], s33 offen sc1
  ds_read_b128 v[128:131], v222 offset:640
  ds_read_b128 v[132:135], v222 offset:656
  ds_read_b128 v[136:139], v222 offset:1664
  ds_read_b128 v[140:143], v222 offset:1680
  s_waitcnt lgkmcnt(8)
  v_pk_fma_f32 v[64:65], v[64:65], v[152:153], v[144:145]
  v_pk_fma_f32 v[66:67], v[66:67], v[154:155], v[146:147]
  v_pk_fma_f32 v[68:69], v[68:69], v[156:157], v[148:149]
  v_pk_fma_f32 v[70:71], v[70:71], v[158:159], v[150:151]
  v_cvt_pk_bf16_f32 v20, v64, v65
  v_cvt_pk_bf16_f32 v21, v66, v67
  v_cvt_pk_bf16_f32 v22, v68, v69
  v_cvt_pk_bf16_f32 v23, v70, v71
  s_add_u32 s33, s1, 1179648
  v_permlane16_swap_b32 v20, v22
  v_permlane16_swap_b32 v21, v23
  s_nop 1
  buffer_store_dwordx4 v[20:23], v251, s[4:7], s33 offen sc1
  ds_read_b128 v[144:147], v222 offset:768
  ds_read_b128 v[148:151], v222 offset:784
  ds_read_b128 v[152:155], v222 offset:1792
  ds_read_b128 v[156:159], v222 offset:1808
  s_waitcnt lgkmcnt(8)
  v_pk_fma_f32 v[72:73], v[72:73], v[168:169], v[160:161]
  v_pk_fma_f32 v[74:75], v[74:75], v[170:171], v[162:163]
  v_pk_fma_f32 v[76:77], v[76:77], v[172:173], v[164:165]
  v_pk_fma_f32 v[78:79], v[78:79], v[174:175], v[166:167]
  v_cvt_pk_bf16_f32 v24, v72, v73
  v_cvt_pk_bf16_f32 v25, v74, v75
  v_cvt_pk_bf16_f32 v26, v76, v77
  v_cvt_pk_bf16_f32 v27, v78, v79
  s_add_u32 s33, s1, 2097152
  v_permlane16_swap_b32 v24, v26
  v_permlane16_swap_b32 v25, v27
  s_nop 1
  buffer_store_dwordx4 v[24:27], v251, s[4:7], s33 offen sc1
  ds_read_b128 v[160:163], v222 offset:896
  ds_read_b128 v[164:167], v222 offset:912
  ds_read_b128 v[168:171], v222 offset:1920
  ds_read_b128 v[172:175], v222 offset:1936
  s_waitcnt lgkmcnt(8)
  v_pk_fma_f32 v[80:81], v[80:81], v[136:137], v[128:129]
  v_pk_fma_f32 v[82:83], v[82:83], v[138:139], v[130:131]
  v_pk_fma_f32 v[84:85], v[84:85], v[140:141], v[132:133]
  v_pk_fma_f32 v[86:87], v[86:87], v[142:143], v[134:135]
  v_cvt_pk_bf16_f32 v28, v80, v81
  v_cvt_pk_bf16_f32 v29, v82, v83
  v_cvt_pk_bf16_f32 v30, v84, v85
  v_cvt_pk_bf16_f32 v31, v86, v87
  s_add_u32 s33, s1, 2228224
  v_permlane16_swap_b32 v28, v30
  v_permlane16_swap_b32 v29, v31
  s_nop 1
  buffer_store_dwordx4 v[28:31], v251, s[4:7], s33 offen sc1
  s_waitcnt lgkmcnt(4)
  v_pk_fma_f32 v[88:89], v[88:89], v[152:153], v[144:145]
  v_pk_fma_f32 v[90:91], v[90:91], v[154:155], v[146:147]
  v_pk_fma_f32 v[92:93], v[92:93], v[156:157], v[148:149]
  v_pk_fma_f32 v[94:95], v[94:95], v[158:159], v[150:151]
  v_cvt_pk_bf16_f32 v32, v88, v89
  v_cvt_pk_bf16_f32 v33, v90, v91
  v_cvt_pk_bf16_f32 v34, v92, v93
  v_cvt_pk_bf16_f32 v35, v94, v95
  s_add_u32 s33, s1, 3145728
  v_permlane16_swap_b32 v32, v34
  v_permlane16_swap_b32 v33, v35
  s_nop 1
  buffer_store_dwordx4 v[32:35], v251, s[4:7], s33 offen sc1
  s_waitcnt lgkmcnt(0)
  v_pk_fma_f32 v[96:97], v[96:97], v[168:169], v[160:161]
  v_pk_fma_f32 v[98:99], v[98:99], v[170:171], v[162:163]
  v_pk_fma_f32 v[100:101], v[100:101], v[172:173], v[164:165]
  v_pk_fma_f32 v[102:103], v[102:103], v[174:175], v[166:167]
  v_cvt_pk_bf16_f32 v36, v96, v97
  v_cvt_pk_bf16_f32 v37, v98, v99
  v_cvt_pk_bf16_f32 v38, v100, v101
  v_cvt_pk_bf16_f32 v39, v102, v103
  s_add_u32 s33, s1, 3276800
  v_permlane16_swap_b32 v36, v38
  v_permlane16_swap_b32 v37, v39
  s_nop 1
  buffer_store_dwordx4 v[36:39], v251, s[4:7], s33 offen sc1
  s_waitcnt vmcnt(6)
  v_add_u32 v248, 0, v245
  buffer_store_dword v248, v246, s[4:7], s0 offen sc1
  s_waitcnt vmcnt(1)
  v_add_u32 v248, 1, v245
  buffer_store_dword v248, v246, s[4:7], s0 offen sc1
  s_mov_b32 s41, 1572864
  s_add_u32 m0, s42, 108544
  s_nop 0
  buffer_load_dwordx4 v185, s[80:83], s41 offen offset:2048 lds
  s_mov_b32 s41, 1572864
  s_add_u32 m0, s42, 112576
  s_nop 0
  buffer_load_dwordx4 v185, s[80:83], s41 offen offset:2112 lds
  s_mov_b32 s41, 1572864
  s_add_u32 m0, s42, 118784
  s_nop 0
  buffer_load_dwordx4 v186, s[80:83], s41 offen offset:0 lds
  s_mov_b32 s41, 1572864
  s_add_u32 m0, s42, 122816
  s_nop 0
  buffer_load_dwordx4 v186, s[80:83], s41 offen offset:64 lds
  s_mov_b32 s41, 1572864
  s_add_u32 m0, s42, 126976
  s_nop 0
  buffer_load_dwordx4 v185, s[80:83], s41 offen offset:0 lds
  s_mov_b32 s41, 1572864
  s_add_u32 m0, s42, 131008
  s_nop 0
  buffer_load_dwordx4 v185, s[80:83], s41 offen offset:64 lds
  s_mov_b32 s41, 1966080
  s_add_u32 m0, s42, 133120
  s_nop 0
  buffer_load_dwordx4 v185, s[80:83], s41 offen offset:2048 lds
  s_mov_b32 s41, 1966080
  s_add_u32 m0, s42, 137152
  s_nop 0
  buffer_load_dwordx4 v185, s[80:83], s41 offen offset:2112 lds
  s_mov_b32 s41, 1966080
  s_add_u32 m0, s42, 143360
  s_nop 0
  buffer_load_dwordx4 v186, s[80:83], s41 offen offset:0 lds
  s_mov_b32 s41, 1966080
  s_add_u32 m0, s42, 147392
  s_nop 0
  buffer_load_dwordx4 v186, s[80:83], s41 offen offset:64 lds
  s_mov_b32 s41, 1966080
  s_add_u32 m0, s42, 151552
  s_nop 0
  buffer_load_dwordx4 v185, s[80:83], s41 offen offset:0 lds
  s_mov_b32 s41, 1966080
  s_add_u32 m0, s42, 155584
  s_nop 0
  buffer_load_dwordx4 v185, s[80:83], s41 offen offset:64 lds
L_j2_5:
  s_mov_b64 vcc, 0
  s_mov_b64 vcc, -1
  s_cmp_eq_u32 s3, 0
  s_cbranch_scc1 L_wk0_0
  s_cmp_eq_u32 s3, 1
  s_cbranch_scc1 L_wk0_1
  s_cmp_eq_u32 s3, 2
  s_cbranch_scc1 L_wk0_2
  s_branch L_wk0_3
L_wk0_end:
  s_mov_b64 vcc, 0
  s_branch L_hot
  .p2align 12
L_hot:
  s_mov_b32 s33, 262144
L_spin_10:
  buffer_load_dword v244, v189, s[4:7], 0 offen sc1
  s_waitcnt vmcnt(0)
  v_subrev_u32 v244, s100, v244
  v_cmp_lt_u32 s[68:69], 7, v244
  s_nop 1
  s_cmp_eq_u64 s[68:69], 0
  s_cbranch_scc1 L_ok_11
  s_sub_u32 s33, s33, 1
  s_cmp_lg_u32 s33, 0
  s_cbranch_scc1 L_spin_10
L_ok_11:
  s_mov_b32 s40, 1048576
  buffer_load_dwordx4 v[112:115], v188, s[4:7], s40 offen sc1
  buffer_load_dwordx4 a[0:3], v187, s[4:7], s40 offen offset:0 sc1
  buffer_load_dwordx4 a[4:7], v187, s[4:7], s40 offen offset:1024 sc1
  s_mov_b32 s40, 1179648
  buffer_load_dwordx4 a[8:11], v187, s[4:7], s40 offen offset:0 sc1
  buffer_load_dwordx4 a[12:15], v187, s[4:7], s40 offen offset:1024 sc1
  s_mov_b32 s40, 1310720
  buffer_load_dwordx4 v[116:119], v188, s[4:7], s40 offen sc1
  buffer_load_dwordx4 a[16:19], v187, s[4:7], s40 offen offset:0 sc1
  buffer_load_dwordx4 a[20:23], v187, s[4:7], s40 offen offset:1024 sc1
  s_mov_b32 s40, 1441792
  buffer_load_dwordx4 a[24:27], v187, s[4:7], s40 offen offset:0 sc1
  buffer_load_dwordx4 a[28:31], v187, s[4:7], s40 offen offset:1024 sc1
  s_barrier
  ds_read_b64_tr_b16 a[192:193], v182 offset:12288
  ds_read_b64_tr_b16 a[194:195], v182 offset:13312
  ds_read_b64_tr_b16 a[196:197], v182 offset:20480
  ds_read_b64_tr_b16 a[198:199], v182 offset:21504
  ds_read_b64_tr_b16 a[200:201], v176 offset:12288
  ds_read_b64_tr_b16 a[202:203], v176 offset:13312
  ds_read_b64_tr_b16 a[204:205], v176 offset:14336
  ds_read_b64_tr_b16 a[206:207], v176 offset:15360
  ds_read_b64_tr_b16 a[208:209], v177 offset:12288
  ds_read_b64_tr_b16 a[210:211], v177 offset:13312
  ds_read_b64_tr_b16 a[212:213], v177 offset:14336
  ds_read_b64_tr_b16 a[214:215], v177 offset:15360
  ds_read_b64_tr_b16 a[216:217], v176 offset:20480
  ds_read_b64_tr_b16 a[218:219], v176 offset:21504
  ds_read_b64_tr_b16 a[220:221], v176 offset:22528
  ds_read_b64_tr_b16 a[222:223], v176 offset:23552
  ds_read_b64_tr_b16 a[224:225], v177 offset:20480
  ds_read_b64_tr_b16 a[226:227], v177 offset:21504
  ds_read_b64_tr_b16 a[228:229], v177 offset:22528
  ds_read_b64_tr_b16 a[230:231], v177 offset:23552
  ds_read_b64_tr_b16 a[232:233], v176 offset:28672
  ds_read_b64_tr_b16 a[234:235], v176 offset:29696
  s_mov_b32 s40, 1572864
  buffer_load_dword v244, v189, s[4:7], 0 offen sc1
  s_waitcnt vmcnt(6) lgkmcnt(13)
  v_mfma_f32_16x16x32_bf16 v[96:99], a[192:195], v[112:115], 0
  ds_read_b64_tr_b16 a[192:193], v176 offset:30720
  ds_read_b64_tr_b16 a[194:195], v176 offset:31744
  v_mfma_f32_16x16x32_bf16 v[100:103], v[112:115], a[196:199], 0
  buffer_load_dwordx4 v[120:123], v188, s[4:7], s40 offen sc1
  v_mfma_f32_16x16x32_bf16 v[8:11], a[200:203], a[0:3], 0
  ds_read_b64_tr_b16 a[196:197], v177 offset:28672
  ds_read_b64_tr_b16 a[198:199], v177 offset:29696
  v_mfma_f32_16x16x32_bf16 v[8:11], a[204:207], a[8:11], v[8:11]
  v_mfma_f32_16x16x32_bf16 v[32:35], a[200:203], a[4:7], 0
  buffer_load_dwordx4 a[32:35], v187, s[4:7], s40 offen offset:0 sc1
  v_mfma_f32_16x16x32_bf16 v[32:35], a[204:207], a[12:15], v[32:35]
  ds_read_b64_tr_b16 a[200:201], v177 offset:30720
  ds_read_b64_tr_b16 a[202:203], v177 offset:31744
  s_waitcnt lgkmcnt(13)
  v_mfma_f32_16x16x32_bf16 v[12:15], a[208:211], a[0:3], 0
  ds_read_b64_tr_b16 a[204:205], v182 offset:16384
  ds_read_b64_tr_b16 a[206:207], v182 offset:17408
  v_mfma_f32_16x16x32_bf16 v[12:15], a[212:215], a[8:11], v[12:15]
  v_mfma_f32_16x16x32_bf16 v[36:39], a[208:211], a[4:7], 0
  buffer_load_dwordx4 a[36:39], v187, s[4:7], s40 offen offset:1024 sc1
  s_mov_b32 s40, 1703936
  v_mfma_f32_16x16x32_bf16 v[36:39], a[212:215], a[12:15], v[36:39]
  ds_read_b64_tr_b16 a[208:209], v182 offset:24576
  ds_read_b64_tr_b16 a[210:211], v182 offset:25600
  v_mfma_f32_16x16x32_bf16 v[16:19], a[0:3], a[216:219], 0
  ds_read_b64_tr_b16 a[212:213], v176 offset:16384
  ds_read_b64_tr_b16 a[214:215], v176 offset:17408
  s_waitcnt lgkmcnt(13)
  v_mfma_f32_16x16x32_bf16 v[16:19], a[8:11], a[220:223], v[16:19]
  v_mfma_f32_16x16x32_bf16 v[40:43], a[4:7], a[216:219], 0
  buffer_load_dwordx4 a[40:43], v187, s[4:7], s40 offen offset:0 sc1
  v_mfma_f32_16x16x32_bf16 v[40:43], a[12:15], a[220:223], v[40:43]
  ds_read_b64_tr_b16 a[216:217], v176 offset:18432
  ds_read_b64_tr_b16 a[218:219], v176 offset:19456
  v_mfma_f32_16x16x32_bf16 v[20:23], a[0:3], a[224:227], 0
  ds_read_b64_tr_b16 a[220:221], v177 offset:16384
  ds_read_b64_tr_b16 a[222:223], v177 offset:17408
  v_mfma_f32_16x16x32_bf16 v[20:23], a[8:11], a[228:231], v[20:23]
  v_mfma_f32_16x16x32_bf16 v[44:47], a[4:7], a[224:227], 0
  buffer_load_dwordx4 a[44:47], v187, s[4:7], s40 offen offset:1024 sc1
  v_mfma_f32_16x16x32_bf16 v[44:47], a[12:15], a[228:231], v[44:47]
  ds_read_b64_tr_b16 a[224:225], v177 offset:18432
  ds_read_b64_tr_b16 a[226:227], v177 offset:19456
  s_mov_b32 s40, 1835008
  s_waitcnt lgkmcnt(13)
  v_mfma_f32_16x16x32_bf16 v[0:3], a[232:235], a[0:3], 0
  ds_read_b64_tr_b16 a[228:229], v176 offset:24576
  ds_read_b64_tr_b16 a[230:231], v176 offset:25600
  v_mfma_f32_16x16x32_bf16 v[0:3], a[192:195], a[8:11], v[0:3]
  v_mfma_f32_16x16x32_bf16 v[24:27], a[232:235], a[4:7], 0
  buffer_load_dwordx4 v[124:127], v188, s[4:7], s40 offen sc1
  v_mfma_f32_16x16x32_bf16 v[24:27], a[192:195], a[12:15], v[24:27]
  ds_read_b64_tr_b16 a[232:233], v176 offset:26624
  ds_read_b64_tr_b16 a[234:235], v176 offset:27648
  v_mfma_f32_16x16x32_bf16 v[4:7], a[196:199], a[0:3], 0
  ds_read_b64_tr_b16 a[192:193], v177 offset:24576
  ds_read_b64_tr_b16 a[194:195], v177 offset:25600
  s_waitcnt lgkmcnt(13)
  v_mfma_f32_16x16x32_bf16 v[4:7], a[200:203], a[8:11], v[4:7]
  v_mfma_f32_16x16x32_bf16 v[28:31], a[196:199], a[4:7], 0
  buffer_load_dwordx4 a[48:51], v187, s[4:7], s40 offen offset:0 sc1
  v_mfma_f32_16x16x32_bf16 v[28:31], a[200:203], a[12:15], v[28:31]
  s_barrier
  ds_read_b64_tr_b16 a[196:197], v177 offset:26624
  v_mfma_f32_16x16x32_bf16 v[104:107], a[204:207], v[112:115], 0
  ds_read_b64_tr_b16 a[198:199], v177 offset:27648
  ds_read_b64_tr_b16 a[200:201], v176 offset:32768
  v_mfma_f32_16x16x32_bf16 v[108:111], v[112:115], a[208:211], 0
  ds_read_b64_tr_b16 a[202:203], v176 offset:33792
  ds_read_b64_tr_b16 a[204:205], v176 offset:34816
  s_waitcnt vmcnt(7)
  v_subrev_u32 v244, s100, v244
  v_subrev_u32 v244, 1, v244
  s_waitcnt lgkmcnt(13)
  v_mfma_f32_16x16x32_bf16 v[56:59], a[212:215], a[0:3], 0
  buffer_load_dwordx4 a[52:55], v187, s[4:7], s40 offen offset:1024 sc1
  s_mov_b32 s40, 1966080
  v_cmp_lt_u32 s[68:69], 6, v244
  v_mfma_f32_16x16x32_bf16 v[56:59], a[216:219], a[8:11], v[56:59]
  ds_read_b64_tr_b16 a[206:207], v176 offset:35840
  ds_read_b64_tr_b16 a[208:209], v177 offset:32768
  s_cmp_lg_u64 s[68:69], 0
  s_cbranch_scc1 L_slow_12
L_back_13:
  v_mfma_f32_16x16x32_bf16 v[80:83], a[212:215], a[4:7], 0
  ds_read_b64_tr_b16 a[210:211], v177 offset:33792
  ds_read_b64_tr_b16 a[212:213], v177 offset:34816
  s_load_dwordx2 s[66:67], s[36:37], 0x0
  v_mfma_f32_16x16x32_bf16 v[80:83], a[216:219], a[12:15], v[80:83]
  ds_read_b64_tr_b16 a[214:215], v177 offset:35840
  ds_read_b64_tr_b16 a[216:217], v182 offset:36864
  v_mfma_f32_16x16x32_bf16 v[60:63], a[220:223], a[0:3], 0
  buffer_load_dwordx4 a[56:59], v187, s[4:7], s40 offen offset:0 sc1
  s_waitcnt lgkmcnt(13)
  v_mfma_f32_16x16x32_bf16 v[60:63], a[224:227], a[8:11], v[60:63]
  ds_read_b64_tr_b16 a[218:219], v182 offset:37888
  v_mfma_f32_16x16x32_bf16 v[84:87], a[220:223], a[4:7], 0
  ds_read_b64_tr_b16 a[220:221], v182 offset:45056
  ds_read_b64_tr_b16 a[222:223], v182 offset:46080
  v_mfma_f32_16x16x32_bf16 v[84:87], a[224:227], a[12:15], v[84:87]
  ds_read_b64_tr_b16 a[224:225], v176 offset:36864
  ds_read_b64_tr_b16 a[226:227], v176 offset:37888
  v_mfma_f32_16x16x32_bf16 v[64:67], a[0:3], a[228:231], 0
  buffer_load_dwordx4 a[60:63], v187, s[4:7], s40 offen offset:1024 sc1
  v_mfma_f32_16x16x32_bf16 v[64:67], a[8:11], a[232:235], v[64:67]
  s_mov_b32 s40, 2097152
  v_mfma_f32_16x16x32_bf16 v[88:91], a[4:7], a[228:231], 0
  ds_read_b64_tr_b16 a[228:229], v176 offset:38912
  ds_read_b64_tr_b16 a[230:231], v176 offset:39936
  v_mfma_f32_16x16x32_bf16 v[88:91], a[12:15], a[232:235], v[88:91]
  ds_read_b64_tr_b16 a[232:233], v177 offset:36864
  ds_read_b64_tr_b16 a[234:235], v177 offset:37888
  s_waitcnt lgkmcnt(13)
  v_mfma_f32_16x16x32_bf16 v[68:71], a[0:3], a[192:195], 0
  buffer_load_dwordx4 v[128:131], v188, s[4:7], s40 offen sc1
  v_mfma_f32_16x16x32_bf16 v[68:71], a[8:11], a[196:199], v[68:71]
  v_mfma_f32_16x16x32_bf16 v[92:95], a[4:7], a[192:195], 0
  ds_read_b64_tr_b16 a[192:193], v177 offset:38912
  ds_read_b64_tr_b16 a[194:195], v177 offset:39936
  v_mfma_f32_16x16x32_bf16 v[92:95], a[12:15], a[196:199], v[92:95]
  ds_read_b64_tr_b16 a[196:197], v176 offset:45056
  ds_read_b64_tr_b16 a[198:199], v176 offset:46080
  v_mfma_f32_16x16x32_bf16 v[48:51], a[200:203], a[0:3], 0
  buffer_load_dwordx4 a[64:67], v187, s[4:7], s40 offen offset:0 sc1
  v_mfma_f32_16x16x32_bf16 v[48:51], a[204:207], a[8:11], v[48:51]
  v_mfma_f32_16x16x32_bf16 v[72:75], a[200:203], a[4:7], 0
  ds_read_b64_tr_b16 a[200:201], v176 offset:47104
  ds_read_b64_tr_b16 a[202:203], v176 offset:48128
  v_mfma_f32_16x16x32_bf16 v[72:75], a[204:207], a[12:15], v[72:75]
  ds_read_b64_tr_b16 a[204:205], v177 offset:45056
  ds_read_b64_tr_b16 a[206:207], v177 offset:46080
  s_load_dwordx2 s[66:67], s[36:37], 0x20000
  s_waitcnt lgkmcnt(13)
  v_mfma_f32_16x16x32_bf16 v[52:55], a[208:211], a[0:3], 0
  buffer_load_dwordx4 a[68:71], v187, s[4:7], s40 offen offset:1024 sc1
  s_mov_b32 s40, 2228224
  v_mfma_f32_16x16x32_bf16 v[52:55], a[212:215], a[8:11], v[52:55]
  v_mfma_f32_16x16x32_bf16 v[76:79], a[208:211], a[4:7], 0
  ds_read_b64_tr_b16 a[208:209], v177 offset:47104
  ds_read_b64_tr_b16 a[210:211], v177 offset:48128
  v_mfma_f32_16x16x32_bf16 v[76:79], a[212:215], a[12:15], v[76:79]
  s_barrier
  ds_read_b64_tr_b16 a[212:213], v176 offset:53248
  v_mfma_f32_16x16x32_bf16 v[96:99], a[216:219], v[116:119], v[96:99]
  buffer_load_dwordx4 a[72:75], v187, s[4:7], s40 offen offset:0 sc1
  v_mfma_f32_16x16x32_bf16 v[100:103], v[116:119], a[220:223], v[100:103]
  ds_read_b64_tr_b16 a[214:215], v176 offset:54272
  ds_read_b64_tr_b16 a[216:217], v176 offset:55296
  s_waitcnt lgkmcnt(13)
  v_mfma_f32_16x16x32_bf16 v[8:11], a[224:227], a[16:19], v[8:11]
  ds_read_b64_tr_b16 a[218:219], v176 offset:56320
  ds_read_b64_tr_b16 a[220:221], v177 offset:53248
  v_mfma_f32_16x16x32_bf16 v[8:11], a[228:231], a[24:27], v[8:11]
  ds_read_b64_tr_b16 a[222:223], v177 offset:54272
  v_mfma_f32_16x16x32_bf16 v[32:35], a[224:227], a[20:23], v[32:35]
  buffer_load_dwordx4 a[76:79], v187, s[4:7], s40 offen offset:1024 sc1
  v_mfma_f32_16x16x32_bf16 v[32:35], a[228:231], a[28:31], v[32:35]
  ds_read_b64_tr_b16 a[224:225], v177 offset:55296
  ds_read_b64_tr_b16 a[226:227], v177 offset:56320
  s_mov_b32 s40, 2359296
  v_mfma_f32_16x16x32_bf16 v[12:15], a[232:235], a[16:19], v[12:15]
  ds_read_b64_tr_b16 a[228:229], v182 offset:40960
  ds_read_b64_tr_b16 a[230:231], v182 offset:41984
  s_waitcnt lgkmcnt(13)
  v_mfma_f32_16x16x32_bf16 v[12:15], a[192:195], a[24:27], v[12:15]
  v_mfma_f32_16x16x32_bf16 v[36:39], a[232:235], a[20:23], v[36:39]
  buffer_load_dwordx4 v[132:135], v188, s[4:7], s40 offen sc1
  v_mfma_f32_16x16x32_bf16 v[36:39], a[192:195], a[28:31], v[36:39]
  ds_read_b64_tr_b16 a[232:233], v182 offset:49152
  ds_read_b64_tr_b16 a[234:235], v182 offset:50176
  v_mfma_f32_16x16x32_bf16 v[16:19], a[16:19], a[196:199], v[16:19]
  ds_read_b64_tr_b16 a[192:193], v176 offset:40960
  ds_read_b64_tr_b16 a[194:195], v176 offset:41984
  v_mfma_f32_16x16x32_bf16 v[16:19], a[24:27], a[200:203], v[16:19]
  v_mfma_f32_16x16x32_bf16 v[40:43], a[20:23], a[196:199], v[40:43]
  buffer_load_dwordx4 a[80:83], v187, s[4:7], s40 offen offset:0 sc1
  s_load_dwordx2 s[66:67], s[36:37], 0x40000
  v_mfma_f32_16x16x32_bf16 v[40:43], a[28:31], a[200:203], v[40:43]
  ds_read_b64_tr_b16 a[196:197], v176 offset:43008
  ds_read_b64_tr_b16 a[198:199], v176 offset:44032
  s_waitcnt lgkmcnt(13)
  v_mfma_f32_16x16x32_bf16 v[20:23], a[16:19], a[204:207], v[20:23]
  ds_read_b64_tr_b16 a[200:201], v177 offset:40960
  ds_read_b64_tr_b16 a[202:203], v177 offset:41984
  v_mfma_f32_16x16x32_bf16 v[20:23], a[24:27], a[208:211], v[20:23]
  v_mfma_f32_16x16x32_bf16 v[44:47], a[20:23], a[204:207], v[44:47]
  buffer_load_dwordx4 a[84:87], v187, s[4:7], s40 offen offset:1024 sc1
  s_mov_b32 s40, 2490368
  v_mfma_f32_16x16x32_bf16 v[44:47], a[28:31], a[208:211], v[44:47]
  ds_read_b64_tr_b16 a[204:205], v177 offset:43008
  ds_read_b64_tr_b16 a[206:207], v177 offset:44032
  v_mfma_f32_16x16x32_bf16 v[0:3], a[212:215], a[16:19], v[0:3]
  ds_read_b64_tr_b16 a[208:209], v176 offset:49152
  ds_read_b64_tr_b16 a[210:211], v176 offset:50176
  s_waitcnt lgkmcnt(13)
  v_mfma_f32_16x16x32_bf16 v[0:3], a[216:219], a[24:27], v[0:3]
  v_mfma_f32_16x16x32_bf16 v[24:27], a[212:215], a[20:23], v[24:27]
  buffer_load_dwordx4 a[88:91], v187, s[4:7], s40 offen offset:0 sc1
  v_mfma_f32_16x16x32_bf16 v[24:27], a[216:219], a[28:31], v[24:27]
  ds_read_b64_tr_b16 a[212:213], v176 offset:51200
  ds_read_b64_tr_b16 a[214:215], v176 offset:52224
  v_mfma_f32_16x16x32_bf16 v[4:7], a[220:223], a[16:19], v[4:7]
  ds_read_b64_tr_b16 a[216:217], v177 offset:49152
  ds_read_b64_tr_b16 a[218:219], v177 offset:50176
  v_mfma_f32_16x16x32_bf16 v[4:7], a[224:227], a[24:27], v[4:7]
  v_mfma_f32_16x16x32_bf16 v[28:31], a[220:223], a[20:23], v[28:31]
  buffer_load_dwordx4 a[92:95], v187, s[4:7], s40 offen offset:1024 sc1
  v_mfma_f32_16x16x32_bf16 v[28:31], a[224:227], a[28:31], v[28:31]
  s_barrier
  ds_read_b64_tr_b16 a[220:221], v177 offset:51200
  s_waitcnt lgkmcnt(13)
  v_mfma_f32_16x16x32_bf16 v[104:107], a[228:231], v[116:119], v[104:107]
  ds_read_b64_tr_b16 a[222:223], v177 offset:52224
  ds_read_b64_tr_b16 a[224:225], v176 offset:57344
  s_mov_b32 s41, 2359296
  v_mfma_f32_16x16x32_bf16 v[108:111], v[116:119], a[232:235], v[108:111]
  ds_read_b64_tr_b16 a[226:227], v176 offset:58368
  ds_read_b64_tr_b16 a[228:229], v176 offset:59392
  s_add_u32 m0, s42, 157696
  v_mfma_f32_16x16x32_bf16 v[56:59], a[192:195], a[16:19], v[56:59]
  buffer_load_dwordx4 v185, s[80:83], s41 offen offset:2048 lds
  s_add_u32 m0, s42, 10176
  s_waitcnt lgkmcnt(13)
  v_mfma_f32_16x16x32_bf16 v[56:59], a[196:199], a[24:27], v[56:59]
  ds_read_b64_tr_b16 a[230:231], v176 offset:60416
  ds_read_b64_tr_b16 a[232:233], v177 offset:57344
  s_load_dwordx2 s[66:67], s[36:37], 0x60000
  v_mfma_f32_16x16x32_bf16 v[80:83], a[192:195], a[20:23], v[80:83]
  ds_read_b64_tr_b16 a[234:235], v177 offset:58368
  ds_read_b64_tr_b16 a[192:193], v177 offset:59392
  v_mfma_f32_16x16x32_bf16 v[80:83], a[196:199], a[28:31], v[80:83]
  ds_read_b64_tr_b16 a[194:195], v177 offset:60416
  ds_read_b64_tr_b16 a[196:197], v182 offset:61440
  v_mfma_f32_16x16x32_bf16 v[60:63], a[200:203], a[16:19], v[60:63]
  buffer_load_dwordx4 v185, s[80:83], s41 offen offset:2112 lds
  s_waitcnt lgkmcnt(13)
  v_mfma_f32_16x16x32_bf16 v[60:63], a[204:207], a[24:27], v[60:63]
  ds_read_b64_tr_b16 a[198:199], v182 offset:62464
  s_add_u32 m0, s42, 20480
  v_mfma_f32_16x16x32_bf16 v[84:87], a[200:203], a[20:23], v[84:87]
  ds_read_b64_tr_b16 a[200:201], v183 offset:4096
  ds_read_b64_tr_b16 a[202:203], v183 offset:5120
  v_mfma_f32_16x16x32_bf16 v[84:87], a[204:207], a[28:31], v[84:87]
  ds_read_b64_tr_b16 a[204:205], v176 offset:61440
  ds_read_b64_tr_b16 a[206:207], v176 offset:62464
  v_mfma_f32_16x16x32_bf16 v[64:67], a[16:19], a[208:211], v[64:67]
  buffer_load_dwordx4 v186, s[80:83], s41 offen offset:0 lds
  s_add_u32 m0, s42, 28608
  v_mfma_f32_16x16x32_bf16 v[64:67], a[24:27], a[212:215], v[64:67]
  v_mfma_f32_16x16x32_bf16 v[88:91], a[20:23], a[208:211], v[88:91]
  ds_read_b64_tr_b16 a[208:209], v176 offset:63488
  ds_read_b64_tr_b16 a[210:211], v176 offset:64512
  v_mfma_f32_16x16x32_bf16 v[88:91], a[28:31], a[212:215], v[88:91]
  ds_read_b64_tr_b16 a[212:213], v177 offset:61440
  ds_read_b64_tr_b16 a[214:215], v177 offset:62464
  s_waitcnt lgkmcnt(13)
  v_mfma_f32_16x16x32_bf16 v[68:71], a[16:19], a[216:219], v[68:71]
  buffer_load_dwordx4 v186, s[80:83], s41 offen offset:64 lds
  v_mfma_f32_16x16x32_bf16 v[68:71], a[24:27], a[220:223], v[68:71]
  s_add_u32 m0, s42, 16384
  v_mfma_f32_16x16x32_bf16 v[92:95], a[20:23], a[216:219], v[92:95]
  ds_read_b64_tr_b16 a[216:217], v177 offset:63488
  ds_read_b64_tr_b16 a[218:219], v177 offset:64512
  v_mfma_f32_16x16x32_bf16 v[92:95], a[28:31], a[220:223], v[92:95]
  ds_read_b64_tr_b16 a[220:221], v178 offset:4096
  ds_read_b64_tr_b16 a[222:223], v178 offset:5120
  v_mfma_f32_16x16x32_bf16 v[48:51], a[224:227], a[16:19], v[48:51]
  buffer_load_dwordx4 v185, s[80:83], s41 offen offset:0 lds
  s_add_u32 m0, s42, 24512
  v_mfma_f32_16x16x32_bf16 v[48:51], a[228:231], a[24:27], v[48:51]
  v_mfma_f32_16x16x32_bf16 v[72:75], a[224:227], a[20:23], v[72:75]
  ds_read_b64_tr_b16 a[224:225], v178 offset:6144
  ds_read_b64_tr_b16 a[226:227], v178 offset:7168
  s_load_dwordx2 s[66:67], s[36:37], 0x80000
  v_mfma_f32_16x16x32_bf16 v[72:75], a[228:231], a[28:31], v[72:75]
  ds_read_b64_tr_b16 a[228:229], v179 offset:4096
  ds_read_b64_tr_b16 a[230:231], v179 offset:5120
  s_waitcnt lgkmcnt(13)
  v_mfma_f32_16x16x32_bf16 v[52:55], a[232:235], a[16:19], v[52:55]
  buffer_load_dwordx4 v185, s[80:83], s41 offen offset:64 lds
  v_mfma_f32_16x16x32_bf16 v[52:55], a[192:195], a[24:27], v[52:55]
  s_mov_b32 s40, 2621440
  v_mfma_f32_16x16x32_bf16 v[76:79], a[232:235], a[20:23], v[76:79]
  ds_read_b64_tr_b16 a[232:233], v179 offset:6144
  ds_read_b64_tr_b16 a[234:235], v179 offset:7168
  v_mfma_f32_16x16x32_bf16 v[76:79], a[192:195], a[28:31], v[76:79]
  s_barrier
  ds_read_b64_tr_b16 a[192:193], v178 offset:12288
  s_waitcnt vmcnt(21)
  v_mfma_f32_16x16x32_bf16 v[96:99], a[196:199], v[120:123], v[96:99]
  buffer_load_dwordx4 v[136:139], v188, s[4:7], s40 offen sc1
  v_mfma_f32_16x16x32_bf16 v[100:103], v[120:123], a[200:203], v[100:103]
  ds_read_b64_tr_b16 a[194:195], v178 offset:13312
  ds_read_b64_tr_b16 a[196:197], v178 offset:14336
  s_waitcnt lgkmcnt(13)
  v_mfma_f32_16x16x32_bf16 v[8:11], a[204:207], a[32:35], v[8:11]
  ds_read_b64_tr_b16 a[198:199], v178 offset:15360
  ds_read_b64_tr_b16 a[200:201], v179 offset:12288
  v_mfma_f32_16x16x32_bf16 v[8:11], a[208:211], a[40:43], v[8:11]
  ds_read_b64_tr_b16 a[202:203], v179 offset:13312
  v_mfma_f32_16x16x32_bf16 v[32:35], a[204:207], a[36:39], v[32:35]
  buffer_load_dwordx4 a[96:99], v187, s[4:7], s40 offen offset:0 sc1
  v_mfma_f32_16x16x32_bf16 v[32:35], a[208:211], a[44:47], v[32:35]
  ds_read_b64_tr_b16 a[204:205], v179 offset:14336
  ds_read_b64_tr_b16 a[206:207], v179 offset:15360
  v_mfma_f32_16x16x32_bf16 v[12:15], a[212:215], a[32:35], v[12:15]
  ds_read_b64_tr_b16 a[208:209], v183 offset:0
  ds_read_b64_tr_b16 a[210:211], v183 offset:1024
  s_waitcnt lgkmcnt(13)
  v_mfma_f32_16x16x32_bf16 v[12:15], a[216:219], a[40:43], v[12:15]
  v_mfma_f32_16x16x32_bf16 v[36:39], a[212:215], a[36:39], v[36:39]
  buffer_load_dwordx4 a[100:103], v187, s[4:7], s40 offen offset:1024 sc1
  s_mov_b32 s40, 2752512
  v_mfma_f32_16x16x32_bf16 v[36:39], a[216:219], a[44:47], v[36:39]
  ds_read_b64_tr_b16 a[212:213], v183 offset:8192
  ds_read_b64_tr_b16 a[214:215], v183 offset:9216
  v_mfma_f32_16x16x32_bf16 v[16:19], a[32:35], a[220:223], v[16:19]
  ds_read_b64_tr_b16 a[216:217], v178 offset:0
  ds_read_b64_tr_b16 a[218:219], v178 offset:1024
  v_mfma_f32_16x16x32_bf16 v[16:19], a[40:43], a[224:227], v[16:19]
  s_load_dwordx2 s[66:67], s[36:37], 0xa0000
  v_mfma_f32_16x16x32_bf16 v[40:43], a[36:39], a[220:223], v[40:43]
  buffer_load_dwordx4 a[104:107], v187, s[4:7], s40 offen offset:0 sc1
  v_mfma_f32_16x16x32_bf16 v[40:43], a[44:47], a[224:227], v[40:43]
  ds_read_b64_tr_b16 a[220:221], v178 offset:2048
  ds_read_b64_tr_b16 a[222:223], v178 offset:3072
  s_waitcnt lgkmcnt(13)
  v_mfma_f32_16x16x32_bf16 v[20:23], a[32:35], a[228:231], v[20:23]
  ds_read_b64_tr_b16 a[224:225], v179 offset:0
  ds_read_b64_tr_b16 a[226:227], v179 offset:1024
  v_mfma_f32_16x16x32_bf16 v[20:23], a[40:43], a[232:235], v[20:23]
  v_mfma_f32_16x16x32_bf16 v[44:47], a[36:39], a[228:231], v[44:47]
  buffer_load_dwordx4 a[108:111], v187, s[4:7], s40 offen offset:1024 sc1
  v_mfma_f32_16x16x32_bf16 v[44:47], a[44:47], a[232:235], v[44:47]
  ds_read_b64_tr_b16 a[228:229], v179 offset:2048
  ds_read_b64_tr_b16 a[230:231], v179 offset:3072
  s_mov_b32 s41, 2752512
  v_mfma_f32_16x16x32_bf16 v[0:3], a[192:195], a[32:35], v[0:3]
  ds_read_b64_tr_b16 a[232:233], v178 offset:8192
  ds_read_b64_tr_b16 a[234:235], v178 offset:9216
  s_add_u32 m0, s42, 30720
  s_waitcnt lgkmcnt(13)
  v_mfma_f32_16x16x32_bf16 v[0:3], a[196:199], a[40:43], v[0:3]
  v_mfma_f32_16x16x32_bf16 v[24:27], a[192:195], a[36:39], v[24:27]
  buffer_load_dwordx4 v185, s[80:83], s41 offen offset:2048 lds
  s_add_u32 m0, s42, 34752
  v_mfma_f32_16x16x32_bf16 v[24:27], a[196:199], a[44:47], v[24:27]
  ds_read_b64_tr_b16 a[192:193], v178 offset:10240
  ds_read_b64_tr_b16 a[194:195], v178 offset:11264
  v_mfma_f32_16x16x32_bf16 v[4:7], a[200:203], a[32:35], v[4:7]
  ds_read_b64_tr_b16 a[196:197], v179 offset:8192
  ds_read_b64_tr_b16 a[198:199], v179 offset:9216
  v_mfma_f32_16x16x32_bf16 v[4:7], a[204:207], a[40:43], v[4:7]
  v_mfma_f32_16x16x32_bf16 v[28:31], a[200:203], a[36:39], v[28:31]
  buffer_load_dwordx4 v185, s[80:83], s41 offen offset:2112 lds
  v_mfma_f32_16x16x32_bf16 v[28:31], a[204:207], a[44:47], v[28:31]
  s_barrier
  ds_read_b64_tr_b16 a[200:201], v179 offset:10240
  s_waitcnt lgkmcnt(13)
  v_mfma_f32_16x16x32_bf16 v[104:107], a[208:211], v[120:123], v[104:107]
  ds_read_b64_tr_b16 a[202:203], v179 offset:11264
  ds_read_b64_tr_b16 a[204:205], v178 offset:16384
  s_add_u32 m0, s42, 45056
  v_mfma_f32_16x16x32_bf16 v[108:111], v[120:123], a[212:215], v[108:111]
  ds_read_b64_tr_b16 a[206:207], v178 offset:17408
  ds_read_b64_tr_b16 a[208:209], v178 offset:18432
  v_mfma_f32_16x16x32_bf16 v[56:59], a[216:219], a[32:35], v[56:59]
  buffer_load_dwordx4 v186, s[80:83], s41 offen offset:0 lds
  s_add_u32 m0, s42, 53184
  s_load_dwordx2 s[66:67], s[36:37], 0xc0000
  s_waitcnt lgkmcnt(13)
  v_mfma_f32_16x16x32_bf16 v[56:59], a[220:223], a[40:43], v[56:59]
  ds_read_b64_tr_b16 a[210:211], v178 offset:19456
  ds_read_b64_tr_b16 a[212:213], v179 offset:16384
  v_mfma_f32_16x16x32_bf16 v[80:83], a[216:219], a[36:39], v[80:83]
  ds_read_b64_tr_b16 a[214:215], v179 offset:17408
  ds_read_b64_tr_b16 a[216:217], v179 offset:18432
  v_mfma_f32_16x16x32_bf16 v[80:83], a[220:223], a[44:47], v[80:83]
  ds_read_b64_tr_b16 a[218:219], v179 offset:19456
  ds_read_b64_tr_b16 a[220:221], v183 offset:20480
  v_mfma_f32_16x16x32_bf16 v[60:63], a[224:227], a[32:35], v[60:63]
  buffer_load_dwordx4 v186, s[80:83], s41 offen offset:64 lds
  s_waitcnt lgkmcnt(13)
  v_mfma_f32_16x16x32_bf16 v[60:63], a[228:231], a[40:43], v[60:63]
  ds_read_b64_tr_b16 a[222:223], v183 offset:21504
  s_add_u32 m0, s42, 40960
  v_mfma_f32_16x16x32_bf16 v[84:87], a[224:227], a[36:39], v[84:87]
  ds_read_b64_tr_b16 a[224:225], v183 offset:28672
  ds_read_b64_tr_b16 a[226:227], v183 offset:29696
  v_mfma_f32_16x16x32_bf16 v[84:87], a[228:231], a[44:47], v[84:87]
  ds_read_b64_tr_b16 a[228:229], v178 offset:20480
  ds_read_b64_tr_b16 a[230:231], v178 offset:21504
  v_mfma_f32_16x16x32_bf16 v[64:67], a[32:35], a[232:235], v[64:67]
  buffer_load_dwordx4 v185, s[80:83], s41 offen offset:0 lds
  s_add_u32 m0, s42, 49088
  v_mfma_f32_16x16x32_bf16 v[64:67], a[40:43], a[192:195], v[64:67]
  v_mfma_f32_16x16x32_bf16 v[88:91], a[36:39], a[232:235], v[88:91]
  ds_read_b64_tr_b16 a[232:233], v178 offset:22528
  ds_read_b64_tr_b16 a[234:235], v178 offset:23552
  v_mfma_f32_16x16x32_bf16 v[88:91], a[44:47], a[192:195], v[88:91]
  ds_read_b64_tr_b16 a[192:193], v179 offset:20480
  ds_read_b64_tr_b16 a[194:195], v179 offset:21504
  s_waitcnt lgkmcnt(13)
  v_mfma_f32_16x16x32_bf16 v[68:71], a[32:35], a[196:199], v[68:71]
  buffer_load_dwordx4 v185, s[80:83], s41 offen offset:64 lds
  v_mfma_f32_16x16x32_bf16 v[68:71], a[40:43], a[200:203], v[68:71]
  s_mov_b32 s40, 2883584
  v_mfma_f32_16x16x32_bf16 v[92:95], a[36:39], a[196:199], v[92:95]
  ds_read_b64_tr_b16 a[196:197], v179 offset:22528
  ds_read_b64_tr_b16 a[198:199], v179 offset:23552
  v_mfma_f32_16x16x32_bf16 v[92:95], a[44:47], a[200:203], v[92:95]
  ds_read_b64_tr_b16 a[200:201], v178 offset:28672
  ds_read_b64_tr_b16 a[202:203], v178 offset:29696
  v_mfma_f32_16x16x32_bf16 v[48:51], a[204:207], a[32:35], v[48:51]
  buffer_load_dwordx4 v[140:143], v188, s[4:7], s40 offen sc1
  v_mfma_f32_16x16x32_bf16 v[48:51], a[208:211], a[40:43], v[48:51]
  s_load_dwordx2 s[66:67], s[36:37], 0xe0000
  s_add_u32 s36, s36, 0x100000
  s_addc_u32 s37, s37, 0
  v_mfma_f32_16x16x32_bf16 v[72:75], a[204:207], a[36:39], v[72:75]
  ds_read_b64_tr_b16 a[204:205], v178 offset:30720
  ds_read_b64_tr_b16 a[206:207], v178 offset:31744
  v_mfma_f32_16x16x32_bf16 v[72:75], a[208:211], a[44:47], v[72:75]
  ds_read_b64_tr_b16 a[208:209], v179 offset:28672
  ds_read_b64_tr_b16 a[210:211], v179 offset:29696
  s_waitcnt lgkmcnt(13)
  v_mfma_f32_16x16x32_bf16 v[52:55], a[212:215], a[32:35], v[52:55]
  buffer_load_dwordx4 a[112:115], v187, s[4:7], s40 offen offset:0 sc1
  v_mfma_f32_16x16x32_bf16 v[52:55], a[216:219], a[40:43], v[52:55]
  v_mfma_f32_16x16x32_bf16 v[76:79], a[212:215], a[36:39], v[76:79]
  ds_read_b64_tr_b16 a[212:213], v179 offset:30720
  ds_read_b64_tr_b16 a[214:215], v179 offset:31744
  v_mfma_f32_16x16x32_bf16 v[76:79], a[216:219], a[44:47], v[76:79]
  s_barrier
  ds_read_b64_tr_b16 a[216:217], v178 offset:36864
  s_waitcnt vmcnt(29)
  v_mfma_f32_16x16x32_bf16 v[96:99], a[220:223], v[124:127], v[96:99]
  buffer_load_dwordx4 a[116:119], v187, s[4:7], s40 offen offset:1024 sc1
  s_mov_b32 s40, 3014656
  v_mfma_f32_16x16x32_bf16 v[100:103], v[124:127], a[224:227], v[100:103]
  ds_read_b64_tr_b16 a[218:219], v178 offset:37888
  ds_read_b64_tr_b16 a[220:221], v178 offset:38912
  s_waitcnt lgkmcnt(13)
  v_mfma_f32_16x16x32_bf16 v[8:11], a[228:231], a[48:51], v[8:11]
  ds_read_b64_tr_b16 a[222:223], v178 offset:39936
  ds_read_b64_tr_b16 a[224:225], v179 offset:36864
  v_mfma_f32_16x16x32_bf16 v[8:11], a[232:235], a[56:59], v[8:11]
  ds_read_b64_tr_b16 a[226:227], v179 offset:37888
  v_mfma_f32_16x16x32_bf16 v[32:35], a[228:231], a[52:55], v[32:35]
  buffer_load_dwordx4 a[120:123], v187, s[4:7], s40 offen offset:0 sc1
  v_mfma_f32_16x16x32_bf16 v[32:35], a[232:235], a[60:63], v[32:35]
  ds_read_b64_tr_b16 a[228:229], v179 offset:38912
  ds_read_b64_tr_b16 a[230:231], v179 offset:39936
  v_mfma_f32_16x16x32_bf16 v[12:15], a[192:195], a[48:51], v[12:15]
  ds_read_b64_tr_b16 a[232:233], v183 offset:24576
  ds_read_b64_tr_b16 a[234:235], v183 offset:25600
  s_waitcnt lgkmcnt(13)
  v_mfma_f32_16x16x32_bf16 v[12:15], a[196:199], a[56:59], v[12:15]
  v_mfma_f32_16x16x32_bf16 v[36:39], a[192:195], a[52:55], v[36:39]
  buffer_load_dwordx4 a[124:127], v187, s[4:7], s40 offen offset:1024 sc1
  v_mfma_f32_16x16x32_bf16 v[36:39], a[196:199], a[60:63], v[36:39]
  ds_read_b64_tr_b16 a[192:193], v183 offset:32768
  ds_read_b64_tr_b16 a[194:195], v183 offset:33792
  s_mov_b32 s41, 3145728
  v_mfma_f32_16x16x32_bf16 v[16:19], a[48:51], a[200:203], v[16:19]
  ds_read_b64_tr_b16 a[196:197], v178 offset:24576
  ds_read_b64_tr_b16 a[198:199], v178 offset:25600
  s_add_u32 m0, s42, 55296
  s_load_dwordx2 s[66:67], s[36:37], 0x0
  v_mfma_f32_16x16x32_bf16 v[16:19], a[56:59], a[204:207], v[16:19]
  v_mfma_f32_16x16x32_bf16 v[40:43], a[52:55], a[200:203], v[40:43]
  buffer_load_dwordx4 v185, s[80:83], s41 offen offset:2048 lds
  s_add_u32 m0, s42, 59328
  v_mfma_f32_16x16x32_bf16 v[40:43], a[60:63], a[204:207], v[40:43]
  ds_read_b64_tr_b16 a[200:201], v178 offset:26624
  ds_read_b64_tr_b16 a[202:203], v178 offset:27648
  s_waitcnt lgkmcnt(13)
  v_mfma_f32_16x16x32_bf16 v[20:23], a[48:51], a[208:211], v[20:23]
  ds_read_b64_tr_b16 a[204:205], v179 offset:24576
  ds_read_b64_tr_b16 a[206:207], v179 offset:25600
  v_mfma_f32_16x16x32_bf16 v[20:23], a[56:59], a[212:215], v[20:23]
  v_mfma_f32_16x16x32_bf16 v[44:47], a[52:55], a[208:211], v[44:47]
  buffer_load_dwordx4 v185, s[80:83], s41 offen offset:2112 lds
  v_mfma_f32_16x16x32_bf16 v[44:47], a[60:63], a[212:215], v[44:47]
  ds_read_b64_tr_b16 a[208:209], v179 offset:26624
  ds_read_b64_tr_b16 a[210:211], v179 offset:27648
  s_add_u32 m0, s42, 69632
  v_mfma_f32_16x16x32_bf16 v[0:3], a[216:219], a[48:51], v[0:3]
L_wk0_0:
  s_cbranch_vccnz L_wk0_4
  ds_read_b64_tr_b16 a[212:213], v178 offset:32768
  ds_read_b64_tr_b16 a[214:215], v178 offset:33792
  s_waitcnt lgkmcnt(13)
  v_mfma_f32_16x16x32_bf16 v[0:3], a[220:223], a[56:59], v[0:3]
  v_mfma_f32_16x16x32_bf16 v[24:27], a[216:219], a[52:55], v[24:27]
  buffer_load_dwordx4 v186, s[80:83], s41 offen offset:0 lds
  s_add_u32 m0, s42, 77760
  v_mfma_f32_16x16x32_bf16 v[24:27], a[220:223], a[60:63], v[24:27]
  ds_read_b64_tr_b16 a[216:217], v178 offset:34816
  ds_read_b64_tr_b16 a[218:219], v178 offset:35840
  v_mfma_f32_16x16x32_bf16 v[4:7], a[224:227], a[48:51], v[4:7]
  ds_read_b64_tr_b16 a[220:221], v179 offset:32768
  ds_read_b64_tr_b16 a[222:223], v179 offset:33792
  v_mfma_f32_16x16x32_bf16 v[4:7], a[228:231], a[56:59], v[4:7]
  v_mfma_f32_16x16x32_bf16 v[28:31], a[224:227], a[52:55], v[28:31]
  buffer_load_dwordx4 v186, s[80:83], s41 offen offset:64 lds
  v_mfma_f32_16x16x32_bf16 v[28:31], a[228:231], a[60:63], v[28:31]
  s_barrier
  ds_read_b64_tr_b16 a[224:225], v179 offset:34816
  s_waitcnt lgkmcnt(13)
  v_mfma_f32_16x16x32_bf16 v[104:107], a[232:235], v[124:127], v[104:107]
  ds_read_b64_tr_b16 a[226:227], v179 offset:35840
  ds_read_b64_tr_b16 a[228:229], v178 offset:40960
  s_add_u32 m0, s42, 65536
  v_mfma_f32_16x16x32_bf16 v[108:111], v[124:127], a[192:195], v[108:111]
  ds_read_b64_tr_b16 a[230:231], v178 offset:41984
  ds_read_b64_tr_b16 a[232:233], v178 offset:43008
  s_load_dwordx2 s[66:67], s[36:37], 0x20000
  v_mfma_f32_16x16x32_bf16 v[56:59], a[196:199], a[48:51], v[56:59]
  buffer_load_dwordx4 v185, s[80:83], s41 offen offset:0 lds
  s_add_u32 m0, s42, 73664
  s_waitcnt lgkmcnt(13)
  v_mfma_f32_16x16x32_bf16 v[56:59], a[200:203], a[56:59], v[56:59]
  ds_read_b64_tr_b16 a[234:235], v178 offset:44032
  ds_read_b64_tr_b16 a[192:193], v179 offset:40960
  v_mfma_f32_16x16x32_bf16 v[80:83], a[196:199], a[52:55], v[80:83]
  ds_read_b64_tr_b16 a[194:195], v179 offset:41984
  ds_read_b64_tr_b16 a[196:197], v179 offset:43008
  v_mfma_f32_16x16x32_bf16 v[80:83], a[200:203], a[60:63], v[80:83]
  ds_read_b64_tr_b16 a[198:199], v179 offset:44032
  ds_read_b64_tr_b16 a[200:201], v183 offset:45056
  v_mfma_f32_16x16x32_bf16 v[60:63], a[204:207], a[48:51], v[60:63]
  buffer_load_dwordx4 v185, s[80:83], s41 offen offset:64 lds
  s_waitcnt lgkmcnt(13)
  v_mfma_f32_16x16x32_bf16 v[60:63], a[208:211], a[56:59], v[60:63]
  ds_read_b64_tr_b16 a[202:203], v183 offset:46080
  s_mov_b32 s41, 3538944
  s_add_u32 m0, s42, 79872
  v_mfma_f32_16x16x32_bf16 v[84:87], a[204:207], a[52:55], v[84:87]
  ds_read_b64_tr_b16 a[204:205], v183 offset:53248
  ds_read_b64_tr_b16 a[206:207], v183 offset:54272
  v_mfma_f32_16x16x32_bf16 v[84:87], a[208:211], a[60:63], v[84:87]
  ds_read_b64_tr_b16 a[208:209], v178 offset:45056
  ds_read_b64_tr_b16 a[210:211], v178 offset:46080
  v_mfma_f32_16x16x32_bf16 v[64:67], a[48:51], a[212:215], v[64:67]
  buffer_load_dwordx4 v185, s[80:83], s41 offen offset:2048 lds
  s_add_u32 m0, s42, 83904
  v_mfma_f32_16x16x32_bf16 v[64:67], a[56:59], a[216:219], v[64:67]
  v_mfma_f32_16x16x32_bf16 v[88:91], a[52:55], a[212:215], v[88:91]
  ds_read_b64_tr_b16 a[212:213], v178 offset:47104
  ds_read_b64_tr_b16 a[214:215], v178 offset:48128
  v_mfma_f32_16x16x32_bf16 v[88:91], a[60:63], a[216:219], v[88:91]
  ds_read_b64_tr_b16 a[216:217], v179 offset:45056
  ds_read_b64_tr_b16 a[218:219], v179 offset:46080
  s_waitcnt lgkmcnt(13)
  v_mfma_f32_16x16x32_bf16 v[68:71], a[48:51], a[220:223], v[68:71]
  buffer_load_dwordx4 v185, s[80:83], s41 offen offset:2112 lds
  v_mfma_f32_16x16x32_bf16 v[68:71], a[56:59], a[224:227], v[68:71]
  s_add_u32 m0, s42, 94208
  v_mfma_f32_16x16x32_bf16 v[92:95], a[52:55], a[220:223], v[92:95]
  ds_read_b64_tr_b16 a[220:221], v179 offset:47104
  ds_read_b64_tr_b16 a[222:223], v179 offset:48128
  v_mfma_f32_16x16x32_bf16 v[92:95], a[60:63], a[224:227], v[92:95]
  ds_read_b64_tr_b16 a[224:225], v178 offset:53248
  ds_read_b64_tr_b16 a[226:227], v178 offset:54272
  v_mfma_f32_16x16x32_bf16 v[48:51], a[228:231], a[48:51], v[48:51]
  buffer_load_dwordx4 v186, s[80:83], s41 offen offset:0 lds
  s_add_u32 m0, s42, 102336
  s_load_dwordx2 s[66:67], s[36:37], 0x40000
  v_mfma_f32_16x16x32_bf16 v[48:51], a[232:235], a[56:59], v[48:51]
  v_mfma_f32_16x16x32_bf16 v[72:75], a[228:231], a[52:55], v[72:75]
  ds_read_b64_tr_b16 a[228:229], v178 offset:55296
  ds_read_b64_tr_b16 a[230:231], v178 offset:56320
  v_mfma_f32_16x16x32_bf16 v[72:75], a[232:235], a[60:63], v[72:75]
  ds_read_b64_tr_b16 a[232:233], v179 offset:53248
  ds_read_b64_tr_b16 a[234:235], v179 offset:54272
  s_waitcnt lgkmcnt(13)
  v_mfma_f32_16x16x32_bf16 v[52:55], a[192:195], a[48:51], v[52:55]
  buffer_load_dwordx4 v186, s[80:83], s41 offen offset:64 lds
  v_mfma_f32_16x16x32_bf16 v[52:55], a[196:199], a[56:59], v[52:55]
  s_mov_b32 s40, 3145728
  v_mfma_f32_16x16x32_bf16 v[76:79], a[192:195], a[52:55], v[76:79]
  ds_read_b64_tr_b16 a[192:193], v179 offset:55296
  ds_read_b64_tr_b16 a[194:195], v179 offset:56320
  v_mfma_f32_16x16x32_bf16 v[76:79], a[196:199], a[60:63], v[76:79]
  s_barrier
  ds_read_b64_tr_b16 a[196:197], v178 offset:61440
  s_waitcnt vmcnt(37)
  v_mfma_f32_16x16x32_bf16 v[96:99], a[200:203], v[128:131], v[96:99]
  buffer_load_dwordx4 v[144:147], v188, s[4:7], s40 offen sc1
  v_mfma_f32_16x16x32_bf16 v[100:103], v[128:131], a[204:207], v[100:103]
  ds_read_b64_tr_b16 a[198:199], v178 offset:62464
  ds_read_b64_tr_b16 a[200:201], v178 offset:63488
  s_waitcnt lgkmcnt(13)
  v_mfma_f32_16x16x32_bf16 v[8:11], a[208:211], a[64:67], v[8:11]
  ds_read_b64_tr_b16 a[202:203], v178 offset:64512
  ds_read_b64_tr_b16 a[204:205], v179 offset:61440
  v_mfma_f32_16x16x32_bf16 v[8:11], a[212:215], a[72:75], v[8:11]
  ds_read_b64_tr_b16 a[206:207], v179 offset:62464
  v_mfma_f32_16x16x32_bf16 v[32:35], a[208:211], a[68:71], v[32:35]
  buffer_load_dwordx4 a[128:131], v187, s[4:7], s40 offen offset:0 sc1
  v_mfma_f32_16x16x32_bf16 v[32:35], a[212:215], a[76:79], v[32:35]
  ds_read_b64_tr_b16 a[208:209], v179 offset:63488
  ds_read_b64_tr_b16 a[210:211], v179 offset:64512
  v_mfma_f32_16x16x32_bf16 v[12:15], a[216:219], a[64:67], v[12:15]
  ds_read_b64_tr_b16 a[212:213], v183 offset:49152
  ds_read_b64_tr_b16 a[214:215], v183 offset:50176
  s_waitcnt lgkmcnt(13)
  v_mfma_f32_16x16x32_bf16 v[12:15], a[220:223], a[72:75], v[12:15]
  v_mfma_f32_16x16x32_bf16 v[36:39], a[216:219], a[68:71], v[36:39]
  buffer_load_dwordx4 a[132:135], v187, s[4:7], s40 offen offset:1024 sc1
  s_mov_b32 s40, 3276800
  v_mfma_f32_16x16x32_bf16 v[36:39], a[220:223], a[76:79], v[36:39]
  ds_read_b64_tr_b16 a[216:217], v183 offset:57344
  ds_read_b64_tr_b16 a[218:219], v183 offset:58368
  s_load_dwordx2 s[66:67], s[36:37], 0x60000
  v_mfma_f32_16x16x32_bf16 v[16:19], a[64:67], a[224:227], v[16:19]
  ds_read_b64_tr_b16 a[220:221], v178 offset:49152
  ds_read_b64_tr_b16 a[222:223], v178 offset:50176
  v_mfma_f32_16x16x32_bf16 v[16:19], a[72:75], a[228:231], v[16:19]
  v_mfma_f32_16x16x32_bf16 v[40:43], a[68:71], a[224:227], v[40:43]
  buffer_load_dwordx4 a[136:139], v187, s[4:7], s40 offen offset:0 sc1
  v_mfma_f32_16x16x32_bf16 v[40:43], a[76:79], a[228:231], v[40:43]
  ds_read_b64_tr_b16 a[224:225], v178 offset:51200
  ds_read_b64_tr_b16 a[226:227], v178 offset:52224
  s_waitcnt lgkmcnt(13)
  v_mfma_f32_16x16x32_bf16 v[20:23], a[64:67], a[232:235], v[20:23]
  ds_read_b64_tr_b16 a[228:229], v179 offset:49152
  ds_read_b64_tr_b16 a[230:231], v179 offset:50176
  v_mfma_f32_16x16x32_bf16 v[20:23], a[72:75], a[192:195], v[20:23]
  v_mfma_f32_16x16x32_bf16 v[44:47], a[68:71], a[232:235], v[44:47]
  buffer_load_dwordx4 a[140:143], v187, s[4:7], s40 offen offset:1024 sc1
  v_mfma_f32_16x16x32_bf16 v[44:47], a[76:79], a[192:195], v[44:47]
  ds_read_b64_tr_b16 a[232:233], v179 offset:51200
  ds_read_b64_tr_b16 a[234:235], v179 offset:52224
  s_add_u32 m0, s42, 90112
  v_mfma_f32_16x16x32_bf16 v[0:3], a[196:199], a[64:67], v[0:3]
  ds_read_b64_tr_b16 a[192:193], v178 offset:57344
  ds_read_b64_tr_b16 a[194:195], v178 offset:58368
  s_waitcnt lgkmcnt(13)
  v_mfma_f32_16x16x32_bf16 v[0:3], a[200:203], a[72:75], v[0:3]
  v_mfma_f32_16x16x32_bf16 v[24:27], a[196:199], a[68:71], v[24:27]
  buffer_load_dwordx4 v185, s[80:83], s41 offen offset:0 lds
  s_add_u32 m0, s42, 98240
  v_mfma_f32_16x16x32_bf16 v[24:27], a[200:203], a[76:79], v[24:27]
  ds_read_b64_tr_b16 a[196:197], v178 offset:59392
  ds_read_b64_tr_b16 a[198:199], v178 offset:60416
  v_mfma_f32_16x16x32_bf16 v[4:7], a[204:207], a[64:67], v[4:7]
  ds_read_b64_tr_b16 a[200:201], v179 offset:57344
  ds_read_b64_tr_b16 a[202:203], v179 offset:58368
  v_mfma_f32_16x16x32_bf16 v[4:7], a[208:211], a[72:75], v[4:7]
  v_mfma_f32_16x16x32_bf16 v[28:31], a[204:207], a[68:71], v[28:31]
  buffer_load_dwordx4 v185, s[80:83], s41 offen offset:64 lds
  v_mfma_f32_16x16x32_bf16 v[28:31], a[208:211], a[76:79], v[28:31]
  s_barrier
  ds_read_b64_tr_b16 a[204:205], v179 offset:59392
  s_waitcnt lgkmcnt(13)
  v_mfma_f32_16x16x32_bf16 v[104:107], a[212:215], v[128:131], v[104:107]
  ds_read_b64_tr_b16 a[206:207], v179 offset:60416
  ds_read_b64_tr_b16 a[208:209], v180 offset:0
  s_mov_b32 s41, 3932160
  s_load_dwordx2 s[66:67], s[36:37], 0x80000
  v_mfma_f32_16x16x32_bf16 v[108:111], v[128:131], a[216:219], v[108:111]
  ds_read_b64_tr_b16 a[210:211], v180 offset:1024
  ds_read_b64_tr_b16 a[212:213], v180 offset:2048
  s_add_u32 m0, s42, 104448
  v_mfma_f32_16x16x32_bf16 v[56:59], a[220:223], a[64:67], v[56:59]
  buffer_load_dwordx4 v185, s[80:83], s41 offen offset:2048 lds
  s_add_u32 m0, s42, 108480
  s_waitcnt lgkmcnt(13)
  v_mfma_f32_16x16x32_bf16 v[56:59], a[224:227], a[72:75], v[56:59]
  ds_read_b64_tr_b16 a[214:215], v180 offset:3072
  ds_read_b64_tr_b16 a[216:217], v181 offset:0
  v_mfma_f32_16x16x32_bf16 v[80:83], a[220:223], a[68:71], v[80:83]
  ds_read_b64_tr_b16 a[218:219], v181 offset:1024
  ds_read_b64_tr_b16 a[220:221], v181 offset:2048
  v_mfma_f32_16x16x32_bf16 v[80:83], a[224:227], a[76:79], v[80:83]
  ds_read_b64_tr_b16 a[222:223], v181 offset:3072
  ds_read_b64_tr_b16 a[224:225], v184 offset:4096
  v_mfma_f32_16x16x32_bf16 v[60:63], a[228:231], a[64:67], v[60:63]
  buffer_load_dwordx4 v185, s[80:83], s41 offen offset:2112 lds
  s_waitcnt lgkmcnt(13)
  v_mfma_f32_16x16x32_bf16 v[60:63], a[232:235], a[72:75], v[60:63]
  ds_read_b64_tr_b16 a[226:227], v184 offset:5120
  s_add_u32 m0, s42, 118784
  v_mfma_f32_16x16x32_bf16 v[84:87], a[228:231], a[68:71], v[84:87]
  ds_read_b64_tr_b16 a[228:229], v184 offset:12288
  ds_read_b64_tr_b16 a[230:231], v184 offset:13312
  v_mfma_f32_16x16x32_bf16 v[84:87], a[232:235], a[76:79], v[84:87]
  ds_read_b64_tr_b16 a[232:233], v180 offset:4096
  ds_read_b64_tr_b16 a[234:235], v180 offset:5120
  v_mfma_f32_16x16x32_bf16 v[64:67], a[64:67], a[192:195], v[64:67]
  buffer_load_dwordx4 v186, s[80:83], s41 offen offset:0 lds
  s_add_u32 m0, s42, 126912
  v_mfma_f32_16x16x32_bf16 v[64:67], a[72:75], a[196:199], v[64:67]
  v_mfma_f32_16x16x32_bf16 v[88:91], a[68:71], a[192:195], v[88:91]
  ds_read_b64_tr_b16 a[192:193], v180 offset:6144
  ds_read_b64_tr_b16 a[194:195], v180 offset:7168
  v_mfma_f32_16x16x32_bf16 v[88:91], a[76:79], a[196:199], v[88:91]
  ds_read_b64_tr_b16 a[196:197], v181 offset:4096
  ds_read_b64_tr_b16 a[198:199], v181 offset:5120
  s_waitcnt lgkmcnt(13)
  v_mfma_f32_16x16x32_bf16 v[68:71], a[64:67], a[200:203], v[68:71]
  buffer_load_dwordx4 v186, s[80:83], s41 offen offset:64 lds
  v_mfma_f32_16x16x32_bf16 v[68:71], a[72:75], a[204:207], v[68:71]
  s_mov_b32 s40, 3407872
  v_mfma_f32_16x16x32_bf16 v[92:95], a[68:71], a[200:203], v[92:95]
  ds_read_b64_tr_b16 a[200:201], v181 offset:6144
  ds_read_b64_tr_b16 a[202:203], v181 offset:7168
  v_mfma_f32_16x16x32_bf16 v[92:95], a[76:79], a[204:207], v[92:95]
  ds_read_b64_tr_b16 a[204:205], v180 offset:12288
  ds_read_b64_tr_b16 a[206:207], v180 offset:13312
  s_load_dwordx2 s[66:67], s[36:37], 0xa0000
  v_mfma_f32_16x16x32_bf16 v[48:51], a[208:211], a[64:67], v[48:51]
  buffer_load_dwordx4 v[148:151], v188, s[4:7], s40 offen sc1
  v_mfma_f32_16x16x32_bf16 v[48:51], a[212:215], a[72:75], v[48:51]
  v_mfma_f32_16x16x32_bf16 v[72:75], a[208:211], a[68:71], v[72:75]
  ds_read_b64_tr_b16 a[208:209], v180 offset:14336
  ds_read_b64_tr_b16 a[210:211], v180 offset:15360
  v_mfma_f32_16x16x32_bf16 v[72:75], a[212:215], a[76:79], v[72:75]
  ds_read_b64_tr_b16 a[212:213], v181 offset:12288
  ds_read_b64_tr_b16 a[214:215], v181 offset:13312
  s_waitcnt lgkmcnt(13)
  v_mfma_f32_16x16x32_bf16 v[52:55], a[216:219], a[64:67], v[52:55]
  buffer_load_dwordx4 a[144:147], v187, s[4:7], s40 offen offset:0 sc1
  v_mfma_f32_16x16x32_bf16 v[52:55], a[220:223], a[72:75], v[52:55]
  v_mfma_f32_16x16x32_bf16 v[76:79], a[216:219], a[68:71], v[76:79]
  ds_read_b64_tr_b16 a[216:217], v181 offset:14336
  ds_read_b64_tr_b16 a[218:219], v181 offset:15360
  v_mfma_f32_16x16x32_bf16 v[76:79], a[220:223], a[76:79], v[76:79]
  s_barrier
  ds_read_b64_tr_b16 a[220:221], v180 offset:20480
  s_waitcnt vmcnt(45)
  v_mfma_f32_16x16x32_bf16 v[96:99], a[224:227], v[132:135], v[96:99]
  buffer_load_dwordx4 a[148:151], v187, s[4:7], s40 offen offset:1024 sc1
  s_mov_b32 s40, 3538944
  v_mfma_f32_16x16x32_bf16 v[100:103], v[132:135], a[228:231], v[100:103]
  ds_read_b64_tr_b16 a[222:223], v180 offset:21504
  ds_read_b64_tr_b16 a[224:225], v180 offset:22528
  s_waitcnt lgkmcnt(13)
  v_mfma_f32_16x16x32_bf16 v[8:11], a[232:235], a[80:83], v[8:11]
  ds_read_b64_tr_b16 a[226:227], v180 offset:23552
  ds_read_b64_tr_b16 a[228:229], v181 offset:20480
  v_mfma_f32_16x16x32_bf16 v[8:11], a[192:195], a[88:91], v[8:11]
  ds_read_b64_tr_b16 a[230:231], v181 offset:21504
  v_mfma_f32_16x16x32_bf16 v[32:35], a[232:235], a[84:87], v[32:35]
  buffer_load_dwordx4 a[152:155], v187, s[4:7], s40 offen offset:0 sc1
  v_mfma_f32_16x16x32_bf16 v[32:35], a[192:195], a[92:95], v[32:35]
  ds_read_b64_tr_b16 a[232:233], v181 offset:22528
  ds_read_b64_tr_b16 a[234:235], v181 offset:23552
  v_mfma_f32_16x16x32_bf16 v[12:15], a[196:199], a[80:83], v[12:15]
  ds_read_b64_tr_b16 a[192:193], v184 offset:8192
  ds_read_b64_tr_b16 a[194:195], v184 offset:9216
  s_waitcnt lgkmcnt(13)
  v_mfma_f32_16x16x32_bf16 v[12:15], a[200:203], a[88:91], v[12:15]
  v_mfma_f32_16x16x32_bf16 v[36:39], a[196:199], a[84:87], v[36:39]
  buffer_load_dwordx4 a[156:159], v187, s[4:7], s40 offen offset:1024 sc1
  s_load_dwordx2 s[66:67], s[36:37], 0xc0000
  v_mfma_f32_16x16x32_bf16 v[36:39], a[200:203], a[92:95], v[36:39]
  ds_read_b64_tr_b16 a[196:197], v184 offset:16384
  ds_read_b64_tr_b16 a[198:199], v184 offset:17408
  s_add_u32 m0, s42, 114688
  v_mfma_f32_16x16x32_bf16 v[16:19], a[80:83], a[204:207], v[16:19]
  ds_read_b64_tr_b16 a[200:201], v180 offset:8192
  ds_read_b64_tr_b16 a[202:203], v180 offset:9216
  v_mfma_f32_16x16x32_bf16 v[16:19], a[88:91], a[208:211], v[16:19]
  v_mfma_f32_16x16x32_bf16 v[40:43], a[84:87], a[204:207], v[40:43]
  buffer_load_dwordx4 v185, s[80:83], s41 offen offset:0 lds
  s_add_u32 m0, s42, 122816
  v_mfma_f32_16x16x32_bf16 v[40:43], a[92:95], a[208:211], v[40:43]
  ds_read_b64_tr_b16 a[204:205], v180 offset:10240
  ds_read_b64_tr_b16 a[206:207], v180 offset:11264
  s_waitcnt lgkmcnt(13)
  v_mfma_f32_16x16x32_bf16 v[20:23], a[80:83], a[212:215], v[20:23]
  ds_read_b64_tr_b16 a[208:209], v181 offset:8192
  ds_read_b64_tr_b16 a[210:211], v181 offset:9216
  v_mfma_f32_16x16x32_bf16 v[20:23], a[88:91], a[216:219], v[20:23]
  v_mfma_f32_16x16x32_bf16 v[44:47], a[84:87], a[212:215], v[44:47]
  buffer_load_dwordx4 v185, s[80:83], s41 offen offset:64 lds
  v_mfma_f32_16x16x32_bf16 v[44:47], a[92:95], a[216:219], v[44:47]
  ds_read_b64_tr_b16 a[212:213], v181 offset:10240
  ds_read_b64_tr_b16 a[214:215], v181 offset:11264
  s_mov_b32 s40, 3670016
  v_mfma_f32_16x16x32_bf16 v[0:3], a[220:223], a[80:83], v[0:3]
  ds_read_b64_tr_b16 a[216:217], v180 offset:16384
  ds_read_b64_tr_b16 a[218:219], v180 offset:17408
  s_waitcnt lgkmcnt(13)
  v_mfma_f32_16x16x32_bf16 v[0:3], a[224:227], a[88:91], v[0:3]
  v_mfma_f32_16x16x32_bf16 v[24:27], a[220:223], a[84:87], v[24:27]
  buffer_load_dwordx4 v[152:155], v188, s[4:7], s40 offen sc1
  v_mfma_f32_16x16x32_bf16 v[24:27], a[224:227], a[92:95], v[24:27]
  ds_read_b64_tr_b16 a[220:221], v180 offset:18432
  ds_read_b64_tr_b16 a[222:223], v180 offset:19456
  v_mfma_f32_16x16x32_bf16 v[4:7], a[228:231], a[80:83], v[4:7]
  ds_read_b64_tr_b16 a[224:225], v181 offset:16384
  ds_read_b64_tr_b16 a[226:227], v181 offset:17408
  v_mfma_f32_16x16x32_bf16 v[4:7], a[232:235], a[88:91], v[4:7]
  v_mfma_f32_16x16x32_bf16 v[28:31], a[228:231], a[84:87], v[28:31]
  buffer_load_dwordx4 a[160:163], v187, s[4:7], s40 offen offset:0 sc1
  v_mfma_f32_16x16x32_bf16 v[28:31], a[232:235], a[92:95], v[28:31]
  s_waitcnt vmcnt(49)
  s_barrier
  ds_read_b64_tr_b16 a[228:229], v181 offset:18432
  s_load_dwordx2 s[66:67], s[36:37], 0xe0000
  s_waitcnt lgkmcnt(13)
  v_mfma_f32_16x16x32_bf16 v[104:107], a[192:195], v[132:135], v[104:107]
  ds_read_b64_tr_b16 a[230:231], v181 offset:19456
  ds_read_b64_tr_b16 a[232:233], v180 offset:24576
  v_mfma_f32_16x16x32_bf16 v[108:111], v[132:135], a[196:199], v[108:111]
  ds_read_b64_tr_b16 a[234:235], v180 offset:25600
  ds_read_b64_tr_b16 a[192:193], v180 offset:26624
  v_mfma_f32_16x16x32_bf16 v[56:59], a[200:203], a[80:83], v[56:59]
  buffer_load_dwordx4 a[164:167], v187, s[4:7], s40 offen offset:1024 sc1
  s_mov_b32 s40, 3801088
  s_waitcnt lgkmcnt(13)
  v_mfma_f32_16x16x32_bf16 v[56:59], a[204:207], a[88:91], v[56:59]
  ds_read_b64_tr_b16 a[194:195], v180 offset:27648
  ds_read_b64_tr_b16 a[196:197], v181 offset:24576
  v_mfma_f32_16x16x32_bf16 v[80:83], a[200:203], a[84:87], v[80:83]
  ds_read_b64_tr_b16 a[198:199], v181 offset:25600
  ds_read_b64_tr_b16 a[200:201], v181 offset:26624
  v_mfma_f32_16x16x32_bf16 v[80:83], a[204:207], a[92:95], v[80:83]
  ds_read_b64_tr_b16 a[202:203], v181 offset:27648
  ds_read_b64_tr_b16 a[204:205], v184 offset:28672
  v_mfma_f32_16x16x32_bf16 v[60:63], a[208:211], a[80:83], v[60:63]
  buffer_load_dwordx4 a[168:171], v187, s[4:7], s40 offen offset:0 sc1
  s_waitcnt lgkmcnt(13)
  v_mfma_f32_16x16x32_bf16 v[60:63], a[212:215], a[88:91], v[60:63]
  ds_read_b64_tr_b16 a[206:207], v184 offset:29696
  s_lshr_b32 s36, s22, 8
  s_lshl_b32 s36, s36, 7
  s_add_u32 s36, s36, 60
  s_add_u32 s36, s36, s56
  s_addc_u32 s37, s57, 0
  v_mfma_f32_16x16x32_bf16 v[84:87], a[208:211], a[84:87], v[84:87]
  ds_read_b64_tr_b16 a[208:209], v182 offset:20480
  ds_read_b64_tr_b16 a[210:211], v182 offset:21504
  v_mfma_f32_16x16x32_bf16 v[84:87], a[212:215], a[92:95], v[84:87]
  ds_read_b64_tr_b16 a[212:213], v180 offset:28672
  ds_read_b64_tr_b16 a[214:215], v180 offset:29696
  v_mfma_f32_16x16x32_bf16 v[64:67], a[80:83], a[216:219], v[64:67]
  buffer_load_dwordx4 a[172:175], v187, s[4:7], s40 offen offset:1024 sc1
  v_mfma_f32_16x16x32_bf16 v[64:67], a[88:91], a[220:223], v[64:67]
  s_mov_b32 s41, 4325376
  s_add_u32 m0, s42, 129024
  v_mfma_f32_16x16x32_bf16 v[88:91], a[84:87], a[216:219], v[88:91]
  ds_read_b64_tr_b16 a[216:217], v180 offset:30720
  ds_read_b64_tr_b16 a[218:219], v180 offset:31744
  v_mfma_f32_16x16x32_bf16 v[88:91], a[92:95], a[220:223], v[88:91]
  ds_read_b64_tr_b16 a[220:221], v181 offset:28672
  ds_read_b64_tr_b16 a[222:223], v181 offset:29696
  s_waitcnt lgkmcnt(13)
  v_mfma_f32_16x16x32_bf16 v[68:71], a[80:83], a[224:227], v[68:71]
  buffer_load_dwordx4 v185, s[80:83], s41 offen offset:2048 lds
  s_add_u32 m0, s42, 133056
  v_mfma_f32_16x16x32_bf16 v[68:71], a[88:91], a[228:231], v[68:71]
  v_mfma_f32_16x16x32_bf16 v[92:95], a[84:87], a[224:227], v[92:95]
  ds_read_b64_tr_b16 a[224:225], v181 offset:30720
  ds_read_b64_tr_b16 a[226:227], v181 offset:31744
  v_mfma_f32_16x16x32_bf16 v[92:95], a[92:95], a[228:231], v[92:95]
  ds_read_b64_tr_b16 a[228:229], v176 offset:20480
  ds_read_b64_tr_b16 a[230:231], v176 offset:21504
  v_mfma_f32_16x16x32_bf16 v[48:51], a[232:235], a[80:83], v[48:51]
  buffer_load_dwordx4 v185, s[80:83], s41 offen offset:2112 lds
  v_mfma_f32_16x16x32_bf16 v[48:51], a[192:195], a[88:91], v[48:51]
  s_add_u32 m0, s42, 143360
  v_mfma_f32_16x16x32_bf16 v[72:75], a[232:235], a[84:87], v[72:75]
  ds_read_b64_tr_b16 a[232:233], v176 offset:22528
  ds_read_b64_tr_b16 a[234:235], v176 offset:23552
  v_mfma_f32_16x16x32_bf16 v[72:75], a[192:195], a[92:95], v[72:75]
  ds_read_b64_tr_b16 a[192:193], v177 offset:20480
  ds_read_b64_tr_b16 a[194:195], v177 offset:21504
  s_waitcnt lgkmcnt(13)
  v_mfma_f32_16x16x32_bf16 v[52:55], a[196:199], a[80:83], v[52:55]
  buffer_load_dwordx4 v186, s[80:83], s41 offen offset:0 lds
  s_add_u32 m0, s42, 151488
  v_mfma_f32_16x16x32_bf16 v[52:55], a[200:203], a[88:91], v[52:55]
  v_mfma_f32_16x16x32_bf16 v[76:79], a[196:199], a[84:87], v[76:79]
  ds_read_b64_tr_b16 a[196:197], v177 offset:22528
  ds_read_b64_tr_b16 a[198:199], v177 offset:23552
  s_load_dwordx2 s[66:67], s[36:37], 0x0
  v_mfma_f32_16x16x32_bf16 v[76:79], a[200:203], a[92:95], v[76:79]
  s_waitcnt vmcnt(53)
  s_barrier
  ds_read_b64_tr_b16 a[200:201], v176 offset:16384
  s_waitcnt vmcnt(47)
  v_mfma_f32_16x16x32_bf16 v[96:99], a[204:207], v[136:139], v[96:99]
  buffer_load_dwordx4 v186, s[80:83], s41 offen offset:64 lds
  v_mfma_f32_16x16x32_bf16 v[100:103], v[136:139], a[208:211], v[100:103]
  ds_read_b64_tr_b16 a[202:203], v176 offset:17408
  ds_read_b64_tr_b16 a[204:205], v176 offset:18432
  s_add_u32 m0, s42, 139264
  s_waitcnt lgkmcnt(13)
  v_mfma_f32_16x16x32_bf16 v[8:11], a[212:215], a[96:99], v[8:11]
  ds_read_b64_tr_b16 a[206:207], v176 offset:19456
  ds_read_b64_tr_b16 a[208:209], v177 offset:16384
  v_mfma_f32_16x16x32_bf16 v[8:11], a[216:219], a[104:107], v[8:11]
  ds_read_b64_tr_b16 a[210:211], v177 offset:17408
  v_mfma_f32_16x16x32_bf16 v[32:35], a[212:215], a[100:103], v[32:35]
  buffer_load_dwordx4 v185, s[80:83], s41 offen offset:0 lds
  s_add_u32 m0, s42, 147392
  v_mfma_f32_16x16x32_bf16 v[32:35], a[216:219], a[108:111], v[32:35]
  ds_read_b64_tr_b16 a[212:213], v177 offset:18432
  ds_read_b64_tr_b16 a[214:215], v177 offset:19456
  v_mfma_f32_16x16x32_bf16 v[12:15], a[220:223], a[96:99], v[12:15]
  ds_read_b64_tr_b16 a[216:217], v182 offset:12288
  ds_read_b64_tr_b16 a[218:219], v182 offset:13312
  s_waitcnt lgkmcnt(13)
  v_mfma_f32_16x16x32_bf16 v[12:15], a[224:227], a[104:107], v[12:15]
  v_mfma_f32_16x16x32_bf16 v[36:39], a[220:223], a[100:103], v[36:39]
  buffer_load_dwordx4 v185, s[80:83], s41 offen offset:64 lds
  v_mfma_f32_16x16x32_bf16 v[36:39], a[224:227], a[108:111], v[36:39]
  ds_read_b64_tr_b16 a[220:221], v182 offset:28672
  ds_read_b64_tr_b16 a[222:223], v182 offset:29696
  s_mov_b32 s40, 3932160
  v_mfma_f32_16x16x32_bf16 v[16:19], a[96:99], a[228:231], v[16:19]
  ds_read_b64_tr_b16 a[224:225], v176 offset:12288
  ds_read_b64_tr_b16 a[226:227], v176 offset:13312
  v_mfma_f32_16x16x32_bf16 v[16:19], a[104:107], a[232:235], v[16:19]
  v_mfma_f32_16x16x32_bf16 v[40:43], a[100:103], a[228:231], v[40:43]
  buffer_load_dwordx4 v[156:159], v188, s[4:7], s40 offen sc1
  v_mfma_f32_16x16x32_bf16 v[40:43], a[108:111], a[232:235], v[40:43]
  ds_read_b64_tr_b16 a[228:229], v176 offset:14336
  ds_read_b64_tr_b16 a[230:231], v176 offset:15360
  s_waitcnt lgkmcnt(13)
  v_mfma_f32_16x16x32_bf16 v[20:23], a[96:99], a[192:195], v[20:23]
  ds_read_b64_tr_b16 a[232:233], v177 offset:12288
  ds_read_b64_tr_b16 a[234:235], v177 offset:13312
  v_mfma_f32_16x16x32_bf16 v[20:23], a[104:107], a[196:199], v[20:23]
  s_load_dwordx2 s[66:67], s[36:37], 0x10000
  v_mfma_f32_16x16x32_bf16 v[44:47], a[100:103], a[192:195], v[44:47]
  buffer_load_dwordx4 a[176:179], v187, s[4:7], s40 offen offset:0 sc1
  v_mfma_f32_16x16x32_bf16 v[44:47], a[108:111], a[196:199], v[44:47]
  ds_read_b64_tr_b16 a[192:193], v177 offset:14336
  ds_read_b64_tr_b16 a[194:195], v177 offset:15360
  v_mfma_f32_16x16x32_bf16 v[0:3], a[200:203], a[96:99], v[0:3]
  ds_read_b64_tr_b16 a[196:197], v176 offset:28672
  ds_read_b64_tr_b16 a[198:199], v176 offset:29696
  s_waitcnt lgkmcnt(13)
  v_mfma_f32_16x16x32_bf16 v[0:3], a[204:207], a[104:107], v[0:3]
  v_mfma_f32_16x16x32_bf16 v[24:27], a[200:203], a[100:103], v[24:27]
  buffer_load_dwordx4 a[180:183], v187, s[4:7], s40 offen offset:1024 sc1
  s_mov_b32 s40, 4063232
  v_mfma_f32_16x16x32_bf16 v[24:27], a[204:207], a[108:111], v[24:27]
  ds_read_b64_tr_b16 a[200:201], v176 offset:30720
  ds_read_b64_tr_b16 a[202:203], v176 offset:31744
  v_mfma_f32_16x16x32_bf16 v[4:7], a[208:211], a[96:99], v[4:7]
  ds_read_b64_tr_b16 a[204:205], v177 offset:28672
  ds_read_b64_tr_b16 a[206:207], v177 offset:29696
  v_mfma_f32_16x16x32_bf16 v[4:7], a[212:215], a[104:107], v[4:7]
  v_mfma_f32_16x16x32_bf16 v[28:31], a[208:211], a[100:103], v[28:31]
  buffer_load_dwordx4 a[184:187], v187, s[4:7], s40 offen offset:0 sc1
  v_mfma_f32_16x16x32_bf16 v[28:31], a[212:215], a[108:111], v[28:31]
  s_waitcnt vmcnt(51)
  s_barrier
  ds_read_b64_tr_b16 a[208:209], v177 offset:30720
  s_waitcnt lgkmcnt(13)
  v_mfma_f32_16x16x32_bf16 v[104:107], a[216:219], v[136:139], v[104:107]
  ds_read_b64_tr_b16 a[210:211], v177 offset:31744
  ds_read_b64_tr_b16 a[212:213], v176 offset:24576
  v_mfma_f32_16x16x32_bf16 v[108:111], v[136:139], a[220:223], v[108:111]
  ds_read_b64_tr_b16 a[214:215], v176 offset:25600
  ds_read_b64_tr_b16 a[216:217], v176 offset:26624
  v_mfma_f32_16x16x32_bf16 v[56:59], a[224:227], a[96:99], v[56:59]
  buffer_load_dwordx4 a[188:191], v187, s[4:7], s40 offen offset:1024 sc1
  s_waitcnt lgkmcnt(13)
  v_mfma_f32_16x16x32_bf16 v[56:59], a[228:231], a[104:107], v[56:59]
  ds_read_b64_tr_b16 a[218:219], v176 offset:27648
  ds_read_b64_tr_b16 a[220:221], v177 offset:24576
  s_mov_b32 s41, 4718592
  v_mfma_f32_16x16x32_bf16 v[80:83], a[224:227], a[100:103], v[80:83]
  ds_read_b64_tr_b16 a[222:223], v177 offset:25600
  ds_read_b64_tr_b16 a[224:225], v177 offset:26624
  s_add_u32 m0, s42, 153600
  v_mfma_f32_16x16x32_bf16 v[80:83], a[228:231], a[108:111], v[80:83]
  ds_read_b64_tr_b16 a[226:227], v177 offset:27648
  ds_read_b64_tr_b16 a[228:229], v182 offset:32768
  v_mfma_f32_16x16x32_bf16 v[60:63], a[232:235], a[96:99], v[60:63]
  buffer_load_dwordx4 v185, s[80:83], s41 offen offset:2048 lds
  s_add_u32 m0, s42, 157632
  s_load_dwordx2 s[66:67], s[36:37], 0x20000
  s_waitcnt lgkmcnt(13)
  v_mfma_f32_16x16x32_bf16 v[60:63], a[192:195], a[104:107], v[60:63]
  ds_read_b64_tr_b16 a[230:231], v182 offset:33792
  v_mfma_f32_16x16x32_bf16 v[84:87], a[232:235], a[100:103], v[84:87]
  ds_read_b64_tr_b16 a[232:233], v182 offset:45056
  ds_read_b64_tr_b16 a[234:235], v182 offset:46080
  v_mfma_f32_16x16x32_bf16 v[84:87], a[192:195], a[108:111], v[84:87]
  ds_read_b64_tr_b16 a[192:193], v176 offset:32768
  ds_read_b64_tr_b16 a[194:195], v176 offset:33792
  v_mfma_f32_16x16x32_bf16 v[64:67], a[96:99], a[196:199], v[64:67]
  buffer_load_dwordx4 v185, s[80:83], s41 offen offset:2112 lds
  v_mfma_f32_16x16x32_bf16 v[64:67], a[104:107], a[200:203], v[64:67]
  s_add_u32 m0, s42, 20480
  v_mfma_f32_16x16x32_bf16 v[88:91], a[100:103], a[196:199], v[88:91]
  ds_read_b64_tr_b16 a[196:197], v176 offset:34816
  ds_read_b64_tr_b16 a[198:199], v176 offset:35840
  v_mfma_f32_16x16x32_bf16 v[88:91], a[108:111], a[200:203], v[88:91]
  ds_read_b64_tr_b16 a[200:201], v177 offset:32768
  ds_read_b64_tr_b16 a[202:203], v177 offset:33792
  s_waitcnt lgkmcnt(13)
  v_mfma_f32_16x16x32_bf16 v[68:71], a[96:99], a[204:207], v[68:71]
  buffer_load_dwordx4 v186, s[80:83], s41 offen offset:0 lds
  s_add_u32 m0, s42, 16320
  v_mfma_f32_16x16x32_bf16 v[68:71], a[104:107], a[208:211], v[68:71]
  v_mfma_f32_16x16x32_bf16 v[92:95], a[100:103], a[204:207], v[92:95]
  ds_read_b64_tr_b16 a[204:205], v177 offset:34816
  ds_read_b64_tr_b16 a[206:207], v177 offset:35840
  v_mfma_f32_16x16x32_bf16 v[92:95], a[108:111], a[208:211], v[92:95]
  ds_read_b64_tr_b16 a[208:209], v176 offset:45056
  ds_read_b64_tr_b16 a[210:211], v176 offset:46080
  v_mfma_f32_16x16x32_bf16 v[48:51], a[212:215], a[96:99], v[48:51]
  buffer_load_dwordx4 v186, s[80:83], s41 offen offset:64 lds
  v_mfma_f32_16x16x32_bf16 v[48:51], a[216:219], a[104:107], v[48:51]
  s_mov_b32 s40, 4194304
  v_mfma_f32_16x16x32_bf16 v[72:75], a[212:215], a[100:103], v[72:75]
  ds_read_b64_tr_b16 a[212:213], v176 offset:47104
  ds_read_b64_tr_b16 a[214:215], v176 offset:48128
  v_mfma_f32_16x16x32_bf16 v[72:75], a[216:219], a[108:111], v[72:75]
  ds_read_b64_tr_b16 a[216:217], v177 offset:45056
  ds_read_b64_tr_b16 a[218:219], v177 offset:46080
  s_waitcnt lgkmcnt(13)
  v_mfma_f32_16x16x32_bf16 v[52:55], a[220:223], a[96:99], v[52:55]
  buffer_load_dwordx4 v[160:163], v188, s[4:7], s40 offen sc1
  v_mfma_f32_16x16x32_bf16 v[52:55], a[224:227], a[104:107], v[52:55]
  s_load_dwordx2 s[66:67], s[36:37], 0x30000
  v_mfma_f32_16x16x32_bf16 v[76:79], a[220:223], a[100:103], v[76:79]
L_wk0_1:
  s_cbranch_vccnz L_wk0_5
  ds_read_b64_tr_b16 a[220:221], v177 offset:47104
  ds_read_b64_tr_b16 a[222:223], v177 offset:48128
  v_mfma_f32_16x16x32_bf16 v[76:79], a[224:227], a[108:111], v[76:79]
  s_waitcnt vmcnt(55)
  s_barrier
  ds_read_b64_tr_b16 a[224:225], v176 offset:40960
  s_waitcnt vmcnt(49)
  v_mfma_f32_16x16x32_bf16 v[96:99], a[228:231], v[140:143], v[96:99]
  buffer_load_dwordx4 a[0:3], v187, s[4:7], s40 offen offset:0 sc1
  v_mfma_f32_16x16x32_bf16 v[100:103], v[140:143], a[232:235], v[100:103]
  ds_read_b64_tr_b16 a[226:227], v176 offset:41984
  ds_read_b64_tr_b16 a[228:229], v176 offset:43008
  s_waitcnt lgkmcnt(13)
  v_mfma_f32_16x16x32_bf16 v[8:11], a[192:195], a[112:115], v[8:11]
  ds_read_b64_tr_b16 a[230:231], v176 offset:44032
  ds_read_b64_tr_b16 a[232:233], v177 offset:40960
  v_mfma_f32_16x16x32_bf16 v[8:11], a[196:199], a[120:123], v[8:11]
  ds_read_b64_tr_b16 a[234:235], v177 offset:41984
  v_mfma_f32_16x16x32_bf16 v[32:35], a[192:195], a[116:119], v[32:35]
  buffer_load_dwordx4 a[4:7], v187, s[4:7], s40 offen offset:1024 sc1
  s_mov_b32 s40, 4325376
  v_mfma_f32_16x16x32_bf16 v[32:35], a[196:199], a[124:127], v[32:35]
  ds_read_b64_tr_b16 a[192:193], v177 offset:43008
  ds_read_b64_tr_b16 a[194:195], v177 offset:44032
  v_mfma_f32_16x16x32_bf16 v[12:15], a[200:203], a[112:115], v[12:15]
  ds_read_b64_tr_b16 a[196:197], v182 offset:36864
  ds_read_b64_tr_b16 a[198:199], v182 offset:37888
  s_waitcnt lgkmcnt(13)
  v_mfma_f32_16x16x32_bf16 v[12:15], a[204:207], a[120:123], v[12:15]
  v_mfma_f32_16x16x32_bf16 v[36:39], a[200:203], a[116:119], v[36:39]
  buffer_load_dwordx4 a[8:11], v187, s[4:7], s40 offen offset:0 sc1
  v_mfma_f32_16x16x32_bf16 v[36:39], a[204:207], a[124:127], v[36:39]
  ds_read_b64_tr_b16 a[200:201], v182 offset:53248
  ds_read_b64_tr_b16 a[202:203], v182 offset:54272
  v_mfma_f32_16x16x32_bf16 v[16:19], a[112:115], a[208:211], v[16:19]
  ds_read_b64_tr_b16 a[204:205], v176 offset:36864
  ds_read_b64_tr_b16 a[206:207], v176 offset:37888
  v_mfma_f32_16x16x32_bf16 v[16:19], a[120:123], a[212:215], v[16:19]
  v_mfma_f32_16x16x32_bf16 v[40:43], a[116:119], a[208:211], v[40:43]
  buffer_load_dwordx4 a[12:15], v187, s[4:7], s40 offen offset:1024 sc1
  v_mfma_f32_16x16x32_bf16 v[40:43], a[124:127], a[212:215], v[40:43]
  ds_read_b64_tr_b16 a[208:209], v176 offset:38912
  ds_read_b64_tr_b16 a[210:211], v176 offset:39936
  s_add_u32 m0, s42, 12288
  s_waitcnt lgkmcnt(13)
  v_mfma_f32_16x16x32_bf16 v[20:23], a[112:115], a[216:219], v[20:23]
  ds_read_b64_tr_b16 a[212:213], v177 offset:36864
  ds_read_b64_tr_b16 a[214:215], v177 offset:37888
  s_load_dwordx2 s[66:67], s[36:37], 0x40000
  v_mfma_f32_16x16x32_bf16 v[20:23], a[120:123], a[220:223], v[20:23]
  v_mfma_f32_16x16x32_bf16 v[44:47], a[116:119], a[216:219], v[44:47]
  buffer_load_dwordx4 v185, s[80:83], s41 offen offset:0 lds
  s_add_u32 m0, s42, 28608
  v_mfma_f32_16x16x32_bf16 v[44:47], a[124:127], a[220:223], v[44:47]
  ds_read_b64_tr_b16 a[216:217], v177 offset:38912
  ds_read_b64_tr_b16 a[218:219], v177 offset:39936
  v_mfma_f32_16x16x32_bf16 v[0:3], a[224:227], a[112:115], v[0:3]
  ds_read_b64_tr_b16 a[220:221], v176 offset:53248
  ds_read_b64_tr_b16 a[222:223], v176 offset:54272
  s_waitcnt lgkmcnt(13)
  v_mfma_f32_16x16x32_bf16 v[0:3], a[228:231], a[120:123], v[0:3]
  v_mfma_f32_16x16x32_bf16 v[24:27], a[224:227], a[116:119], v[24:27]
  buffer_load_dwordx4 v185, s[80:83], s41 offen offset:64 lds
  v_mfma_f32_16x16x32_bf16 v[24:27], a[228:231], a[124:127], v[24:27]
  ds_read_b64_tr_b16 a[224:225], v176 offset:55296
  ds_read_b64_tr_b16 a[226:227], v176 offset:56320
  s_mov_b32 s40, 4456448
  v_mfma_f32_16x16x32_bf16 v[4:7], a[232:235], a[112:115], v[4:7]
  ds_read_b64_tr_b16 a[228:229], v177 offset:53248
  ds_read_b64_tr_b16 a[230:231], v177 offset:54272
  v_mfma_f32_16x16x32_bf16 v[4:7], a[192:195], a[120:123], v[4:7]
  v_mfma_f32_16x16x32_bf16 v[28:31], a[232:235], a[116:119], v[28:31]
  buffer_load_dwordx4 v[164:167], v188, s[4:7], s40 offen sc1
  v_mfma_f32_16x16x32_bf16 v[28:31], a[192:195], a[124:127], v[28:31]
  s_waitcnt vmcnt(53)
  s_barrier
  ds_read_b64_tr_b16 a[232:233], v177 offset:55296
  s_waitcnt lgkmcnt(13)
  v_mfma_f32_16x16x32_bf16 v[104:107], a[196:199], v[140:143], v[104:107]
  ds_read_b64_tr_b16 a[234:235], v177 offset:56320
  ds_read_b64_tr_b16 a[192:193], v176 offset:49152
  v_mfma_f32_16x16x32_bf16 v[108:111], v[140:143], a[200:203], v[108:111]
  ds_read_b64_tr_b16 a[194:195], v176 offset:50176
  ds_read_b64_tr_b16 a[196:197], v176 offset:51200
  v_mfma_f32_16x16x32_bf16 v[56:59], a[204:207], a[112:115], v[56:59]
  buffer_load_dwordx4 a[16:19], v187, s[4:7], s40 offen offset:0 sc1
  s_waitcnt lgkmcnt(13)
  v_mfma_f32_16x16x32_bf16 v[56:59], a[208:211], a[120:123], v[56:59]
  ds_read_b64_tr_b16 a[198:199], v176 offset:52224
  ds_read_b64_tr_b16 a[200:201], v177 offset:49152
  v_mfma_f32_16x16x32_bf16 v[80:83], a[204:207], a[116:119], v[80:83]
  ds_read_b64_tr_b16 a[202:203], v177 offset:50176
  ds_read_b64_tr_b16 a[204:205], v177 offset:51200
  v_mfma_f32_16x16x32_bf16 v[80:83], a[208:211], a[124:127], v[80:83]
  ds_read_b64_tr_b16 a[206:207], v177 offset:52224
  ds_read_b64_tr_b16 a[208:209], v182 offset:57344
  s_load_dwordx2 s[66:67], s[36:37], 0x50000
  v_mfma_f32_16x16x32_bf16 v[60:63], a[212:215], a[112:115], v[60:63]
  buffer_load_dwordx4 a[20:23], v187, s[4:7], s40 offen offset:1024 sc1
  s_mov_b32 s40, 4587520
  s_waitcnt lgkmcnt(13)
  v_mfma_f32_16x16x32_bf16 v[60:63], a[216:219], a[120:123], v[60:63]
  ds_read_b64_tr_b16 a[210:211], v182 offset:58368
  v_mfma_f32_16x16x32_bf16 v[84:87], a[212:215], a[116:119], v[84:87]
  ds_read_b64_tr_b16 a[212:213], v183 offset:4096
  ds_read_b64_tr_b16 a[214:215], v183 offset:5120
  v_mfma_f32_16x16x32_bf16 v[84:87], a[216:219], a[124:127], v[84:87]
  ds_read_b64_tr_b16 a[216:217], v176 offset:57344
  ds_read_b64_tr_b16 a[218:219], v176 offset:58368
  v_mfma_f32_16x16x32_bf16 v[64:67], a[112:115], a[220:223], v[64:67]
  buffer_load_dwordx4 a[24:27], v187, s[4:7], s40 offen offset:0 sc1
  v_mfma_f32_16x16x32_bf16 v[64:67], a[120:123], a[224:227], v[64:67]
  v_mfma_f32_16x16x32_bf16 v[88:91], a[116:119], a[220:223], v[88:91]
  ds_read_b64_tr_b16 a[220:221], v176 offset:59392
  ds_read_b64_tr_b16 a[222:223], v176 offset:60416
  v_mfma_f32_16x16x32_bf16 v[88:91], a[124:127], a[224:227], v[88:91]
  ds_read_b64_tr_b16 a[224:225], v177 offset:57344
  ds_read_b64_tr_b16 a[226:227], v177 offset:58368
  s_waitcnt lgkmcnt(13)
  v_mfma_f32_16x16x32_bf16 v[68:71], a[112:115], a[228:231], v[68:71]
  buffer_load_dwordx4 a[28:31], v187, s[4:7], s40 offen offset:1024 sc1
  v_mfma_f32_16x16x32_bf16 v[68:71], a[120:123], a[232:235], v[68:71]
  s_mov_b32 s41, 5111808
  s_add_u32 m0, s42, 22528
  v_mfma_f32_16x16x32_bf16 v[92:95], a[116:119], a[228:231], v[92:95]
  ds_read_b64_tr_b16 a[228:229], v177 offset:59392
  ds_read_b64_tr_b16 a[230:231], v177 offset:60416
  v_mfma_f32_16x16x32_bf16 v[92:95], a[124:127], a[232:235], v[92:95]
  ds_read_b64_tr_b16 a[232:233], v178 offset:4096
  ds_read_b64_tr_b16 a[234:235], v178 offset:5120
  v_mfma_f32_16x16x32_bf16 v[48:51], a[192:195], a[112:115], v[48:51]
  buffer_load_dwordx4 v185, s[80:83], s41 offen offset:2048 lds
  s_add_u32 m0, s42, 30656
  v_mfma_f32_16x16x32_bf16 v[48:51], a[196:199], a[120:123], v[48:51]
  v_mfma_f32_16x16x32_bf16 v[72:75], a[192:195], a[116:119], v[72:75]
  ds_read_b64_tr_b16 a[192:193], v178 offset:6144
  ds_read_b64_tr_b16 a[194:195], v178 offset:7168
  v_mfma_f32_16x16x32_bf16 v[72:75], a[196:199], a[124:127], v[72:75]
  ds_read_b64_tr_b16 a[196:197], v179 offset:4096
  ds_read_b64_tr_b16 a[198:199], v179 offset:5120
  s_waitcnt lgkmcnt(13)
  v_mfma_f32_16x16x32_bf16 v[52:55], a[200:203], a[112:115], v[52:55]
  buffer_load_dwordx4 v185, s[80:83], s41 offen offset:2112 lds
  s_load_dwordx2 s[66:67], s[36:37], 0x60000
  v_mfma_f32_16x16x32_bf16 v[52:55], a[204:207], a[120:123], v[52:55]
  s_add_u32 m0, s42, 45056
  v_mfma_f32_16x16x32_bf16 v[76:79], a[200:203], a[116:119], v[76:79]
  ds_read_b64_tr_b16 a[200:201], v179 offset:6144
  ds_read_b64_tr_b16 a[202:203], v179 offset:7168
  v_mfma_f32_16x16x32_bf16 v[76:79], a[204:207], a[124:127], v[76:79]
  s_waitcnt vmcnt(53)
  s_barrier
  ds_read_b64_tr_b16 a[204:205], v178 offset:0
  s_waitcnt vmcnt(47)
  v_mfma_f32_16x16x32_bf16 v[96:99], a[208:211], v[144:147], v[96:99]
  buffer_load_dwordx4 v186, s[80:83], s41 offen offset:0 lds
  s_add_u32 m0, s42, 40896
  v_mfma_f32_16x16x32_bf16 v[100:103], v[144:147], a[212:215], v[100:103]
  ds_read_b64_tr_b16 a[206:207], v178 offset:1024
  ds_read_b64_tr_b16 a[208:209], v178 offset:2048
  s_waitcnt lgkmcnt(13)
  v_mfma_f32_16x16x32_bf16 v[8:11], a[216:219], a[128:131], v[8:11]
  ds_read_b64_tr_b16 a[210:211], v178 offset:3072
  ds_read_b64_tr_b16 a[212:213], v179 offset:0
  v_mfma_f32_16x16x32_bf16 v[8:11], a[220:223], a[136:139], v[8:11]
  ds_read_b64_tr_b16 a[214:215], v179 offset:1024
  v_mfma_f32_16x16x32_bf16 v[32:35], a[216:219], a[132:135], v[32:35]
  buffer_load_dwordx4 v186, s[80:83], s41 offen offset:64 lds
  v_mfma_f32_16x16x32_bf16 v[32:35], a[220:223], a[140:143], v[32:35]
  ds_read_b64_tr_b16 a[216:217], v179 offset:2048
  ds_read_b64_tr_b16 a[218:219], v179 offset:3072
  s_add_u32 m0, s42, 36864
  v_mfma_f32_16x16x32_bf16 v[12:15], a[224:227], a[128:131], v[12:15]
  ds_read_b64_tr_b16 a[220:221], v183 offset:16384
  ds_read_b64_tr_b16 a[222:223], v183 offset:17408
  s_waitcnt lgkmcnt(13)
  v_mfma_f32_16x16x32_bf16 v[12:15], a[228:231], a[136:139], v[12:15]
  v_mfma_f32_16x16x32_bf16 v[36:39], a[224:227], a[132:135], v[36:39]
  buffer_load_dwordx4 v185, s[80:83], s41 offen offset:0 lds
  s_add_u32 m0, s42, 53184
  v_mfma_f32_16x16x32_bf16 v[36:39], a[228:231], a[140:143], v[36:39]
  ds_read_b64_tr_b16 a[224:225], v183 offset:28672
  ds_read_b64_tr_b16 a[226:227], v183 offset:29696
  v_mfma_f32_16x16x32_bf16 v[16:19], a[128:131], a[232:235], v[16:19]
  ds_read_b64_tr_b16 a[228:229], v178 offset:16384
  ds_read_b64_tr_b16 a[230:231], v178 offset:17408
  v_mfma_f32_16x16x32_bf16 v[16:19], a[136:139], a[192:195], v[16:19]
  v_mfma_f32_16x16x32_bf16 v[40:43], a[132:135], a[232:235], v[40:43]
  buffer_load_dwordx4 v185, s[80:83], s41 offen offset:64 lds
  v_mfma_f32_16x16x32_bf16 v[40:43], a[140:143], a[192:195], v[40:43]
  ds_read_b64_tr_b16 a[232:233], v178 offset:18432
  ds_read_b64_tr_b16 a[234:235], v178 offset:19456
  s_mov_b32 s40, 4718592
  s_load_dwordx2 s[66:67], s[36:37], 0x70000
  s_waitcnt lgkmcnt(13)
  v_mfma_f32_16x16x32_bf16 v[20:23], a[128:131], a[196:199], v[20:23]
  ds_read_b64_tr_b16 a[192:193], v179 offset:16384
  ds_read_b64_tr_b16 a[194:195], v179 offset:17408
  v_mfma_f32_16x16x32_bf16 v[20:23], a[136:139], a[200:203], v[20:23]
  v_mfma_f32_16x16x32_bf16 v[44:47], a[132:135], a[196:199], v[44:47]
  buffer_load_dwordx4 v[168:171], v188, s[4:7], s40 offen sc1
  v_mfma_f32_16x16x32_bf16 v[44:47], a[140:143], a[200:203], v[44:47]
  ds_read_b64_tr_b16 a[196:197], v179 offset:18432
  ds_read_b64_tr_b16 a[198:199], v179 offset:19456
  v_mfma_f32_16x16x32_bf16 v[0:3], a[204:207], a[128:131], v[0:3]
  ds_read_b64_tr_b16 a[200:201], v178 offset:28672
  ds_read_b64_tr_b16 a[202:203], v178 offset:29696
  s_waitcnt lgkmcnt(13)
  v_mfma_f32_16x16x32_bf16 v[0:3], a[208:211], a[136:139], v[0:3]
  v_mfma_f32_16x16x32_bf16 v[24:27], a[204:207], a[132:135], v[24:27]
  buffer_load_dwordx4 a[32:35], v187, s[4:7], s40 offen offset:0 sc1
  v_mfma_f32_16x16x32_bf16 v[24:27], a[208:211], a[140:143], v[24:27]
  ds_read_b64_tr_b16 a[204:205], v178 offset:30720
  ds_read_b64_tr_b16 a[206:207], v178 offset:31744
  v_mfma_f32_16x16x32_bf16 v[4:7], a[212:215], a[128:131], v[4:7]
  ds_read_b64_tr_b16 a[208:209], v179 offset:28672
  ds_read_b64_tr_b16 a[210:211], v179 offset:29696
  v_mfma_f32_16x16x32_bf16 v[4:7], a[216:219], a[136:139], v[4:7]
  v_mfma_f32_16x16x32_bf16 v[28:31], a[212:215], a[132:135], v[28:31]
  buffer_load_dwordx4 a[36:39], v187, s[4:7], s40 offen offset:1024 sc1
  s_mov_b32 s40, 4849664
  v_mfma_f32_16x16x32_bf16 v[28:31], a[216:219], a[140:143], v[28:31]
  s_waitcnt vmcnt(49)
  s_barrier
  ds_read_b64_tr_b16 a[212:213], v179 offset:30720
  s_waitcnt vmcnt(43) lgkmcnt(13)
  v_mfma_f32_16x16x32_bf16 v[96:99], a[220:223], v[148:151], v[96:99]
  ds_read_b64_tr_b16 a[214:215], v179 offset:31744
  ds_read_b64_tr_b16 a[216:217], v178 offset:24576
  v_mfma_f32_16x16x32_bf16 v[100:103], v[148:151], a[224:227], v[100:103]
  ds_read_b64_tr_b16 a[218:219], v178 offset:25600
  ds_read_b64_tr_b16 a[220:221], v178 offset:26624
  v_mfma_f32_16x16x32_bf16 v[8:11], a[228:231], a[144:147], v[8:11]
  buffer_load_dwordx4 a[40:43], v187, s[4:7], s40 offen offset:0 sc1
  s_waitcnt lgkmcnt(13)
  v_mfma_f32_16x16x32_bf16 v[8:11], a[232:235], a[152:155], v[8:11]
  ds_read_b64_tr_b16 a[222:223], v178 offset:27648
  ds_read_b64_tr_b16 a[224:225], v179 offset:24576
  v_mfma_f32_16x16x32_bf16 v[32:35], a[228:231], a[148:151], v[32:35]
  ds_read_b64_tr_b16 a[226:227], v179 offset:25600
  ds_read_b64_tr_b16 a[228:229], v179 offset:26624
  s_load_dwordx2 s[66:67], s[36:37], 0x80000
  v_mfma_f32_16x16x32_bf16 v[32:35], a[232:235], a[156:159], v[32:35]
  ds_read_b64_tr_b16 a[230:231], v179 offset:27648
  ds_read_b64_tr_b16 a[232:233], v183 offset:40960
  v_mfma_f32_16x16x32_bf16 v[12:15], a[192:195], a[144:147], v[12:15]
  buffer_load_dwordx4 a[44:47], v187, s[4:7], s40 offen offset:1024 sc1
  s_waitcnt lgkmcnt(13)
  v_mfma_f32_16x16x32_bf16 v[12:15], a[196:199], a[152:155], v[12:15]
  ds_read_b64_tr_b16 a[234:235], v183 offset:41984
  s_mov_b32 s41, 5505024
  s_add_u32 m0, s42, 47104
  v_mfma_f32_16x16x32_bf16 v[36:39], a[192:195], a[148:151], v[36:39]
  ds_read_b64_tr_b16 a[192:193], v183 offset:53248
  ds_read_b64_tr_b16 a[194:195], v183 offset:54272
  v_mfma_f32_16x16x32_bf16 v[36:39], a[196:199], a[156:159], v[36:39]
  ds_read_b64_tr_b16 a[196:197], v178 offset:40960
  ds_read_b64_tr_b16 a[198:199], v178 offset:41984
  v_mfma_f32_16x16x32_bf16 v[16:19], a[144:147], a[200:203], v[16:19]
  buffer_load_dwordx4 v185, s[80:83], s41 offen offset:2048 lds
  s_add_u32 m0, s42, 55232
  v_mfma_f32_16x16x32_bf16 v[16:19], a[152:155], a[204:207], v[16:19]
  v_mfma_f32_16x16x32_bf16 v[40:43], a[148:151], a[200:203], v[40:43]
  ds_read_b64_tr_b16 a[200:201], v178 offset:43008
  ds_read_b64_tr_b16 a[202:203], v178 offset:44032
  v_mfma_f32_16x16x32_bf16 v[40:43], a[156:159], a[204:207], v[40:43]
  ds_read_b64_tr_b16 a[204:205], v179 offset:40960
  ds_read_b64_tr_b16 a[206:207], v179 offset:41984
  s_waitcnt lgkmcnt(13)
  v_mfma_f32_16x16x32_bf16 v[20:23], a[144:147], a[208:211], v[20:23]
  buffer_load_dwordx4 v185, s[80:83], s41 offen offset:2112 lds
  v_mfma_f32_16x16x32_bf16 v[20:23], a[152:155], a[212:215], v[20:23]
  s_add_u32 m0, s42, 69632
  v_mfma_f32_16x16x32_bf16 v[44:47], a[148:151], a[208:211], v[44:47]
  ds_read_b64_tr_b16 a[208:209], v179 offset:43008
  ds_read_b64_tr_b16 a[210:211], v179 offset:44032
  v_mfma_f32_16x16x32_bf16 v[44:47], a[156:159], a[212:215], v[44:47]
  ds_read_b64_tr_b16 a[212:213], v178 offset:53248
  ds_read_b64_tr_b16 a[214:215], v178 offset:54272
  v_mov_b32 v200, -1
  v_mfma_f32_16x16x32_bf16 v[0:3], a[216:219], a[144:147], v[0:3]
  buffer_load_dwordx4 v186, s[80:83], s41 offen offset:0 lds
  s_add_u32 m0, s42, 65472
  v_mfma_f32_16x16x32_bf16 v[0:3], a[220:223], a[152:155], v[0:3]
  v_lshlrev_b32 v204, 2, v224
  buffer_store_dword v200, v204, s[4:7], s89 offen sc1
  v_mfma_f32_16x16x32_bf16 v[24:27], a[216:219], a[148:151], v[24:27]
  ds_read_b64_tr_b16 a[216:217], v178 offset:55296
  ds_read_b64_tr_b16 a[218:219], v178 offset:56320
  v_mfma_f32_16x16x32_bf16 v[24:27], a[220:223], a[156:159], v[24:27]
  ds_read_b64_tr_b16 a[220:221], v179 offset:53248
  ds_read_b64_tr_b16 a[222:223], v179 offset:54272
  s_load_dwordx2 s[66:67], s[36:37], 0x90000
  s_waitcnt lgkmcnt(13)
  v_mfma_f32_16x16x32_bf16 v[4:7], a[224:227], a[144:147], v[4:7]
  buffer_load_dwordx4 v186, s[80:83], s41 offen offset:64 lds
  v_mfma_f32_16x16x32_bf16 v[4:7], a[228:231], a[152:155], v[4:7]
  s_mov_b32 s40, 4980736
  v_mfma_f32_16x16x32_bf16 v[28:31], a[224:227], a[148:151], v[28:31]
  ds_read_b64_tr_b16 a[224:225], v179 offset:55296
  ds_read_b64_tr_b16 a[226:227], v179 offset:56320
  v_mfma_f32_16x16x32_bf16 v[28:31], a[228:231], a[156:159], v[28:31]
  s_waitcnt vmcnt(40)
  s_barrier
  ds_read_b64_tr_b16 a[228:229], v178 offset:49152
  v_mfma_f32_16x16x32_bf16 v[96:99], a[232:235], v[152:155], v[96:99]
  buffer_load_dwordx4 v[172:175], v188, s[4:7], s40 offen sc1
  v_mfma_f32_16x16x32_bf16 v[100:103], v[152:155], a[192:195], v[100:103]
  ds_read_b64_tr_b16 a[230:231], v178 offset:50176
  ds_read_b64_tr_b16 a[232:233], v178 offset:51200
  s_waitcnt lgkmcnt(13)
  v_mfma_f32_16x16x32_bf16 v[8:11], a[196:199], a[160:163], v[8:11]
  ds_read_b64_tr_b16 a[234:235], v178 offset:52224
  ds_read_b64_tr_b16 a[192:193], v179 offset:49152
  v_mfma_f32_16x16x32_bf16 v[8:11], a[200:203], a[168:171], v[8:11]
  ds_read_b64_tr_b16 a[194:195], v179 offset:50176
  v_mfma_f32_16x16x32_bf16 v[32:35], a[196:199], a[164:167], v[32:35]
  buffer_load_dwordx4 a[48:51], v187, s[4:7], s40 offen offset:0 sc1
  v_mfma_f32_16x16x32_bf16 v[32:35], a[200:203], a[172:175], v[32:35]
  ds_read_b64_tr_b16 a[196:197], v179 offset:51200
  ds_read_b64_tr_b16 a[198:199], v179 offset:52224
  v_mfma_f32_16x16x32_bf16 v[12:15], a[204:207], a[160:163], v[12:15]
  ds_read_b64_tr_b16 a[200:201], v184 offset:0
  ds_read_b64_tr_b16 a[202:203], v184 offset:1024
  s_waitcnt lgkmcnt(13)
  v_mfma_f32_16x16x32_bf16 v[12:15], a[208:211], a[168:171], v[12:15]
  v_mfma_f32_16x16x32_bf16 v[36:39], a[204:207], a[164:167], v[36:39]
  buffer_load_dwordx4 a[52:55], v187, s[4:7], s40 offen offset:1024 sc1
  s_mov_b32 s40, 5111808
  v_mfma_f32_16x16x32_bf16 v[36:39], a[208:211], a[172:175], v[36:39]
  ds_read_b64_tr_b16 a[204:205], v184 offset:12288
  ds_read_b64_tr_b16 a[206:207], v184 offset:13312
  v_mfma_f32_16x16x32_bf16 v[16:19], a[160:163], a[212:215], v[16:19]
  ds_read_b64_tr_b16 a[208:209], v180 offset:0
  ds_read_b64_tr_b16 a[210:211], v180 offset:1024
  v_mfma_f32_16x16x32_bf16 v[16:19], a[168:171], a[216:219], v[16:19]
  v_mfma_f32_16x16x32_bf16 v[40:43], a[164:167], a[212:215], v[40:43]
  buffer_load_dwordx4 a[56:59], v187, s[4:7], s40 offen offset:0 sc1
  s_load_dwordx2 s[66:67], s[36:37], 0xa0000
  v_mfma_f32_16x16x32_bf16 v[40:43], a[172:175], a[216:219], v[40:43]
  ds_read_b64_tr_b16 a[212:213], v180 offset:2048
  ds_read_b64_tr_b16 a[214:215], v180 offset:3072
  s_waitcnt lgkmcnt(13)
  v_mfma_f32_16x16x32_bf16 v[20:23], a[160:163], a[220:223], v[20:23]
  ds_read_b64_tr_b16 a[216:217], v181 offset:0
  ds_read_b64_tr_b16 a[218:219], v181 offset:1024
  v_mfma_f32_16x16x32_bf16 v[20:23], a[168:171], a[224:227], v[20:23]
  v_mfma_f32_16x16x32_bf16 v[44:47], a[164:167], a[220:223], v[44:47]
  buffer_load_dwordx4 a[60:63], v187, s[4:7], s40 offen offset:1024 sc1
  v_mfma_f32_16x16x32_bf16 v[44:47], a[172:175], a[224:227], v[44:47]
  ds_read_b64_tr_b16 a[220:221], v181 offset:2048
  ds_read_b64_tr_b16 a[222:223], v181 offset:3072
  s_add_u32 m0, s42, 81920
  v_mfma_f32_16x16x32_bf16 v[0:3], a[228:231], a[160:163], v[0:3]
  ds_read_b64_tr_b16 a[224:225], v180 offset:12288
  ds_read_b64_tr_b16 a[226:227], v180 offset:13312
  s_waitcnt lgkmcnt(13)
  v_mfma_f32_16x16x32_bf16 v[0:3], a[232:235], a[168:171], v[0:3]
  v_mfma_f32_16x16x32_bf16 v[24:27], a[228:231], a[164:167], v[24:27]
  buffer_load_dwordx4 v185, s[80:83], s41 offen offset:0 lds
  s_add_u32 m0, s42, 94144
  v_mfma_f32_16x16x32_bf16 v[24:27], a[232:235], a[172:175], v[24:27]
  ds_read_b64_tr_b16 a[228:229], v180 offset:14336
  ds_read_b64_tr_b16 a[230:231], v180 offset:15360
  v_mfma_f32_16x16x32_bf16 v[4:7], a[192:195], a[160:163], v[4:7]
  ds_read_b64_tr_b16 a[232:233], v181 offset:12288
  ds_read_b64_tr_b16 a[234:235], v181 offset:13312
  v_mfma_f32_16x16x32_bf16 v[4:7], a[196:199], a[168:171], v[4:7]
  v_mfma_f32_16x16x32_bf16 v[28:31], a[192:195], a[164:167], v[28:31]
  buffer_load_dwordx4 v185, s[80:83], s41 offen offset:64 lds
  v_mfma_f32_16x16x32_bf16 v[28:31], a[196:199], a[172:175], v[28:31]
  s_waitcnt vmcnt(36)
  s_barrier
  ds_read_b64_tr_b16 a[192:193], v181 offset:14336
  s_waitcnt lgkmcnt(13)
  v_mfma_f32_16x16x32_bf16 v[96:99], a[200:203], v[156:159], v[96:99]
  ds_read_b64_tr_b16 a[194:195], v181 offset:15360
  ds_read_b64_tr_b16 a[196:197], v180 offset:8192
  s_mov_b32 s41, 5898240
  v_mfma_f32_16x16x32_bf16 v[100:103], v[156:159], a[204:207], v[100:103]
  ds_read_b64_tr_b16 a[198:199], v180 offset:9216
  ds_read_b64_tr_b16 a[200:201], v180 offset:10240
  s_add_u32 m0, s42, 88064
  v_mfma_f32_16x16x32_bf16 v[8:11], a[208:211], a[176:179], v[8:11]
  buffer_load_dwordx4 v185, s[80:83], s41 offen offset:2048 lds
  s_add_u32 m0, s42, 104384
  s_waitcnt lgkmcnt(13)
  v_mfma_f32_16x16x32_bf16 v[8:11], a[212:215], a[184:187], v[8:11]
  ds_read_b64_tr_b16 a[202:203], v180 offset:11264
  ds_read_b64_tr_b16 a[204:205], v181 offset:8192
  s_load_dwordx2 s[66:67], s[36:37], 0xb0000
  v_mfma_f32_16x16x32_bf16 v[32:35], a[208:211], a[180:183], v[32:35]
  ds_read_b64_tr_b16 a[206:207], v181 offset:9216
  ds_read_b64_tr_b16 a[208:209], v181 offset:10240
  v_mfma_f32_16x16x32_bf16 v[32:35], a[212:215], a[188:191], v[32:35]
  ds_read_b64_tr_b16 a[210:211], v181 offset:11264
  ds_read_b64_tr_b16 a[212:213], v184 offset:24576
  v_mfma_f32_16x16x32_bf16 v[12:15], a[216:219], a[176:179], v[12:15]
  buffer_load_dwordx4 v185, s[80:83], s41 offen offset:2112 lds
  s_waitcnt lgkmcnt(13)
  v_mfma_f32_16x16x32_bf16 v[12:15], a[220:223], a[184:187], v[12:15]
  ds_read_b64_tr_b16 a[214:215], v184 offset:25600
  s_add_u32 m0, s42, 118784
  v_mfma_f32_16x16x32_bf16 v[36:39], a[216:219], a[180:183], v[36:39]
  ds_read_b64_tr_b16 a[216:217], v182 offset:20480
  ds_read_b64_tr_b16 a[218:219], v182 offset:21504
  v_mfma_f32_16x16x32_bf16 v[36:39], a[220:223], a[188:191], v[36:39]
  ds_read_b64_tr_b16 a[220:221], v180 offset:24576
  ds_read_b64_tr_b16 a[222:223], v180 offset:25600
  v_mfma_f32_16x16x32_bf16 v[16:19], a[176:179], a[224:227], v[16:19]
  buffer_load_dwordx4 v186, s[80:83], s41 offen offset:0 lds
  s_add_u32 m0, s42, 114624
  v_mfma_f32_16x16x32_bf16 v[16:19], a[184:187], a[228:231], v[16:19]
  v_mfma_f32_16x16x32_bf16 v[40:43], a[180:183], a[224:227], v[40:43]
  ds_read_b64_tr_b16 a[224:225], v180 offset:26624
  ds_read_b64_tr_b16 a[226:227], v180 offset:27648
  v_mfma_f32_16x16x32_bf16 v[40:43], a[188:191], a[228:231], v[40:43]
  ds_read_b64_tr_b16 a[228:229], v181 offset:24576
  ds_read_b64_tr_b16 a[230:231], v181 offset:25600
  s_waitcnt lgkmcnt(13)
  v_mfma_f32_16x16x32_bf16 v[20:23], a[176:179], a[232:235], v[20:23]
  buffer_load_dwordx4 v186, s[80:83], s41 offen offset:64 lds
  v_mfma_f32_16x16x32_bf16 v[20:23], a[184:187], a[192:195], v[20:23]
  v_mfma_f32_16x16x32_bf16 v[44:47], a[180:183], a[232:235], v[44:47]
  ds_read_b64_tr_b16 a[232:233], v181 offset:26624
  ds_read_b64_tr_b16 a[234:235], v181 offset:27648
  v_mfma_f32_16x16x32_bf16 v[44:47], a[188:191], a[192:195], v[44:47]
  ds_read_b64_tr_b16 a[192:193], v176 offset:20480
  ds_read_b64_tr_b16 a[194:195], v176 offset:21504
  v_mfma_f32_16x16x32_bf16 v[0:3], a[196:199], a[176:179], v[0:3]
  v_mfma_f32_16x16x32_bf16 v[0:3], a[200:203], a[184:187], v[0:3]
  v_mfma_f32_16x16x32_bf16 v[24:27], a[196:199], a[180:183], v[24:27]
  ds_read_b64_tr_b16 a[196:197], v176 offset:22528
  ds_read_b64_tr_b16 a[198:199], v176 offset:23552
  s_load_dwordx2 s[66:67], s[36:37], 0xc0000
  v_mfma_f32_16x16x32_bf16 v[24:27], a[200:203], a[188:191], v[24:27]
  ds_read_b64_tr_b16 a[200:201], v177 offset:20480
  ds_read_b64_tr_b16 a[202:203], v177 offset:21504
  s_waitcnt lgkmcnt(13)
  v_mfma_f32_16x16x32_bf16 v[4:7], a[204:207], a[176:179], v[4:7]
  v_mfma_f32_16x16x32_bf16 v[4:7], a[208:211], a[184:187], v[4:7]
  v_mfma_f32_16x16x32_bf16 v[28:31], a[204:207], a[180:183], v[28:31]
  ds_read_b64_tr_b16 a[204:205], v177 offset:22528
  ds_read_b64_tr_b16 a[206:207], v177 offset:23552
  v_mfma_f32_16x16x32_bf16 v[28:31], a[208:211], a[188:191], v[28:31]
  s_waitcnt vmcnt(24)
  s_barrier
  ds_read_b64_tr_b16 a[208:209], v176 offset:12288
  v_mfma_f32_16x16x32_bf16 v[96:99], a[212:215], v[160:163], v[96:99]
  ds_read_b64_tr_b16 a[210:211], v176 offset:13312
  ds_read_b64_tr_b16 a[212:213], v176 offset:14336
  s_add_u32 m0, s42, 131072
  v_mfma_f32_16x16x32_bf16 v[100:103], v[160:163], a[216:219], v[100:103]
  buffer_load_dwordx4 v185, s[80:83], s41 offen offset:0 lds
  s_add_u32 m0, s42, 143296
  s_waitcnt lgkmcnt(13)
  v_mfma_f32_16x16x32_bf16 v[8:11], a[220:223], a[0:3], v[8:11]
  ds_read_b64_tr_b16 a[214:215], v176 offset:15360
  ds_read_b64_tr_b16 a[216:217], v177 offset:12288
  v_mfma_f32_16x16x32_bf16 v[8:11], a[224:227], a[8:11], v[8:11]
  ds_read_b64_tr_b16 a[218:219], v177 offset:13312
  v_mfma_f32_16x16x32_bf16 v[32:35], a[220:223], a[4:7], v[32:35]
  buffer_load_dwordx4 v185, s[80:83], s41 offen offset:64 lds
  v_mfma_f32_16x16x32_bf16 v[32:35], a[224:227], a[12:15], v[32:35]
  ds_read_b64_tr_b16 a[220:221], v177 offset:14336
  ds_read_b64_tr_b16 a[222:223], v177 offset:15360
  s_mov_b32 s41, 0
  v_mfma_f32_16x16x32_bf16 v[12:15], a[228:231], a[0:3], v[12:15]
  ds_read_b64_tr_b16 a[224:225], v182 offset:24576
  ds_read_b64_tr_b16 a[226:227], v182 offset:25600
  s_add_u32 m0, s42, 139264
  s_waitcnt lgkmcnt(13)
  v_mfma_f32_16x16x32_bf16 v[12:15], a[232:235], a[8:11], v[12:15]
  v_mfma_f32_16x16x32_bf16 v[36:39], a[228:231], a[4:7], v[36:39]
  buffer_load_dwordx4 v217, s[60:63], s41 offen offset:0 nt lds
  v_mfma_f32_16x16x32_bf16 v[36:39], a[232:235], a[12:15], v[36:39]
  ds_read_b64_tr_b16 a[228:229], v182 offset:45056
  ds_read_b64_tr_b16 a[230:231], v182 offset:46080
  v_mfma_f32_16x16x32_bf16 v[16:19], a[0:3], a[192:195], v[16:19]
  ds_read_b64_tr_b16 a[232:233], v176 offset:24576
  ds_read_b64_tr_b16 a[234:235], v176 offset:25600
  v_mfma_f32_16x16x32_bf16 v[16:19], a[8:11], a[196:199], v[16:19]
  s_load_dwordx2 s[66:67], s[36:37], 0xd0000
  v_mfma_f32_16x16x32_bf16 v[40:43], a[4:7], a[192:195], v[40:43]
  ds_read_b64_tr_b16 a[192:193], v176 offset:26624
  ds_read_b64_tr_b16 a[194:195], v176 offset:27648
  v_mfma_f32_16x16x32_bf16 v[40:43], a[12:15], a[196:199], v[40:43]
  ds_read_b64_tr_b16 a[196:197], v177 offset:24576
  ds_read_b64_tr_b16 a[198:199], v177 offset:25600
  s_waitcnt lgkmcnt(13)
  v_mfma_f32_16x16x32_bf16 v[20:23], a[0:3], a[200:203], v[20:23]
  v_mfma_f32_16x16x32_bf16 v[20:23], a[8:11], a[204:207], v[20:23]
  v_mfma_f32_16x16x32_bf16 v[44:47], a[4:7], a[200:203], v[44:47]
  ds_read_b64_tr_b16 a[200:201], v177 offset:26624
  ds_read_b64_tr_b16 a[202:203], v177 offset:27648
  v_mfma_f32_16x16x32_bf16 v[44:47], a[12:15], a[204:207], v[44:47]
  ds_read_b64_tr_b16 a[204:205], v176 offset:45056
  ds_read_b64_tr_b16 a[206:207], v176 offset:46080
  v_mfma_f32_16x16x32_bf16 v[0:3], a[208:211], a[0:3], v[0:3]
  v_mfma_f32_16x16x32_bf16 v[0:3], a[212:215], a[8:11], v[0:3]
  v_mfma_f32_16x16x32_bf16 v[24:27], a[208:211], a[4:7], v[24:27]
  ds_read_b64_tr_b16 a[208:209], v176 offset:47104
  ds_read_b64_tr_b16 a[210:211], v176 offset:48128
  v_mfma_f32_16x16x32_bf16 v[24:27], a[212:215], a[12:15], v[24:27]
  ds_read_b64_tr_b16 a[212:213], v177 offset:45056
  ds_read_b64_tr_b16 a[214:215], v177 offset:46080
  s_waitcnt lgkmcnt(13)
  v_mfma_f32_16x16x32_bf16 v[4:7], a[216:219], a[0:3], v[4:7]
  v_mfma_f32_16x16x32_bf16 v[4:7], a[220:223], a[8:11], v[4:7]
  v_mfma_f32_16x16x32_bf16 v[28:31], a[216:219], a[4:7], v[28:31]
  ds_read_b64_tr_b16 a[216:217], v177 offset:47104
  ds_read_b64_tr_b16 a[218:219], v177 offset:48128
  v_mfma_f32_16x16x32_bf16 v[28:31], a[220:223], a[12:15], v[28:31]
  s_waitcnt vmcnt(4)
  s_barrier
  ds_read_b64_tr_b16 a[220:221], v176 offset:36864
  v_mfma_f32_16x16x32_bf16 v[96:99], a[224:227], v[164:167], v[96:99]
  ds_read_b64_tr_b16 a[222:223], v176 offset:37888
  ds_read_b64_tr_b16 a[224:225], v176 offset:38912
  s_mov_b32 s41, 393216
  v_mfma_f32_16x16x32_bf16 v[100:103], v[164:167], a[228:231], v[100:103]
  ds_read_b64_tr_b16 a[226:227], v176 offset:39936
  ds_read_b64_tr_b16 a[228:229], v177 offset:36864
  s_add_u32 m0, s42, 155648
  s_waitcnt lgkmcnt(13)
  v_mfma_f32_16x16x32_bf16 v[8:11], a[232:235], a[16:19], v[8:11]
  buffer_load_dwordx4 v217, s[60:63], s41 offen offset:0 nt lds
  s_load_dwordx2 s[66:67], s[36:37], 0xe0000
  v_mfma_f32_16x16x32_bf16 v[8:11], a[192:195], a[24:27], v[8:11]
  ds_read_b64_tr_b16 a[230:231], v177 offset:37888
  s_mov_b32 s41, 786432
  s_add_u32 m0, s42, 20480
  v_mfma_f32_16x16x32_bf16 v[32:35], a[232:235], a[20:23], v[32:35]
  ds_read_b64_tr_b16 a[232:233], v177 offset:38912
  ds_read_b64_tr_b16 a[234:235], v177 offset:39936
  v_mfma_f32_16x16x32_bf16 v[32:35], a[192:195], a[28:31], v[32:35]
  buffer_load_dwordx4 v217, s[60:63], s41 offen offset:0 nt lds
  v_mfma_f32_16x16x32_bf16 v[12:15], a[196:199], a[16:19], v[12:15]
L_wk0_2:
  s_cbranch_vccnz L_wk0_end
  ds_read_b64_tr_b16 a[192:193], v182 offset:49152
  ds_read_b64_tr_b16 a[194:195], v182 offset:50176
  s_mov_b32 s41, 1179648
  v_mfma_f32_16x16x32_bf16 v[12:15], a[200:203], a[24:27], v[12:15]
  s_add_u32 m0, s42, 12288
  v_mfma_f32_16x16x32_bf16 v[36:39], a[196:199], a[20:23], v[36:39]
  ds_read_b64_tr_b16 a[196:197], v183 offset:4096
  ds_read_b64_tr_b16 a[198:199], v183 offset:5120
  v_mfma_f32_16x16x32_bf16 v[36:39], a[200:203], a[28:31], v[36:39]
  buffer_load_dwordx4 v217, s[60:63], s41 offen offset:0 nt lds
  s_waitcnt lgkmcnt(13)
  v_mfma_f32_16x16x32_bf16 v[16:19], a[16:19], a[204:207], v[16:19]
  ds_read_b64_tr_b16 a[200:201], v183 offset:24576
  ds_read_b64_tr_b16 a[202:203], v183 offset:25600
  v_mfma_f32_16x16x32_bf16 v[16:19], a[24:27], a[208:211], v[16:19]
  v_mfma_f32_16x16x32_bf16 v[40:43], a[20:23], a[204:207], v[40:43]
  ds_read_b64_tr_b16 a[204:205], v183 offset:53248
  ds_read_b64_tr_b16 a[206:207], v183 offset:54272
  v_mfma_f32_16x16x32_bf16 v[40:43], a[28:31], a[208:211], v[40:43]
  ds_read_b64_tr_b16 a[208:209], v176 offset:49152
  ds_read_b64_tr_b16 a[210:211], v176 offset:50176
  v_mfma_f32_16x16x32_bf16 v[20:23], a[16:19], a[212:215], v[20:23]
  s_waitcnt lgkmcnt(13)
  v_mfma_f32_16x16x32_bf16 v[20:23], a[24:27], a[216:219], v[20:23]
  v_mfma_f32_16x16x32_bf16 v[44:47], a[20:23], a[212:215], v[44:47]
  ds_read_b64_tr_b16 a[212:213], v176 offset:51200
  ds_read_b64_tr_b16 a[214:215], v176 offset:52224
  v_mfma_f32_16x16x32_bf16 v[44:47], a[28:31], a[216:219], v[44:47]
  ds_read_b64_tr_b16 a[216:217], v177 offset:49152
  ds_read_b64_tr_b16 a[218:219], v177 offset:50176
  v_mfma_f32_16x16x32_bf16 v[0:3], a[220:223], a[16:19], v[0:3]
  v_mfma_f32_16x16x32_bf16 v[0:3], a[224:227], a[24:27], v[0:3]
  s_load_dwordx2 s[66:67], s[36:37], 0xf0000
  s_add_u32 s36, s36, 0x100000
  s_addc_u32 s37, s37, 0
  v_mfma_f32_16x16x32_bf16 v[24:27], a[220:223], a[20:23], v[24:27]
  ds_read_b64_tr_b16 a[220:221], v177 offset:51200
  ds_read_b64_tr_b16 a[222:223], v177 offset:52224
  v_mfma_f32_16x16x32_bf16 v[24:27], a[224:227], a[28:31], v[24:27]
  ds_read_b64_tr_b16 a[224:225], v178 offset:4096
  ds_read_b64_tr_b16 a[226:227], v178 offset:5120
  s_waitcnt lgkmcnt(13)
  v_mfma_f32_16x16x32_bf16 v[4:7], a[228:231], a[16:19], v[4:7]
  v_mfma_f32_16x16x32_bf16 v[4:7], a[232:235], a[24:27], v[4:7]
  v_mfma_f32_16x16x32_bf16 v[28:31], a[228:231], a[20:23], v[28:31]
  ds_read_b64_tr_b16 a[228:229], v178 offset:6144
  ds_read_b64_tr_b16 a[230:231], v178 offset:7168
  v_mfma_f32_16x16x32_bf16 v[28:31], a[232:235], a[28:31], v[28:31]
  s_barrier
  ds_read_b64_tr_b16 a[232:233], v179 offset:4096
  v_mfma_f32_16x16x32_bf16 v[96:99], a[192:195], v[168:171], v[96:99]
  ds_read_b64_tr_b16 a[234:235], v179 offset:5120
  ds_read_b64_tr_b16 a[192:193], v179 offset:6144
  s_mov_b32 s41, 1572864
  v_mfma_f32_16x16x32_bf16 v[100:103], v[168:171], a[196:199], v[100:103]
  ds_read_b64_tr_b16 a[194:195], v179 offset:7168
  ds_read_b64_tr_b16 a[196:197], v178 offset:16384
  s_add_u32 m0, s42, 24576
  s_waitcnt lgkmcnt(13)
  v_mfma_f32_16x16x32_bf16 v[96:99], a[200:203], v[172:175], v[96:99]
  buffer_load_dwordx4 v217, s[60:63], s41 offen offset:0 nt lds
  v_mfma_f32_16x16x32_bf16 v[100:103], v[172:175], a[204:207], v[100:103]
  ds_read_b64_tr_b16 a[198:199], v178 offset:17408
  ds_read_b64_tr_b16 a[200:201], v178 offset:18432
  s_mov_b32 s41, 1966080
  v_mfma_f32_16x16x32_bf16 v[8:11], a[208:211], a[32:35], v[8:11]
  ds_read_b64_tr_b16 a[202:203], v178 offset:19456
  ds_read_b64_tr_b16 a[204:205], v179 offset:16384
  s_add_u32 m0, s42, 45056
  ds_write_b128 v192, v[96:99] offset:0
  ds_write_b128 v192, v[100:103] offset:1024
  v_mfma_f32_16x16x32_bf16 v[8:11], a[212:215], a[40:43], v[8:11]
  buffer_load_dwordx4 v217, s[60:63], s41 offen offset:0 nt lds
  v_mfma_f32_16x16x32_bf16 v[32:35], a[208:211], a[36:39], v[32:35]
  ds_read_b64_tr_b16 a[206:207], v179 offset:17408
  ds_read_b64_tr_b16 a[208:209], v179 offset:18432
  s_mov_b32 s41, 2359296
  v_mfma_f32_16x16x32_bf16 v[32:35], a[212:215], a[44:47], v[32:35]
  ds_read_b64_tr_b16 a[210:211], v179 offset:19456
  ds_read_b64_tr_b16 a[212:213], v178 offset:24576
  s_add_u32 m0, s42, 36864
  s_waitcnt lgkmcnt(13)
  v_mfma_f32_16x16x32_bf16 v[12:15], a[216:219], a[32:35], v[12:15]
  ds_read_b64_tr_b16 a[214:215], v178 offset:25600
  v_mfma_f32_16x16x32_bf16 v[12:15], a[220:223], a[40:43], v[12:15]
  buffer_load_dwordx4 v217, s[60:63], s41 offen offset:0 nt lds
  v_mfma_f32_16x16x32_bf16 v[36:39], a[216:219], a[36:39], v[36:39]
  ds_read_b64_tr_b16 a[216:217], v178 offset:26624
  ds_read_b64_tr_b16 a[218:219], v178 offset:27648
  s_load_dwordx2 s[66:67], s[36:37], 0x0
  v_mfma_f32_16x16x32_bf16 v[36:39], a[220:223], a[44:47], v[36:39]
  ds_read_b64_tr_b16 a[220:221], v179 offset:24576
  ds_read_b64_tr_b16 a[222:223], v179 offset:25600
  s_waitcnt lgkmcnt(9)
  v_mfma_f32_16x16x32_bf16 v[16:19], a[32:35], a[224:227], v[16:19]
  v_mfma_f32_16x16x32_bf16 v[16:19], a[40:43], a[228:231], v[16:19]
  v_mfma_f32_16x16x32_bf16 v[40:43], a[36:39], a[224:227], v[40:43]
  ds_read_b64_tr_b16 a[224:225], v179 offset:26624
  ds_read_b64_tr_b16 a[226:227], v179 offset:27648
  v_mfma_f32_16x16x32_bf16 v[40:43], a[44:47], a[228:231], v[40:43]
  ds_read_b64_tr_b16 a[228:229], v178 offset:53248
  ds_read_b64_tr_b16 a[230:231], v178 offset:54272
  v_mfma_f32_16x16x32_bf16 v[20:23], a[32:35], a[232:235], v[20:23]
  v_mfma_f32_16x16x32_bf16 v[20:23], a[40:43], a[192:195], v[20:23]
  v_mfma_f32_16x16x32_bf16 v[44:47], a[36:39], a[232:235], v[44:47]
  ds_read_b64_tr_b16 a[232:233], v178 offset:55296
  ds_read_b64_tr_b16 a[234:235], v178 offset:56320
  v_mfma_f32_16x16x32_bf16 v[44:47], a[44:47], a[192:195], v[44:47]
  ds_read_b64_tr_b16 a[192:193], v179 offset:53248
  ds_read_b64_tr_b16 a[194:195], v179 offset:54272
  v_mfma_f32_16x16x32_bf16 v[0:3], a[196:199], a[32:35], v[0:3]
  v_mfma_f32_16x16x32_bf16 v[0:3], a[200:203], a[40:43], v[0:3]
  v_mfma_f32_16x16x32_bf16 v[24:27], a[196:199], a[36:39], v[24:27]
  ds_read_b64_tr_b16 a[196:197], v179 offset:55296
  ds_read_b64_tr_b16 a[198:199], v179 offset:56320
  v_mfma_f32_16x16x32_bf16 v[24:27], a[200:203], a[44:47], v[24:27]
  s_waitcnt lgkmcnt(13)
  v_mfma_f32_16x16x32_bf16 v[4:7], a[204:207], a[32:35], v[4:7]
  v_mfma_f32_16x16x32_bf16 v[4:7], a[208:211], a[40:43], v[4:7]
  v_mfma_f32_16x16x32_bf16 v[28:31], a[204:207], a[36:39], v[28:31]
  v_mfma_f32_16x16x32_bf16 v[28:31], a[208:211], a[44:47], v[28:31]
  s_waitcnt vmcnt(8)
  s_barrier
  ds_read_b64_tr_b16 a[200:201], v180 offset:0
  ds_read_b128 v[200:203], v191 offset:0
  ds_read_b128 v[204:207], v191 offset:1024
  s_load_dwordx2 s[66:67], s[36:37], 0x10000
  v_mfma_f32_16x16x32_bf16 v[8:11], a[212:215], a[48:51], v[8:11]
  ds_read_b64_tr_b16 a[202:203], v180 offset:1024
  ds_read_b64_tr_b16 a[204:205], v180 offset:2048
  s_mov_b32 s41, 2752512
  s_waitcnt lgkmcnt(13)
  v_mfma_f32_16x16x32_bf16 v[8:11], a[216:219], a[56:59], v[8:11]
  ds_read_b64_tr_b16 a[206:207], v180 offset:3072
  ds_read_b64_tr_b16 a[208:209], v181 offset:0
  s_add_u32 m0, s42, 49152
  v_mfma_f32_16x16x32_bf16 v[32:35], a[212:215], a[52:55], v[32:35]
  buffer_load_dwordx4 v217, s[60:63], s41 offen offset:0 nt lds
  v_mfma_f32_16x16x32_bf16 v[32:35], a[216:219], a[60:63], v[32:35]
  ds_read_b64_tr_b16 a[210:211], v181 offset:1024
  ds_read_b64_tr_b16 a[212:213], v181 offset:2048
  s_mov_b32 s41, 0
  v_mfma_f32_16x16x32_bf16 v[12:15], a[220:223], a[48:51], v[12:15]
  ds_read_b64_tr_b16 a[214:215], v181 offset:3072
  ds_read_b64_tr_b16 a[216:217], v182 offset:61440
  s_add_u32 m0, s42, 69632
  s_waitcnt lgkmcnt(8)
  v_add_f32 v200, v200, v96
  v_add_f32 v201, v201, v97
  v_add_f32 v202, v202, v98
  v_add_f32 v203, v203, v99
  v_add_f32 v204, v204, v100
  v_add_f32 v205, v205, v101
  v_add_f32 v206, v206, v102
  v_add_f32 v207, v207, v103
  v_cvt_pk_bf16_f32 v196, v200, v201
  v_cvt_pk_bf16_f32 v197, v202, v203
  v_mfma_f32_16x16x32_bf16 v[12:15], a[224:227], a[56:59], v[12:15]
  buffer_load_dwordx4 v241, s[8:11], s41 offen offset:0 lds
  v_cvt_pk_bf16_f32 v198, v204, v205
  v_cvt_pk_bf16_f32 v199, v206, v207
  ds_write_b64 v208, v[196:197] offset:0
  ds_write_b64 v208, v[198:199] offset:1024
  v_mfma_f32_16x16x32_bf16 v[36:39], a[220:223], a[52:55], v[36:39]
  ds_read_b64_tr_b16 a[218:219], v182 offset:62464
  ds_read_b64_tr_b16 a[220:221], v183 offset:12288
  s_mov_b32 s41, 131072
  v_mfma_f32_16x16x32_bf16 v[36:39], a[224:227], a[60:63], v[36:39]
  ds_read_b64_tr_b16 a[222:223], v183 offset:13312
  ds_read_b64_tr_b16 a[224:225], v176 offset:61440
  s_add_u32 m0, s42, 81920
  v_cvt_pk_bf16_f32 v128, v32, v33
  v_cvt_pk_bf16_f32 v129, v34, v35
  v_mfma_f32_16x16x32_bf16 v[16:19], a[48:51], a[228:231], v[16:19]
  ds_read_b64_tr_b16 a[226:227], v176 offset:62464
  v_mfma_f32_16x16x32_bf16 v[16:19], a[56:59], a[232:235], v[16:19]
  buffer_load_dwordx4 v241, s[8:11], s41 offen offset:0 lds
  v_cvt_pk_bf16_f32 v130, v36, v37
  v_cvt_pk_bf16_f32 v131, v38, v39
  ds_write_b128 v191, v[128:131]
  v_cvt_pk_bf16_f32 v124, v8, v9
  v_cvt_pk_bf16_f32 v125, v10, v11
  v_cvt_pk_bf16_f32 v126, v12, v13
  v_cvt_pk_bf16_f32 v127, v14, v15
  v_mfma_f32_16x16x32_bf16 v[40:43], a[52:55], a[228:231], v[40:43]
  ds_read_b64_tr_b16 a[228:229], v176 offset:63488
  ds_read_b64_tr_b16 a[230:231], v176 offset:64512
  v_mfma_f32_16x16x32_bf16 v[40:43], a[60:63], a[232:235], v[40:43]
  ds_read_b64_tr_b16 a[232:233], v177 offset:61440
  ds_read_b64_tr_b16 a[234:235], v177 offset:62464
  v_mfma_f32_16x16x32_bf16 v[20:23], a[48:51], a[192:195], v[20:23]
  v_mfma_f32_16x16x32_bf16 v[20:23], a[56:59], a[196:199], v[20:23]
  v_mfma_f32_16x16x32_bf16 v[44:47], a[52:55], a[192:195], v[44:47]
  ds_read_b64_tr_b16 a[192:193], v177 offset:63488
  ds_read_b64_tr_b16 a[194:195], v177 offset:64512
  v_mfma_f32_16x16x32_bf16 v[44:47], a[60:63], a[196:199], v[44:47]
  ds_read_b64_tr_b16 a[196:197], v178 offset:12288
  ds_read_b64_tr_b16 a[198:199], v178 offset:13312
  v_cvt_pk_bf16_f32 v136, v40, v41
  v_cvt_pk_bf16_f32 v137, v42, v43
  s_waitcnt lgkmcnt(13)
  v_mfma_f32_16x16x32_bf16 v[0:3], a[200:203], a[48:51], v[0:3]
  s_load_dwordx2 s[66:67], s[36:37], 0x20000
  v_mfma_f32_16x16x32_bf16 v[0:3], a[204:207], a[56:59], v[0:3]
  v_cvt_pk_bf16_f32 v142, v44, v45
  v_cvt_pk_bf16_f32 v143, v46, v47
  ds_write_b64 v191, v[136:137] offset:1024
  ds_write_b64 v191, v[142:143] offset:1032
  v_cvt_pk_bf16_f32 v134, v16, v17
  v_cvt_pk_bf16_f32 v135, v18, v19
  v_cvt_pk_bf16_f32 v140, v20, v21
  v_cvt_pk_bf16_f32 v141, v22, v23
  v_mfma_f32_16x16x32_bf16 v[24:27], a[200:203], a[52:55], v[24:27]
  ds_read_b64_tr_b16 a[200:201], v178 offset:14336
  ds_read_b64_tr_b16 a[202:203], v178 offset:15360
  v_mfma_f32_16x16x32_bf16 v[24:27], a[204:207], a[60:63], v[24:27]
  ds_read_b64_tr_b16 a[204:205], v179 offset:12288
  ds_read_b64_tr_b16 a[206:207], v179 offset:13312
  v_mfma_f32_16x16x32_bf16 v[4:7], a[208:211], a[48:51], v[4:7]
  v_mfma_f32_16x16x32_bf16 v[4:7], a[212:215], a[56:59], v[4:7]
  v_mfma_f32_16x16x32_bf16 v[28:31], a[208:211], a[52:55], v[28:31]
  ds_read_b64_tr_b16 a[208:209], v179 offset:14336
  ds_read_b64_tr_b16 a[210:211], v179 offset:15360
  v_mfma_f32_16x16x32_bf16 v[28:31], a[212:215], a[60:63], v[28:31]
  ds_read_b64_tr_b16 a[212:213], v178 offset:8192
  ds_read_b64_tr_b16 a[214:215], v178 offset:9216
  v_cvt_pk_bf16_f32 v116, v24, v25
  v_cvt_pk_bf16_f32 v117, v26, v27
  v_mfma_f32_16x16x32_bf16 v[104:107], a[216:219], v[144:147], v[104:107]
  ds_read_b64_tr_b16 a[216:217], v178 offset:10240
  ds_read_b64_tr_b16 a[218:219], v178 offset:11264
  s_waitcnt lgkmcnt(13)
  v_mfma_f32_16x16x32_bf16 v[108:111], v[144:147], a[220:223], v[108:111]
  ds_read_b64_tr_b16 a[220:221], v179 offset:8192
  ds_read_b64_tr_b16 a[222:223], v179 offset:9216
  v_cvt_pk_bf16_f32 v118, v28, v29
  v_cvt_pk_bf16_f32 v119, v30, v31
  v_cvt_pk_bf16_f32 v112, v0, v1
  v_cvt_pk_bf16_f32 v113, v2, v3
  v_cvt_pk_bf16_f32 v114, v4, v5
  v_cvt_pk_bf16_f32 v115, v6, v7
  v_mfma_f32_16x16x32_bf16 v[56:59], a[224:227], a[128:131], v[56:59]
  s_waitcnt lgkmcnt(12)
  ds_read_b128 v[24:27], v250 offset:11264
  ds_read_b128 v[28:31], v250 offset:11328
  v_mfma_f32_16x16x32_bf16 v[56:59], a[228:231], a[136:139], v[56:59]
  ds_read_b128 v[32:35], v250 offset:11392
  ds_read_b128 v[36:39], v250 offset:11456
  ds_read_b128 v[40:43], v250 offset:11520
  v_mfma_f32_16x16x32_bf16 v[80:83], a[224:227], a[132:135], v[80:83]
  ds_read_b64_tr_b16 a[224:225], v179 offset:10240
  ds_read_b64_tr_b16 a[226:227], v179 offset:11264
  ds_read_b128 v[44:47], v250 offset:11584
  v_mfma_f32_16x16x32_bf16 v[80:83], a[228:231], a[140:143], v[80:83]
  s_barrier
  ds_read_b64_tr_b16 a[228:229], v183 offset:20480
  ds_read_b128 v[120:123], v209
  ds_read_b64 v[132:133], v209 offset:1024
  ds_read_b64 v[138:139], v209 offset:1032
  v_mfma_f32_16x16x32_bf16 v[4:7], v[128:131], v[116:119], 0
  v_mfma_f32_16x16x32_bf16 v[60:63], a[232:235], a[128:131], v[60:63]
  ds_read_b64_tr_b16 a[230:231], v183 offset:21504
  s_mov_b32 s41, 262144
  s_add_u32 m0, s42, 61440
  v_mfma_f32_16x16x32_bf16 v[0:3], v[124:127], v[116:119], 0
  v_mfma_f32_16x16x32_bf16 v[60:63], a[192:195], a[136:139], v[60:63]
  buffer_load_dwordx4 v241, s[8:11], s41 offen offset:0 lds
  v_mfma_f32_16x16x32_bf16 v[12:15], v[124:127], v[112:115], 0
  v_mfma_f32_16x16x32_bf16 v[84:87], a[232:235], a[132:135], v[84:87]
  ds_read_b64_tr_b16 a[232:233], v183 offset:36864
  ds_read_b64_tr_b16 a[234:235], v183 offset:37888
  s_mov_b32 s41, 393216
  v_mfma_f32_16x16x32_bf16 v[84:87], a[192:195], a[140:143], v[84:87]
  ds_read_b64_tr_b16 a[192:193], v178 offset:20480
  ds_read_b64_tr_b16 a[194:195], v178 offset:21504
  s_add_u32 m0, s42, 90112
  ds_read_b128 v[96:99], v250 offset:11648
  s_load_dwordx2 s[66:67], s[36:37], 0x30000
  v_mfma_f32_16x16x32_bf16 v[64:67], a[128:131], a[196:199], v[64:67]
  buffer_load_dwordx4 v241, s[8:11], s41 offen offset:0 lds
  ds_read_b128 v[100:103], v250 offset:11712
  s_waitcnt lgkmcnt(13)
  v_mfma_f32_16x16x32_bf16 v[64:67], a[136:139], a[200:203], v[64:67]
  s_mov_b32 s41, 524288
  s_add_u32 m0, s42, 118784
  v_mfma_f32_16x16x32_bf16 v[88:91], a[132:135], a[196:199], v[88:91]
  ds_read_b64_tr_b16 a[196:197], v178 offset:22528
  ds_read_b64_tr_b16 a[198:199], v178 offset:23552
  s_waitcnt lgkmcnt(9)
  v_mfma_f32_16x16x32_bf16 v[8:11], v[120:123], v[112:115], 0
  v_cndmask_b32_e64 v0, v0, v1, s[28:29]
  v_cndmask_b32_e64 v2, v2, v3, s[28:29]
  v_cndmask_b32_e64 v4, v4, v5, s[28:29]
  v_cndmask_b32_e64 v6, v6, v7, s[28:29]
  v_mfma_f32_16x16x32_bf16 v[88:91], a[140:143], a[200:203], v[88:91]
  ds_read_b64_tr_b16 a[200:201], v179 offset:20480
  ds_read_b64_tr_b16 a[202:203], v179 offset:21504
  v_mfma_f32_16x16x32_bf16 v[68:71], a[128:131], a[204:207], v[68:71]
  buffer_load_dwordx4 v241, s[8:11], s41 offen offset:0 lds
  v_cndmask_b32_e64 v8, v8, v9, s[28:29]
  v_cndmask_b32_e64 v10, v10, v11, s[28:29]
  v_cndmask_b32_e64 v12, v12, v13, s[28:29]
  v_cndmask_b32_e64 v14, v14, v15, s[28:29]
  v_cndmask_b32_e64 v0, v0, v4, s[24:25]
  v_cndmask_b32_e64 v1, v2, v6, s[26:27]
  v_cndmask_b32_e64 v8, v8, v12, s[24:25]
  v_cndmask_b32_e64 v9, v10, v14, s[26:27]
  v_mfma_f32_16x16x32_bf16 v[68:71], a[136:139], a[208:211], v[68:71]
  s_mov_b32 s41, 655360
  s_add_u32 m0, s42, 131072
  s_mov_b32 s33, 0x3e8293ee
  v_mul_f32 v0, s33, v0
  v_mul_f32 v1, s33, v1
  v_fma_f32 v8, v8, s33, v193
  v_fma_f32 v9, v9, s33, v194
  v_max_f32 v16, v0, v1
  v_max_f32 v17, v8, v9
  v_mov_b32 v20, v16
  v_mov_b32 v21, v17
  v_mfma_f32_16x16x32_bf16 v[92:95], a[132:135], a[204:207], v[92:95]
  ds_read_b64_tr_b16 a[204:205], v179 offset:22528
  ds_read_b64_tr_b16 a[206:207], v179 offset:23552
  v_permlane16_swap_b32 v20, v16
  v_permlane16_swap_b32 v21, v17
  v_mfma_f32_16x16x32_bf16 v[92:95], a[140:143], a[208:211], v[92:95]
  ds_read_b64_tr_b16 a[208:209], v178 offset:36864
  ds_read_b64_tr_b16 a[210:211], v178 offset:37888
  v_max_f32 v16, v16, v20
  v_max_f32 v17, v17, v21
  v_mov_b32 v20, v16
  v_mov_b32 v21, v17
  v_mfma_f32_16x16x32_bf16 v[48:51], a[212:215], a[128:131], v[48:51]
  buffer_load_dwordx4 v241, s[8:11], s41 offen offset:0 lds
  v_permlane32_swap_b32 v20, v16
  v_permlane32_swap_b32 v21, v17
  v_mfma_f32_16x16x32_bf16 v[48:51], a[216:219], a[136:139], v[48:51]
  v_max_f32 v16, v16, v20
  v_max_f32 v17, v17, v21
  v_sub_f32 v0, v0, v16
  v_sub_f32 v1, v1, v16
  v_sub_f32 v8, v8, v17
  v_sub_f32 v9, v9, v17
  v_exp_f32 v0, v0
  v_exp_f32 v1, v1
  v_mfma_f32_16x16x32_bf16 v[72:75], a[212:215], a[132:135], v[72:75]
  ds_read_b64_tr_b16 a[212:213], v178 offset:38912
  ds_read_b64_tr_b16 a[214:215], v178 offset:39936
  v_exp_f32 v8, v8
  v_exp_f32 v9, v9
  v_add_f32 v16, v0, v1
  v_add_f32 v17, v8, v9
  v_mov_b32 v20, v16
  v_mfma_f32_16x16x32_bf16 v[72:75], a[216:219], a[140:143], v[72:75]
  ds_read_b64_tr_b16 a[216:217], v179 offset:36864
  ds_read_b64_tr_b16 a[218:219], v179 offset:37888
  v_mov_b32 v21, v17
  v_permlane16_swap_b32 v20, v16
  v_mfma_f32_16x16x32_bf16 v[52:55], a[220:223], a[128:131], v[52:55]
  v_permlane16_swap_b32 v21, v17
  v_add_f32 v16, v16, v20
  v_mfma_f32_16x16x32_bf16 v[52:55], a[224:227], a[136:139], v[52:55]
  v_add_f32 v17, v17, v21
  v_mov_b32 v20, v16
  v_mov_b32 v21, v17
  v_mfma_f32_16x16x32_bf16 v[76:79], a[220:223], a[132:135], v[76:79]
  ds_read_b64_tr_b16 a[220:221], v179 offset:38912
  ds_read_b64_tr_b16 a[222:223], v179 offset:39936
  v_permlane32_swap_b32 v20, v16
  v_permlane32_swap_b32 v21, v17
  v_mfma_f32_16x16x32_bf16 v[76:79], a[224:227], a[140:143], v[76:79]
  s_barrier
  ds_read_b64_tr_b16 a[224:225], v178 offset:32768
  v_add_f32 v16, v16, v20
  v_add_f32 v17, v17, v21
  v_rcp_f32 v16, v16
  v_rcp_f32 v17, v17
  v_mul_f32 v0, v0, v16
  v_mul_f32 v1, v1, v16
  v_mul_f32 v8, v8, v17
  v_mul_f32 v9, v9, v17
  v_cvt_pk_bf16_f32 v0, v0, 0
  s_waitcnt lgkmcnt(13)
  v_mfma_f32_16x16x32_bf16 v[104:107], a[228:231], v[148:151], v[104:107]
  ds_read_b64_tr_b16 a[226:227], v178 offset:33792
  ds_read_b64_tr_b16 a[228:229], v178 offset:34816
  s_mov_b32 s41, 786432
  v_cvt_pk_bf16_f32 v1, v1, 0
  v_cvt_pk_bf16_f32 v8, v8, 0
  v_cvt_pk_bf16_f32 v9, v9, 0
  v_lshlrev_b32 v0, v195, v0
  v_lshlrev_b32 v1, v195, v1
  v_lshlrev_b32 v8, v195, v8
  s_load_dwordx2 s[66:67], s[36:37], 0x40000
  v_mfma_f32_16x16x32_bf16 v[108:111], v[148:151], a[232:235], v[108:111]
  ds_read_b64_tr_b16 a[230:231], v178 offset:35840
  ds_read_b64_tr_b16 a[232:233], v179 offset:32768
  s_add_u32 m0, s42, 77824
  v_lshlrev_b32 v9, v195, v9
  v_cndmask_b32_e64 v112, v0, 0, s[24:25]
  v_cndmask_b32_e64 v114, 0, v0, s[24:25]
  v_cndmask_b32_e64 v113, v1, 0, s[26:27]
  v_cndmask_b32_e64 v115, 0, v1, s[26:27]
  v_cndmask_b32_e64 v116, v8, 0, s[24:25]
  v_mfma_f32_16x16x32_bf16 v[56:59], a[192:195], a[144:147], v[56:59]
  buffer_load_dwordx4 v241, s[8:11], s41 offen offset:0 lds
  v_cndmask_b32_e64 v118, 0, v8, s[24:25]
  v_cndmask_b32_e64 v117, v9, 0, s[26:27]
  v_cndmask_b32_e64 v119, 0, v9, s[26:27]
  v_mfma_f32_16x16x32_bf16 v[56:59], a[196:199], a[152:155], v[56:59]
  ds_read_b64_tr_b16 a[234:235], v179 offset:33792
  s_mov_b32 s41, 917504
  s_add_u32 m0, s42, 73728
  v_mfma_f32_16x16x32_bf16 v[0:3], v[134:137], v[112:115], 0
  v_mfma_f32_16x16x32_bf16 v[80:83], a[192:195], a[148:151], v[80:83]
  ds_read_b64_tr_b16 a[192:193], v179 offset:34816
  ds_read_b64_tr_b16 a[194:195], v179 offset:35840
  v_mfma_f32_16x16x32_bf16 v[4:7], v[140:143], v[112:115], 0
  v_mfma_f32_16x16x32_bf16 v[8:11], v[132:135], v[116:119], 0
  v_mfma_f32_16x16x32_bf16 v[80:83], a[196:199], a[156:159], v[80:83]
  buffer_load_dwordx4 v241, s[8:11], s41 offen offset:0 lds
  v_mfma_f32_16x16x32_bf16 v[12:15], v[138:141], v[116:119], 0
  v_cvt_pk_bf16_f32 v120, v0, v1
  v_cvt_pk_bf16_f32 v121, v2, v3
  s_waitcnt lgkmcnt(13)
  v_mfma_f32_16x16x32_bf16 v[60:63], a[200:203], a[144:147], v[60:63]
  ds_read_b64_tr_b16 a[196:197], v183 offset:45056
  ds_read_b64_tr_b16 a[198:199], v183 offset:46080
  v_cvt_pk_bf16_f32 v122, v4, v5
  v_cvt_pk_bf16_f32 v123, v6, v7
  buffer_store_dwordx4 v[120:123], v187, s[4:7], s78 offen offset:1024 sc1
  v_cvt_pk_bf16_f32 v124, v8, v9
  v_cvt_pk_bf16_f32 v125, v10, v11
  v_cvt_pk_bf16_f32 v126, v12, v13
  v_cvt_pk_bf16_f32 v127, v14, v15
  v_mfma_f32_16x16x32_bf16 v[60:63], a[204:207], a[152:155], v[60:63]
  buffer_store_dwordx4 v[124:127], v187, s[4:7], s78 offen offset:0 sc1
  s_add_u32 s78, s78, 2097152
  v_mfma_f32_16x16x32_bf16 v[84:87], a[200:203], a[148:151], v[84:87]
  ds_read_b64_tr_b16 a[200:201], v183 offset:61440
  ds_read_b64_tr_b16 a[202:203], v183 offset:62464
  v_mfma_f32_16x16x32_bf16 v[84:87], a[204:207], a[156:159], v[84:87]
  ds_read_b64_tr_b16 a[204:205], v178 offset:45056
  ds_read_b64_tr_b16 a[206:207], v178 offset:46080
  v_mfma_f32_16x16x32_bf16 v[64:67], a[144:147], a[208:211], v[64:67]
  s_waitcnt lgkmcnt(13)
  v_mfma_f32_16x16x32_bf16 v[64:67], a[152:155], a[212:215], v[64:67]
  v_mfma_f32_16x16x32_bf16 v[88:91], a[148:151], a[208:211], v[88:91]
  ds_read_b64_tr_b16 a[208:209], v178 offset:47104
  ds_read_b64_tr_b16 a[210:211], v178 offset:48128
  v_mfma_f32_16x16x32_bf16 v[88:91], a[156:159], a[212:215], v[88:91]
  ds_read_b64_tr_b16 a[212:213], v179 offset:45056
  ds_read_b64_tr_b16 a[214:215], v179 offset:46080
  v_mfma_f32_16x16x32_bf16 v[68:71], a[144:147], a[216:219], v[68:71]
  v_mfma_f32_16x16x32_bf16 v[68:71], a[152:155], a[220:223], v[68:71]
  v_mfma_f32_16x16x32_bf16 v[92:95], a[148:151], a[216:219], v[92:95]
  ds_read_b64_tr_b16 a[216:217], v179 offset:47104
  ds_read_b64_tr_b16 a[218:219], v179 offset:48128
  v_mfma_f32_16x16x32_bf16 v[92:95], a[156:159], a[220:223], v[92:95]
  ds_read_b64_tr_b16 a[220:221], v178 offset:61440
  ds_read_b64_tr_b16 a[222:223], v178 offset:62464
  s_load_dwordx2 s[66:67], s[36:37], 0x50000
  s_waitcnt lgkmcnt(13)
  v_mfma_f32_16x16x32_bf16 v[48:51], a[224:227], a[144:147], v[48:51]
  v_mfma_f32_16x16x32_bf16 v[48:51], a[228:231], a[152:155], v[48:51]
  v_mfma_f32_16x16x32_bf16 v[72:75], a[224:227], a[148:151], v[72:75]
  ds_read_b64_tr_b16 a[224:225], v178 offset:63488
  ds_read_b64_tr_b16 a[226:227], v178 offset:64512
  v_mfma_f32_16x16x32_bf16 v[72:75], a[228:231], a[156:159], v[72:75]
  ds_read_b64_tr_b16 a[228:229], v179 offset:61440
  ds_read_b64_tr_b16 a[230:231], v179 offset:62464
  v_mfma_f32_16x16x32_bf16 v[52:55], a[232:235], a[144:147], v[52:55]
  v_mfma_f32_16x16x32_bf16 v[52:55], a[192:195], a[152:155], v[52:55]
  v_mfma_f32_16x16x32_bf16 v[76:79], a[232:235], a[148:151], v[76:79]
  ds_read_b64_tr_b16 a[232:233], v179 offset:63488
  ds_read_b64_tr_b16 a[234:235], v179 offset:64512
  v_mfma_f32_16x16x32_bf16 v[76:79], a[192:195], a[156:159], v[76:79]
  s_barrier
  ds_read_b64_tr_b16 a[192:193], v178 offset:57344
  s_waitcnt lgkmcnt(13)
  v_mfma_f32_16x16x32_bf16 v[104:107], a[196:199], v[152:155], v[104:107]
  ds_read_b64_tr_b16 a[194:195], v178 offset:58368
  ds_read_b64_tr_b16 a[196:197], v178 offset:59392
  s_mov_b32 s41, 1048576
  v_mfma_f32_16x16x32_bf16 v[108:111], v[152:155], a[200:203], v[108:111]
  ds_read_b64_tr_b16 a[198:199], v178 offset:60416
  ds_read_b64_tr_b16 a[200:201], v179 offset:57344
  s_add_u32 m0, s42, 86016
  v_mfma_f32_16x16x32_bf16 v[56:59], a[204:207], a[160:163], v[56:59]
  buffer_load_dwordx4 v241, s[8:11], s41 offen offset:0 lds
  v_mfma_f32_16x16x32_bf16 v[56:59], a[208:211], a[168:171], v[56:59]
  ds_read_b64_tr_b16 a[202:203], v179 offset:58368
  s_mov_b32 s41, 1179648
  s_add_u32 m0, s42, 102400
  v_mfma_f32_16x16x32_bf16 v[80:83], a[204:207], a[164:167], v[80:83]
  ds_read_b64_tr_b16 a[204:205], v179 offset:59392
  ds_read_b64_tr_b16 a[206:207], v179 offset:60416
  v_mfma_f32_16x16x32_bf16 v[80:83], a[208:211], a[172:175], v[80:83]
  buffer_load_dwordx4 v241, s[8:11], s41 offen offset:0 lds
  s_waitcnt lgkmcnt(13)
  v_mfma_f32_16x16x32_bf16 v[60:63], a[212:215], a[160:163], v[60:63]
  ds_read_b64_tr_b16 a[208:209], v184 offset:4096
  ds_read_b64_tr_b16 a[210:211], v184 offset:5120
  s_mov_b32 s41, 1310720
  v_mfma_f32_16x16x32_bf16 v[60:63], a[216:219], a[168:171], v[60:63]
  s_add_u32 m0, s42, 98304
  v_mfma_f32_16x16x32_bf16 v[84:87], a[212:215], a[164:167], v[84:87]
  ds_read_b64_tr_b16 a[212:213], v184 offset:20480
  ds_read_b64_tr_b16 a[214:215], v184 offset:21504
  s_load_dwordx2 s[66:67], s[36:37], 0x60000
  v_mfma_f32_16x16x32_bf16 v[84:87], a[216:219], a[172:175], v[84:87]
  buffer_load_dwordx4 v241, s[8:11], s41 offen offset:0 lds
  v_mfma_f32_16x16x32_bf16 v[64:67], a[160:163], a[220:223], v[64:67]
  ds_read_b64_tr_b16 a[216:217], v180 offset:4096
  ds_read_b64_tr_b16 a[218:219], v180 offset:5120
  s_waitcnt lgkmcnt(13)
  v_mfma_f32_16x16x32_bf16 v[64:67], a[168:171], a[224:227], v[64:67]
  v_mfma_f32_16x16x32_bf16 v[88:91], a[164:167], a[220:223], v[88:91]
  ds_read_b64_tr_b16 a[220:221], v180 offset:6144
  ds_read_b64_tr_b16 a[222:223], v180 offset:7168
  v_mfma_f32_16x16x32_bf16 v[88:91], a[172:175], a[224:227], v[88:91]
  ds_read_b64_tr_b16 a[224:225], v181 offset:4096
  ds_read_b64_tr_b16 a[226:227], v181 offset:5120
  v_mfma_f32_16x16x32_bf16 v[68:71], a[160:163], a[228:231], v[68:71]
  v_mfma_f32_16x16x32_bf16 v[68:71], a[168:171], a[232:235], v[68:71]
  v_mfma_f32_16x16x32_bf16 v[92:95], a[164:167], a[228:231], v[92:95]
  ds_read_b64_tr_b16 a[228:229], v181 offset:6144
  ds_read_b64_tr_b16 a[230:231], v181 offset:7168
  v_mfma_f32_16x16x32_bf16 v[92:95], a[172:175], a[232:235], v[92:95]
  ds_read_b64_tr_b16 a[232:233], v180 offset:20480
  ds_read_b64_tr_b16 a[234:235], v180 offset:21504
  s_waitcnt lgkmcnt(13)
  v_mfma_f32_16x16x32_bf16 v[48:51], a[192:195], a[160:163], v[48:51]
  v_mfma_f32_16x16x32_bf16 v[48:51], a[196:199], a[168:171], v[48:51]
  v_mfma_f32_16x16x32_bf16 v[72:75], a[192:195], a[164:167], v[72:75]
  ds_read_b64_tr_b16 a[192:193], v180 offset:22528
  ds_read_b64_tr_b16 a[194:195], v180 offset:23552
  v_mfma_f32_16x16x32_bf16 v[72:75], a[196:199], a[172:175], v[72:75]
  ds_read_b64_tr_b16 a[196:197], v181 offset:20480
  ds_read_b64_tr_b16 a[198:199], v181 offset:21504
  v_mfma_f32_16x16x32_bf16 v[52:55], a[200:203], a[160:163], v[52:55]
  v_mfma_f32_16x16x32_bf16 v[52:55], a[204:207], a[168:171], v[52:55]
  v_mfma_f32_16x16x32_bf16 v[76:79], a[200:203], a[164:167], v[76:79]
  ds_read_b64_tr_b16 a[200:201], v181 offset:22528
  ds_read_b64_tr_b16 a[202:203], v181 offset:23552
  v_mfma_f32_16x16x32_bf16 v[76:79], a[204:207], a[172:175], v[76:79]
  s_waitcnt vmcnt(13)
  s_barrier
  ds_read_b64_tr_b16 a[204:205], v180 offset:16384
  s_waitcnt vmcnt(3)
  v_add_u32 v248, 0, v245
  buffer_store_dword v248, v246, s[4:7], s79 offen sc1
  s_load_dwordx2 s[66:67], s[36:37], 0x70000
  s_add_u32 s36, s23, s44
  s_addc_u32 s37, s45, 0
  s_waitcnt lgkmcnt(13)
  v_mfma_f32_16x16x32_bf16 v[104:107], a[208:211], v[156:159], v[104:107]
  ds_read_b64_tr_b16 a[206:207], v180 offset:17408
  ds_read_b64_tr_b16 a[208:209], v180 offset:18432
L_wk0_3:
  s_cbranch_vccnz L_wk0_end
  s_mov_b32 s41, 1441792
  v_mfma_f32_16x16x32_bf16 v[108:111], v[156:159], a[212:215], v[108:111]
  ds_read_b64_tr_b16 a[210:211], v180 offset:19456
  ds_read_b64_tr_b16 a[212:213], v181 offset:16384
  s_add_u32 m0, s42, 110592
  v_mfma_f32_16x16x32_bf16 v[56:59], a[216:219], a[176:179], v[56:59]
  buffer_load_dwordx4 v241, s[8:11], s41 offen offset:0 lds
  v_mfma_f32_16x16x32_bf16 v[56:59], a[220:223], a[184:187], v[56:59]
  ds_read_b64_tr_b16 a[214:215], v181 offset:17408
  s_mov_b32 s41, 1572864
  s_add_u32 m0, s42, 126976
  v_mfma_f32_16x16x32_bf16 v[80:83], a[216:219], a[180:183], v[80:83]
  ds_read_b64_tr_b16 a[216:217], v181 offset:18432
  ds_read_b64_tr_b16 a[218:219], v181 offset:19456
  v_mfma_f32_16x16x32_bf16 v[80:83], a[220:223], a[188:191], v[80:83]
  buffer_load_dwordx4 v241, s[8:11], s41 offen offset:0 lds
  s_waitcnt lgkmcnt(13)
  v_mfma_f32_16x16x32_bf16 v[60:63], a[224:227], a[176:179], v[60:63]
  ds_read_b64_tr_b16 a[220:221], v216 offset:8192
  ds_read_b64_tr_b16 a[222:223], v216 offset:10240
  s_mov_b32 s41, 1703936
  v_mfma_f32_16x16x32_bf16 v[60:63], a[228:231], a[184:187], v[60:63]
  s_add_u32 m0, s42, 122880
  v_mfma_f32_16x16x32_bf16 v[84:87], a[224:227], a[180:183], v[84:87]
  ds_read_b64_tr_b16 a[224:225], v216 offset:24576
  ds_read_b64_tr_b16 a[226:227], v216 offset:26624
  v_mfma_f32_16x16x32_bf16 v[84:87], a[228:231], a[188:191], v[84:87]
  buffer_load_dwordx4 v241, s[8:11], s41 offen offset:0 lds
  v_mfma_f32_16x16x32_bf16 v[64:67], a[176:179], a[232:235], v[64:67]
  ds_read_b64_tr_b16 a[228:229], v214 offset:20480
  ds_read_b64_tr_b16 a[230:231], v214 offset:22528
  s_waitcnt lgkmcnt(13)
  v_mfma_f32_16x16x32_bf16 v[64:67], a[184:187], a[192:195], v[64:67]
  v_mfma_f32_16x16x32_bf16 v[88:91], a[180:183], a[232:235], v[88:91]
  ds_read_b64_tr_b16 a[232:233], v214 offset:12288
  ds_read_b64_tr_b16 a[234:235], v214 offset:14336
  v_mfma_f32_16x16x32_bf16 v[88:91], a[188:191], a[192:195], v[88:91]
  ds_read_b64_tr_b16 a[192:193], v214 offset:24576
  ds_read_b64_tr_b16 a[194:195], v214 offset:26624
  v_mfma_f32_16x16x32_bf16 v[68:71], a[176:179], a[196:199], v[68:71]
  v_mfma_f32_16x16x32_bf16 v[68:71], a[184:187], a[200:203], v[68:71]
  v_mfma_f32_16x16x32_bf16 v[92:95], a[180:183], a[196:199], v[92:95]
  ds_read_b64_tr_b16 a[196:197], v214 offset:45056
  ds_read_b64_tr_b16 a[198:199], v214 offset:47104
  v_mfma_f32_16x16x32_bf16 v[92:95], a[188:191], a[200:203], v[92:95]
  ds_read_b64_tr_b16 a[200:201], v214 offset:36864
  ds_read_b64_tr_b16 a[202:203], v214 offset:38912
  s_waitcnt lgkmcnt(13)
  v_mfma_f32_16x16x32_bf16 v[48:51], a[204:207], a[176:179], v[48:51]
  v_mfma_f32_16x16x32_bf16 v[48:51], a[208:211], a[184:187], v[48:51]
  v_mfma_f32_16x16x32_bf16 v[72:75], a[204:207], a[180:183], v[72:75]
  ds_read_b64_tr_b16 a[204:205], v214 offset:49152
  ds_read_b64_tr_b16 a[206:207], v214 offset:51200
  v_mfma_f32_16x16x32_bf16 v[72:75], a[208:211], a[188:191], v[72:75]
  ds_read_b64_tr_b16 a[208:209], v184 offset:28672
  ds_read_b64_tr_b16 a[210:211], v184 offset:29696
  v_mfma_f32_16x16x32_bf16 v[52:55], a[212:215], a[176:179], v[52:55]
  v_mfma_f32_16x16x32_bf16 v[52:55], a[216:219], a[184:187], v[52:55]
  v_mfma_f32_16x16x32_bf16 v[76:79], a[212:215], a[180:183], v[76:79]
  ds_read_b64_tr_b16 a[212:213], v182 offset:16384
  ds_read_b64_tr_b16 a[214:215], v182 offset:17408
  v_mfma_f32_16x16x32_bf16 v[76:79], a[216:219], a[188:191], v[76:79]
  s_barrier
  ds_read_b64_tr_b16 a[216:217], v180 offset:28672
  s_waitcnt lgkmcnt(13)
  v_mfma_f32_16x16x32_bf16 v[220:223], a[220:223], v[24:27], 0
  ds_read_b64_tr_b16 a[218:219], v180 offset:29696
  ds_read_b64_tr_b16 a[220:221], v180 offset:30720
  s_mov_b32 s41, 1835008
  v_mfma_f32_16x16x32_bf16 v[220:223], a[224:227], v[28:31], v[220:223]
  ds_read_b64_tr_b16 a[222:223], v180 offset:31744
  ds_read_b64_tr_b16 a[224:225], v181 offset:28672
  s_add_u32 m0, s42, 135168
  v_mfma_f32_16x16x32_bf16 v[220:223], a[228:231], v[32:35], v[220:223]
  buffer_load_dwordx4 v241, s[8:11], s41 offen offset:0 lds
  v_mfma_f32_16x16x32_bf16 v[220:223], a[232:235], v[36:39], v[220:223]
  ds_read_b64_tr_b16 a[226:227], v181 offset:29696
  ds_read_b64_tr_b16 a[228:229], v181 offset:30720
  s_mov_b32 s41, 1966080
  s_waitcnt lgkmcnt(13)
  v_mfma_f32_16x16x32_bf16 v[220:223], a[192:195], v[40:43], v[220:223]
  ds_read_b64_tr_b16 a[230:231], v181 offset:31744
  ds_read_b64_tr_b16 a[232:233], v176 offset:16384
  s_add_u32 m0, s42, 151552
  v_mfma_f32_16x16x32_bf16 v[220:223], a[196:199], v[44:47], v[220:223]
  buffer_load_dwordx4 v241, s[8:11], s41 offen offset:0 lds
  v_mfma_f32_16x16x32_bf16 v[220:223], a[200:203], v[96:99], v[220:223]
  ds_read_b64_tr_b16 a[234:235], v176 offset:17408
  ds_read_b64_tr_b16 a[192:193], v176 offset:18432
  s_mov_b32 s41, 65536
  s_waitcnt lgkmcnt(13)
  v_mfma_f32_16x16x32_bf16 v[220:223], a[204:207], v[100:103], v[220:223]
  ds_read_b64_tr_b16 a[194:195], v176 offset:19456
  ds_read_b64_tr_b16 a[196:197], v177 offset:16384
  s_add_u32 m0, s42, 147456
  v_mov_b32 v217, 0xff
  v_mfma_f32_16x16x32_bf16 v[104:107], a[208:211], v[160:163], v[104:107]
  ds_read_b64_tr_b16 a[198:199], v177 offset:17408
  ds_read_b64_tr_b16 a[200:201], v177 offset:18432
  s_waitcnt lgkmcnt(13)
  v_mfma_f32_16x16x32_bf16 v[108:111], v[160:163], a[212:215], v[108:111]
  buffer_load_dwordx4 v241, s[8:11], s41 offen offset:0 lds
  v_bfi_b32 v220, v217, s84, v220
  v_bfi_b32 v221, v217, s85, v221
  v_mfma_f32_16x16x32_bf16 v[56:59], a[216:219], a[0:3], v[56:59]
  ds_read_b64_tr_b16 a[202:203], v177 offset:19456
  ds_read_b64_tr_b16 a[204:205], v176 offset:28672
  v_bfi_b32 v222, v217, s86, v222
  s_waitcnt lgkmcnt(13)
  v_mfma_f32_16x16x32_bf16 v[56:59], a[220:223], a[8:11], v[56:59]
  ds_read_b64_tr_b16 a[206:207], v176 offset:29696
  ds_read_b64_tr_b16 a[208:209], v176 offset:30720
  buffer_load_dword v244, v243, s[4:7], s88 offen sc1
  v_bfi_b32 v223, v217, s87, v223
  v_mfma_f32_16x16x32_bf16 v[80:83], a[216:219], a[4:7], v[80:83]
  ds_read_b64_tr_b16 a[210:211], v176 offset:31744
  ds_read_b64_tr_b16 a[212:213], v177 offset:28672
  v_mfma_f32_16x16x32_bf16 v[80:83], a[220:223], a[12:15], v[80:83]
  ds_read_b64_tr_b16 a[214:215], v177 offset:29696
  ds_read_b64_tr_b16 a[216:217], v177 offset:30720
  buffer_store_dwordx4 v[220:223], v218, s[4:7], 0 offen sc1
  s_waitcnt lgkmcnt(13)
  v_mfma_f32_16x16x32_bf16 v[60:63], a[224:227], a[0:3], v[60:63]
  ds_read_b64_tr_b16 a[218:219], v177 offset:31744
  ds_read_b64_tr_b16 a[220:221], v182 offset:32768
  v_mfma_f32_16x16x32_bf16 v[60:63], a[228:231], a[8:11], v[60:63]
  ds_read_b64_tr_b16 a[222:223], v182 offset:33792
  v_mfma_f32_16x16x32_bf16 v[84:87], a[224:227], a[4:7], v[84:87]
  ds_read_b64_tr_b16 a[224:225], v182 offset:40960
  ds_read_b64_tr_b16 a[226:227], v182 offset:41984
  v_mfma_f32_16x16x32_bf16 v[84:87], a[228:231], a[12:15], v[84:87]
  ds_read_b64_tr_b16 a[228:229], v176 offset:32768
  ds_read_b64_tr_b16 a[230:231], v176 offset:33792
  buffer_load_dwordx4 v[32:35], v249, s[48:51], 0 offen offset:0
  v_mfma_f32_16x16x32_bf16 v[64:67], a[0:3], a[232:235], v[64:67]
  s_waitcnt lgkmcnt(13)
  v_mfma_f32_16x16x32_bf16 v[64:67], a[8:11], a[192:195], v[64:67]
  v_mfma_f32_16x16x32_bf16 v[88:91], a[4:7], a[232:235], v[88:91]
  ds_read_b64_tr_b16 a[232:233], v176 offset:34816
  ds_read_b64_tr_b16 a[234:235], v176 offset:35840
  v_mfma_f32_16x16x32_bf16 v[88:91], a[12:15], a[192:195], v[88:91]
  ds_read_b64_tr_b16 a[192:193], v177 offset:32768
  ds_read_b64_tr_b16 a[194:195], v177 offset:33792
  buffer_load_dwordx4 v[36:39], v249, s[48:51], 0 offen offset:64
  v_mfma_f32_16x16x32_bf16 v[68:71], a[0:3], a[196:199], v[68:71]
  v_mfma_f32_16x16x32_bf16 v[68:71], a[8:11], a[200:203], v[68:71]
  v_mfma_f32_16x16x32_bf16 v[92:95], a[4:7], a[196:199], v[92:95]
  ds_read_b64_tr_b16 a[196:197], v177 offset:34816
  ds_read_b64_tr_b16 a[198:199], v177 offset:35840
  v_mfma_f32_16x16x32_bf16 v[92:95], a[12:15], a[200:203], v[92:95]
  ds_read_b64_tr_b16 a[200:201], v176 offset:40960
  ds_read_b64_tr_b16 a[202:203], v176 offset:41984
  buffer_load_dwordx4 v[40:43], v249, s[48:51], s38 offen offset:0
  s_waitcnt lgkmcnt(13)
  v_mfma_f32_16x16x32_bf16 v[48:51], a[204:207], a[0:3], v[48:51]
  v_mfma_f32_16x16x32_bf16 v[48:51], a[208:211], a[8:11], v[48:51]
  v_mfma_f32_16x16x32_bf16 v[72:75], a[204:207], a[4:7], v[72:75]
  ds_read_b64_tr_b16 a[204:205], v176 offset:43008
  ds_read_b64_tr_b16 a[206:207], v176 offset:44032
  v_mfma_f32_16x16x32_bf16 v[72:75], a[208:211], a[12:15], v[72:75]
  ds_read_b64_tr_b16 a[208:209], v177 offset:40960
  ds_read_b64_tr_b16 a[210:211], v177 offset:41984
  buffer_load_dwordx4 v[44:47], v249, s[48:51], s38 offen offset:64
  v_mfma_f32_16x16x32_bf16 v[52:55], a[212:215], a[0:3], v[52:55]
  v_mfma_f32_16x16x32_bf16 v[52:55], a[216:219], a[8:11], v[52:55]
  v_mfma_f32_16x16x32_bf16 v[76:79], a[212:215], a[4:7], v[76:79]
  ds_read_b64_tr_b16 a[212:213], v177 offset:43008
  ds_read_b64_tr_b16 a[214:215], v177 offset:44032
  v_mfma_f32_16x16x32_bf16 v[76:79], a[216:219], a[12:15], v[76:79]
  s_barrier
  ds_read_b64_tr_b16 a[216:217], v176 offset:53248
  s_waitcnt lgkmcnt(13)
  v_mfma_f32_16x16x32_bf16 v[104:107], a[220:223], v[164:167], v[104:107]
  ds_read_b64_tr_b16 a[218:219], v176 offset:54272
  ds_read_b64_tr_b16 a[220:221], v176 offset:55296
  s_mov_b32 s41, 196608
  v_mfma_f32_16x16x32_bf16 v[108:111], v[164:167], a[224:227], v[108:111]
  ds_read_b64_tr_b16 a[222:223], v176 offset:56320
  ds_read_b64_tr_b16 a[224:225], v177 offset:53248
  s_add_u32 m0, s42, 159744
  v_mfma_f32_16x16x32_bf16 v[56:59], a[228:231], a[16:19], v[56:59]
  buffer_load_dwordx4 v241, s[8:11], s41 offen offset:0 lds
  v_mfma_f32_16x16x32_bf16 v[56:59], a[232:235], a[24:27], v[56:59]
  ds_read_b64_tr_b16 a[226:227], v177 offset:54272
  s_mov_b32 s41, 327680
  s_add_u32 m0, s42, 16384
  v_mfma_f32_16x16x32_bf16 v[80:83], a[228:231], a[20:23], v[80:83]
  ds_read_b64_tr_b16 a[228:229], v177 offset:55296
  ds_read_b64_tr_b16 a[230:231], v177 offset:56320
  v_mfma_f32_16x16x32_bf16 v[80:83], a[232:235], a[28:31], v[80:83]
  buffer_load_dwordx4 v241, s[8:11], s41 offen offset:0 lds
  s_waitcnt lgkmcnt(13)
  v_mfma_f32_16x16x32_bf16 v[60:63], a[192:195], a[16:19], v[60:63]
  ds_read_b64_tr_b16 a[232:233], v182 offset:57344
  ds_read_b64_tr_b16 a[234:235], v182 offset:58368
  s_mov_b32 s41, 458752
  v_mfma_f32_16x16x32_bf16 v[60:63], a[196:199], a[24:27], v[60:63]
  s_add_u32 m0, s42, 28672
  v_mfma_f32_16x16x32_bf16 v[84:87], a[192:195], a[20:23], v[84:87]
  ds_read_b64_tr_b16 a[192:193], v183 offset:0
  ds_read_b64_tr_b16 a[194:195], v183 offset:1024
  v_mfma_f32_16x16x32_bf16 v[84:87], a[196:199], a[28:31], v[84:87]
  buffer_load_dwordx4 v241, s[8:11], s41 offen offset:0 lds
  v_mfma_f32_16x16x32_bf16 v[64:67], a[16:19], a[200:203], v[64:67]
  ds_read_b64_tr_b16 a[196:197], v183 offset:40960
  ds_read_b64_tr_b16 a[198:199], v183 offset:41984
  s_mov_b32 s41, 589824
  s_waitcnt lgkmcnt(13)
  v_mfma_f32_16x16x32_bf16 v[64:67], a[24:27], a[204:207], v[64:67]
  s_add_u32 m0, s42, 139264
  v_mfma_f32_16x16x32_bf16 v[88:91], a[20:23], a[200:203], v[88:91]
  ds_read_b64_tr_b16 a[200:201], v183 offset:49152
  ds_read_b64_tr_b16 a[202:203], v183 offset:50176
  v_mfma_f32_16x16x32_bf16 v[88:91], a[28:31], a[204:207], v[88:91]
  buffer_load_dwordx4 v241, s[8:11], s41 offen offset:0 lds
  v_mfma_f32_16x16x32_bf16 v[68:71], a[16:19], a[208:211], v[68:71]
  ds_read_b64_tr_b16 a[204:205], v176 offset:57344
  ds_read_b64_tr_b16 a[206:207], v176 offset:58368
  s_mov_b32 s41, 720896
  v_mfma_f32_16x16x32_bf16 v[68:71], a[24:27], a[212:215], v[68:71]
  s_add_u32 m0, s42, 155648
  v_mfma_f32_16x16x32_bf16 v[92:95], a[20:23], a[208:211], v[92:95]
  ds_read_b64_tr_b16 a[208:209], v176 offset:59392
  ds_read_b64_tr_b16 a[210:211], v176 offset:60416
  v_mfma_f32_16x16x32_bf16 v[92:95], a[28:31], a[212:215], v[92:95]
  buffer_load_dwordx4 v241, s[8:11], s41 offen offset:0 lds
  s_waitcnt vmcnt(10)
  v_subrev_u32 v244, s100, v244
  v_cmp_lt_u32 s[68:69], 7, v244
  s_waitcnt lgkmcnt(13)
  v_mfma_f32_16x16x32_bf16 v[48:51], a[216:219], a[16:19], v[48:51]
  ds_read_b64_tr_b16 a[212:213], v177 offset:57344
  ds_read_b64_tr_b16 a[214:215], v177 offset:58368
  s_mov_b32 s41, 851968
  s_cmp_lg_u64 s[68:69], 0
  s_cbranch_scc1 L_slow_14
L_back_15:
  v_mfma_f32_16x16x32_bf16 v[48:51], a[220:223], a[24:27], v[48:51]
  s_add_u32 m0, s42, 20480
  v_mfma_f32_16x16x32_bf16 v[72:75], a[216:219], a[20:23], v[72:75]
  ds_read_b64_tr_b16 a[216:217], v177 offset:59392
  ds_read_b64_tr_b16 a[218:219], v177 offset:60416
  v_mfma_f32_16x16x32_bf16 v[72:75], a[220:223], a[28:31], v[72:75]
  buffer_load_dwordx4 v241, s[8:11], s41 offen offset:0 lds
  v_mfma_f32_16x16x32_bf16 v[52:55], a[224:227], a[16:19], v[52:55]
  ds_read_b64_tr_b16 a[220:221], v178 offset:0
  ds_read_b64_tr_b16 a[222:223], v178 offset:1024
  s_mov_b32 s40, 5242880
  s_waitcnt lgkmcnt(13)
  v_mfma_f32_16x16x32_bf16 v[52:55], a[228:231], a[24:27], v[52:55]
  v_mfma_f32_16x16x32_bf16 v[76:79], a[224:227], a[20:23], v[76:79]
  ds_read_b64_tr_b16 a[224:225], v178 offset:2048
  ds_read_b64_tr_b16 a[226:227], v178 offset:3072
  v_mfma_f32_16x16x32_bf16 v[76:79], a[228:231], a[28:31], v[76:79]
  s_barrier
  ds_read_b64_tr_b16 a[228:229], v179 offset:0
  v_mfma_f32_16x16x32_bf16 v[104:107], a[232:235], v[168:171], v[104:107]
  buffer_load_dwordx4 a[64:67], v240, s[4:7], s40 offen offset:0 sc1
  v_mfma_f32_16x16x32_bf16 v[108:111], v[168:171], a[192:195], v[108:111]
  ds_read_b64_tr_b16 a[230:231], v179 offset:1024
  ds_read_b64_tr_b16 a[232:233], v179 offset:2048
  s_waitcnt lgkmcnt(13)
  v_mfma_f32_16x16x32_bf16 v[104:107], a[196:199], v[172:175], v[104:107]
  ds_read_b64_tr_b16 a[234:235], v179 offset:3072
  ds_read_b64_tr_b16 a[192:193], v178 offset:28672
  v_mfma_f32_16x16x32_bf16 v[108:111], v[172:175], a[200:203], v[108:111]
  buffer_load_dwordx4 a[68:71], v240, s[4:7], s40 offen offset:1024 sc1
  s_mov_b32 s40, 5373952
  v_mfma_f32_16x16x32_bf16 v[56:59], a[204:207], a[32:35], v[56:59]
  ds_read_b64_tr_b16 a[194:195], v178 offset:29696
  ds_read_b64_tr_b16 a[196:197], v178 offset:30720
  ds_write_b128 v192, v[104:107] offset:0
  s_waitcnt lgkmcnt(13)
  v_mfma_f32_16x16x32_bf16 v[56:59], a[208:211], a[40:43], v[56:59]
  ds_read_b64_tr_b16 a[198:199], v178 offset:31744
  ds_read_b64_tr_b16 a[200:201], v179 offset:28672
  ds_write_b128 v192, v[108:111] offset:1024
  v_mfma_f32_16x16x32_bf16 v[80:83], a[204:207], a[36:39], v[80:83]
  ds_read_b64_tr_b16 a[202:203], v179 offset:29696
  ds_read_b64_tr_b16 a[204:205], v179 offset:30720
  v_mfma_f32_16x16x32_bf16 v[80:83], a[208:211], a[44:47], v[80:83]
  buffer_load_dwordx4 a[72:75], v240, s[4:7], s40 offen offset:0 sc1
  v_mfma_f32_16x16x32_bf16 v[60:63], a[212:215], a[32:35], v[60:63]
  ds_read_b64_tr_b16 a[206:207], v179 offset:31744
  ds_read_b64_tr_b16 a[208:209], v178 offset:40960
  s_waitcnt lgkmcnt(13)
  v_mfma_f32_16x16x32_bf16 v[60:63], a[216:219], a[40:43], v[60:63]
  ds_read_b64_tr_b16 a[210:211], v178 offset:41984
  v_mfma_f32_16x16x32_bf16 v[84:87], a[212:215], a[36:39], v[84:87]
  ds_read_b64_tr_b16 a[212:213], v178 offset:43008
  ds_read_b64_tr_b16 a[214:215], v178 offset:44032
  v_mfma_f32_16x16x32_bf16 v[84:87], a[216:219], a[44:47], v[84:87]
  buffer_load_dwordx4 a[76:79], v240, s[4:7], s40 offen offset:1024 sc1
  v_mfma_f32_16x16x32_bf16 v[64:67], a[32:35], a[220:223], v[64:67]
  ds_read_b64_tr_b16 a[216:217], v179 offset:40960
  ds_read_b64_tr_b16 a[218:219], v179 offset:41984
  s_mov_b32 s40, 5505024
  s_waitcnt lgkmcnt(9)
  v_mfma_f32_16x16x32_bf16 v[64:67], a[40:43], a[224:227], v[64:67]
  v_mfma_f32_16x16x32_bf16 v[88:91], a[36:39], a[220:223], v[88:91]
  ds_read_b64_tr_b16 a[220:221], v179 offset:43008
  ds_read_b64_tr_b16 a[222:223], v179 offset:44032
  v_mfma_f32_16x16x32_bf16 v[88:91], a[44:47], a[224:227], v[88:91]
  buffer_load_dwordx4 a[80:83], v240, s[4:7], s40 offen offset:0 sc1
  v_mfma_f32_16x16x32_bf16 v[68:71], a[32:35], a[228:231], v[68:71]
  ds_read_b64_tr_b16 a[224:225], v178 offset:49152
  ds_read_b64_tr_b16 a[226:227], v178 offset:50176
  v_mfma_f32_16x16x32_bf16 v[68:71], a[40:43], a[232:235], v[68:71]
  v_mfma_f32_16x16x32_bf16 v[92:95], a[36:39], a[228:231], v[92:95]
  ds_read_b64_tr_b16 a[228:229], v178 offset:51200
  ds_read_b64_tr_b16 a[230:231], v178 offset:52224
  v_mfma_f32_16x16x32_bf16 v[92:95], a[44:47], a[232:235], v[92:95]
  buffer_load_dwordx4 a[84:87], v240, s[4:7], s40 offen offset:1024 sc1
  s_mov_b32 s40, 5636096
  v_mfma_f32_16x16x32_bf16 v[48:51], a[192:195], a[32:35], v[48:51]
  ds_read_b64_tr_b16 a[232:233], v179 offset:49152
  ds_read_b64_tr_b16 a[234:235], v179 offset:50176
  v_mfma_f32_16x16x32_bf16 v[48:51], a[196:199], a[40:43], v[48:51]
  v_mfma_f32_16x16x32_bf16 v[72:75], a[192:195], a[36:39], v[72:75]
  ds_read_b64_tr_b16 a[192:193], v179 offset:51200
  ds_read_b64_tr_b16 a[194:195], v179 offset:52224
  v_mfma_f32_16x16x32_bf16 v[72:75], a[196:199], a[44:47], v[72:75]
  buffer_load_dwordx4 a[88:91], v240, s[4:7], s40 offen offset:0 sc1
  s_waitcnt lgkmcnt(13)
  v_mfma_f32_16x16x32_bf16 v[52:55], a[200:203], a[32:35], v[52:55]
  ds_read_b64_tr_b16 a[196:197], v180 offset:12288
  ds_read_b64_tr_b16 a[198:199], v180 offset:13312
  v_mfma_f32_16x16x32_bf16 v[52:55], a[204:207], a[40:43], v[52:55]
  v_mfma_f32_16x16x32_bf16 v[76:79], a[200:203], a[36:39], v[76:79]
  ds_read_b64_tr_b16 a[200:201], v180 offset:14336
  ds_read_b64_tr_b16 a[202:203], v180 offset:15360
  v_mfma_f32_16x16x32_bf16 v[76:79], a[204:207], a[44:47], v[76:79]
  s_barrier
  ds_read_b64_tr_b16 a[204:205], v181 offset:12288
  ds_read_b128 v[200:203], v191 offset:0
  ds_read_b128 v[204:207], v191 offset:1024
  v_mfma_f32_16x16x32_bf16 v[56:59], a[208:211], a[48:51], v[56:59]
  buffer_load_dwordx4 a[92:95], v240, s[4:7], s40 offen offset:1024 sc1
  s_waitcnt lgkmcnt(13)
  v_mfma_f32_16x16x32_bf16 v[56:59], a[212:215], a[56:59], v[56:59]
  ds_read_b64_tr_b16 a[206:207], v181 offset:13312
  s_mov_b32 s40, 5767168
  v_mfma_f32_16x16x32_bf16 v[80:83], a[208:211], a[52:55], v[80:83]
  ds_read_b64_tr_b16 a[208:209], v181 offset:14336
  ds_read_b64_tr_b16 a[210:211], v181 offset:15360
  v_mfma_f32_16x16x32_bf16 v[80:83], a[212:215], a[60:63], v[80:83]
  buffer_load_dwordx4 a[96:99], v240, s[4:7], s40 offen offset:0 sc1
  v_mfma_f32_16x16x32_bf16 v[60:63], a[216:219], a[48:51], v[60:63]
  ds_read_b64_tr_b16 a[212:213], v232 offset:4096
  ds_read_b64_tr_b16 a[214:215], v232 offset:6144
  v_mfma_f32_16x16x32_bf16 v[60:63], a[220:223], a[56:59], v[60:63]
  v_mfma_f32_16x16x32_bf16 v[84:87], a[216:219], a[52:55], v[84:87]
  ds_read_b64_tr_b16 a[216:217], v232 offset:16384
  ds_read_b64_tr_b16 a[218:219], v232 offset:18432
  v_mfma_f32_16x16x32_bf16 v[84:87], a[220:223], a[60:63], v[84:87]
  buffer_load_dwordx4 a[100:103], v240, s[4:7], s40 offen offset:1024 sc1
  s_mov_b32 s40, 5898240
  v_mfma_f32_16x16x32_bf16 v[64:67], a[48:51], a[224:227], v[64:67]
  ds_read_b64_tr_b16 a[220:221], v233 offset:4096
  ds_read_b64_tr_b16 a[222:223], v233 offset:6144
  s_waitcnt lgkmcnt(9)
  v_add_f32 v200, v200, v104
  v_add_f32 v201, v201, v105
  v_add_f32 v202, v202, v106
  v_add_f32 v203, v203, v107
  v_add_f32 v204, v204, v108
  v_add_f32 v205, v205, v109
  v_add_f32 v206, v206, v110
  v_add_f32 v207, v207, v111
  v_cvt_pk_bf16_f32 v196, v200, v201
  v_cvt_pk_bf16_f32 v197, v202, v203
  v_mfma_f32_16x16x32_bf16 v[64:67], a[56:59], a[228:231], v[64:67]
  v_cvt_pk_bf16_f32 v198, v204, v205
  v_cvt_pk_bf16_f32 v199, v206, v207
  ds_write_b64 v208, v[196:197] offset:0
  ds_write_b64 v208, v[198:199] offset:1024
  v_cvt_pk_bf16_f32 v128, v80, v81
  v_cvt_pk_bf16_f32 v129, v82, v83
  v_mfma_f32_16x16x32_bf16 v[88:91], a[52:55], a[224:227], v[88:91]
  ds_read_b64_tr_b16 a[224:225], v233 offset:16384
  ds_read_b64_tr_b16 a[226:227], v233 offset:18432
  v_cvt_pk_bf16_f32 v130, v84, v85
  v_cvt_pk_bf16_f32 v131, v86, v87
  ds_write_b128 v191, v[128:131]
  v_cvt_pk_bf16_f32 v124, v56, v57
  v_cvt_pk_bf16_f32 v125, v58, v59
  v_cvt_pk_bf16_f32 v126, v60, v61
  v_mfma_f32_16x16x32_bf16 v[88:91], a[60:63], a[228:231], v[88:91]
  buffer_load_dwordx4 a[104:107], v240, s[4:7], s40 offen offset:0 sc1
  v_cvt_pk_bf16_f32 v127, v62, v63
  v_mfma_f32_16x16x32_bf16 v[68:71], a[48:51], a[232:235], v[68:71]
  ds_read_b64_tr_b16 a[228:229], v234 offset:4096
  ds_read_b64_tr_b16 a[230:231], v234 offset:6144
  v_mfma_f32_16x16x32_bf16 v[68:71], a[56:59], a[192:195], v[68:71]
  v_mfma_f32_16x16x32_bf16 v[92:95], a[52:55], a[232:235], v[92:95]
  ds_read_b64_tr_b16 a[232:233], v234 offset:16384
  ds_read_b64_tr_b16 a[234:235], v234 offset:18432
  v_mfma_f32_16x16x32_bf16 v[92:95], a[60:63], a[192:195], v[92:95]
  buffer_load_dwordx4 a[108:111], v240, s[4:7], s40 offen offset:1024 sc1
  v_cvt_pk_bf16_f32 v136, v88, v89
  v_cvt_pk_bf16_f32 v137, v90, v91
  v_mfma_f32_16x16x32_bf16 v[48:51], a[196:199], a[48:51], v[48:51]
  ds_read_b64_tr_b16 a[192:193], v235 offset:4096
  ds_read_b64_tr_b16 a[194:195], v235 offset:6144
  s_mov_b32 s40, 6029312
  v_mfma_f32_16x16x32_bf16 v[48:51], a[200:203], a[56:59], v[48:51]
  v_cvt_pk_bf16_f32 v142, v92, v93
  v_cvt_pk_bf16_f32 v143, v94, v95
  ds_write_b64 v191, v[136:137] offset:1024
  ds_write_b64 v191, v[142:143] offset:1032
  v_cvt_pk_bf16_f32 v134, v64, v65
  v_cvt_pk_bf16_f32 v135, v66, v67
  v_cvt_pk_bf16_f32 v140, v68, v69
  v_cvt_pk_bf16_f32 v141, v70, v71
  v_mfma_f32_16x16x32_bf16 v[72:75], a[196:199], a[52:55], v[72:75]
  ds_read_b64_tr_b16 a[196:197], v235 offset:16384
  ds_read_b64_tr_b16 a[198:199], v235 offset:18432
  v_mfma_f32_16x16x32_bf16 v[72:75], a[200:203], a[60:63], v[72:75]
  buffer_load_dwordx4 a[112:115], v240, s[4:7], s40 offen offset:0 sc1
  s_waitcnt lgkmcnt(13)
  v_mfma_f32_16x16x32_bf16 v[52:55], a[204:207], a[48:51], v[52:55]
  ds_read_b64_tr_b16 a[200:201], v228 offset:61440
  ds_read_b64_tr_b16 a[202:203], v228 offset:63488
  v_mfma_f32_16x16x32_bf16 v[52:55], a[208:211], a[56:59], v[52:55]
  v_mfma_f32_16x16x32_bf16 v[76:79], a[204:207], a[52:55], v[76:79]
  ds_read_b64_tr_b16 a[204:205], v232 offset:24576
  ds_read_b64_tr_b16 a[206:207], v232 offset:26624
  v_mfma_f32_16x16x32_bf16 v[76:79], a[208:211], a[60:63], v[76:79]
  v_cvt_pk_bf16_f32 v116, v72, v73
  v_cvt_pk_bf16_f32 v117, v74, v75
  s_nop 5
  v_cvt_pk_bf16_f32 v118, v76, v77
  v_cvt_pk_bf16_f32 v119, v78, v79
  v_cvt_pk_bf16_f32 v112, v48, v49
  buffer_load_dwordx4 a[116:119], v240, s[4:7], s40 offen offset:1024 sc1
  v_cvt_pk_bf16_f32 v113, v50, v51
  v_cvt_pk_bf16_f32 v114, v52, v53
  v_cvt_pk_bf16_f32 v115, v54, v55
  s_waitcnt lgkmcnt(6)
  s_barrier
  ds_read_b128 v[120:123], v209
  s_mov_b32 s40, 6160384
  buffer_load_dwordx4 a[120:123], v240, s[4:7], s40 offen offset:0 sc1
  ds_read_b64 v[132:133], v209 offset:1024
  ds_read_b64 v[138:139], v209 offset:1032
  v_mfma_f32_16x16x32_bf16 v[52:55], v[128:131], v[116:119], 0
  v_mfma_f32_16x16x32_bf16 v[48:51], v[124:127], v[116:119], 0
  v_mfma_f32_16x16x32_bf16 v[60:63], v[124:127], v[112:115], 0
  buffer_load_dwordx4 a[124:127], v240, s[4:7], s40 offen offset:1024 sc1
  s_waitcnt lgkmcnt(0)
  v_mfma_f32_16x16x32_bf16 v[56:59], v[120:123], v[112:115], 0
  s_nop 3
  v_cndmask_b32_e64 v48, v48, v49, s[28:29]
  v_cndmask_b32_e64 v50, v50, v51, s[28:29]
  v_cndmask_b32_e64 v52, v52, v53, s[28:29]
  v_cndmask_b32_e64 v54, v54, v55, s[28:29]
  s_mov_b32 s40, 6291456
  buffer_load_dwordx4 a[128:131], v240, s[4:7], s40 offen offset:0 sc1
  v_cndmask_b32_e64 v56, v56, v57, s[28:29]
  v_cndmask_b32_e64 v58, v58, v59, s[28:29]
  v_cndmask_b32_e64 v60, v60, v61, s[28:29]
  v_cndmask_b32_e64 v62, v62, v63, s[28:29]
  v_cndmask_b32_e64 v48, v48, v52, s[24:25]
  buffer_load_dwordx4 a[132:135], v240, s[4:7], s40 offen offset:1024 sc1
  v_cndmask_b32_e64 v49, v50, v54, s[26:27]
  v_cndmask_b32_e64 v56, v56, v60, s[24:25]
  v_cndmask_b32_e64 v57, v58, v62, s[26:27]
  s_mov_b32 s33, 0x3e8293ee
  v_mul_f32 v48, s33, v48
  v_mul_f32 v49, s33, v49
  v_fma_f32 v56, v56, s33, v193
  v_fma_f32 v57, v57, s33, v194
  v_max_f32 v64, v48, v49
  s_mov_b32 s40, 6422528
  buffer_load_dwordx4 a[136:139], v240, s[4:7], s40 offen offset:0 sc1
  v_max_f32 v65, v56, v57
  v_mov_b32 v68, v64
  v_mov_b32 v69, v65
  s_nop 0
  v_permlane16_swap_b32 v68, v64
  v_permlane16_swap_b32 v69, v65
  buffer_load_dwordx4 a[140:143], v240, s[4:7], s40 offen offset:1024 sc1
  v_max_f32 v64, v64, v68
  v_max_f32 v65, v65, v69
  v_mov_b32 v68, v64
  v_mov_b32 v69, v65
  s_nop 0
  v_permlane32_swap_b32 v68, v64
  s_mov_b32 s40, 6553600
  buffer_load_dwordx4 a[144:147], v240, s[4:7], s40 offen offset:0 sc1
  v_permlane32_swap_b32 v69, v65
  v_max_f32 v64, v64, v68
  s_nop 0
  v_max_f32 v65, v65, v69
  v_sub_f32 v48, v48, v64
  v_sub_f32 v49, v49, v64
  buffer_load_dwordx4 a[148:151], v240, s[4:7], s40 offen offset:1024 sc1
  v_sub_f32 v56, v56, v65
  v_sub_f32 v57, v57, v65
  v_exp_f32 v48, v48
  v_exp_f32 v49, v49
  v_exp_f32 v56, v56
  s_mov_b32 s40, 6684672
  buffer_load_dwordx4 a[152:155], v240, s[4:7], s40 offen offset:0 sc1
  v_exp_f32 v57, v57
  v_add_f32 v64, v48, v49
  v_add_f32 v65, v56, v57
  v_mov_b32 v68, v64
  v_mov_b32 v69, v65
  buffer_load_dwordx4 a[156:159], v240, s[4:7], s40 offen offset:1024 sc1
  v_permlane16_swap_b32 v68, v64
  v_permlane16_swap_b32 v69, v65
  s_nop 0
  v_add_f32 v64, v64, v68
  v_add_f32 v65, v65, v69
  v_mov_b32 v68, v64
  s_mov_b32 s40, 6815744
  buffer_load_dwordx4 a[160:163], v240, s[4:7], s40 offen offset:0 sc1
  v_mov_b32 v69, v65
  v_permlane32_swap_b32 v68, v64
  s_nop 0
  v_permlane32_swap_b32 v69, v65
  v_add_f32 v64, v64, v68
  s_nop 0
  v_add_f32 v65, v65, v69
  buffer_load_dwordx4 a[164:167], v240, s[4:7], s40 offen offset:1024 sc1
  v_rcp_f32 v64, v64
  v_rcp_f32 v65, v65
  v_mul_f32 v48, v48, v64
  v_mul_f32 v49, v49, v64
  v_mul_f32 v56, v56, v65
  s_mov_b32 s40, 6946816
  buffer_load_dwordx4 a[168:171], v240, s[4:7], s40 offen offset:0 sc1
  v_mul_f32 v57, v57, v65
  v_cvt_pk_bf16_f32 v48, v48, 0
  v_cvt_pk_bf16_f32 v49, v49, 0
  v_cvt_pk_bf16_f32 v56, v56, 0
  v_cvt_pk_bf16_f32 v57, v57, 0
  buffer_load_dwordx4 a[172:175], v240, s[4:7], s40 offen offset:1024 sc1
  v_lshlrev_b32 v48, v195, v48
  v_lshlrev_b32 v49, v195, v49
  v_lshlrev_b32 v56, v195, v56
  v_lshlrev_b32 v57, v195, v57
  v_cndmask_b32_e64 v112, v48, 0, s[24:25]
  s_mov_b32 s40, 7077888
  buffer_load_dwordx4 a[176:179], v240, s[4:7], s40 offen offset:0 sc1
  v_cndmask_b32_e64 v114, 0, v48, s[24:25]
  v_cndmask_b32_e64 v113, v49, 0, s[26:27]
  v_cndmask_b32_e64 v115, 0, v49, s[26:27]
  v_cndmask_b32_e64 v116, v56, 0, s[24:25]
  v_cndmask_b32_e64 v118, 0, v56, s[24:25]
  v_cndmask_b32_e64 v117, v57, 0, s[26:27]
  v_cndmask_b32_e64 v119, 0, v57, s[26:27]
  v_mfma_f32_16x16x32_bf16 v[48:51], v[134:137], v[112:115], 0
  v_mfma_f32_16x16x32_bf16 v[52:55], v[140:143], v[112:115], 0
  v_mfma_f32_16x16x32_bf16 v[56:59], v[132:135], v[116:119], 0
  v_mfma_f32_16x16x32_bf16 v[60:63], v[138:141], v[116:119], 0
  s_nop 4
  v_cvt_pk_bf16_f32 v120, v48, v49
  v_cvt_pk_bf16_f32 v121, v50, v51
  v_cvt_pk_bf16_f32 v122, v52, v53
  v_cvt_pk_bf16_f32 v123, v54, v55
L_wk0_4:
  s_cbranch_vccnz L_wk0_end
  buffer_store_dwordx4 v[120:123], v187, s[4:7], s78 offen offset:1024 sc1
  v_cvt_pk_bf16_f32 v124, v56, v57
  v_cvt_pk_bf16_f32 v125, v58, v59
  v_cvt_pk_bf16_f32 v126, v60, v61
  v_cvt_pk_bf16_f32 v127, v62, v63
  buffer_store_dwordx4 v[124:127], v187, s[4:7], s78 offen offset:0 sc1
  s_add_u32 s78, s78, 2097152
  ds_read_b64_tr_b16 a[208:209], v229 offset:61440
  ds_read_b64_tr_b16 a[210:211], v229 offset:63488
  s_waitcnt vmcnt(27)
  v_mfma_f32_16x16x32_bf16 v[0:3], a[212:215], a[64:67], 0
  v_mfma_f32_16x16x32_bf16 v[0:3], a[216:219], a[72:75], v[0:3]
  v_mfma_f32_16x16x32_bf16 v[16:19], a[212:215], a[68:71], 0
  ds_read_b64_tr_b16 a[212:213], v233 offset:24576
  ds_read_b64_tr_b16 a[214:215], v233 offset:26624
  v_mfma_f32_16x16x32_bf16 v[16:19], a[216:219], a[76:79], v[16:19]
  ds_read_b64_tr_b16 a[216:217], v230 offset:61440
  ds_read_b64_tr_b16 a[218:219], v230 offset:63488
  v_mfma_f32_16x16x32_bf16 v[4:7], a[220:223], a[64:67], 0
  v_mfma_f32_16x16x32_bf16 v[4:7], a[224:227], a[72:75], v[4:7]
  v_mfma_f32_16x16x32_bf16 v[20:23], a[220:223], a[68:71], 0
  ds_read_b64_tr_b16 a[220:221], v234 offset:24576
  ds_read_b64_tr_b16 a[222:223], v234 offset:26624
  v_mfma_f32_16x16x32_bf16 v[20:23], a[224:227], a[76:79], v[20:23]
  ds_read_b64_tr_b16 a[224:225], v231 offset:61440
  ds_read_b64_tr_b16 a[226:227], v231 offset:63488
  v_mfma_f32_16x16x32_bf16 v[8:11], a[228:231], a[64:67], 0
  v_mfma_f32_16x16x32_bf16 v[8:11], a[232:235], a[72:75], v[8:11]
  v_mfma_f32_16x16x32_bf16 v[24:27], a[228:231], a[68:71], 0
  ds_read_b64_tr_b16 a[228:229], v235 offset:24576
  ds_read_b64_tr_b16 a[230:231], v235 offset:26624
  v_mfma_f32_16x16x32_bf16 v[24:27], a[232:235], a[76:79], v[24:27]
  ds_read_b64_tr_b16 a[232:233], v232 offset:53248
  ds_read_b64_tr_b16 a[234:235], v232 offset:55296
  v_mfma_f32_16x16x32_bf16 v[12:15], a[192:195], a[64:67], 0
  v_mfma_f32_16x16x32_bf16 v[12:15], a[196:199], a[72:75], v[12:15]
  v_mfma_f32_16x16x32_bf16 v[28:31], a[192:195], a[68:71], 0
  ds_read_b64_tr_b16 a[192:193], v236 offset:0
  ds_read_b64_tr_b16 a[194:195], v236 offset:2048
  v_mfma_f32_16x16x32_bf16 v[28:31], a[196:199], a[76:79], v[28:31]
  s_barrier
  ds_read_b64_tr_b16 a[196:197], v233 offset:53248
  s_waitcnt vmcnt(23)
  v_mfma_f32_16x16x32_bf16 v[0:3], a[200:203], a[80:83], v[0:3]
  ds_read_b64_tr_b16 a[198:199], v233 offset:55296
  v_mfma_f32_16x16x32_bf16 v[0:3], a[204:207], a[88:91], v[0:3]
  v_mfma_f32_16x16x32_bf16 v[16:19], a[200:203], a[84:87], v[16:19]
  ds_read_b64_tr_b16 a[200:201], v237 offset:0
  ds_read_b64_tr_b16 a[202:203], v237 offset:2048
  v_mfma_f32_16x16x32_bf16 v[16:19], a[204:207], a[92:95], v[16:19]
  ds_read_b64_tr_b16 a[204:205], v234 offset:53248
  ds_read_b64_tr_b16 a[206:207], v234 offset:55296
  s_waitcnt lgkmcnt(13)
  v_mfma_f32_16x16x32_bf16 v[4:7], a[208:211], a[80:83], v[4:7]
  v_mfma_f32_16x16x32_bf16 v[4:7], a[212:215], a[88:91], v[4:7]
  v_mfma_f32_16x16x32_bf16 v[20:23], a[208:211], a[84:87], v[20:23]
  ds_read_b64_tr_b16 a[208:209], v238 offset:0
  ds_read_b64_tr_b16 a[210:211], v238 offset:2048
  v_mfma_f32_16x16x32_bf16 v[20:23], a[212:215], a[92:95], v[20:23]
  ds_read_b64_tr_b16 a[212:213], v235 offset:53248
  ds_read_b64_tr_b16 a[214:215], v235 offset:55296
  v_mfma_f32_16x16x32_bf16 v[8:11], a[216:219], a[80:83], v[8:11]
  v_mfma_f32_16x16x32_bf16 v[8:11], a[220:223], a[88:91], v[8:11]
  v_mfma_f32_16x16x32_bf16 v[24:27], a[216:219], a[84:87], v[24:27]
  ds_read_b64_tr_b16 a[216:217], v239 offset:0
  ds_read_b64_tr_b16 a[218:219], v239 offset:2048
  v_mfma_f32_16x16x32_bf16 v[24:27], a[220:223], a[92:95], v[24:27]
  ds_read_b64_tr_b16 a[220:221], v232 offset:12288
  ds_read_b64_tr_b16 a[222:223], v232 offset:14336
  s_waitcnt lgkmcnt(13)
  v_mfma_f32_16x16x32_bf16 v[12:15], a[224:227], a[80:83], v[12:15]
  v_mfma_f32_16x16x32_bf16 v[12:15], a[228:231], a[88:91], v[12:15]
  v_mfma_f32_16x16x32_bf16 v[28:31], a[224:227], a[84:87], v[28:31]
  ds_read_b64_tr_b16 a[224:225], v232 offset:8192
  ds_read_b64_tr_b16 a[226:227], v232 offset:10240
  v_mfma_f32_16x16x32_bf16 v[28:31], a[228:231], a[92:95], v[28:31]
  s_barrier
  ds_read_b64_tr_b16 a[228:229], v233 offset:12288
  s_waitcnt vmcnt(19)
  v_mfma_f32_16x16x32_bf16 v[0:3], a[232:235], a[96:99], v[0:3]
  ds_read_b64_tr_b16 a[230:231], v233 offset:14336
  v_mfma_f32_16x16x32_bf16 v[0:3], a[192:195], a[104:107], v[0:3]
  v_mfma_f32_16x16x32_bf16 v[16:19], a[232:235], a[100:103], v[16:19]
  ds_read_b64_tr_b16 a[232:233], v233 offset:8192
  ds_read_b64_tr_b16 a[234:235], v233 offset:10240
  v_mfma_f32_16x16x32_bf16 v[16:19], a[192:195], a[108:111], v[16:19]
  ds_read_b64_tr_b16 a[192:193], v234 offset:12288
  ds_read_b64_tr_b16 a[194:195], v234 offset:14336
  s_waitcnt lgkmcnt(13)
  v_mfma_f32_16x16x32_bf16 v[4:7], a[196:199], a[96:99], v[4:7]
  v_mfma_f32_16x16x32_bf16 v[4:7], a[200:203], a[104:107], v[4:7]
  v_mfma_f32_16x16x32_bf16 v[20:23], a[196:199], a[100:103], v[20:23]
  ds_read_b64_tr_b16 a[196:197], v234 offset:8192
  ds_read_b64_tr_b16 a[198:199], v234 offset:10240
  v_mfma_f32_16x16x32_bf16 v[20:23], a[200:203], a[108:111], v[20:23]
  buffer_load_dwordx4 a[180:183], v240, s[4:7], s40 offen offset:1024 sc1
  s_mov_b32 s40, 7208960
  s_waitcnt vmcnt(1)
  v_add_u32 v248, 1, v245
  buffer_store_dword v248, v246, s[4:7], s79 offen sc1
  v_mfma_f32_16x16x32_bf16 v[8:11], a[204:207], a[96:99], v[8:11]
  ds_read_b64_tr_b16 a[200:201], v235 offset:12288
  ds_read_b64_tr_b16 a[202:203], v235 offset:14336
  v_mfma_f32_16x16x32_bf16 v[8:11], a[208:211], a[104:107], v[8:11]
  v_mfma_f32_16x16x32_bf16 v[24:27], a[204:207], a[100:103], v[24:27]
  buffer_load_dwordx4 a[184:187], v240, s[4:7], s40 offen offset:0 sc1
  v_mfma_f32_16x16x32_bf16 v[24:27], a[208:211], a[108:111], v[24:27]
  ds_read_b64_tr_b16 a[204:205], v235 offset:8192
  ds_read_b64_tr_b16 a[206:207], v235 offset:10240
  s_waitcnt lgkmcnt(13)
  v_mfma_f32_16x16x32_bf16 v[12:15], a[212:215], a[96:99], v[12:15]
  ds_read_b64_tr_b16 a[208:209], v232 offset:20480
  ds_read_b64_tr_b16 a[210:211], v232 offset:22528
  v_mfma_f32_16x16x32_bf16 v[12:15], a[216:219], a[104:107], v[12:15]
  buffer_load_dwordx4 a[188:191], v240, s[4:7], s40 offen offset:1024 sc1
  v_mfma_f32_16x16x32_bf16 v[28:31], a[212:215], a[100:103], v[28:31]
  ds_read_b64_tr_b16 a[212:213], v232 offset:36864
  ds_read_b64_tr_b16 a[214:215], v232 offset:38912
  s_mov_b32 s41, 983040
  v_mfma_f32_16x16x32_bf16 v[28:31], a[216:219], a[108:111], v[28:31]
  s_barrier
  ds_read_b64_tr_b16 a[216:217], v233 offset:20480
  v_mfma_f32_16x16x32_bf16 v[0:3], a[220:223], a[112:115], v[0:3]
  ds_read_b64_tr_b16 a[218:219], v233 offset:22528
  s_add_u32 m0, s42, 12288
  s_waitcnt lgkmcnt(13)
  v_mfma_f32_16x16x32_bf16 v[0:3], a[224:227], a[120:123], v[0:3]
  buffer_load_dwordx4 v241, s[8:11], s41 offen offset:0 lds
  v_permlane16_swap_b32 v32, v34
  v_mfma_f32_16x16x32_bf16 v[16:19], a[220:223], a[116:119], v[16:19]
  ds_read_b64_tr_b16 a[220:221], v233 offset:36864
  ds_read_b64_tr_b16 a[222:223], v233 offset:38912
  s_mov_b32 s41, 1114112
  v_mfma_f32_16x16x32_bf16 v[16:19], a[224:227], a[124:127], v[16:19]
  ds_read_b64_tr_b16 a[224:225], v234 offset:20480
  ds_read_b64_tr_b16 a[226:227], v234 offset:22528
  s_add_u32 m0, s42, 24576
  v_permlane16_swap_b32 v33, v35
  v_mfma_f32_16x16x32_bf16 v[4:7], a[228:231], a[112:115], v[4:7]
  buffer_load_dwordx4 v241, s[8:11], s41 offen offset:0 lds
  v_permlane16_swap_b32 v36, v38
  v_mfma_f32_16x16x32_bf16 v[4:7], a[232:235], a[120:123], v[4:7]
  s_mov_b32 s41, 1245184
  s_add_u32 m0, s42, 45056
  v_permlane16_swap_b32 v37, v39
  v_mfma_f32_16x16x32_bf16 v[20:23], a[228:231], a[116:119], v[20:23]
  buffer_load_dwordx4 v241, s[8:11], s41 offen offset:0 lds
  v_permlane16_swap_b32 v40, v42
  v_mfma_f32_16x16x32_bf16 v[20:23], a[232:235], a[124:127], v[20:23]
  ds_read_b64_tr_b16 a[228:229], v234 offset:36864
  ds_read_b64_tr_b16 a[230:231], v234 offset:38912
  s_mov_b32 s41, 1376256
  v_permlane16_swap_b32 v41, v43
  s_waitcnt lgkmcnt(13)
  v_mfma_f32_16x16x32_bf16 v[8:11], a[192:195], a[112:115], v[8:11]
  ds_read_b64_tr_b16 a[232:233], v235 offset:20480
  ds_read_b64_tr_b16 a[234:235], v235 offset:22528
  s_add_u32 m0, s42, 36864
  v_permlane16_swap_b32 v44, v46
  v_mfma_f32_16x16x32_bf16 v[8:11], a[196:199], a[120:123], v[8:11]
  buffer_load_dwordx4 v241, s[8:11], s41 offen offset:0 lds
  v_permlane16_swap_b32 v45, v47
  v_mfma_f32_16x16x32_bf16 v[24:27], a[192:195], a[116:119], v[24:27]
  ds_read_b64_tr_b16 a[192:193], v235 offset:36864
  ds_read_b64_tr_b16 a[194:195], v235 offset:38912
  s_mov_b32 s41, 1507328
  v_lshlrev_b32 v160, 16, v32
  v_mfma_f32_16x16x32_bf16 v[24:27], a[196:199], a[124:127], v[24:27]
  ds_read_b64_tr_b16 a[196:197], v232 offset:32768
  ds_read_b64_tr_b16 a[198:199], v232 offset:34816
  s_add_u32 m0, s42, 49152
  buffer_load_dword v244, v243, s[4:7], s88 offen sc1
  v_and_b32 v161, 0xffff0000, v32
  v_mfma_f32_16x16x32_bf16 v[12:15], a[200:203], a[112:115], v[12:15]
  v_lshlrev_b32 v162, 16, v33
  v_and_b32 v163, 0xffff0000, v33
  v_lshlrev_b32 v164, 16, v34
  s_waitcnt lgkmcnt(13)
  v_mfma_f32_16x16x32_bf16 v[12:15], a[204:207], a[120:123], v[12:15]
  buffer_load_dwordx4 v241, s[8:11], s41 offen offset:0 lds
  v_and_b32 v165, 0xffff0000, v34
  v_mfma_f32_16x16x32_bf16 v[28:31], a[200:203], a[116:119], v[28:31]
  ds_read_b64_tr_b16 a[200:201], v232 offset:45056
  ds_read_b64_tr_b16 a[202:203], v232 offset:47104
  s_mov_b32 s41, 1638400
  v_mfma_f32_16x16x32_bf16 v[28:31], a[204:207], a[124:127], v[28:31]
  s_barrier
  ds_read_b64_tr_b16 a[204:205], v233 offset:32768
  v_mfma_f32_16x16x32_bf16 v[0:3], a[208:211], a[128:131], v[0:3]
  ds_read_b64_tr_b16 a[206:207], v233 offset:34816
  s_add_u32 m0, s42, 32768
  v_lshlrev_b32 v166, 16, v35
  v_mfma_f32_16x16x32_bf16 v[0:3], a[212:215], a[136:139], v[0:3]
  buffer_load_dwordx4 v241, s[8:11], s41 offen offset:0 lds
  v_and_b32 v167, 0xffff0000, v35
  v_mfma_f32_16x16x32_bf16 v[16:19], a[208:211], a[132:135], v[16:19]
  ds_read_b64_tr_b16 a[208:209], v233 offset:45056
  ds_read_b64_tr_b16 a[210:211], v233 offset:47104
  s_mov_b32 s41, 1769472
  v_lshlrev_b32 v168, 16, v36
  v_mfma_f32_16x16x32_bf16 v[16:19], a[212:215], a[140:143], v[16:19]
  ds_read_b64_tr_b16 a[212:213], v234 offset:32768
  ds_read_b64_tr_b16 a[214:215], v234 offset:34816
  s_add_u32 m0, s42, 40960
  v_and_b32 v169, 0xffff0000, v36
  s_waitcnt lgkmcnt(13)
  v_mfma_f32_16x16x32_bf16 v[4:7], a[216:219], a[128:131], v[4:7]
  buffer_load_dwordx4 v241, s[8:11], s41 offen offset:0 lds
  v_lshlrev_b32 v170, 16, v37
  v_mfma_f32_16x16x32_bf16 v[4:7], a[220:223], a[136:139], v[4:7]
  s_mov_b32 s41, 1900544
  s_add_u32 m0, s42, 53248
  v_and_b32 v171, 0xffff0000, v37
  v_mfma_f32_16x16x32_bf16 v[20:23], a[216:219], a[132:135], v[20:23]
  buffer_load_dwordx4 v241, s[8:11], s41 offen offset:0 lds
  v_lshlrev_b32 v172, 16, v38
  v_mfma_f32_16x16x32_bf16 v[20:23], a[220:223], a[140:143], v[20:23]
  ds_read_b64_tr_b16 a[216:217], v234 offset:45056
  ds_read_b64_tr_b16 a[218:219], v234 offset:47104
  s_mov_b32 s41, 2031616
  v_and_b32 v173, 0xffff0000, v38
  v_mfma_f32_16x16x32_bf16 v[8:11], a[224:227], a[128:131], v[8:11]
  ds_read_b64_tr_b16 a[220:221], v235 offset:32768
  ds_read_b64_tr_b16 a[222:223], v235 offset:34816
  s_add_u32 m0, s42, 57344
  v_lshlrev_b32 v174, 16, v39
  v_mfma_f32_16x16x32_bf16 v[8:11], a[228:231], a[136:139], v[8:11]
  buffer_load_dwordx4 v241, s[8:11], s41 offen offset:0 lds
  v_and_b32 v175, 0xffff0000, v39
  v_mfma_f32_16x16x32_bf16 v[24:27], a[224:227], a[132:135], v[24:27]
  ds_read_b64_tr_b16 a[224:225], v235 offset:45056
  ds_read_b64_tr_b16 a[226:227], v235 offset:47104
  v_lshlrev_b32 v176, 16, v40
  v_mfma_f32_16x16x32_bf16 v[24:27], a[228:231], a[140:143], v[24:27]
  ds_read_b64_tr_b16 a[228:229], v232 offset:61440
  ds_read_b64_tr_b16 a[230:231], v232 offset:63488
  v_and_b32 v177, 0xffff0000, v40
  s_waitcnt lgkmcnt(13)
  v_mfma_f32_16x16x32_bf16 v[12:15], a[232:235], a[128:131], v[12:15]
  v_lshlrev_b32 v178, 16, v41
  v_and_b32 v179, 0xffff0000, v41
  v_lshlrev_b32 v180, 16, v42
  v_mfma_f32_16x16x32_bf16 v[12:15], a[192:195], a[136:139], v[12:15]
  v_and_b32 v181, 0xffff0000, v42
  v_lshlrev_b32 v182, 16, v43
  v_and_b32 v183, 0xffff0000, v43
  v_mfma_f32_16x16x32_bf16 v[28:31], a[232:235], a[132:135], v[28:31]
  ds_read_b64_tr_b16 a[232:233], v232 offset:57344
  ds_read_b64_tr_b16 a[234:235], v232 offset:59392
  v_lshlrev_b32 v184, 16, v44
  v_mfma_f32_16x16x32_bf16 v[28:31], a[192:195], a[140:143], v[28:31]
  s_barrier
  ds_read_b64_tr_b16 a[192:193], v233 offset:61440
  v_mfma_f32_16x16x32_bf16 v[0:3], a[196:199], a[144:147], v[0:3]
  ds_read_b64_tr_b16 a[194:195], v233 offset:63488
  v_and_b32 v185, 0xffff0000, v44
  v_lshlrev_b32 v186, 16, v45
  v_mfma_f32_16x16x32_bf16 v[0:3], a[200:203], a[152:155], v[0:3]
  v_and_b32 v187, 0xffff0000, v45
  v_lshlrev_b32 v188, 16, v46
  v_and_b32 v189, 0xffff0000, v46
  v_mfma_f32_16x16x32_bf16 v[16:19], a[196:199], a[148:151], v[16:19]
  ds_read_b64_tr_b16 a[196:197], v233 offset:57344
  ds_read_b64_tr_b16 a[198:199], v233 offset:59392
  v_lshlrev_b32 v190, 16, v47
  v_mfma_f32_16x16x32_bf16 v[16:19], a[200:203], a[156:159], v[16:19]
  ds_read_b64_tr_b16 a[200:201], v234 offset:61440
  ds_read_b64_tr_b16 a[202:203], v234 offset:63488
  v_and_b32 v191, 0xffff0000, v47
  s_waitcnt lgkmcnt(13)
  v_mfma_f32_16x16x32_bf16 v[4:7], a[204:207], a[144:147], v[4:7]
  v_mfma_f32_16x16x32_bf16 v[4:7], a[208:211], a[152:155], v[4:7]
  v_mfma_f32_16x16x32_bf16 v[20:23], a[204:207], a[148:151], v[20:23]
  ds_read_b64_tr_b16 a[204:205], v234 offset:57344
  ds_read_b64_tr_b16 a[206:207], v234 offset:59392
  v_mfma_f32_16x16x32_bf16 v[20:23], a[208:211], a[156:159], v[20:23]
  ds_read_b64_tr_b16 a[208:209], v235 offset:61440
  ds_read_b64_tr_b16 a[210:211], v235 offset:63488
  v_mfma_f32_16x16x32_bf16 v[8:11], a[212:215], a[144:147], v[8:11]
  v_mfma_f32_16x16x32_bf16 v[8:11], a[216:219], a[152:155], v[8:11]
  s_waitcnt vmcnt(5)
  v_subrev_u32 v244, s100, v244
  v_subrev_u32 v244, 1, v244
  v_cmp_lt_u32 s[68:69], 6, v244
  v_mfma_f32_16x16x32_bf16 v[24:27], a[212:215], a[148:151], v[24:27]
  ds_read_b64_tr_b16 a[212:213], v235 offset:57344
  ds_read_b64_tr_b16 a[214:215], v235 offset:59392
  s_cmp_lg_u64 s[68:69], 0
  s_cbranch_scc1 L_slow_16
L_back_17:
  v_mfma_f32_16x16x32_bf16 v[24:27], a[216:219], a[156:159], v[24:27]
  ds_read_b64_tr_b16 a[216:217], v236 offset:4096
  ds_read_b64_tr_b16 a[218:219], v236 offset:6144
  s_mov_b32 s40, 7340032
  s_waitcnt lgkmcnt(13)
  v_mfma_f32_16x16x32_bf16 v[12:15], a[220:223], a[144:147], v[12:15]
  buffer_load_dwordx4 a[0:3], v240, s[4:7], s40 offen offset:0 sc1
  v_mfma_f32_16x16x32_bf16 v[12:15], a[224:227], a[152:155], v[12:15]
  v_mfma_f32_16x16x32_bf16 v[28:31], a[220:223], a[148:151], v[28:31]
  buffer_load_dwordx4 a[4:7], v240, s[4:7], s40 offen offset:1024 sc1
  s_mov_b32 s40, 7471104
  v_mfma_f32_16x16x32_bf16 v[28:31], a[224:227], a[156:159], v[28:31]
  s_barrier
  ds_read_b64_tr_b16 a[220:221], v236 offset:20480
  v_mfma_f32_16x16x32_bf16 v[0:3], a[228:231], a[160:163], v[0:3]
  ds_read_b64_tr_b16 a[222:223], v236 offset:22528
  ds_read_b64_tr_b16 a[224:225], v237 offset:4096
  v_mfma_f32_16x16x32_bf16 v[0:3], a[232:235], a[168:171], v[0:3]
  buffer_load_dwordx4 a[8:11], v240, s[4:7], s40 offen offset:0 sc1
  v_mfma_f32_16x16x32_bf16 v[16:19], a[228:231], a[164:167], v[16:19]
  ds_read_b64_tr_b16 a[226:227], v237 offset:6144
  ds_read_b64_tr_b16 a[228:229], v237 offset:20480
  v_mfma_f32_16x16x32_bf16 v[16:19], a[232:235], a[172:175], v[16:19]
  ds_read_b64_tr_b16 a[230:231], v237 offset:22528
  ds_read_b64_tr_b16 a[232:233], v238 offset:4096
  s_waitcnt lgkmcnt(13)
  v_mfma_f32_16x16x32_bf16 v[4:7], a[192:195], a[160:163], v[4:7]
  buffer_load_dwordx4 a[12:15], v240, s[4:7], s40 offen offset:1024 sc1
  buffer_load_dwordx4 v[96:99], v210, s[4:7], s101 offen sc1
  v_mfma_f32_16x16x32_bf16 v[4:7], a[196:199], a[168:171], v[4:7]
  ds_read_b64_tr_b16 a[234:235], v238 offset:6144
  s_mov_b32 s40, 7602176
  v_mfma_f32_16x16x32_bf16 v[20:23], a[192:195], a[164:167], v[20:23]
  ds_read_b64_tr_b16 a[192:193], v238 offset:20480
  ds_read_b64_tr_b16 a[194:195], v238 offset:22528
  v_mfma_f32_16x16x32_bf16 v[20:23], a[196:199], a[172:175], v[20:23]
  buffer_load_dwordx4 a[16:19], v240, s[4:7], s40 offen offset:0 sc1
  v_mfma_f32_16x16x32_bf16 v[8:11], a[200:203], a[160:163], v[8:11]
  ds_read_b64_tr_b16 a[196:197], v239 offset:4096
  ds_read_b64_tr_b16 a[198:199], v239 offset:6144
  v_mfma_f32_16x16x32_bf16 v[8:11], a[204:207], a[168:171], v[8:11]
  v_mfma_f32_16x16x32_bf16 v[24:27], a[200:203], a[164:167], v[24:27]
  buffer_load_dwordx4 a[20:23], v240, s[4:7], s40 offen offset:1024 sc1
  s_mov_b32 s40, 7733248
  v_mfma_f32_16x16x32_bf16 v[24:27], a[204:207], a[172:175], v[24:27]
  ds_read_b64_tr_b16 a[200:201], v239 offset:20480
  ds_read_b64_tr_b16 a[202:203], v239 offset:22528
  s_waitcnt lgkmcnt(13)
  v_mfma_f32_16x16x32_bf16 v[12:15], a[208:211], a[160:163], v[12:15]
  ds_read_b64_tr_b16 a[204:205], v236 offset:16384
  ds_read_b64_tr_b16 a[206:207], v236 offset:18432
  v_mfma_f32_16x16x32_bf16 v[12:15], a[212:215], a[168:171], v[12:15]
  buffer_load_dwordx4 a[24:27], v240, s[4:7], s40 offen offset:0 sc1
  v_mfma_f32_16x16x32_bf16 v[28:31], a[208:211], a[164:167], v[28:31]
  ds_read_b64_tr_b16 a[208:209], v236 offset:28672
  ds_read_b64_tr_b16 a[210:211], v236 offset:30720
  v_mfma_f32_16x16x32_bf16 v[28:31], a[212:215], a[172:175], v[28:31]
  s_barrier
  ds_read_b64_tr_b16 a[212:213], v237 offset:16384
  v_mfma_f32_16x16x32_bf16 v[0:3], a[216:219], a[176:179], v[0:3]
  buffer_load_dwordx4 a[28:31], v240, s[4:7], s40 offen offset:1024 sc1
  s_waitcnt lgkmcnt(13)
  v_mfma_f32_16x16x32_bf16 v[0:3], a[220:223], a[184:187], v[0:3]
  ds_read_b64_tr_b16 a[214:215], v237 offset:18432
  s_mov_b32 s40, 7864320
  v_mfma_f32_16x16x32_bf16 v[16:19], a[216:219], a[180:183], v[16:19]
  ds_read_b64_tr_b16 a[216:217], v237 offset:28672
  ds_read_b64_tr_b16 a[218:219], v237 offset:30720
  v_mfma_f32_16x16x32_bf16 v[16:19], a[220:223], a[188:191], v[16:19]
  buffer_load_dwordx4 a[32:35], v240, s[4:7], s40 offen offset:0 sc1
  v_mfma_f32_16x16x32_bf16 v[4:7], a[224:227], a[176:179], v[4:7]
  ds_read_b64_tr_b16 a[220:221], v238 offset:16384
  ds_read_b64_tr_b16 a[222:223], v238 offset:18432
  v_mfma_f32_16x16x32_bf16 v[4:7], a[228:231], a[184:187], v[4:7]
  v_mfma_f32_16x16x32_bf16 v[20:23], a[224:227], a[180:183], v[20:23]
  buffer_load_dwordx4 a[36:39], v240, s[4:7], s40 offen offset:1024 sc1
  s_mov_b32 s40, 7995392
  v_mfma_f32_16x16x32_bf16 v[20:23], a[228:231], a[188:191], v[20:23]
  ds_read_b64_tr_b16 a[224:225], v238 offset:28672
  ds_read_b64_tr_b16 a[226:227], v238 offset:30720
  s_waitcnt lgkmcnt(13)
  v_mfma_f32_16x16x32_bf16 v[8:11], a[232:235], a[176:179], v[8:11]
  ds_read_b64_tr_b16 a[228:229], v239 offset:16384
  ds_read_b64_tr_b16 a[230:231], v239 offset:18432
  v_mfma_f32_16x16x32_bf16 v[8:11], a[192:195], a[184:187], v[8:11]
  buffer_load_dwordx4 a[40:43], v240, s[4:7], s40 offen offset:0 sc1
  v_mfma_f32_16x16x32_bf16 v[24:27], a[232:235], a[180:183], v[24:27]
  ds_read_b64_tr_b16 a[232:233], v239 offset:28672
  ds_read_b64_tr_b16 a[234:235], v239 offset:30720
  v_mfma_f32_16x16x32_bf16 v[24:27], a[192:195], a[188:191], v[24:27]
  ds_read_b64_tr_b16 a[192:193], v228 offset:16384
  ds_read_b64_tr_b16 a[194:195], v228 offset:18432
  v_mfma_f32_16x16x32_bf16 v[12:15], a[196:199], a[176:179], v[12:15]
  buffer_load_dwordx4 a[44:47], v240, s[4:7], s40 offen offset:1024 sc1
  s_waitcnt lgkmcnt(13)
  v_mfma_f32_16x16x32_bf16 v[12:15], a[200:203], a[184:187], v[12:15]
  s_mov_b32 s40, 8126464
  v_mfma_f32_16x16x32_bf16 v[28:31], a[196:199], a[180:183], v[28:31]
  ds_read_b64_tr_b16 a[196:197], v228 offset:28672
  ds_read_b64_tr_b16 a[198:199], v228 offset:30720
  v_mfma_f32_16x16x32_bf16 v[28:31], a[200:203], a[188:191], v[28:31]
  s_barrier
  ds_read_b64_tr_b16 a[200:201], v229 offset:16384
  s_waitcnt vmcnt(9)
  v_mfma_f32_16x16x32_bf16 v[0:3], a[204:207], a[0:3], v[0:3]
  buffer_load_dwordx4 a[48:51], v240, s[4:7], s40 offen offset:0 sc1
  v_mfma_f32_16x16x32_bf16 v[0:3], a[208:211], a[8:11], v[0:3]
  ds_read_b64_tr_b16 a[202:203], v229 offset:18432
  v_mfma_f32_16x16x32_bf16 v[16:19], a[204:207], a[4:7], v[16:19]
  buffer_load_dwordx4 a[52:55], v240, s[4:7], s40 offen offset:1024 sc1
  s_mov_b32 s40, 8257536
  v_mfma_f32_16x16x32_bf16 v[16:19], a[208:211], a[12:15], v[16:19]
  ds_read_b64_tr_b16 a[204:205], v229 offset:28672
  ds_read_b64_tr_b16 a[206:207], v229 offset:30720
  s_waitcnt lgkmcnt(13)
  v_mfma_f32_16x16x32_bf16 v[4:7], a[212:215], a[0:3], v[4:7]
  ds_read_b64_tr_b16 a[208:209], v230 offset:16384
  ds_read_b64_tr_b16 a[210:211], v230 offset:18432
  v_mfma_f32_16x16x32_bf16 v[4:7], a[216:219], a[8:11], v[4:7]
  buffer_load_dwordx4 a[56:59], v240, s[4:7], s40 offen offset:0 sc1
  v_mfma_f32_16x16x32_bf16 v[20:23], a[212:215], a[4:7], v[20:23]
  ds_read_b64_tr_b16 a[212:213], v230 offset:28672
  ds_read_b64_tr_b16 a[214:215], v230 offset:30720
  v_mfma_f32_16x16x32_bf16 v[20:23], a[216:219], a[12:15], v[20:23]
  ds_read_b64_tr_b16 a[216:217], v231 offset:16384
  ds_read_b64_tr_b16 a[218:219], v231 offset:18432
  v_mfma_f32_16x16x32_bf16 v[8:11], a[220:223], a[0:3], v[8:11]
  buffer_load_dwordx4 a[60:63], v240, s[4:7], s40 offen offset:1024 sc1
  s_waitcnt lgkmcnt(13)
  v_mfma_f32_16x16x32_bf16 v[8:11], a[224:227], a[8:11], v[8:11]
  s_mov_b32 s40, 8388608
  v_mfma_f32_16x16x32_bf16 v[24:27], a[220:223], a[4:7], v[24:27]
  ds_read_b64_tr_b16 a[220:221], v231 offset:28672
  ds_read_b64_tr_b16 a[222:223], v231 offset:30720
  v_mfma_f32_16x16x32_bf16 v[24:27], a[224:227], a[12:15], v[24:27]
  buffer_load_dwordx4 a[64:67], v240, s[4:7], s40 offen offset:0 sc1
  v_mfma_f32_16x16x32_bf16 v[12:15], a[228:231], a[0:3], v[12:15]
  ds_read_b64_tr_b16 a[224:225], v236 offset:8192
  ds_read_b64_tr_b16 a[226:227], v236 offset:10240
  s_waitcnt vmcnt(13)
  v_xor_b32 v96, s84, v96
  v_xor_b32 v97, s85, v97
  v_or_b32 v100, v96, v97
  v_xor_b32 v98, s86, v98
  v_mfma_f32_16x16x32_bf16 v[12:15], a[232:235], a[8:11], v[12:15]
  v_xor_b32 v99, s87, v99
  v_or3_b32 v100, v100, v98, v99
  v_and_b32 v100, 0xff, v100
  v_mfma_f32_16x16x32_bf16 v[28:31], a[228:231], a[4:7], v[28:31]
  buffer_load_dwordx4 a[68:71], v240, s[4:7], s40 offen offset:1024 sc1
  s_mov_b32 s40, 8519680
  v_mfma_f32_16x16x32_bf16 v[28:31], a[232:235], a[12:15], v[28:31]
  s_barrier
  ds_read_b64_tr_b16 a[228:229], v236 offset:24576
  v_cmp_ne_u32 s[68:69], 0, v100
  s_waitcnt vmcnt(10) lgkmcnt(13)
  v_mfma_f32_16x16x32_bf16 v[0:3], a[192:195], a[16:19], v[0:3]
  ds_read_b64_tr_b16 a[230:231], v236 offset:26624
  ds_read_b64_tr_b16 a[232:233], v237 offset:8192
  s_cmp_lg_u64 s[68:69], 0
  s_cbranch_scc1 L_slow_18
L_back_19:
  v_mfma_f32_16x16x32_bf16 v[0:3], a[196:199], a[24:27], v[0:3]
  buffer_load_dwordx4 a[72:75], v240, s[4:7], s40 offen offset:0 sc1
  v_mov_b32 v100, v96
  v_mfma_f32_16x16x32_bf16 v[16:19], a[192:195], a[20:23], v[16:19]
  ds_read_b64_tr_b16 a[234:235], v237 offset:10240
  ds_read_b64_tr_b16 a[192:193], v237 offset:24576
  v_mov_b32 v101, v97
  v_mov_b32 v102, v98
  v_mfma_f32_16x16x32_bf16 v[16:19], a[196:199], a[28:31], v[16:19]
  ds_read_b64_tr_b16 a[194:195], v237 offset:26624
  ds_read_b64_tr_b16 a[196:197], v238 offset:8192
  v_mov_b32 v103, v99
  v_mfma_f32_16x16x32_bf16 v[4:7], a[200:203], a[16:19], v[4:7]
  buffer_load_dwordx4 a[76:79], v240, s[4:7], s40 offen offset:1024 sc1
  v_permlane16_swap_b32 v100, v96
  v_permlane16_swap_b32 v101, v97
  s_waitcnt lgkmcnt(13)
  v_mfma_f32_16x16x32_bf16 v[4:7], a[204:207], a[24:27], v[4:7]
  ds_read_b64_tr_b16 a[198:199], v238 offset:10240
  s_mov_b32 s40, 8650752
  v_permlane16_swap_b32 v102, v98
  v_mfma_f32_16x16x32_bf16 v[20:23], a[200:203], a[20:23], v[20:23]
  ds_read_b64_tr_b16 a[200:201], v238 offset:24576
  ds_read_b64_tr_b16 a[202:203], v238 offset:26624
  v_permlane16_swap_b32 v103, v99
  v_add_f32 v96, v96, v100
  v_mfma_f32_16x16x32_bf16 v[20:23], a[204:207], a[28:31], v[20:23]
  buffer_load_dwordx4 a[80:83], v240, s[4:7], s40 offen offset:0 sc1
  v_add_f32 v97, v97, v101
  v_mfma_f32_16x16x32_bf16 v[8:11], a[208:211], a[16:19], v[8:11]
  ds_read_b64_tr_b16 a[204:205], v239 offset:8192
  ds_read_b64_tr_b16 a[206:207], v239 offset:10240
  v_add_f32 v98, v98, v102
  v_add_f32 v99, v99, v103
  v_mfma_f32_16x16x32_bf16 v[8:11], a[212:215], a[24:27], v[8:11]
  v_mov_b32 v100, v96
  v_mov_b32 v101, v97
  v_mov_b32 v102, v98
  v_mfma_f32_16x16x32_bf16 v[24:27], a[208:211], a[20:23], v[24:27]
  buffer_load_dwordx4 a[84:87], v240, s[4:7], s40 offen offset:1024 sc1
  s_mov_b32 s40, 8781824
  v_mfma_f32_16x16x32_bf16 v[24:27], a[212:215], a[28:31], v[24:27]
  ds_read_b64_tr_b16 a[208:209], v239 offset:24576
  ds_read_b64_tr_b16 a[210:211], v239 offset:26624
  v_mov_b32 v103, v99
  s_waitcnt lgkmcnt(13)
  v_mfma_f32_16x16x32_bf16 v[12:15], a[216:219], a[16:19], v[12:15]
  ds_read_b64_tr_b16 a[212:213], v228 offset:20480
  ds_read_b64_tr_b16 a[214:215], v228 offset:22528
  v_permlane32_swap_b32 v100, v96
  v_permlane32_swap_b32 v101, v97
  v_mfma_f32_16x16x32_bf16 v[12:15], a[220:223], a[24:27], v[12:15]
  buffer_load_dwordx4 a[88:91], v240, s[4:7], s40 offen offset:0 sc1
  v_permlane32_swap_b32 v102, v98
  v_mfma_f32_16x16x32_bf16 v[28:31], a[216:219], a[20:23], v[28:31]
  ds_read_b64_tr_b16 a[216:217], v228 offset:12288
  ds_read_b64_tr_b16 a[218:219], v228 offset:14336
  v_permlane32_swap_b32 v103, v99
  v_add_f32 v96, v96, v100
  v_mfma_f32_16x16x32_bf16 v[28:31], a[220:223], a[28:31], v[28:31]
  s_barrier
  ds_read_b64_tr_b16 a[220:221], v229 offset:20480
  v_add_f32 v97, v97, v101
  s_waitcnt vmcnt(11)
  v_mfma_f32_16x16x32_bf16 v[0:3], a[224:227], a[32:35], v[0:3]
  buffer_load_dwordx4 a[92:95], v240, s[4:7], s40 offen offset:1024 sc1
  v_add_f32 v98, v98, v102
  v_add_f32 v99, v99, v103
  s_waitcnt lgkmcnt(13)
  v_mfma_f32_16x16x32_bf16 v[0:3], a[228:231], a[40:43], v[0:3]
  ds_read_b64_tr_b16 a[222:223], v229 offset:22528
  s_mov_b32 s41, 0
  s_add_u32 m0, s42, 65536
  v_cvt_pk_bf16_f32 v100, v96, v97
  v_mfma_f32_16x16x32_bf16 v[16:19], a[224:227], a[36:39], v[16:19]
  ds_read_b64_tr_b16 a[224:225], v229 offset:12288
  ds_read_b64_tr_b16 a[226:227], v229 offset:14336
  v_lshlrev_b32 v96, 16, v100
  v_and_b32 v97, 0xffff0000, v100
  v_mfma_f32_16x16x32_bf16 v[16:19], a[228:231], a[44:47], v[16:19]
  buffer_load_dwordx4 v227, s[12:15], s41 offen offset:0 lds
  v_cvt_pk_bf16_f32 v101, v98, v99
  v_mfma_f32_16x16x32_bf16 v[4:7], a[232:235], a[32:35], v[4:7]
  ds_read_b64_tr_b16 a[228:229], v230 offset:20480
  ds_read_b64_tr_b16 a[230:231], v230 offset:22528
  s_mov_b32 s41, 229376
  v_lshlrev_b32 v98, 16, v101
  v_and_b32 v99, 0xffff0000, v101
  v_mfma_f32_16x16x32_bf16 v[4:7], a[192:195], a[40:43], v[4:7]
  s_add_u32 m0, s42, 94208
  v_add_f32 v96, s39, v96
  v_add_f32 v97, s39, v97
  v_mfma_f32_16x16x32_bf16 v[20:23], a[232:235], a[36:39], v[20:23]
  buffer_load_dwordx4 v227, s[12:15], s41 offen offset:0 lds
  v_add_f32 v98, s39, v98
  v_mfma_f32_16x16x32_bf16 v[20:23], a[192:195], a[44:47], v[20:23]
  ds_read_b64_tr_b16 a[232:233], v230 offset:12288
  ds_read_b64_tr_b16 a[234:235], v230 offset:14336
  s_mov_b32 s40, 8912896
  v_add_f32 v99, s39, v99
  s_waitcnt lgkmcnt(13)
  v_mfma_f32_16x16x32_bf16 v[8:11], a[196:199], a[32:35], v[8:11]
  ds_read_b64_tr_b16 a[192:193], v231 offset:20480
  ds_read_b64_tr_b16 a[194:195], v231 offset:22528
  v_cvt_pk_bf16_f32 v100, v96, v97
  v_lshlrev_b32 v96, 16, v100
  v_mfma_f32_16x16x32_bf16 v[8:11], a[200:203], a[40:43], v[8:11]
  buffer_load_dwordx4 a[96:99], v240, s[4:7], s40 offen offset:0 sc1
  v_and_b32 v97, 0xffff0000, v100
  v_mfma_f32_16x16x32_bf16 v[24:27], a[196:199], a[36:39], v[24:27]
  ds_read_b64_tr_b16 a[196:197], v231 offset:12288
  ds_read_b64_tr_b16 a[198:199], v231 offset:14336
  v_cvt_pk_bf16_f32 v101, v98, v99
  v_lshlrev_b32 v98, 16, v101
  v_mfma_f32_16x16x32_bf16 v[24:27], a[200:203], a[44:47], v[24:27]
  ds_read_b64_tr_b16 a[200:201], v228 offset:24576
  ds_read_b64_tr_b16 a[202:203], v228 offset:26624
L_wk0_5:
  s_cbranch_vccnz L_wk0_end
  v_and_b32 v99, 0xffff0000, v101
  v_mfma_f32_16x16x32_bf16 v[12:15], a[204:207], a[32:35], v[12:15]
  buffer_load_dwordx4 a[100:103], v240, s[4:7], s40 offen offset:1024 sc1
  s_mov_b32 s40, 9043968
  ds_write_b128 v213, v[96:99] offset:10240
  s_waitcnt lgkmcnt(13)
  v_mfma_f32_16x16x32_bf16 v[12:15], a[208:211], a[40:43], v[12:15]
  v_mfma_f32_16x16x32_bf16 v[28:31], a[204:207], a[36:39], v[28:31]
  ds_read_b64_tr_b16 a[204:205], v228 offset:45056
  ds_read_b64_tr_b16 a[206:207], v228 offset:47104
  v_mfma_f32_16x16x32_bf16 v[28:31], a[208:211], a[44:47], v[28:31]
  s_barrier
  ds_read_b64_tr_b16 a[208:209], v229 offset:24576
  s_waitcnt vmcnt(12)
  v_mfma_f32_16x16x32_bf16 v[0:3], a[212:215], a[48:51], v[0:3]
  buffer_load_dwordx4 a[104:107], v240, s[4:7], s40 offen offset:0 sc1
  v_mfma_f32_16x16x32_bf16 v[0:3], a[216:219], a[56:59], v[0:3]
  ds_read_b64_tr_b16 a[210:211], v229 offset:26624
  v_mfma_f32_16x16x32_bf16 v[16:19], a[212:215], a[52:55], v[16:19]
  buffer_load_dwordx4 a[108:111], v240, s[4:7], s40 offen offset:1024 sc1
  s_waitcnt lgkmcnt(4)
  v_mfma_f32_16x16x32_bf16 v[16:19], a[216:219], a[60:63], v[16:19]
  ds_read_b64_tr_b16 a[212:213], v229 offset:45056
  ds_read_b64_tr_b16 a[214:215], v229 offset:47104
  s_mov_b32 s41, 0
  v_mfma_f32_16x16x32_bf16 v[4:7], a[220:223], a[48:51], v[4:7]
  ds_read_b64_tr_b16 a[216:217], v230 offset:24576
  ds_read_b64_tr_b16 a[218:219], v230 offset:26624
  s_add_u32 m0, s42, 106496
  v_mfma_f32_16x16x32_bf16 v[4:7], a[224:227], a[56:59], v[4:7]
  buffer_load_dwordx4 v227, s[16:19], s41 offen offset:0 lds
  v_mfma_f32_16x16x32_bf16 v[20:23], a[220:223], a[52:55], v[20:23]
  ds_read_b64_tr_b16 a[220:221], v230 offset:45056
  ds_read_b64_tr_b16 a[222:223], v230 offset:47104
  s_mov_b32 s41, 229376
  v_mfma_f32_16x16x32_bf16 v[20:23], a[224:227], a[60:63], v[20:23]
  ds_read_b64_tr_b16 a[224:225], v231 offset:24576
  ds_read_b64_tr_b16 a[226:227], v231 offset:26624
  s_add_u32 m0, s42, 114688
  v_mfma_f32_16x16x32_bf16 v[8:11], a[228:231], a[48:51], v[8:11]
  buffer_load_dwordx4 v227, s[16:19], s41 offen offset:0 lds
  v_mfma_f32_16x16x32_bf16 v[8:11], a[232:235], a[56:59], v[8:11]
  s_mov_b32 s40, 9175040
  v_mfma_f32_16x16x32_bf16 v[24:27], a[228:231], a[52:55], v[24:27]
  ds_read_b64_tr_b16 a[228:229], v231 offset:45056
  ds_read_b64_tr_b16 a[230:231], v231 offset:47104
  v_mfma_f32_16x16x32_bf16 v[24:27], a[232:235], a[60:63], v[24:27]
  buffer_load_dwordx4 a[112:115], v240, s[4:7], s40 offen offset:0 sc1
  v_mfma_f32_16x16x32_bf16 v[12:15], a[192:195], a[48:51], v[12:15]
  ds_read_b64_tr_b16 a[232:233], v228 offset:36864
  ds_read_b64_tr_b16 a[234:235], v228 offset:38912
  v_mfma_f32_16x16x32_bf16 v[12:15], a[196:199], a[56:59], v[12:15]
  v_mfma_f32_16x16x32_bf16 v[28:31], a[192:195], a[52:55], v[28:31]
  buffer_load_dwordx4 a[116:119], v240, s[4:7], s40 offen offset:1024 sc1
  s_mov_b32 s40, 9306112
  v_mfma_f32_16x16x32_bf16 v[28:31], a[196:199], a[60:63], v[28:31]
  s_barrier
  ds_read_b64_tr_b16 a[192:193], v228 offset:49152
  ds_read_b128 v[64:67], v250 offset:10240
  s_waitcnt vmcnt(14)
  v_mfma_f32_16x16x32_bf16 v[0:3], a[200:203], a[64:67], v[0:3]
  ds_read_b64_tr_b16 a[194:195], v228 offset:51200
  ds_read_b64_tr_b16 a[196:197], v229 offset:36864
  ds_read_b128 v[68:71], v250 offset:10304
  s_waitcnt lgkmcnt(13)
  v_mfma_f32_16x16x32_bf16 v[0:3], a[204:207], a[72:75], v[0:3]
  buffer_load_dwordx4 a[120:123], v240, s[4:7], s40 offen offset:0 sc1
  ds_read_b128 v[72:75], v250 offset:10368
  v_mfma_f32_16x16x32_bf16 v[16:19], a[200:203], a[68:71], v[16:19]
  ds_read_b64_tr_b16 a[198:199], v229 offset:38912
  ds_read_b64_tr_b16 a[200:201], v229 offset:49152
  ds_read_b128 v[76:79], v250 offset:10432
  v_mfma_f32_16x16x32_bf16 v[16:19], a[204:207], a[76:79], v[16:19]
  ds_read_b64_tr_b16 a[202:203], v229 offset:51200
  ds_read_b64_tr_b16 a[204:205], v230 offset:36864
  ds_read_b128 v[96:99], v250 offset:10496
  v_mfma_f32_16x16x32_bf16 v[4:7], a[208:211], a[64:67], v[4:7]
  buffer_load_dwordx4 a[124:127], v240, s[4:7], s40 offen offset:1024 sc1
  ds_read_b128 v[100:103], v250 offset:10560
  v_mfma_f32_16x16x32_bf16 v[4:7], a[212:215], a[72:75], v[4:7]
  ds_read_b64_tr_b16 a[206:207], v230 offset:38912
  s_mov_b32 s41, 0
  s_add_u32 m0, s42, 143360
  ds_read_b128 v[104:107], v250 offset:10624
  v_mfma_f32_16x16x32_bf16 v[20:23], a[208:211], a[68:71], v[20:23]
  ds_read_b64_tr_b16 a[208:209], v230 offset:49152
  ds_read_b64_tr_b16 a[210:211], v230 offset:51200
  ds_read_b128 v[108:111], v250 offset:10688
  v_mfma_f32_16x16x32_bf16 v[20:23], a[212:215], a[76:79], v[20:23]
  buffer_load_dwordx4 v226, s[12:15], s41 offen offset:0 lds
  ds_read_b128 v[144:147], v250 offset:10752
  v_mfma_f32_16x16x32_bf16 v[8:11], a[216:219], a[64:67], v[8:11]
  ds_read_b64_tr_b16 a[212:213], v231 offset:36864
  ds_read_b64_tr_b16 a[214:215], v231 offset:38912
  s_mov_b32 s41, 229376
  ds_read_b128 v[148:151], v250 offset:10816
  s_waitcnt lgkmcnt(13)
  v_mfma_f32_16x16x32_bf16 v[8:11], a[220:223], a[72:75], v[8:11]
  s_add_u32 m0, s42, 69632
  ds_read_b128 v[152:155], v250 offset:10880
  v_mfma_f32_16x16x32_bf16 v[24:27], a[216:219], a[68:71], v[24:27]
  buffer_load_dwordx4 v226, s[12:15], s41 offen offset:0 lds
  ds_read_b128 v[156:159], v250 offset:10944
  v_mfma_f32_16x16x32_bf16 v[24:27], a[220:223], a[76:79], v[24:27]
  ds_read_b64_tr_b16 a[216:217], v231 offset:49152
  ds_read_b64_tr_b16 a[218:219], v231 offset:51200
  s_mov_b32 s41, 0
  v_mfma_f32_16x16x32_bf16 v[12:15], a[224:227], a[64:67], v[12:15]
  ds_read_b64_tr_b16 a[220:221], v228 offset:32768
  ds_read_b64_tr_b16 a[222:223], v228 offset:34816
  s_add_u32 m0, s42, 81920
  v_mfma_f32_16x16x32_bf16 v[12:15], a[228:231], a[72:75], v[12:15]
  buffer_load_dwordx4 v226, s[16:19], s41 offen offset:0 lds
  v_mfma_f32_16x16x32_bf16 v[28:31], a[224:227], a[68:71], v[28:31]
  ds_read_b64_tr_b16 a[224:225], v228 offset:40960
  ds_read_b64_tr_b16 a[226:227], v228 offset:43008
  s_mov_b32 s41, 229376
  v_mfma_f32_16x16x32_bf16 v[28:31], a[228:231], a[76:79], v[28:31]
  s_barrier
  ds_read_b64_tr_b16 a[228:229], v229 offset:32768
  s_waitcnt vmcnt(15)
  v_mfma_f32_16x16x32_bf16 v[0:3], a[232:235], a[80:83], v[0:3]
  ds_read_b64_tr_b16 a[230:231], v229 offset:34816
  s_add_u32 m0, s42, 61440
  v_mfma_f32_16x16x32_bf16 v[0:3], a[192:195], a[88:91], v[0:3]
  buffer_load_dwordx4 v226, s[16:19], s41 offen offset:0 lds
  v_mfma_f32_16x16x32_bf16 v[16:19], a[232:235], a[84:87], v[16:19]
  ds_read_b64_tr_b16 a[232:233], v229 offset:40960
  ds_read_b64_tr_b16 a[234:235], v229 offset:43008
  s_mov_b32 s41, 458752
  v_mfma_f32_16x16x32_bf16 v[16:19], a[192:195], a[92:95], v[16:19]
  ds_read_b64_tr_b16 a[192:193], v230 offset:32768
  ds_read_b64_tr_b16 a[194:195], v230 offset:34816
  s_add_u32 m0, s42, 90112
  v_mfma_f32_16x16x32_bf16 v[4:7], a[196:199], a[80:83], v[4:7]
  buffer_load_dwordx4 v227, s[12:15], s41 offen offset:0 lds
  s_waitcnt lgkmcnt(13)
  v_mfma_f32_16x16x32_bf16 v[4:7], a[200:203], a[88:91], v[4:7]
  s_mov_b32 s41, 688128
  s_add_u32 m0, s42, 118784
  v_mfma_f32_16x16x32_bf16 v[20:23], a[196:199], a[84:87], v[20:23]
  buffer_load_dwordx4 v227, s[12:15], s41 offen offset:0 lds
  v_mfma_f32_16x16x32_bf16 v[20:23], a[200:203], a[92:95], v[20:23]
  ds_read_b64_tr_b16 a[196:197], v230 offset:40960
  ds_read_b64_tr_b16 a[198:199], v230 offset:43008
  s_mov_b32 s41, 458752
  v_mfma_f32_16x16x32_bf16 v[8:11], a[204:207], a[80:83], v[8:11]
  ds_read_b64_tr_b16 a[200:201], v231 offset:32768
  ds_read_b64_tr_b16 a[202:203], v231 offset:34816
  s_add_u32 m0, s42, 131072
  v_mfma_f32_16x16x32_bf16 v[8:11], a[208:211], a[88:91], v[8:11]
  buffer_load_dwordx4 v227, s[16:19], s41 offen offset:0 lds
  v_mfma_f32_16x16x32_bf16 v[24:27], a[204:207], a[84:87], v[24:27]
  ds_read_b64_tr_b16 a[204:205], v231 offset:40960
  ds_read_b64_tr_b16 a[206:207], v231 offset:43008
  s_mov_b32 s41, 688128
  v_mfma_f32_16x16x32_bf16 v[24:27], a[208:211], a[92:95], v[24:27]
  ds_read_b64_tr_b16 a[208:209], v228 offset:53248
  ds_read_b64_tr_b16 a[210:211], v228 offset:55296
  s_add_u32 m0, s42, 77824
  v_mfma_f32_16x16x32_bf16 v[12:15], a[212:215], a[80:83], v[12:15]
  buffer_load_dwordx4 v227, s[16:19], s41 offen offset:0 lds
  s_waitcnt lgkmcnt(13)
  v_mfma_f32_16x16x32_bf16 v[12:15], a[216:219], a[88:91], v[12:15]
  s_mov_b32 s41, 458752
  s_add_u32 m0, s42, 73728
  v_mfma_f32_16x16x32_bf16 v[28:31], a[212:215], a[84:87], v[28:31]
  ds_read_b64_tr_b16 a[212:213], v228 offset:57344
  ds_read_b64_tr_b16 a[214:215], v228 offset:59392
  v_mfma_f32_16x16x32_bf16 v[28:31], a[216:219], a[92:95], v[28:31]
  s_waitcnt vmcnt(19)
  s_barrier
  ds_read_b64_tr_b16 a[216:217], v229 offset:53248
  s_waitcnt vmcnt(14)
  v_mfma_f32_16x16x32_bf16 v[0:3], a[220:223], a[96:99], v[0:3]
  buffer_load_dwordx4 v226, s[12:15], s41 offen offset:0 lds
  v_mfma_f32_16x16x32_bf16 v[0:3], a[224:227], a[104:107], v[0:3]
  ds_read_b64_tr_b16 a[218:219], v229 offset:55296
  s_mov_b32 s41, 688128
  s_add_u32 m0, s42, 86016
  v_mfma_f32_16x16x32_bf16 v[16:19], a[220:223], a[100:103], v[16:19]
  buffer_load_dwordx4 v226, s[12:15], s41 offen offset:0 lds
  v_mfma_f32_16x16x32_bf16 v[16:19], a[224:227], a[108:111], v[16:19]
  ds_read_b64_tr_b16 a[220:221], v229 offset:57344
  ds_read_b64_tr_b16 a[222:223], v229 offset:59392
  s_mov_b32 s41, 458752
  s_waitcnt lgkmcnt(13)
  v_mfma_f32_16x16x32_bf16 v[4:7], a[228:231], a[96:99], v[4:7]
  ds_read_b64_tr_b16 a[224:225], v230 offset:53248
  ds_read_b64_tr_b16 a[226:227], v230 offset:55296
  s_add_u32 m0, s42, 102400
  v_mfma_f32_16x16x32_bf16 v[4:7], a[232:235], a[104:107], v[4:7]
  buffer_load_dwordx4 v226, s[16:19], s41 offen offset:0 lds
  v_mfma_f32_16x16x32_bf16 v[20:23], a[228:231], a[100:103], v[20:23]
  ds_read_b64_tr_b16 a[228:229], v230 offset:57344
  ds_read_b64_tr_b16 a[230:231], v230 offset:59392
  s_mov_b32 s41, 688128
  v_mfma_f32_16x16x32_bf16 v[20:23], a[232:235], a[108:111], v[20:23]
  ds_read_b64_tr_b16 a[232:233], v231 offset:53248
  ds_read_b64_tr_b16 a[234:235], v231 offset:55296
  s_add_u32 m0, s42, 98304
  v_mfma_f32_16x16x32_bf16 v[8:11], a[192:195], a[96:99], v[8:11]
  buffer_load_dwordx4 v226, s[16:19], s41 offen offset:0 lds
  s_waitcnt lgkmcnt(13)
  v_mfma_f32_16x16x32_bf16 v[8:11], a[196:199], a[104:107], v[8:11]
  s_mov_b32 s41, 917504
  s_add_u32 m0, s42, 110592
  v_mfma_f32_16x16x32_bf16 v[24:27], a[192:195], a[100:103], v[24:27]
  ds_read_b64_tr_b16 a[192:193], v231 offset:57344
  ds_read_b64_tr_b16 a[194:195], v231 offset:59392
  v_mfma_f32_16x16x32_bf16 v[24:27], a[196:199], a[108:111], v[24:27]
  buffer_load_dwordx4 v227, s[12:15], s41 offen offset:0 lds
  v_mfma_f32_16x16x32_bf16 v[12:15], a[200:203], a[96:99], v[12:15]
  ds_read_b64_tr_b16 a[196:197], v232 offset:0
  ds_read_b64_tr_b16 a[198:199], v232 offset:2048
  s_mov_b32 s41, 1146880
  v_mfma_f32_16x16x32_bf16 v[12:15], a[204:207], a[104:107], v[12:15]
  s_add_u32 m0, s42, 126976
  v_mfma_f32_16x16x32_bf16 v[28:31], a[200:203], a[100:103], v[28:31]
  buffer_load_dwordx4 v227, s[12:15], s41 offen offset:0 lds
  v_mfma_f32_16x16x32_bf16 v[28:31], a[204:207], a[108:111], v[28:31]
  s_barrier
  ds_read_b64_tr_b16 a[200:201], v232 offset:28672
  s_waitcnt vmcnt(14) lgkmcnt(13)
  v_mfma_f32_16x16x32_bf16 v[0:3], a[208:211], a[112:115], v[0:3]
  ds_read_b64_tr_b16 a[202:203], v232 offset:30720
  ds_read_b64_tr_b16 a[204:205], v233 offset:0
  s_mov_b32 s41, 917504
  v_mfma_f32_16x16x32_bf16 v[0:3], a[212:215], a[120:123], v[0:3]
  ds_read_b64_tr_b16 a[206:207], v233 offset:2048
  s_add_u32 m0, s42, 122880
  v_mfma_f32_16x16x32_bf16 v[16:19], a[208:211], a[116:119], v[16:19]
  buffer_load_dwordx4 v227, s[16:19], s41 offen offset:0 lds
  v_mfma_f32_16x16x32_bf16 v[16:19], a[212:215], a[124:127], v[16:19]
  ds_read_b64_tr_b16 a[208:209], v233 offset:28672
  ds_read_b64_tr_b16 a[210:211], v233 offset:30720
  s_mov_b32 s41, 1146880
  v_mfma_f32_16x16x32_bf16 v[4:7], a[216:219], a[112:115], v[4:7]
  s_add_u32 m0, s42, 135168
  s_waitcnt lgkmcnt(13)
  v_mfma_f32_16x16x32_bf16 v[4:7], a[220:223], a[120:123], v[4:7]
  buffer_load_dwordx4 v227, s[16:19], s41 offen offset:0 lds
  v_mfma_f32_16x16x32_bf16 v[20:23], a[216:219], a[116:119], v[20:23]
  v_mfma_f32_16x16x32_bf16 v[20:23], a[220:223], a[124:127], v[20:23]
  v_mfma_f32_16x16x32_bf16 v[8:11], a[224:227], a[112:115], v[8:11]
  s_waitcnt lgkmcnt(12)
  v_mfma_f32_16x16x32_bf16 v[8:11], a[228:231], a[120:123], v[8:11]
  v_mfma_f32_16x16x32_bf16 v[24:27], a[224:227], a[116:119], v[24:27]
  v_mfma_f32_16x16x32_bf16 v[24:27], a[228:231], a[124:127], v[24:27]
  s_waitcnt lgkmcnt(10)
  v_mfma_f32_16x16x32_bf16 v[12:15], a[232:235], a[112:115], v[12:15]
  s_waitcnt lgkmcnt(8)
  v_mfma_f32_16x16x32_bf16 v[12:15], a[192:195], a[120:123], v[12:15]
  v_mfma_f32_16x16x32_bf16 v[28:31], a[232:235], a[116:119], v[28:31]
  v_mfma_f32_16x16x32_bf16 v[28:31], a[192:195], a[124:127], v[28:31]
  v_pk_fma_f32 v[160:161], v[0:1], v[64:65], v[160:161]
  v_pk_fma_f32 v[162:163], v[2:3], v[66:67], v[162:163]
  v_pk_fma_f32 v[164:165], v[4:5], v[68:69], v[164:165]
  v_pk_fma_f32 v[166:167], v[6:7], v[70:71], v[166:167]
  v_pk_fma_f32 v[168:169], v[8:9], v[72:73], v[168:169]
  v_pk_fma_f32 v[170:171], v[10:11], v[74:75], v[170:171]
  v_pk_fma_f32 v[172:173], v[12:13], v[76:77], v[172:173]
  v_pk_fma_f32 v[174:175], v[14:15], v[78:79], v[174:175]
  v_pk_fma_f32 v[176:177], v[16:17], v[64:65], v[176:177]
  v_pk_fma_f32 v[178:179], v[18:19], v[66:67], v[178:179]
  v_pk_fma_f32 v[180:181], v[20:21], v[68:69], v[180:181]
  v_pk_fma_f32 v[182:183], v[22:23], v[70:71], v[182:183]
  v_pk_fma_f32 v[184:185], v[24:25], v[72:73], v[184:185]
  v_pk_fma_f32 v[186:187], v[26:27], v[74:75], v[186:187]
  v_pk_fma_f32 v[188:189], v[28:29], v[76:77], v[188:189]
  v_pk_fma_f32 v[190:191], v[30:31], v[78:79], v[190:191]
  v_pk_mul_f32 v[84:85], v[160:161], v[160:161]
  v_pk_mul_f32 v[86:87], v[176:177], v[176:177]
  v_pk_fma_f32 v[84:85], v[162:163], v[162:163], v[84:85]
  v_pk_add_f32 v[80:81], v[160:161], v[162:163]
  v_pk_fma_f32 v[86:87], v[178:179], v[178:179], v[86:87]
  v_pk_add_f32 v[82:83], v[176:177], v[178:179]
  v_pk_fma_f32 v[84:85], v[164:165], v[164:165], v[84:85]
  v_pk_add_f32 v[80:81], v[80:81], v[164:165]
  v_pk_fma_f32 v[86:87], v[180:181], v[180:181], v[86:87]
  v_pk_add_f32 v[82:83], v[82:83], v[180:181]
  v_pk_fma_f32 v[84:85], v[166:167], v[166:167], v[84:85]
  v_pk_add_f32 v[80:81], v[80:81], v[166:167]
  v_pk_fma_f32 v[86:87], v[182:183], v[182:183], v[86:87]
  v_pk_add_f32 v[82:83], v[82:83], v[182:183]
  v_pk_fma_f32 v[84:85], v[168:169], v[168:169], v[84:85]
  v_pk_add_f32 v[80:81], v[80:81], v[168:169]
  v_pk_fma_f32 v[86:87], v[184:185], v[184:185], v[86:87]
  v_pk_add_f32 v[82:83], v[82:83], v[184:185]
  v_pk_fma_f32 v[84:85], v[170:171], v[170:171], v[84:85]
  v_pk_add_f32 v[80:81], v[80:81], v[170:171]
  v_pk_fma_f32 v[86:87], v[186:187], v[186:187], v[86:87]
  v_pk_add_f32 v[82:83], v[82:83], v[186:187]
  v_pk_fma_f32 v[84:85], v[172:173], v[172:173], v[84:85]
  v_pk_add_f32 v[80:81], v[80:81], v[172:173]
  v_pk_fma_f32 v[86:87], v[188:189], v[188:189], v[86:87]
  v_pk_add_f32 v[82:83], v[82:83], v[188:189]
  v_pk_fma_f32 v[84:85], v[174:175], v[174:175], v[84:85]
  v_pk_add_f32 v[80:81], v[80:81], v[174:175]
  v_pk_fma_f32 v[86:87], v[190:191], v[190:191], v[86:87]
  v_pk_add_f32 v[82:83], v[82:83], v[190:191]
  v_add_f32 v80, v80, v81
  v_add_f32 v81, v84, v85
  v_add_f32 v82, v82, v83
  v_add_f32 v83, v86, v87
  v_mov_b32 v84, v80
  v_mov_b32 v85, v81
  v_mov_b32 v86, v82
  v_mov_b32 v87, v83
  v_permlane16_swap_b32 v84, v80
  v_permlane16_swap_b32 v85, v81
  v_permlane16_swap_b32 v86, v82
  v_permlane16_swap_b32 v87, v83
  v_add_f32 v80, v80, v84
  v_add_f32 v81, v81, v85
  v_add_f32 v82, v82, v86
  v_add_f32 v83, v83, v87
  v_mov_b32 v84, v80
  v_mov_b32 v85, v81
  v_mov_b32 v86, v82
  v_mov_b32 v87, v83
  v_permlane32_swap_b32 v84, v80
  v_permlane32_swap_b32 v85, v81
  v_permlane32_swap_b32 v86, v82
  v_permlane32_swap_b32 v87, v83
  v_add_f32 v80, v80, v84
  v_add_f32 v81, v81, v85
  v_add_f32 v82, v82, v86
  v_add_f32 v83, v83, v87
  v_cndmask_b32_e64 v84, v82, v80, s[34:35]
  v_cndmask_b32_e64 v85, v83, v81, s[34:35]
  v_and_b32 v84, -2, v84
  v_and_b32 v85, 0x7fffffff, v85
  s_mov_b32 exec_hi, 0
  buffer_store_dwordx2 v[84:85], v211, s[4:7], s95 offen sc1
  s_mov_b64 exec, -1
  v_cvt_pk_bf16_f32 v32, v160, v161
  v_cvt_pk_bf16_f32 v33, v162, v163
  v_cvt_pk_bf16_f32 v34, v164, v165
  v_cvt_pk_bf16_f32 v35, v166, v167
  v_cvt_pk_bf16_f32 v36, v168, v169
  v_cvt_pk_bf16_f32 v37, v170, v171
  v_cvt_pk_bf16_f32 v38, v172, v173
  v_cvt_pk_bf16_f32 v39, v174, v175
  v_cvt_pk_bf16_f32 v40, v176, v177
  v_cvt_pk_bf16_f32 v41, v178, v179
  v_cvt_pk_bf16_f32 v42, v180, v181
  v_cvt_pk_bf16_f32 v43, v182, v183
  v_cvt_pk_bf16_f32 v44, v184, v185
  v_cvt_pk_bf16_f32 v45, v186, v187
  v_cvt_pk_bf16_f32 v46, v188, v189
  v_cvt_pk_bf16_f32 v47, v190, v191
  v_accvgpr_write_b32 a236, v32
  v_lshlrev_b32 v0, 16, v32
  v_and_b32 v1, 0xffff0000, v32
  v_accvgpr_write_b32 a237, v33
  v_lshlrev_b32 v2, 16, v33
  v_and_b32 v3, 0xffff0000, v33
  v_accvgpr_write_b32 a238, v34
  v_lshlrev_b32 v4, 16, v34
  v_and_b32 v5, 0xffff0000, v34
  v_accvgpr_write_b32 a239, v35
  v_lshlrev_b32 v6, 16, v35
  v_and_b32 v7, 0xffff0000, v35
  v_accvgpr_write_b32 a240, v36
  v_lshlrev_b32 v8, 16, v36
  v_and_b32 v9, 0xffff0000, v36
  v_accvgpr_write_b32 a241, v37
  v_lshlrev_b32 v10, 16, v37
  v_and_b32 v11, 0xffff0000, v37
  v_accvgpr_write_b32 a242, v38
  v_lshlrev_b32 v12, 16, v38
  v_and_b32 v13, 0xffff0000, v38
  v_accvgpr_write_b32 a243, v39
  v_lshlrev_b32 v14, 16, v39
  v_and_b32 v15, 0xffff0000, v39
  v_accvgpr_write_b32 a244, v40
  v_lshlrev_b32 v16, 16, v40
  v_and_b32 v17, 0xffff0000, v40
  v_accvgpr_write_b32 a245, v41
  v_lshlrev_b32 v18, 16, v41
  v_and_b32 v19, 0xffff0000, v41
  v_accvgpr_write_b32 a246, v42
  v_lshlrev_b32 v20, 16, v42
  v_and_b32 v21, 0xffff0000, v42
  v_accvgpr_write_b32 a247, v43
  v_lshlrev_b32 v22, 16, v43
  v_and_b32 v23, 0xffff0000, v43
  v_accvgpr_write_b32 a248, v44
  v_lshlrev_b32 v24, 16, v44
  v_and_b32 v25, 0xffff0000, v44
  v_accvgpr_write_b32 a249, v45
  v_lshlrev_b32 v26, 16, v45
  v_and_b32 v27, 0xffff0000, v45
  v_accvgpr_write_b32 a250, v46
  v_lshlrev_b32 v28, 16, v46
  v_and_b32 v29, 0xffff0000, v46
  v_accvgpr_write_b32 a251, v47
  v_lshlrev_b32 v30, 16, v47
  v_and_b32 v31, 0xffff0000, v47
  s_mov_b64 vcc, -1
  s_cmp_eq_u32 s3, 0
  s_cbranch_scc1 L_wk1_0
  s_cmp_eq_u32 s3, 1
  s_cbranch_scc1 L_wk1_1
  s_cmp_eq_u32 s3, 2
  s_cbranch_scc1 L_wk1_2
  s_branch L_wk1_3
L_wk1_end:
  s_mov_b64 vcc, 0
  s_mov_b32 s33, 262144
L_spin_20:
  buffer_load_dwordx2 v[112:113], v212, s[4:7], s94 offen offset:0 sc1
  buffer_load_dwordx2 v[114:115], v212, s[4:7], s94 offen offset:1024 sc1
  buffer_load_dwordx2 v[116:117], v212, s[4:7], s94 offen offset:2048 sc1
  buffer_load_dwordx2 v[118:119], v212, s[4:7], s94 offen offset:3072 sc1
  buffer_load_dwordx2 v[120:121], v212, s[4:7], s94 offen offset:128 sc1
  buffer_load_dwordx2 v[122:123], v212, s[4:7], s94 offen offset:1152 sc1
  buffer_load_dwordx2 v[124:125], v212, s[4:7], s94 offen offset:2176 sc1
  buffer_load_dwordx2 v[126:127], v212, s[4:7], s94 offen offset:3200 sc1
  s_waitcnt vmcnt(0)
  v_max3_u32 v88, v112, v113, v114
  v_max3_u32 v88, v88, v115, v116
  v_max3_u32 v88, v88, v117, v118
  v_max3_u32 v88, v88, v119, v120
  v_max3_u32 v88, v88, v121, v122
  v_max3_u32 v88, v88, v123, v124
  v_max3_u32 v88, v88, v125, v126
  v_max_u32 v88, v88, v127
  v_cmp_eq_u32 s[68:69], -1, v88
  s_nop 1
  s_cmp_eq_u64 s[68:69], 0
  s_cbranch_scc1 L_ok_21
  s_sub_u32 s33, s33, 1
  s_cmp_lg_u32 s33, 0
  s_cbranch_scc1 L_spin_20
L_ok_21:
  v_pk_add_f32 v[80:81], v[112:113], v[114:115]
  v_pk_add_f32 v[84:85], v[116:117], v[118:119]
  v_pk_add_f32 v[82:83], v[120:121], v[122:123]
  v_pk_add_f32 v[86:87], v[124:125], v[126:127]
  v_pk_add_f32 v[80:81], v[80:81], v[84:85]
  v_pk_add_f32 v[82:83], v[82:83], v[86:87]
  v_mov_b32 v84, v80
  v_mov_b32 v85, v81
  v_mov_b32 v86, v82
  v_mov_b32 v87, v83
  v_permlane16_swap_b32 v84, v80
  v_permlane16_swap_b32 v85, v81
  v_permlane16_swap_b32 v86, v82
  v_permlane16_swap_b32 v87, v83
  v_add_f32 v80, v80, v84
  v_add_f32 v81, v81, v85
  v_add_f32 v82, v82, v86
  v_add_f32 v83, v83, v87
  v_mov_b32 v84, v80
  v_mov_b32 v85, v81
  v_mov_b32 v86, v82
  v_mov_b32 v87, v83
  v_permlane32_swap_b32 v84, v80
  v_permlane32_swap_b32 v85, v81
  v_permlane32_swap_b32 v86, v82
  v_permlane32_swap_b32 v87, v83
  v_add_f32 v80, v80, v84
  v_add_f32 v81, v81, v85
  v_add_f32 v82, v82, v86
  v_add_f32 v83, v83, v87
  v_mul_f32 v160, 0x3a800000, v80
  v_mul_f32 v164, 0x3a800000, v81
  v_mul_f32 v172, 0x3a800000, v82
  v_mul_f32 v176, 0x3a800000, v83
  v_fma_f32 v164, -v160, v160, v164
  v_fma_f32 v176, -v172, v172, v176
  v_max_f32 v164, 0, v164
  v_max_f32 v176, 0, v176
  v_cvt_pk_bf16_f32 v168, v160, v164
  v_cvt_pk_bf16_f32 v180, v172, v176
  v_lshlrev_b32 v160, 16, v168
  v_lshlrev_b32 v172, 16, v180
  v_and_b32 v164, 0xffff0000, v168
  v_and_b32 v176, 0xffff0000, v180
  v_add_f32 v164, 0x3727c5ac, v164
  v_add_f32 v176, 0x3727c5ac, v176
  v_cvt_pk_bf16_f32 v168, v164, v165
  v_cvt_pk_bf16_f32 v180, v176, v177
  v_lshlrev_b32 v164, 16, v168
  v_lshlrev_b32 v176, 16, v180
  v_and_b32 v165, 0xffff0000, v168
  v_and_b32 v177, 0xffff0000, v180
  v_sqrt_f32 v164, v164
  v_sqrt_f32 v176, v176
  v_cvt_pk_bf16_f32 v168, v164, v165
  v_cvt_pk_bf16_f32 v180, v176, v177
  v_lshlrev_b32 v164, 16, v168
  v_lshlrev_b32 v176, 16, v180
  v_and_b32 v165, 0xffff0000, v168
  v_and_b32 v177, 0xffff0000, v180
  v_rcp_f32 v164, v164
  v_rcp_f32 v176, v176
  v_mov_b32 v161, v160
  v_mov_b32 v173, v172
  v_mov_b32 v165, v164
  v_mov_b32 v177, v176
  v_pk_add_f32 v[0:1], v[0:1], v[160:161] neg_lo:[0,1] neg_hi:[0,1]
  v_pk_add_f32 v[2:3], v[2:3], v[160:161] neg_lo:[0,1] neg_hi:[0,1]
  v_pk_add_f32 v[4:5], v[4:5], v[160:161] neg_lo:[0,1] neg_hi:[0,1]
  v_pk_add_f32 v[6:7], v[6:7], v[160:161] neg_lo:[0,1] neg_hi:[0,1]
  v_pk_add_f32 v[8:9], v[8:9], v[160:161] neg_lo:[0,1] neg_hi:[0,1]
  v_pk_add_f32 v[10:11], v[10:11], v[160:161] neg_lo:[0,1] neg_hi:[0,1]
  v_pk_add_f32 v[12:13], v[12:13], v[160:161] neg_lo:[0,1] neg_hi:[0,1]
  v_pk_add_f32 v[14:15], v[14:15], v[160:161] neg_lo:[0,1] neg_hi:[0,1]
  v_pk_mul_f32 v[0:1], v[0:1], v[164:165]
  v_pk_mul_f32 v[2:3], v[2:3], v[164:165]
  v_pk_mul_f32 v[4:5], v[4:5], v[164:165]
  v_pk_mul_f32 v[6:7], v[6:7], v[164:165]
  v_pk_mul_f32 v[8:9], v[8:9], v[164:165]
  v_pk_mul_f32 v[10:11], v[10:11], v[164:165]
  v_pk_mul_f32 v[12:13], v[12:13], v[164:165]
  v_pk_mul_f32 v[14:15], v[14:15], v[164:165]
  v_pk_fma_f32 v[0:1], v[0:1], v[144:145], v[96:97]
  v_pk_fma_f32 v[2:3], v[2:3], v[146:147], v[98:99]
  v_pk_fma_f32 v[4:5], v[4:5], v[148:149], v[100:101]
  v_pk_fma_f32 v[6:7], v[6:7], v[150:151], v[102:103]
  v_pk_fma_f32 v[8:9], v[8:9], v[152:153], v[104:105]
  v_pk_fma_f32 v[10:11], v[10:11], v[154:155], v[106:107]
  v_pk_fma_f32 v[12:13], v[12:13], v[156:157], v[108:109]
  v_pk_fma_f32 v[14:15], v[14:15], v[158:159], v[110:111]
  v_cvt_pk_bf16_f32 v112, v0, v1
  v_cvt_pk_bf16_f32 v113, v2, v3
  v_cvt_pk_bf16_f32 v114, v4, v5
  v_cvt_pk_bf16_f32 v115, v6, v7
  v_cvt_pk_bf16_f32 v116, v8, v9
  v_cvt_pk_bf16_f32 v117, v10, v11
  v_cvt_pk_bf16_f32 v118, v12, v13
  v_cvt_pk_bf16_f32 v119, v14, v15
  buffer_store_dwordx4 v[112:115], v240, s[4:7], s98 offen offset:0 sc1
  buffer_store_dwordx4 v[116:119], v240, s[4:7], s99 offen offset:0 sc1
  v_pk_add_f32 v[16:17], v[16:17], v[172:173] neg_lo:[0,1] neg_hi:[0,1]
  v_pk_add_f32 v[18:19], v[18:19], v[172:173] neg_lo:[0,1] neg_hi:[0,1]
  v_pk_add_f32 v[20:21], v[20:21], v[172:173] neg_lo:[0,1] neg_hi:[0,1]
  v_pk_add_f32 v[22:23], v[22:23], v[172:173] neg_lo:[0,1] neg_hi:[0,1]
  v_pk_add_f32 v[24:25], v[24:25], v[172:173] neg_lo:[0,1] neg_hi:[0,1]
  v_pk_add_f32 v[26:27], v[26:27], v[172:173] neg_lo:[0,1] neg_hi:[0,1]
  v_pk_add_f32 v[28:29], v[28:29], v[172:173] neg_lo:[0,1] neg_hi:[0,1]
  v_pk_add_f32 v[30:31], v[30:31], v[172:173] neg_lo:[0,1] neg_hi:[0,1]
  v_pk_mul_f32 v[16:17], v[16:17], v[176:177]
  v_pk_mul_f32 v[18:19], v[18:19], v[176:177]
  v_pk_mul_f32 v[20:21], v[20:21], v[176:177]
  v_pk_mul_f32 v[22:23], v[22:23], v[176:177]
  v_pk_mul_f32 v[24:25], v[24:25], v[176:177]
  v_pk_mul_f32 v[26:27], v[26:27], v[176:177]
  v_pk_mul_f32 v[28:29], v[28:29], v[176:177]
  v_pk_mul_f32 v[30:31], v[30:31], v[176:177]
  v_pk_fma_f32 v[16:17], v[16:17], v[144:145], v[96:97]
  v_pk_fma_f32 v[18:19], v[18:19], v[146:147], v[98:99]
  v_pk_fma_f32 v[20:21], v[20:21], v[148:149], v[100:101]
  v_pk_fma_f32 v[22:23], v[22:23], v[150:151], v[102:103]
  v_pk_fma_f32 v[24:25], v[24:25], v[152:153], v[104:105]
  v_pk_fma_f32 v[26:27], v[26:27], v[154:155], v[106:107]
  v_pk_fma_f32 v[28:29], v[28:29], v[156:157], v[108:109]
  v_pk_fma_f32 v[30:31], v[30:31], v[158:159], v[110:111]
  v_cvt_pk_bf16_f32 v120, v16, v17
  v_cvt_pk_bf16_f32 v121, v18, v19
  v_cvt_pk_bf16_f32 v122, v20, v21
  v_cvt_pk_bf16_f32 v123, v22, v23
  v_cvt_pk_bf16_f32 v124, v24, v25
  v_cvt_pk_bf16_f32 v125, v26, v27
  v_cvt_pk_bf16_f32 v126, v28, v29
  v_cvt_pk_bf16_f32 v127, v30, v31
  buffer_store_dwordx4 v[120:123], v240, s[4:7], s98 offen offset:1024 sc1
  buffer_store_dwordx4 v[124:127], v240, s[4:7], s99 offen offset:1024 sc1
  v_and_b32 v80, 1088, v254
  s_barrier
  ds_read_b64_tr_b16 a[212:213], v232 offset:40960
  ds_read_b64_tr_b16 a[214:215], v232 offset:43008
  ds_read_b64_tr_b16 a[216:217], v232 offset:49152
  ds_read_b64_tr_b16 a[218:219], v232 offset:51200
  ds_read_b64_tr_b16 a[220:221], v233 offset:40960
  ds_read_b64_tr_b16 a[222:223], v233 offset:43008
  ds_read_b64_tr_b16 a[224:225], v233 offset:49152
L_wk1_0:
  s_cbranch_vccnz L_wk1_4
  ds_read_b64_tr_b16 a[226:227], v233 offset:51200
  ds_read_b64_tr_b16 a[228:229], v234 offset:0
  ds_read_b64_tr_b16 a[230:231], v234 offset:2048
  ds_read_b64_tr_b16 a[232:233], v234 offset:28672
  ds_read_b64_tr_b16 a[234:235], v234 offset:30720
  ds_read_b64_tr_b16 a[192:193], v234 offset:40960
  ds_read_b64_tr_b16 a[194:195], v234 offset:43008
  s_waitcnt vmcnt(0)
  v_add_u32 v248, 0, v245
  buffer_store_dword v248, v246, s[4:7], s92 offen sc1
  s_mov_b32 s33, 262144
L_spin_22:
  buffer_load_dword v244, v80, s[4:7], s93 offen sc1
  s_waitcnt vmcnt(0)
  v_subrev_u32 v244, s100, v244
  v_cmp_lt_u32 s[68:69], 7, v244
  s_nop 1
  s_cmp_eq_u64 s[68:69], 0
  s_cbranch_scc1 L_ok_23
  s_sub_u32 s33, s33, 1
  s_cmp_lg_u32 s33, 0
  s_cbranch_scc1 L_spin_22
L_ok_23:
  s_mov_b32 s40, 9437184
  buffer_load_dwordx4 a[128:131], v225, s[4:7], s40 offen offset:0 sc1
  buffer_load_dwordx4 a[132:135], v225, s[4:7], s40 offen offset:1024 sc1
  buffer_load_dwordx4 a[136:139], v225, s[4:7], s40 offen offset:2048 sc1
  buffer_load_dwordx4 a[140:143], v225, s[4:7], s40 offen offset:3072 sc1
  s_mov_b32 s40, 9568256
  buffer_load_dwordx4 a[144:147], v225, s[4:7], s40 offen offset:0 sc1
  buffer_load_dwordx4 a[148:151], v225, s[4:7], s40 offen offset:1024 sc1
  buffer_load_dwordx4 a[152:155], v225, s[4:7], s40 offen offset:2048 sc1
  buffer_load_dwordx4 a[156:159], v225, s[4:7], s40 offen offset:3072 sc1
  s_mov_b32 s40, 9699328
  buffer_load_dword v244, v254, s[4:7], s93 offen sc1
  s_waitcnt vmcnt(5) lgkmcnt(13)
  v_mfma_f32_16x16x32_bf16 v[0:3], a[196:199], a[128:131], 0
  s_waitcnt vmcnt(1)
  v_mfma_f32_16x16x32_bf16 v[0:3], a[200:203], a[144:147], v[0:3]
  buffer_load_dwordx4 a[160:163], v225, s[4:7], s40 offen offset:0 sc1
  v_mfma_f32_16x16x32_bf16 v[16:19], a[196:199], a[132:135], 0
  v_mfma_f32_16x16x32_bf16 v[16:19], a[200:203], a[148:151], v[16:19]
  s_load_dwordx2 s[66:67], s[36:37], 0x0
  v_mfma_f32_16x16x32_bf16 v[32:35], a[196:199], a[136:139], 0
  v_mfma_f32_16x16x32_bf16 v[32:35], a[200:203], a[152:155], v[32:35]
  v_mfma_f32_16x16x32_bf16 v[48:51], a[196:199], a[140:143], 0
  buffer_load_dwordx4 a[164:167], v225, s[4:7], s40 offen offset:1024 sc1
  v_mfma_f32_16x16x32_bf16 v[48:51], a[200:203], a[156:159], v[48:51]
  ds_read_b64_tr_b16 a[196:197], v234 offset:49152
  v_mfma_f32_16x16x32_bf16 v[4:7], a[204:207], a[128:131], 0
  ds_read_b64_tr_b16 a[198:199], v234 offset:51200
  v_mfma_f32_16x16x32_bf16 v[4:7], a[208:211], a[144:147], v[4:7]
  ds_read_b64_tr_b16 a[200:201], v236 offset:12288
  ds_read_b64_tr_b16 a[202:203], v236 offset:14336
  v_mfma_f32_16x16x32_bf16 v[20:23], a[204:207], a[132:135], 0
  v_mfma_f32_16x16x32_bf16 v[20:23], a[208:211], a[148:151], v[20:23]
  v_mfma_f32_16x16x32_bf16 v[36:39], a[204:207], a[136:139], 0
  buffer_load_dwordx4 a[168:171], v225, s[4:7], s40 offen offset:2048 sc1
  v_mfma_f32_16x16x32_bf16 v[36:39], a[208:211], a[152:155], v[36:39]
  v_mfma_f32_16x16x32_bf16 v[52:55], a[204:207], a[140:143], 0
  ds_read_b64_tr_b16 a[204:205], v232 offset:4096
  v_mfma_f32_16x16x32_bf16 v[52:55], a[208:211], a[156:159], v[52:55]
  ds_read_b64_tr_b16 a[206:207], v232 offset:6144
  s_waitcnt lgkmcnt(13)
  v_mfma_f32_16x16x32_bf16 v[8:11], a[212:215], a[128:131], 0
  ds_read_b64_tr_b16 a[208:209], v237 offset:12288
  v_mfma_f32_16x16x32_bf16 v[8:11], a[216:219], a[144:147], v[8:11]
  s_barrier
  v_mfma_f32_16x16x32_bf16 v[24:27], a[212:215], a[132:135], 0
  buffer_load_dwordx4 a[172:175], v225, s[4:7], s40 offen offset:3072 sc1
  v_mfma_f32_16x16x32_bf16 v[24:27], a[216:219], a[148:151], v[24:27]
  ds_read_b64_tr_b16 a[210:211], v237 offset:14336
  s_mov_b32 s40, 9830400
  v_mfma_f32_16x16x32_bf16 v[40:43], a[212:215], a[136:139], 0
  v_mfma_f32_16x16x32_bf16 v[40:43], a[216:219], a[152:155], v[40:43]
  v_mfma_f32_16x16x32_bf16 v[56:59], a[212:215], a[140:143], 0
  ds_read_b64_tr_b16 a[212:213], v233 offset:4096
  v_mfma_f32_16x16x32_bf16 v[56:59], a[216:219], a[156:159], v[56:59]
  ds_read_b64_tr_b16 a[214:215], v233 offset:6144
  v_mfma_f32_16x16x32_bf16 v[12:15], a[220:223], a[128:131], 0
  buffer_load_dwordx4 a[176:179], v225, s[4:7], s40 offen offset:0 sc1
  s_waitcnt lgkmcnt(13)
  v_mfma_f32_16x16x32_bf16 v[12:15], a[224:227], a[144:147], v[12:15]
  ds_read_b64_tr_b16 a[216:217], v238 offset:12288
  ds_read_b64_tr_b16 a[218:219], v238 offset:14336
  s_load_dwordx2 s[66:67], s[36:37], 0x20000
  v_mfma_f32_16x16x32_bf16 v[28:31], a[220:223], a[132:135], 0
  v_mfma_f32_16x16x32_bf16 v[28:31], a[224:227], a[148:151], v[28:31]
  v_mfma_f32_16x16x32_bf16 v[44:47], a[220:223], a[136:139], 0
  v_mfma_f32_16x16x32_bf16 v[44:47], a[224:227], a[152:155], v[44:47]
  v_mfma_f32_16x16x32_bf16 v[60:63], a[220:223], a[140:143], 0
  buffer_load_dwordx4 a[180:183], v225, s[4:7], s40 offen offset:1024 sc1
  v_mfma_f32_16x16x32_bf16 v[60:63], a[224:227], a[156:159], v[60:63]
  ds_read_b64_tr_b16 a[220:221], v234 offset:4096
  v_mfma_f32_16x16x32_bf16 v[64:67], a[228:231], a[128:131], 0
  ds_read_b64_tr_b16 a[222:223], v234 offset:6144
  s_waitcnt lgkmcnt(13)
  v_mfma_f32_16x16x32_bf16 v[64:67], a[232:235], a[144:147], v[64:67]
  ds_read_b64_tr_b16 a[224:225], v239 offset:12288
  ds_read_b64_tr_b16 a[226:227], v239 offset:14336
  v_mfma_f32_16x16x32_bf16 v[72:75], a[228:231], a[132:135], 0
  v_mfma_f32_16x16x32_bf16 v[72:75], a[232:235], a[148:151], v[72:75]
  v_mfma_f32_16x16x32_bf16 v[80:83], a[228:231], a[136:139], 0
  buffer_load_dwordx4 a[184:187], v225, s[4:7], s40 offen offset:2048 sc1
  v_mfma_f32_16x16x32_bf16 v[80:83], a[232:235], a[152:155], v[80:83]
  v_mfma_f32_16x16x32_bf16 v[88:91], a[228:231], a[140:143], 0
  ds_read_b64_tr_b16 a[228:229], v235 offset:4096
  v_mfma_f32_16x16x32_bf16 v[88:91], a[232:235], a[156:159], v[88:91]
  ds_read_b64_tr_b16 a[230:231], v235 offset:6144
  s_waitcnt vmcnt(7)
  v_subrev_u32 v244, s100, v244
  v_cmp_lt_u32 s[68:69], 7, v244
  v_mfma_f32_16x16x32_bf16 v[68:71], a[192:195], a[128:131], 0
  ds_read_b64_tr_b16 a[232:233], v232 offset:16384
  s_cmp_lg_u64 s[68:69], 0
  s_cbranch_scc1 L_slow_24
L_back_25:
  s_waitcnt lgkmcnt(13)
  v_mfma_f32_16x16x32_bf16 v[68:71], a[196:199], a[144:147], v[68:71]
  ds_read_b64_tr_b16 a[234:235], v232 offset:18432
  v_mfma_f32_16x16x32_bf16 v[76:79], a[192:195], a[132:135], 0
  buffer_load_dwordx4 a[188:191], v225, s[4:7], s40 offen offset:3072 sc1
  v_mfma_f32_16x16x32_bf16 v[76:79], a[196:199], a[148:151], v[76:79]
  s_mov_b32 s41, 917504
  s_add_u32 m0, s42, 151552
  v_mfma_f32_16x16x32_bf16 v[84:87], a[192:195], a[136:139], 0
  v_mfma_f32_16x16x32_bf16 v[84:87], a[196:199], a[152:155], v[84:87]
  v_mfma_f32_16x16x32_bf16 v[92:95], a[192:195], a[140:143], 0
  ds_read_b64_tr_b16 a[192:193], v228 offset:61440
  v_mfma_f32_16x16x32_bf16 v[92:95], a[196:199], a[156:159], v[92:95]
  ds_read_b64_tr_b16 a[194:195], v228 offset:63488
  s_load_dwordx2 s[66:67], s[36:37], 0x40000
  v_mfma_f32_16x16x32_bf16 v[96:99], a[200:203], a[128:131], 0
  buffer_load_dwordx4 v226, s[12:15], s41 offen offset:0 lds
  v_mfma_f32_16x16x32_bf16 v[96:99], a[204:207], a[144:147], v[96:99]
  ds_read_b64_tr_b16 a[196:197], v233 offset:16384
  ds_read_b64_tr_b16 a[198:199], v233 offset:18432
  v_mfma_f32_16x16x32_bf16 v[128:131], a[200:203], a[132:135], 0
  s_mov_b32 s41, 1146880
  s_add_u32 m0, s42, 147456
  v_mfma_f32_16x16x32_bf16 v[128:131], a[204:207], a[148:151], v[128:131]
  v_mfma_f32_16x16x32_bf16 v[160:163], a[200:203], a[136:139], 0
  v_mfma_f32_16x16x32_bf16 v[160:163], a[204:207], a[152:155], v[160:163]
  v_mfma_f32_16x16x32_bf16 v[192:195], a[200:203], a[140:143], 0
  buffer_load_dwordx4 v226, s[12:15], s41 offen offset:0 lds
  v_mfma_f32_16x16x32_bf16 v[192:195], a[204:207], a[156:159], v[192:195]
  ds_read_b64_tr_b16 a[200:201], v229 offset:61440
  s_mov_b32 s40, 9961472
  s_waitcnt lgkmcnt(13)
  v_mfma_f32_16x16x32_bf16 v[100:103], a[208:211], a[128:131], 0
  ds_read_b64_tr_b16 a[202:203], v229 offset:63488
  v_mfma_f32_16x16x32_bf16 v[100:103], a[212:215], a[144:147], v[100:103]
  ds_read_b64_tr_b16 a[204:205], v234 offset:16384
  ds_read_b64_tr_b16 a[206:207], v234 offset:18432
  v_mfma_f32_16x16x32_bf16 v[132:135], a[208:211], a[132:135], 0
  v_mfma_f32_16x16x32_bf16 v[132:135], a[212:215], a[148:151], v[132:135]
  s_mov_b32 s78, 1572864
  v_mfma_f32_16x16x32_bf16 v[164:167], a[208:211], a[136:139], 0
  buffer_load_dwordx4 a[0:3], v225, s[4:7], s40 offen offset:0 sc1
  v_mfma_f32_16x16x32_bf16 v[164:167], a[212:215], a[152:155], v[164:167]
  buffer_load_dword v241, v247, s[56:59], s78 offen
  v_mfma_f32_16x16x32_bf16 v[196:199], a[208:211], a[140:143], 0
  ds_read_b64_tr_b16 a[208:209], v230 offset:61440
  v_mfma_f32_16x16x32_bf16 v[196:199], a[212:215], a[156:159], v[196:199]
  ds_read_b64_tr_b16 a[210:211], v230 offset:63488
  v_mfma_f32_16x16x32_bf16 v[104:107], a[216:219], a[128:131], 0
  ds_read_b64_tr_b16 a[212:213], v235 offset:16384
  s_waitcnt lgkmcnt(13)
  v_mfma_f32_16x16x32_bf16 v[104:107], a[220:223], a[144:147], v[104:107]
  ds_read_b64_tr_b16 a[214:215], v235 offset:18432
  v_mfma_f32_16x16x32_bf16 v[136:139], a[216:219], a[132:135], 0
  buffer_load_dwordx4 a[4:7], v225, s[4:7], s40 offen offset:1024 sc1
  v_mfma_f32_16x16x32_bf16 v[136:139], a[220:223], a[148:151], v[136:139]
  v_mfma_f32_16x16x32_bf16 v[168:171], a[216:219], a[136:139], 0
  v_mfma_f32_16x16x32_bf16 v[168:171], a[220:223], a[152:155], v[168:171]
  s_load_dwordx2 s[66:67], s[36:37], 0x60000
  v_mfma_f32_16x16x32_bf16 v[200:203], a[216:219], a[140:143], 0
  ds_read_b64_tr_b16 a[216:217], v231 offset:61440
  v_mfma_f32_16x16x32_bf16 v[200:203], a[220:223], a[156:159], v[200:203]
  ds_read_b64_tr_b16 a[218:219], v231 offset:63488
  v_mfma_f32_16x16x32_bf16 v[108:111], a[224:227], a[128:131], 0
  buffer_load_dwordx4 a[8:11], v225, s[4:7], s40 offen offset:2048 sc1
  v_mfma_f32_16x16x32_bf16 v[108:111], a[228:231], a[144:147], v[108:111]
  s_barrier
  v_mfma_f32_16x16x32_bf16 v[140:143], a[224:227], a[132:135], 0
  ds_read_b64_tr_b16 a[220:221], v232 offset:24576
  ds_read_b64_tr_b16 a[222:223], v232 offset:26624
  v_mfma_f32_16x16x32_bf16 v[140:143], a[228:231], a[148:151], v[140:143]
  v_mfma_f32_16x16x32_bf16 v[172:175], a[224:227], a[136:139], 0
  v_mfma_f32_16x16x32_bf16 v[172:175], a[228:231], a[152:155], v[172:175]
  v_mfma_f32_16x16x32_bf16 v[204:207], a[224:227], a[140:143], 0
  buffer_load_dwordx4 a[12:15], v225, s[4:7], s40 offen offset:3072 sc1
  v_mfma_f32_16x16x32_bf16 v[204:207], a[228:231], a[156:159], v[204:207]
  ds_read_b64_tr_b16 a[224:225], v232 offset:53248
  s_mov_b32 s40, 10092544
  s_waitcnt lgkmcnt(13)
  v_mfma_f32_16x16x32_bf16 v[112:115], a[232:235], a[128:131], 0
  ds_read_b64_tr_b16 a[226:227], v232 offset:55296
  v_mfma_f32_16x16x32_bf16 v[112:115], a[192:195], a[144:147], v[112:115]
  ds_read_b64_tr_b16 a[228:229], v233 offset:24576
  ds_read_b64_tr_b16 a[230:231], v233 offset:26624
  v_mfma_f32_16x16x32_bf16 v[144:147], a[232:235], a[132:135], 0
  v_mfma_f32_16x16x32_bf16 v[144:147], a[192:195], a[148:151], v[144:147]
  v_mfma_f32_16x16x32_bf16 v[176:179], a[232:235], a[136:139], 0
  buffer_load_dwordx4 a[16:19], v225, s[4:7], s40 offen offset:0 sc1
  v_mfma_f32_16x16x32_bf16 v[176:179], a[192:195], a[152:155], v[176:179]
  v_mfma_f32_16x16x32_bf16 v[208:211], a[232:235], a[140:143], 0
  ds_read_b64_tr_b16 a[232:233], v233 offset:53248
  v_mfma_f32_16x16x32_bf16 v[208:211], a[192:195], a[156:159], v[208:211]
  ds_read_b64_tr_b16 a[234:235], v233 offset:55296
  v_mfma_f32_16x16x32_bf16 v[116:119], a[196:199], a[128:131], 0
  ds_read_b64_tr_b16 a[192:193], v236 offset:0
  s_waitcnt lgkmcnt(13)
  v_mfma_f32_16x16x32_bf16 v[116:119], a[200:203], a[144:147], v[116:119]
  ds_read_b64_tr_b16 a[194:195], v236 offset:2048
  v_mfma_f32_16x16x32_bf16 v[148:151], a[196:199], a[132:135], 0
  buffer_load_dwordx4 a[20:23], v225, s[4:7], s40 offen offset:1024 sc1
  v_mfma_f32_16x16x32_bf16 v[148:151], a[200:203], a[148:151], v[148:151]
  s_load_dwordx2 s[66:67], s[36:37], 0x80000
  v_mfma_f32_16x16x32_bf16 v[180:183], a[196:199], a[136:139], 0
  v_mfma_f32_16x16x32_bf16 v[180:183], a[200:203], a[152:155], v[180:183]
  v_mfma_f32_16x16x32_bf16 v[212:215], a[196:199], a[140:143], 0
  ds_read_b64_tr_b16 a[196:197], v232 offset:12288
  v_mfma_f32_16x16x32_bf16 v[212:215], a[200:203], a[156:159], v[212:215]
  ds_read_b64_tr_b16 a[198:199], v232 offset:14336
  v_mfma_f32_16x16x32_bf16 v[120:123], a[204:207], a[128:131], 0
  buffer_load_dwordx4 a[24:27], v225, s[4:7], s40 offen offset:2048 sc1
  v_mfma_f32_16x16x32_bf16 v[120:123], a[208:211], a[144:147], v[120:123]
  ds_read_b64_tr_b16 a[200:201], v237 offset:0
  ds_read_b64_tr_b16 a[202:203], v237 offset:2048
  v_mfma_f32_16x16x32_bf16 v[152:155], a[204:207], a[132:135], 0
  v_mfma_f32_16x16x32_bf16 v[152:155], a[208:211], a[148:151], v[152:155]
  v_mfma_f32_16x16x32_bf16 v[184:187], a[204:207], a[136:139], 0
  v_mfma_f32_16x16x32_bf16 v[184:187], a[208:211], a[152:155], v[184:187]
  v_mfma_f32_16x16x32_bf16 v[216:219], a[204:207], a[140:143], 0
  buffer_load_dwordx4 a[28:31], v225, s[4:7], s40 offen offset:3072 sc1
  v_mfma_f32_16x16x32_bf16 v[216:219], a[208:211], a[156:159], v[216:219]
  ds_read_b64_tr_b16 a[204:205], v233 offset:12288
  s_mov_b32 s41, 917504
  s_waitcnt lgkmcnt(13)
  v_mfma_f32_16x16x32_bf16 v[124:127], a[212:215], a[128:131], 0
  ds_read_b64_tr_b16 a[206:207], v233 offset:14336
  s_add_u32 m0, s42, 159744
  v_mfma_f32_16x16x32_bf16 v[124:127], a[216:219], a[144:147], v[124:127]
  ds_read_b64_tr_b16 a[208:209], v234 offset:24576
  ds_read_b64_tr_b16 a[210:211], v234 offset:26624
  v_mfma_f32_16x16x32_bf16 v[156:159], a[212:215], a[132:135], 0
  v_mfma_f32_16x16x32_bf16 v[156:159], a[216:219], a[148:151], v[156:159]
  v_mfma_f32_16x16x32_bf16 v[188:191], a[212:215], a[136:139], 0
  buffer_load_dwordx4 v226, s[16:19], s41 offen offset:0 lds
  v_mfma_f32_16x16x32_bf16 v[188:191], a[216:219], a[152:155], v[188:191]
  s_mov_b32 s41, 1146880
  s_add_u32 m0, s42, 16384
  v_mfma_f32_16x16x32_bf16 v[220:223], a[212:215], a[140:143], 0
  ds_read_b64_tr_b16 a[212:213], v234 offset:53248
  v_mfma_f32_16x16x32_bf16 v[220:223], a[216:219], a[156:159], v[220:223]
  ds_read_b64_tr_b16 a[214:215], v234 offset:55296
  s_waitcnt vmcnt(16)
  v_mfma_f32_16x16x32_bf16 v[0:3], a[220:223], a[160:163], v[0:3]
  ds_read_b64_tr_b16 a[216:217], v238 offset:0
  s_waitcnt vmcnt(12) lgkmcnt(13)
  v_mfma_f32_16x16x32_bf16 v[0:3], a[224:227], a[176:179], v[0:3]
  ds_read_b64_tr_b16 a[218:219], v238 offset:2048
  s_load_dwordx2 s[66:67], s[36:37], 0xa0000
  v_mfma_f32_16x16x32_bf16 v[16:19], a[220:223], a[164:167], v[16:19]
  buffer_load_dwordx4 v226, s[16:19], s41 offen offset:0 lds
  v_mfma_f32_16x16x32_bf16 v[16:19], a[224:227], a[180:183], v[16:19]
  s_mov_b32 s41, 1376256
  s_add_u32 m0, s42, 28672
  v_mfma_f32_16x16x32_bf16 v[32:35], a[220:223], a[168:171], v[32:35]
  v_mfma_f32_16x16x32_bf16 v[32:35], a[224:227], a[184:187], v[32:35]
  v_mfma_f32_16x16x32_bf16 v[48:51], a[220:223], a[172:175], v[48:51]
  ds_read_b64_tr_b16 a[220:221], v234 offset:12288
  v_mfma_f32_16x16x32_bf16 v[48:51], a[224:227], a[188:191], v[48:51]
  ds_read_b64_tr_b16 a[222:223], v234 offset:14336
  v_mfma_f32_16x16x32_bf16 v[4:7], a[228:231], a[160:163], v[4:7]
  buffer_load_dwordx4 v227, s[12:15], s41 offen offset:0 lds
  v_mfma_f32_16x16x32_bf16 v[4:7], a[232:235], a[176:179], v[4:7]
  ds_read_b64_tr_b16 a[224:225], v232 offset:8192
  ds_read_b64_tr_b16 a[226:227], v232 offset:10240
  v_mfma_f32_16x16x32_bf16 v[20:23], a[228:231], a[164:167], v[20:23]
  s_mov_b32 s41, 1605632
  s_add_u32 m0, s42, 139264
  v_mfma_f32_16x16x32_bf16 v[20:23], a[232:235], a[180:183], v[20:23]
  v_mfma_f32_16x16x32_bf16 v[36:39], a[228:231], a[168:171], v[36:39]
  v_mfma_f32_16x16x32_bf16 v[36:39], a[232:235], a[184:187], v[36:39]
  v_mfma_f32_16x16x32_bf16 v[52:55], a[228:231], a[172:175], v[52:55]
  buffer_load_dwordx4 v227, s[12:15], s41 offen offset:0 lds
  v_mfma_f32_16x16x32_bf16 v[52:55], a[232:235], a[188:191], v[52:55]
  ds_read_b64_tr_b16 a[228:229], v232 offset:20480
  s_mov_b32 s41, 1376256
  s_waitcnt lgkmcnt(13)
  v_mfma_f32_16x16x32_bf16 v[8:11], a[192:195], a[160:163], v[8:11]
  ds_read_b64_tr_b16 a[230:231], v232 offset:22528
  s_add_u32 m0, s42, 155648
  v_mfma_f32_16x16x32_bf16 v[8:11], a[196:199], a[176:179], v[8:11]
  s_barrier
  v_mfma_f32_16x16x32_bf16 v[24:27], a[192:195], a[164:167], v[24:27]
  ds_read_b64_tr_b16 a[232:233], v233 offset:8192
  ds_read_b64_tr_b16 a[234:235], v233 offset:10240
  v_mfma_f32_16x16x32_bf16 v[24:27], a[196:199], a[180:183], v[24:27]
  v_mfma_f32_16x16x32_bf16 v[40:43], a[192:195], a[168:171], v[40:43]
  buffer_load_dwordx4 v227, s[16:19], s41 offen offset:0 lds
  v_mfma_f32_16x16x32_bf16 v[40:43], a[196:199], a[184:187], v[40:43]
  s_mov_b32 s41, 1605632
  s_add_u32 m0, s42, 20480
  v_mfma_f32_16x16x32_bf16 v[56:59], a[192:195], a[172:175], v[56:59]
  ds_read_b64_tr_b16 a[192:193], v233 offset:20480
  v_mfma_f32_16x16x32_bf16 v[56:59], a[196:199], a[188:191], v[56:59]
  ds_read_b64_tr_b16 a[194:195], v233 offset:22528
  s_load_dwordx2 s[66:67], s[36:37], 0xc0000
  v_mfma_f32_16x16x32_bf16 v[12:15], a[200:203], a[160:163], v[12:15]
  ds_read_b64_tr_b16 a[196:197], v234 offset:8192
  s_waitcnt lgkmcnt(13)
  v_mfma_f32_16x16x32_bf16 v[12:15], a[204:207], a[176:179], v[12:15]
  ds_read_b64_tr_b16 a[198:199], v234 offset:10240
  v_mfma_f32_16x16x32_bf16 v[28:31], a[200:203], a[164:167], v[28:31]
  buffer_load_dwordx4 v227, s[16:19], s41 offen offset:0 lds
  v_mfma_f32_16x16x32_bf16 v[28:31], a[204:207], a[180:183], v[28:31]
  s_mov_b32 s41, 1376256
  s_add_u32 m0, s42, 12288
  v_mfma_f32_16x16x32_bf16 v[44:47], a[200:203], a[168:171], v[44:47]
  v_mfma_f32_16x16x32_bf16 v[44:47], a[204:207], a[184:187], v[44:47]
  v_mfma_f32_16x16x32_bf16 v[60:63], a[200:203], a[172:175], v[60:63]
  ds_read_b64_tr_b16 a[200:201], v234 offset:20480
  v_mfma_f32_16x16x32_bf16 v[60:63], a[204:207], a[188:191], v[60:63]
  ds_read_b64_tr_b16 a[202:203], v234 offset:22528
  s_mov_b32 s78, 2097152
  v_mfma_f32_16x16x32_bf16 v[64:67], a[208:211], a[160:163], v[64:67]
  buffer_load_dwordx4 v226, s[12:15], s41 offen offset:0 lds
  v_mfma_f32_16x16x32_bf16 v[64:67], a[212:215], a[176:179], v[64:67]
  ds_read_b64_tr_b16 a[204:205], v235 offset:8192
  ds_read_b64_tr_b16 a[206:207], v235 offset:10240
  v_mfma_f32_16x16x32_bf16 v[72:75], a[208:211], a[164:167], v[72:75]
  s_mov_b32 s41, 1605632
  s_add_u32 m0, s42, 24576
  v_mfma_f32_16x16x32_bf16 v[72:75], a[212:215], a[180:183], v[72:75]
  buffer_load_dword v241, v247, s[56:59], s78 offen
  v_mfma_f32_16x16x32_bf16 v[80:83], a[208:211], a[168:171], v[80:83]
  v_mfma_f32_16x16x32_bf16 v[80:83], a[212:215], a[184:187], v[80:83]
  v_mfma_f32_16x16x32_bf16 v[88:91], a[208:211], a[172:175], v[88:91]
  buffer_load_dwordx4 v226, s[12:15], s41 offen offset:0 lds
  v_mfma_f32_16x16x32_bf16 v[88:91], a[212:215], a[188:191], v[88:91]
  ds_read_b64_tr_b16 a[208:209], v235 offset:20480
  s_mov_b32 s40, 10223616
  s_waitcnt lgkmcnt(13)
  v_mfma_f32_16x16x32_bf16 v[68:71], a[216:219], a[160:163], v[68:71]
  ds_read_b64_tr_b16 a[210:211], v235 offset:22528
  v_mfma_f32_16x16x32_bf16 v[68:71], a[220:223], a[176:179], v[68:71]
  ds_read_b64_tr_b16 a[212:213], v232 offset:36864
  ds_read_b64_tr_b16 a[214:215], v232 offset:38912
  v_mfma_f32_16x16x32_bf16 v[76:79], a[216:219], a[164:167], v[76:79]
  v_mfma_f32_16x16x32_bf16 v[76:79], a[220:223], a[180:183], v[76:79]
  v_mfma_f32_16x16x32_bf16 v[84:87], a[216:219], a[168:171], v[84:87]
  buffer_load_dwordx4 a[32:35], v225, s[4:7], s40 offen offset:0 sc1
  v_mfma_f32_16x16x32_bf16 v[84:87], a[220:223], a[184:187], v[84:87]
  s_load_dwordx2 s[66:67], s[36:37], 0xe0000
  s_add_u32 s36, s36, 0x100000
  s_addc_u32 s37, s37, 0
  v_mfma_f32_16x16x32_bf16 v[92:95], a[216:219], a[172:175], v[92:95]
  ds_read_b64_tr_b16 a[216:217], v232 offset:32768
  v_mfma_f32_16x16x32_bf16 v[92:95], a[220:223], a[188:191], v[92:95]
  ds_read_b64_tr_b16 a[218:219], v232 offset:34816
  v_mfma_f32_16x16x32_bf16 v[96:99], a[224:227], a[160:163], v[96:99]
  ds_read_b64_tr_b16 a[220:221], v233 offset:36864
  s_waitcnt lgkmcnt(13)
  v_mfma_f32_16x16x32_bf16 v[96:99], a[228:231], a[176:179], v[96:99]
  ds_read_b64_tr_b16 a[222:223], v233 offset:38912
  v_mfma_f32_16x16x32_bf16 v[128:131], a[224:227], a[164:167], v[128:131]
  buffer_load_dwordx4 a[36:39], v225, s[4:7], s40 offen offset:1024 sc1
  v_mfma_f32_16x16x32_bf16 v[128:131], a[228:231], a[180:183], v[128:131]
  v_mfma_f32_16x16x32_bf16 v[160:163], a[224:227], a[168:171], v[160:163]
  v_mfma_f32_16x16x32_bf16 v[160:163], a[228:231], a[184:187], v[160:163]
  v_mfma_f32_16x16x32_bf16 v[192:195], a[224:227], a[172:175], v[192:195]
  ds_read_b64_tr_b16 a[224:225], v233 offset:32768
  v_mfma_f32_16x16x32_bf16 v[192:195], a[228:231], a[188:191], v[192:195]
  ds_read_b64_tr_b16 a[226:227], v233 offset:34816
  v_mfma_f32_16x16x32_bf16 v[100:103], a[232:235], a[160:163], v[100:103]
  buffer_load_dwordx4 a[40:43], v225, s[4:7], s40 offen offset:2048 sc1
  v_mfma_f32_16x16x32_bf16 v[100:103], a[192:195], a[176:179], v[100:103]
  ds_read_b64_tr_b16 a[228:229], v234 offset:36864
  ds_read_b64_tr_b16 a[230:231], v234 offset:38912
  v_mfma_f32_16x16x32_bf16 v[132:135], a[232:235], a[164:167], v[132:135]
  v_mfma_f32_16x16x32_bf16 v[132:135], a[192:195], a[180:183], v[132:135]
  v_mfma_f32_16x16x32_bf16 v[164:167], a[232:235], a[168:171], v[164:167]
  v_mfma_f32_16x16x32_bf16 v[164:167], a[192:195], a[184:187], v[164:167]
  v_mfma_f32_16x16x32_bf16 v[196:199], a[232:235], a[172:175], v[196:199]
  buffer_load_dwordx4 a[44:47], v225, s[4:7], s40 offen offset:3072 sc1
  v_mfma_f32_16x16x32_bf16 v[196:199], a[192:195], a[188:191], v[196:199]
  ds_read_b64_tr_b16 a[232:233], v234 offset:32768
  s_mov_b32 s40, 10354688
  s_waitcnt lgkmcnt(13)
  v_mfma_f32_16x16x32_bf16 v[104:107], a[196:199], a[160:163], v[104:107]
  ds_read_b64_tr_b16 a[234:235], v234 offset:34816
  v_mfma_f32_16x16x32_bf16 v[104:107], a[200:203], a[176:179], v[104:107]
  ds_read_b64_tr_b16 a[192:193], v235 offset:36864
  ds_read_b64_tr_b16 a[194:195], v235 offset:38912
  v_mfma_f32_16x16x32_bf16 v[136:139], a[196:199], a[164:167], v[136:139]
  v_mfma_f32_16x16x32_bf16 v[136:139], a[200:203], a[180:183], v[136:139]
  s_load_dwordx2 s[66:67], s[36:37], 0x0
  v_mfma_f32_16x16x32_bf16 v[168:171], a[196:199], a[168:171], v[168:171]
  buffer_load_dwordx4 a[48:51], v225, s[4:7], s40 offen offset:0 sc1
  v_mfma_f32_16x16x32_bf16 v[168:171], a[200:203], a[184:187], v[168:171]
  v_mfma_f32_16x16x32_bf16 v[200:203], a[196:199], a[172:175], v[200:203]
  ds_read_b64_tr_b16 a[196:197], v235 offset:32768
  v_mfma_f32_16x16x32_bf16 v[200:203], a[200:203], a[188:191], v[200:203]
  ds_read_b64_tr_b16 a[198:199], v235 offset:34816
  v_mfma_f32_16x16x32_bf16 v[108:111], a[204:207], a[160:163], v[108:111]
  ds_read_b64_tr_b16 a[200:201], v232 offset:45056
  s_waitcnt lgkmcnt(13)
  v_mfma_f32_16x16x32_bf16 v[108:111], a[208:211], a[176:179], v[108:111]
  s_waitcnt vmcnt(23)
  s_barrier
  v_mfma_f32_16x16x32_bf16 v[140:143], a[204:207], a[164:167], v[140:143]
  buffer_load_dwordx4 a[52:55], v225, s[4:7], s40 offen offset:1024 sc1
  v_mfma_f32_16x16x32_bf16 v[140:143], a[208:211], a[180:183], v[140:143]
  ds_read_b64_tr_b16 a[202:203], v232 offset:47104
  v_mfma_f32_16x16x32_bf16 v[172:175], a[204:207], a[168:171], v[172:175]
  v_mfma_f32_16x16x32_bf16 v[172:175], a[208:211], a[184:187], v[172:175]
  v_mfma_f32_16x16x32_bf16 v[204:207], a[204:207], a[172:175], v[204:207]
  ds_read_b64_tr_b16 a[204:205], v232 offset:61440
  v_mfma_f32_16x16x32_bf16 v[204:207], a[208:211], a[188:191], v[204:207]
  ds_read_b64_tr_b16 a[206:207], v232 offset:63488
  v_mfma_f32_16x16x32_bf16 v[112:115], a[212:215], a[160:163], v[112:115]
  buffer_load_dwordx4 a[56:59], v225, s[4:7], s40 offen offset:2048 sc1
  v_mfma_f32_16x16x32_bf16 v[112:115], a[216:219], a[176:179], v[112:115]
  ds_read_b64_tr_b16 a[208:209], v233 offset:45056
  ds_read_b64_tr_b16 a[210:211], v233 offset:47104
  v_mfma_f32_16x16x32_bf16 v[144:147], a[212:215], a[164:167], v[144:147]
  v_mfma_f32_16x16x32_bf16 v[144:147], a[216:219], a[180:183], v[144:147]
  v_mfma_f32_16x16x32_bf16 v[176:179], a[212:215], a[168:171], v[176:179]
  v_mfma_f32_16x16x32_bf16 v[176:179], a[216:219], a[184:187], v[176:179]
  v_mfma_f32_16x16x32_bf16 v[208:211], a[212:215], a[172:175], v[208:211]
  buffer_load_dwordx4 a[60:63], v225, s[4:7], s40 offen offset:3072 sc1
  v_mfma_f32_16x16x32_bf16 v[208:211], a[216:219], a[188:191], v[208:211]
  ds_read_b64_tr_b16 a[212:213], v233 offset:61440
  s_mov_b32 s41, 1376256
  s_waitcnt lgkmcnt(13)
  v_mfma_f32_16x16x32_bf16 v[116:119], a[220:223], a[160:163], v[116:119]
  ds_read_b64_tr_b16 a[214:215], v233 offset:63488
  s_add_u32 m0, s42, 45056
  v_mfma_f32_16x16x32_bf16 v[116:119], a[224:227], a[176:179], v[116:119]
  ds_read_b64_tr_b16 a[216:217], v232 offset:57344
  ds_read_b64_tr_b16 a[218:219], v232 offset:59392
  s_load_dwordx2 s[66:67], s[36:37], 0x20000
  v_mfma_f32_16x16x32_bf16 v[148:151], a[220:223], a[164:167], v[148:151]
  v_mfma_f32_16x16x32_bf16 v[148:151], a[224:227], a[180:183], v[148:151]
  v_mfma_f32_16x16x32_bf16 v[180:183], a[220:223], a[168:171], v[180:183]
  buffer_load_dwordx4 v226, s[16:19], s41 offen offset:0 lds
  v_mfma_f32_16x16x32_bf16 v[180:183], a[224:227], a[184:187], v[180:183]
  s_mov_b32 s41, 1605632
  s_add_u32 m0, s42, 36864
  v_mfma_f32_16x16x32_bf16 v[212:215], a[220:223], a[172:175], v[212:215]
  ds_read_b64_tr_b16 a[220:221], v236 offset:4096
  v_mfma_f32_16x16x32_bf16 v[212:215], a[224:227], a[188:191], v[212:215]
  ds_read_b64_tr_b16 a[222:223], v236 offset:6144
  v_mfma_f32_16x16x32_bf16 v[120:123], a[228:231], a[160:163], v[120:123]
  ds_read_b64_tr_b16 a[224:225], v233 offset:57344
  s_waitcnt lgkmcnt(13)
  v_mfma_f32_16x16x32_bf16 v[120:123], a[232:235], a[176:179], v[120:123]
  ds_read_b64_tr_b16 a[226:227], v233 offset:59392
  v_mfma_f32_16x16x32_bf16 v[152:155], a[228:231], a[164:167], v[152:155]
  buffer_load_dwordx4 v226, s[16:19], s41 offen offset:0 lds
  v_mfma_f32_16x16x32_bf16 v[152:155], a[232:235], a[180:183], v[152:155]
  s_mov_b32 s41, 1835008
  s_add_u32 m0, s42, 49152
  v_mfma_f32_16x16x32_bf16 v[184:187], a[228:231], a[168:171], v[184:187]
  v_mfma_f32_16x16x32_bf16 v[184:187], a[232:235], a[184:187], v[184:187]
  v_mfma_f32_16x16x32_bf16 v[216:219], a[228:231], a[172:175], v[216:219]
  ds_read_b64_tr_b16 a[228:229], v237 offset:4096
  v_mfma_f32_16x16x32_bf16 v[216:219], a[232:235], a[188:191], v[216:219]
  ds_read_b64_tr_b16 a[230:231], v237 offset:6144
  v_mfma_f32_16x16x32_bf16 v[124:127], a[192:195], a[160:163], v[124:127]
  buffer_load_dwordx4 v227, s[12:15], s41 offen offset:0 lds
  v_mfma_f32_16x16x32_bf16 v[124:127], a[196:199], a[176:179], v[124:127]
  ds_read_b64_tr_b16 a[232:233], v234 offset:45056
  ds_read_b64_tr_b16 a[234:235], v234 offset:47104
  v_mfma_f32_16x16x32_bf16 v[156:159], a[192:195], a[164:167], v[156:159]
  s_mov_b32 s41, 2064384
  s_add_u32 m0, s42, 32768
  v_mfma_f32_16x16x32_bf16 v[156:159], a[196:199], a[180:183], v[156:159]
  v_mfma_f32_16x16x32_bf16 v[188:191], a[192:195], a[168:171], v[188:191]
  v_mfma_f32_16x16x32_bf16 v[188:191], a[196:199], a[184:187], v[188:191]
  v_mfma_f32_16x16x32_bf16 v[220:223], a[192:195], a[172:175], v[220:223]
  buffer_load_dwordx4 v227, s[12:15], s41 offen offset:0 lds
  v_mfma_f32_16x16x32_bf16 v[220:223], a[196:199], a[188:191], v[220:223]
  ds_read_b64_tr_b16 a[192:193], v234 offset:61440
  s_mov_b32 s41, 1835008
  s_load_dwordx2 s[66:67], s[36:37], 0x40000
  s_waitcnt vmcnt(25) lgkmcnt(13)
  v_mfma_f32_16x16x32_bf16 v[0:3], a[200:203], a[0:3], v[0:3]
  ds_read_b64_tr_b16 a[194:195], v234 offset:63488
  s_add_u32 m0, s42, 40960
  s_waitcnt vmcnt(21)
  v_mfma_f32_16x16x32_bf16 v[0:3], a[204:207], a[16:19], v[0:3]
  ds_read_b64_tr_b16 a[196:197], v234 offset:57344
  ds_read_b64_tr_b16 a[198:199], v234 offset:59392
  v_mfma_f32_16x16x32_bf16 v[16:19], a[200:203], a[4:7], v[16:19]
  v_mfma_f32_16x16x32_bf16 v[16:19], a[204:207], a[20:23], v[16:19]
  s_mov_b32 s78, 2621440
  v_mfma_f32_16x16x32_bf16 v[32:35], a[200:203], a[8:11], v[32:35]
  buffer_load_dwordx4 v227, s[16:19], s41 offen offset:0 lds
  v_mfma_f32_16x16x32_bf16 v[32:35], a[204:207], a[24:27], v[32:35]
  s_mov_b32 s41, 2064384
  s_add_u32 m0, s42, 53248
  v_mfma_f32_16x16x32_bf16 v[48:51], a[200:203], a[12:15], v[48:51]
  ds_read_b64_tr_b16 a[200:201], v238 offset:4096
  v_mfma_f32_16x16x32_bf16 v[48:51], a[204:207], a[28:31], v[48:51]
  ds_read_b64_tr_b16 a[202:203], v238 offset:6144
  v_mfma_f32_16x16x32_bf16 v[4:7], a[208:211], a[0:3], v[4:7]
  ds_read_b64_tr_b16 a[204:205], v236 offset:20480
  s_waitcnt lgkmcnt(13)
  v_mfma_f32_16x16x32_bf16 v[4:7], a[212:215], a[16:19], v[4:7]
  ds_read_b64_tr_b16 a[206:207], v236 offset:22528
  v_mfma_f32_16x16x32_bf16 v[20:23], a[208:211], a[4:7], v[20:23]
  buffer_load_dwordx4 v227, s[16:19], s41 offen offset:0 lds
  v_mfma_f32_16x16x32_bf16 v[20:23], a[212:215], a[20:23], v[20:23]
  s_mov_b32 s41, 1835008
  s_add_u32 m0, s42, 57344
  v_mfma_f32_16x16x32_bf16 v[36:39], a[208:211], a[8:11], v[36:39]
  buffer_load_dword v241, v247, s[56:59], s78 offen
  v_mfma_f32_16x16x32_bf16 v[36:39], a[212:215], a[24:27], v[36:39]
  v_mfma_f32_16x16x32_bf16 v[52:55], a[208:211], a[12:15], v[52:55]
  ds_read_b64_tr_b16 a[208:209], v236 offset:16384
  v_mfma_f32_16x16x32_bf16 v[52:55], a[212:215], a[28:31], v[52:55]
  ds_read_b64_tr_b16 a[210:211], v236 offset:18432
  v_mfma_f32_16x16x32_bf16 v[8:11], a[216:219], a[0:3], v[8:11]
  buffer_load_dwordx4 v226, s[12:15], s41 offen offset:0 lds
  v_mfma_f32_16x16x32_bf16 v[8:11], a[220:223], a[16:19], v[8:11]
  s_waitcnt vmcnt(22)
  s_barrier
  v_mfma_f32_16x16x32_bf16 v[24:27], a[216:219], a[4:7], v[24:27]
  ds_read_b64_tr_b16 a[212:213], v237 offset:20480
  ds_read_b64_tr_b16 a[214:215], v237 offset:22528
  v_mfma_f32_16x16x32_bf16 v[24:27], a[220:223], a[20:23], v[24:27]
  s_mov_b32 s41, 2064384
  s_add_u32 m0, s42, 65536
L_wk1_1:
  s_cbranch_vccnz L_wk1_5
  v_mfma_f32_16x16x32_bf16 v[40:43], a[216:219], a[8:11], v[40:43]
  v_mfma_f32_16x16x32_bf16 v[40:43], a[220:223], a[24:27], v[40:43]
  s_load_dwordx2 s[66:67], s[36:37], 0x60000
  v_mfma_f32_16x16x32_bf16 v[56:59], a[216:219], a[12:15], v[56:59]
  buffer_load_dwordx4 v226, s[12:15], s41 offen offset:0 lds
  v_mfma_f32_16x16x32_bf16 v[56:59], a[220:223], a[28:31], v[56:59]
  ds_read_b64_tr_b16 a[216:217], v237 offset:16384
  s_mov_b32 s40, 10485760
  s_waitcnt lgkmcnt(13)
  v_mfma_f32_16x16x32_bf16 v[12:15], a[224:227], a[0:3], v[12:15]
  ds_read_b64_tr_b16 a[218:219], v237 offset:18432
  v_mfma_f32_16x16x32_bf16 v[12:15], a[228:231], a[16:19], v[12:15]
  ds_read_b64_tr_b16 a[220:221], v238 offset:20480
  ds_read_b64_tr_b16 a[222:223], v238 offset:22528
  v_mfma_f32_16x16x32_bf16 v[28:31], a[224:227], a[4:7], v[28:31]
  v_mfma_f32_16x16x32_bf16 v[28:31], a[228:231], a[20:23], v[28:31]
  v_mfma_f32_16x16x32_bf16 v[44:47], a[224:227], a[8:11], v[44:47]
  buffer_load_dwordx4 a[64:67], v225, s[4:7], s40 offen offset:0 sc1
  v_mfma_f32_16x16x32_bf16 v[44:47], a[228:231], a[24:27], v[44:47]
  v_mfma_f32_16x16x32_bf16 v[60:63], a[224:227], a[12:15], v[60:63]
  ds_read_b64_tr_b16 a[224:225], v238 offset:16384
  v_mfma_f32_16x16x32_bf16 v[60:63], a[228:231], a[28:31], v[60:63]
  ds_read_b64_tr_b16 a[226:227], v238 offset:18432
  v_mfma_f32_16x16x32_bf16 v[64:67], a[232:235], a[0:3], v[64:67]
  ds_read_b64_tr_b16 a[228:229], v239 offset:20480
  s_waitcnt lgkmcnt(13)
  v_mfma_f32_16x16x32_bf16 v[64:67], a[192:195], a[16:19], v[64:67]
  ds_read_b64_tr_b16 a[230:231], v239 offset:22528
  v_mfma_f32_16x16x32_bf16 v[72:75], a[232:235], a[4:7], v[72:75]
  buffer_load_dwordx4 a[68:71], v225, s[4:7], s40 offen offset:1024 sc1
  v_mfma_f32_16x16x32_bf16 v[72:75], a[192:195], a[20:23], v[72:75]
  v_mfma_f32_16x16x32_bf16 v[80:83], a[232:235], a[8:11], v[80:83]
  v_mfma_f32_16x16x32_bf16 v[80:83], a[192:195], a[24:27], v[80:83]
  v_mfma_f32_16x16x32_bf16 v[88:91], a[232:235], a[12:15], v[88:91]
  ds_read_b64_tr_b16 a[232:233], v239 offset:16384
  v_mfma_f32_16x16x32_bf16 v[88:91], a[192:195], a[28:31], v[88:91]
  ds_read_b64_tr_b16 a[234:235], v239 offset:18432
  v_mfma_f32_16x16x32_bf16 v[68:71], a[196:199], a[0:3], v[68:71]
  buffer_load_dwordx4 a[72:75], v225, s[4:7], s40 offen offset:2048 sc1
  v_mfma_f32_16x16x32_bf16 v[68:71], a[200:203], a[16:19], v[68:71]
  ds_read_b64_tr_b16 a[192:193], v236 offset:28672
  ds_read_b64_tr_b16 a[194:195], v236 offset:30720
  v_mfma_f32_16x16x32_bf16 v[76:79], a[196:199], a[4:7], v[76:79]
  v_mfma_f32_16x16x32_bf16 v[76:79], a[200:203], a[20:23], v[76:79]
  s_load_dwordx2 s[66:67], s[36:37], 0x80000
  v_mfma_f32_16x16x32_bf16 v[84:87], a[196:199], a[8:11], v[84:87]
  v_mfma_f32_16x16x32_bf16 v[84:87], a[200:203], a[24:27], v[84:87]
  v_mfma_f32_16x16x32_bf16 v[92:95], a[196:199], a[12:15], v[92:95]
  buffer_load_dwordx4 a[76:79], v225, s[4:7], s40 offen offset:3072 sc1
  v_mfma_f32_16x16x32_bf16 v[92:95], a[200:203], a[28:31], v[92:95]
  ds_read_b64_tr_b16 a[196:197], v228 offset:16384
  s_mov_b32 s40, 10616832
  s_waitcnt lgkmcnt(13)
  v_mfma_f32_16x16x32_bf16 v[96:99], a[204:207], a[0:3], v[96:99]
  ds_read_b64_tr_b16 a[198:199], v228 offset:18432
  v_mfma_f32_16x16x32_bf16 v[96:99], a[208:211], a[16:19], v[96:99]
  ds_read_b64_tr_b16 a[200:201], v237 offset:28672
  ds_read_b64_tr_b16 a[202:203], v237 offset:30720
  v_mfma_f32_16x16x32_bf16 v[128:131], a[204:207], a[4:7], v[128:131]
  v_mfma_f32_16x16x32_bf16 v[128:131], a[208:211], a[20:23], v[128:131]
  v_mfma_f32_16x16x32_bf16 v[160:163], a[204:207], a[8:11], v[160:163]
  buffer_load_dwordx4 a[80:83], v225, s[4:7], s40 offen offset:0 sc1
  v_mfma_f32_16x16x32_bf16 v[160:163], a[208:211], a[24:27], v[160:163]
  v_mfma_f32_16x16x32_bf16 v[192:195], a[204:207], a[12:15], v[192:195]
  ds_read_b64_tr_b16 a[204:205], v229 offset:16384
  v_mfma_f32_16x16x32_bf16 v[192:195], a[208:211], a[28:31], v[192:195]
  ds_read_b64_tr_b16 a[206:207], v229 offset:18432
  v_mfma_f32_16x16x32_bf16 v[100:103], a[212:215], a[0:3], v[100:103]
  ds_read_b64_tr_b16 a[208:209], v238 offset:28672
  s_waitcnt lgkmcnt(13)
  v_mfma_f32_16x16x32_bf16 v[100:103], a[216:219], a[16:19], v[100:103]
  ds_read_b64_tr_b16 a[210:211], v238 offset:30720
  v_mfma_f32_16x16x32_bf16 v[132:135], a[212:215], a[4:7], v[132:135]
  buffer_load_dwordx4 a[84:87], v225, s[4:7], s40 offen offset:1024 sc1
  v_mfma_f32_16x16x32_bf16 v[132:135], a[216:219], a[20:23], v[132:135]
  v_mfma_f32_16x16x32_bf16 v[164:167], a[212:215], a[8:11], v[164:167]
  v_mfma_f32_16x16x32_bf16 v[164:167], a[216:219], a[24:27], v[164:167]
  v_mfma_f32_16x16x32_bf16 v[196:199], a[212:215], a[12:15], v[196:199]
  ds_read_b64_tr_b16 a[212:213], v230 offset:16384
  v_mfma_f32_16x16x32_bf16 v[196:199], a[216:219], a[28:31], v[196:199]
  ds_read_b64_tr_b16 a[214:215], v230 offset:18432
  v_mfma_f32_16x16x32_bf16 v[104:107], a[220:223], a[0:3], v[104:107]
  buffer_load_dwordx4 a[88:91], v225, s[4:7], s40 offen offset:2048 sc1
  v_mfma_f32_16x16x32_bf16 v[104:107], a[224:227], a[16:19], v[104:107]
  ds_read_b64_tr_b16 a[216:217], v239 offset:28672
  ds_read_b64_tr_b16 a[218:219], v239 offset:30720
  s_load_dwordx2 s[66:67], s[36:37], 0xa0000
  v_mfma_f32_16x16x32_bf16 v[136:139], a[220:223], a[4:7], v[136:139]
  v_mfma_f32_16x16x32_bf16 v[136:139], a[224:227], a[20:23], v[136:139]
  v_mfma_f32_16x16x32_bf16 v[168:171], a[220:223], a[8:11], v[168:171]
  v_mfma_f32_16x16x32_bf16 v[168:171], a[224:227], a[24:27], v[168:171]
  v_mfma_f32_16x16x32_bf16 v[200:203], a[220:223], a[12:15], v[200:203]
  buffer_load_dwordx4 a[92:95], v225, s[4:7], s40 offen offset:3072 sc1
  v_mfma_f32_16x16x32_bf16 v[200:203], a[224:227], a[28:31], v[200:203]
  ds_read_b64_tr_b16 a[220:221], v231 offset:16384
  s_mov_b32 s41, 1835008
  s_waitcnt lgkmcnt(13)
  v_mfma_f32_16x16x32_bf16 v[108:111], a[228:231], a[0:3], v[108:111]
  ds_read_b64_tr_b16 a[222:223], v231 offset:18432
  s_add_u32 m0, s42, 94208
  v_mfma_f32_16x16x32_bf16 v[108:111], a[232:235], a[16:19], v[108:111]
  s_waitcnt vmcnt(25)
  s_barrier
  v_mfma_f32_16x16x32_bf16 v[140:143], a[228:231], a[4:7], v[140:143]
  ds_read_b64_tr_b16 a[224:225], v228 offset:28672
  ds_read_b64_tr_b16 a[226:227], v228 offset:30720
  v_mfma_f32_16x16x32_bf16 v[140:143], a[232:235], a[20:23], v[140:143]
  v_lshrrev_b32 v254, 4, v224
  v_lshl_add_u32 v254, v254, 12, v243
  s_lshl_b32 s32, s3, 14
  s_add_u32 s32, s32, 0x90000
  v_mfma_f32_16x16x32_bf16 v[172:175], a[228:231], a[8:11], v[172:175]
  buffer_load_dwordx4 v226, s[16:19], s41 offen offset:0 lds
  s_cmp_eq_u32 s2, 0
  s_cselect_b32 s32, s32, s79
  s_cselect_b32 s31, -1, 0
  v_mfma_f32_16x16x32_bf16 v[172:175], a[232:235], a[24:27], v[172:175]
  s_mov_b32 s41, 2064384
  s_add_u32 m0, s42, 106496
  v_and_b32 v254, s31, v254
  v_mfma_f32_16x16x32_bf16 v[204:207], a[228:231], a[12:15], v[204:207]
  ds_read_b64_tr_b16 a[228:229], v236 offset:8192
  v_mfma_f32_16x16x32_bf16 v[204:207], a[232:235], a[28:31], v[204:207]
  ds_read_b64_tr_b16 a[230:231], v236 offset:10240
  v_mfma_f32_16x16x32_bf16 v[112:115], a[192:195], a[0:3], v[112:115]
  ds_read_b64_tr_b16 a[232:233], v229 offset:28672
  s_waitcnt lgkmcnt(13)
  v_mfma_f32_16x16x32_bf16 v[112:115], a[196:199], a[16:19], v[112:115]
  ds_read_b64_tr_b16 a[234:235], v229 offset:30720
  v_mfma_f32_16x16x32_bf16 v[144:147], a[192:195], a[4:7], v[144:147]
  buffer_load_dwordx4 v226, s[16:19], s41 offen offset:0 lds
  v_mfma_f32_16x16x32_bf16 v[144:147], a[196:199], a[20:23], v[144:147]
  s_mov_b32 s41, 2293760
  s_add_u32 m0, s42, 114688
  v_mfma_f32_16x16x32_bf16 v[176:179], a[192:195], a[8:11], v[176:179]
  v_mfma_f32_16x16x32_bf16 v[176:179], a[196:199], a[24:27], v[176:179]
  v_mfma_f32_16x16x32_bf16 v[208:211], a[192:195], a[12:15], v[208:211]
  ds_read_b64_tr_b16 a[192:193], v237 offset:8192
  v_mfma_f32_16x16x32_bf16 v[208:211], a[196:199], a[28:31], v[208:211]
  ds_read_b64_tr_b16 a[194:195], v237 offset:10240
  s_load_dwordx2 s[66:67], s[36:37], 0xc0000
  v_mfma_f32_16x16x32_bf16 v[116:119], a[200:203], a[0:3], v[116:119]
  buffer_load_dwordx4 v227, s[12:15], s41 offen offset:0 lds
  v_mfma_f32_16x16x32_bf16 v[116:119], a[204:207], a[16:19], v[116:119]
  ds_read_b64_tr_b16 a[196:197], v236 offset:24576
  ds_read_b64_tr_b16 a[198:199], v236 offset:26624
  v_mfma_f32_16x16x32_bf16 v[148:151], a[200:203], a[4:7], v[148:151]
  s_mov_b32 s41, 2523136
  s_add_u32 m0, s42, 143360
  v_mfma_f32_16x16x32_bf16 v[148:151], a[204:207], a[20:23], v[148:151]
  s_mov_b32 s78, 3145728
  v_mfma_f32_16x16x32_bf16 v[180:183], a[200:203], a[8:11], v[180:183]
  buffer_load_dword v241, v247, s[56:59], s78 offen
  v_mfma_f32_16x16x32_bf16 v[180:183], a[204:207], a[24:27], v[180:183]
  v_mfma_f32_16x16x32_bf16 v[212:215], a[200:203], a[12:15], v[212:215]
  buffer_load_dwordx4 v227, s[12:15], s41 offen offset:0 lds
  v_mfma_f32_16x16x32_bf16 v[212:215], a[204:207], a[28:31], v[212:215]
  ds_read_b64_tr_b16 a[200:201], v228 offset:20480
  s_mov_b32 s41, 2293760
  s_waitcnt lgkmcnt(13)
  v_mfma_f32_16x16x32_bf16 v[120:123], a[208:211], a[0:3], v[120:123]
  ds_read_b64_tr_b16 a[202:203], v228 offset:22528
  s_add_u32 m0, s42, 69632
  v_mfma_f32_16x16x32_bf16 v[120:123], a[212:215], a[16:19], v[120:123]
  ds_read_b64_tr_b16 a[204:205], v237 offset:24576
  ds_read_b64_tr_b16 a[206:207], v237 offset:26624
  v_mfma_f32_16x16x32_bf16 v[152:155], a[208:211], a[4:7], v[152:155]
  v_mfma_f32_16x16x32_bf16 v[152:155], a[212:215], a[20:23], v[152:155]
  v_mfma_f32_16x16x32_bf16 v[184:187], a[208:211], a[8:11], v[184:187]
  buffer_load_dwordx4 v227, s[16:19], s41 offen offset:0 lds
  v_mfma_f32_16x16x32_bf16 v[184:187], a[212:215], a[24:27], v[184:187]
  s_mov_b32 s41, 2523136
  s_add_u32 m0, s42, 81920
  v_mfma_f32_16x16x32_bf16 v[216:219], a[208:211], a[12:15], v[216:219]
  ds_read_b64_tr_b16 a[208:209], v229 offset:20480
  v_mfma_f32_16x16x32_bf16 v[216:219], a[212:215], a[28:31], v[216:219]
  ds_read_b64_tr_b16 a[210:211], v229 offset:22528
  v_mfma_f32_16x16x32_bf16 v[124:127], a[216:219], a[0:3], v[124:127]
  ds_read_b64_tr_b16 a[212:213], v230 offset:28672
  s_waitcnt lgkmcnt(13)
  v_mfma_f32_16x16x32_bf16 v[124:127], a[220:223], a[16:19], v[124:127]
  ds_read_b64_tr_b16 a[214:215], v230 offset:30720
  v_mfma_f32_16x16x32_bf16 v[156:159], a[216:219], a[4:7], v[156:159]
  buffer_load_dwordx4 v227, s[16:19], s41 offen offset:0 lds
  v_mfma_f32_16x16x32_bf16 v[156:159], a[220:223], a[20:23], v[156:159]
  v_mfma_f32_16x16x32_bf16 v[188:191], a[216:219], a[8:11], v[188:191]
  v_mfma_f32_16x16x32_bf16 v[188:191], a[220:223], a[24:27], v[188:191]
  s_load_dwordx2 s[66:67], s[36:37], 0xe0000
  s_add_u32 s36, s36, 0x100000
  s_addc_u32 s37, s37, 0
  v_mfma_f32_16x16x32_bf16 v[220:223], a[216:219], a[12:15], v[220:223]
  ds_read_b64_tr_b16 a[216:217], v238 offset:8192
  v_mfma_f32_16x16x32_bf16 v[220:223], a[220:223], a[28:31], v[220:223]
  ds_read_b64_tr_b16 a[218:219], v238 offset:10240
  s_mov_b32 s40, 10747904
  s_waitcnt vmcnt(28)
  v_mfma_f32_16x16x32_bf16 v[0:3], a[224:227], a[32:35], v[0:3]
  buffer_load_dwordx4 a[96:99], v225, s[4:7], s40 offen offset:0 sc1
  s_waitcnt vmcnt(25)
  v_mfma_f32_16x16x32_bf16 v[0:3], a[228:231], a[48:51], v[0:3]
  ds_read_b64_tr_b16 a[220:221], v238 offset:24576
  ds_read_b64_tr_b16 a[222:223], v238 offset:26624
  v_mfma_f32_16x16x32_bf16 v[16:19], a[224:227], a[36:39], v[16:19]
  v_mfma_f32_16x16x32_bf16 v[16:19], a[228:231], a[52:55], v[16:19]
  buffer_load_dword v244, v254, s[4:7], s32 offen sc1
  v_mfma_f32_16x16x32_bf16 v[32:35], a[224:227], a[40:43], v[32:35]
  v_mfma_f32_16x16x32_bf16 v[32:35], a[228:231], a[56:59], v[32:35]
  v_mfma_f32_16x16x32_bf16 v[48:51], a[224:227], a[44:47], v[48:51]
  buffer_load_dwordx4 a[100:103], v225, s[4:7], s40 offen offset:1024 sc1
  v_mfma_f32_16x16x32_bf16 v[48:51], a[228:231], a[60:63], v[48:51]
  ds_read_b64_tr_b16 a[224:225], v230 offset:20480
  s_waitcnt lgkmcnt(13)
  v_mfma_f32_16x16x32_bf16 v[4:7], a[232:235], a[32:35], v[4:7]
  ds_read_b64_tr_b16 a[226:227], v230 offset:22528
  v_mfma_f32_16x16x32_bf16 v[4:7], a[192:195], a[48:51], v[4:7]
  ds_read_b64_tr_b16 a[228:229], v228 offset:12288
  ds_read_b64_tr_b16 a[230:231], v228 offset:14336
  v_mfma_f32_16x16x32_bf16 v[20:23], a[232:235], a[36:39], v[20:23]
  v_mfma_f32_16x16x32_bf16 v[20:23], a[192:195], a[52:55], v[20:23]
  v_mfma_f32_16x16x32_bf16 v[36:39], a[232:235], a[40:43], v[36:39]
  buffer_load_dwordx4 a[104:107], v225, s[4:7], s40 offen offset:2048 sc1
  v_mfma_f32_16x16x32_bf16 v[36:39], a[192:195], a[56:59], v[36:39]
  v_mfma_f32_16x16x32_bf16 v[52:55], a[232:235], a[44:47], v[52:55]
  ds_read_b64_tr_b16 a[232:233], v228 offset:24576
  v_mfma_f32_16x16x32_bf16 v[52:55], a[192:195], a[60:63], v[52:55]
  ds_read_b64_tr_b16 a[234:235], v228 offset:26624
  v_mfma_f32_16x16x32_bf16 v[8:11], a[196:199], a[32:35], v[8:11]
  ds_read_b64_tr_b16 a[192:193], v229 offset:12288
  s_waitcnt lgkmcnt(13)
  v_mfma_f32_16x16x32_bf16 v[8:11], a[200:203], a[48:51], v[8:11]
  s_waitcnt vmcnt(25)
  s_barrier
  v_mfma_f32_16x16x32_bf16 v[24:27], a[196:199], a[36:39], v[24:27]
  buffer_load_dwordx4 a[108:111], v225, s[4:7], s40 offen offset:3072 sc1
  v_mfma_f32_16x16x32_bf16 v[24:27], a[200:203], a[52:55], v[24:27]
  ds_read_b64_tr_b16 a[194:195], v229 offset:14336
  s_mov_b32 s41, 2293760
  s_load_dwordx2 s[66:67], s[36:37], 0x0
  v_mfma_f32_16x16x32_bf16 v[40:43], a[196:199], a[40:43], v[40:43]
  s_add_u32 m0, s42, 61440
  v_mfma_f32_16x16x32_bf16 v[40:43], a[200:203], a[56:59], v[40:43]
  v_mfma_f32_16x16x32_bf16 v[56:59], a[196:199], a[44:47], v[56:59]
  ds_read_b64_tr_b16 a[196:197], v229 offset:24576
  v_mfma_f32_16x16x32_bf16 v[56:59], a[200:203], a[60:63], v[56:59]
  ds_read_b64_tr_b16 a[198:199], v229 offset:26624
  v_mfma_f32_16x16x32_bf16 v[12:15], a[204:207], a[32:35], v[12:15]
  buffer_load_dwordx4 v226, s[12:15], s41 offen offset:0 lds
  v_mfma_f32_16x16x32_bf16 v[12:15], a[208:211], a[48:51], v[12:15]
  ds_read_b64_tr_b16 a[200:201], v230 offset:12288
  ds_read_b64_tr_b16 a[202:203], v230 offset:14336
  v_mfma_f32_16x16x32_bf16 v[28:31], a[204:207], a[36:39], v[28:31]
  s_mov_b32 s41, 2523136
  s_add_u32 m0, s42, 90112
  v_mfma_f32_16x16x32_bf16 v[28:31], a[208:211], a[52:55], v[28:31]
  v_mfma_f32_16x16x32_bf16 v[44:47], a[204:207], a[40:43], v[44:47]
  v_mfma_f32_16x16x32_bf16 v[44:47], a[208:211], a[56:59], v[44:47]
  v_mfma_f32_16x16x32_bf16 v[60:63], a[204:207], a[44:47], v[60:63]
  buffer_load_dwordx4 v226, s[12:15], s41 offen offset:0 lds
  v_mfma_f32_16x16x32_bf16 v[60:63], a[208:211], a[60:63], v[60:63]
  ds_read_b64_tr_b16 a[204:205], v230 offset:24576
  s_mov_b32 s40, 10878976
  s_waitcnt lgkmcnt(13)
  v_mfma_f32_16x16x32_bf16 v[64:67], a[212:215], a[32:35], v[64:67]
  ds_read_b64_tr_b16 a[206:207], v230 offset:26624
  v_mfma_f32_16x16x32_bf16 v[64:67], a[216:219], a[48:51], v[64:67]
  ds_read_b64_tr_b16 a[208:209], v231 offset:12288
  ds_read_b64_tr_b16 a[210:211], v231 offset:14336
  v_mfma_f32_16x16x32_bf16 v[72:75], a[212:215], a[36:39], v[72:75]
  v_mfma_f32_16x16x32_bf16 v[72:75], a[216:219], a[52:55], v[72:75]
  v_mfma_f32_16x16x32_bf16 v[80:83], a[212:215], a[40:43], v[80:83]
  buffer_load_dwordx4 a[112:115], v225, s[4:7], s40 offen offset:0 sc1
  v_mfma_f32_16x16x32_bf16 v[80:83], a[216:219], a[56:59], v[80:83]
  v_mfma_f32_16x16x32_bf16 v[88:91], a[212:215], a[44:47], v[88:91]
  ds_read_b64_tr_b16 a[212:213], v231 offset:24576
  v_mfma_f32_16x16x32_bf16 v[88:91], a[216:219], a[60:63], v[88:91]
  ds_read_b64_tr_b16 a[214:215], v231 offset:26624
  v_mfma_f32_16x16x32_bf16 v[68:71], a[220:223], a[32:35], v[68:71]
  ds_read_b64_tr_b16 a[216:217], v228 offset:45056
  s_waitcnt lgkmcnt(13)
  v_mfma_f32_16x16x32_bf16 v[68:71], a[224:227], a[48:51], v[68:71]
  ds_read_b64_tr_b16 a[218:219], v228 offset:47104
  s_load_dwordx2 s[66:67], s[36:37], 0x20000
  v_mfma_f32_16x16x32_bf16 v[76:79], a[220:223], a[36:39], v[76:79]
  buffer_load_dwordx4 a[116:119], v225, s[4:7], s40 offen offset:1024 sc1
  v_mfma_f32_16x16x32_bf16 v[76:79], a[224:227], a[52:55], v[76:79]
  s_waitcnt vmcnt(7)
  v_subrev_u32 v244, s100, v244
  v_cmp_lt_u32 s[68:69], 7, v244
  v_mfma_f32_16x16x32_bf16 v[84:87], a[220:223], a[40:43], v[84:87]
  v_mfma_f32_16x16x32_bf16 v[84:87], a[224:227], a[56:59], v[84:87]
  s_cmp_lg_u64 s[68:69], 0
  s_cbranch_scc1 L_slow_26
L_back_27:
  s_or_b32 s32, s2, s3
  s_cselect_b32 s32, 0x40000000, 0
  s_add_u32 s32, s32, 0xd2d00
  v_mfma_f32_16x16x32_bf16 v[92:95], a[220:223], a[44:47], v[92:95]
  ds_read_b64_tr_b16 a[220:221], v228 offset:36864
  v_mfma_f32_16x16x32_bf16 v[92:95], a[224:227], a[60:63], v[92:95]
  ds_read_b64_tr_b16 a[222:223], v228 offset:38912
  v_mfma_f32_16x16x32_bf16 v[96:99], a[228:231], a[32:35], v[96:99]
  buffer_load_dwordx4 a[120:123], v225, s[4:7], s40 offen offset:2048 sc1
  v_mfma_f32_16x16x32_bf16 v[96:99], a[232:235], a[48:51], v[96:99]
  ds_read_b64_tr_b16 a[224:225], v229 offset:45056
  ds_read_b64_tr_b16 a[226:227], v229 offset:47104
  v_mfma_f32_16x16x32_bf16 v[128:131], a[228:231], a[36:39], v[128:131]
  v_mfma_f32_16x16x32_bf16 v[128:131], a[232:235], a[52:55], v[128:131]
  v_mfma_f32_16x16x32_bf16 v[160:163], a[228:231], a[40:43], v[160:163]
  v_mfma_f32_16x16x32_bf16 v[160:163], a[232:235], a[56:59], v[160:163]
  v_mfma_f32_16x16x32_bf16 v[192:195], a[228:231], a[44:47], v[192:195]
  buffer_load_dwordx4 a[124:127], v225, s[4:7], s40 offen offset:3072 sc1
  v_mfma_f32_16x16x32_bf16 v[192:195], a[232:235], a[60:63], v[192:195]
  ds_read_b64_tr_b16 a[228:229], v229 offset:36864
  s_mov_b32 s41, 2293760
  s_waitcnt lgkmcnt(13)
  v_mfma_f32_16x16x32_bf16 v[100:103], a[192:195], a[32:35], v[100:103]
  ds_read_b64_tr_b16 a[230:231], v229 offset:38912
  s_add_u32 m0, s42, 118784
  v_mfma_f32_16x16x32_bf16 v[100:103], a[196:199], a[48:51], v[100:103]
  ds_read_b64_tr_b16 a[232:233], v230 offset:45056
  ds_read_b64_tr_b16 a[234:235], v230 offset:47104
  v_mfma_f32_16x16x32_bf16 v[132:135], a[192:195], a[36:39], v[132:135]
  v_mfma_f32_16x16x32_bf16 v[132:135], a[196:199], a[52:55], v[132:135]
  s_mov_b32 s78, 3670016
  v_mfma_f32_16x16x32_bf16 v[164:167], a[192:195], a[40:43], v[164:167]
  buffer_load_dwordx4 v226, s[16:19], s41 offen offset:0 lds
  v_mfma_f32_16x16x32_bf16 v[164:167], a[196:199], a[56:59], v[164:167]
  s_mov_b32 s41, 2523136
  s_add_u32 m0, s42, 131072
  v_mfma_f32_16x16x32_bf16 v[196:199], a[192:195], a[44:47], v[196:199]
  ds_read_b64_tr_b16 a[192:193], v230 offset:36864
  v_mfma_f32_16x16x32_bf16 v[196:199], a[196:199], a[60:63], v[196:199]
  ds_read_b64_tr_b16 a[194:195], v230 offset:38912
  s_load_dwordx2 s[66:67], s[36:37], 0x40000
  v_mfma_f32_16x16x32_bf16 v[104:107], a[200:203], a[32:35], v[104:107]
  ds_read_b64_tr_b16 a[196:197], v231 offset:45056
  s_waitcnt lgkmcnt(13)
  v_mfma_f32_16x16x32_bf16 v[104:107], a[204:207], a[48:51], v[104:107]
  ds_read_b64_tr_b16 a[198:199], v231 offset:47104
  v_mfma_f32_16x16x32_bf16 v[136:139], a[200:203], a[36:39], v[136:139]
  buffer_load_dwordx4 v226, s[16:19], s41 offen offset:0 lds
  v_mfma_f32_16x16x32_bf16 v[136:139], a[204:207], a[52:55], v[136:139]
  buffer_load_dword v241, v247, s[56:59], s78 offen
  v_mfma_f32_16x16x32_bf16 v[168:171], a[200:203], a[40:43], v[168:171]
  v_mfma_f32_16x16x32_bf16 v[168:171], a[204:207], a[56:59], v[168:171]
  v_mfma_f32_16x16x32_bf16 v[200:203], a[200:203], a[44:47], v[200:203]
  ds_read_b64_tr_b16 a[200:201], v231 offset:36864
  v_mfma_f32_16x16x32_bf16 v[200:203], a[204:207], a[60:63], v[200:203]
  ds_read_b64_tr_b16 a[202:203], v231 offset:38912
  s_mov_b32 s41, 2752512
  v_mfma_f32_16x16x32_bf16 v[108:111], a[208:211], a[32:35], v[108:111]
  ds_read_b64_tr_b16 a[204:205], v228 offset:49152
  s_add_u32 m0, s42, 77824
  v_mfma_f32_16x16x32_bf16 v[108:111], a[212:215], a[48:51], v[108:111]
  s_barrier
  buffer_store_dword v245, v246, s[4:7], s32 offen sc1
  v_mfma_f32_16x16x32_bf16 v[140:143], a[208:211], a[36:39], v[140:143]
  ds_read_b64_tr_b16 a[206:207], v228 offset:51200
  v_add_u32 v243, s91, v243
  s_xor_b32 s32, s90, 0x8000
  v_mov_b32 v254, s32
  v_mfma_f32_16x16x32_bf16 v[140:143], a[212:215], a[52:55], v[140:143]
  buffer_load_dwordx4 v227, s[12:15], s41 offen offset:0 lds
  v_cndmask_b32_e64 v243, v254, v243, s[34:35]
  s_mov_b32 s91, 0
  v_mfma_f32_16x16x32_bf16 v[172:175], a[208:211], a[40:43], v[172:175]
  v_accvgpr_write_b32 a252, -1
  v_accvgpr_write_b32 a253, -1
  v_accvgpr_write_b32 a254, -1
  v_accvgpr_write_b32 a255, -1
  v_mfma_f32_16x16x32_bf16 v[172:175], a[212:215], a[56:59], v[172:175]
  v_mfma_f32_16x16x32_bf16 v[204:207], a[208:211], a[44:47], v[204:207]
  ds_read_b64_tr_b16 a[208:209], v228 offset:32768
  s_mov_b32 s41, 2981888
  v_mfma_f32_16x16x32_bf16 v[204:207], a[212:215], a[60:63], v[204:207]
  ds_read_b64_tr_b16 a[210:211], v228 offset:34816
  s_add_u32 m0, s42, 73728
  s_waitcnt lgkmcnt(13)
  v_mfma_f32_16x16x32_bf16 v[112:115], a[216:219], a[32:35], v[112:115]
  buffer_load_dwordx4 v227, s[12:15], s41 offen offset:0 lds
  v_mfma_f32_16x16x32_bf16 v[112:115], a[220:223], a[48:51], v[112:115]
  ds_read_b64_tr_b16 a[212:213], v229 offset:49152
  ds_read_b64_tr_b16 a[214:215], v229 offset:51200
  v_mfma_f32_16x16x32_bf16 v[144:147], a[216:219], a[36:39], v[144:147]
  v_mfma_f32_16x16x32_bf16 v[144:147], a[220:223], a[52:55], v[144:147]
  v_mfma_f32_16x16x32_bf16 v[176:179], a[216:219], a[40:43], v[176:179]
  v_mfma_f32_16x16x32_bf16 v[176:179], a[220:223], a[56:59], v[176:179]
  s_load_dwordx2 s[66:67], s[36:37], 0x60000
  v_mfma_f32_16x16x32_bf16 v[208:211], a[216:219], a[44:47], v[208:211]
  ds_read_b64_tr_b16 a[216:217], v229 offset:32768
  v_mfma_f32_16x16x32_bf16 v[208:211], a[220:223], a[60:63], v[208:211]
  ds_read_b64_tr_b16 a[218:219], v229 offset:34816
  s_mov_b32 s41, 2752512
  v_mfma_f32_16x16x32_bf16 v[116:119], a[224:227], a[32:35], v[116:119]
  ds_read_b64_tr_b16 a[220:221], v228 offset:40960
  s_add_u32 m0, s42, 86016
  s_waitcnt lgkmcnt(13)
  v_mfma_f32_16x16x32_bf16 v[116:119], a[228:231], a[48:51], v[116:119]
  buffer_load_dwordx4 v227, s[16:19], s41 offen offset:0 lds
  v_mfma_f32_16x16x32_bf16 v[148:151], a[224:227], a[36:39], v[148:151]
  ds_read_b64_tr_b16 a[222:223], v228 offset:43008
  v_mfma_f32_16x16x32_bf16 v[148:151], a[228:231], a[52:55], v[148:151]
  v_mfma_f32_16x16x32_bf16 v[180:183], a[224:227], a[40:43], v[180:183]
  v_mfma_f32_16x16x32_bf16 v[180:183], a[228:231], a[56:59], v[180:183]
  v_mfma_f32_16x16x32_bf16 v[212:215], a[224:227], a[44:47], v[212:215]
  ds_read_b64_tr_b16 a[224:225], v228 offset:53248
  s_mov_b32 s41, 2981888
  v_mfma_f32_16x16x32_bf16 v[212:215], a[228:231], a[60:63], v[212:215]
  ds_read_b64_tr_b16 a[226:227], v228 offset:55296
  s_add_u32 m0, s42, 102400
  v_mfma_f32_16x16x32_bf16 v[120:123], a[232:235], a[32:35], v[120:123]
  buffer_load_dwordx4 v227, s[16:19], s41 offen offset:0 lds
  v_mfma_f32_16x16x32_bf16 v[120:123], a[192:195], a[48:51], v[120:123]
  ds_read_b64_tr_b16 a[228:229], v229 offset:40960
  ds_read_b64_tr_b16 a[230:231], v229 offset:43008
  v_mfma_f32_16x16x32_bf16 v[152:155], a[232:235], a[36:39], v[152:155]
  v_mfma_f32_16x16x32_bf16 v[152:155], a[192:195], a[52:55], v[152:155]
  v_mfma_f32_16x16x32_bf16 v[184:187], a[232:235], a[40:43], v[184:187]
  v_mfma_f32_16x16x32_bf16 v[184:187], a[192:195], a[56:59], v[184:187]
  v_mfma_f32_16x16x32_bf16 v[216:219], a[232:235], a[44:47], v[216:219]
  ds_read_b64_tr_b16 a[232:233], v229 offset:53248
  v_mfma_f32_16x16x32_bf16 v[216:219], a[192:195], a[60:63], v[216:219]
  ds_read_b64_tr_b16 a[234:235], v229 offset:55296
  s_waitcnt lgkmcnt(13)
  v_mfma_f32_16x16x32_bf16 v[124:127], a[196:199], a[32:35], v[124:127]
  ds_read_b64_tr_b16 a[192:193], v230 offset:49152
  v_mfma_f32_16x16x32_bf16 v[124:127], a[200:203], a[48:51], v[124:127]
  ds_read_b64_tr_b16 a[194:195], v230 offset:51200
  v_mfma_f32_16x16x32_bf16 v[156:159], a[196:199], a[36:39], v[156:159]
  v_mfma_f32_16x16x32_bf16 v[156:159], a[200:203], a[52:55], v[156:159]
  s_load_dwordx2 s[66:67], s[36:37], 0x80000
  v_mfma_f32_16x16x32_bf16 v[188:191], a[196:199], a[40:43], v[188:191]
  v_mfma_f32_16x16x32_bf16 v[188:191], a[200:203], a[56:59], v[188:191]
  v_mfma_f32_16x16x32_bf16 v[220:223], a[196:199], a[44:47], v[220:223]
  ds_read_b64_tr_b16 a[196:197], v230 offset:32768
  v_mfma_f32_16x16x32_bf16 v[220:223], a[200:203], a[60:63], v[220:223]
  ds_read_b64_tr_b16 a[198:199], v230 offset:34816
  s_mov_b32 s40, 11010048
  v_mfma_f32_16x16x32_bf16 v[0:3], a[204:207], a[64:67], v[0:3]
  buffer_load_dwordx4 a[128:131], v225, s[4:7], s40 offen offset:0 sc1
  s_waitcnt lgkmcnt(13)
  v_mfma_f32_16x16x32_bf16 v[0:3], a[208:211], a[80:83], v[0:3]
  ds_read_b64_tr_b16 a[200:201], v230 offset:40960
  ds_read_b64_tr_b16 a[202:203], v230 offset:43008
  v_mfma_f32_16x16x32_bf16 v[16:19], a[204:207], a[68:71], v[16:19]
  v_mfma_f32_16x16x32_bf16 v[16:19], a[208:211], a[84:87], v[16:19]
  v_mfma_f32_16x16x32_bf16 v[32:35], a[204:207], a[72:75], v[32:35]
  v_mfma_f32_16x16x32_bf16 v[32:35], a[208:211], a[88:91], v[32:35]
  buffer_load_dwordx4 a[132:135], v225, s[4:7], s40 offen offset:1024 sc1
  v_mfma_f32_16x16x32_bf16 v[48:51], a[204:207], a[76:79], v[48:51]
  ds_read_b64_tr_b16 a[204:205], v230 offset:53248
  v_mfma_f32_16x16x32_bf16 v[48:51], a[208:211], a[92:95], v[48:51]
  ds_read_b64_tr_b16 a[206:207], v230 offset:55296
  v_mfma_f32_16x16x32_bf16 v[4:7], a[212:215], a[64:67], v[4:7]
  ds_read_b64_tr_b16 a[208:209], v228 offset:57344
  s_waitcnt lgkmcnt(13)
  v_mfma_f32_16x16x32_bf16 v[4:7], a[216:219], a[80:83], v[4:7]
  ds_read_b64_tr_b16 a[210:211], v228 offset:59392
  v_mfma_f32_16x16x32_bf16 v[20:23], a[212:215], a[68:71], v[20:23]
  v_mfma_f32_16x16x32_bf16 v[20:23], a[216:219], a[84:87], v[20:23]
  buffer_load_dwordx4 a[136:139], v225, s[4:7], s40 offen offset:2048 sc1
  v_mfma_f32_16x16x32_bf16 v[36:39], a[212:215], a[72:75], v[36:39]
  v_mfma_f32_16x16x32_bf16 v[36:39], a[216:219], a[88:91], v[36:39]
  v_mfma_f32_16x16x32_bf16 v[52:55], a[212:215], a[76:79], v[52:55]
  ds_read_b64_tr_b16 a[212:213], v232 offset:0
  v_mfma_f32_16x16x32_bf16 v[52:55], a[216:219], a[92:95], v[52:55]
  ds_read_b64_tr_b16 a[214:215], v232 offset:2048
  v_mfma_f32_16x16x32_bf16 v[8:11], a[220:223], a[64:67], v[8:11]
  ds_read_b64_tr_b16 a[216:217], v229 offset:57344
  v_mfma_f32_16x16x32_bf16 v[8:11], a[224:227], a[80:83], v[8:11]
  s_barrier
  s_load_dwordx2 s[66:67], s[36:37], 0xa0000
  v_mfma_f32_16x16x32_bf16 v[24:27], a[220:223], a[68:71], v[24:27]
  buffer_load_dwordx4 a[140:143], v225, s[4:7], s40 offen offset:3072 sc1
  v_mfma_f32_16x16x32_bf16 v[24:27], a[224:227], a[84:87], v[24:27]
  ds_read_b64_tr_b16 a[218:219], v229 offset:59392
  s_mov_b32 s41, 2752512
  v_mfma_f32_16x16x32_bf16 v[40:43], a[220:223], a[72:75], v[40:43]
  s_add_u32 m0, s42, 98304
  v_mfma_f32_16x16x32_bf16 v[40:43], a[224:227], a[88:91], v[40:43]
  v_mfma_f32_16x16x32_bf16 v[56:59], a[220:223], a[76:79], v[56:59]
  ds_read_b64_tr_b16 a[220:221], v233 offset:0
  v_mfma_f32_16x16x32_bf16 v[56:59], a[224:227], a[92:95], v[56:59]
  buffer_load_dwordx4 v226, s[12:15], s41 offen offset:0 lds
  s_waitcnt lgkmcnt(13)
  v_mfma_f32_16x16x32_bf16 v[12:15], a[228:231], a[64:67], v[12:15]
  ds_read_b64_tr_b16 a[222:223], v233 offset:2048
  s_mov_b32 s41, 2981888
  buffer_store_dwordx4 a[252:255], v251, s[4:7], s96 offen offset:0 sc1
  v_mfma_f32_16x16x32_bf16 v[12:15], a[232:235], a[80:83], v[12:15]
  ds_read_b64_tr_b16 a[224:225], v230 offset:57344
  ds_read_b64_tr_b16 a[226:227], v230 offset:59392
  v_mfma_f32_16x16x32_bf16 v[28:31], a[228:231], a[68:71], v[28:31]
  s_add_u32 m0, s42, 110592
  v_mfma_f32_16x16x32_bf16 v[28:31], a[232:235], a[84:87], v[28:31]
  v_mfma_f32_16x16x32_bf16 v[44:47], a[228:231], a[72:75], v[44:47]
  v_mfma_f32_16x16x32_bf16 v[44:47], a[232:235], a[88:91], v[44:47]
  buffer_load_dwordx4 v226, s[12:15], s41 offen offset:0 lds
  v_mfma_f32_16x16x32_bf16 v[60:63], a[228:231], a[76:79], v[60:63]
  ds_read_b64_tr_b16 a[228:229], v234 offset:0
  s_mov_b32 s40, 11141120
  v_mfma_f32_16x16x32_bf16 v[60:63], a[232:235], a[92:95], v[60:63]
  ds_read_b64_tr_b16 a[230:231], v234 offset:2048
  s_mov_b32 s78, 4194304
  v_mfma_f32_16x16x32_bf16 v[64:67], a[192:195], a[64:67], v[64:67]
  ds_read_b64_tr_b16 a[232:233], v231 offset:57344
  s_waitcnt lgkmcnt(13)
  v_mfma_f32_16x16x32_bf16 v[64:67], a[196:199], a[80:83], v[64:67]
  ds_read_b64_tr_b16 a[234:235], v231 offset:59392
  v_mfma_f32_16x16x32_bf16 v[72:75], a[192:195], a[68:71], v[72:75]
  buffer_load_dword v241, v247, s[56:59], s78 offen
  v_mfma_f32_16x16x32_bf16 v[72:75], a[196:199], a[84:87], v[72:75]
  v_mfma_f32_16x16x32_bf16 v[80:83], a[192:195], a[72:75], v[80:83]
  buffer_load_dwordx4 a[144:147], v225, s[4:7], s40 offen offset:0 sc1
  v_mfma_f32_16x16x32_bf16 v[80:83], a[196:199], a[88:91], v[80:83]
  v_mfma_f32_16x16x32_bf16 v[88:91], a[192:195], a[76:79], v[88:91]
  ds_read_b64_tr_b16 a[192:193], v235 offset:0
  v_mfma_f32_16x16x32_bf16 v[88:91], a[196:199], a[92:95], v[88:91]
  ds_read_b64_tr_b16 a[194:195], v235 offset:2048
  s_load_dwordx2 s[66:67], s[36:37], 0xc0000
  v_mfma_f32_16x16x32_bf16 v[68:71], a[200:203], a[64:67], v[68:71]
  ds_read_b64_tr_b16 a[196:197], v232 offset:28672
  v_mfma_f32_16x16x32_bf16 v[68:71], a[204:207], a[80:83], v[68:71]
  buffer_load_dwordx4 a[148:151], v225, s[4:7], s40 offen offset:1024 sc1
  v_mfma_f32_16x16x32_bf16 v[76:79], a[200:203], a[68:71], v[76:79]
  ds_read_b64_tr_b16 a[198:199], v232 offset:30720
  v_mfma_f32_16x16x32_bf16 v[76:79], a[204:207], a[84:87], v[76:79]
  v_mfma_f32_16x16x32_bf16 v[84:87], a[200:203], a[72:75], v[84:87]
  v_mfma_f32_16x16x32_bf16 v[84:87], a[204:207], a[88:91], v[84:87]
  v_mfma_f32_16x16x32_bf16 v[92:95], a[200:203], a[76:79], v[92:95]
  ds_read_b64_tr_b16 a[200:201], v232 offset:40960
  v_mfma_f32_16x16x32_bf16 v[92:95], a[204:207], a[92:95], v[92:95]
  buffer_load_dwordx4 a[152:155], v225, s[4:7], s40 offen offset:2048 sc1
  s_waitcnt lgkmcnt(13)
  v_mfma_f32_16x16x32_bf16 v[96:99], a[208:211], a[64:67], v[96:99]
  ds_read_b64_tr_b16 a[202:203], v232 offset:43008
L_wk1_2:
  s_cbranch_vccnz L_wk1_6
  v_mfma_f32_16x16x32_bf16 v[96:99], a[212:215], a[80:83], v[96:99]
  ds_read_b64_tr_b16 a[204:205], v233 offset:28672
  ds_read_b64_tr_b16 a[206:207], v233 offset:30720
  v_mfma_f32_16x16x32_bf16 v[128:131], a[208:211], a[68:71], v[128:131]
  v_mfma_f32_16x16x32_bf16 v[128:131], a[212:215], a[84:87], v[128:131]
  v_mfma_f32_16x16x32_bf16 v[160:163], a[208:211], a[72:75], v[160:163]
  v_mfma_f32_16x16x32_bf16 v[160:163], a[212:215], a[88:91], v[160:163]
  buffer_load_dwordx4 a[156:159], v225, s[4:7], s40 offen offset:3072 sc1
  v_mfma_f32_16x16x32_bf16 v[192:195], a[208:211], a[76:79], v[192:195]
  ds_read_b64_tr_b16 a[208:209], v233 offset:40960
  s_mov_b32 s41, 2752512
  v_mfma_f32_16x16x32_bf16 v[192:195], a[212:215], a[92:95], v[192:195]
  ds_read_b64_tr_b16 a[210:211], v233 offset:43008
  s_add_u32 m0, s42, 126976
  v_mfma_f32_16x16x32_bf16 v[100:103], a[216:219], a[64:67], v[100:103]
  ds_read_b64_tr_b16 a[212:213], v234 offset:28672
  s_waitcnt lgkmcnt(13)
  v_mfma_f32_16x16x32_bf16 v[100:103], a[220:223], a[80:83], v[100:103]
  ds_read_b64_tr_b16 a[214:215], v234 offset:30720
  v_mfma_f32_16x16x32_bf16 v[132:135], a[216:219], a[68:71], v[132:135]
  v_mfma_f32_16x16x32_bf16 v[132:135], a[220:223], a[84:87], v[132:135]
  buffer_load_dwordx4 v226, s[16:19], s41 offen offset:0 lds
  v_mfma_f32_16x16x32_bf16 v[164:167], a[216:219], a[72:75], v[164:167]
  s_mov_b32 s41, 2981888
  s_add_u32 m0, s42, 122880
  v_mfma_f32_16x16x32_bf16 v[164:167], a[220:223], a[88:91], v[164:167]
  s_load_dwordx2 s[66:67], s[36:37], 0xe0000
  s_add_u32 s36, s36, 0x100000
  s_addc_u32 s37, s37, 0
  v_mfma_f32_16x16x32_bf16 v[196:199], a[216:219], a[76:79], v[196:199]
  ds_read_b64_tr_b16 a[216:217], v234 offset:40960
  v_mfma_f32_16x16x32_bf16 v[196:199], a[220:223], a[92:95], v[196:199]
  ds_read_b64_tr_b16 a[218:219], v234 offset:43008
  v_mfma_f32_16x16x32_bf16 v[104:107], a[224:227], a[64:67], v[104:107]
  ds_read_b64_tr_b16 a[220:221], v235 offset:28672
  v_mfma_f32_16x16x32_bf16 v[104:107], a[228:231], a[80:83], v[104:107]
  buffer_load_dwordx4 v226, s[16:19], s41 offen offset:0 lds
  v_mfma_f32_16x16x32_bf16 v[136:139], a[224:227], a[68:71], v[136:139]
  ds_read_b64_tr_b16 a[222:223], v235 offset:30720
  v_mfma_f32_16x16x32_bf16 v[136:139], a[228:231], a[84:87], v[136:139]
  v_mfma_f32_16x16x32_bf16 v[168:171], a[224:227], a[72:75], v[168:171]
  v_mfma_f32_16x16x32_bf16 v[168:171], a[228:231], a[88:91], v[168:171]
  v_mfma_f32_16x16x32_bf16 v[200:203], a[224:227], a[76:79], v[200:203]
  ds_read_b64_tr_b16 a[224:225], v235 offset:40960
  v_mfma_f32_16x16x32_bf16 v[200:203], a[228:231], a[92:95], v[200:203]
  ds_read_b64_tr_b16 a[226:227], v235 offset:43008
  s_mov_b32 s41, 3211264
  s_waitcnt lgkmcnt(13)
  v_mfma_f32_16x16x32_bf16 v[108:111], a[232:235], a[64:67], v[108:111]
  ds_read_b64_tr_b16 a[228:229], v232 offset:49152
  s_add_u32 m0, s42, 135168
  v_mfma_f32_16x16x32_bf16 v[108:111], a[192:195], a[80:83], v[108:111]
  s_waitcnt vmcnt(26)
  s_barrier
  v_mfma_f32_16x16x32_bf16 v[140:143], a[232:235], a[68:71], v[140:143]
  buffer_load_dwordx4 v227, s[12:15], s41 offen offset:0 lds
  v_mfma_f32_16x16x32_bf16 v[140:143], a[192:195], a[84:87], v[140:143]
  ds_read_b64_tr_b16 a[230:231], v232 offset:51200
  v_mfma_f32_16x16x32_bf16 v[172:175], a[232:235], a[72:75], v[172:175]
  v_mfma_f32_16x16x32_bf16 v[172:175], a[192:195], a[88:91], v[172:175]
  v_mfma_f32_16x16x32_bf16 v[204:207], a[232:235], a[76:79], v[204:207]
  ds_read_b64_tr_b16 a[232:233], v236 offset:12288
  s_mov_b32 s41, 3440640
  v_mfma_f32_16x16x32_bf16 v[204:207], a[192:195], a[92:95], v[204:207]
  ds_read_b64_tr_b16 a[234:235], v236 offset:14336
  s_add_u32 m0, s42, 151552
  v_mfma_f32_16x16x32_bf16 v[112:115], a[196:199], a[64:67], v[112:115]
  buffer_load_dwordx4 v227, s[12:15], s41 offen offset:0 lds
  s_waitcnt lgkmcnt(13)
  v_mfma_f32_16x16x32_bf16 v[112:115], a[200:203], a[80:83], v[112:115]
  ds_read_b64_tr_b16 a[192:193], v233 offset:49152
  ds_read_b64_tr_b16 a[194:195], v233 offset:51200
  v_mfma_f32_16x16x32_bf16 v[144:147], a[196:199], a[68:71], v[144:147]
  v_mfma_f32_16x16x32_bf16 v[144:147], a[200:203], a[84:87], v[144:147]
  s_load_dwordx2 s[66:67], s[36:37], 0x0
  v_mfma_f32_16x16x32_bf16 v[176:179], a[196:199], a[72:75], v[176:179]
  buffer_store_dwordx4 a[252:255], v251, s[4:7], s96 offen offset:1024 sc1
  v_mfma_f32_16x16x32_bf16 v[176:179], a[200:203], a[88:91], v[176:179]
  v_mfma_f32_16x16x32_bf16 v[208:211], a[196:199], a[76:79], v[208:211]
  ds_read_b64_tr_b16 a[196:197], v237 offset:12288
  v_mfma_f32_16x16x32_bf16 v[208:211], a[200:203], a[92:95], v[208:211]
  ds_read_b64_tr_b16 a[198:199], v237 offset:14336
  s_mov_b32 s41, 3211264
  v_mfma_f32_16x16x32_bf16 v[116:119], a[204:207], a[64:67], v[116:119]
  ds_read_b64_tr_b16 a[200:201], v232 offset:4096
  s_add_u32 m0, s42, 147456
  s_waitcnt lgkmcnt(13)
  v_mfma_f32_16x16x32_bf16 v[116:119], a[208:211], a[80:83], v[116:119]
  buffer_load_dwordx4 v227, s[16:19], s41 offen offset:0 lds
  v_mfma_f32_16x16x32_bf16 v[148:151], a[204:207], a[68:71], v[148:151]
  ds_read_b64_tr_b16 a[202:203], v232 offset:6144
  v_mfma_f32_16x16x32_bf16 v[148:151], a[208:211], a[84:87], v[148:151]
  v_mfma_f32_16x16x32_bf16 v[180:183], a[204:207], a[72:75], v[180:183]
  v_mfma_f32_16x16x32_bf16 v[180:183], a[208:211], a[88:91], v[180:183]
  v_mfma_f32_16x16x32_bf16 v[212:215], a[204:207], a[76:79], v[212:215]
  ds_read_b64_tr_b16 a[204:205], v232 offset:16384
  s_mov_b32 s41, 3440640
  v_mfma_f32_16x16x32_bf16 v[212:215], a[208:211], a[92:95], v[212:215]
  ds_read_b64_tr_b16 a[206:207], v232 offset:18432
  s_add_u32 m0, s42, 159744
  v_mfma_f32_16x16x32_bf16 v[120:123], a[212:215], a[64:67], v[120:123]
  buffer_load_dwordx4 v227, s[16:19], s41 offen offset:0 lds
  v_mfma_f32_16x16x32_bf16 v[120:123], a[216:219], a[80:83], v[120:123]
  ds_read_b64_tr_b16 a[208:209], v233 offset:4096
  ds_read_b64_tr_b16 a[210:211], v233 offset:6144
  v_mfma_f32_16x16x32_bf16 v[152:155], a[212:215], a[68:71], v[152:155]
  v_mfma_f32_16x16x32_bf16 v[152:155], a[216:219], a[84:87], v[152:155]
  v_mfma_f32_16x16x32_bf16 v[184:187], a[212:215], a[72:75], v[184:187]
  v_mfma_f32_16x16x32_bf16 v[184:187], a[216:219], a[88:91], v[184:187]
  v_mfma_f32_16x16x32_bf16 v[216:219], a[212:215], a[76:79], v[216:219]
  ds_read_b64_tr_b16 a[212:213], v233 offset:16384
  v_mfma_f32_16x16x32_bf16 v[216:219], a[216:219], a[92:95], v[216:219]
  ds_read_b64_tr_b16 a[214:215], v233 offset:18432
  s_waitcnt lgkmcnt(13)
  v_mfma_f32_16x16x32_bf16 v[124:127], a[220:223], a[64:67], v[124:127]
  ds_read_b64_tr_b16 a[216:217], v234 offset:49152
  v_mfma_f32_16x16x32_bf16 v[124:127], a[224:227], a[80:83], v[124:127]
  ds_read_b64_tr_b16 a[218:219], v234 offset:51200
  s_load_dwordx2 s[66:67], s[36:37], 0x20000
  v_mfma_f32_16x16x32_bf16 v[156:159], a[220:223], a[68:71], v[156:159]
  v_mfma_f32_16x16x32_bf16 v[156:159], a[224:227], a[84:87], v[156:159]
  v_mfma_f32_16x16x32_bf16 v[188:191], a[220:223], a[72:75], v[188:191]
  v_mfma_f32_16x16x32_bf16 v[188:191], a[224:227], a[88:91], v[188:191]
  v_mfma_f32_16x16x32_bf16 v[220:223], a[220:223], a[76:79], v[220:223]
  ds_read_b64_tr_b16 a[220:221], v238 offset:12288
  v_mfma_f32_16x16x32_bf16 v[220:223], a[224:227], a[92:95], v[220:223]
  ds_read_b64_tr_b16 a[222:223], v238 offset:14336
  s_mov_b32 s40, 11272192
  v_mfma_f32_16x16x32_bf16 v[0:3], a[228:231], a[96:99], v[0:3]
  buffer_load_dwordx4 a[160:163], v225, s[4:7], s40 offen offset:0 sc1
  s_waitcnt vmcnt(28) lgkmcnt(13)
  v_mfma_f32_16x16x32_bf16 v[0:3], a[232:235], a[112:115], v[0:3]
  ds_read_b64_tr_b16 a[224:225], v234 offset:4096
  ds_read_b64_tr_b16 a[226:227], v234 offset:6144
  v_mfma_f32_16x16x32_bf16 v[16:19], a[228:231], a[100:103], v[16:19]
  v_mfma_f32_16x16x32_bf16 v[16:19], a[232:235], a[116:119], v[16:19]
  s_mov_b32 s78, 4718592
  v_mfma_f32_16x16x32_bf16 v[32:35], a[228:231], a[104:107], v[32:35]
  buffer_load_dword v241, v247, s[56:59], s78 offen
  v_mfma_f32_16x16x32_bf16 v[32:35], a[232:235], a[120:123], v[32:35]
  v_mfma_f32_16x16x32_bf16 v[48:51], a[228:231], a[108:111], v[48:51]
  buffer_load_dwordx4 a[164:167], v225, s[4:7], s40 offen offset:1024 sc1
  v_mfma_f32_16x16x32_bf16 v[48:51], a[232:235], a[124:127], v[48:51]
  ds_read_b64_tr_b16 a[228:229], v234 offset:16384
  v_mfma_f32_16x16x32_bf16 v[4:7], a[192:195], a[96:99], v[4:7]
  ds_read_b64_tr_b16 a[230:231], v234 offset:18432
  s_waitcnt lgkmcnt(13)
  v_mfma_f32_16x16x32_bf16 v[4:7], a[196:199], a[112:115], v[4:7]
  ds_read_b64_tr_b16 a[232:233], v228 offset:61440
  ds_read_b64_tr_b16 a[234:235], v228 offset:63488
  v_mfma_f32_16x16x32_bf16 v[20:23], a[192:195], a[100:103], v[20:23]
  v_mfma_f32_16x16x32_bf16 v[20:23], a[196:199], a[116:119], v[20:23]
  buffer_load_dwordx4 a[168:171], v225, s[4:7], s40 offen offset:2048 sc1
  v_mfma_f32_16x16x32_bf16 v[36:39], a[192:195], a[104:107], v[36:39]
  v_mfma_f32_16x16x32_bf16 v[36:39], a[196:199], a[120:123], v[36:39]
  v_mfma_f32_16x16x32_bf16 v[52:55], a[192:195], a[108:111], v[52:55]
  ds_read_b64_tr_b16 a[192:193], v232 offset:24576
  v_mfma_f32_16x16x32_bf16 v[52:55], a[196:199], a[124:127], v[52:55]
  ds_read_b64_tr_b16 a[194:195], v232 offset:26624
  s_load_dwordx2 s[66:67], s[36:37], 0x40000
  v_mfma_f32_16x16x32_bf16 v[8:11], a[200:203], a[96:99], v[8:11]
  ds_read_b64_tr_b16 a[196:197], v229 offset:61440
  s_waitcnt lgkmcnt(13)
  v_mfma_f32_16x16x32_bf16 v[8:11], a[204:207], a[112:115], v[8:11]
  s_waitcnt vmcnt(26)
  s_barrier
  v_mfma_f32_16x16x32_bf16 v[24:27], a[200:203], a[100:103], v[24:27]
  buffer_load_dwordx4 a[172:175], v225, s[4:7], s40 offen offset:3072 sc1
  v_mfma_f32_16x16x32_bf16 v[24:27], a[204:207], a[116:119], v[24:27]
  ds_read_b64_tr_b16 a[198:199], v229 offset:63488
  s_mov_b32 s41, 3211264
  v_mfma_f32_16x16x32_bf16 v[40:43], a[200:203], a[104:107], v[40:43]
  s_add_u32 m0, s42, 16384
  v_mfma_f32_16x16x32_bf16 v[40:43], a[204:207], a[120:123], v[40:43]
  v_mfma_f32_16x16x32_bf16 v[56:59], a[200:203], a[108:111], v[56:59]
  ds_read_b64_tr_b16 a[200:201], v233 offset:24576
  v_mfma_f32_16x16x32_bf16 v[56:59], a[204:207], a[124:127], v[56:59]
  buffer_load_dwordx4 v226, s[12:15], s41 offen offset:0 lds
  v_mfma_f32_16x16x32_bf16 v[12:15], a[208:211], a[96:99], v[12:15]
  ds_read_b64_tr_b16 a[202:203], v233 offset:26624
  s_mov_b32 s41, 3440640
  v_mfma_f32_16x16x32_bf16 v[12:15], a[212:215], a[112:115], v[12:15]
  ds_read_b64_tr_b16 a[204:205], v230 offset:61440
  ds_read_b64_tr_b16 a[206:207], v230 offset:63488
  v_mfma_f32_16x16x32_bf16 v[28:31], a[208:211], a[100:103], v[28:31]
  s_add_u32 m0, s42, 28672
  v_mfma_f32_16x16x32_bf16 v[28:31], a[212:215], a[116:119], v[28:31]
  v_mfma_f32_16x16x32_bf16 v[44:47], a[208:211], a[104:107], v[44:47]
  v_mfma_f32_16x16x32_bf16 v[44:47], a[212:215], a[120:123], v[44:47]
  buffer_load_dwordx4 v226, s[12:15], s41 offen offset:0 lds
  v_mfma_f32_16x16x32_bf16 v[60:63], a[208:211], a[108:111], v[60:63]
  ds_read_b64_tr_b16 a[208:209], v234 offset:24576
  s_mov_b32 s40, 11403264
  v_mfma_f32_16x16x32_bf16 v[60:63], a[212:215], a[124:127], v[60:63]
  ds_read_b64_tr_b16 a[210:211], v234 offset:26624
  s_waitcnt lgkmcnt(13)
  v_mfma_f32_16x16x32_bf16 v[64:67], a[216:219], a[96:99], v[64:67]
  ds_read_b64_tr_b16 a[212:213], v231 offset:61440
  buffer_store_dwordx4 a[252:255], v251, s[4:7], s96 offen offset:2048 sc1
  v_mfma_f32_16x16x32_bf16 v[64:67], a[220:223], a[112:115], v[64:67]
  ds_read_b64_tr_b16 a[214:215], v231 offset:63488
  v_mfma_f32_16x16x32_bf16 v[72:75], a[216:219], a[100:103], v[72:75]
  v_mfma_f32_16x16x32_bf16 v[72:75], a[220:223], a[116:119], v[72:75]
  buffer_load_dwordx4 a[176:179], v225, s[4:7], s40 offen offset:0 sc1
  v_mfma_f32_16x16x32_bf16 v[80:83], a[216:219], a[104:107], v[80:83]
  v_mfma_f32_16x16x32_bf16 v[80:83], a[220:223], a[120:123], v[80:83]
  s_load_dwordx2 s[66:67], s[36:37], 0x60000
  v_mfma_f32_16x16x32_bf16 v[88:91], a[216:219], a[108:111], v[88:91]
  ds_read_b64_tr_b16 a[216:217], v235 offset:24576
  v_mfma_f32_16x16x32_bf16 v[88:91], a[220:223], a[124:127], v[88:91]
  ds_read_b64_tr_b16 a[218:219], v235 offset:26624
  v_mfma_f32_16x16x32_bf16 v[68:71], a[224:227], a[96:99], v[68:71]
  ds_read_b64_tr_b16 a[220:221], v232 offset:53248
  s_waitcnt lgkmcnt(13)
  v_mfma_f32_16x16x32_bf16 v[68:71], a[228:231], a[112:115], v[68:71]
  buffer_load_dwordx4 a[180:183], v225, s[4:7], s40 offen offset:1024 sc1
  v_mfma_f32_16x16x32_bf16 v[76:79], a[224:227], a[100:103], v[76:79]
  ds_read_b64_tr_b16 a[222:223], v232 offset:55296
  v_mfma_f32_16x16x32_bf16 v[76:79], a[228:231], a[116:119], v[76:79]
  v_mfma_f32_16x16x32_bf16 v[84:87], a[224:227], a[104:107], v[84:87]
  v_mfma_f32_16x16x32_bf16 v[84:87], a[228:231], a[120:123], v[84:87]
  v_mfma_f32_16x16x32_bf16 v[92:95], a[224:227], a[108:111], v[92:95]
  ds_read_b64_tr_b16 a[224:225], v236 offset:0
  v_mfma_f32_16x16x32_bf16 v[92:95], a[228:231], a[124:127], v[92:95]
  buffer_load_dwordx4 a[184:187], v225, s[4:7], s40 offen offset:2048 sc1
  v_mfma_f32_16x16x32_bf16 v[96:99], a[232:235], a[96:99], v[96:99]
  ds_read_b64_tr_b16 a[226:227], v236 offset:2048
  v_mfma_f32_16x16x32_bf16 v[96:99], a[192:195], a[112:115], v[96:99]
  ds_read_b64_tr_b16 a[228:229], v233 offset:53248
  ds_read_b64_tr_b16 a[230:231], v233 offset:55296
  v_mfma_f32_16x16x32_bf16 v[128:131], a[232:235], a[100:103], v[128:131]
  v_mfma_f32_16x16x32_bf16 v[128:131], a[192:195], a[116:119], v[128:131]
  v_mfma_f32_16x16x32_bf16 v[160:163], a[232:235], a[104:107], v[160:163]
  v_mfma_f32_16x16x32_bf16 v[160:163], a[192:195], a[120:123], v[160:163]
  buffer_load_dwordx4 a[188:191], v225, s[4:7], s40 offen offset:3072 sc1
  v_mfma_f32_16x16x32_bf16 v[192:195], a[232:235], a[108:111], v[192:195]
  ds_read_b64_tr_b16 a[232:233], v237 offset:0
  s_mov_b32 s41, 3211264
  v_mfma_f32_16x16x32_bf16 v[192:195], a[192:195], a[124:127], v[192:195]
  ds_read_b64_tr_b16 a[234:235], v237 offset:2048
  s_add_u32 m0, s42, 139264
  s_waitcnt lgkmcnt(13)
  v_mfma_f32_16x16x32_bf16 v[100:103], a[196:199], a[96:99], v[100:103]
  ds_read_b64_tr_b16 a[192:193], v234 offset:53248
  v_mfma_f32_16x16x32_bf16 v[100:103], a[200:203], a[112:115], v[100:103]
  ds_read_b64_tr_b16 a[194:195], v234 offset:55296
  v_mfma_f32_16x16x32_bf16 v[132:135], a[196:199], a[100:103], v[132:135]
  v_mfma_f32_16x16x32_bf16 v[132:135], a[200:203], a[116:119], v[132:135]
  buffer_load_dwordx4 v226, s[16:19], s41 offen offset:0 lds
  s_load_dwordx2 s[66:67], s[36:37], 0x80000
  v_mfma_f32_16x16x32_bf16 v[164:167], a[196:199], a[104:107], v[164:167]
  s_mov_b32 s41, 3440640
  s_add_u32 m0, s42, 155648
  v_mfma_f32_16x16x32_bf16 v[164:167], a[200:203], a[120:123], v[164:167]
  v_mfma_f32_16x16x32_bf16 v[196:199], a[196:199], a[108:111], v[196:199]
  ds_read_b64_tr_b16 a[196:197], v238 offset:0
  v_mfma_f32_16x16x32_bf16 v[196:199], a[200:203], a[124:127], v[196:199]
  ds_read_b64_tr_b16 a[198:199], v238 offset:2048
  v_mfma_f32_16x16x32_bf16 v[104:107], a[204:207], a[96:99], v[104:107]
  ds_read_b64_tr_b16 a[200:201], v235 offset:53248
  s_waitcnt lgkmcnt(13)
  v_mfma_f32_16x16x32_bf16 v[104:107], a[208:211], a[112:115], v[104:107]
  buffer_load_dwordx4 v226, s[16:19], s41 offen offset:0 lds
  v_mfma_f32_16x16x32_bf16 v[136:139], a[204:207], a[100:103], v[136:139]
  ds_read_b64_tr_b16 a[202:203], v235 offset:55296
  v_mfma_f32_16x16x32_bf16 v[136:139], a[208:211], a[116:119], v[136:139]
  v_mfma_f32_16x16x32_bf16 v[168:171], a[204:207], a[104:107], v[168:171]
  v_mfma_f32_16x16x32_bf16 v[168:171], a[208:211], a[120:123], v[168:171]
  v_mfma_f32_16x16x32_bf16 v[200:203], a[204:207], a[108:111], v[200:203]
  ds_read_b64_tr_b16 a[204:205], v239 offset:0
  v_mfma_f32_16x16x32_bf16 v[200:203], a[208:211], a[124:127], v[200:203]
  ds_read_b64_tr_b16 a[206:207], v239 offset:2048
  s_mov_b32 s41, 3670016
  v_mfma_f32_16x16x32_bf16 v[108:111], a[212:215], a[96:99], v[108:111]
  ds_read_b64_tr_b16 a[208:209], v232 offset:12288
  s_add_u32 m0, s42, 20480
  v_mfma_f32_16x16x32_bf16 v[108:111], a[216:219], a[112:115], v[108:111]
  s_waitcnt vmcnt(26)
  s_barrier
  v_mfma_f32_16x16x32_bf16 v[140:143], a[212:215], a[100:103], v[140:143]
  buffer_load_dwordx4 v227, s[12:15], s41 offen offset:0 lds
  v_mfma_f32_16x16x32_bf16 v[140:143], a[216:219], a[116:119], v[140:143]
  ds_read_b64_tr_b16 a[210:211], v232 offset:14336
  v_mfma_f32_16x16x32_bf16 v[172:175], a[212:215], a[104:107], v[172:175]
  v_mfma_f32_16x16x32_bf16 v[172:175], a[216:219], a[120:123], v[172:175]
  v_mfma_f32_16x16x32_bf16 v[204:207], a[212:215], a[108:111], v[204:207]
  ds_read_b64_tr_b16 a[212:213], v232 offset:8192
  s_mov_b32 s41, 3899392
  v_mfma_f32_16x16x32_bf16 v[204:207], a[216:219], a[124:127], v[204:207]
  ds_read_b64_tr_b16 a[214:215], v232 offset:10240
  s_add_u32 m0, s42, 12288
  s_waitcnt lgkmcnt(13)
  v_mfma_f32_16x16x32_bf16 v[112:115], a[220:223], a[96:99], v[112:115]
  buffer_load_dwordx4 v227, s[12:15], s41 offen offset:0 lds
  v_mfma_f32_16x16x32_bf16 v[112:115], a[224:227], a[112:115], v[112:115]
  ds_read_b64_tr_b16 a[216:217], v233 offset:12288
  ds_read_b64_tr_b16 a[218:219], v233 offset:14336
  s_load_dwordx2 s[66:67], s[36:37], 0xa0000
  v_mfma_f32_16x16x32_bf16 v[144:147], a[220:223], a[100:103], v[144:147]
  v_mfma_f32_16x16x32_bf16 v[144:147], a[224:227], a[116:119], v[144:147]
  v_mfma_f32_16x16x32_bf16 v[176:179], a[220:223], a[104:107], v[176:179]
  v_mfma_f32_16x16x32_bf16 v[176:179], a[224:227], a[120:123], v[176:179]
  v_mfma_f32_16x16x32_bf16 v[208:211], a[220:223], a[108:111], v[208:211]
  ds_read_b64_tr_b16 a[220:221], v233 offset:8192
  v_mfma_f32_16x16x32_bf16 v[208:211], a[224:227], a[124:127], v[208:211]
  ds_read_b64_tr_b16 a[222:223], v233 offset:10240
  s_mov_b32 s41, 3670016
  v_mfma_f32_16x16x32_bf16 v[116:119], a[228:231], a[96:99], v[116:119]
  ds_read_b64_tr_b16 a[224:225], v232 offset:20480
  s_add_u32 m0, s42, 24576
  s_waitcnt lgkmcnt(13)
  v_mfma_f32_16x16x32_bf16 v[116:119], a[232:235], a[112:115], v[116:119]
  buffer_load_dwordx4 v227, s[16:19], s41 offen offset:0 lds
  v_mfma_f32_16x16x32_bf16 v[148:151], a[228:231], a[100:103], v[148:151]
  ds_read_b64_tr_b16 a[226:227], v232 offset:22528
  s_mov_b32 s78, 5242880
  v_mfma_f32_16x16x32_bf16 v[148:151], a[232:235], a[116:119], v[148:151]
  buffer_load_dword v241, v247, s[56:59], s78 offen
  v_mfma_f32_16x16x32_bf16 v[180:183], a[228:231], a[104:107], v[180:183]
  buffer_store_dwordx4 a[252:255], v251, s[4:7], s96 offen offset:3072 sc1
  v_mfma_f32_16x16x32_bf16 v[180:183], a[232:235], a[120:123], v[180:183]
  v_mfma_f32_16x16x32_bf16 v[212:215], a[228:231], a[108:111], v[212:215]
  ds_read_b64_tr_b16 a[228:229], v232 offset:36864
  s_mov_b32 s41, 3899392
  v_mfma_f32_16x16x32_bf16 v[212:215], a[232:235], a[124:127], v[212:215]
  ds_read_b64_tr_b16 a[230:231], v232 offset:38912
  s_add_u32 m0, s42, 45056
  v_mfma_f32_16x16x32_bf16 v[120:123], a[192:195], a[96:99], v[120:123]
  buffer_load_dwordx4 v227, s[16:19], s41 offen offset:0 lds
  v_mfma_f32_16x16x32_bf16 v[120:123], a[196:199], a[112:115], v[120:123]
  ds_read_b64_tr_b16 a[232:233], v233 offset:20480
  ds_read_b64_tr_b16 a[234:235], v233 offset:22528
  v_mfma_f32_16x16x32_bf16 v[152:155], a[192:195], a[100:103], v[152:155]
  v_mfma_f32_16x16x32_bf16 v[152:155], a[196:199], a[116:119], v[152:155]
  v_mfma_f32_16x16x32_bf16 v[184:187], a[192:195], a[104:107], v[184:187]
  v_mfma_f32_16x16x32_bf16 v[184:187], a[196:199], a[120:123], v[184:187]
  v_mfma_f32_16x16x32_bf16 v[216:219], a[192:195], a[108:111], v[216:219]
  ds_read_b64_tr_b16 a[192:193], v233 offset:36864
  v_mfma_f32_16x16x32_bf16 v[216:219], a[196:199], a[124:127], v[216:219]
  ds_read_b64_tr_b16 a[194:195], v233 offset:38912
  s_load_dwordx2 s[66:67], s[36:37], 0xc0000
  s_waitcnt lgkmcnt(13)
  v_mfma_f32_16x16x32_bf16 v[124:127], a[200:203], a[96:99], v[124:127]
  ds_read_b64_tr_b16 a[196:197], v234 offset:12288
  v_mfma_f32_16x16x32_bf16 v[124:127], a[204:207], a[112:115], v[124:127]
  ds_read_b64_tr_b16 a[198:199], v234 offset:14336
  v_mfma_f32_16x16x32_bf16 v[156:159], a[200:203], a[100:103], v[156:159]
  v_mfma_f32_16x16x32_bf16 v[156:159], a[204:207], a[116:119], v[156:159]
  v_mfma_f32_16x16x32_bf16 v[188:191], a[200:203], a[104:107], v[188:191]
  v_mfma_f32_16x16x32_bf16 v[188:191], a[204:207], a[120:123], v[188:191]
  v_mfma_f32_16x16x32_bf16 v[220:223], a[200:203], a[108:111], v[220:223]
  ds_read_b64_tr_b16 a[200:201], v234 offset:8192
  v_mfma_f32_16x16x32_bf16 v[220:223], a[204:207], a[124:127], v[220:223]
  ds_read_b64_tr_b16 a[202:203], v234 offset:10240
  s_mov_b32 s40, 11534336
  v_mfma_f32_16x16x32_bf16 v[0:3], a[208:211], a[128:131], v[0:3]
  buffer_load_dwordx4 a[0:3], v225, s[4:7], s40 offen offset:0 sc1
  s_waitcnt vmcnt(28) lgkmcnt(13)
  v_mfma_f32_16x16x32_bf16 v[0:3], a[212:215], a[144:147], v[0:3]
  ds_read_b64_tr_b16 a[204:205], v234 offset:20480
  ds_read_b64_tr_b16 a[206:207], v234 offset:22528
  v_mfma_f32_16x16x32_bf16 v[16:19], a[208:211], a[132:135], v[16:19]
  v_mfma_f32_16x16x32_bf16 v[16:19], a[212:215], a[148:151], v[16:19]
  v_mfma_f32_16x16x32_bf16 v[32:35], a[208:211], a[136:139], v[32:35]
  v_mfma_f32_16x16x32_bf16 v[32:35], a[212:215], a[152:155], v[32:35]
  buffer_load_dwordx4 a[4:7], v225, s[4:7], s40 offen offset:1024 sc1
  v_mfma_f32_16x16x32_bf16 v[48:51], a[208:211], a[140:143], v[48:51]
  ds_read_b64_tr_b16 a[208:209], v234 offset:36864
  v_mfma_f32_16x16x32_bf16 v[48:51], a[212:215], a[156:159], v[48:51]
  ds_read_b64_tr_b16 a[210:211], v234 offset:38912
  v_mfma_f32_16x16x32_bf16 v[4:7], a[216:219], a[128:131], v[4:7]
  ds_read_b64_tr_b16 a[212:213], v232 offset:32768
  s_waitcnt lgkmcnt(13)
  v_mfma_f32_16x16x32_bf16 v[4:7], a[220:223], a[144:147], v[4:7]
  ds_read_b64_tr_b16 a[214:215], v232 offset:34816
  v_mfma_f32_16x16x32_bf16 v[20:23], a[216:219], a[132:135], v[20:23]
  v_mfma_f32_16x16x32_bf16 v[20:23], a[220:223], a[148:151], v[20:23]
  buffer_load_dwordx4 a[8:11], v225, s[4:7], s40 offen offset:2048 sc1
  v_mfma_f32_16x16x32_bf16 v[36:39], a[216:219], a[136:139], v[36:39]
  v_mfma_f32_16x16x32_bf16 v[36:39], a[220:223], a[152:155], v[36:39]
  s_load_dwordx2 s[66:67], s[36:37], 0xe0000
  s_add_u32 s36, s36, 0x100000
  s_addc_u32 s37, s37, 0
  v_mfma_f32_16x16x32_bf16 v[52:55], a[216:219], a[140:143], v[52:55]
  ds_read_b64_tr_b16 a[216:217], v232 offset:45056
  v_mfma_f32_16x16x32_bf16 v[52:55], a[220:223], a[156:159], v[52:55]
  ds_read_b64_tr_b16 a[218:219], v232 offset:47104
  v_mfma_f32_16x16x32_bf16 v[8:11], a[224:227], a[128:131], v[8:11]
  ds_read_b64_tr_b16 a[220:221], v233 offset:32768
  v_mfma_f32_16x16x32_bf16 v[8:11], a[228:231], a[144:147], v[8:11]
  s_waitcnt vmcnt(27)
  s_barrier
  v_mfma_f32_16x16x32_bf16 v[24:27], a[224:227], a[132:135], v[24:27]
  buffer_load_dwordx4 a[12:15], v225, s[4:7], s40 offen offset:3072 sc1
  v_mfma_f32_16x16x32_bf16 v[24:27], a[228:231], a[148:151], v[24:27]
  ds_read_b64_tr_b16 a[222:223], v233 offset:34816
  s_mov_b32 s41, 3670016
  v_mfma_f32_16x16x32_bf16 v[40:43], a[224:227], a[136:139], v[40:43]
  s_add_u32 m0, s42, 36864
  v_mfma_f32_16x16x32_bf16 v[40:43], a[228:231], a[152:155], v[40:43]
  v_mfma_f32_16x16x32_bf16 v[56:59], a[224:227], a[140:143], v[56:59]
  ds_read_b64_tr_b16 a[224:225], v233 offset:45056
  v_mfma_f32_16x16x32_bf16 v[56:59], a[228:231], a[156:159], v[56:59]
  buffer_load_dwordx4 v226, s[12:15], s41 offen offset:0 lds
  s_waitcnt lgkmcnt(13)
  v_mfma_f32_16x16x32_bf16 v[12:15], a[232:235], a[128:131], v[12:15]
  ds_read_b64_tr_b16 a[226:227], v233 offset:47104
  s_mov_b32 s41, 3899392
  v_mfma_f32_16x16x32_bf16 v[12:15], a[192:195], a[144:147], v[12:15]
  ds_read_b64_tr_b16 a[228:229], v234 offset:32768
  ds_read_b64_tr_b16 a[230:231], v234 offset:34816
  v_mfma_f32_16x16x32_bf16 v[28:31], a[232:235], a[132:135], v[28:31]
  s_add_u32 m0, s42, 49152
  v_mfma_f32_16x16x32_bf16 v[28:31], a[192:195], a[148:151], v[28:31]
  v_mfma_f32_16x16x32_bf16 v[44:47], a[232:235], a[136:139], v[44:47]
  v_mfma_f32_16x16x32_bf16 v[44:47], a[192:195], a[152:155], v[44:47]
  buffer_load_dwordx4 v226, s[12:15], s41 offen offset:0 lds
  v_mfma_f32_16x16x32_bf16 v[60:63], a[232:235], a[140:143], v[60:63]
  ds_read_b64_tr_b16 a[232:233], v234 offset:45056
  s_mov_b32 s40, 11665408
  v_mfma_f32_16x16x32_bf16 v[60:63], a[192:195], a[156:159], v[60:63]
  ds_read_b64_tr_b16 a[234:235], v234 offset:47104
  v_mfma_f32_16x16x32_bf16 v[64:67], a[196:199], a[128:131], v[64:67]
  ds_read_b64_tr_b16 a[192:193], v235 offset:32768
  s_waitcnt lgkmcnt(13)
  v_mfma_f32_16x16x32_bf16 v[64:67], a[200:203], a[144:147], v[64:67]
  ds_read_b64_tr_b16 a[194:195], v235 offset:34816
  v_mfma_f32_16x16x32_bf16 v[72:75], a[196:199], a[132:135], v[72:75]
  v_mfma_f32_16x16x32_bf16 v[72:75], a[200:203], a[148:151], v[72:75]
  buffer_load_dwordx4 a[16:19], v225, s[4:7], s40 offen offset:0 sc1
  s_load_dwordx2 s[66:67], s[36:37], 0x0
  v_mfma_f32_16x16x32_bf16 v[80:83], a[196:199], a[136:139], v[80:83]
  v_mfma_f32_16x16x32_bf16 v[80:83], a[200:203], a[152:155], v[80:83]
  v_mfma_f32_16x16x32_bf16 v[88:91], a[196:199], a[140:143], v[88:91]
  ds_read_b64_tr_b16 a[196:197], v235 offset:45056
  v_mfma_f32_16x16x32_bf16 v[88:91], a[200:203], a[156:159], v[88:91]
  ds_read_b64_tr_b16 a[198:199], v235 offset:47104
  v_mfma_f32_16x16x32_bf16 v[68:71], a[204:207], a[128:131], v[68:71]
  ds_read_b64_tr_b16 a[200:201], v232 offset:61440
  v_mfma_f32_16x16x32_bf16 v[68:71], a[208:211], a[144:147], v[68:71]
  buffer_load_dwordx4 a[20:23], v225, s[4:7], s40 offen offset:1024 sc1
  v_mfma_f32_16x16x32_bf16 v[76:79], a[204:207], a[132:135], v[76:79]
  ds_read_b64_tr_b16 a[202:203], v232 offset:63488
  v_mfma_f32_16x16x32_bf16 v[76:79], a[208:211], a[148:151], v[76:79]
  v_mfma_f32_16x16x32_bf16 v[84:87], a[204:207], a[136:139], v[84:87]
  v_mfma_f32_16x16x32_bf16 v[84:87], a[208:211], a[152:155], v[84:87]
  v_mfma_f32_16x16x32_bf16 v[92:95], a[204:207], a[140:143], v[92:95]
  ds_read_b64_tr_b16 a[204:205], v232 offset:57344
  v_mfma_f32_16x16x32_bf16 v[92:95], a[208:211], a[156:159], v[92:95]
  buffer_load_dwordx4 a[24:27], v225, s[4:7], s40 offen offset:2048 sc1
  s_waitcnt lgkmcnt(13)
  v_mfma_f32_16x16x32_bf16 v[96:99], a[212:215], a[128:131], v[96:99]
  ds_read_b64_tr_b16 a[206:207], v232 offset:59392
  v_mfma_f32_16x16x32_bf16 v[96:99], a[216:219], a[144:147], v[96:99]
  ds_read_b64_tr_b16 a[208:209], v233 offset:61440
  ds_read_b64_tr_b16 a[210:211], v233 offset:63488
  v_mfma_f32_16x16x32_bf16 v[128:131], a[212:215], a[132:135], v[128:131]
  v_mfma_f32_16x16x32_bf16 v[128:131], a[216:219], a[148:151], v[128:131]
  v_mfma_f32_16x16x32_bf16 v[160:163], a[212:215], a[136:139], v[160:163]
  v_mfma_f32_16x16x32_bf16 v[160:163], a[216:219], a[152:155], v[160:163]
  buffer_load_dwordx4 a[28:31], v225, s[4:7], s40 offen offset:3072 sc1
  v_mfma_f32_16x16x32_bf16 v[192:195], a[212:215], a[140:143], v[192:195]
  ds_read_b64_tr_b16 a[212:213], v233 offset:57344
  s_mov_b32 s41, 3670016
  v_mfma_f32_16x16x32_bf16 v[192:195], a[216:219], a[156:159], v[192:195]
  ds_read_b64_tr_b16 a[214:215], v233 offset:59392
  s_add_u32 m0, s42, 32768
  v_mfma_f32_16x16x32_bf16 v[100:103], a[220:223], a[128:131], v[100:103]
  ds_read_b64_tr_b16 a[216:217], v234 offset:61440
  s_waitcnt lgkmcnt(13)
  v_mfma_f32_16x16x32_bf16 v[100:103], a[224:227], a[144:147], v[100:103]
  ds_read_b64_tr_b16 a[218:219], v234 offset:63488
  s_load_dwordx2 s[66:67], s[36:37], 0x20000
  v_mfma_f32_16x16x32_bf16 v[132:135], a[220:223], a[132:135], v[132:135]
  v_mfma_f32_16x16x32_bf16 v[132:135], a[224:227], a[148:151], v[132:135]
  buffer_load_dwordx4 v226, s[16:19], s41 offen offset:0 lds
  v_mfma_f32_16x16x32_bf16 v[164:167], a[220:223], a[136:139], v[164:167]
  s_mov_b32 s41, 3899392
  s_add_u32 m0, s42, 40960
  v_mfma_f32_16x16x32_bf16 v[164:167], a[224:227], a[152:155], v[164:167]
  s_mov_b32 s78, 5767168
  v_mfma_f32_16x16x32_bf16 v[196:199], a[220:223], a[140:143], v[196:199]
  ds_read_b64_tr_b16 a[220:221], v234 offset:57344
  v_mfma_f32_16x16x32_bf16 v[196:199], a[224:227], a[156:159], v[196:199]
  ds_read_b64_tr_b16 a[222:223], v234 offset:59392
  v_mfma_f32_16x16x32_bf16 v[104:107], a[228:231], a[128:131], v[104:107]
  ds_read_b64_tr_b16 a[224:225], v235 offset:61440
  v_mfma_f32_16x16x32_bf16 v[104:107], a[232:235], a[144:147], v[104:107]
  buffer_load_dwordx4 v226, s[16:19], s41 offen offset:0 lds
  v_mfma_f32_16x16x32_bf16 v[136:139], a[228:231], a[132:135], v[136:139]
  ds_read_b64_tr_b16 a[226:227], v235 offset:63488
  v_mfma_f32_16x16x32_bf16 v[136:139], a[232:235], a[148:151], v[136:139]
  buffer_load_dword v241, v247, s[56:59], s78 offen
  v_mfma_f32_16x16x32_bf16 v[168:171], a[228:231], a[136:139], v[168:171]
  v_mfma_f32_16x16x32_bf16 v[168:171], a[232:235], a[152:155], v[168:171]
  v_mfma_f32_16x16x32_bf16 v[200:203], a[228:231], a[140:143], v[200:203]
  ds_read_b64_tr_b16 a[228:229], v235 offset:57344
  v_mfma_f32_16x16x32_bf16 v[200:203], a[232:235], a[156:159], v[200:203]
  ds_read_b64_tr_b16 a[230:231], v235 offset:59392
  s_mov_b32 s41, 4128768
  s_waitcnt lgkmcnt(13)
  v_mfma_f32_16x16x32_bf16 v[108:111], a[192:195], a[128:131], v[108:111]
  ds_read_b64_tr_b16 a[232:233], v236 offset:4096
  s_add_u32 m0, s42, 53248
  v_mfma_f32_16x16x32_bf16 v[108:111], a[196:199], a[144:147], v[108:111]
  s_waitcnt vmcnt(26)
  s_barrier
  v_mfma_f32_16x16x32_bf16 v[140:143], a[192:195], a[132:135], v[140:143]
  buffer_load_dwordx4 v227, s[12:15], s41 offen offset:0 lds
  v_mfma_f32_16x16x32_bf16 v[140:143], a[196:199], a[148:151], v[140:143]
  ds_read_b64_tr_b16 a[234:235], v236 offset:6144
  v_mfma_f32_16x16x32_bf16 v[172:175], a[192:195], a[136:139], v[172:175]
  v_mfma_f32_16x16x32_bf16 v[172:175], a[196:199], a[152:155], v[172:175]
  v_mfma_f32_16x16x32_bf16 v[204:207], a[192:195], a[140:143], v[204:207]
  ds_read_b64_tr_b16 a[192:193], v236 offset:20480
  s_mov_b32 s41, 4358144
  v_mfma_f32_16x16x32_bf16 v[204:207], a[196:199], a[156:159], v[204:207]
  ds_read_b64_tr_b16 a[194:195], v236 offset:22528
  s_add_u32 m0, s42, 57344
  s_load_dwordx2 s[66:67], s[36:37], 0x40000
  v_mfma_f32_16x16x32_bf16 v[112:115], a[200:203], a[128:131], v[112:115]
  buffer_load_dwordx4 v227, s[12:15], s41 offen offset:0 lds
  s_waitcnt lgkmcnt(13)
  v_mfma_f32_16x16x32_bf16 v[112:115], a[204:207], a[144:147], v[112:115]
  ds_read_b64_tr_b16 a[196:197], v237 offset:4096
  ds_read_b64_tr_b16 a[198:199], v237 offset:6144
  v_mfma_f32_16x16x32_bf16 v[144:147], a[200:203], a[132:135], v[144:147]
  v_mfma_f32_16x16x32_bf16 v[144:147], a[204:207], a[148:151], v[144:147]
  v_mfma_f32_16x16x32_bf16 v[176:179], a[200:203], a[136:139], v[176:179]
L_wk1_3:
  s_cbranch_vccnz L_wk1_7
  v_mfma_f32_16x16x32_bf16 v[176:179], a[204:207], a[152:155], v[176:179]
  v_mfma_f32_16x16x32_bf16 v[208:211], a[200:203], a[140:143], v[208:211]
  ds_read_b64_tr_b16 a[200:201], v237 offset:20480
  v_mfma_f32_16x16x32_bf16 v[208:211], a[204:207], a[156:159], v[208:211]
  ds_read_b64_tr_b16 a[202:203], v237 offset:22528
  s_mov_b32 s41, 4128768
  v_mfma_f32_16x16x32_bf16 v[116:119], a[208:211], a[128:131], v[116:119]
  ds_read_b64_tr_b16 a[204:205], v236 offset:16384
  s_add_u32 m0, s42, 65536
  s_waitcnt lgkmcnt(13)
  v_mfma_f32_16x16x32_bf16 v[116:119], a[212:215], a[144:147], v[116:119]
  buffer_load_dwordx4 v227, s[16:19], s41 offen offset:0 lds
  v_mfma_f32_16x16x32_bf16 v[148:151], a[208:211], a[132:135], v[148:151]
  ds_read_b64_tr_b16 a[206:207], v236 offset:18432
  v_mfma_f32_16x16x32_bf16 v[148:151], a[212:215], a[148:151], v[148:151]
  v_mfma_f32_16x16x32_bf16 v[180:183], a[208:211], a[136:139], v[180:183]
  v_mfma_f32_16x16x32_bf16 v[180:183], a[212:215], a[152:155], v[180:183]
  v_mfma_f32_16x16x32_bf16 v[212:215], a[208:211], a[140:143], v[212:215]
  ds_read_b64_tr_b16 a[208:209], v236 offset:28672
  s_mov_b32 s41, 4358144
  v_mfma_f32_16x16x32_bf16 v[212:215], a[212:215], a[156:159], v[212:215]
  ds_read_b64_tr_b16 a[210:211], v236 offset:30720
  s_add_u32 m0, s42, 94208
  v_mfma_f32_16x16x32_bf16 v[120:123], a[216:219], a[128:131], v[120:123]
  buffer_load_dwordx4 v227, s[16:19], s41 offen offset:0 lds
  v_mfma_f32_16x16x32_bf16 v[120:123], a[220:223], a[144:147], v[120:123]
  ds_read_b64_tr_b16 a[212:213], v237 offset:16384
  ds_read_b64_tr_b16 a[214:215], v237 offset:18432
  v_mfma_f32_16x16x32_bf16 v[152:155], a[216:219], a[132:135], v[152:155]
  v_mfma_f32_16x16x32_bf16 v[152:155], a[220:223], a[148:151], v[152:155]
  v_mfma_f32_16x16x32_bf16 v[184:187], a[216:219], a[136:139], v[184:187]
  v_mfma_f32_16x16x32_bf16 v[184:187], a[220:223], a[152:155], v[184:187]
  s_load_dwordx2 s[66:67], s[36:37], 0x60000
  v_mfma_f32_16x16x32_bf16 v[216:219], a[216:219], a[140:143], v[216:219]
  ds_read_b64_tr_b16 a[216:217], v237 offset:28672
  v_mfma_f32_16x16x32_bf16 v[216:219], a[220:223], a[156:159], v[216:219]
  ds_read_b64_tr_b16 a[218:219], v237 offset:30720
  s_waitcnt lgkmcnt(13)
  v_mfma_f32_16x16x32_bf16 v[124:127], a[224:227], a[128:131], v[124:127]
  ds_read_b64_tr_b16 a[220:221], v238 offset:4096
  v_mfma_f32_16x16x32_bf16 v[124:127], a[228:231], a[144:147], v[124:127]
  ds_read_b64_tr_b16 a[222:223], v238 offset:6144
  v_mfma_f32_16x16x32_bf16 v[156:159], a[224:227], a[132:135], v[156:159]
  v_mfma_f32_16x16x32_bf16 v[156:159], a[228:231], a[148:151], v[156:159]
  v_mfma_f32_16x16x32_bf16 v[188:191], a[224:227], a[136:139], v[188:191]
  v_mfma_f32_16x16x32_bf16 v[188:191], a[228:231], a[152:155], v[188:191]
  v_mfma_f32_16x16x32_bf16 v[220:223], a[224:227], a[140:143], v[220:223]
  ds_read_b64_tr_b16 a[224:225], v238 offset:20480
  v_mfma_f32_16x16x32_bf16 v[220:223], a[228:231], a[156:159], v[220:223]
  ds_read_b64_tr_b16 a[226:227], v238 offset:22528
  s_mov_b32 s40, 11796480
  v_mfma_f32_16x16x32_bf16 v[0:3], a[232:235], a[160:163], v[0:3]
  buffer_load_dwordx4 a[32:35], v225, s[4:7], s40 offen offset:0 sc1
  s_waitcnt vmcnt(26) lgkmcnt(13)
  v_mfma_f32_16x16x32_bf16 v[0:3], a[192:195], a[176:179], v[0:3]
  ds_read_b64_tr_b16 a[228:229], v238 offset:16384
  ds_read_b64_tr_b16 a[230:231], v238 offset:18432
  v_mfma_f32_16x16x32_bf16 v[16:19], a[232:235], a[164:167], v[16:19]
  v_mfma_f32_16x16x32_bf16 v[16:19], a[192:195], a[180:183], v[16:19]
  v_mfma_f32_16x16x32_bf16 v[32:35], a[232:235], a[168:171], v[32:35]
  v_mfma_f32_16x16x32_bf16 v[32:35], a[192:195], a[184:187], v[32:35]
  buffer_load_dwordx4 a[36:39], v225, s[4:7], s40 offen offset:1024 sc1
  v_mfma_f32_16x16x32_bf16 v[48:51], a[232:235], a[172:175], v[48:51]
  ds_read_b64_tr_b16 a[232:233], v238 offset:28672
  v_mfma_f32_16x16x32_bf16 v[48:51], a[192:195], a[188:191], v[48:51]
  ds_read_b64_tr_b16 a[234:235], v238 offset:30720
  v_mfma_f32_16x16x32_bf16 v[4:7], a[196:199], a[160:163], v[4:7]
  ds_read_b64_tr_b16 a[192:193], v228 offset:16384
  s_waitcnt lgkmcnt(13)
  v_mfma_f32_16x16x32_bf16 v[4:7], a[200:203], a[176:179], v[4:7]
  ds_read_b64_tr_b16 a[194:195], v228 offset:18432
  v_mfma_f32_16x16x32_bf16 v[20:23], a[196:199], a[164:167], v[20:23]
  v_mfma_f32_16x16x32_bf16 v[20:23], a[200:203], a[180:183], v[20:23]
  buffer_load_dwordx4 a[40:43], v225, s[4:7], s40 offen offset:2048 sc1
  s_load_dwordx2 s[66:67], s[36:37], 0x80000
  v_mfma_f32_16x16x32_bf16 v[36:39], a[196:199], a[168:171], v[36:39]
  v_mfma_f32_16x16x32_bf16 v[36:39], a[200:203], a[184:187], v[36:39]
  v_mfma_f32_16x16x32_bf16 v[52:55], a[196:199], a[172:175], v[52:55]
  ds_read_b64_tr_b16 a[196:197], v228 offset:28672
  v_mfma_f32_16x16x32_bf16 v[52:55], a[200:203], a[188:191], v[52:55]
  ds_read_b64_tr_b16 a[198:199], v228 offset:30720
  v_mfma_f32_16x16x32_bf16 v[8:11], a[204:207], a[160:163], v[8:11]
  ds_read_b64_tr_b16 a[200:201], v229 offset:16384
  v_mfma_f32_16x16x32_bf16 v[8:11], a[208:211], a[176:179], v[8:11]
  s_waitcnt vmcnt(25)
  s_barrier
  v_mfma_f32_16x16x32_bf16 v[24:27], a[204:207], a[164:167], v[24:27]
  buffer_load_dwordx4 a[44:47], v225, s[4:7], s40 offen offset:3072 sc1
  v_mfma_f32_16x16x32_bf16 v[24:27], a[208:211], a[180:183], v[24:27]
  ds_read_b64_tr_b16 a[202:203], v229 offset:18432
  s_mov_b32 s41, 4128768
  v_mfma_f32_16x16x32_bf16 v[40:43], a[204:207], a[168:171], v[40:43]
  s_add_u32 m0, s42, 106496
  v_mfma_f32_16x16x32_bf16 v[40:43], a[208:211], a[184:187], v[40:43]
  v_mfma_f32_16x16x32_bf16 v[56:59], a[204:207], a[172:175], v[56:59]
  ds_read_b64_tr_b16 a[204:205], v229 offset:28672
  v_mfma_f32_16x16x32_bf16 v[56:59], a[208:211], a[188:191], v[56:59]
  buffer_load_dwordx4 v226, s[12:15], s41 offen offset:0 lds
  s_waitcnt lgkmcnt(13)
  v_mfma_f32_16x16x32_bf16 v[12:15], a[212:215], a[160:163], v[12:15]
  ds_read_b64_tr_b16 a[206:207], v229 offset:30720
  s_mov_b32 s41, 4358144
  v_mfma_f32_16x16x32_bf16 v[12:15], a[216:219], a[176:179], v[12:15]
  ds_read_b64_tr_b16 a[208:209], v230 offset:16384
  ds_read_b64_tr_b16 a[210:211], v230 offset:18432
  v_mfma_f32_16x16x32_bf16 v[28:31], a[212:215], a[164:167], v[28:31]
  s_add_u32 m0, s42, 114688
  v_mfma_f32_16x16x32_bf16 v[28:31], a[216:219], a[180:183], v[28:31]
  v_mfma_f32_16x16x32_bf16 v[44:47], a[212:215], a[168:171], v[44:47]
  v_mfma_f32_16x16x32_bf16 v[44:47], a[216:219], a[184:187], v[44:47]
  buffer_load_dwordx4 v226, s[12:15], s41 offen offset:0 lds
  v_mfma_f32_16x16x32_bf16 v[60:63], a[212:215], a[172:175], v[60:63]
  ds_read_b64_tr_b16 a[212:213], v230 offset:28672
  s_mov_b32 s40, 11927552
  v_mfma_f32_16x16x32_bf16 v[60:63], a[216:219], a[188:191], v[60:63]
  ds_read_b64_tr_b16 a[214:215], v230 offset:30720
  s_mov_b32 s78, 6291456
  v_mfma_f32_16x16x32_bf16 v[64:67], a[220:223], a[160:163], v[64:67]
  ds_read_b64_tr_b16 a[216:217], v231 offset:16384
  s_waitcnt lgkmcnt(13)
  v_mfma_f32_16x16x32_bf16 v[64:67], a[224:227], a[176:179], v[64:67]
  ds_read_b64_tr_b16 a[218:219], v231 offset:18432
  s_load_dwordx2 s[66:67], s[36:37], 0xa0000
  v_mfma_f32_16x16x32_bf16 v[72:75], a[220:223], a[164:167], v[72:75]
  buffer_load_dword v241, v247, s[56:59], s78 offen
  v_mfma_f32_16x16x32_bf16 v[72:75], a[224:227], a[180:183], v[72:75]
  v_mfma_f32_16x16x32_bf16 v[80:83], a[220:223], a[168:171], v[80:83]
  buffer_load_dwordx4 a[48:51], v225, s[4:7], s40 offen offset:0 sc1
  v_mfma_f32_16x16x32_bf16 v[80:83], a[224:227], a[184:187], v[80:83]
  v_mfma_f32_16x16x32_bf16 v[88:91], a[220:223], a[172:175], v[88:91]
  ds_read_b64_tr_b16 a[220:221], v231 offset:28672
  v_mfma_f32_16x16x32_bf16 v[88:91], a[224:227], a[188:191], v[88:91]
  ds_read_b64_tr_b16 a[222:223], v231 offset:30720
  v_mfma_f32_16x16x32_bf16 v[68:71], a[228:231], a[160:163], v[68:71]
  ds_read_b64_tr_b16 a[224:225], v236 offset:8192
  v_mfma_f32_16x16x32_bf16 v[68:71], a[232:235], a[176:179], v[68:71]
  buffer_load_dwordx4 a[52:55], v225, s[4:7], s40 offen offset:1024 sc1
  v_mfma_f32_16x16x32_bf16 v[76:79], a[228:231], a[164:167], v[76:79]
  ds_read_b64_tr_b16 a[226:227], v236 offset:10240
  v_mfma_f32_16x16x32_bf16 v[76:79], a[232:235], a[180:183], v[76:79]
  v_mfma_f32_16x16x32_bf16 v[84:87], a[228:231], a[168:171], v[84:87]
  v_mfma_f32_16x16x32_bf16 v[84:87], a[232:235], a[184:187], v[84:87]
  v_mfma_f32_16x16x32_bf16 v[92:95], a[228:231], a[172:175], v[92:95]
  ds_read_b64_tr_b16 a[228:229], v236 offset:24576
  v_mfma_f32_16x16x32_bf16 v[92:95], a[232:235], a[188:191], v[92:95]
  buffer_load_dwordx4 a[56:59], v225, s[4:7], s40 offen offset:2048 sc1
  s_waitcnt lgkmcnt(13)
  v_mfma_f32_16x16x32_bf16 v[96:99], a[192:195], a[160:163], v[96:99]
  ds_read_b64_tr_b16 a[230:231], v236 offset:26624
  v_mfma_f32_16x16x32_bf16 v[96:99], a[196:199], a[176:179], v[96:99]
  ds_read_b64_tr_b16 a[232:233], v237 offset:8192
  ds_read_b64_tr_b16 a[234:235], v237 offset:10240
  v_mfma_f32_16x16x32_bf16 v[128:131], a[192:195], a[164:167], v[128:131]
  v_mfma_f32_16x16x32_bf16 v[128:131], a[196:199], a[180:183], v[128:131]
  v_mfma_f32_16x16x32_bf16 v[160:163], a[192:195], a[168:171], v[160:163]
  v_mfma_f32_16x16x32_bf16 v[160:163], a[196:199], a[184:187], v[160:163]
  buffer_load_dwordx4 a[60:63], v225, s[4:7], s40 offen offset:3072 sc1
  v_mfma_f32_16x16x32_bf16 v[192:195], a[192:195], a[172:175], v[192:195]
  ds_read_b64_tr_b16 a[192:193], v237 offset:24576
  s_mov_b32 s41, 4128768
  v_mfma_f32_16x16x32_bf16 v[192:195], a[196:199], a[188:191], v[192:195]
  ds_read_b64_tr_b16 a[194:195], v237 offset:26624
  s_add_u32 m0, s42, 143360
  s_load_dwordx2 s[66:67], s[36:37], 0xc0000
  v_mfma_f32_16x16x32_bf16 v[100:103], a[200:203], a[160:163], v[100:103]
  ds_read_b64_tr_b16 a[196:197], v238 offset:8192
  s_waitcnt lgkmcnt(13)
  v_mfma_f32_16x16x32_bf16 v[100:103], a[204:207], a[176:179], v[100:103]
  ds_read_b64_tr_b16 a[198:199], v238 offset:10240
  v_mfma_f32_16x16x32_bf16 v[132:135], a[200:203], a[164:167], v[132:135]
  v_mfma_f32_16x16x32_bf16 v[132:135], a[204:207], a[180:183], v[132:135]
  buffer_load_dwordx4 v226, s[16:19], s41 offen offset:0 lds
  v_mfma_f32_16x16x32_bf16 v[164:167], a[200:203], a[168:171], v[164:167]
  s_mov_b32 s41, 4358144
  s_add_u32 m0, s42, 69632
  v_mfma_f32_16x16x32_bf16 v[164:167], a[204:207], a[184:187], v[164:167]
  v_mfma_f32_16x16x32_bf16 v[196:199], a[200:203], a[172:175], v[196:199]
  ds_read_b64_tr_b16 a[200:201], v238 offset:24576
  v_mfma_f32_16x16x32_bf16 v[196:199], a[204:207], a[188:191], v[196:199]
  ds_read_b64_tr_b16 a[202:203], v238 offset:26624
  v_mfma_f32_16x16x32_bf16 v[104:107], a[208:211], a[160:163], v[104:107]
  ds_read_b64_tr_b16 a[204:205], v239 offset:8192
  v_mfma_f32_16x16x32_bf16 v[104:107], a[212:215], a[176:179], v[104:107]
  buffer_load_dwordx4 v226, s[16:19], s41 offen offset:0 lds
  v_mfma_f32_16x16x32_bf16 v[136:139], a[208:211], a[164:167], v[136:139]
  ds_read_b64_tr_b16 a[206:207], v239 offset:10240
  v_mfma_f32_16x16x32_bf16 v[136:139], a[212:215], a[180:183], v[136:139]
  v_mfma_f32_16x16x32_bf16 v[168:171], a[208:211], a[168:171], v[168:171]
  v_mfma_f32_16x16x32_bf16 v[168:171], a[212:215], a[184:187], v[168:171]
  v_mfma_f32_16x16x32_bf16 v[200:203], a[208:211], a[172:175], v[200:203]
  ds_read_b64_tr_b16 a[208:209], v239 offset:24576
  v_mfma_f32_16x16x32_bf16 v[200:203], a[212:215], a[188:191], v[200:203]
  ds_read_b64_tr_b16 a[210:211], v239 offset:26624
  s_mov_b32 s41, 4587520
  s_waitcnt lgkmcnt(13)
  v_mfma_f32_16x16x32_bf16 v[108:111], a[216:219], a[160:163], v[108:111]
  ds_read_b64_tr_b16 a[212:213], v228 offset:20480
  s_add_u32 m0, s42, 81920
  v_mfma_f32_16x16x32_bf16 v[108:111], a[220:223], a[176:179], v[108:111]
  s_waitcnt vmcnt(24)
  s_barrier
  v_mfma_f32_16x16x32_bf16 v[140:143], a[216:219], a[164:167], v[140:143]
  buffer_load_dwordx4 v227, s[12:15], s41 offen offset:0 lds
  v_mfma_f32_16x16x32_bf16 v[140:143], a[220:223], a[180:183], v[140:143]
  ds_read_b64_tr_b16 a[214:215], v228 offset:22528
  v_mfma_f32_16x16x32_bf16 v[172:175], a[216:219], a[168:171], v[172:175]
  v_mfma_f32_16x16x32_bf16 v[172:175], a[220:223], a[184:187], v[172:175]
  s_load_dwordx2 s[66:67], s[36:37], 0xe0000
  s_add_u32 s36, s36, 0x100000
  s_addc_u32 s37, s37, 0
  v_mfma_f32_16x16x32_bf16 v[204:207], a[216:219], a[172:175], v[204:207]
  ds_read_b64_tr_b16 a[216:217], v228 offset:12288
  s_mov_b32 s41, 4816896
  v_mfma_f32_16x16x32_bf16 v[204:207], a[220:223], a[188:191], v[204:207]
  ds_read_b64_tr_b16 a[218:219], v228 offset:14336
  s_add_u32 m0, s42, 61440
  v_mfma_f32_16x16x32_bf16 v[112:115], a[224:227], a[160:163], v[112:115]
  buffer_load_dwordx4 v227, s[12:15], s41 offen offset:0 lds
  s_waitcnt lgkmcnt(13)
  v_mfma_f32_16x16x32_bf16 v[112:115], a[228:231], a[176:179], v[112:115]
  ds_read_b64_tr_b16 a[220:221], v229 offset:20480
  ds_read_b64_tr_b16 a[222:223], v229 offset:22528
  v_mfma_f32_16x16x32_bf16 v[144:147], a[224:227], a[164:167], v[144:147]
  v_mfma_f32_16x16x32_bf16 v[144:147], a[228:231], a[180:183], v[144:147]
  v_mfma_f32_16x16x32_bf16 v[176:179], a[224:227], a[168:171], v[176:179]
  v_mfma_f32_16x16x32_bf16 v[176:179], a[228:231], a[184:187], v[176:179]
  v_mfma_f32_16x16x32_bf16 v[208:211], a[224:227], a[172:175], v[208:211]
  ds_read_b64_tr_b16 a[224:225], v229 offset:12288
  v_mfma_f32_16x16x32_bf16 v[208:211], a[228:231], a[188:191], v[208:211]
  ds_read_b64_tr_b16 a[226:227], v229 offset:14336
  s_mov_b32 s41, 4587520
  v_mfma_f32_16x16x32_bf16 v[116:119], a[232:235], a[160:163], v[116:119]
  ds_read_b64_tr_b16 a[228:229], v228 offset:24576
  s_add_u32 m0, s42, 90112
  s_waitcnt lgkmcnt(13)
  v_mfma_f32_16x16x32_bf16 v[116:119], a[192:195], a[176:179], v[116:119]
  buffer_load_dwordx4 v227, s[16:19], s41 offen offset:0 lds
  v_mfma_f32_16x16x32_bf16 v[148:151], a[232:235], a[164:167], v[148:151]
  ds_read_b64_tr_b16 a[230:231], v228 offset:26624
  v_mfma_f32_16x16x32_bf16 v[148:151], a[192:195], a[180:183], v[148:151]
  v_mfma_f32_16x16x32_bf16 v[180:183], a[232:235], a[168:171], v[180:183]
  v_mfma_f32_16x16x32_bf16 v[180:183], a[192:195], a[184:187], v[180:183]
  v_mfma_f32_16x16x32_bf16 v[212:215], a[232:235], a[172:175], v[212:215]
  ds_read_b64_tr_b16 a[232:233], v228 offset:45056
  s_mov_b32 s41, 4816896
  v_mfma_f32_16x16x32_bf16 v[212:215], a[192:195], a[188:191], v[212:215]
  ds_read_b64_tr_b16 a[234:235], v228 offset:47104
  s_add_u32 m0, s42, 118784
  v_mfma_f32_16x16x32_bf16 v[120:123], a[196:199], a[160:163], v[120:123]
  buffer_load_dwordx4 v227, s[16:19], s41 offen offset:0 lds
  v_mfma_f32_16x16x32_bf16 v[120:123], a[200:203], a[176:179], v[120:123]
  ds_read_b64_tr_b16 a[192:193], v229 offset:24576
  ds_read_b64_tr_b16 a[194:195], v229 offset:26624
  v_mfma_f32_16x16x32_bf16 v[152:155], a[196:199], a[164:167], v[152:155]
  v_mfma_f32_16x16x32_bf16 v[152:155], a[200:203], a[180:183], v[152:155]
  s_load_dwordx2 s[66:67], s[36:37], 0x0
  v_mfma_f32_16x16x32_bf16 v[184:187], a[196:199], a[168:171], v[184:187]
  v_mfma_f32_16x16x32_bf16 v[184:187], a[200:203], a[184:187], v[184:187]
  v_mfma_f32_16x16x32_bf16 v[216:219], a[196:199], a[172:175], v[216:219]
  ds_read_b64_tr_b16 a[196:197], v229 offset:45056
  v_mfma_f32_16x16x32_bf16 v[216:219], a[200:203], a[188:191], v[216:219]
  ds_read_b64_tr_b16 a[198:199], v229 offset:47104
  s_waitcnt lgkmcnt(13)
  v_mfma_f32_16x16x32_bf16 v[124:127], a[204:207], a[160:163], v[124:127]
  ds_read_b64_tr_b16 a[200:201], v230 offset:20480
  v_mfma_f32_16x16x32_bf16 v[124:127], a[208:211], a[176:179], v[124:127]
  ds_read_b64_tr_b16 a[202:203], v230 offset:22528
  v_mfma_f32_16x16x32_bf16 v[156:159], a[204:207], a[164:167], v[156:159]
  v_mfma_f32_16x16x32_bf16 v[156:159], a[208:211], a[180:183], v[156:159]
  v_mfma_f32_16x16x32_bf16 v[188:191], a[204:207], a[168:171], v[188:191]
  v_mfma_f32_16x16x32_bf16 v[188:191], a[208:211], a[184:187], v[188:191]
  v_mfma_f32_16x16x32_bf16 v[220:223], a[204:207], a[172:175], v[220:223]
  ds_read_b64_tr_b16 a[204:205], v230 offset:12288
  v_mfma_f32_16x16x32_bf16 v[220:223], a[208:211], a[188:191], v[220:223]
  ds_read_b64_tr_b16 a[206:207], v230 offset:14336
  s_mov_b32 s40, 12058624
  v_mfma_f32_16x16x32_bf16 v[0:3], a[212:215], a[0:3], v[0:3]
  buffer_load_dwordx4 a[64:67], v225, s[4:7], s40 offen offset:0 sc1
  s_waitcnt vmcnt(25) lgkmcnt(13)
  v_mfma_f32_16x16x32_bf16 v[0:3], a[216:219], a[16:19], v[0:3]
  ds_read_b64_tr_b16 a[208:209], v230 offset:24576
  ds_read_b64_tr_b16 a[210:211], v230 offset:26624
  v_mfma_f32_16x16x32_bf16 v[16:19], a[212:215], a[4:7], v[16:19]
  v_mfma_f32_16x16x32_bf16 v[16:19], a[216:219], a[20:23], v[16:19]
  s_mov_b32 s78, 6815744
  v_mfma_f32_16x16x32_bf16 v[32:35], a[212:215], a[8:11], v[32:35]
  buffer_load_dword v241, v247, s[56:59], s78 offen
  v_mfma_f32_16x16x32_bf16 v[32:35], a[216:219], a[24:27], v[32:35]
  v_mfma_f32_16x16x32_bf16 v[48:51], a[212:215], a[12:15], v[48:51]
  buffer_load_dwordx4 a[68:71], v225, s[4:7], s40 offen offset:1024 sc1
  v_mfma_f32_16x16x32_bf16 v[48:51], a[216:219], a[28:31], v[48:51]
  ds_read_b64_tr_b16 a[212:213], v230 offset:45056
  v_mfma_f32_16x16x32_bf16 v[4:7], a[220:223], a[0:3], v[4:7]
  ds_read_b64_tr_b16 a[214:215], v230 offset:47104
  s_waitcnt lgkmcnt(13)
  v_mfma_f32_16x16x32_bf16 v[4:7], a[224:227], a[16:19], v[4:7]
  ds_read_b64_tr_b16 a[216:217], v228 offset:36864
  ds_read_b64_tr_b16 a[218:219], v228 offset:38912
  s_load_dwordx2 s[66:67], s[36:37], 0x20000
  v_mfma_f32_16x16x32_bf16 v[20:23], a[220:223], a[4:7], v[20:23]
  v_mfma_f32_16x16x32_bf16 v[20:23], a[224:227], a[20:23], v[20:23]
  buffer_load_dwordx4 a[72:75], v225, s[4:7], s40 offen offset:2048 sc1
  v_mfma_f32_16x16x32_bf16 v[36:39], a[220:223], a[8:11], v[36:39]
  v_mfma_f32_16x16x32_bf16 v[36:39], a[224:227], a[24:27], v[36:39]
  v_mfma_f32_16x16x32_bf16 v[52:55], a[220:223], a[12:15], v[52:55]
  ds_read_b64_tr_b16 a[220:221], v228 offset:49152
  v_mfma_f32_16x16x32_bf16 v[52:55], a[224:227], a[28:31], v[52:55]
  ds_read_b64_tr_b16 a[222:223], v228 offset:51200
  v_mfma_f32_16x16x32_bf16 v[8:11], a[228:231], a[0:3], v[8:11]
  ds_read_b64_tr_b16 a[224:225], v229 offset:36864
  s_waitcnt lgkmcnt(13)
  v_mfma_f32_16x16x32_bf16 v[8:11], a[232:235], a[16:19], v[8:11]
  s_waitcnt vmcnt(24)
  s_barrier
  v_mfma_f32_16x16x32_bf16 v[24:27], a[228:231], a[4:7], v[24:27]
  buffer_load_dwordx4 a[76:79], v225, s[4:7], s40 offen offset:3072 sc1
  v_mfma_f32_16x16x32_bf16 v[24:27], a[232:235], a[20:23], v[24:27]
  ds_read_b64_tr_b16 a[226:227], v229 offset:38912
  s_mov_b32 s41, 4587520
  v_mfma_f32_16x16x32_bf16 v[40:43], a[228:231], a[8:11], v[40:43]
  s_add_u32 m0, s42, 131072
  v_mfma_f32_16x16x32_bf16 v[40:43], a[232:235], a[24:27], v[40:43]
  v_mfma_f32_16x16x32_bf16 v[56:59], a[228:231], a[12:15], v[56:59]
  ds_read_b64_tr_b16 a[228:229], v229 offset:49152
  v_mfma_f32_16x16x32_bf16 v[56:59], a[232:235], a[28:31], v[56:59]
  buffer_load_dwordx4 v226, s[12:15], s41 offen offset:0 lds
  v_mfma_f32_16x16x32_bf16 v[12:15], a[192:195], a[0:3], v[12:15]
  ds_read_b64_tr_b16 a[230:231], v229 offset:51200
  s_mov_b32 s41, 4816896
  v_mfma_f32_16x16x32_bf16 v[12:15], a[196:199], a[16:19], v[12:15]
  ds_read_b64_tr_b16 a[232:233], v230 offset:36864
  ds_read_b64_tr_b16 a[234:235], v230 offset:38912
  v_mfma_f32_16x16x32_bf16 v[28:31], a[192:195], a[4:7], v[28:31]
  s_add_u32 m0, s42, 77824
  v_mfma_f32_16x16x32_bf16 v[28:31], a[196:199], a[20:23], v[28:31]
  v_mfma_f32_16x16x32_bf16 v[44:47], a[192:195], a[8:11], v[44:47]
  v_mfma_f32_16x16x32_bf16 v[44:47], a[196:199], a[24:27], v[44:47]
  buffer_load_dwordx4 v226, s[12:15], s41 offen offset:0 lds
  v_mfma_f32_16x16x32_bf16 v[60:63], a[192:195], a[12:15], v[60:63]
  ds_read_b64_tr_b16 a[192:193], v230 offset:49152
  s_mov_b32 s40, 12189696
  v_mfma_f32_16x16x32_bf16 v[60:63], a[196:199], a[28:31], v[60:63]
  ds_read_b64_tr_b16 a[194:195], v230 offset:51200
  s_load_dwordx2 s[66:67], s[36:37], 0x40000
  s_waitcnt lgkmcnt(13)
  v_mfma_f32_16x16x32_bf16 v[64:67], a[200:203], a[0:3], v[64:67]
  ds_read_b64_tr_b16 a[196:197], v231 offset:36864
  v_mfma_f32_16x16x32_bf16 v[64:67], a[204:207], a[16:19], v[64:67]
  ds_read_b64_tr_b16 a[198:199], v231 offset:38912
  v_mfma_f32_16x16x32_bf16 v[72:75], a[200:203], a[4:7], v[72:75]
  v_mfma_f32_16x16x32_bf16 v[72:75], a[204:207], a[20:23], v[72:75]
  buffer_load_dwordx4 a[80:83], v225, s[4:7], s40 offen offset:0 sc1
  v_mfma_f32_16x16x32_bf16 v[80:83], a[200:203], a[8:11], v[80:83]
  v_mfma_f32_16x16x32_bf16 v[80:83], a[204:207], a[24:27], v[80:83]
  v_mfma_f32_16x16x32_bf16 v[88:91], a[200:203], a[12:15], v[88:91]
  ds_read_b64_tr_b16 a[200:201], v231 offset:49152
  v_mfma_f32_16x16x32_bf16 v[88:91], a[204:207], a[28:31], v[88:91]
  ds_read_b64_tr_b16 a[202:203], v231 offset:51200
  v_mfma_f32_16x16x32_bf16 v[68:71], a[208:211], a[0:3], v[68:71]
  ds_read_b64_tr_b16 a[204:205], v228 offset:32768
  s_waitcnt lgkmcnt(13)
  v_mfma_f32_16x16x32_bf16 v[68:71], a[212:215], a[16:19], v[68:71]
  buffer_load_dwordx4 a[84:87], v225, s[4:7], s40 offen offset:1024 sc1
  v_mfma_f32_16x16x32_bf16 v[76:79], a[208:211], a[4:7], v[76:79]
  ds_read_b64_tr_b16 a[206:207], v228 offset:34816
  v_mfma_f32_16x16x32_bf16 v[76:79], a[212:215], a[20:23], v[76:79]
  v_mfma_f32_16x16x32_bf16 v[84:87], a[208:211], a[8:11], v[84:87]
  v_mfma_f32_16x16x32_bf16 v[84:87], a[212:215], a[24:27], v[84:87]
  v_mfma_f32_16x16x32_bf16 v[92:95], a[208:211], a[12:15], v[92:95]
  ds_read_b64_tr_b16 a[208:209], v228 offset:40960
  v_mfma_f32_16x16x32_bf16 v[92:95], a[212:215], a[28:31], v[92:95]
  buffer_load_dwordx4 a[88:91], v225, s[4:7], s40 offen offset:2048 sc1
  v_mfma_f32_16x16x32_bf16 v[96:99], a[216:219], a[0:3], v[96:99]
  ds_read_b64_tr_b16 a[210:211], v228 offset:43008
  v_mfma_f32_16x16x32_bf16 v[96:99], a[220:223], a[16:19], v[96:99]
  ds_read_b64_tr_b16 a[212:213], v229 offset:32768
  ds_read_b64_tr_b16 a[214:215], v229 offset:34816
  v_mfma_f32_16x16x32_bf16 v[128:131], a[216:219], a[4:7], v[128:131]
  v_mfma_f32_16x16x32_bf16 v[128:131], a[220:223], a[20:23], v[128:131]
  v_mfma_f32_16x16x32_bf16 v[160:163], a[216:219], a[8:11], v[160:163]
  v_mfma_f32_16x16x32_bf16 v[160:163], a[220:223], a[24:27], v[160:163]
  buffer_load_dwordx4 a[92:95], v225, s[4:7], s40 offen offset:3072 sc1
  s_load_dwordx2 s[66:67], s[36:37], 0x60000
  v_mfma_f32_16x16x32_bf16 v[192:195], a[216:219], a[12:15], v[192:195]
  ds_read_b64_tr_b16 a[216:217], v229 offset:40960
  s_mov_b32 s41, 4587520
  v_mfma_f32_16x16x32_bf16 v[192:195], a[220:223], a[28:31], v[192:195]
  ds_read_b64_tr_b16 a[218:219], v229 offset:43008
  s_add_u32 m0, s42, 73728
  s_waitcnt lgkmcnt(13)
  v_mfma_f32_16x16x32_bf16 v[100:103], a[224:227], a[0:3], v[100:103]
  ds_read_b64_tr_b16 a[220:221], v230 offset:32768
  v_mfma_f32_16x16x32_bf16 v[100:103], a[228:231], a[16:19], v[100:103]
  ds_read_b64_tr_b16 a[222:223], v230 offset:34816
  v_mfma_f32_16x16x32_bf16 v[132:135], a[224:227], a[4:7], v[132:135]
  v_mfma_f32_16x16x32_bf16 v[132:135], a[228:231], a[20:23], v[132:135]
  buffer_load_dwordx4 v226, s[16:19], s41 offen offset:0 lds
  v_mfma_f32_16x16x32_bf16 v[164:167], a[224:227], a[8:11], v[164:167]
  s_mov_b32 s41, 4816896
  s_add_u32 m0, s42, 86016
  v_mfma_f32_16x16x32_bf16 v[164:167], a[228:231], a[24:27], v[164:167]
  v_mfma_f32_16x16x32_bf16 v[196:199], a[224:227], a[12:15], v[196:199]
  ds_read_b64_tr_b16 a[224:225], v230 offset:40960
  v_mfma_f32_16x16x32_bf16 v[196:199], a[228:231], a[28:31], v[196:199]
  ds_read_b64_tr_b16 a[226:227], v230 offset:43008
  v_mfma_f32_16x16x32_bf16 v[104:107], a[232:235], a[0:3], v[104:107]
  ds_read_b64_tr_b16 a[228:229], v231 offset:32768
  s_waitcnt lgkmcnt(13)
  v_mfma_f32_16x16x32_bf16 v[104:107], a[192:195], a[16:19], v[104:107]
  buffer_load_dwordx4 v226, s[16:19], s41 offen offset:0 lds
  v_mfma_f32_16x16x32_bf16 v[136:139], a[232:235], a[4:7], v[136:139]
  ds_read_b64_tr_b16 a[230:231], v231 offset:34816
  s_mov_b32 s40, 12320768
  v_mfma_f32_16x16x32_bf16 v[136:139], a[192:195], a[20:23], v[136:139]
  v_mfma_f32_16x16x32_bf16 v[168:171], a[232:235], a[8:11], v[168:171]
  v_mfma_f32_16x16x32_bf16 v[168:171], a[192:195], a[24:27], v[168:171]
  v_mfma_f32_16x16x32_bf16 v[200:203], a[232:235], a[12:15], v[200:203]
  ds_read_b64_tr_b16 a[232:233], v231 offset:40960
  v_mfma_f32_16x16x32_bf16 v[200:203], a[192:195], a[28:31], v[200:203]
  buffer_load_dwordx4 a[96:99], v225, s[4:7], s40 offen offset:0 sc1
  v_mfma_f32_16x16x32_bf16 v[108:111], a[196:199], a[0:3], v[108:111]
  ds_read_b64_tr_b16 a[234:235], v231 offset:43008
  v_mfma_f32_16x16x32_bf16 v[108:111], a[200:203], a[16:19], v[108:111]
  s_waitcnt vmcnt(25)
  s_barrier
  v_mfma_f32_16x16x32_bf16 v[140:143], a[196:199], a[4:7], v[140:143]
  ds_read_b64_tr_b16 a[192:193], v228 offset:53248
  ds_read_b64_tr_b16 a[194:195], v228 offset:55296
  v_mfma_f32_16x16x32_bf16 v[140:143], a[200:203], a[20:23], v[140:143]
  s_load_dwordx2 s[66:67], s[36:37], 0x80000
  v_mfma_f32_16x16x32_bf16 v[172:175], a[196:199], a[8:11], v[172:175]
  v_mfma_f32_16x16x32_bf16 v[172:175], a[200:203], a[24:27], v[172:175]
  buffer_load_dwordx4 a[100:103], v225, s[4:7], s40 offen offset:1024 sc1
  v_mfma_f32_16x16x32_bf16 v[204:207], a[196:199], a[12:15], v[204:207]
  ds_read_b64_tr_b16 a[196:197], v228 offset:57344
  v_mfma_f32_16x16x32_bf16 v[204:207], a[200:203], a[28:31], v[204:207]
  ds_read_b64_tr_b16 a[198:199], v228 offset:59392
  s_waitcnt lgkmcnt(13)
  v_mfma_f32_16x16x32_bf16 v[112:115], a[204:207], a[0:3], v[112:115]
  ds_read_b64_tr_b16 a[200:201], v229 offset:53248
  v_mfma_f32_16x16x32_bf16 v[112:115], a[208:211], a[16:19], v[112:115]
  ds_read_b64_tr_b16 a[202:203], v229 offset:55296
  v_mfma_f32_16x16x32_bf16 v[144:147], a[204:207], a[4:7], v[144:147]
  v_mfma_f32_16x16x32_bf16 v[144:147], a[208:211], a[20:23], v[144:147]
  buffer_load_dwordx4 a[104:107], v225, s[4:7], s40 offen offset:2048 sc1
  v_mfma_f32_16x16x32_bf16 v[176:179], a[204:207], a[8:11], v[176:179]
  v_mfma_f32_16x16x32_bf16 v[176:179], a[208:211], a[24:27], v[176:179]
  v_mfma_f32_16x16x32_bf16 v[208:211], a[204:207], a[12:15], v[208:211]
  ds_read_b64_tr_b16 a[204:205], v229 offset:57344
  v_mfma_f32_16x16x32_bf16 v[208:211], a[208:211], a[28:31], v[208:211]
  ds_read_b64_tr_b16 a[206:207], v229 offset:59392
  v_mfma_f32_16x16x32_bf16 v[116:119], a[212:215], a[0:3], v[116:119]
  ds_read_b64_tr_b16 a[208:209], v232 offset:0
  s_waitcnt lgkmcnt(13)
  v_mfma_f32_16x16x32_bf16 v[116:119], a[216:219], a[16:19], v[116:119]
  buffer_load_dwordx4 a[108:111], v225, s[4:7], s40 offen offset:3072 sc1
  v_mfma_f32_16x16x32_bf16 v[148:151], a[212:215], a[4:7], v[148:151]
  ds_read_b64_tr_b16 a[210:211], v232 offset:2048
  s_mov_b32 s41, 5046272
  v_mfma_f32_16x16x32_bf16 v[148:151], a[216:219], a[20:23], v[148:151]
  s_add_u32 m0, s42, 102400
  v_mfma_f32_16x16x32_bf16 v[180:183], a[212:215], a[8:11], v[180:183]
  v_mfma_f32_16x16x32_bf16 v[180:183], a[216:219], a[24:27], v[180:183]
  v_mfma_f32_16x16x32_bf16 v[212:215], a[212:215], a[12:15], v[212:215]
  ds_read_b64_tr_b16 a[212:213], v232 offset:28672
  v_mfma_f32_16x16x32_bf16 v[212:215], a[216:219], a[28:31], v[212:215]
  buffer_load_dwordx4 v227, s[12:15], s41 offen offset:0 lds
  v_mfma_f32_16x16x32_bf16 v[120:123], a[220:223], a[0:3], v[120:123]
  ds_read_b64_tr_b16 a[214:215], v232 offset:30720
  s_mov_b32 s41, 5275648
  v_mfma_f32_16x16x32_bf16 v[120:123], a[224:227], a[16:19], v[120:123]
  ds_read_b64_tr_b16 a[216:217], v233 offset:0
  ds_read_b64_tr_b16 a[218:219], v233 offset:2048
  s_load_dwordx2 s[66:67], s[36:37], 0xa0000
  v_mfma_f32_16x16x32_bf16 v[152:155], a[220:223], a[4:7], v[152:155]
  s_add_u32 m0, s42, 98304
  v_mfma_f32_16x16x32_bf16 v[152:155], a[224:227], a[20:23], v[152:155]
  v_mfma_f32_16x16x32_bf16 v[184:187], a[220:223], a[8:11], v[184:187]
  v_mfma_f32_16x16x32_bf16 v[184:187], a[224:227], a[24:27], v[184:187]
  buffer_load_dwordx4 v227, s[12:15], s41 offen offset:0 lds
  v_mfma_f32_16x16x32_bf16 v[216:219], a[220:223], a[12:15], v[216:219]
  ds_read_b64_tr_b16 a[220:221], v233 offset:28672
  s_mov_b32 s41, 5046272
  v_mfma_f32_16x16x32_bf16 v[216:219], a[224:227], a[28:31], v[216:219]
  ds_read_b64_tr_b16 a[222:223], v233 offset:30720
  s_add_u32 m0, s42, 110592
  s_getpc_b64 s[30:31]
L_pc_28:
  s_lshr_b32 s32, s2, 4
  s_lshl_b32 s32, s32, 2
  s_add_u32 s32, s32, s3
  s_lshl_b32 s32, s32, 13
  v_lshlrev_b32 v244, 7, v224
  v_add_u32 v244, s32, v244
  v_min_u32 v244, L_code_end-L_pc_28-4, v244
  global_load_dword v241, v244, s[30:31]
  s_waitcnt lgkmcnt(13)
  v_mfma_f32_16x16x32_bf16 v[124:127], a[228:231], a[0:3], v[124:127]
  ds_read_b64_tr_b16 a[224:225], v230 offset:53248
  v_mfma_f32_16x16x32_bf16 v[124:127], a[232:235], a[16:19], v[124:127]
  ds_read_b64_tr_b16 a[226:227], v230 offset:55296
  v_mfma_f32_16x16x32_bf16 v[156:159], a[228:231], a[4:7], v[156:159]
  v_mfma_f32_16x16x32_bf16 v[156:159], a[232:235], a[20:23], v[156:159]
  buffer_load_dwordx4 v227, s[16:19], s41 offen offset:0 lds
  v_mfma_f32_16x16x32_bf16 v[188:191], a[228:231], a[8:11], v[188:191]
  s_mov_b32 s41, 5275648
  s_add_u32 m0, s42, 126976
  v_mfma_f32_16x16x32_bf16 v[188:191], a[232:235], a[24:27], v[188:191]
  v_mfma_f32_16x16x32_bf16 v[220:223], a[228:231], a[12:15], v[220:223]
  ds_read_b64_tr_b16 a[228:229], v230 offset:57344
  v_mfma_f32_16x16x32_bf16 v[220:223], a[232:235], a[28:31], v[220:223]
  ds_read_b64_tr_b16 a[230:231], v230 offset:59392
  v_mfma_f32_16x16x32_bf16 v[0:3], a[192:195], a[32:35], v[0:3]
  ds_read_b64_tr_b16 a[232:233], v234 offset:0
  s_waitcnt vmcnt(27) lgkmcnt(13)
  v_mfma_f32_16x16x32_bf16 v[0:3], a[196:199], a[48:51], v[0:3]
  buffer_load_dwordx4 v227, s[16:19], s41 offen offset:0 lds
  v_mfma_f32_16x16x32_bf16 v[16:19], a[192:195], a[36:39], v[16:19]
  ds_read_b64_tr_b16 a[234:235], v234 offset:2048
  s_mov_b32 s41, 5505024
  v_mfma_f32_16x16x32_bf16 v[16:19], a[196:199], a[52:55], v[16:19]
  s_add_u32 m0, s42, 122880
  v_mfma_f32_16x16x32_bf16 v[32:35], a[192:195], a[40:43], v[32:35]
  v_mfma_f32_16x16x32_bf16 v[32:35], a[196:199], a[56:59], v[32:35]
  v_mfma_f32_16x16x32_bf16 v[48:51], a[192:195], a[44:47], v[48:51]
  ds_read_b64_tr_b16 a[192:193], v234 offset:28672
  v_mfma_f32_16x16x32_bf16 v[48:51], a[196:199], a[60:63], v[48:51]
  buffer_load_dwordx4 v227, s[12:15], s41 offen offset:0 lds
  s_load_dwordx2 s[66:67], s[36:37], 0xc0000
  v_mfma_f32_16x16x32_bf16 v[4:7], a[200:203], a[32:35], v[4:7]
  ds_read_b64_tr_b16 a[194:195], v234 offset:30720
  s_mov_b32 s41, 5734400
L_wk1_4:
  s_cbranch_vccnz L_wk1_8
  v_mfma_f32_16x16x32_bf16 v[4:7], a[204:207], a[48:51], v[4:7]
  ds_read_b64_tr_b16 a[196:197], v232 offset:40960
  ds_read_b64_tr_b16 a[198:199], v232 offset:43008
  v_mfma_f32_16x16x32_bf16 v[20:23], a[200:203], a[36:39], v[20:23]
  s_add_u32 m0, s42, 135168
  v_mfma_f32_16x16x32_bf16 v[20:23], a[204:207], a[52:55], v[20:23]
  v_mfma_f32_16x16x32_bf16 v[36:39], a[200:203], a[40:43], v[36:39]
  v_mfma_f32_16x16x32_bf16 v[36:39], a[204:207], a[56:59], v[36:39]
  buffer_load_dwordx4 v227, s[12:15], s41 offen offset:0 lds
  v_mfma_f32_16x16x32_bf16 v[52:55], a[200:203], a[44:47], v[52:55]
  ds_read_b64_tr_b16 a[200:201], v232 offset:49152
  s_mov_b32 s40, 12451840
  v_mfma_f32_16x16x32_bf16 v[52:55], a[204:207], a[60:63], v[52:55]
  ds_read_b64_tr_b16 a[202:203], v232 offset:51200
  s_waitcnt lgkmcnt(13)
  v_mfma_f32_16x16x32_bf16 v[8:11], a[208:211], a[32:35], v[8:11]
  ds_read_b64_tr_b16 a[204:205], v233 offset:40960
  v_mfma_f32_16x16x32_bf16 v[8:11], a[212:215], a[48:51], v[8:11]
  s_waitcnt vmcnt(27)
  s_barrier
  v_mfma_f32_16x16x32_bf16 v[24:27], a[208:211], a[36:39], v[24:27]
  ds_read_b64_tr_b16 a[206:207], v233 offset:43008
  v_mfma_f32_16x16x32_bf16 v[24:27], a[212:215], a[52:55], v[24:27]
  buffer_load_dwordx4 a[112:115], v225, s[4:7], s40 offen offset:0 sc1
  v_mfma_f32_16x16x32_bf16 v[40:43], a[208:211], a[40:43], v[40:43]
  v_mfma_f32_16x16x32_bf16 v[40:43], a[212:215], a[56:59], v[40:43]
  v_mfma_f32_16x16x32_bf16 v[56:59], a[208:211], a[44:47], v[56:59]
  ds_read_b64_tr_b16 a[208:209], v233 offset:49152
  v_mfma_f32_16x16x32_bf16 v[56:59], a[212:215], a[60:63], v[56:59]
  ds_read_b64_tr_b16 a[210:211], v233 offset:51200
  v_mfma_f32_16x16x32_bf16 v[12:15], a[216:219], a[32:35], v[12:15]
  ds_read_b64_tr_b16 a[212:213], v234 offset:40960
  s_waitcnt lgkmcnt(13)
  v_mfma_f32_16x16x32_bf16 v[12:15], a[220:223], a[48:51], v[12:15]
  buffer_load_dwordx4 a[116:119], v225, s[4:7], s40 offen offset:1024 sc1
  v_mfma_f32_16x16x32_bf16 v[28:31], a[216:219], a[36:39], v[28:31]
  ds_read_b64_tr_b16 a[214:215], v234 offset:43008
  v_mfma_f32_16x16x32_bf16 v[28:31], a[220:223], a[52:55], v[28:31]
  v_mfma_f32_16x16x32_bf16 v[44:47], a[216:219], a[40:43], v[44:47]
  v_mfma_f32_16x16x32_bf16 v[44:47], a[220:223], a[56:59], v[44:47]
  s_load_dwordx2 s[66:67], s[36:37], 0xe0000
  s_add_u32 s36, s36, 0x100000
  s_addc_u32 s37, s37, 0
  v_mfma_f32_16x16x32_bf16 v[60:63], a[216:219], a[44:47], v[60:63]
  ds_read_b64_tr_b16 a[216:217], v234 offset:49152
  v_mfma_f32_16x16x32_bf16 v[60:63], a[220:223], a[60:63], v[60:63]
  buffer_load_dwordx4 a[120:123], v225, s[4:7], s40 offen offset:2048 sc1
  v_mfma_f32_16x16x32_bf16 v[64:67], a[224:227], a[32:35], v[64:67]
  ds_read_b64_tr_b16 a[218:219], v234 offset:51200
  v_mfma_f32_16x16x32_bf16 v[64:67], a[228:231], a[48:51], v[64:67]
  ds_read_b64_tr_b16 a[220:221], v235 offset:40960
  ds_read_b64_tr_b16 a[222:223], v235 offset:43008
  v_mfma_f32_16x16x32_bf16 v[72:75], a[224:227], a[36:39], v[72:75]
  v_mfma_f32_16x16x32_bf16 v[72:75], a[228:231], a[52:55], v[72:75]
  v_mfma_f32_16x16x32_bf16 v[80:83], a[224:227], a[40:43], v[80:83]
  v_mfma_f32_16x16x32_bf16 v[80:83], a[228:231], a[56:59], v[80:83]
  buffer_load_dwordx4 a[124:127], v225, s[4:7], s40 offen offset:3072 sc1
  v_mfma_f32_16x16x32_bf16 v[88:91], a[224:227], a[44:47], v[88:91]
  ds_read_b64_tr_b16 a[224:225], v235 offset:49152
  s_mov_b32 s41, 5505024
  v_mfma_f32_16x16x32_bf16 v[88:91], a[228:231], a[60:63], v[88:91]
  ds_read_b64_tr_b16 a[226:227], v235 offset:51200
  s_add_u32 m0, s42, 151552
  s_waitcnt lgkmcnt(13)
  v_mfma_f32_16x16x32_bf16 v[68:71], a[232:235], a[32:35], v[68:71]
  ds_read_b64_tr_b16 a[228:229], v236 offset:12288
  v_mfma_f32_16x16x32_bf16 v[68:71], a[192:195], a[48:51], v[68:71]
  ds_read_b64_tr_b16 a[230:231], v236 offset:14336
  v_mfma_f32_16x16x32_bf16 v[76:79], a[232:235], a[36:39], v[76:79]
  v_mfma_f32_16x16x32_bf16 v[76:79], a[192:195], a[52:55], v[76:79]
  buffer_load_dwordx4 v227, s[16:19], s41 offen offset:0 lds
  v_mfma_f32_16x16x32_bf16 v[84:87], a[232:235], a[40:43], v[84:87]
  s_mov_b32 s41, 5734400
  s_add_u32 m0, s42, 147456
  v_mfma_f32_16x16x32_bf16 v[84:87], a[192:195], a[56:59], v[84:87]
  v_mfma_f32_16x16x32_bf16 v[92:95], a[232:235], a[44:47], v[92:95]
  ds_read_b64_tr_b16 a[232:233], v232 offset:4096
  v_mfma_f32_16x16x32_bf16 v[92:95], a[192:195], a[60:63], v[92:95]
  ds_read_b64_tr_b16 a[234:235], v232 offset:6144
  v_mfma_f32_16x16x32_bf16 v[96:99], a[196:199], a[32:35], v[96:99]
  ds_read_b64_tr_b16 a[192:193], v237 offset:12288
  s_waitcnt lgkmcnt(13)
  v_mfma_f32_16x16x32_bf16 v[96:99], a[200:203], a[48:51], v[96:99]
  buffer_load_dwordx4 v227, s[16:19], s41 offen offset:0 lds
  v_mfma_f32_16x16x32_bf16 v[128:131], a[196:199], a[36:39], v[128:131]
  ds_read_b64_tr_b16 a[194:195], v237 offset:14336
  s_mov_b32 s41, 5963776
  v_mfma_f32_16x16x32_bf16 v[128:131], a[200:203], a[52:55], v[128:131]
  s_add_u32 m0, s42, 159744
  s_load_dwordx2 s[66:67], s[36:37], 0x0
  v_mfma_f32_16x16x32_bf16 v[160:163], a[196:199], a[40:43], v[160:163]
  v_mfma_f32_16x16x32_bf16 v[160:163], a[200:203], a[56:59], v[160:163]
  v_mfma_f32_16x16x32_bf16 v[192:195], a[196:199], a[44:47], v[192:195]
  ds_read_b64_tr_b16 a[196:197], v233 offset:4096
  v_mfma_f32_16x16x32_bf16 v[192:195], a[200:203], a[60:63], v[192:195]
  buffer_load_dwordx4 v227, s[12:15], s41 offen offset:0 lds
  v_mfma_f32_16x16x32_bf16 v[100:103], a[204:207], a[32:35], v[100:103]
  ds_read_b64_tr_b16 a[198:199], v233 offset:6144
  s_mov_b32 s41, 6193152
  v_mfma_f32_16x16x32_bf16 v[100:103], a[208:211], a[48:51], v[100:103]
  ds_read_b64_tr_b16 a[200:201], v238 offset:12288
  ds_read_b64_tr_b16 a[202:203], v238 offset:14336
  v_mfma_f32_16x16x32_bf16 v[132:135], a[204:207], a[36:39], v[132:135]
  s_add_u32 m0, s42, 16384
  v_mfma_f32_16x16x32_bf16 v[132:135], a[208:211], a[52:55], v[132:135]
  v_mfma_f32_16x16x32_bf16 v[164:167], a[204:207], a[40:43], v[164:167]
  v_mfma_f32_16x16x32_bf16 v[164:167], a[208:211], a[56:59], v[164:167]
  buffer_load_dwordx4 v227, s[12:15], s41 offen offset:0 lds
  v_mfma_f32_16x16x32_bf16 v[196:199], a[204:207], a[44:47], v[196:199]
  ds_read_b64_tr_b16 a[204:205], v234 offset:4096
  s_mov_b32 s41, 5963776
  v_mfma_f32_16x16x32_bf16 v[196:199], a[208:211], a[60:63], v[196:199]
  ds_read_b64_tr_b16 a[206:207], v234 offset:6144
  s_add_u32 m0, s42, 28672
  s_waitcnt lgkmcnt(13)
  v_mfma_f32_16x16x32_bf16 v[104:107], a[212:215], a[32:35], v[104:107]
  ds_read_b64_tr_b16 a[208:209], v239 offset:12288
  v_mfma_f32_16x16x32_bf16 v[104:107], a[216:219], a[48:51], v[104:107]
  ds_read_b64_tr_b16 a[210:211], v239 offset:14336
  v_mfma_f32_16x16x32_bf16 v[136:139], a[212:215], a[36:39], v[136:139]
  v_mfma_f32_16x16x32_bf16 v[136:139], a[216:219], a[52:55], v[136:139]
  buffer_load_dwordx4 v227, s[16:19], s41 offen offset:0 lds
  v_mfma_f32_16x16x32_bf16 v[168:171], a[212:215], a[40:43], v[168:171]
  s_mov_b32 s40, 12582912
  v_mfma_f32_16x16x32_bf16 v[168:171], a[216:219], a[56:59], v[168:171]
  v_mfma_f32_16x16x32_bf16 v[200:203], a[212:215], a[44:47], v[200:203]
  ds_read_b64_tr_b16 a[212:213], v235 offset:4096
  v_mfma_f32_16x16x32_bf16 v[200:203], a[216:219], a[60:63], v[200:203]
  ds_read_b64_tr_b16 a[214:215], v235 offset:6144
  v_mfma_f32_16x16x32_bf16 v[108:111], a[220:223], a[32:35], v[108:111]
  ds_read_b64_tr_b16 a[216:217], v232 offset:16384
  s_waitcnt lgkmcnt(13)
  v_mfma_f32_16x16x32_bf16 v[108:111], a[224:227], a[48:51], v[108:111]
  s_waitcnt vmcnt(26)
  s_barrier
  s_load_dwordx2 s[66:67], s[36:37], 0x20000
  v_mfma_f32_16x16x32_bf16 v[140:143], a[220:223], a[36:39], v[140:143]
  buffer_load_dwordx4 a[128:131], v225, s[4:7], s40 offen offset:0 sc1
  v_mfma_f32_16x16x32_bf16 v[140:143], a[224:227], a[52:55], v[140:143]
  ds_read_b64_tr_b16 a[218:219], v232 offset:18432
  v_mfma_f32_16x16x32_bf16 v[172:175], a[220:223], a[40:43], v[172:175]
  v_mfma_f32_16x16x32_bf16 v[172:175], a[224:227], a[56:59], v[172:175]
  v_mfma_f32_16x16x32_bf16 v[204:207], a[220:223], a[44:47], v[204:207]
  ds_read_b64_tr_b16 a[220:221], v228 offset:61440
  v_mfma_f32_16x16x32_bf16 v[204:207], a[224:227], a[60:63], v[204:207]
  buffer_load_dwordx4 a[132:135], v225, s[4:7], s40 offen offset:1024 sc1
  v_mfma_f32_16x16x32_bf16 v[112:115], a[228:231], a[32:35], v[112:115]
  ds_read_b64_tr_b16 a[222:223], v228 offset:63488
  v_mfma_f32_16x16x32_bf16 v[112:115], a[232:235], a[48:51], v[112:115]
  ds_read_b64_tr_b16 a[224:225], v233 offset:16384
  ds_read_b64_tr_b16 a[226:227], v233 offset:18432
  v_mfma_f32_16x16x32_bf16 v[144:147], a[228:231], a[36:39], v[144:147]
  v_mfma_f32_16x16x32_bf16 v[144:147], a[232:235], a[52:55], v[144:147]
  v_mfma_f32_16x16x32_bf16 v[176:179], a[228:231], a[40:43], v[176:179]
  v_mfma_f32_16x16x32_bf16 v[176:179], a[232:235], a[56:59], v[176:179]
  buffer_load_dwordx4 a[136:139], v225, s[4:7], s40 offen offset:2048 sc1
  v_mfma_f32_16x16x32_bf16 v[208:211], a[228:231], a[44:47], v[208:211]
  ds_read_b64_tr_b16 a[228:229], v229 offset:61440
  v_mfma_f32_16x16x32_bf16 v[208:211], a[232:235], a[60:63], v[208:211]
  ds_read_b64_tr_b16 a[230:231], v229 offset:63488
  s_waitcnt lgkmcnt(13)
  v_mfma_f32_16x16x32_bf16 v[116:119], a[192:195], a[32:35], v[116:119]
  ds_read_b64_tr_b16 a[232:233], v232 offset:24576
  v_mfma_f32_16x16x32_bf16 v[116:119], a[196:199], a[48:51], v[116:119]
  ds_read_b64_tr_b16 a[234:235], v232 offset:26624
  v_mfma_f32_16x16x32_bf16 v[148:151], a[192:195], a[36:39], v[148:151]
  v_mfma_f32_16x16x32_bf16 v[148:151], a[196:199], a[52:55], v[148:151]
  buffer_load_dwordx4 a[140:143], v225, s[4:7], s40 offen offset:3072 sc1
  v_mfma_f32_16x16x32_bf16 v[180:183], a[192:195], a[40:43], v[180:183]
  s_mov_b32 s40, 12713984
  v_mfma_f32_16x16x32_bf16 v[180:183], a[196:199], a[56:59], v[180:183]
  v_mfma_f32_16x16x32_bf16 v[212:215], a[192:195], a[44:47], v[212:215]
  ds_read_b64_tr_b16 a[192:193], v232 offset:53248
  v_mfma_f32_16x16x32_bf16 v[212:215], a[196:199], a[60:63], v[212:215]
  ds_read_b64_tr_b16 a[194:195], v232 offset:55296
  s_load_dwordx2 s[66:67], s[36:37], 0x40000
  v_mfma_f32_16x16x32_bf16 v[120:123], a[200:203], a[32:35], v[120:123]
  ds_read_b64_tr_b16 a[196:197], v233 offset:24576
  s_waitcnt lgkmcnt(13)
  v_mfma_f32_16x16x32_bf16 v[120:123], a[204:207], a[48:51], v[120:123]
  buffer_load_dwordx4 a[144:147], v225, s[4:7], s40 offen offset:0 sc1
  v_mfma_f32_16x16x32_bf16 v[152:155], a[200:203], a[36:39], v[152:155]
  ds_read_b64_tr_b16 a[198:199], v233 offset:26624
  v_mfma_f32_16x16x32_bf16 v[152:155], a[204:207], a[52:55], v[152:155]
  v_mfma_f32_16x16x32_bf16 v[184:187], a[200:203], a[40:43], v[184:187]
  v_mfma_f32_16x16x32_bf16 v[184:187], a[204:207], a[56:59], v[184:187]
  v_mfma_f32_16x16x32_bf16 v[216:219], a[200:203], a[44:47], v[216:219]
  ds_read_b64_tr_b16 a[200:201], v233 offset:53248
  v_mfma_f32_16x16x32_bf16 v[216:219], a[204:207], a[60:63], v[216:219]
  buffer_load_dwordx4 a[148:151], v225, s[4:7], s40 offen offset:1024 sc1
  v_mfma_f32_16x16x32_bf16 v[124:127], a[208:211], a[32:35], v[124:127]
  ds_read_b64_tr_b16 a[202:203], v233 offset:55296
  v_mfma_f32_16x16x32_bf16 v[124:127], a[212:215], a[48:51], v[124:127]
  ds_read_b64_tr_b16 a[204:205], v234 offset:16384
  ds_read_b64_tr_b16 a[206:207], v234 offset:18432
  v_mfma_f32_16x16x32_bf16 v[156:159], a[208:211], a[36:39], v[156:159]
  v_mfma_f32_16x16x32_bf16 v[156:159], a[212:215], a[52:55], v[156:159]
  v_mfma_f32_16x16x32_bf16 v[188:191], a[208:211], a[40:43], v[188:191]
  v_mfma_f32_16x16x32_bf16 v[188:191], a[212:215], a[56:59], v[188:191]
  buffer_load_dwordx4 a[152:155], v225, s[4:7], s40 offen offset:2048 sc1
  v_mfma_f32_16x16x32_bf16 v[220:223], a[208:211], a[44:47], v[220:223]
  ds_read_b64_tr_b16 a[208:209], v230 offset:61440
  v_mfma_f32_16x16x32_bf16 v[220:223], a[212:215], a[60:63], v[220:223]
  ds_read_b64_tr_b16 a[210:211], v230 offset:63488
  s_waitcnt lgkmcnt(13)
  v_mfma_f32_16x16x32_bf16 v[0:3], a[216:219], a[64:67], v[0:3]
  ds_read_b64_tr_b16 a[212:213], v234 offset:24576
  s_waitcnt vmcnt(29)
  v_mfma_f32_16x16x32_bf16 v[0:3], a[220:223], a[80:83], v[0:3]
  ds_read_b64_tr_b16 a[214:215], v234 offset:26624
  v_mfma_f32_16x16x32_bf16 v[16:19], a[216:219], a[68:71], v[16:19]
  v_mfma_f32_16x16x32_bf16 v[16:19], a[220:223], a[84:87], v[16:19]
  buffer_load_dwordx4 a[156:159], v225, s[4:7], s40 offen offset:3072 sc1
  v_mfma_f32_16x16x32_bf16 v[32:35], a[216:219], a[72:75], v[32:35]
  s_mov_b32 s41, 6193152
  s_add_u32 m0, s42, 139264
  v_mfma_f32_16x16x32_bf16 v[32:35], a[220:223], a[88:91], v[32:35]
  s_load_dwordx2 s[66:67], s[36:37], 0x60000
  v_mfma_f32_16x16x32_bf16 v[48:51], a[216:219], a[76:79], v[48:51]
  ds_read_b64_tr_b16 a[216:217], v234 offset:53248
  v_mfma_f32_16x16x32_bf16 v[48:51], a[220:223], a[92:95], v[48:51]
  ds_read_b64_tr_b16 a[218:219], v234 offset:55296
  v_mfma_f32_16x16x32_bf16 v[4:7], a[224:227], a[64:67], v[4:7]
  ds_read_b64_tr_b16 a[220:221], v236 offset:0
  s_waitcnt lgkmcnt(13)
  v_mfma_f32_16x16x32_bf16 v[4:7], a[228:231], a[80:83], v[4:7]
  buffer_load_dwordx4 v227, s[16:19], s41 offen offset:0 lds
  v_mfma_f32_16x16x32_bf16 v[20:23], a[224:227], a[68:71], v[20:23]
  ds_read_b64_tr_b16 a[222:223], v236 offset:2048
  s_mov_b32 s41, 6422528
  v_mfma_f32_16x16x32_bf16 v[20:23], a[228:231], a[84:87], v[20:23]
  s_add_u32 m0, s42, 155648
  v_mfma_f32_16x16x32_bf16 v[36:39], a[224:227], a[72:75], v[36:39]
  v_mfma_f32_16x16x32_bf16 v[36:39], a[228:231], a[88:91], v[36:39]
  v_mfma_f32_16x16x32_bf16 v[52:55], a[224:227], a[76:79], v[52:55]
  ds_read_b64_tr_b16 a[224:225], v232 offset:12288
  v_mfma_f32_16x16x32_bf16 v[52:55], a[228:231], a[92:95], v[52:55]
  buffer_load_dwordx4 v227, s[12:15], s41 offen offset:0 lds
  v_mfma_f32_16x16x32_bf16 v[8:11], a[232:235], a[64:67], v[8:11]
  ds_read_b64_tr_b16 a[226:227], v232 offset:14336
  s_mov_b32 s41, 6651904
  v_mfma_f32_16x16x32_bf16 v[8:11], a[192:195], a[80:83], v[8:11]
  s_waitcnt vmcnt(25)
  s_barrier
  v_mfma_f32_16x16x32_bf16 v[24:27], a[232:235], a[68:71], v[24:27]
  ds_read_b64_tr_b16 a[228:229], v237 offset:0
  ds_read_b64_tr_b16 a[230:231], v237 offset:2048
  v_mfma_f32_16x16x32_bf16 v[24:27], a[192:195], a[84:87], v[24:27]
  s_add_u32 m0, s42, 20480
  v_mfma_f32_16x16x32_bf16 v[40:43], a[232:235], a[72:75], v[40:43]
  v_mfma_f32_16x16x32_bf16 v[40:43], a[192:195], a[88:91], v[40:43]
  buffer_load_dwordx4 v227, s[12:15], s41 offen offset:0 lds
  v_mfma_f32_16x16x32_bf16 v[56:59], a[232:235], a[76:79], v[56:59]
  ds_read_b64_tr_b16 a[232:233], v233 offset:12288
  s_mov_b32 s41, 6422528
  v_mfma_f32_16x16x32_bf16 v[56:59], a[192:195], a[92:95], v[56:59]
  ds_read_b64_tr_b16 a[234:235], v233 offset:14336
  s_add_u32 m0, s42, 12288
  s_waitcnt lgkmcnt(13)
  v_mfma_f32_16x16x32_bf16 v[12:15], a[196:199], a[64:67], v[12:15]
  ds_read_b64_tr_b16 a[192:193], v238 offset:0
  v_mfma_f32_16x16x32_bf16 v[12:15], a[200:203], a[80:83], v[12:15]
  ds_read_b64_tr_b16 a[194:195], v238 offset:2048
  v_mfma_f32_16x16x32_bf16 v[28:31], a[196:199], a[68:71], v[28:31]
  v_mfma_f32_16x16x32_bf16 v[28:31], a[200:203], a[84:87], v[28:31]
  buffer_load_dwordx4 v227, s[16:19], s41 offen offset:0 lds
  s_load_dwordx2 s[66:67], s[36:37], 0x80000
  v_mfma_f32_16x16x32_bf16 v[44:47], a[196:199], a[72:75], v[44:47]
  s_mov_b32 s41, 6651904
  s_add_u32 m0, s42, 24576
  v_mfma_f32_16x16x32_bf16 v[44:47], a[200:203], a[88:91], v[44:47]
  v_mfma_f32_16x16x32_bf16 v[60:63], a[196:199], a[76:79], v[60:63]
  ds_read_b64_tr_b16 a[196:197], v234 offset:12288
  v_mfma_f32_16x16x32_bf16 v[60:63], a[200:203], a[92:95], v[60:63]
  ds_read_b64_tr_b16 a[198:199], v234 offset:14336
  v_mfma_f32_16x16x32_bf16 v[64:67], a[204:207], a[64:67], v[64:67]
  ds_read_b64_tr_b16 a[200:201], v239 offset:0
  s_waitcnt lgkmcnt(13)
  v_mfma_f32_16x16x32_bf16 v[64:67], a[208:211], a[80:83], v[64:67]
  buffer_load_dwordx4 v227, s[16:19], s41 offen offset:0 lds
  v_mfma_f32_16x16x32_bf16 v[72:75], a[204:207], a[68:71], v[72:75]
  ds_read_b64_tr_b16 a[202:203], v239 offset:2048
  s_mov_b32 s40, 12845056
  v_mfma_f32_16x16x32_bf16 v[72:75], a[208:211], a[84:87], v[72:75]
  v_mfma_f32_16x16x32_bf16 v[80:83], a[204:207], a[72:75], v[80:83]
  v_mfma_f32_16x16x32_bf16 v[80:83], a[208:211], a[88:91], v[80:83]
  v_mfma_f32_16x16x32_bf16 v[88:91], a[204:207], a[76:79], v[88:91]
  ds_read_b64_tr_b16 a[204:205], v235 offset:12288
  v_mfma_f32_16x16x32_bf16 v[88:91], a[208:211], a[92:95], v[88:91]
  buffer_load_dwordx4 a[160:163], v225, s[4:7], s40 offen offset:0 sc1
  v_mfma_f32_16x16x32_bf16 v[68:71], a[212:215], a[64:67], v[68:71]
  ds_read_b64_tr_b16 a[206:207], v235 offset:14336
  v_mfma_f32_16x16x32_bf16 v[68:71], a[216:219], a[80:83], v[68:71]
  ds_read_b64_tr_b16 a[208:209], v232 offset:8192
  ds_read_b64_tr_b16 a[210:211], v232 offset:10240
  v_mfma_f32_16x16x32_bf16 v[76:79], a[212:215], a[68:71], v[76:79]
  v_mfma_f32_16x16x32_bf16 v[76:79], a[216:219], a[84:87], v[76:79]
  v_mfma_f32_16x16x32_bf16 v[84:87], a[212:215], a[72:75], v[84:87]
  v_mfma_f32_16x16x32_bf16 v[84:87], a[216:219], a[88:91], v[84:87]
  buffer_load_dwordx4 a[164:167], v225, s[4:7], s40 offen offset:1024 sc1
  v_mfma_f32_16x16x32_bf16 v[92:95], a[212:215], a[76:79], v[92:95]
  ds_read_b64_tr_b16 a[212:213], v232 offset:20480
  v_mfma_f32_16x16x32_bf16 v[92:95], a[216:219], a[92:95], v[92:95]
  ds_read_b64_tr_b16 a[214:215], v232 offset:22528
  s_waitcnt lgkmcnt(13)
  v_mfma_f32_16x16x32_bf16 v[96:99], a[220:223], a[64:67], v[96:99]
  ds_read_b64_tr_b16 a[216:217], v233 offset:8192
  v_mfma_f32_16x16x32_bf16 v[96:99], a[224:227], a[80:83], v[96:99]
  ds_read_b64_tr_b16 a[218:219], v233 offset:10240
  s_load_dwordx2 s[66:67], s[36:37], 0xa0000
  v_mfma_f32_16x16x32_bf16 v[128:131], a[220:223], a[68:71], v[128:131]
  v_mfma_f32_16x16x32_bf16 v[128:131], a[224:227], a[84:87], v[128:131]
  buffer_load_dwordx4 a[168:171], v225, s[4:7], s40 offen offset:2048 sc1
  v_mfma_f32_16x16x32_bf16 v[160:163], a[220:223], a[72:75], v[160:163]
  v_mfma_f32_16x16x32_bf16 v[160:163], a[224:227], a[88:91], v[160:163]
  v_mfma_f32_16x16x32_bf16 v[192:195], a[220:223], a[76:79], v[192:195]
  ds_read_b64_tr_b16 a[220:221], v233 offset:20480
  v_mfma_f32_16x16x32_bf16 v[192:195], a[224:227], a[92:95], v[192:195]
  ds_read_b64_tr_b16 a[222:223], v233 offset:22528
  v_mfma_f32_16x16x32_bf16 v[100:103], a[228:231], a[64:67], v[100:103]
  ds_read_b64_tr_b16 a[224:225], v234 offset:8192
  s_waitcnt lgkmcnt(13)
  v_mfma_f32_16x16x32_bf16 v[100:103], a[232:235], a[80:83], v[100:103]
  buffer_load_dwordx4 a[172:175], v225, s[4:7], s40 offen offset:3072 sc1
  v_mfma_f32_16x16x32_bf16 v[132:135], a[228:231], a[68:71], v[132:135]
  ds_read_b64_tr_b16 a[226:227], v234 offset:10240
  s_mov_b32 s40, 12976128
  v_mfma_f32_16x16x32_bf16 v[132:135], a[232:235], a[84:87], v[132:135]
  v_mfma_f32_16x16x32_bf16 v[164:167], a[228:231], a[72:75], v[164:167]
  v_mfma_f32_16x16x32_bf16 v[164:167], a[232:235], a[88:91], v[164:167]
  v_mfma_f32_16x16x32_bf16 v[196:199], a[228:231], a[76:79], v[196:199]
  ds_read_b64_tr_b16 a[228:229], v234 offset:20480
  v_mfma_f32_16x16x32_bf16 v[196:199], a[232:235], a[92:95], v[196:199]
  buffer_load_dwordx4 a[176:179], v225, s[4:7], s40 offen offset:0 sc1
  v_mfma_f32_16x16x32_bf16 v[104:107], a[192:195], a[64:67], v[104:107]
  ds_read_b64_tr_b16 a[230:231], v234 offset:22528
  v_mfma_f32_16x16x32_bf16 v[104:107], a[196:199], a[80:83], v[104:107]
  ds_read_b64_tr_b16 a[232:233], v235 offset:8192
  ds_read_b64_tr_b16 a[234:235], v235 offset:10240
  v_mfma_f32_16x16x32_bf16 v[136:139], a[192:195], a[68:71], v[136:139]
  v_mfma_f32_16x16x32_bf16 v[136:139], a[196:199], a[84:87], v[136:139]
  v_mfma_f32_16x16x32_bf16 v[168:171], a[192:195], a[72:75], v[168:171]
  v_mfma_f32_16x16x32_bf16 v[168:171], a[196:199], a[88:91], v[168:171]
  buffer_load_dwordx4 a[180:183], v225, s[4:7], s40 offen offset:1024 sc1
  v_mfma_f32_16x16x32_bf16 v[200:203], a[192:195], a[76:79], v[200:203]
  ds_read_b64_tr_b16 a[192:193], v235 offset:20480
  v_mfma_f32_16x16x32_bf16 v[200:203], a[196:199], a[92:95], v[200:203]
  ds_read_b64_tr_b16 a[194:195], v235 offset:22528
  s_load_dwordx2 s[66:67], s[36:37], 0xc0000
  s_waitcnt lgkmcnt(13)
  v_mfma_f32_16x16x32_bf16 v[108:111], a[200:203], a[64:67], v[108:111]
  ds_read_b64_tr_b16 a[196:197], v232 offset:36864
  v_mfma_f32_16x16x32_bf16 v[108:111], a[204:207], a[80:83], v[108:111]
  s_waitcnt vmcnt(28)
  s_barrier
  v_mfma_f32_16x16x32_bf16 v[140:143], a[200:203], a[68:71], v[140:143]
  ds_read_b64_tr_b16 a[198:199], v232 offset:38912
  v_mfma_f32_16x16x32_bf16 v[140:143], a[204:207], a[84:87], v[140:143]
  buffer_load_dwordx4 a[184:187], v225, s[4:7], s40 offen offset:2048 sc1
  v_mfma_f32_16x16x32_bf16 v[172:175], a[200:203], a[72:75], v[172:175]
  v_mfma_f32_16x16x32_bf16 v[172:175], a[204:207], a[88:91], v[172:175]
  v_mfma_f32_16x16x32_bf16 v[204:207], a[200:203], a[76:79], v[204:207]
  ds_read_b64_tr_b16 a[200:201], v232 offset:32768
  v_mfma_f32_16x16x32_bf16 v[204:207], a[204:207], a[92:95], v[204:207]
  ds_read_b64_tr_b16 a[202:203], v232 offset:34816
  v_mfma_f32_16x16x32_bf16 v[112:115], a[208:211], a[64:67], v[112:115]
  ds_read_b64_tr_b16 a[204:205], v233 offset:36864
  s_waitcnt lgkmcnt(13)
  v_mfma_f32_16x16x32_bf16 v[112:115], a[212:215], a[80:83], v[112:115]
  buffer_load_dwordx4 a[188:191], v225, s[4:7], s40 offen offset:3072 sc1
  v_mfma_f32_16x16x32_bf16 v[144:147], a[208:211], a[68:71], v[144:147]
  ds_read_b64_tr_b16 a[206:207], v233 offset:38912
  s_mov_b32 s41, 6881280
  v_mfma_f32_16x16x32_bf16 v[144:147], a[212:215], a[84:87], v[144:147]
  s_add_u32 m0, s42, 45056
  v_mfma_f32_16x16x32_bf16 v[176:179], a[208:211], a[72:75], v[176:179]
  v_mfma_f32_16x16x32_bf16 v[176:179], a[212:215], a[88:91], v[176:179]
  v_mfma_f32_16x16x32_bf16 v[208:211], a[208:211], a[76:79], v[208:211]
  ds_read_b64_tr_b16 a[208:209], v233 offset:32768
  v_mfma_f32_16x16x32_bf16 v[208:211], a[212:215], a[92:95], v[208:211]
  buffer_load_dwordx4 v227, s[12:15], s41 offen offset:0 lds
  v_mfma_f32_16x16x32_bf16 v[116:119], a[216:219], a[64:67], v[116:119]
  ds_read_b64_tr_b16 a[210:211], v233 offset:34816
  s_mov_b32 s41, 7110656
  v_mfma_f32_16x16x32_bf16 v[116:119], a[220:223], a[80:83], v[116:119]
  ds_read_b64_tr_b16 a[212:213], v232 offset:45056
  ds_read_b64_tr_b16 a[214:215], v232 offset:47104
  v_mfma_f32_16x16x32_bf16 v[148:151], a[216:219], a[68:71], v[148:151]
  s_add_u32 m0, s42, 36864
  v_mfma_f32_16x16x32_bf16 v[148:151], a[220:223], a[84:87], v[148:151]
  v_mfma_f32_16x16x32_bf16 v[180:183], a[216:219], a[72:75], v[180:183]
  v_mfma_f32_16x16x32_bf16 v[180:183], a[220:223], a[88:91], v[180:183]
  buffer_load_dwordx4 v227, s[12:15], s41 offen offset:0 lds
  s_load_dwordx2 s[66:67], s[36:37], 0xe0000
  v_mfma_f32_16x16x32_bf16 v[212:215], a[216:219], a[76:79], v[212:215]
  ds_read_b64_tr_b16 a[216:217], v232 offset:61440
  s_mov_b32 s41, 6881280
  v_mfma_f32_16x16x32_bf16 v[212:215], a[220:223], a[92:95], v[212:215]
  ds_read_b64_tr_b16 a[218:219], v232 offset:63488
  s_add_u32 m0, s42, 49152
  s_waitcnt lgkmcnt(13)
  v_mfma_f32_16x16x32_bf16 v[120:123], a[224:227], a[64:67], v[120:123]
  ds_read_b64_tr_b16 a[220:221], v233 offset:45056
  v_mfma_f32_16x16x32_bf16 v[120:123], a[228:231], a[80:83], v[120:123]
  ds_read_b64_tr_b16 a[222:223], v233 offset:47104
  v_mfma_f32_16x16x32_bf16 v[152:155], a[224:227], a[68:71], v[152:155]
  v_mfma_f32_16x16x32_bf16 v[152:155], a[228:231], a[84:87], v[152:155]
  buffer_load_dwordx4 v227, s[16:19], s41 offen offset:0 lds
  v_mfma_f32_16x16x32_bf16 v[184:187], a[224:227], a[72:75], v[184:187]
  s_mov_b32 s41, 7110656
  s_add_u32 m0, s42, 32768
  v_mfma_f32_16x16x32_bf16 v[184:187], a[228:231], a[88:91], v[184:187]
  v_mfma_f32_16x16x32_bf16 v[216:219], a[224:227], a[76:79], v[216:219]
  ds_read_b64_tr_b16 a[224:225], v233 offset:61440
  v_mfma_f32_16x16x32_bf16 v[216:219], a[228:231], a[92:95], v[216:219]
  ds_read_b64_tr_b16 a[226:227], v233 offset:63488
  v_mfma_f32_16x16x32_bf16 v[124:127], a[232:235], a[64:67], v[124:127]
  ds_read_b64_tr_b16 a[228:229], v234 offset:36864
  s_waitcnt lgkmcnt(13)
  v_mfma_f32_16x16x32_bf16 v[124:127], a[192:195], a[80:83], v[124:127]
  buffer_load_dwordx4 v227, s[16:19], s41 offen offset:0 lds
  v_mfma_f32_16x16x32_bf16 v[156:159], a[232:235], a[68:71], v[156:159]
  ds_read_b64_tr_b16 a[230:231], v234 offset:38912
  s_mov_b32 s40, 13107200
  v_mfma_f32_16x16x32_bf16 v[156:159], a[192:195], a[84:87], v[156:159]
  v_mfma_f32_16x16x32_bf16 v[188:191], a[232:235], a[72:75], v[188:191]
  v_mfma_f32_16x16x32_bf16 v[188:191], a[192:195], a[88:91], v[188:191]
  v_mfma_f32_16x16x32_bf16 v[220:223], a[232:235], a[76:79], v[220:223]
  ds_read_b64_tr_b16 a[232:233], v234 offset:32768
  v_mfma_f32_16x16x32_bf16 v[220:223], a[192:195], a[92:95], v[220:223]
  buffer_load_dwordx4 a[0:3], v225, s[4:7], s40 offen offset:0 sc1
  v_mfma_f32_16x16x32_bf16 v[0:3], a[196:199], a[96:99], v[0:3]
  ds_read_b64_tr_b16 a[234:235], v234 offset:34816
  s_waitcnt vmcnt(31)
  v_mfma_f32_16x16x32_bf16 v[0:3], a[200:203], a[112:115], v[0:3]
  ds_read_b64_tr_b16 a[192:193], v234 offset:45056
  ds_read_b64_tr_b16 a[194:195], v234 offset:47104
  v_mfma_f32_16x16x32_bf16 v[16:19], a[196:199], a[100:103], v[16:19]
  v_mfma_f32_16x16x32_bf16 v[16:19], a[200:203], a[116:119], v[16:19]
  v_mfma_f32_16x16x32_bf16 v[32:35], a[196:199], a[104:107], v[32:35]
  v_mfma_f32_16x16x32_bf16 v[32:35], a[200:203], a[120:123], v[32:35]
  buffer_load_dwordx4 a[4:7], v225, s[4:7], s40 offen offset:1024 sc1
  v_mfma_f32_16x16x32_bf16 v[48:51], a[196:199], a[108:111], v[48:51]
  ds_read_b64_tr_b16 a[196:197], v234 offset:61440
  v_mfma_f32_16x16x32_bf16 v[48:51], a[200:203], a[124:127], v[48:51]
  ds_read_b64_tr_b16 a[198:199], v234 offset:63488
  s_waitcnt lgkmcnt(13)
  v_mfma_f32_16x16x32_bf16 v[4:7], a[204:207], a[96:99], v[4:7]
  ds_read_b64_tr_b16 a[200:201], v232 offset:57344
  v_mfma_f32_16x16x32_bf16 v[4:7], a[208:211], a[112:115], v[4:7]
  ds_read_b64_tr_b16 a[202:203], v232 offset:59392
  v_mfma_f32_16x16x32_bf16 v[20:23], a[204:207], a[100:103], v[20:23]
  v_mfma_f32_16x16x32_bf16 v[20:23], a[208:211], a[116:119], v[20:23]
  buffer_load_dwordx4 a[8:11], v225, s[4:7], s40 offen offset:2048 sc1
  v_mfma_f32_16x16x32_bf16 v[36:39], a[204:207], a[104:107], v[36:39]
  v_mfma_f32_16x16x32_bf16 v[36:39], a[208:211], a[120:123], v[36:39]
  v_mfma_f32_16x16x32_bf16 v[52:55], a[204:207], a[108:111], v[52:55]
  ds_read_b64_tr_b16 a[204:205], v236 offset:4096
  v_mfma_f32_16x16x32_bf16 v[52:55], a[208:211], a[124:127], v[52:55]
  ds_read_b64_tr_b16 a[206:207], v236 offset:6144
  v_mfma_f32_16x16x32_bf16 v[8:11], a[212:215], a[96:99], v[8:11]
  ds_read_b64_tr_b16 a[208:209], v233 offset:57344
  s_waitcnt lgkmcnt(13)
  v_mfma_f32_16x16x32_bf16 v[8:11], a[216:219], a[112:115], v[8:11]
  s_waitcnt vmcnt(28)
  s_barrier
  v_mfma_f32_16x16x32_bf16 v[24:27], a[212:215], a[100:103], v[24:27]
  buffer_load_dwordx4 a[12:15], v225, s[4:7], s40 offen offset:3072 sc1
  v_mfma_f32_16x16x32_bf16 v[24:27], a[216:219], a[116:119], v[24:27]
  ds_read_b64_tr_b16 a[210:211], v233 offset:59392
  s_mov_b32 s40, 13238272
  v_mfma_f32_16x16x32_bf16 v[40:43], a[212:215], a[104:107], v[40:43]
  v_mfma_f32_16x16x32_bf16 v[40:43], a[216:219], a[120:123], v[40:43]
  v_mfma_f32_16x16x32_bf16 v[56:59], a[212:215], a[108:111], v[56:59]
  ds_read_b64_tr_b16 a[212:213], v237 offset:4096
  v_mfma_f32_16x16x32_bf16 v[56:59], a[216:219], a[124:127], v[56:59]
  buffer_load_dwordx4 a[16:19], v225, s[4:7], s40 offen offset:0 sc1
  v_mfma_f32_16x16x32_bf16 v[12:15], a[220:223], a[96:99], v[12:15]
  ds_read_b64_tr_b16 a[214:215], v237 offset:6144
  v_mfma_f32_16x16x32_bf16 v[12:15], a[224:227], a[112:115], v[12:15]
  ds_read_b64_tr_b16 a[216:217], v236 offset:20480
  ds_read_b64_tr_b16 a[218:219], v236 offset:22528
  v_mfma_f32_16x16x32_bf16 v[28:31], a[220:223], a[100:103], v[28:31]
  v_mfma_f32_16x16x32_bf16 v[28:31], a[224:227], a[116:119], v[28:31]
  v_mfma_f32_16x16x32_bf16 v[44:47], a[220:223], a[104:107], v[44:47]
  v_mfma_f32_16x16x32_bf16 v[44:47], a[224:227], a[120:123], v[44:47]
  buffer_load_dwordx4 a[20:23], v225, s[4:7], s40 offen offset:1024 sc1
  v_mfma_f32_16x16x32_bf16 v[60:63], a[220:223], a[108:111], v[60:63]
  ds_read_b64_tr_b16 a[220:221], v236 offset:16384
  v_mfma_f32_16x16x32_bf16 v[60:63], a[224:227], a[124:127], v[60:63]
  ds_read_b64_tr_b16 a[222:223], v236 offset:18432
  s_waitcnt lgkmcnt(13)
  v_mfma_f32_16x16x32_bf16 v[64:67], a[228:231], a[96:99], v[64:67]
  ds_read_b64_tr_b16 a[224:225], v237 offset:20480
  v_mfma_f32_16x16x32_bf16 v[64:67], a[232:235], a[112:115], v[64:67]
  ds_read_b64_tr_b16 a[226:227], v237 offset:22528
  v_mfma_f32_16x16x32_bf16 v[72:75], a[228:231], a[100:103], v[72:75]
  v_mfma_f32_16x16x32_bf16 v[72:75], a[232:235], a[116:119], v[72:75]
  buffer_load_dwordx4 a[24:27], v225, s[4:7], s40 offen offset:2048 sc1
  v_mfma_f32_16x16x32_bf16 v[80:83], a[228:231], a[104:107], v[80:83]
  v_mfma_f32_16x16x32_bf16 v[80:83], a[232:235], a[120:123], v[80:83]
  v_mfma_f32_16x16x32_bf16 v[88:91], a[228:231], a[108:111], v[88:91]
  ds_read_b64_tr_b16 a[228:229], v237 offset:16384
  v_mfma_f32_16x16x32_bf16 v[88:91], a[232:235], a[124:127], v[88:91]
  ds_read_b64_tr_b16 a[230:231], v237 offset:18432
  v_mfma_f32_16x16x32_bf16 v[68:71], a[192:195], a[96:99], v[68:71]
  ds_read_b64_tr_b16 a[232:233], v234 offset:57344
  s_waitcnt lgkmcnt(13)
  v_mfma_f32_16x16x32_bf16 v[68:71], a[196:199], a[112:115], v[68:71]
  buffer_load_dwordx4 a[28:31], v225, s[4:7], s40 offen offset:3072 sc1
  v_mfma_f32_16x16x32_bf16 v[76:79], a[192:195], a[100:103], v[76:79]
  ds_read_b64_tr_b16 a[234:235], v234 offset:59392
  s_mov_b32 s41, 5046272
  v_mfma_f32_16x16x32_bf16 v[76:79], a[196:199], a[116:119], v[76:79]
  s_add_u32 m0, s42, 40960
  v_mfma_f32_16x16x32_bf16 v[84:87], a[192:195], a[104:107], v[84:87]
  v_mfma_f32_16x16x32_bf16 v[84:87], a[196:199], a[120:123], v[84:87]
  v_mfma_f32_16x16x32_bf16 v[92:95], a[192:195], a[108:111], v[92:95]
  ds_read_b64_tr_b16 a[192:193], v238 offset:4096
  v_mfma_f32_16x16x32_bf16 v[92:95], a[196:199], a[124:127], v[92:95]
  buffer_load_dwordx4 v226, s[12:15], s41 offen offset:0 lds
  s_waitcnt vmcnt(30)
  v_mfma_f32_16x16x32_bf16 v[0:3], a[200:203], a[128:131], v[0:3]
  ds_read_b64_tr_b16 a[194:195], v238 offset:6144
  s_mov_b32 s41, 5275648
  s_waitcnt vmcnt(26)
  v_mfma_f32_16x16x32_bf16 v[0:3], a[204:207], a[144:147], v[0:3]
  ds_read_b64_tr_b16 a[196:197], v238 offset:20480
  ds_read_b64_tr_b16 a[198:199], v238 offset:22528
  v_mfma_f32_16x16x32_bf16 v[16:19], a[200:203], a[132:135], v[16:19]
L_wk1_5:
  s_cbranch_vccnz L_wk1_9
  s_add_u32 m0, s42, 53248
  v_mfma_f32_16x16x32_bf16 v[16:19], a[204:207], a[148:151], v[16:19]
  v_mfma_f32_16x16x32_bf16 v[32:35], a[200:203], a[136:139], v[32:35]
  v_mfma_f32_16x16x32_bf16 v[32:35], a[204:207], a[152:155], v[32:35]
  buffer_load_dwordx4 v226, s[12:15], s41 offen offset:0 lds
  v_mfma_f32_16x16x32_bf16 v[48:51], a[200:203], a[140:143], v[48:51]
  ds_read_b64_tr_b16 a[200:201], v238 offset:16384
  s_mov_b32 s41, 5046272
  v_mfma_f32_16x16x32_bf16 v[48:51], a[204:207], a[156:159], v[48:51]
  ds_read_b64_tr_b16 a[202:203], v238 offset:18432
  s_add_u32 m0, s42, 57344
  s_waitcnt lgkmcnt(13)
  v_mfma_f32_16x16x32_bf16 v[4:7], a[208:211], a[128:131], v[4:7]
  ds_read_b64_tr_b16 a[204:205], v236 offset:28672
  v_mfma_f32_16x16x32_bf16 v[4:7], a[212:215], a[144:147], v[4:7]
  ds_read_b64_tr_b16 a[206:207], v236 offset:30720
  v_mfma_f32_16x16x32_bf16 v[20:23], a[208:211], a[132:135], v[20:23]
  v_mfma_f32_16x16x32_bf16 v[20:23], a[212:215], a[148:151], v[20:23]
  buffer_load_dwordx4 v226, s[16:19], s41 offen offset:0 lds
  v_mfma_f32_16x16x32_bf16 v[36:39], a[208:211], a[136:139], v[36:39]
  s_mov_b32 s41, 5275648
  s_add_u32 m0, s42, 65536
  v_mfma_f32_16x16x32_bf16 v[36:39], a[212:215], a[152:155], v[36:39]
  v_mfma_f32_16x16x32_bf16 v[52:55], a[208:211], a[140:143], v[52:55]
  ds_read_b64_tr_b16 a[208:209], v228 offset:16384
  v_mfma_f32_16x16x32_bf16 v[52:55], a[212:215], a[156:159], v[52:55]
  ds_read_b64_tr_b16 a[210:211], v228 offset:18432
  v_mfma_f32_16x16x32_bf16 v[8:11], a[216:219], a[128:131], v[8:11]
  ds_read_b64_tr_b16 a[212:213], v237 offset:28672
  s_waitcnt lgkmcnt(13)
  v_mfma_f32_16x16x32_bf16 v[8:11], a[220:223], a[144:147], v[8:11]
  buffer_load_dwordx4 v226, s[16:19], s41 offen offset:0 lds
  v_mfma_f32_16x16x32_bf16 v[24:27], a[216:219], a[132:135], v[24:27]
  ds_read_b64_tr_b16 a[214:215], v237 offset:30720
  s_mov_b32 s41, 5505024
  v_mfma_f32_16x16x32_bf16 v[24:27], a[220:223], a[148:151], v[24:27]
  s_add_u32 m0, s42, 94208
  v_mfma_f32_16x16x32_bf16 v[40:43], a[216:219], a[136:139], v[40:43]
  v_mfma_f32_16x16x32_bf16 v[40:43], a[220:223], a[152:155], v[40:43]
  v_mfma_f32_16x16x32_bf16 v[56:59], a[216:219], a[140:143], v[56:59]
  ds_read_b64_tr_b16 a[216:217], v229 offset:16384
  v_mfma_f32_16x16x32_bf16 v[56:59], a[220:223], a[156:159], v[56:59]
  buffer_load_dwordx4 v226, s[12:15], s41 offen offset:0 lds
  v_mfma_f32_16x16x32_bf16 v[12:15], a[224:227], a[128:131], v[12:15]
  ds_read_b64_tr_b16 a[218:219], v229 offset:18432
  s_mov_b32 s41, 5734400
  v_mfma_f32_16x16x32_bf16 v[12:15], a[228:231], a[144:147], v[12:15]
  s_waitcnt vmcnt(25)
  s_barrier
  v_mfma_f32_16x16x32_bf16 v[28:31], a[224:227], a[132:135], v[28:31]
  ds_read_b64_tr_b16 a[220:221], v228 offset:28672
  ds_read_b64_tr_b16 a[222:223], v228 offset:30720
  v_mfma_f32_16x16x32_bf16 v[28:31], a[228:231], a[148:151], v[28:31]
  s_add_u32 m0, s42, 106496
  v_mfma_f32_16x16x32_bf16 v[44:47], a[224:227], a[136:139], v[44:47]
  v_mfma_f32_16x16x32_bf16 v[44:47], a[228:231], a[152:155], v[44:47]
  buffer_load_dwordx4 v226, s[12:15], s41 offen offset:0 lds
  v_mfma_f32_16x16x32_bf16 v[60:63], a[224:227], a[140:143], v[60:63]
  ds_read_b64_tr_b16 a[224:225], v236 offset:8192
  s_mov_b32 s40, 13369344
  v_mfma_f32_16x16x32_bf16 v[60:63], a[228:231], a[156:159], v[60:63]
  ds_read_b64_tr_b16 a[226:227], v236 offset:10240
  s_waitcnt lgkmcnt(13)
  v_mfma_f32_16x16x32_bf16 v[64:67], a[232:235], a[128:131], v[64:67]
  ds_read_b64_tr_b16 a[228:229], v229 offset:28672
  v_mfma_f32_16x16x32_bf16 v[64:67], a[192:195], a[144:147], v[64:67]
  ds_read_b64_tr_b16 a[230:231], v229 offset:30720
  v_mfma_f32_16x16x32_bf16 v[72:75], a[232:235], a[132:135], v[72:75]
  v_mfma_f32_16x16x32_bf16 v[72:75], a[192:195], a[148:151], v[72:75]
  buffer_load_dwordx4 a[32:35], v225, s[4:7], s40 offen offset:0 sc1
  v_mfma_f32_16x16x32_bf16 v[80:83], a[232:235], a[136:139], v[80:83]
  v_mfma_f32_16x16x32_bf16 v[80:83], a[192:195], a[152:155], v[80:83]
  v_mfma_f32_16x16x32_bf16 v[88:91], a[232:235], a[140:143], v[88:91]
  ds_read_b64_tr_b16 a[232:233], v237 offset:8192
  v_mfma_f32_16x16x32_bf16 v[88:91], a[192:195], a[156:159], v[88:91]
  ds_read_b64_tr_b16 a[234:235], v237 offset:10240
  v_mfma_f32_16x16x32_bf16 v[68:71], a[196:199], a[128:131], v[68:71]
  ds_read_b64_tr_b16 a[192:193], v238 offset:28672
  s_waitcnt lgkmcnt(13)
  v_mfma_f32_16x16x32_bf16 v[68:71], a[200:203], a[144:147], v[68:71]
  buffer_load_dwordx4 a[36:39], v225, s[4:7], s40 offen offset:1024 sc1
  v_mfma_f32_16x16x32_bf16 v[76:79], a[196:199], a[132:135], v[76:79]
  ds_read_b64_tr_b16 a[194:195], v238 offset:30720
  v_mfma_f32_16x16x32_bf16 v[76:79], a[200:203], a[148:151], v[76:79]
  v_mfma_f32_16x16x32_bf16 v[84:87], a[196:199], a[136:139], v[84:87]
  v_mfma_f32_16x16x32_bf16 v[84:87], a[200:203], a[152:155], v[84:87]
  v_mfma_f32_16x16x32_bf16 v[92:95], a[196:199], a[140:143], v[92:95]
  ds_read_b64_tr_b16 a[196:197], v230 offset:16384
  v_mfma_f32_16x16x32_bf16 v[92:95], a[200:203], a[156:159], v[92:95]
  buffer_load_dwordx4 a[40:43], v225, s[4:7], s40 offen offset:2048 sc1
  s_waitcnt vmcnt(25)
  v_mfma_f32_16x16x32_bf16 v[0:3], a[204:207], a[160:163], v[0:3]
  ds_read_b64_tr_b16 a[198:199], v230 offset:18432
  s_waitcnt vmcnt(21)
  v_mfma_f32_16x16x32_bf16 v[0:3], a[208:211], a[176:179], v[0:3]
  ds_read_b64_tr_b16 a[200:201], v230 offset:28672
  ds_read_b64_tr_b16 a[202:203], v230 offset:30720
  v_mfma_f32_16x16x32_bf16 v[16:19], a[204:207], a[164:167], v[16:19]
  v_mfma_f32_16x16x32_bf16 v[16:19], a[208:211], a[180:183], v[16:19]
  v_mfma_f32_16x16x32_bf16 v[32:35], a[204:207], a[168:171], v[32:35]
  v_mfma_f32_16x16x32_bf16 v[32:35], a[208:211], a[184:187], v[32:35]
  buffer_load_dwordx4 a[44:47], v225, s[4:7], s40 offen offset:3072 sc1
  v_mfma_f32_16x16x32_bf16 v[48:51], a[204:207], a[172:175], v[48:51]
  ds_read_b64_tr_b16 a[204:205], v238 offset:8192
  s_mov_b32 s40, 13500416
  v_mfma_f32_16x16x32_bf16 v[48:51], a[208:211], a[188:191], v[48:51]
  ds_read_b64_tr_b16 a[206:207], v238 offset:10240
  s_waitcnt lgkmcnt(13)
  v_mfma_f32_16x16x32_bf16 v[4:7], a[212:215], a[160:163], v[4:7]
  ds_read_b64_tr_b16 a[208:209], v236 offset:24576
  v_mfma_f32_16x16x32_bf16 v[4:7], a[216:219], a[176:179], v[4:7]
  ds_read_b64_tr_b16 a[210:211], v236 offset:26624
  v_mfma_f32_16x16x32_bf16 v[20:23], a[212:215], a[164:167], v[20:23]
  v_mfma_f32_16x16x32_bf16 v[20:23], a[216:219], a[180:183], v[20:23]
  buffer_load_dwordx4 a[48:51], v225, s[4:7], s40 offen offset:0 sc1
  v_mfma_f32_16x16x32_bf16 v[36:39], a[212:215], a[168:171], v[36:39]
  v_mfma_f32_16x16x32_bf16 v[36:39], a[216:219], a[184:187], v[36:39]
  v_mfma_f32_16x16x32_bf16 v[52:55], a[212:215], a[172:175], v[52:55]
  ds_read_b64_tr_b16 a[212:213], v228 offset:20480
  v_mfma_f32_16x16x32_bf16 v[52:55], a[216:219], a[188:191], v[52:55]
  ds_read_b64_tr_b16 a[214:215], v228 offset:22528
  v_mfma_f32_16x16x32_bf16 v[8:11], a[220:223], a[160:163], v[8:11]
  ds_read_b64_tr_b16 a[216:217], v237 offset:24576
  s_waitcnt lgkmcnt(13)
  v_mfma_f32_16x16x32_bf16 v[8:11], a[224:227], a[176:179], v[8:11]
  buffer_load_dwordx4 a[52:55], v225, s[4:7], s40 offen offset:1024 sc1
  v_mfma_f32_16x16x32_bf16 v[24:27], a[220:223], a[164:167], v[24:27]
  ds_read_b64_tr_b16 a[218:219], v237 offset:26624
  v_mfma_f32_16x16x32_bf16 v[24:27], a[224:227], a[180:183], v[24:27]
  v_mfma_f32_16x16x32_bf16 v[40:43], a[220:223], a[168:171], v[40:43]
  v_mfma_f32_16x16x32_bf16 v[40:43], a[224:227], a[184:187], v[40:43]
  v_mfma_f32_16x16x32_bf16 v[56:59], a[220:223], a[172:175], v[56:59]
  ds_read_b64_tr_b16 a[220:221], v229 offset:20480
  v_mfma_f32_16x16x32_bf16 v[56:59], a[224:227], a[188:191], v[56:59]
  buffer_load_dwordx4 a[56:59], v225, s[4:7], s40 offen offset:2048 sc1
  v_mfma_f32_16x16x32_bf16 v[12:15], a[228:231], a[160:163], v[12:15]
  ds_read_b64_tr_b16 a[222:223], v229 offset:22528
  v_mfma_f32_16x16x32_bf16 v[12:15], a[232:235], a[176:179], v[12:15]
  ds_read_b64_tr_b16 a[224:225], v228 offset:12288
  ds_read_b64_tr_b16 a[226:227], v228 offset:14336
  v_mfma_f32_16x16x32_bf16 v[28:31], a[228:231], a[164:167], v[28:31]
  v_mfma_f32_16x16x32_bf16 v[28:31], a[232:235], a[180:183], v[28:31]
  v_mfma_f32_16x16x32_bf16 v[44:47], a[228:231], a[168:171], v[44:47]
  v_mfma_f32_16x16x32_bf16 v[44:47], a[232:235], a[184:187], v[44:47]
  buffer_load_dwordx4 a[60:63], v225, s[4:7], s40 offen offset:3072 sc1
  v_mfma_f32_16x16x32_bf16 v[60:63], a[228:231], a[172:175], v[60:63]
  ds_read_b64_tr_b16 a[228:229], v228 offset:24576
  s_mov_b32 s41, 5505024
  v_mfma_f32_16x16x32_bf16 v[60:63], a[232:235], a[188:191], v[60:63]
  ds_read_b64_tr_b16 a[230:231], v228 offset:26624
  s_add_u32 m0, s42, 114688
  s_waitcnt lgkmcnt(13)
  v_mfma_f32_16x16x32_bf16 v[64:67], a[192:195], a[160:163], v[64:67]
  ds_read_b64_tr_b16 a[232:233], v229 offset:12288
  v_mfma_f32_16x16x32_bf16 v[64:67], a[196:199], a[176:179], v[64:67]
  s_waitcnt vmcnt(22)
  s_barrier
  v_mfma_f32_16x16x32_bf16 v[72:75], a[192:195], a[164:167], v[72:75]
  ds_read_b64_tr_b16 a[234:235], v229 offset:14336
  v_mfma_f32_16x16x32_bf16 v[72:75], a[196:199], a[180:183], v[72:75]
  buffer_load_dwordx4 v226, s[16:19], s41 offen offset:0 lds
  v_mfma_f32_16x16x32_bf16 v[80:83], a[192:195], a[168:171], v[80:83]
  s_mov_b32 s41, 5734400
  s_add_u32 m0, s42, 143360
  v_mfma_f32_16x16x32_bf16 v[80:83], a[196:199], a[184:187], v[80:83]
  v_mfma_f32_16x16x32_bf16 v[88:91], a[192:195], a[172:175], v[88:91]
  ds_read_b64_tr_b16 a[192:193], v229 offset:24576
  v_mfma_f32_16x16x32_bf16 v[88:91], a[196:199], a[188:191], v[88:91]
  ds_read_b64_tr_b16 a[194:195], v229 offset:26624
  v_mfma_f32_16x16x32_bf16 v[68:71], a[200:203], a[160:163], v[68:71]
  ds_read_b64_tr_b16 a[196:197], v238 offset:24576
  s_waitcnt lgkmcnt(13)
  v_mfma_f32_16x16x32_bf16 v[68:71], a[204:207], a[176:179], v[68:71]
  buffer_load_dwordx4 v226, s[16:19], s41 offen offset:0 lds
  v_mfma_f32_16x16x32_bf16 v[76:79], a[200:203], a[164:167], v[76:79]
  ds_read_b64_tr_b16 a[198:199], v238 offset:26624
  s_mov_b32 s41, 5963776
  v_mfma_f32_16x16x32_bf16 v[76:79], a[204:207], a[180:183], v[76:79]
  s_add_u32 m0, s42, 69632
  v_mfma_f32_16x16x32_bf16 v[84:87], a[200:203], a[168:171], v[84:87]
  v_mfma_f32_16x16x32_bf16 v[84:87], a[204:207], a[184:187], v[84:87]
  v_mfma_f32_16x16x32_bf16 v[92:95], a[200:203], a[172:175], v[92:95]
  ds_read_b64_tr_b16 a[200:201], v230 offset:20480
  v_mfma_f32_16x16x32_bf16 v[92:95], a[204:207], a[188:191], v[92:95]
  buffer_load_dwordx4 v226, s[12:15], s41 offen offset:0 lds
  s_waitcnt vmcnt(21)
  v_mfma_f32_16x16x32_bf16 v[0:3], a[208:211], a[0:3], v[0:3]
  ds_read_b64_tr_b16 a[202:203], v230 offset:22528
  s_mov_b32 s41, 6193152
  s_waitcnt vmcnt(17)
  v_mfma_f32_16x16x32_bf16 v[0:3], a[212:215], a[16:19], v[0:3]
  ds_read_b64_tr_b16 a[204:205], v230 offset:12288
  ds_read_b64_tr_b16 a[206:207], v230 offset:14336
  v_mfma_f32_16x16x32_bf16 v[16:19], a[208:211], a[4:7], v[16:19]
  s_add_u32 m0, s42, 81920
  v_mfma_f32_16x16x32_bf16 v[16:19], a[212:215], a[20:23], v[16:19]
  v_mfma_f32_16x16x32_bf16 v[32:35], a[208:211], a[8:11], v[32:35]
  v_mfma_f32_16x16x32_bf16 v[32:35], a[212:215], a[24:27], v[32:35]
  buffer_load_dwordx4 v226, s[12:15], s41 offen offset:0 lds
  v_mfma_f32_16x16x32_bf16 v[48:51], a[208:211], a[12:15], v[48:51]
  ds_read_b64_tr_b16 a[208:209], v230 offset:24576
  s_mov_b32 s41, 5963776
  v_mfma_f32_16x16x32_bf16 v[48:51], a[212:215], a[28:31], v[48:51]
  ds_read_b64_tr_b16 a[210:211], v230 offset:26624
  s_add_u32 m0, s42, 61440
  s_waitcnt lgkmcnt(13)
  v_mfma_f32_16x16x32_bf16 v[4:7], a[216:219], a[0:3], v[4:7]
  ds_read_b64_tr_b16 a[212:213], v228 offset:45056
  v_mfma_f32_16x16x32_bf16 v[4:7], a[220:223], a[16:19], v[4:7]
  ds_read_b64_tr_b16 a[214:215], v228 offset:47104
  v_mfma_f32_16x16x32_bf16 v[20:23], a[216:219], a[4:7], v[20:23]
  v_mfma_f32_16x16x32_bf16 v[20:23], a[220:223], a[20:23], v[20:23]
  buffer_load_dwordx4 v226, s[16:19], s41 offen offset:0 lds
  v_mfma_f32_16x16x32_bf16 v[36:39], a[216:219], a[8:11], v[36:39]
  s_mov_b32 s41, 6193152
  s_add_u32 m0, s42, 90112
  v_mfma_f32_16x16x32_bf16 v[36:39], a[220:223], a[24:27], v[36:39]
  v_mfma_f32_16x16x32_bf16 v[52:55], a[216:219], a[12:15], v[52:55]
  ds_read_b64_tr_b16 a[216:217], v228 offset:36864
  v_mfma_f32_16x16x32_bf16 v[52:55], a[220:223], a[28:31], v[52:55]
  ds_read_b64_tr_b16 a[218:219], v228 offset:38912
  v_mfma_f32_16x16x32_bf16 v[8:11], a[224:227], a[0:3], v[8:11]
  ds_read_b64_tr_b16 a[220:221], v229 offset:45056
  s_waitcnt lgkmcnt(13)
  v_mfma_f32_16x16x32_bf16 v[8:11], a[228:231], a[16:19], v[8:11]
  buffer_load_dwordx4 v226, s[16:19], s41 offen offset:0 lds
  v_mfma_f32_16x16x32_bf16 v[24:27], a[224:227], a[4:7], v[24:27]
  ds_read_b64_tr_b16 a[222:223], v229 offset:47104
  s_mov_b32 s41, 6422528
  v_mfma_f32_16x16x32_bf16 v[24:27], a[228:231], a[20:23], v[24:27]
  s_add_u32 m0, s42, 118784
  v_mfma_f32_16x16x32_bf16 v[40:43], a[224:227], a[8:11], v[40:43]
  v_mfma_f32_16x16x32_bf16 v[40:43], a[228:231], a[24:27], v[40:43]
  v_mfma_f32_16x16x32_bf16 v[56:59], a[224:227], a[12:15], v[56:59]
  ds_read_b64_tr_b16 a[224:225], v229 offset:36864
  v_mfma_f32_16x16x32_bf16 v[56:59], a[228:231], a[28:31], v[56:59]
  buffer_load_dwordx4 v226, s[12:15], s41 offen offset:0 lds
  v_mfma_f32_16x16x32_bf16 v[12:15], a[232:235], a[0:3], v[12:15]
  ds_read_b64_tr_b16 a[226:227], v229 offset:38912
  s_mov_b32 s41, 6651904
  v_mfma_f32_16x16x32_bf16 v[12:15], a[192:195], a[16:19], v[12:15]
  ds_read_b64_tr_b16 a[228:229], v228 offset:49152
  ds_read_b64_tr_b16 a[230:231], v228 offset:51200
  v_mfma_f32_16x16x32_bf16 v[28:31], a[232:235], a[4:7], v[28:31]
  s_add_u32 m0, s42, 131072
  v_mfma_f32_16x16x32_bf16 v[28:31], a[192:195], a[20:23], v[28:31]
  v_mfma_f32_16x16x32_bf16 v[44:47], a[232:235], a[8:11], v[44:47]
  v_mfma_f32_16x16x32_bf16 v[44:47], a[192:195], a[24:27], v[44:47]
  buffer_load_dwordx4 v226, s[12:15], s41 offen offset:0 lds
  v_mfma_f32_16x16x32_bf16 v[60:63], a[232:235], a[12:15], v[60:63]
  ds_read_b64_tr_b16 a[232:233], v228 offset:32768
  s_mov_b32 s41, 6422528
  v_mfma_f32_16x16x32_bf16 v[60:63], a[192:195], a[28:31], v[60:63]
  ds_read_b64_tr_b16 a[234:235], v228 offset:34816
  s_add_u32 m0, s42, 77824
  s_waitcnt lgkmcnt(13)
  v_mfma_f32_16x16x32_bf16 v[64:67], a[196:199], a[0:3], v[64:67]
  ds_read_b64_tr_b16 a[192:193], v229 offset:49152
  v_mfma_f32_16x16x32_bf16 v[64:67], a[200:203], a[16:19], v[64:67]
  ds_read_b64_tr_b16 a[194:195], v229 offset:51200
  v_mfma_f32_16x16x32_bf16 v[72:75], a[196:199], a[4:7], v[72:75]
  v_mfma_f32_16x16x32_bf16 v[72:75], a[200:203], a[20:23], v[72:75]
  buffer_load_dwordx4 v226, s[16:19], s41 offen offset:0 lds
  v_mfma_f32_16x16x32_bf16 v[80:83], a[196:199], a[8:11], v[80:83]
  s_mov_b32 s41, 6651904
  s_add_u32 m0, s42, 73728
  v_mfma_f32_16x16x32_bf16 v[80:83], a[200:203], a[24:27], v[80:83]
  v_mfma_f32_16x16x32_bf16 v[88:91], a[196:199], a[12:15], v[88:91]
  ds_read_b64_tr_b16 a[196:197], v229 offset:32768
  v_mfma_f32_16x16x32_bf16 v[88:91], a[200:203], a[28:31], v[88:91]
  ds_read_b64_tr_b16 a[198:199], v229 offset:34816
  v_mfma_f32_16x16x32_bf16 v[68:71], a[204:207], a[0:3], v[68:71]
  ds_read_b64_tr_b16 a[200:201], v230 offset:45056
  s_waitcnt lgkmcnt(13)
  v_mfma_f32_16x16x32_bf16 v[68:71], a[208:211], a[16:19], v[68:71]
  s_waitcnt vmcnt(17)
  s_barrier
  v_mfma_f32_16x16x32_bf16 v[76:79], a[204:207], a[4:7], v[76:79]
  buffer_load_dwordx4 v226, s[16:19], s41 offen offset:0 lds
  v_mfma_f32_16x16x32_bf16 v[76:79], a[208:211], a[20:23], v[76:79]
  ds_read_b64_tr_b16 a[202:203], v230 offset:47104
  s_mov_b32 s41, 6881280
  v_mfma_f32_16x16x32_bf16 v[84:87], a[204:207], a[8:11], v[84:87]
  s_add_u32 m0, s42, 86016
  v_mfma_f32_16x16x32_bf16 v[84:87], a[208:211], a[24:27], v[84:87]
  v_mfma_f32_16x16x32_bf16 v[92:95], a[204:207], a[12:15], v[92:95]
  ds_read_b64_tr_b16 a[204:205], v230 offset:36864
  v_mfma_f32_16x16x32_bf16 v[92:95], a[208:211], a[28:31], v[92:95]
  buffer_load_dwordx4 v226, s[12:15], s41 offen offset:0 lds
  s_waitcnt vmcnt(15)
  v_mfma_f32_16x16x32_bf16 v[0:3], a[212:215], a[32:35], v[0:3]
  ds_read_b64_tr_b16 a[206:207], v230 offset:38912
  s_mov_b32 s41, 7110656
  s_waitcnt vmcnt(11)
  v_mfma_f32_16x16x32_bf16 v[0:3], a[216:219], a[48:51], v[0:3]
  ds_read_b64_tr_b16 a[208:209], v230 offset:49152
  ds_read_b64_tr_b16 a[210:211], v230 offset:51200
  v_mfma_f32_16x16x32_bf16 v[16:19], a[212:215], a[36:39], v[16:19]
  s_add_u32 m0, s42, 102400
  v_mfma_f32_16x16x32_bf16 v[16:19], a[216:219], a[52:55], v[16:19]
  v_mfma_f32_16x16x32_bf16 v[32:35], a[212:215], a[40:43], v[32:35]
  v_mfma_f32_16x16x32_bf16 v[32:35], a[216:219], a[56:59], v[32:35]
  buffer_load_dwordx4 v226, s[12:15], s41 offen offset:0 lds
  v_mfma_f32_16x16x32_bf16 v[48:51], a[212:215], a[44:47], v[48:51]
  ds_read_b64_tr_b16 a[212:213], v230 offset:32768
  s_mov_b32 s41, 6881280
  v_mfma_f32_16x16x32_bf16 v[48:51], a[216:219], a[60:63], v[48:51]
  ds_read_b64_tr_b16 a[214:215], v230 offset:34816
  s_add_u32 m0, s42, 98304
  s_waitcnt lgkmcnt(13)
  v_mfma_f32_16x16x32_bf16 v[4:7], a[220:223], a[32:35], v[4:7]
  ds_read_b64_tr_b16 a[216:217], v228 offset:40960
  v_mfma_f32_16x16x32_bf16 v[4:7], a[224:227], a[48:51], v[4:7]
  ds_read_b64_tr_b16 a[218:219], v228 offset:43008
  v_mfma_f32_16x16x32_bf16 v[20:23], a[220:223], a[36:39], v[20:23]
  v_mfma_f32_16x16x32_bf16 v[20:23], a[224:227], a[52:55], v[20:23]
  buffer_load_dwordx4 v226, s[16:19], s41 offen offset:0 lds
  v_mfma_f32_16x16x32_bf16 v[36:39], a[220:223], a[40:43], v[36:39]
  s_mov_b32 s41, 7110656
  s_add_u32 m0, s42, 110592
  v_mfma_f32_16x16x32_bf16 v[36:39], a[224:227], a[56:59], v[36:39]
  v_mfma_f32_16x16x32_bf16 v[52:55], a[220:223], a[44:47], v[52:55]
  ds_read_b64_tr_b16 a[220:221], v228 offset:53248
  v_mfma_f32_16x16x32_bf16 v[52:55], a[224:227], a[60:63], v[52:55]
  ds_read_b64_tr_b16 a[222:223], v228 offset:55296
  v_mfma_f32_16x16x32_bf16 v[8:11], a[228:231], a[32:35], v[8:11]
  ds_read_b64_tr_b16 a[224:225], v229 offset:40960
  s_waitcnt lgkmcnt(13)
  v_mfma_f32_16x16x32_bf16 v[8:11], a[232:235], a[48:51], v[8:11]
  buffer_load_dwordx4 v226, s[16:19], s41 offen offset:0 lds
  v_mfma_f32_16x16x32_bf16 v[24:27], a[228:231], a[36:39], v[24:27]
  ds_read_b64_tr_b16 a[226:227], v229 offset:43008
  s_mov_b32 s41, 131072
  v_mfma_f32_16x16x32_bf16 v[24:27], a[232:235], a[52:55], v[24:27]
  s_add_u32 m0, s42, 126976
  v_mfma_f32_16x16x32_bf16 v[40:43], a[228:231], a[40:43], v[40:43]
  v_mfma_f32_16x16x32_bf16 v[40:43], a[232:235], a[56:59], v[40:43]
  v_mfma_f32_16x16x32_bf16 v[56:59], a[228:231], a[44:47], v[56:59]
  ds_read_b64_tr_b16 a[228:229], v229 offset:53248
  v_mfma_f32_16x16x32_bf16 v[56:59], a[232:235], a[60:63], v[56:59]
  buffer_load_dwordx4 v242, s[44:47], s41 offen offset:0 lds
  v_mfma_f32_16x16x32_bf16 v[12:15], a[192:195], a[32:35], v[12:15]
  ds_read_b64_tr_b16 a[230:231], v229 offset:55296
  s_mov_b32 s41, 393216
  v_mfma_f32_16x16x32_bf16 v[12:15], a[196:199], a[48:51], v[12:15]
  ds_read_b64_tr_b16 a[232:233], v228 offset:57344
  ds_read_b64_tr_b16 a[234:235], v228 offset:59392
  v_mfma_f32_16x16x32_bf16 v[28:31], a[192:195], a[36:39], v[28:31]
  s_add_u32 m0, s42, 122880
  v_mfma_f32_16x16x32_bf16 v[28:31], a[196:199], a[52:55], v[28:31]
  v_mfma_f32_16x16x32_bf16 v[44:47], a[192:195], a[40:43], v[44:47]
  v_mfma_f32_16x16x32_bf16 v[44:47], a[196:199], a[56:59], v[44:47]
  buffer_load_dwordx4 v242, s[44:47], s41 offen offset:0 lds
  v_mfma_f32_16x16x32_bf16 v[60:63], a[192:195], a[44:47], v[60:63]
  ds_read_b64_tr_b16 a[192:193], v232 offset:0
  s_mov_b32 s41, 131072
  v_mfma_f32_16x16x32_bf16 v[60:63], a[196:199], a[60:63], v[60:63]
  ds_read_b64_tr_b16 a[194:195], v232 offset:2048
  ds_read_b64_tr_b16 a[196:197], v229 offset:57344
  v_mul_f32 v0, s43, v0
  v_mul_f32 v1, s43, v1
  v_mul_f32 v2, s43, v2
  s_waitcnt lgkmcnt(13)
  v_mfma_f32_16x16x32_bf16 v[64:67], a[200:203], a[32:35], v[64:67]
  ds_read_b64_tr_b16 a[198:199], v229 offset:59392
  s_add_u32 m0, s42, 135168
  v_mul_f32 v3, s43, v3
  v_mul_f32 v4, s43, v4
  v_mul_f32 v5, s43, v5
  v_mul_f32 v6, s43, v6
  v_mfma_f32_16x16x32_bf16 v[64:67], a[204:207], a[48:51], v[64:67]
  v_mul_f32 v7, s43, v7
  v_exp_f32 v0, v0
  v_mfma_f32_16x16x32_bf16 v[72:75], a[200:203], a[36:39], v[72:75]
  v_exp_f32 v1, v1
  v_exp_f32 v2, v2
  v_mfma_f32_16x16x32_bf16 v[72:75], a[204:207], a[52:55], v[72:75]
  buffer_load_dwordx4 v253, s[44:47], s41 offen offset:0 lds
  v_exp_f32 v3, v3
  v_exp_f32 v4, v4
  v_mfma_f32_16x16x32_bf16 v[80:83], a[200:203], a[40:43], v[80:83]
  s_mov_b32 s41, 393216
  s_add_u32 m0, s42, 151552
  v_exp_f32 v5, v5
  v_exp_f32 v6, v6
  v_mfma_f32_16x16x32_bf16 v[80:83], a[204:207], a[56:59], v[80:83]
  v_exp_f32 v7, v7
  v_add_f32 v0, 1.0, v0
  v_add_f32 v1, 1.0, v1
  v_add_f32 v2, 1.0, v2
  v_mfma_f32_16x16x32_bf16 v[88:91], a[200:203], a[44:47], v[88:91]
  ds_read_b64_tr_b16 a[200:201], v233 offset:0
  ds_read_b64_tr_b16 a[202:203], v233 offset:2048
  v_add_f32 v3, 1.0, v3
  v_add_f32 v4, 1.0, v4
  v_add_f32 v5, 1.0, v5
  v_add_f32 v6, 1.0, v6
  v_mfma_f32_16x16x32_bf16 v[88:91], a[204:207], a[60:63], v[88:91]
  ds_read_b64_tr_b16 a[204:205], v232 offset:28672
  ds_read_b64_tr_b16 a[206:207], v232 offset:30720
  v_add_f32 v7, 1.0, v7
  v_rcp_f32 v0, v0
  v_mfma_f32_16x16x32_bf16 v[68:71], a[208:211], a[32:35], v[68:71]
  v_rcp_f32 v1, v1
  v_rcp_f32 v2, v2
  v_mfma_f32_16x16x32_bf16 v[68:71], a[212:215], a[48:51], v[68:71]
  buffer_load_dwordx4 v253, s[44:47], s41 offen offset:0 lds
  v_rcp_f32 v3, v3
  v_rcp_f32 v4, v4
  v_mfma_f32_16x16x32_bf16 v[76:79], a[208:211], a[36:39], v[76:79]
  s_mov_b32 s41, 458752
  s_add_u32 m0, s42, 147456
  v_rcp_f32 v5, v5
  v_rcp_f32 v6, v6
  v_mfma_f32_16x16x32_bf16 v[76:79], a[212:215], a[52:55], v[76:79]
  v_rcp_f32 v7, v7
  v_mul_f32 v0, v0, v8
  v_mul_f32 v1, v1, v9
  v_mul_f32 v2, v2, v10
  v_mfma_f32_16x16x32_bf16 v[84:87], a[208:211], a[40:43], v[84:87]
  v_mul_f32 v3, v3, v11
  v_mul_f32 v4, v4, v12
  v_mul_f32 v5, v5, v13
  v_mul_f32 v6, v6, v14
  v_mfma_f32_16x16x32_bf16 v[84:87], a[212:215], a[56:59], v[84:87]
  v_mul_f32 v7, v7, v15
  v_cvt_pk_bf16_f32 v0, v0, v1
  v_cvt_pk_bf16_f32 v1, v2, v3
  v_cvt_pk_bf16_f32 v2, v4, v5
  v_mfma_f32_16x16x32_bf16 v[92:95], a[208:211], a[44:47], v[92:95]
  ds_read_b64_tr_b16 a[208:209], v232 offset:40960
  ds_read_b64_tr_b16 a[210:211], v232 offset:43008
  v_cvt_pk_bf16_f32 v3, v6, v7
  buffer_store_dwordx4 v[0:3], v225, s[4:7], s64 offen offset:0 sc1
  v_mul_f32 v16, s43, v16
  v_mfma_f32_16x16x32_bf16 v[92:95], a[212:215], a[60:63], v[92:95]
  ds_read_b64_tr_b16 a[212:213], v233 offset:28672
  ds_read_b64_tr_b16 a[214:215], v233 offset:30720
  v_mul_f32 v17, s43, v17
  v_mul_f32 v18, s43, v18
  v_mul_f32 v19, s43, v19
  v_mul_f32 v20, s43, v20
  s_waitcnt lgkmcnt(13)
  v_mfma_f32_16x16x32_bf16 v[96:99], a[216:219], a[96:99], v[96:99]
  buffer_load_dwordx4 v242, s[44:47], s41 offen offset:0 lds
  v_mul_f32 v21, s43, v21
  v_mul_f32 v22, s43, v22
  v_mul_f32 v23, s43, v23
  v_mfma_f32_16x16x32_bf16 v[96:99], a[220:223], a[112:115], v[96:99]
  s_waitcnt vmcnt(13)
  s_barrier
  v_exp_f32 v16, v16
  v_exp_f32 v17, v17
  v_mfma_f32_16x16x32_bf16 v[128:131], a[216:219], a[100:103], v[128:131]
  s_mov_b32 s41, 720896
  s_add_u32 m0, s42, 159744
  v_exp_f32 v18, v18
  v_exp_f32 v19, v19
  v_mfma_f32_16x16x32_bf16 v[128:131], a[220:223], a[116:119], v[128:131]
  v_exp_f32 v20, v20
  v_exp_f32 v21, v21
  v_mfma_f32_16x16x32_bf16 v[160:163], a[216:219], a[104:107], v[160:163]
  v_exp_f32 v22, v22
  v_exp_f32 v23, v23
  v_add_f32 v16, 1.0, v16
  v_mfma_f32_16x16x32_bf16 v[160:163], a[220:223], a[120:123], v[160:163]
  buffer_load_dwordx4 v242, s[44:47], s41 offen offset:0 lds
  v_add_f32 v17, 1.0, v17
  v_add_f32 v18, 1.0, v18
  v_add_f32 v19, 1.0, v19
  v_add_f32 v20, 1.0, v20
  v_mfma_f32_16x16x32_bf16 v[192:195], a[216:219], a[108:111], v[192:195]
  ds_read_b64_tr_b16 a[216:217], v233 offset:40960
  ds_read_b64_tr_b16 a[218:219], v233 offset:43008
  v_add_f32 v21, 1.0, v21
  v_add_f32 v22, 1.0, v22
  v_add_f32 v23, 1.0, v23
  v_mfma_f32_16x16x32_bf16 v[192:195], a[220:223], a[124:127], v[192:195]
  ds_read_b64_tr_b16 a[220:221], v232 offset:49152
  ds_read_b64_tr_b16 a[222:223], v232 offset:51200
  v_rcp_f32 v16, v16
  v_rcp_f32 v17, v17
  v_mfma_f32_16x16x32_bf16 v[100:103], a[224:227], a[96:99], v[100:103]
  s_mov_b32 s41, 458752
  s_add_u32 m0, s42, 16384
  v_rcp_f32 v18, v18
  v_rcp_f32 v19, v19
  v_mfma_f32_16x16x32_bf16 v[100:103], a[228:231], a[112:115], v[100:103]
  v_rcp_f32 v20, v20
  v_rcp_f32 v21, v21
  v_mfma_f32_16x16x32_bf16 v[132:135], a[224:227], a[100:103], v[132:135]
  v_rcp_f32 v22, v22
  v_rcp_f32 v23, v23
  v_mul_f32 v16, v16, v24
  v_mfma_f32_16x16x32_bf16 v[132:135], a[228:231], a[116:119], v[132:135]
  buffer_load_dwordx4 v253, s[44:47], s41 offen offset:0 lds
  v_mul_f32 v17, v17, v25
  v_mul_f32 v18, v18, v26
  v_mul_f32 v19, v19, v27
  v_mul_f32 v20, v20, v28
  v_mfma_f32_16x16x32_bf16 v[164:167], a[224:227], a[104:107], v[164:167]
  s_mov_b32 s41, 720896
  s_add_u32 m0, s42, 28672
  v_mul_f32 v21, v21, v29
  v_mul_f32 v22, v22, v30
  v_mul_f32 v23, v23, v31
  v_cvt_pk_bf16_f32 v16, v16, v17
  v_mfma_f32_16x16x32_bf16 v[164:167], a[228:231], a[120:123], v[164:167]
  v_cvt_pk_bf16_f32 v17, v18, v19
  v_cvt_pk_bf16_f32 v18, v20, v21
  v_cvt_pk_bf16_f32 v19, v22, v23
  v_mfma_f32_16x16x32_bf16 v[196:199], a[224:227], a[108:111], v[196:199]
  ds_read_b64_tr_b16 a[224:225], v236 offset:12288
  ds_read_b64_tr_b16 a[226:227], v236 offset:14336
  buffer_store_dwordx4 v[16:19], v225, s[4:7], s64 offen offset:1024 sc1
  v_mul_f32 v32, s43, v32
  v_mul_f32 v33, s43, v33
  v_mul_f32 v34, s43, v34
  v_mfma_f32_16x16x32_bf16 v[196:199], a[228:231], a[124:127], v[196:199]
  ds_read_b64_tr_b16 a[228:229], v233 offset:49152
  ds_read_b64_tr_b16 a[230:231], v233 offset:51200
  v_mul_f32 v35, s43, v35
  v_mul_f32 v36, s43, v36
  v_mul_f32 v37, s43, v37
  v_mul_f32 v38, s43, v38
  s_waitcnt lgkmcnt(13)
  v_mfma_f32_16x16x32_bf16 v[112:115], a[232:235], a[96:99], v[112:115]
  v_mul_f32 v39, s43, v39
  v_exp_f32 v32, v32
  v_mfma_f32_16x16x32_bf16 v[112:115], a[192:195], a[112:115], v[112:115]
  buffer_load_dwordx4 v253, s[44:47], s41 offen offset:0 lds
  v_exp_f32 v33, v33
  v_exp_f32 v34, v34
  v_mfma_f32_16x16x32_bf16 v[144:147], a[232:235], a[100:103], v[144:147]
  s_mov_b32 s41, 1048576
  s_add_u32 m0, s42, 139264
  v_exp_f32 v35, v35
  v_exp_f32 v36, v36
  v_mfma_f32_16x16x32_bf16 v[144:147], a[192:195], a[116:119], v[144:147]
  v_exp_f32 v37, v37
  v_exp_f32 v38, v38
  v_mfma_f32_16x16x32_bf16 v[176:179], a[232:235], a[104:107], v[176:179]
  v_exp_f32 v39, v39
  v_add_f32 v32, 1.0, v32
  v_add_f32 v33, 1.0, v33
  v_add_f32 v34, 1.0, v34
  v_mfma_f32_16x16x32_bf16 v[176:179], a[192:195], a[120:123], v[176:179]
  v_add_f32 v35, 1.0, v35
  v_add_f32 v36, 1.0, v36
  v_add_f32 v37, 1.0, v37
  v_add_f32 v38, 1.0, v38
  v_mfma_f32_16x16x32_bf16 v[208:211], a[232:235], a[108:111], v[208:211]
  ds_read_b64_tr_b16 a[232:233], v237 offset:12288
  ds_read_b64_tr_b16 a[234:235], v237 offset:14336
  v_add_f32 v39, 1.0, v39
  v_rcp_f32 v32, v32
  v_mfma_f32_16x16x32_bf16 v[208:211], a[192:195], a[124:127], v[208:211]
  buffer_load_dwordx4 v242, s[44:47], s41 offen offset:0 lds
  v_rcp_f32 v33, v33
  v_rcp_f32 v34, v34
  v_mfma_f32_16x16x32_bf16 v[116:119], a[196:199], a[96:99], v[116:119]
  ds_read_b64_tr_b16 a[192:193], v232 offset:4096
  ds_read_b64_tr_b16 a[194:195], v232 offset:6144
  v_rcp_f32 v35, v35
  v_rcp_f32 v36, v36
  v_mfma_f32_16x16x32_bf16 v[116:119], a[200:203], a[112:115], v[116:119]
  s_mov_b32 s41, 1310720
  s_add_u32 m0, s42, 155648
  v_rcp_f32 v37, v37
  v_rcp_f32 v38, v38
  v_mfma_f32_16x16x32_bf16 v[148:151], a[196:199], a[100:103], v[148:151]
  v_rcp_f32 v39, v39
  v_mul_f32 v32, v32, v40
  v_mul_f32 v33, v33, v41
  v_mul_f32 v34, v34, v42
  v_mfma_f32_16x16x32_bf16 v[148:151], a[200:203], a[116:119], v[148:151]
  v_mul_f32 v35, v35, v43
  v_mul_f32 v36, v36, v44
  v_mul_f32 v37, v37, v45
  v_mul_f32 v38, v38, v46
  v_mfma_f32_16x16x32_bf16 v[180:183], a[196:199], a[104:107], v[180:183]
  v_mul_f32 v39, v39, v47
  v_cvt_pk_bf16_f32 v32, v32, v33
  v_cvt_pk_bf16_f32 v33, v34, v35
  v_cvt_pk_bf16_f32 v34, v36, v37
  v_mfma_f32_16x16x32_bf16 v[180:183], a[200:203], a[120:123], v[180:183]
  buffer_load_dwordx4 v242, s[44:47], s41 offen offset:0 lds
L_wk1_6:
  s_cbranch_vccnz L_wk1_10
  v_cvt_pk_bf16_f32 v35, v38, v39
  buffer_store_dwordx4 v[32:35], v225, s[4:7], s64 offen offset:2048 sc1
  v_mul_f32 v48, s43, v48
  v_mfma_f32_16x16x32_bf16 v[212:215], a[196:199], a[108:111], v[212:215]
  ds_read_b64_tr_b16 a[196:197], v232 offset:16384
  ds_read_b64_tr_b16 a[198:199], v232 offset:18432
  v_mul_f32 v49, s43, v49
  v_mul_f32 v50, s43, v50
  v_mul_f32 v51, s43, v51
  v_mul_f32 v52, s43, v52
  v_mfma_f32_16x16x32_bf16 v[212:215], a[200:203], a[124:127], v[212:215]
  ds_read_b64_tr_b16 a[200:201], v233 offset:4096
  ds_read_b64_tr_b16 a[202:203], v233 offset:6144
  v_mul_f32 v53, s43, v53
  v_mul_f32 v54, s43, v54
  v_mul_f32 v55, s43, v55
  s_waitcnt lgkmcnt(13)
  v_mfma_f32_16x16x32_bf16 v[96:99], a[204:207], a[128:131], v[96:99]
  s_mov_b32 s41, 1048576
  s_add_u32 m0, s42, 20480
  v_exp_f32 v48, v48
  v_exp_f32 v49, v49
  v_mfma_f32_16x16x32_bf16 v[96:99], a[208:211], a[144:147], v[96:99]
  v_exp_f32 v50, v50
  v_exp_f32 v51, v51
  v_mfma_f32_16x16x32_bf16 v[128:131], a[204:207], a[132:135], v[128:131]
  v_exp_f32 v52, v52
  v_exp_f32 v53, v53
  v_mfma_f32_16x16x32_bf16 v[128:131], a[208:211], a[148:151], v[128:131]
  buffer_load_dwordx4 v253, s[44:47], s41 offen offset:0 lds
  v_exp_f32 v54, v54
  v_exp_f32 v55, v55
  v_add_f32 v48, 1.0, v48
  v_mfma_f32_16x16x32_bf16 v[160:163], a[204:207], a[136:139], v[160:163]
  s_mov_b32 s41, 1310720
  s_add_u32 m0, s42, 12288
  v_add_f32 v49, 1.0, v49
  v_add_f32 v50, 1.0, v50
  v_add_f32 v51, 1.0, v51
  v_add_f32 v52, 1.0, v52
  v_mfma_f32_16x16x32_bf16 v[160:163], a[208:211], a[152:155], v[160:163]
  v_add_f32 v53, 1.0, v53
  v_add_f32 v54, 1.0, v54
  v_add_f32 v55, 1.0, v55
  v_mfma_f32_16x16x32_bf16 v[192:195], a[204:207], a[140:143], v[192:195]
  ds_read_b64_tr_b16 a[204:205], v233 offset:16384
  ds_read_b64_tr_b16 a[206:207], v233 offset:18432
  v_rcp_f32 v48, v48
  v_rcp_f32 v49, v49
  v_mfma_f32_16x16x32_bf16 v[192:195], a[208:211], a[156:159], v[192:195]
  ds_read_b64_tr_b16 a[208:209], v228 offset:61440
  ds_read_b64_tr_b16 a[210:211], v228 offset:63488
  v_rcp_f32 v50, v50
  v_rcp_f32 v51, v51
  v_mfma_f32_16x16x32_bf16 v[100:103], a[212:215], a[128:131], v[100:103]
  v_rcp_f32 v52, v52
  v_rcp_f32 v53, v53
  v_mfma_f32_16x16x32_bf16 v[100:103], a[216:219], a[144:147], v[100:103]
  buffer_load_dwordx4 v253, s[44:47], s41 offen offset:0 lds
  v_rcp_f32 v54, v54
  v_rcp_f32 v55, v55
  v_mul_f32 v48, v48, v56
  v_mfma_f32_16x16x32_bf16 v[132:135], a[212:215], a[132:135], v[132:135]
  s_mov_b32 s41, 1376256
  s_add_u32 m0, s42, 24576
  v_mul_f32 v49, v49, v57
  v_mul_f32 v50, v50, v58
  v_mul_f32 v51, v51, v59
  v_mul_f32 v52, v52, v60
  v_mfma_f32_16x16x32_bf16 v[132:135], a[216:219], a[148:151], v[132:135]
  v_mul_f32 v53, v53, v61
  v_mul_f32 v54, v54, v62
  v_mul_f32 v55, v55, v63
  v_cvt_pk_bf16_f32 v48, v48, v49
  v_mfma_f32_16x16x32_bf16 v[164:167], a[212:215], a[136:139], v[164:167]
  v_cvt_pk_bf16_f32 v49, v50, v51
  v_cvt_pk_bf16_f32 v50, v52, v53
  v_cvt_pk_bf16_f32 v51, v54, v55
  v_mfma_f32_16x16x32_bf16 v[164:167], a[216:219], a[152:155], v[164:167]
  buffer_store_dwordx4 v[48:51], v225, s[4:7], s64 offen offset:3072 sc1
  v_mul_f32 v64, s43, v64
  v_mul_f32 v65, s43, v65
  v_mul_f32 v66, s43, v66
  v_mfma_f32_16x16x32_bf16 v[196:199], a[212:215], a[140:143], v[196:199]
  ds_read_b64_tr_b16 a[212:213], v232 offset:24576
  ds_read_b64_tr_b16 a[214:215], v232 offset:26624
  v_mul_f32 v67, s43, v67
  v_mfma_f32_16x16x32_bf16 v[196:199], a[216:219], a[156:159], v[196:199]
  buffer_load_dwordx4 v242, s[44:47], s41 offen offset:0 lds
  s_waitcnt lgkmcnt(13)
  v_mfma_f32_16x16x32_bf16 v[112:115], a[220:223], a[128:131], v[112:115]
  ds_read_b64_tr_b16 a[216:217], v229 offset:61440
  ds_read_b64_tr_b16 a[218:219], v229 offset:63488
  v_exp_f32 v64, v64
  v_mfma_f32_16x16x32_bf16 v[112:115], a[224:227], a[144:147], v[112:115]
  s_mov_b32 s41, 1638400
  s_add_u32 m0, s42, 45056
  v_exp_f32 v65, v65
  v_mfma_f32_16x16x32_bf16 v[144:147], a[220:223], a[132:135], v[144:147]
  v_exp_f32 v66, v66
  v_mfma_f32_16x16x32_bf16 v[144:147], a[224:227], a[148:151], v[144:147]
  v_exp_f32 v67, v67
  v_mfma_f32_16x16x32_bf16 v[176:179], a[220:223], a[136:139], v[176:179]
  v_add_f32 v64, 1.0, v64
  v_add_f32 v65, 1.0, v65
  v_mfma_f32_16x16x32_bf16 v[176:179], a[224:227], a[152:155], v[176:179]
  buffer_load_dwordx4 v242, s[44:47], s41 offen offset:0 lds
  v_add_f32 v66, 1.0, v66
  v_mfma_f32_16x16x32_bf16 v[208:211], a[220:223], a[140:143], v[208:211]
  ds_read_b64_tr_b16 a[220:221], v233 offset:24576
  ds_read_b64_tr_b16 a[222:223], v233 offset:26624
  v_add_f32 v67, 1.0, v67
  v_mfma_f32_16x16x32_bf16 v[208:211], a[224:227], a[156:159], v[208:211]
  ds_read_b64_tr_b16 a[224:225], v232 offset:53248
  ds_read_b64_tr_b16 a[226:227], v232 offset:55296
  v_mfma_f32_16x16x32_bf16 v[116:119], a[228:231], a[128:131], v[116:119]
  s_mov_b32 s41, 1376256
  s_add_u32 m0, s42, 36864
  v_rcp_f32 v64, v64
  s_waitcnt lgkmcnt(13)
  v_mfma_f32_16x16x32_bf16 v[116:119], a[232:235], a[144:147], v[116:119]
  s_waitcnt vmcnt(18)
  s_barrier
  v_rcp_f32 v65, v65
  v_mfma_f32_16x16x32_bf16 v[148:151], a[228:231], a[132:135], v[148:151]
  v_rcp_f32 v66, v66
  v_mfma_f32_16x16x32_bf16 v[148:151], a[232:235], a[148:151], v[148:151]
  buffer_load_dwordx4 v253, s[44:47], s41 offen offset:0 lds
  v_mfma_f32_16x16x32_bf16 v[180:183], a[228:231], a[136:139], v[180:183]
  s_mov_b32 s41, 1638400
  s_add_u32 m0, s42, 49152
  v_rcp_f32 v67, v67
  v_mul_f32 v64, v64, v68
  v_mfma_f32_16x16x32_bf16 v[180:183], a[232:235], a[152:155], v[180:183]
  v_mul_f32 v65, v65, v69
  v_mul_f32 v66, v66, v70
  v_mfma_f32_16x16x32_bf16 v[212:215], a[228:231], a[140:143], v[212:215]
  ds_read_b64_tr_b16 a[228:229], v236 offset:0
  ds_read_b64_tr_b16 a[230:231], v236 offset:2048
  v_mul_f32 v67, v67, v71
  v_mfma_f32_16x16x32_bf16 v[212:215], a[232:235], a[156:159], v[212:215]
  ds_read_b64_tr_b16 a[232:233], v233 offset:53248
  ds_read_b64_tr_b16 a[234:235], v233 offset:55296
  v_cvt_pk_bf16_f32 v64, v64, v65
  v_cvt_pk_bf16_f32 v65, v66, v67
  v_mfma_f32_16x16x32_bf16 v[96:99], a[192:195], a[160:163], v[96:99]
  v_mul_f32 v72, s43, v72
  v_mul_f32 v73, s43, v73
  v_mfma_f32_16x16x32_bf16 v[96:99], a[196:199], a[176:179], v[96:99]
  buffer_load_dwordx4 v253, s[44:47], s41 offen offset:0 lds
  v_mul_f32 v74, s43, v74
  v_mfma_f32_16x16x32_bf16 v[128:131], a[192:195], a[164:167], v[128:131]
  s_mov_b32 s41, 1966080
  s_add_u32 m0, s42, 32768
  v_mul_f32 v75, s43, v75
  v_mfma_f32_16x16x32_bf16 v[128:131], a[196:199], a[180:183], v[128:131]
  v_exp_f32 v72, v72
  v_mfma_f32_16x16x32_bf16 v[160:163], a[192:195], a[168:171], v[160:163]
  v_exp_f32 v73, v73
  v_mfma_f32_16x16x32_bf16 v[160:163], a[196:199], a[184:187], v[160:163]
  v_exp_f32 v74, v74
  v_mfma_f32_16x16x32_bf16 v[192:195], a[192:195], a[172:175], v[192:195]
  ds_read_b64_tr_b16 a[192:193], v237 offset:0
  ds_read_b64_tr_b16 a[194:195], v237 offset:2048
  v_mfma_f32_16x16x32_bf16 v[192:195], a[196:199], a[188:191], v[192:195]
  buffer_load_dwordx4 v242, s[44:47], s41 offen offset:0 lds
  s_waitcnt lgkmcnt(13)
  v_mfma_f32_16x16x32_bf16 v[100:103], a[200:203], a[160:163], v[100:103]
  ds_read_b64_tr_b16 a[196:197], v232 offset:12288
  ds_read_b64_tr_b16 a[198:199], v232 offset:14336
  v_exp_f32 v75, v75
  v_add_f32 v72, 1.0, v72
  v_mfma_f32_16x16x32_bf16 v[100:103], a[204:207], a[176:179], v[100:103]
  v_add_f32 v73, 1.0, v73
  v_add_f32 v74, 1.0, v74
  v_mfma_f32_16x16x32_bf16 v[132:135], a[200:203], a[164:167], v[132:135]
  v_add_f32 v75, 1.0, v75
  v_mfma_f32_16x16x32_bf16 v[132:135], a[204:207], a[180:183], v[132:135]
  v_rcp_f32 v72, v72
  v_mfma_f32_16x16x32_bf16 v[164:167], a[200:203], a[168:171], v[164:167]
  v_rcp_f32 v73, v73
  v_mfma_f32_16x16x32_bf16 v[164:167], a[204:207], a[184:187], v[164:167]
  v_rcp_f32 v74, v74
  v_mfma_f32_16x16x32_bf16 v[196:199], a[200:203], a[172:175], v[196:199]
  ds_read_b64_tr_b16 a[200:201], v232 offset:8192
  ds_read_b64_tr_b16 a[202:203], v232 offset:10240
  v_mfma_f32_16x16x32_bf16 v[196:199], a[204:207], a[188:191], v[196:199]
  ds_read_b64_tr_b16 a[204:205], v233 offset:12288
  ds_read_b64_tr_b16 a[206:207], v233 offset:14336
  v_mfma_f32_16x16x32_bf16 v[112:115], a[208:211], a[160:163], v[112:115]
  v_rcp_f32 v75, v75
  v_mul_f32 v72, v72, v76
  s_waitcnt lgkmcnt(13)
  v_mfma_f32_16x16x32_bf16 v[112:115], a[212:215], a[176:179], v[112:115]
  v_mul_f32 v73, v73, v77
  v_mul_f32 v74, v74, v78
  v_mfma_f32_16x16x32_bf16 v[144:147], a[208:211], a[164:167], v[144:147]
  v_mul_f32 v75, v75, v79
  v_cvt_pk_bf16_f32 v66, v72, v73
  v_mfma_f32_16x16x32_bf16 v[144:147], a[212:215], a[180:183], v[144:147]
  v_cvt_pk_bf16_f32 v67, v74, v75
  v_mfma_f32_16x16x32_bf16 v[176:179], a[208:211], a[168:171], v[176:179]
  buffer_store_dwordx4 v[64:67], v225, s[4:7], s65 offen offset:0 sc1
  v_mfma_f32_16x16x32_bf16 v[176:179], a[212:215], a[184:187], v[176:179]
  v_mul_f32 v80, s43, v80
  v_mul_f32 v81, s43, v81
  v_mfma_f32_16x16x32_bf16 v[208:211], a[208:211], a[172:175], v[208:211]
  ds_read_b64_tr_b16 a[208:209], v233 offset:8192
  ds_read_b64_tr_b16 a[210:211], v233 offset:10240
  v_mfma_f32_16x16x32_bf16 v[208:211], a[212:215], a[188:191], v[208:211]
  ds_read_b64_tr_b16 a[212:213], v232 offset:20480
  ds_read_b64_tr_b16 a[214:215], v232 offset:22528
  v_mul_f32 v82, s43, v82
  v_mul_f32 v83, s43, v83
  v_mfma_f32_16x16x32_bf16 v[116:119], a[216:219], a[160:163], v[116:119]
  v_exp_f32 v80, v80
  v_mfma_f32_16x16x32_bf16 v[116:119], a[220:223], a[176:179], v[116:119]
  v_exp_f32 v81, v81
  v_mfma_f32_16x16x32_bf16 v[148:151], a[216:219], a[164:167], v[148:151]
  v_exp_f32 v82, v82
  v_mfma_f32_16x16x32_bf16 v[148:151], a[220:223], a[180:183], v[148:151]
  v_exp_f32 v83, v83
  v_mfma_f32_16x16x32_bf16 v[180:183], a[216:219], a[168:171], v[180:183]
  v_add_f32 v80, 1.0, v80
  v_add_f32 v81, 1.0, v81
  v_mfma_f32_16x16x32_bf16 v[180:183], a[220:223], a[184:187], v[180:183]
  v_add_f32 v82, 1.0, v82
  v_add_f32 v83, 1.0, v83
  v_mfma_f32_16x16x32_bf16 v[212:215], a[216:219], a[172:175], v[212:215]
  ds_read_b64_tr_b16 a[216:217], v232 offset:36864
  ds_read_b64_tr_b16 a[218:219], v232 offset:38912
  s_waitcnt vmcnt(6)
  v_add_u32 v248, 0, v245
  buffer_store_dword v248, v246, s[4:7], s90 offen sc1
  v_mfma_f32_16x16x32_bf16 v[212:215], a[220:223], a[188:191], v[212:215]
  ds_read_b64_tr_b16 a[220:221], v233 offset:20480
  ds_read_b64_tr_b16 a[222:223], v233 offset:22528
  s_waitcnt lgkmcnt(13)
  v_mfma_f32_16x16x32_bf16 v[96:99], a[224:227], a[0:3], v[96:99]
  v_rcp_f32 v80, v80
  v_mfma_f32_16x16x32_bf16 v[96:99], a[228:231], a[16:19], v[96:99]
  v_rcp_f32 v81, v81
  v_mfma_f32_16x16x32_bf16 v[128:131], a[224:227], a[4:7], v[128:131]
  v_rcp_f32 v82, v82
  v_mfma_f32_16x16x32_bf16 v[128:131], a[228:231], a[20:23], v[128:131]
  v_rcp_f32 v83, v83
  v_mfma_f32_16x16x32_bf16 v[160:163], a[224:227], a[8:11], v[160:163]
  v_mul_f32 v80, v80, v84
  v_mul_f32 v81, v81, v85
  v_mfma_f32_16x16x32_bf16 v[160:163], a[228:231], a[24:27], v[160:163]
  v_mul_f32 v82, v82, v86
  v_mul_f32 v83, v83, v87
  v_mfma_f32_16x16x32_bf16 v[192:195], a[224:227], a[12:15], v[192:195]
  ds_read_b64_tr_b16 a[224:225], v233 offset:36864
  ds_read_b64_tr_b16 a[226:227], v233 offset:38912
  v_mfma_f32_16x16x32_bf16 v[192:195], a[228:231], a[28:31], v[192:195]
  ds_read_b64_tr_b16 a[228:229], v232 offset:32768
  ds_read_b64_tr_b16 a[230:231], v232 offset:34816
  v_mfma_f32_16x16x32_bf16 v[100:103], a[232:235], a[0:3], v[100:103]
  v_cvt_pk_bf16_f32 v80, v80, v81
  v_cvt_pk_bf16_f32 v81, v82, v83
  v_mfma_f32_16x16x32_bf16 v[100:103], a[192:195], a[16:19], v[100:103]
  v_mul_f32 v88, s43, v88
  v_mul_f32 v89, s43, v89
  v_mfma_f32_16x16x32_bf16 v[132:135], a[232:235], a[4:7], v[132:135]
  v_mul_f32 v90, s43, v90
  v_mul_f32 v91, s43, v91
  v_mfma_f32_16x16x32_bf16 v[132:135], a[192:195], a[20:23], v[132:135]
  v_exp_f32 v88, v88
  v_mfma_f32_16x16x32_bf16 v[164:167], a[232:235], a[8:11], v[164:167]
  v_exp_f32 v89, v89
  v_mfma_f32_16x16x32_bf16 v[164:167], a[192:195], a[24:27], v[164:167]
  v_exp_f32 v90, v90
  v_mfma_f32_16x16x32_bf16 v[196:199], a[232:235], a[12:15], v[196:199]
  ds_read_b64_tr_b16 a[232:233], v232 offset:45056
  ds_read_b64_tr_b16 a[234:235], v232 offset:47104
  v_mfma_f32_16x16x32_bf16 v[196:199], a[192:195], a[28:31], v[196:199]
  ds_read_b64_tr_b16 a[192:193], v233 offset:32768
  ds_read_b64_tr_b16 a[194:195], v233 offset:34816
  s_waitcnt lgkmcnt(13)
  v_mfma_f32_16x16x32_bf16 v[112:115], a[196:199], a[0:3], v[112:115]
  v_exp_f32 v91, v91
  v_mfma_f32_16x16x32_bf16 v[112:115], a[200:203], a[16:19], v[112:115]
  s_barrier
  v_add_f32 v88, 1.0, v88
  v_mfma_f32_16x16x32_bf16 v[144:147], a[196:199], a[4:7], v[144:147]
  v_add_f32 v89, 1.0, v89
  v_add_f32 v90, 1.0, v90
  v_mfma_f32_16x16x32_bf16 v[144:147], a[200:203], a[20:23], v[144:147]
  v_add_f32 v91, 1.0, v91
  v_mfma_f32_16x16x32_bf16 v[176:179], a[196:199], a[8:11], v[176:179]
  v_rcp_f32 v88, v88
  v_mfma_f32_16x16x32_bf16 v[176:179], a[200:203], a[24:27], v[176:179]
  v_rcp_f32 v89, v89
  v_mfma_f32_16x16x32_bf16 v[208:211], a[196:199], a[12:15], v[208:211]
  ds_read_b64_tr_b16 a[196:197], v233 offset:45056
  ds_read_b64_tr_b16 a[198:199], v233 offset:47104
  v_mfma_f32_16x16x32_bf16 v[208:211], a[200:203], a[28:31], v[208:211]
  ds_read_b64_tr_b16 a[200:201], v230 offset:40960
  ds_read_b64_tr_b16 a[202:203], v230 offset:43008
  v_mfma_f32_16x16x32_bf16 v[116:119], a[204:207], a[0:3], v[116:119]
  v_rcp_f32 v90, v90
  v_mfma_f32_16x16x32_bf16 v[116:119], a[208:211], a[16:19], v[116:119]
  v_rcp_f32 v91, v91
  v_mul_f32 v88, v88, v92
  v_mfma_f32_16x16x32_bf16 v[148:151], a[204:207], a[4:7], v[148:151]
  v_mul_f32 v89, v89, v93
  v_mul_f32 v90, v90, v94
  v_mfma_f32_16x16x32_bf16 v[148:151], a[208:211], a[20:23], v[148:151]
  v_mul_f32 v91, v91, v95
  v_cvt_pk_bf16_f32 v82, v88, v89
  v_mfma_f32_16x16x32_bf16 v[180:183], a[204:207], a[8:11], v[180:183]
  v_cvt_pk_bf16_f32 v83, v90, v91
  v_mfma_f32_16x16x32_bf16 v[180:183], a[208:211], a[24:27], v[180:183]
  buffer_store_dwordx4 v[80:83], v225, s[4:7], s65 offen offset:2048 sc1
  v_mfma_f32_16x16x32_bf16 v[212:215], a[204:207], a[12:15], v[212:215]
  ds_read_b64_tr_b16 a[204:205], v230 offset:53248
  ds_read_b64_tr_b16 a[206:207], v230 offset:55296
  v_mfma_f32_16x16x32_bf16 v[212:215], a[208:211], a[28:31], v[212:215]
  ds_read_b64_tr_b16 a[208:209], v231 offset:40960
  ds_read_b64_tr_b16 a[210:211], v231 offset:43008
  s_waitcnt lgkmcnt(13)
  v_mfma_f32_16x16x32_bf16 v[96:99], a[212:215], a[32:35], v[96:99]
  v_mfma_f32_16x16x32_bf16 v[96:99], a[216:219], a[48:51], v[96:99]
  v_mfma_f32_16x16x32_bf16 v[128:131], a[212:215], a[36:39], v[128:131]
  v_mfma_f32_16x16x32_bf16 v[128:131], a[216:219], a[52:55], v[128:131]
  v_mfma_f32_16x16x32_bf16 v[160:163], a[212:215], a[40:43], v[160:163]
  v_mfma_f32_16x16x32_bf16 v[160:163], a[216:219], a[56:59], v[160:163]
  v_mfma_f32_16x16x32_bf16 v[192:195], a[212:215], a[44:47], v[192:195]
  ds_read_b64_tr_b16 a[212:213], v231 offset:53248
  ds_read_b64_tr_b16 a[214:215], v231 offset:55296
  v_mfma_f32_16x16x32_bf16 v[192:195], a[216:219], a[60:63], v[192:195]
  ds_read_b64_tr_b16 a[216:217], v230 offset:57344
  ds_read_b64_tr_b16 a[218:219], v230 offset:59392
  v_mfma_f32_16x16x32_bf16 v[100:103], a[220:223], a[32:35], v[100:103]
  v_mfma_f32_16x16x32_bf16 v[100:103], a[224:227], a[48:51], v[100:103]
  v_mfma_f32_16x16x32_bf16 v[132:135], a[220:223], a[36:39], v[132:135]
  v_mfma_f32_16x16x32_bf16 v[132:135], a[224:227], a[52:55], v[132:135]
  v_mfma_f32_16x16x32_bf16 v[164:167], a[220:223], a[40:43], v[164:167]
  v_mfma_f32_16x16x32_bf16 v[164:167], a[224:227], a[56:59], v[164:167]
  v_mfma_f32_16x16x32_bf16 v[196:199], a[220:223], a[44:47], v[196:199]
  ds_read_b64_tr_b16 a[220:221], v234 offset:0
  ds_read_b64_tr_b16 a[222:223], v234 offset:2048
  v_mfma_f32_16x16x32_bf16 v[196:199], a[224:227], a[60:63], v[196:199]
  ds_read_b64_tr_b16 a[224:225], v231 offset:57344
  ds_read_b64_tr_b16 a[226:227], v231 offset:59392
  s_waitcnt lgkmcnt(13)
  v_mfma_f32_16x16x32_bf16 v[112:115], a[228:231], a[32:35], v[112:115]
  v_mfma_f32_16x16x32_bf16 v[112:115], a[232:235], a[48:51], v[112:115]
  v_mfma_f32_16x16x32_bf16 v[144:147], a[228:231], a[36:39], v[144:147]
  v_mfma_f32_16x16x32_bf16 v[144:147], a[232:235], a[52:55], v[144:147]
  v_mfma_f32_16x16x32_bf16 v[176:179], a[228:231], a[40:43], v[176:179]
  v_mfma_f32_16x16x32_bf16 v[176:179], a[232:235], a[56:59], v[176:179]
  v_mfma_f32_16x16x32_bf16 v[208:211], a[228:231], a[44:47], v[208:211]
  ds_read_b64_tr_b16 a[228:229], v235 offset:0
  ds_read_b64_tr_b16 a[230:231], v235 offset:2048
  v_mfma_f32_16x16x32_bf16 v[208:211], a[232:235], a[60:63], v[208:211]
  ds_read_b64_tr_b16 a[232:233], v234 offset:28672
  ds_read_b64_tr_b16 a[234:235], v234 offset:30720
  v_mfma_f32_16x16x32_bf16 v[116:119], a[192:195], a[32:35], v[116:119]
  v_mfma_f32_16x16x32_bf16 v[116:119], a[196:199], a[48:51], v[116:119]
  v_mfma_f32_16x16x32_bf16 v[148:151], a[192:195], a[36:39], v[148:151]
  v_mfma_f32_16x16x32_bf16 v[148:151], a[196:199], a[52:55], v[148:151]
  v_mfma_f32_16x16x32_bf16 v[180:183], a[192:195], a[40:43], v[180:183]
  v_mfma_f32_16x16x32_bf16 v[180:183], a[196:199], a[56:59], v[180:183]
  v_mfma_f32_16x16x32_bf16 v[212:215], a[192:195], a[44:47], v[212:215]
  ds_read_b64_tr_b16 a[192:193], v234 offset:40960
  ds_read_b64_tr_b16 a[194:195], v234 offset:43008
  v_mfma_f32_16x16x32_bf16 v[212:215], a[196:199], a[60:63], v[212:215]
  ds_read_b64_tr_b16 a[196:197], v235 offset:28672
  ds_read_b64_tr_b16 a[198:199], v235 offset:30720
  s_waitcnt lgkmcnt(13)
  v_mfma_f32_16x16x32_bf16 v[104:107], a[200:203], a[96:99], v[104:107]
  v_mul_f32 v96, s43, v96
  v_mul_f32 v97, s43, v97
  v_mfma_f32_16x16x32_bf16 v[104:107], a[204:207], a[112:115], v[104:107]
  v_mul_f32 v98, s43, v98
  v_mul_f32 v99, s43, v99
  v_mfma_f32_16x16x32_bf16 v[136:139], a[200:203], a[100:103], v[136:139]
  v_mul_f32 v100, s43, v100
  v_mul_f32 v101, s43, v101
  v_mfma_f32_16x16x32_bf16 v[136:139], a[204:207], a[116:119], v[136:139]
  v_mul_f32 v102, s43, v102
  v_mul_f32 v103, s43, v103
  v_mfma_f32_16x16x32_bf16 v[168:171], a[200:203], a[104:107], v[168:171]
  v_exp_f32 v96, v96
  v_mfma_f32_16x16x32_bf16 v[168:171], a[204:207], a[120:123], v[168:171]
  v_exp_f32 v97, v97
  v_mfma_f32_16x16x32_bf16 v[200:203], a[200:203], a[108:111], v[200:203]
  ds_read_b64_tr_b16 a[200:201], v235 offset:40960
  ds_read_b64_tr_b16 a[202:203], v235 offset:43008
  v_mfma_f32_16x16x32_bf16 v[200:203], a[204:207], a[124:127], v[200:203]
  ds_read_b64_tr_b16 a[204:205], v234 offset:49152
  ds_read_b64_tr_b16 a[206:207], v234 offset:51200
  v_mfma_f32_16x16x32_bf16 v[108:111], a[208:211], a[96:99], v[108:111]
  v_exp_f32 v98, v98
  v_mfma_f32_16x16x32_bf16 v[108:111], a[212:215], a[112:115], v[108:111]
  s_barrier
  v_exp_f32 v99, v99
  v_mfma_f32_16x16x32_bf16 v[140:143], a[208:211], a[100:103], v[140:143]
  s_mov_b32 s41, 2228224
  s_add_u32 m0, s42, 40960
  v_exp_f32 v100, v100
  v_mfma_f32_16x16x32_bf16 v[140:143], a[212:215], a[116:119], v[140:143]
  buffer_load_dwordx4 v242, s[44:47], s41 offen offset:0 lds
  v_exp_f32 v101, v101
  v_mfma_f32_16x16x32_bf16 v[172:175], a[208:211], a[104:107], v[172:175]
  s_mov_b32 s41, 1966080
  s_add_u32 m0, s42, 53248
  v_exp_f32 v102, v102
  v_mfma_f32_16x16x32_bf16 v[172:175], a[212:215], a[120:123], v[172:175]
  v_exp_f32 v103, v103
  v_add_f32 v96, 1.0, v96
  v_mfma_f32_16x16x32_bf16 v[204:207], a[208:211], a[108:111], v[204:207]
  ds_read_b64_tr_b16 a[208:209], v238 offset:12288
  ds_read_b64_tr_b16 a[210:211], v238 offset:14336
  v_add_f32 v97, 1.0, v97
  v_add_f32 v98, 1.0, v98
  v_mfma_f32_16x16x32_bf16 v[204:207], a[212:215], a[124:127], v[204:207]
  ds_read_b64_tr_b16 a[212:213], v235 offset:49152
  ds_read_b64_tr_b16 a[214:215], v235 offset:51200
  v_add_f32 v99, 1.0, v99
  s_waitcnt lgkmcnt(13)
  v_mfma_f32_16x16x32_bf16 v[120:123], a[216:219], a[96:99], v[120:123]
  buffer_load_dwordx4 v253, s[44:47], s41 offen offset:0 lds
  v_add_f32 v100, 1.0, v100
  v_add_f32 v101, 1.0, v101
  v_mfma_f32_16x16x32_bf16 v[120:123], a[220:223], a[112:115], v[120:123]
  v_add_f32 v102, 1.0, v102
  v_add_f32 v103, 1.0, v103
  v_mfma_f32_16x16x32_bf16 v[152:155], a[216:219], a[100:103], v[152:155]
  v_rcp_f32 v96, v96
  v_mfma_f32_16x16x32_bf16 v[152:155], a[220:223], a[116:119], v[152:155]
  v_rcp_f32 v97, v97
  v_mfma_f32_16x16x32_bf16 v[184:187], a[216:219], a[104:107], v[184:187]
  v_rcp_f32 v98, v98
  v_mfma_f32_16x16x32_bf16 v[184:187], a[220:223], a[120:123], v[184:187]
  v_rcp_f32 v99, v99
  v_mfma_f32_16x16x32_bf16 v[216:219], a[216:219], a[108:111], v[216:219]
  ds_read_b64_tr_b16 a[216:217], v239 offset:12288
  ds_read_b64_tr_b16 a[218:219], v239 offset:14336
  v_mfma_f32_16x16x32_bf16 v[216:219], a[220:223], a[124:127], v[216:219]
  ds_read_b64_tr_b16 a[220:221], v234 offset:4096
  ds_read_b64_tr_b16 a[222:223], v234 offset:6144
  v_mfma_f32_16x16x32_bf16 v[124:127], a[224:227], a[96:99], v[124:127]
  v_rcp_f32 v100, v100
  v_mfma_f32_16x16x32_bf16 v[124:127], a[228:231], a[112:115], v[124:127]
  v_rcp_f32 v101, v101
  v_mfma_f32_16x16x32_bf16 v[156:159], a[224:227], a[100:103], v[156:159]
  s_waitcnt vmcnt(2)
  v_add_u32 v248, 1, v245
  buffer_store_dword v248, v246, s[4:7], s90 offen sc1
  v_rcp_f32 v102, v102
  v_mfma_f32_16x16x32_bf16 v[156:159], a[228:231], a[116:119], v[156:159]
  v_rcp_f32 v103, v103
  v_mul_f32 v96, v96, v112
  v_mfma_f32_16x16x32_bf16 v[188:191], a[224:227], a[104:107], v[188:191]
  v_mul_f32 v97, v97, v113
  v_mul_f32 v98, v98, v114
  v_mfma_f32_16x16x32_bf16 v[188:191], a[228:231], a[120:123], v[188:191]
  v_mul_f32 v99, v99, v115
  v_mul_f32 v100, v100, v116
  v_mfma_f32_16x16x32_bf16 v[220:223], a[224:227], a[108:111], v[220:223]
  ds_read_b64_tr_b16 a[224:225], v234 offset:16384
  ds_read_b64_tr_b16 a[226:227], v234 offset:18432
  v_mul_f32 v101, v101, v117
  v_mul_f32 v102, v102, v118
  v_mfma_f32_16x16x32_bf16 v[220:223], a[228:231], a[124:127], v[220:223]
  ds_read_b64_tr_b16 a[228:229], v235 offset:4096
  ds_read_b64_tr_b16 a[230:231], v235 offset:6144
  v_mul_f32 v103, v103, v119
  s_waitcnt lgkmcnt(13)
  v_mfma_f32_16x16x32_bf16 v[104:107], a[232:235], a[128:131], v[104:107]
  v_cvt_pk_bf16_f32 v96, v96, v97
  v_cvt_pk_bf16_f32 v97, v98, v99
  v_mfma_f32_16x16x32_bf16 v[104:107], a[192:195], a[144:147], v[104:107]
  v_cvt_pk_bf16_f32 v98, v100, v101
  v_cvt_pk_bf16_f32 v99, v102, v103
  v_mfma_f32_16x16x32_bf16 v[136:139], a[232:235], a[132:135], v[136:139]
  buffer_store_dwordx4 v[96:99], v225, s[4:7], s20 offen offset:0 sc1
  v_mfma_f32_16x16x32_bf16 v[136:139], a[192:195], a[148:151], v[136:139]
  v_mul_f32 v128, s43, v128
  v_mul_f32 v129, s43, v129
  v_mfma_f32_16x16x32_bf16 v[168:171], a[232:235], a[136:139], v[168:171]
  v_mul_f32 v130, s43, v130
  v_mul_f32 v131, s43, v131
  v_mfma_f32_16x16x32_bf16 v[168:171], a[192:195], a[152:155], v[168:171]
  v_mul_f32 v132, s43, v132
  v_mul_f32 v133, s43, v133
  v_mfma_f32_16x16x32_bf16 v[200:203], a[232:235], a[140:143], v[200:203]
  ds_read_b64_tr_b16 a[232:233], v235 offset:16384
  ds_read_b64_tr_b16 a[234:235], v235 offset:18432
  v_mul_f32 v134, s43, v134
  v_mfma_f32_16x16x32_bf16 v[200:203], a[192:195], a[156:159], v[200:203]
  ds_read_b64_tr_b16 a[192:193], v230 offset:61440
  ds_read_b64_tr_b16 a[194:195], v230 offset:63488
  v_mul_f32 v135, s43, v135
  v_mfma_f32_16x16x32_bf16 v[108:111], a[196:199], a[128:131], v[108:111]
  v_exp_f32 v128, v128
  v_mfma_f32_16x16x32_bf16 v[108:111], a[200:203], a[144:147], v[108:111]
  v_exp_f32 v129, v129
  v_mfma_f32_16x16x32_bf16 v[140:143], a[196:199], a[132:135], v[140:143]
  v_exp_f32 v130, v130
  v_mfma_f32_16x16x32_bf16 v[140:143], a[200:203], a[148:151], v[140:143]
  v_exp_f32 v131, v131
  v_mfma_f32_16x16x32_bf16 v[172:175], a[196:199], a[136:139], v[172:175]
  v_exp_f32 v132, v132
  v_mfma_f32_16x16x32_bf16 v[172:175], a[200:203], a[152:155], v[172:175]
  v_exp_f32 v133, v133
  v_mfma_f32_16x16x32_bf16 v[204:207], a[196:199], a[140:143], v[204:207]
  ds_read_b64_tr_b16 a[196:197], v234 offset:24576
  ds_read_b64_tr_b16 a[198:199], v234 offset:26624
  v_mfma_f32_16x16x32_bf16 v[204:207], a[200:203], a[156:159], v[204:207]
  ds_read_b64_tr_b16 a[200:201], v231 offset:61440
  ds_read_b64_tr_b16 a[202:203], v231 offset:63488
  s_waitcnt lgkmcnt(13)
  v_mfma_f32_16x16x32_bf16 v[120:123], a[204:207], a[128:131], v[120:123]
  v_exp_f32 v134, v134
  v_mfma_f32_16x16x32_bf16 v[120:123], a[208:211], a[144:147], v[120:123]
  v_exp_f32 v135, v135
  v_add_f32 v128, 1.0, v128
  v_add_f32 v129, 1.0, v129
  v_mfma_f32_16x16x32_bf16 v[152:155], a[204:207], a[132:135], v[152:155]
  v_add_f32 v130, 1.0, v130
  v_add_f32 v131, 1.0, v131
  v_mfma_f32_16x16x32_bf16 v[152:155], a[208:211], a[148:151], v[152:155]
  v_add_f32 v132, 1.0, v132
  v_add_f32 v133, 1.0, v133
  v_mfma_f32_16x16x32_bf16 v[184:187], a[204:207], a[136:139], v[184:187]
  v_add_f32 v134, 1.0, v134
  v_add_f32 v135, 1.0, v135
  v_mfma_f32_16x16x32_bf16 v[184:187], a[208:211], a[152:155], v[184:187]
  v_rcp_f32 v128, v128
  v_mfma_f32_16x16x32_bf16 v[216:219], a[204:207], a[140:143], v[216:219]
  ds_read_b64_tr_b16 a[204:205], v235 offset:24576
  ds_read_b64_tr_b16 a[206:207], v235 offset:26624
  v_mfma_f32_16x16x32_bf16 v[216:219], a[208:211], a[156:159], v[216:219]
  ds_read_b64_tr_b16 a[208:209], v234 offset:53248
  ds_read_b64_tr_b16 a[210:211], v234 offset:55296
  v_mfma_f32_16x16x32_bf16 v[124:127], a[212:215], a[128:131], v[124:127]
  v_rcp_f32 v129, v129
  v_mfma_f32_16x16x32_bf16 v[124:127], a[216:219], a[144:147], v[124:127]
  v_rcp_f32 v130, v130
  v_mfma_f32_16x16x32_bf16 v[156:159], a[212:215], a[132:135], v[156:159]
  v_rcp_f32 v131, v131
  v_mfma_f32_16x16x32_bf16 v[156:159], a[216:219], a[148:151], v[156:159]
  v_rcp_f32 v132, v132
  v_mfma_f32_16x16x32_bf16 v[188:191], a[212:215], a[136:139], v[188:191]
  v_rcp_f32 v133, v133
  v_mfma_f32_16x16x32_bf16 v[188:191], a[216:219], a[152:155], v[188:191]
  v_rcp_f32 v134, v134
  v_mfma_f32_16x16x32_bf16 v[220:223], a[212:215], a[140:143], v[220:223]
  ds_read_b64_tr_b16 a[212:213], v238 offset:0
  ds_read_b64_tr_b16 a[214:215], v238 offset:2048
  v_rcp_f32 v135, v135
  v_mul_f32 v128, v128, v144
  v_mfma_f32_16x16x32_bf16 v[220:223], a[216:219], a[156:159], v[220:223]
  ds_read_b64_tr_b16 a[216:217], v235 offset:53248
  ds_read_b64_tr_b16 a[218:219], v235 offset:55296
  v_mul_f32 v129, v129, v145
  s_waitcnt lgkmcnt(13)
  v_mfma_f32_16x16x32_bf16 v[104:107], a[220:223], a[160:163], v[104:107]
  v_mul_f32 v130, v130, v146
  v_mul_f32 v131, v131, v147
  v_mfma_f32_16x16x32_bf16 v[104:107], a[224:227], a[176:179], v[104:107]
  s_barrier
  v_mul_f32 v132, v132, v148
  v_mul_f32 v133, v133, v149
  v_mfma_f32_16x16x32_bf16 v[136:139], a[220:223], a[164:167], v[136:139]
  s_mov_b32 s41, 2228224
  s_add_u32 m0, s42, 57344
  v_mul_f32 v134, v134, v150
  v_mul_f32 v135, v135, v151
  v_mfma_f32_16x16x32_bf16 v[136:139], a[224:227], a[180:183], v[136:139]
  buffer_load_dwordx4 v253, s[44:47], s41 offen offset:0 lds
  v_cvt_pk_bf16_f32 v128, v128, v129
  v_mfma_f32_16x16x32_bf16 v[168:171], a[220:223], a[168:171], v[168:171]
  s_mov_b32 s41, 2293760
  s_add_u32 m0, s42, 65536
  v_cvt_pk_bf16_f32 v129, v130, v131
  v_cvt_pk_bf16_f32 v130, v132, v133
  v_mfma_f32_16x16x32_bf16 v[168:171], a[224:227], a[184:187], v[168:171]
  buffer_load_dword v244, v243, s[4:7], s91 offen sc1
  v_cvt_pk_bf16_f32 v131, v134, v135
  v_mfma_f32_16x16x32_bf16 v[200:203], a[220:223], a[172:175], v[200:203]
  ds_read_b64_tr_b16 a[220:221], v239 offset:0
  ds_read_b64_tr_b16 a[222:223], v239 offset:2048
  buffer_store_dwordx4 v[128:131], v225, s[4:7], s20 offen offset:1024 sc1
  v_mul_f32 v160, s43, v160
  v_mfma_f32_16x16x32_bf16 v[200:203], a[224:227], a[188:191], v[200:203]
  ds_read_b64_tr_b16 a[224:225], v234 offset:12288
  ds_read_b64_tr_b16 a[226:227], v234 offset:14336
  v_mul_f32 v161, s43, v161
  v_mfma_f32_16x16x32_bf16 v[108:111], a[228:231], a[160:163], v[108:111]
  buffer_load_dwordx4 v242, s[44:47], s41 offen offset:0 lds
  v_mul_f32 v162, s43, v162
  v_mul_f32 v163, s43, v163
  v_mfma_f32_16x16x32_bf16 v[108:111], a[232:235], a[176:179], v[108:111]
  s_mov_b32 s41, 2555904
  s_add_u32 m0, s42, 94208
  v_mul_f32 v164, s43, v164
  v_mul_f32 v165, s43, v165
  v_mfma_f32_16x16x32_bf16 v[140:143], a[228:231], a[164:167], v[140:143]
  v_mul_f32 v166, s43, v166
  v_mul_f32 v167, s43, v167
  v_mfma_f32_16x16x32_bf16 v[140:143], a[232:235], a[180:183], v[140:143]
  v_exp_f32 v160, v160
  v_mfma_f32_16x16x32_bf16 v[172:175], a[228:231], a[168:171], v[172:175]
  v_exp_f32 v161, v161
  v_mfma_f32_16x16x32_bf16 v[172:175], a[232:235], a[184:187], v[172:175]
  v_exp_f32 v162, v162
  v_mfma_f32_16x16x32_bf16 v[204:207], a[228:231], a[172:175], v[204:207]
  buffer_load_dwordx4 v242, s[44:47], s41 offen offset:0 lds
  v_mfma_f32_16x16x32_bf16 v[204:207], a[232:235], a[188:191], v[204:207]
  ds_read_b64_tr_b16 a[228:229], v234 offset:8192
  ds_read_b64_tr_b16 a[230:231], v234 offset:10240
  s_waitcnt lgkmcnt(13)
  v_mfma_f32_16x16x32_bf16 v[120:123], a[192:195], a[160:163], v[120:123]
  ds_read_b64_tr_b16 a[232:233], v235 offset:12288
  ds_read_b64_tr_b16 a[234:235], v235 offset:14336
  v_exp_f32 v163, v163
  v_mfma_f32_16x16x32_bf16 v[120:123], a[196:199], a[176:179], v[120:123]
  s_mov_b32 s41, 2293760
  s_add_u32 m0, s42, 106496
  v_exp_f32 v164, v164
  v_mfma_f32_16x16x32_bf16 v[152:155], a[192:195], a[164:167], v[152:155]
  v_exp_f32 v165, v165
  v_mfma_f32_16x16x32_bf16 v[152:155], a[196:199], a[180:183], v[152:155]
  v_exp_f32 v166, v166
  v_mfma_f32_16x16x32_bf16 v[184:187], a[192:195], a[168:171], v[184:187]
  buffer_load_dwordx4 v253, s[44:47], s41 offen offset:0 lds
L_wk1_7:
  s_cbranch_vccnz L_wk1_11
  v_exp_f32 v167, v167
  v_add_f32 v160, 1.0, v160
  v_mfma_f32_16x16x32_bf16 v[184:187], a[196:199], a[184:187], v[184:187]
  s_mov_b32 s41, 2555904
  s_add_u32 m0, s42, 114688
  v_add_f32 v161, 1.0, v161
  v_add_f32 v162, 1.0, v162
  v_mfma_f32_16x16x32_bf16 v[216:219], a[192:195], a[172:175], v[216:219]
  ds_read_b64_tr_b16 a[192:193], v235 offset:8192
  ds_read_b64_tr_b16 a[194:195], v235 offset:10240
  v_add_f32 v163, 1.0, v163
  v_add_f32 v164, 1.0, v164
  v_mfma_f32_16x16x32_bf16 v[216:219], a[196:199], a[188:191], v[216:219]
  ds_read_b64_tr_b16 a[196:197], v234 offset:20480
  ds_read_b64_tr_b16 a[198:199], v234 offset:22528
  v_add_f32 v165, 1.0, v165
  v_mfma_f32_16x16x32_bf16 v[124:127], a[200:203], a[160:163], v[124:127]
  v_add_f32 v166, 1.0, v166
  v_add_f32 v167, 1.0, v167
  s_waitcnt lgkmcnt(13)
  v_mfma_f32_16x16x32_bf16 v[124:127], a[204:207], a[176:179], v[124:127]
  v_rcp_f32 v160, v160
  v_mfma_f32_16x16x32_bf16 v[156:159], a[200:203], a[164:167], v[156:159]
  buffer_load_dwordx4 v253, s[44:47], s41 offen offset:0 lds
  v_mfma_f32_16x16x32_bf16 v[156:159], a[204:207], a[180:183], v[156:159]
  s_mov_b32 s41, 2883584
  s_add_u32 m0, s42, 143360
  v_rcp_f32 v161, v161
  v_mfma_f32_16x16x32_bf16 v[188:191], a[200:203], a[168:171], v[188:191]
  v_rcp_f32 v162, v162
  v_mfma_f32_16x16x32_bf16 v[188:191], a[204:207], a[184:187], v[188:191]
  v_rcp_f32 v163, v163
  v_mfma_f32_16x16x32_bf16 v[220:223], a[200:203], a[172:175], v[220:223]
  ds_read_b64_tr_b16 a[200:201], v234 offset:36864
  ds_read_b64_tr_b16 a[202:203], v234 offset:38912
  v_rcp_f32 v164, v164
  v_mfma_f32_16x16x32_bf16 v[220:223], a[204:207], a[188:191], v[220:223]
  ds_read_b64_tr_b16 a[204:205], v235 offset:20480
  ds_read_b64_tr_b16 a[206:207], v235 offset:22528
  v_mfma_f32_16x16x32_bf16 v[104:107], a[208:211], a[0:3], v[104:107]
  buffer_load_dwordx4 v242, s[44:47], s41 offen offset:0 lds
  v_rcp_f32 v165, v165
  v_mfma_f32_16x16x32_bf16 v[104:107], a[212:215], a[16:19], v[104:107]
  s_mov_b32 s41, 3145728
  s_add_u32 m0, s42, 69632
  v_rcp_f32 v166, v166
  v_mfma_f32_16x16x32_bf16 v[136:139], a[208:211], a[4:7], v[136:139]
  v_rcp_f32 v167, v167
  v_mul_f32 v160, v160, v176
  v_mul_f32 v161, v161, v177
  v_mfma_f32_16x16x32_bf16 v[136:139], a[212:215], a[20:23], v[136:139]
  v_mul_f32 v162, v162, v178
  v_mul_f32 v163, v163, v179
  v_mfma_f32_16x16x32_bf16 v[168:171], a[208:211], a[8:11], v[168:171]
  v_mul_f32 v164, v164, v180
  v_mul_f32 v165, v165, v181
  v_mfma_f32_16x16x32_bf16 v[168:171], a[212:215], a[24:27], v[168:171]
  v_mul_f32 v166, v166, v182
  v_mul_f32 v167, v167, v183
  v_mfma_f32_16x16x32_bf16 v[200:203], a[208:211], a[12:15], v[200:203]
  buffer_load_dwordx4 v242, s[44:47], s41 offen offset:0 lds
  v_cvt_pk_bf16_f32 v160, v160, v161
  v_mfma_f32_16x16x32_bf16 v[200:203], a[212:215], a[28:31], v[200:203]
  ds_read_b64_tr_b16 a[208:209], v235 offset:36864
  ds_read_b64_tr_b16 a[210:211], v235 offset:38912
  v_cvt_pk_bf16_f32 v161, v162, v163
  s_waitcnt lgkmcnt(13)
  v_mfma_f32_16x16x32_bf16 v[108:111], a[216:219], a[0:3], v[108:111]
  ds_read_b64_tr_b16 a[212:213], v234 offset:32768
  ds_read_b64_tr_b16 a[214:215], v234 offset:34816
  v_cvt_pk_bf16_f32 v162, v164, v165
  v_cvt_pk_bf16_f32 v163, v166, v167
  v_mfma_f32_16x16x32_bf16 v[108:111], a[220:223], a[16:19], v[108:111]
  s_mov_b32 s41, 2883584
  s_add_u32 m0, s42, 81920
  v_mfma_f32_16x16x32_bf16 v[140:143], a[216:219], a[4:7], v[140:143]
  buffer_store_dwordx4 v[160:163], v225, s[4:7], s20 offen offset:2048 sc1
  v_mul_f32 v192, s43, v192
  v_mul_f32 v193, s43, v193
  v_mfma_f32_16x16x32_bf16 v[140:143], a[220:223], a[20:23], v[140:143]
  v_mul_f32 v194, s43, v194
  v_mul_f32 v195, s43, v195
  v_mfma_f32_16x16x32_bf16 v[172:175], a[216:219], a[8:11], v[172:175]
  buffer_load_dwordx4 v253, s[44:47], s41 offen offset:0 lds
  v_mul_f32 v196, s43, v196
  v_mfma_f32_16x16x32_bf16 v[172:175], a[220:223], a[24:27], v[172:175]
  s_waitcnt vmcnt(9)
  v_subrev_u32 v244, s100, v244
  v_cmp_lt_u32 s[68:69], 7, v244
  v_mul_f32 v197, s43, v197
  v_mul_f32 v198, s43, v198
  v_mfma_f32_16x16x32_bf16 v[204:207], a[216:219], a[12:15], v[204:207]
  ds_read_b64_tr_b16 a[216:217], v234 offset:45056
  ds_read_b64_tr_b16 a[218:219], v234 offset:47104
  s_cmp_lg_u64 s[68:69], 0
  s_cbranch_scc1 L_slow_29
L_back_30:
  v_mul_f32 v199, s43, v199
  v_mfma_f32_16x16x32_bf16 v[204:207], a[220:223], a[28:31], v[204:207]
  ds_read_b64_tr_b16 a[220:221], v235 offset:32768
  ds_read_b64_tr_b16 a[222:223], v235 offset:34816
  v_mfma_f32_16x16x32_bf16 v[120:123], a[224:227], a[0:3], v[120:123]
  s_mov_b32 s40, 17825792
  v_exp_f32 v192, v192
  s_waitcnt lgkmcnt(13)
  v_mfma_f32_16x16x32_bf16 v[120:123], a[228:231], a[16:19], v[120:123]
  v_exp_f32 v193, v193
  v_mfma_f32_16x16x32_bf16 v[152:155], a[224:227], a[4:7], v[152:155]
  buffer_load_dwordx4 a[64:67], v252, s[4:7], s40 offen offset:0 sc1
  v_exp_f32 v194, v194
  v_mfma_f32_16x16x32_bf16 v[152:155], a[228:231], a[20:23], v[152:155]
  v_exp_f32 v195, v195
  v_mfma_f32_16x16x32_bf16 v[184:187], a[224:227], a[8:11], v[184:187]
  v_exp_f32 v196, v196
  v_mfma_f32_16x16x32_bf16 v[184:187], a[228:231], a[24:27], v[184:187]
  v_exp_f32 v197, v197
  v_mfma_f32_16x16x32_bf16 v[216:219], a[224:227], a[12:15], v[216:219]
  ds_read_b64_tr_b16 a[224:225], v235 offset:45056
  ds_read_b64_tr_b16 a[226:227], v235 offset:47104
  v_exp_f32 v198, v198
  v_mfma_f32_16x16x32_bf16 v[216:219], a[228:231], a[28:31], v[216:219]
  ds_read_b64_tr_b16 a[228:229], v232 offset:61440
  ds_read_b64_tr_b16 a[230:231], v232 offset:63488
  v_mfma_f32_16x16x32_bf16 v[124:127], a[232:235], a[0:3], v[124:127]
  buffer_load_dwordx4 a[68:71], v252, s[4:7], s40 offen offset:1024 sc1
  v_exp_f32 v199, v199
  v_add_f32 v192, 1.0, v192
  v_add_f32 v193, 1.0, v193
  v_mfma_f32_16x16x32_bf16 v[124:127], a[192:195], a[16:19], v[124:127]
  s_barrier
  v_add_f32 v194, 1.0, v194
  v_add_f32 v195, 1.0, v195
  v_mfma_f32_16x16x32_bf16 v[156:159], a[232:235], a[4:7], v[156:159]
  s_mov_b32 s40, 17956864
  v_add_f32 v196, 1.0, v196
  v_add_f32 v197, 1.0, v197
  v_mfma_f32_16x16x32_bf16 v[156:159], a[192:195], a[20:23], v[156:159]
  v_add_f32 v198, 1.0, v198
  v_add_f32 v199, 1.0, v199
  v_mfma_f32_16x16x32_bf16 v[188:191], a[232:235], a[8:11], v[188:191]
  v_rcp_f32 v192, v192
  v_mfma_f32_16x16x32_bf16 v[188:191], a[192:195], a[24:27], v[188:191]
  v_rcp_f32 v193, v193
  v_mfma_f32_16x16x32_bf16 v[220:223], a[232:235], a[12:15], v[220:223]
  buffer_load_dwordx4 a[72:75], v252, s[4:7], s40 offen offset:0 sc1
  v_mfma_f32_16x16x32_bf16 v[220:223], a[192:195], a[28:31], v[220:223]
  ds_read_b64_tr_b16 a[232:233], v232 offset:57344
  ds_read_b64_tr_b16 a[234:235], v232 offset:59392
  s_waitcnt lgkmcnt(13)
  v_mfma_f32_16x16x32_bf16 v[104:107], a[196:199], a[32:35], v[104:107]
  ds_read_b64_tr_b16 a[192:193], v233 offset:61440
  ds_read_b64_tr_b16 a[194:195], v233 offset:63488
  v_rcp_f32 v194, v194
  v_mfma_f32_16x16x32_bf16 v[104:107], a[200:203], a[48:51], v[104:107]
  v_rcp_f32 v195, v195
  v_mfma_f32_16x16x32_bf16 v[136:139], a[196:199], a[36:39], v[136:139]
  v_rcp_f32 v196, v196
  v_mfma_f32_16x16x32_bf16 v[136:139], a[200:203], a[52:55], v[136:139]
  v_rcp_f32 v197, v197
  v_mfma_f32_16x16x32_bf16 v[168:171], a[196:199], a[40:43], v[168:171]
  buffer_load_dwordx4 a[76:79], v252, s[4:7], s40 offen offset:1024 sc1
  v_rcp_f32 v198, v198
  v_mfma_f32_16x16x32_bf16 v[168:171], a[200:203], a[56:59], v[168:171]
  s_mov_b32 s40, 18087936
  v_rcp_f32 v199, v199
  v_mul_f32 v192, v192, v208
  v_mfma_f32_16x16x32_bf16 v[200:203], a[196:199], a[44:47], v[200:203]
  ds_read_b64_tr_b16 a[196:197], v233 offset:57344
  ds_read_b64_tr_b16 a[198:199], v233 offset:59392
  v_mul_f32 v193, v193, v209
  v_mul_f32 v194, v194, v210
  v_mfma_f32_16x16x32_bf16 v[200:203], a[200:203], a[60:63], v[200:203]
  ds_read_b64_tr_b16 a[200:201], v234 offset:61440
  ds_read_b64_tr_b16 a[202:203], v234 offset:63488
  v_mul_f32 v195, v195, v211
  v_mfma_f32_16x16x32_bf16 v[108:111], a[204:207], a[32:35], v[108:111]
  v_mul_f32 v196, v196, v212
  v_mul_f32 v197, v197, v213
  s_waitcnt lgkmcnt(13)
  v_mfma_f32_16x16x32_bf16 v[108:111], a[208:211], a[48:51], v[108:111]
  v_mul_f32 v198, v198, v214
  v_mul_f32 v199, v199, v215
  v_mfma_f32_16x16x32_bf16 v[140:143], a[204:207], a[36:39], v[140:143]
  buffer_load_dwordx4 a[80:83], v252, s[4:7], s40 offen offset:0 sc1
  v_cvt_pk_bf16_f32 v192, v192, v193
  v_cvt_pk_bf16_f32 v193, v194, v195
  v_mfma_f32_16x16x32_bf16 v[140:143], a[208:211], a[52:55], v[140:143]
  v_cvt_pk_bf16_f32 v194, v196, v197
  v_cvt_pk_bf16_f32 v195, v198, v199
  v_mfma_f32_16x16x32_bf16 v[172:175], a[204:207], a[40:43], v[172:175]
  buffer_store_dwordx4 v[192:195], v225, s[4:7], s20 offen offset:3072 sc1
  v_mfma_f32_16x16x32_bf16 v[172:175], a[208:211], a[56:59], v[172:175]
  v_mfma_f32_16x16x32_bf16 v[204:207], a[204:207], a[44:47], v[204:207]
  ds_read_b64_tr_b16 a[204:205], v234 offset:57344
  ds_read_b64_tr_b16 a[206:207], v234 offset:59392
  v_mfma_f32_16x16x32_bf16 v[204:207], a[208:211], a[60:63], v[204:207]
  ds_read_b64_tr_b16 a[208:209], v235 offset:61440
  ds_read_b64_tr_b16 a[210:211], v235 offset:63488
  v_mfma_f32_16x16x32_bf16 v[120:123], a[212:215], a[32:35], v[120:123]
  buffer_load_dwordx4 a[84:87], v252, s[4:7], s40 offen offset:1024 sc1
  v_mfma_f32_16x16x32_bf16 v[120:123], a[216:219], a[48:51], v[120:123]
  s_mov_b32 s40, 18219008
  v_mfma_f32_16x16x32_bf16 v[152:155], a[212:215], a[36:39], v[152:155]
  v_mfma_f32_16x16x32_bf16 v[152:155], a[216:219], a[52:55], v[152:155]
  v_mfma_f32_16x16x32_bf16 v[184:187], a[212:215], a[40:43], v[184:187]
  v_mfma_f32_16x16x32_bf16 v[184:187], a[216:219], a[56:59], v[184:187]
  v_mfma_f32_16x16x32_bf16 v[216:219], a[212:215], a[44:47], v[216:219]
  buffer_load_dwordx4 a[88:91], v252, s[4:7], s40 offen offset:0 sc1
  v_mfma_f32_16x16x32_bf16 v[216:219], a[216:219], a[60:63], v[216:219]
  ds_read_b64_tr_b16 a[212:213], v235 offset:57344
  ds_read_b64_tr_b16 a[214:215], v235 offset:59392
  s_waitcnt lgkmcnt(13)
  v_mfma_f32_16x16x32_bf16 v[124:127], a[220:223], a[32:35], v[124:127]
  ds_read_b64_tr_b16 a[216:217], v236 offset:4096
  ds_read_b64_tr_b16 a[218:219], v236 offset:6144
  v_mfma_f32_16x16x32_bf16 v[124:127], a[224:227], a[48:51], v[124:127]
  v_mfma_f32_16x16x32_bf16 v[156:159], a[220:223], a[36:39], v[156:159]
  v_mfma_f32_16x16x32_bf16 v[156:159], a[224:227], a[52:55], v[156:159]
  v_mfma_f32_16x16x32_bf16 v[188:191], a[220:223], a[40:43], v[188:191]
  buffer_load_dwordx4 a[92:95], v252, s[4:7], s40 offen offset:1024 sc1
  v_mfma_f32_16x16x32_bf16 v[188:191], a[224:227], a[56:59], v[188:191]
  s_mov_b32 s40, 18350080
  v_mfma_f32_16x16x32_bf16 v[220:223], a[220:223], a[44:47], v[220:223]
  ds_read_b64_tr_b16 a[220:221], v236 offset:20480
  ds_read_b64_tr_b16 a[222:223], v236 offset:22528
  v_mfma_f32_16x16x32_bf16 v[220:223], a[224:227], a[60:63], v[220:223]
  ds_read_b64_tr_b16 a[224:225], v237 offset:4096
  ds_read_b64_tr_b16 a[226:227], v237 offset:6144
  s_waitcnt vmcnt(5)
  v_mfma_f32_16x16x32_bf16 v[32:35], a[228:231], a[64:67], 0
  v_mul_f32 v104, s43, v104
  v_mul_f32 v105, s43, v105
  s_waitcnt lgkmcnt(13)
  v_mfma_f32_16x16x32_bf16 v[32:35], a[232:235], a[72:75], v[32:35]
  s_barrier
  v_mfma_f32_16x16x32_bf16 v[48:51], a[228:231], a[68:71], 0
  buffer_load_dwordx4 a[96:99], v252, s[4:7], s40 offen offset:0 sc1
  v_mfma_f32_16x16x32_bf16 v[48:51], a[232:235], a[76:79], v[48:51]
  ds_read_b64_tr_b16 a[228:229], v237 offset:20480
  ds_read_b64_tr_b16 a[230:231], v237 offset:22528
  v_mul_f32 v106, s43, v106
  v_mfma_f32_16x16x32_bf16 v[36:39], a[192:195], a[64:67], 0
  ds_read_b64_tr_b16 a[232:233], v238 offset:4096
  ds_read_b64_tr_b16 a[234:235], v238 offset:6144
  v_mul_f32 v107, s43, v107
  v_mfma_f32_16x16x32_bf16 v[36:39], a[196:199], a[72:75], v[36:39]
  v_mul_f32 v108, s43, v108
  v_mul_f32 v109, s43, v109
  v_mfma_f32_16x16x32_bf16 v[52:55], a[192:195], a[68:71], 0
  buffer_load_dwordx4 a[100:103], v252, s[4:7], s40 offen offset:1024 sc1
  v_mfma_f32_16x16x32_bf16 v[52:55], a[196:199], a[76:79], v[52:55]
  ds_read_b64_tr_b16 a[192:193], v238 offset:20480
  ds_read_b64_tr_b16 a[194:195], v238 offset:22528
  s_waitcnt lgkmcnt(13)
  v_mfma_f32_16x16x32_bf16 v[40:43], a[200:203], a[64:67], 0
  ds_read_b64_tr_b16 a[196:197], v239 offset:4096
  ds_read_b64_tr_b16 a[198:199], v239 offset:6144
  v_mul_f32 v110, s43, v110
  v_mfma_f32_16x16x32_bf16 v[40:43], a[204:207], a[72:75], v[40:43]
  s_mov_b32 s40, 18481152
  v_mul_f32 v111, s43, v111
  v_mfma_f32_16x16x32_bf16 v[56:59], a[200:203], a[68:71], 0
  buffer_load_dwordx4 a[104:107], v252, s[4:7], s40 offen offset:0 sc1
  v_mfma_f32_16x16x32_bf16 v[56:59], a[204:207], a[76:79], v[56:59]
  ds_read_b64_tr_b16 a[200:201], v239 offset:20480
  ds_read_b64_tr_b16 a[202:203], v239 offset:22528
  v_mfma_f32_16x16x32_bf16 v[44:47], a[208:211], a[64:67], 0
  ds_read_b64_tr_b16 a[204:205], v236 offset:16384
  ds_read_b64_tr_b16 a[206:207], v236 offset:18432
  s_waitcnt lgkmcnt(13)
  v_mfma_f32_16x16x32_bf16 v[44:47], a[212:215], a[72:75], v[44:47]
  v_exp_f32 v104, v104
  v_mfma_f32_16x16x32_bf16 v[60:63], a[208:211], a[68:71], 0
  buffer_load_dwordx4 a[108:111], v252, s[4:7], s40 offen offset:1024 sc1
  v_mfma_f32_16x16x32_bf16 v[60:63], a[212:215], a[76:79], v[60:63]
  ds_read_b64_tr_b16 a[208:209], v236 offset:28672
  ds_read_b64_tr_b16 a[210:211], v236 offset:30720
  v_mfma_f32_16x16x32_bf16 v[0:3], a[216:219], a[64:67], 0
  ds_read_b64_tr_b16 a[212:213], v237 offset:16384
  ds_read_b64_tr_b16 a[214:215], v237 offset:18432
  v_exp_f32 v105, v105
  v_mfma_f32_16x16x32_bf16 v[0:3], a[220:223], a[72:75], v[0:3]
  s_mov_b32 s40, 18612224
  v_mfma_f32_16x16x32_bf16 v[16:19], a[216:219], a[68:71], 0
  buffer_load_dwordx4 a[112:115], v252, s[4:7], s40 offen offset:0 sc1
  v_mfma_f32_16x16x32_bf16 v[16:19], a[220:223], a[76:79], v[16:19]
  ds_read_b64_tr_b16 a[216:217], v237 offset:28672
  ds_read_b64_tr_b16 a[218:219], v237 offset:30720
  v_exp_f32 v106, v106
  s_waitcnt lgkmcnt(13)
  v_mfma_f32_16x16x32_bf16 v[4:7], a[224:227], a[64:67], 0
  ds_read_b64_tr_b16 a[220:221], v238 offset:16384
  ds_read_b64_tr_b16 a[222:223], v238 offset:18432
  v_mfma_f32_16x16x32_bf16 v[4:7], a[228:231], a[72:75], v[4:7]
  v_exp_f32 v107, v107
  v_mfma_f32_16x16x32_bf16 v[20:23], a[224:227], a[68:71], 0
  buffer_load_dwordx4 a[116:119], v252, s[4:7], s40 offen offset:1024 sc1
  v_mfma_f32_16x16x32_bf16 v[20:23], a[228:231], a[76:79], v[20:23]
  ds_read_b64_tr_b16 a[224:225], v238 offset:28672
  ds_read_b64_tr_b16 a[226:227], v238 offset:30720
  v_mfma_f32_16x16x32_bf16 v[8:11], a[232:235], a[64:67], 0
  ds_read_b64_tr_b16 a[228:229], v239 offset:16384
  ds_read_b64_tr_b16 a[230:231], v239 offset:18432
  v_exp_f32 v108, v108
  s_waitcnt lgkmcnt(13)
  v_mfma_f32_16x16x32_bf16 v[8:11], a[192:195], a[72:75], v[8:11]
  s_mov_b32 s40, 18743296
  v_mfma_f32_16x16x32_bf16 v[24:27], a[232:235], a[68:71], 0
  buffer_load_dwordx4 a[120:123], v252, s[4:7], s40 offen offset:0 sc1
  v_mfma_f32_16x16x32_bf16 v[24:27], a[192:195], a[76:79], v[24:27]
  ds_read_b64_tr_b16 a[232:233], v239 offset:28672
  ds_read_b64_tr_b16 a[234:235], v239 offset:30720
  v_exp_f32 v109, v109
  v_mfma_f32_16x16x32_bf16 v[12:15], a[196:199], a[64:67], 0
  ds_read_b64_tr_b16 a[192:193], v228 offset:16384
  ds_read_b64_tr_b16 a[194:195], v228 offset:18432
  v_mfma_f32_16x16x32_bf16 v[12:15], a[200:203], a[72:75], v[12:15]
  v_exp_f32 v110, v110
  v_mfma_f32_16x16x32_bf16 v[28:31], a[196:199], a[68:71], 0
  buffer_load_dwordx4 a[124:127], v252, s[4:7], s40 offen offset:1024 sc1
  v_mfma_f32_16x16x32_bf16 v[28:31], a[200:203], a[76:79], v[28:31]
  ds_read_b64_tr_b16 a[196:197], v228 offset:28672
  ds_read_b64_tr_b16 a[198:199], v228 offset:30720
  s_waitcnt vmcnt(8) lgkmcnt(13)
  v_mfma_f32_16x16x32_bf16 v[32:35], a[204:207], a[80:83], v[32:35]
  ds_read_b64_tr_b16 a[200:201], v229 offset:16384
  ds_read_b64_tr_b16 a[202:203], v229 offset:18432
  v_exp_f32 v111, v111
  v_add_f32 v104, 1.0, v104
  v_mfma_f32_16x16x32_bf16 v[32:35], a[208:211], a[88:91], v[32:35]
  s_barrier
  v_mfma_f32_16x16x32_bf16 v[48:51], a[204:207], a[84:87], v[48:51]
  ds_read_b64_tr_b16 a[204:205], v229 offset:28672
  ds_read_b64_tr_b16 a[206:207], v229 offset:30720
  v_add_f32 v105, 1.0, v105
  v_mfma_f32_16x16x32_bf16 v[48:51], a[208:211], a[92:95], v[48:51]
  ds_read_b64_tr_b16 a[208:209], v230 offset:16384
  ds_read_b64_tr_b16 a[210:211], v230 offset:18432
  v_add_f32 v106, 1.0, v106
  v_mfma_f32_16x16x32_bf16 v[36:39], a[212:215], a[80:83], v[36:39]
  s_mov_b32 s40, 18874368
  v_add_f32 v107, 1.0, v107
  s_waitcnt lgkmcnt(13)
  v_mfma_f32_16x16x32_bf16 v[36:39], a[216:219], a[88:91], v[36:39]
  buffer_load_dwordx4 a[128:131], v252, s[4:7], s40 offen offset:0 sc1
  v_mfma_f32_16x16x32_bf16 v[52:55], a[212:215], a[84:87], v[52:55]
  ds_read_b64_tr_b16 a[212:213], v230 offset:28672
  ds_read_b64_tr_b16 a[214:215], v230 offset:30720
  v_add_f32 v108, 1.0, v108
  v_mfma_f32_16x16x32_bf16 v[52:55], a[216:219], a[92:95], v[52:55]
  ds_read_b64_tr_b16 a[216:217], v231 offset:16384
  ds_read_b64_tr_b16 a[218:219], v231 offset:18432
  v_add_f32 v109, 1.0, v109
  v_mfma_f32_16x16x32_bf16 v[40:43], a[220:223], a[80:83], v[40:43]
  buffer_load_dwordx4 a[132:135], v252, s[4:7], s40 offen offset:1024 sc1
  v_add_f32 v110, 1.0, v110
  v_mfma_f32_16x16x32_bf16 v[40:43], a[224:227], a[88:91], v[40:43]
  s_mov_b32 s40, 19005440
  v_add_u32 v248, 2, v245
  buffer_store_dword v248, v246, s[4:7], s90 offen sc1
  v_mfma_f32_16x16x32_bf16 v[56:59], a[220:223], a[84:87], v[56:59]
  ds_read_b64_tr_b16 a[220:221], v231 offset:28672
  ds_read_b64_tr_b16 a[222:223], v231 offset:30720
  v_add_f32 v111, 1.0, v111
  v_mfma_f32_16x16x32_bf16 v[56:59], a[224:227], a[92:95], v[56:59]
  ds_read_b64_tr_b16 a[224:225], v236 offset:8192
  ds_read_b64_tr_b16 a[226:227], v236 offset:10240
  s_waitcnt lgkmcnt(13)
  v_mfma_f32_16x16x32_bf16 v[44:47], a[228:231], a[80:83], v[44:47]
  buffer_load_dwordx4 a[136:139], v252, s[4:7], s40 offen offset:0 sc1
  v_mfma_f32_16x16x32_bf16 v[44:47], a[232:235], a[88:91], v[44:47]
  v_rcp_f32 v104, v104
  v_mfma_f32_16x16x32_bf16 v[60:63], a[228:231], a[84:87], v[60:63]
  ds_read_b64_tr_b16 a[228:229], v236 offset:24576
  ds_read_b64_tr_b16 a[230:231], v236 offset:26624
  v_mfma_f32_16x16x32_bf16 v[60:63], a[232:235], a[92:95], v[60:63]
  ds_read_b64_tr_b16 a[232:233], v237 offset:8192
  ds_read_b64_tr_b16 a[234:235], v237 offset:10240
  v_mfma_f32_16x16x32_bf16 v[0:3], a[192:195], a[80:83], v[0:3]
  buffer_load_dwordx4 a[140:143], v252, s[4:7], s40 offen offset:1024 sc1
  v_rcp_f32 v105, v105
  v_mfma_f32_16x16x32_bf16 v[0:3], a[196:199], a[88:91], v[0:3]
  s_mov_b32 s40, 19136512
  v_mfma_f32_16x16x32_bf16 v[16:19], a[192:195], a[84:87], v[16:19]
  ds_read_b64_tr_b16 a[192:193], v237 offset:24576
  ds_read_b64_tr_b16 a[194:195], v237 offset:26624
  v_mfma_f32_16x16x32_bf16 v[16:19], a[196:199], a[92:95], v[16:19]
  ds_read_b64_tr_b16 a[196:197], v238 offset:8192
  ds_read_b64_tr_b16 a[198:199], v238 offset:10240
  v_rcp_f32 v106, v106
  s_waitcnt lgkmcnt(13)
  v_mfma_f32_16x16x32_bf16 v[4:7], a[200:203], a[80:83], v[4:7]
  buffer_load_dwordx4 a[144:147], v252, s[4:7], s40 offen offset:0 sc1
  v_mfma_f32_16x16x32_bf16 v[4:7], a[204:207], a[88:91], v[4:7]
  v_rcp_f32 v107, v107
  v_mfma_f32_16x16x32_bf16 v[20:23], a[200:203], a[84:87], v[20:23]
  ds_read_b64_tr_b16 a[200:201], v238 offset:24576
  ds_read_b64_tr_b16 a[202:203], v238 offset:26624
  v_mfma_f32_16x16x32_bf16 v[20:23], a[204:207], a[92:95], v[20:23]
  ds_read_b64_tr_b16 a[204:205], v239 offset:8192
  ds_read_b64_tr_b16 a[206:207], v239 offset:10240
  v_mfma_f32_16x16x32_bf16 v[8:11], a[208:211], a[80:83], v[8:11]
  buffer_load_dwordx4 a[148:151], v252, s[4:7], s40 offen offset:1024 sc1
  v_rcp_f32 v108, v108
  v_mfma_f32_16x16x32_bf16 v[8:11], a[212:215], a[88:91], v[8:11]
  s_mov_b32 s40, 19267584
  v_mfma_f32_16x16x32_bf16 v[24:27], a[208:211], a[84:87], v[24:27]
  ds_read_b64_tr_b16 a[208:209], v239 offset:24576
  ds_read_b64_tr_b16 a[210:211], v239 offset:26624
  v_mfma_f32_16x16x32_bf16 v[24:27], a[212:215], a[92:95], v[24:27]
  ds_read_b64_tr_b16 a[212:213], v228 offset:20480
  ds_read_b64_tr_b16 a[214:215], v228 offset:22528
  v_rcp_f32 v109, v109
  s_waitcnt lgkmcnt(13)
  v_mfma_f32_16x16x32_bf16 v[12:15], a[216:219], a[80:83], v[12:15]
  buffer_load_dwordx4 a[152:155], v252, s[4:7], s40 offen offset:0 sc1
  v_mfma_f32_16x16x32_bf16 v[12:15], a[220:223], a[88:91], v[12:15]
  v_rcp_f32 v110, v110
  v_mfma_f32_16x16x32_bf16 v[28:31], a[216:219], a[84:87], v[28:31]
  ds_read_b64_tr_b16 a[216:217], v228 offset:12288
  ds_read_b64_tr_b16 a[218:219], v228 offset:14336
  v_mfma_f32_16x16x32_bf16 v[28:31], a[220:223], a[92:95], v[28:31]
  ds_read_b64_tr_b16 a[220:221], v229 offset:20480
  ds_read_b64_tr_b16 a[222:223], v229 offset:22528
  s_waitcnt vmcnt(12)
  v_mfma_f32_16x16x32_bf16 v[32:35], a[224:227], a[96:99], v[32:35]
  buffer_load_dwordx4 a[156:159], v252, s[4:7], s40 offen offset:1024 sc1
  v_rcp_f32 v111, v111
  v_mul_f32 v104, v104, v120
  v_mfma_f32_16x16x32_bf16 v[32:35], a[228:231], a[104:107], v[32:35]
  s_barrier
  v_mfma_f32_16x16x32_bf16 v[48:51], a[224:227], a[100:103], v[48:51]
  ds_read_b64_tr_b16 a[224:225], v229 offset:12288
  ds_read_b64_tr_b16 a[226:227], v229 offset:14336
  v_mul_f32 v105, v105, v121
  v_mfma_f32_16x16x32_bf16 v[48:51], a[228:231], a[108:111], v[48:51]
  ds_read_b64_tr_b16 a[228:229], v230 offset:20480
  ds_read_b64_tr_b16 a[230:231], v230 offset:22528
  v_mul_f32 v106, v106, v122
  s_waitcnt lgkmcnt(13)
  v_mfma_f32_16x16x32_bf16 v[36:39], a[232:235], a[96:99], v[36:39]
  s_mov_b32 s41, 3145728
  s_add_u32 m0, s42, 61440
  v_mul_f32 v107, v107, v123
  v_mfma_f32_16x16x32_bf16 v[36:39], a[192:195], a[104:107], v[36:39]
  buffer_load_dwordx4 v253, s[44:47], s41 offen offset:0 lds
  v_mfma_f32_16x16x32_bf16 v[52:55], a[232:235], a[100:103], v[52:55]
  ds_read_b64_tr_b16 a[232:233], v230 offset:12288
  ds_read_b64_tr_b16 a[234:235], v230 offset:14336
  v_mul_f32 v108, v108, v124
  v_mfma_f32_16x16x32_bf16 v[52:55], a[192:195], a[108:111], v[52:55]
  ds_read_b64_tr_b16 a[192:193], v231 offset:20480
  ds_read_b64_tr_b16 a[194:195], v231 offset:22528
  v_mul_f32 v109, v109, v125
  v_mfma_f32_16x16x32_bf16 v[40:43], a[196:199], a[96:99], v[40:43]
  s_mov_b32 s40, 19398656
  v_mul_f32 v110, v110, v126
  v_mfma_f32_16x16x32_bf16 v[40:43], a[200:203], a[104:107], v[40:43]
  buffer_load_dwordx4 a[160:163], v252, s[4:7], s40 offen offset:0 sc1
  v_mfma_f32_16x16x32_bf16 v[56:59], a[196:199], a[100:103], v[56:59]
  ds_read_b64_tr_b16 a[196:197], v231 offset:12288
  ds_read_b64_tr_b16 a[198:199], v231 offset:14336
  v_mul_f32 v111, v111, v127
  v_mfma_f32_16x16x32_bf16 v[56:59], a[200:203], a[108:111], v[56:59]
  ds_read_b64_tr_b16 a[200:201], v228 offset:24576
  ds_read_b64_tr_b16 a[202:203], v228 offset:26624
  v_cvt_pk_bf16_f32 v104, v104, v105
  s_waitcnt lgkmcnt(13)
  v_mfma_f32_16x16x32_bf16 v[44:47], a[204:207], a[96:99], v[44:47]
  buffer_load_dwordx4 a[164:167], v252, s[4:7], s40 offen offset:1024 sc1
  v_cvt_pk_bf16_f32 v105, v106, v107
  v_mfma_f32_16x16x32_bf16 v[44:47], a[208:211], a[104:107], v[44:47]
  s_mov_b32 s40, 19529728
  v_cvt_pk_bf16_f32 v106, v108, v109
  v_mfma_f32_16x16x32_bf16 v[60:63], a[204:207], a[100:103], v[60:63]
  ds_read_b64_tr_b16 a[204:205], v228 offset:45056
  ds_read_b64_tr_b16 a[206:207], v228 offset:47104
  v_mfma_f32_16x16x32_bf16 v[60:63], a[208:211], a[108:111], v[60:63]
  ds_read_b64_tr_b16 a[208:209], v229 offset:24576
  ds_read_b64_tr_b16 a[210:211], v229 offset:26624
  v_cvt_pk_bf16_f32 v107, v110, v111
  v_mfma_f32_16x16x32_bf16 v[0:3], a[212:215], a[96:99], v[0:3]
  buffer_load_dwordx4 a[168:171], v252, s[4:7], s40 offen offset:0 sc1
  v_mfma_f32_16x16x32_bf16 v[0:3], a[216:219], a[104:107], v[0:3]
  buffer_store_dwordx4 v[104:107], v225, s[4:7], s21 offen offset:0 sc1
  v_mfma_f32_16x16x32_bf16 v[16:19], a[212:215], a[100:103], v[16:19]
  ds_read_b64_tr_b16 a[212:213], v229 offset:45056
  ds_read_b64_tr_b16 a[214:215], v229 offset:47104
  v_mfma_f32_16x16x32_bf16 v[16:19], a[216:219], a[108:111], v[16:19]
  ds_read_b64_tr_b16 a[216:217], v230 offset:24576
  ds_read_b64_tr_b16 a[218:219], v230 offset:26624
  v_mul_f32 v136, s43, v136
  s_waitcnt lgkmcnt(13)
  v_mfma_f32_16x16x32_bf16 v[4:7], a[220:223], a[96:99], v[4:7]
  buffer_load_dwordx4 a[172:175], v252, s[4:7], s40 offen offset:1024 sc1
  v_mul_f32 v137, s43, v137
  v_mfma_f32_16x16x32_bf16 v[4:7], a[224:227], a[104:107], v[4:7]
  s_mov_b32 s41, 3211264
  s_add_u32 m0, s42, 90112
  v_mfma_f32_16x16x32_bf16 v[20:23], a[220:223], a[100:103], v[20:23]
  ds_read_b64_tr_b16 a[220:221], v230 offset:45056
  ds_read_b64_tr_b16 a[222:223], v230 offset:47104
  v_mul_f32 v138, s43, v138
  v_mfma_f32_16x16x32_bf16 v[20:23], a[224:227], a[108:111], v[20:23]
  ds_read_b64_tr_b16 a[224:225], v231 offset:24576
  ds_read_b64_tr_b16 a[226:227], v231 offset:26624
  v_mul_f32 v139, s43, v139
  v_mfma_f32_16x16x32_bf16 v[8:11], a[228:231], a[96:99], v[8:11]
  buffer_load_dwordx4 v242, s[44:47], s41 offen offset:0 lds
  v_mul_f32 v140, s43, v140
  v_mfma_f32_16x16x32_bf16 v[8:11], a[232:235], a[104:107], v[8:11]
  s_mov_b32 s41, 3473408
  s_add_u32 m0, s42, 118784
  v_mfma_f32_16x16x32_bf16 v[24:27], a[228:231], a[100:103], v[24:27]
  ds_read_b64_tr_b16 a[228:229], v231 offset:45056
  ds_read_b64_tr_b16 a[230:231], v231 offset:47104
  v_mul_f32 v141, s43, v141
  v_mfma_f32_16x16x32_bf16 v[24:27], a[232:235], a[108:111], v[24:27]
  ds_read_b64_tr_b16 a[232:233], v228 offset:36864
  ds_read_b64_tr_b16 a[234:235], v228 offset:38912
  v_mul_f32 v142, s43, v142
  s_waitcnt lgkmcnt(13)
  v_mfma_f32_16x16x32_bf16 v[12:15], a[192:195], a[96:99], v[12:15]
  buffer_load_dwordx4 v242, s[44:47], s41 offen offset:0 lds
  v_mul_f32 v143, s43, v143
  v_mfma_f32_16x16x32_bf16 v[12:15], a[196:199], a[104:107], v[12:15]
  s_mov_b32 s41, 3211264
  s_add_u32 m0, s42, 131072
  v_mfma_f32_16x16x32_bf16 v[28:31], a[192:195], a[100:103], v[28:31]
  ds_read_b64_tr_b16 a[192:193], v228 offset:49152
  ds_read_b64_tr_b16 a[194:195], v228 offset:51200
  v_mfma_f32_16x16x32_bf16 v[28:31], a[196:199], a[108:111], v[28:31]
  ds_read_b64_tr_b16 a[196:197], v229 offset:36864
  ds_read_b64_tr_b16 a[198:199], v229 offset:38912
  s_waitcnt vmcnt(17)
  v_mfma_f32_16x16x32_bf16 v[32:35], a[200:203], a[112:115], v[32:35]
  buffer_load_dwordx4 v253, s[44:47], s41 offen offset:0 lds
  v_exp_f32 v136, v136
  v_mfma_f32_16x16x32_bf16 v[32:35], a[204:207], a[120:123], v[32:35]
  s_barrier
  v_mfma_f32_16x16x32_bf16 v[48:51], a[200:203], a[116:119], v[48:51]
  ds_read_b64_tr_b16 a[200:201], v229 offset:49152
  ds_read_b64_tr_b16 a[202:203], v229 offset:51200
  v_mfma_f32_16x16x32_bf16 v[48:51], a[204:207], a[124:127], v[48:51]
  ds_read_b64_tr_b16 a[204:205], v230 offset:36864
  ds_read_b64_tr_b16 a[206:207], v230 offset:38912
  v_exp_f32 v137, v137
  s_waitcnt lgkmcnt(13)
  v_mfma_f32_16x16x32_bf16 v[36:39], a[208:211], a[112:115], v[36:39]
  s_mov_b32 s41, 3473408
  s_add_u32 m0, s42, 77824
  v_mfma_f32_16x16x32_bf16 v[36:39], a[212:215], a[120:123], v[36:39]
  buffer_load_dwordx4 v253, s[44:47], s41 offen offset:0 lds
  v_mfma_f32_16x16x32_bf16 v[52:55], a[208:211], a[116:119], v[52:55]
  ds_read_b64_tr_b16 a[208:209], v230 offset:49152
  ds_read_b64_tr_b16 a[210:211], v230 offset:51200
  v_exp_f32 v138, v138
  v_mfma_f32_16x16x32_bf16 v[52:55], a[212:215], a[124:127], v[52:55]
  ds_read_b64_tr_b16 a[212:213], v231 offset:36864
  ds_read_b64_tr_b16 a[214:215], v231 offset:38912
  v_mfma_f32_16x16x32_bf16 v[40:43], a[216:219], a[112:115], v[40:43]
  s_mov_b32 s40, 19660800
  v_exp_f32 v139, v139
  v_mfma_f32_16x16x32_bf16 v[40:43], a[220:223], a[120:123], v[40:43]
  buffer_load_dwordx4 a[176:179], v252, s[4:7], s40 offen offset:0 sc1
  v_mfma_f32_16x16x32_bf16 v[56:59], a[216:219], a[116:119], v[56:59]
  ds_read_b64_tr_b16 a[216:217], v231 offset:49152
  ds_read_b64_tr_b16 a[218:219], v231 offset:51200
  v_mfma_f32_16x16x32_bf16 v[56:59], a[220:223], a[124:127], v[56:59]
  ds_read_b64_tr_b16 a[220:221], v228 offset:32768
  ds_read_b64_tr_b16 a[222:223], v228 offset:34816
  v_exp_f32 v140, v140
  s_waitcnt lgkmcnt(13)
  v_mfma_f32_16x16x32_bf16 v[44:47], a[224:227], a[112:115], v[44:47]
  buffer_load_dwordx4 a[180:183], v252, s[4:7], s40 offen offset:1024 sc1
  v_mfma_f32_16x16x32_bf16 v[44:47], a[228:231], a[120:123], v[44:47]
  s_mov_b32 s40, 19791872
  v_exp_f32 v141, v141
  v_mfma_f32_16x16x32_bf16 v[60:63], a[224:227], a[116:119], v[60:63]
  ds_read_b64_tr_b16 a[224:225], v228 offset:40960
  ds_read_b64_tr_b16 a[226:227], v228 offset:43008
  v_mfma_f32_16x16x32_bf16 v[60:63], a[228:231], a[124:127], v[60:63]
  ds_read_b64_tr_b16 a[228:229], v229 offset:32768
  ds_read_b64_tr_b16 a[230:231], v229 offset:34816
  v_mfma_f32_16x16x32_bf16 v[0:3], a[232:235], a[112:115], v[0:3]
  buffer_load_dwordx4 a[184:187], v252, s[4:7], s40 offen offset:0 sc1
  v_exp_f32 v142, v142
  v_mfma_f32_16x16x32_bf16 v[0:3], a[192:195], a[120:123], v[0:3]
  v_exp_f32 v143, v143
  v_mfma_f32_16x16x32_bf16 v[16:19], a[232:235], a[116:119], v[16:19]
L_wk1_8:
  s_cbranch_vccnz L_wk1_12
  ds_read_b64_tr_b16 a[232:233], v229 offset:40960
  ds_read_b64_tr_b16 a[234:235], v229 offset:43008
  v_mfma_f32_16x16x32_bf16 v[16:19], a[192:195], a[124:127], v[16:19]
  ds_read_b64_tr_b16 a[192:193], v230 offset:32768
  ds_read_b64_tr_b16 a[194:195], v230 offset:34816
  v_add_f32 v136, 1.0, v136
  s_waitcnt lgkmcnt(13)
  v_mfma_f32_16x16x32_bf16 v[4:7], a[196:199], a[112:115], v[4:7]
  buffer_load_dwordx4 a[188:191], v252, s[4:7], s40 offen offset:1024 sc1
  v_add_f32 v137, 1.0, v137
  v_mfma_f32_16x16x32_bf16 v[4:7], a[200:203], a[120:123], v[4:7]
  s_mov_b32 s41, 196608
  s_add_u32 m0, s42, 73728
  v_mfma_f32_16x16x32_bf16 v[20:23], a[196:199], a[116:119], v[20:23]
  ds_read_b64_tr_b16 a[196:197], v230 offset:40960
  ds_read_b64_tr_b16 a[198:199], v230 offset:43008
  v_add_f32 v138, 1.0, v138
  v_mfma_f32_16x16x32_bf16 v[20:23], a[200:203], a[124:127], v[20:23]
  ds_read_b64_tr_b16 a[200:201], v231 offset:32768
  ds_read_b64_tr_b16 a[202:203], v231 offset:34816
  v_add_f32 v139, 1.0, v139
  v_mfma_f32_16x16x32_bf16 v[8:11], a[204:207], a[112:115], v[8:11]
  buffer_load_dwordx4 v242, s[44:47], s41 offen offset:0 lds
  v_add_f32 v140, 1.0, v140
  v_mfma_f32_16x16x32_bf16 v[8:11], a[208:211], a[120:123], v[8:11]
  s_mov_b32 s41, 655360
  s_add_u32 m0, s42, 86016
  v_mfma_f32_16x16x32_bf16 v[24:27], a[204:207], a[116:119], v[24:27]
  ds_read_b64_tr_b16 a[204:205], v231 offset:40960
  ds_read_b64_tr_b16 a[206:207], v231 offset:43008
  v_add_f32 v141, 1.0, v141
  v_mfma_f32_16x16x32_bf16 v[24:27], a[208:211], a[124:127], v[24:27]
  ds_read_b64_tr_b16 a[208:209], v228 offset:53248
  ds_read_b64_tr_b16 a[210:211], v228 offset:55296
  v_add_f32 v142, 1.0, v142
  s_waitcnt lgkmcnt(13)
  v_mfma_f32_16x16x32_bf16 v[12:15], a[212:215], a[112:115], v[12:15]
  buffer_load_dwordx4 v242, s[44:47], s41 offen offset:0 lds
  v_add_f32 v143, 1.0, v143
  v_mfma_f32_16x16x32_bf16 v[12:15], a[216:219], a[120:123], v[12:15]
  s_mov_b32 s41, 196608
  s_add_u32 m0, s42, 102400
  v_mfma_f32_16x16x32_bf16 v[28:31], a[212:215], a[116:119], v[28:31]
  ds_read_b64_tr_b16 a[212:213], v228 offset:57344
  ds_read_b64_tr_b16 a[214:215], v228 offset:59392
  v_mfma_f32_16x16x32_bf16 v[28:31], a[216:219], a[124:127], v[28:31]
  ds_read_b64_tr_b16 a[216:217], v229 offset:53248
  ds_read_b64_tr_b16 a[218:219], v229 offset:55296
  s_waitcnt vmcnt(20)
  v_mfma_f32_16x16x32_bf16 v[32:35], a[220:223], a[128:131], v[32:35]
  buffer_load_dwordx4 v253, s[44:47], s41 offen offset:0 lds
  v_rcp_f32 v136, v136
  v_mfma_f32_16x16x32_bf16 v[32:35], a[224:227], a[136:139], v[32:35]
  s_barrier
  v_mfma_f32_16x16x32_bf16 v[48:51], a[220:223], a[132:135], v[48:51]
  ds_read_b64_tr_b16 a[220:221], v229 offset:57344
  ds_read_b64_tr_b16 a[222:223], v229 offset:59392
  v_mfma_f32_16x16x32_bf16 v[48:51], a[224:227], a[140:143], v[48:51]
  ds_read_b64_tr_b16 a[224:225], v230 offset:53248
  ds_read_b64_tr_b16 a[226:227], v230 offset:55296
  v_rcp_f32 v137, v137
  s_waitcnt lgkmcnt(13)
  v_mfma_f32_16x16x32_bf16 v[36:39], a[228:231], a[128:131], v[36:39]
  s_mov_b32 s41, 655360
  s_add_u32 m0, s42, 98304
  v_mfma_f32_16x16x32_bf16 v[36:39], a[232:235], a[136:139], v[36:39]
  buffer_load_dwordx4 v253, s[44:47], s41 offen offset:0 lds
  v_mfma_f32_16x16x32_bf16 v[52:55], a[228:231], a[132:135], v[52:55]
  ds_read_b64_tr_b16 a[228:229], v230 offset:57344
  ds_read_b64_tr_b16 a[230:231], v230 offset:59392
  v_rcp_f32 v138, v138
  v_mfma_f32_16x16x32_bf16 v[52:55], a[232:235], a[140:143], v[52:55]
  ds_read_b64_tr_b16 a[232:233], v231 offset:53248
  ds_read_b64_tr_b16 a[234:235], v231 offset:55296
  v_mfma_f32_16x16x32_bf16 v[40:43], a[192:195], a[128:131], v[40:43]
  s_mov_b32 s41, 1114112
  s_add_u32 m0, s42, 110592
  v_rcp_f32 v139, v139
  v_mfma_f32_16x16x32_bf16 v[40:43], a[196:199], a[136:139], v[40:43]
  buffer_load_dwordx4 v242, s[44:47], s41 offen offset:0 lds
  v_mfma_f32_16x16x32_bf16 v[56:59], a[192:195], a[132:135], v[56:59]
  ds_read_b64_tr_b16 a[192:193], v231 offset:57344
  ds_read_b64_tr_b16 a[194:195], v231 offset:59392
  v_mfma_f32_16x16x32_bf16 v[56:59], a[196:199], a[140:143], v[56:59]
  ds_read_b64_tr_b16 a[196:197], v232 offset:0
  ds_read_b64_tr_b16 a[198:199], v232 offset:2048
  v_rcp_f32 v140, v140
  s_waitcnt lgkmcnt(13)
  v_mfma_f32_16x16x32_bf16 v[44:47], a[200:203], a[128:131], v[44:47]
  s_mov_b32 s41, 1572864
  s_add_u32 m0, s42, 126976
  v_mfma_f32_16x16x32_bf16 v[44:47], a[204:207], a[136:139], v[44:47]
  buffer_load_dwordx4 v242, s[44:47], s41 offen offset:0 lds
  v_mfma_f32_16x16x32_bf16 v[60:63], a[200:203], a[132:135], v[60:63]
  ds_read_b64_tr_b16 a[200:201], v232 offset:28672
  ds_read_b64_tr_b16 a[202:203], v232 offset:30720
  v_rcp_f32 v141, v141
  v_mfma_f32_16x16x32_bf16 v[60:63], a[204:207], a[140:143], v[60:63]
  ds_read_b64_tr_b16 a[204:205], v233 offset:0
  ds_read_b64_tr_b16 a[206:207], v233 offset:2048
  v_mfma_f32_16x16x32_bf16 v[0:3], a[208:211], a[128:131], v[0:3]
  s_mov_b32 s41, 1114112
  s_add_u32 m0, s42, 122880
  v_rcp_f32 v142, v142
  v_mfma_f32_16x16x32_bf16 v[0:3], a[212:215], a[136:139], v[0:3]
  buffer_load_dwordx4 v253, s[44:47], s41 offen offset:0 lds
  v_mfma_f32_16x16x32_bf16 v[16:19], a[208:211], a[132:135], v[16:19]
  ds_read_b64_tr_b16 a[208:209], v233 offset:28672
  ds_read_b64_tr_b16 a[210:211], v233 offset:30720
  v_mfma_f32_16x16x32_bf16 v[16:19], a[212:215], a[140:143], v[16:19]
  ds_read_b64_tr_b16 a[212:213], v234 offset:0
  ds_read_b64_tr_b16 a[214:215], v234 offset:2048
  v_rcp_f32 v143, v143
  v_mul_f32 v136, v136, v152
  s_waitcnt lgkmcnt(13)
  v_mfma_f32_16x16x32_bf16 v[4:7], a[216:219], a[128:131], v[4:7]
  s_mov_b32 s41, 1572864
  s_add_u32 m0, s42, 135168
  v_mul_f32 v137, v137, v153
  v_mfma_f32_16x16x32_bf16 v[4:7], a[220:223], a[136:139], v[4:7]
  buffer_load_dwordx4 v253, s[44:47], s41 offen offset:0 lds
  v_mfma_f32_16x16x32_bf16 v[20:23], a[216:219], a[132:135], v[20:23]
  ds_read_b64_tr_b16 a[216:217], v234 offset:28672
  ds_read_b64_tr_b16 a[218:219], v234 offset:30720
  v_mul_f32 v138, v138, v154
  v_mfma_f32_16x16x32_bf16 v[20:23], a[220:223], a[140:143], v[20:23]
  ds_read_b64_tr_b16 a[220:221], v235 offset:0
  ds_read_b64_tr_b16 a[222:223], v235 offset:2048
  buffer_load_dword v244, v243, s[4:7], s91 offen sc1
  v_mul_f32 v139, v139, v155
  v_mfma_f32_16x16x32_bf16 v[8:11], a[224:227], a[128:131], v[8:11]
  s_mov_b32 s41, 2031616
  s_add_u32 m0, s42, 151552
  v_mul_f32 v140, v140, v156
  v_mfma_f32_16x16x32_bf16 v[8:11], a[228:231], a[136:139], v[8:11]
  buffer_load_dwordx4 v242, s[44:47], s41 offen offset:0 lds
  v_mfma_f32_16x16x32_bf16 v[24:27], a[224:227], a[132:135], v[24:27]
  ds_read_b64_tr_b16 a[224:225], v235 offset:28672
  ds_read_b64_tr_b16 a[226:227], v235 offset:30720
  v_mul_f32 v141, v141, v157
  v_mfma_f32_16x16x32_bf16 v[24:27], a[228:231], a[140:143], v[24:27]
  ds_read_b64_tr_b16 a[228:229], v232 offset:40960
  ds_read_b64_tr_b16 a[230:231], v232 offset:43008
  v_mul_f32 v142, v142, v158
  s_waitcnt lgkmcnt(13)
  v_mfma_f32_16x16x32_bf16 v[12:15], a[232:235], a[128:131], v[12:15]
  s_mov_b32 s41, 2490368
  s_add_u32 m0, s42, 147456
  v_mul_f32 v143, v143, v159
  v_mfma_f32_16x16x32_bf16 v[12:15], a[192:195], a[136:139], v[12:15]
  buffer_load_dwordx4 v242, s[44:47], s41 offen offset:0 lds
  v_mfma_f32_16x16x32_bf16 v[28:31], a[232:235], a[132:135], v[28:31]
  ds_read_b64_tr_b16 a[232:233], v232 offset:49152
  ds_read_b64_tr_b16 a[234:235], v232 offset:51200
  v_cvt_pk_bf16_f32 v136, v136, v137
  v_mfma_f32_16x16x32_bf16 v[28:31], a[192:195], a[140:143], v[28:31]
  ds_read_b64_tr_b16 a[192:193], v233 offset:40960
  ds_read_b64_tr_b16 a[194:195], v233 offset:43008
  v_cvt_pk_bf16_f32 v137, v138, v139
  s_waitcnt vmcnt(25)
  v_mfma_f32_16x16x32_bf16 v[32:35], a[196:199], a[144:147], v[32:35]
  s_mov_b32 s41, 2031616
  s_add_u32 m0, s42, 159744
  v_cvt_pk_bf16_f32 v138, v140, v141
  v_mfma_f32_16x16x32_bf16 v[32:35], a[200:203], a[152:155], v[32:35]
  s_waitcnt vmcnt(24)
  s_barrier
  v_mfma_f32_16x16x32_bf16 v[48:51], a[196:199], a[148:151], v[48:51]
  buffer_load_dwordx4 v253, s[44:47], s41 offen offset:0 lds
  v_cvt_pk_bf16_f32 v139, v142, v143
  v_mfma_f32_16x16x32_bf16 v[48:51], a[200:203], a[156:159], v[48:51]
  ds_read_b64_tr_b16 a[196:197], v233 offset:49152
  ds_read_b64_tr_b16 a[198:199], v233 offset:51200
  s_waitcnt lgkmcnt(13)
  v_mfma_f32_16x16x32_bf16 v[36:39], a[204:207], a[144:147], v[36:39]
  ds_read_b64_tr_b16 a[200:201], v234 offset:40960
  ds_read_b64_tr_b16 a[202:203], v234 offset:43008
  v_mfma_f32_16x16x32_bf16 v[36:39], a[208:211], a[152:155], v[36:39]
  s_mov_b32 s41, 2490368
  s_add_u32 m0, s42, 16384
  v_mfma_f32_16x16x32_bf16 v[52:55], a[204:207], a[148:151], v[52:55]
  buffer_load_dwordx4 v253, s[44:47], s41 offen offset:0 lds
  buffer_store_dwordx4 v[136:139], v225, s[4:7], s21 offen offset:1024 sc1
  v_mul_f32 v168, s43, v168
  v_mfma_f32_16x16x32_bf16 v[52:55], a[208:211], a[156:159], v[52:55]
  ds_read_b64_tr_b16 a[204:205], v234 offset:49152
  ds_read_b64_tr_b16 a[206:207], v234 offset:51200
  v_mul_f32 v169, s43, v169
  v_mfma_f32_16x16x32_bf16 v[40:43], a[212:215], a[144:147], v[40:43]
  ds_read_b64_tr_b16 a[208:209], v235 offset:40960
  ds_read_b64_tr_b16 a[210:211], v235 offset:43008
  v_mul_f32 v170, s43, v170
  s_waitcnt lgkmcnt(13)
  v_mfma_f32_16x16x32_bf16 v[40:43], a[216:219], a[152:155], v[40:43]
  s_mov_b32 s41, 2949120
  s_add_u32 m0, s42, 28672
  v_mfma_f32_16x16x32_bf16 v[56:59], a[212:215], a[148:151], v[56:59]
  buffer_load_dwordx4 v242, s[44:47], s41 offen offset:0 lds
  v_mul_f32 v171, s43, v171
  v_mfma_f32_16x16x32_bf16 v[56:59], a[216:219], a[156:159], v[56:59]
  ds_read_b64_tr_b16 a[212:213], v235 offset:49152
  ds_read_b64_tr_b16 a[214:215], v235 offset:51200
  v_mul_f32 v172, s43, v172
  v_mfma_f32_16x16x32_bf16 v[44:47], a[220:223], a[144:147], v[44:47]
  ds_read_b64_tr_b16 a[216:217], v236 offset:12288
  ds_read_b64_tr_b16 a[218:219], v236 offset:14336
  v_mul_f32 v173, s43, v173
  v_mfma_f32_16x16x32_bf16 v[44:47], a[224:227], a[152:155], v[44:47]
  s_mov_b32 s41, 3407872
  s_add_u32 m0, s42, 139264
  v_mfma_f32_16x16x32_bf16 v[60:63], a[220:223], a[148:151], v[60:63]
  buffer_load_dwordx4 v242, s[44:47], s41 offen offset:0 lds
  v_mul_f32 v174, s43, v174
  v_mfma_f32_16x16x32_bf16 v[60:63], a[224:227], a[156:159], v[60:63]
  ds_read_b64_tr_b16 a[220:221], v232 offset:4096
  ds_read_b64_tr_b16 a[222:223], v232 offset:6144
  v_mul_f32 v175, s43, v175
  s_waitcnt lgkmcnt(13)
  v_mfma_f32_16x16x32_bf16 v[0:3], a[228:231], a[144:147], v[0:3]
  ds_read_b64_tr_b16 a[224:225], v237 offset:12288
  ds_read_b64_tr_b16 a[226:227], v237 offset:14336
  v_mfma_f32_16x16x32_bf16 v[0:3], a[232:235], a[152:155], v[0:3]
  s_mov_b32 s41, 2949120
  s_add_u32 m0, s42, 155648
  v_mfma_f32_16x16x32_bf16 v[16:19], a[228:231], a[148:151], v[16:19]
  buffer_load_dwordx4 v253, s[44:47], s41 offen offset:0 lds
  v_mfma_f32_16x16x32_bf16 v[16:19], a[232:235], a[156:159], v[16:19]
  ds_read_b64_tr_b16 a[228:229], v233 offset:4096
  ds_read_b64_tr_b16 a[230:231], v233 offset:6144
  v_exp_f32 v168, v168
  v_mfma_f32_16x16x32_bf16 v[4:7], a[192:195], a[144:147], v[4:7]
  ds_read_b64_tr_b16 a[232:233], v238 offset:12288
  ds_read_b64_tr_b16 a[234:235], v238 offset:14336
  s_waitcnt lgkmcnt(13)
  v_mfma_f32_16x16x32_bf16 v[4:7], a[196:199], a[152:155], v[4:7]
  s_mov_b32 s41, 3407872
  s_add_u32 m0, s42, 20480
  v_mfma_f32_16x16x32_bf16 v[20:23], a[192:195], a[148:151], v[20:23]
  buffer_load_dwordx4 v253, s[44:47], s41 offen offset:0 lds
  v_exp_f32 v169, v169
  v_mfma_f32_16x16x32_bf16 v[20:23], a[196:199], a[156:159], v[20:23]
  ds_read_b64_tr_b16 a[192:193], v234 offset:4096
  ds_read_b64_tr_b16 a[194:195], v234 offset:6144
  v_mfma_f32_16x16x32_bf16 v[8:11], a[200:203], a[144:147], v[8:11]
  ds_read_b64_tr_b16 a[196:197], v239 offset:12288
  ds_read_b64_tr_b16 a[198:199], v239 offset:14336
  v_exp_f32 v170, v170
  v_mfma_f32_16x16x32_bf16 v[8:11], a[204:207], a[152:155], v[8:11]
  s_mov_b32 s41, 0
  s_add_u32 m0, s42, 12288
  v_mfma_f32_16x16x32_bf16 v[24:27], a[200:203], a[148:151], v[24:27]
  buffer_load_dwordx4 v242, s[44:47], s41 offen offset:0 lds
  v_mfma_f32_16x16x32_bf16 v[24:27], a[204:207], a[156:159], v[24:27]
  ds_read_b64_tr_b16 a[200:201], v235 offset:4096
  ds_read_b64_tr_b16 a[202:203], v235 offset:6144
  v_exp_f32 v171, v171
  s_waitcnt lgkmcnt(13)
  v_mfma_f32_16x16x32_bf16 v[12:15], a[208:211], a[144:147], v[12:15]
  ds_read_b64_tr_b16 a[204:205], v232 offset:16384
  ds_read_b64_tr_b16 a[206:207], v232 offset:18432
  v_mfma_f32_16x16x32_bf16 v[12:15], a[212:215], a[152:155], v[12:15]
  s_mov_b32 s41, 262144
  s_add_u32 m0, s42, 24576
  v_mfma_f32_16x16x32_bf16 v[28:31], a[208:211], a[148:151], v[28:31]
  buffer_load_dwordx4 v242, s[44:47], s41 offen offset:0 lds
  v_exp_f32 v172, v172
  v_mfma_f32_16x16x32_bf16 v[28:31], a[212:215], a[156:159], v[28:31]
  ds_read_b64_tr_b16 a[208:209], v228 offset:61440
  ds_read_b64_tr_b16 a[210:211], v228 offset:63488
  s_waitcnt vmcnt(11)
  v_subrev_u32 v244, s100, v244
  v_mfma_f32_16x16x32_bf16 v[32:35], a[216:219], a[160:163], v[32:35]
  ds_read_b64_tr_b16 a[212:213], v233 offset:16384
  ds_read_b64_tr_b16 a[214:215], v233 offset:18432
  v_subrev_u32 v244, 1, v244
  v_cmp_lt_u32 s[68:69], 6, v244
  v_exp_f32 v173, v173
  s_waitcnt lgkmcnt(13)
  v_mfma_f32_16x16x32_bf16 v[32:35], a[220:223], a[168:171], v[32:35]
  s_barrier
  s_cmp_lg_u64 s[68:69], 0
  s_cbranch_scc1 L_slow_31
L_back_32:
  v_mfma_f32_16x16x32_bf16 v[48:51], a[216:219], a[164:167], v[48:51]
  ds_read_b64_tr_b16 a[216:217], v229 offset:61440
  ds_read_b64_tr_b16 a[218:219], v229 offset:63488
  v_mfma_f32_16x16x32_bf16 v[48:51], a[220:223], a[172:175], v[48:51]
  ds_read_b64_tr_b16 a[220:221], v234 offset:16384
  ds_read_b64_tr_b16 a[222:223], v234 offset:18432
  v_exp_f32 v174, v174
  v_mfma_f32_16x16x32_bf16 v[36:39], a[224:227], a[160:163], v[36:39]
  s_mov_b32 s41, 0
  s_add_u32 m0, s42, 45056
  v_mfma_f32_16x16x32_bf16 v[36:39], a[228:231], a[168:171], v[36:39]
  buffer_load_dwordx4 v253, s[44:47], s41 offen offset:0 lds
  v_mfma_f32_16x16x32_bf16 v[52:55], a[224:227], a[164:167], v[52:55]
  ds_read_b64_tr_b16 a[224:225], v230 offset:61440
  ds_read_b64_tr_b16 a[226:227], v230 offset:63488
  v_exp_f32 v175, v175
  v_add_f32 v168, 1.0, v168
  v_mfma_f32_16x16x32_bf16 v[52:55], a[228:231], a[172:175], v[52:55]
  ds_read_b64_tr_b16 a[228:229], v235 offset:16384
  ds_read_b64_tr_b16 a[230:231], v235 offset:18432
  v_add_f32 v169, 1.0, v169
  s_waitcnt lgkmcnt(13)
  v_mfma_f32_16x16x32_bf16 v[40:43], a[232:235], a[160:163], v[40:43]
  s_mov_b32 s40, 19922944
  v_add_f32 v170, 1.0, v170
  v_mfma_f32_16x16x32_bf16 v[40:43], a[192:195], a[168:171], v[40:43]
  buffer_load_dwordx4 v[96:99], v252, s[4:7], s40 offen offset:0 sc1
  v_mfma_f32_16x16x32_bf16 v[56:59], a[232:235], a[164:167], v[56:59]
  ds_read_b64_tr_b16 a[232:233], v231 offset:61440
  ds_read_b64_tr_b16 a[234:235], v231 offset:63488
  v_add_f32 v171, 1.0, v171
  v_mfma_f32_16x16x32_bf16 v[56:59], a[192:195], a[172:175], v[56:59]
  ds_read_b64_tr_b16 a[192:193], v232 offset:24576
  ds_read_b64_tr_b16 a[194:195], v232 offset:26624
  v_add_f32 v172, 1.0, v172
  v_mfma_f32_16x16x32_bf16 v[44:47], a[196:199], a[160:163], v[44:47]
  buffer_load_dwordx4 v[100:103], v252, s[4:7], s40 offen offset:1024 sc1
  v_add_f32 v173, 1.0, v173
  v_mfma_f32_16x16x32_bf16 v[44:47], a[200:203], a[168:171], v[44:47]
  s_mov_b32 s40, 20054016
  v_add_f32 v174, 1.0, v174
  v_mfma_f32_16x16x32_bf16 v[60:63], a[196:199], a[164:167], v[60:63]
  ds_read_b64_tr_b16 a[196:197], v232 offset:53248
  ds_read_b64_tr_b16 a[198:199], v232 offset:55296
  v_mfma_f32_16x16x32_bf16 v[60:63], a[200:203], a[172:175], v[60:63]
  ds_read_b64_tr_b16 a[200:201], v233 offset:24576
  ds_read_b64_tr_b16 a[202:203], v233 offset:26624
  v_add_f32 v175, 1.0, v175
  s_waitcnt lgkmcnt(13)
  v_mfma_f32_16x16x32_bf16 v[0:3], a[204:207], a[160:163], v[0:3]
  buffer_load_dwordx4 v[112:115], v252, s[4:7], s40 offen offset:0 sc1
  v_mfma_f32_16x16x32_bf16 v[0:3], a[208:211], a[168:171], v[0:3]
  v_rcp_f32 v168, v168
  v_mfma_f32_16x16x32_bf16 v[16:19], a[204:207], a[164:167], v[16:19]
  ds_read_b64_tr_b16 a[204:205], v233 offset:53248
  ds_read_b64_tr_b16 a[206:207], v233 offset:55296
  v_mfma_f32_16x16x32_bf16 v[16:19], a[208:211], a[172:175], v[16:19]
  ds_read_b64_tr_b16 a[208:209], v234 offset:24576
  ds_read_b64_tr_b16 a[210:211], v234 offset:26624
  v_mfma_f32_16x16x32_bf16 v[4:7], a[212:215], a[160:163], v[4:7]
  buffer_load_dwordx4 v[116:119], v252, s[4:7], s40 offen offset:1024 sc1
  v_mfma_f32_16x16x32_bf16 v[4:7], a[216:219], a[168:171], v[4:7]
  s_mov_b32 s40, 20185088
  v_rcp_f32 v169, v169
  v_mfma_f32_16x16x32_bf16 v[20:23], a[212:215], a[164:167], v[20:23]
  ds_read_b64_tr_b16 a[212:213], v234 offset:53248
  ds_read_b64_tr_b16 a[214:215], v234 offset:55296
  v_mfma_f32_16x16x32_bf16 v[20:23], a[216:219], a[172:175], v[20:23]
  ds_read_b64_tr_b16 a[216:217], v235 offset:24576
  ds_read_b64_tr_b16 a[218:219], v235 offset:26624
  s_waitcnt lgkmcnt(13)
  v_mfma_f32_16x16x32_bf16 v[8:11], a[220:223], a[160:163], v[8:11]
  buffer_load_dwordx4 v[128:131], v252, s[4:7], s40 offen offset:0 sc1
  v_rcp_f32 v170, v170
  v_mfma_f32_16x16x32_bf16 v[8:11], a[224:227], a[168:171], v[8:11]
  v_rcp_f32 v171, v171
  v_mfma_f32_16x16x32_bf16 v[24:27], a[220:223], a[164:167], v[24:27]
  ds_read_b64_tr_b16 a[220:221], v235 offset:53248
  ds_read_b64_tr_b16 a[222:223], v235 offset:55296
  v_mfma_f32_16x16x32_bf16 v[24:27], a[224:227], a[172:175], v[24:27]
  ds_read_b64_tr_b16 a[224:225], v236 offset:0
  ds_read_b64_tr_b16 a[226:227], v236 offset:2048
  v_mfma_f32_16x16x32_bf16 v[12:15], a[228:231], a[160:163], v[12:15]
  buffer_load_dwordx4 v[132:135], v252, s[4:7], s40 offen offset:1024 sc1
  v_mfma_f32_16x16x32_bf16 v[12:15], a[232:235], a[168:171], v[12:15]
  s_mov_b32 s40, 20316160
  v_rcp_f32 v172, v172
  v_mfma_f32_16x16x32_bf16 v[28:31], a[228:231], a[164:167], v[28:31]
  ds_read_b64_tr_b16 a[228:229], v232 offset:12288
  ds_read_b64_tr_b16 a[230:231], v232 offset:14336
  v_mfma_f32_16x16x32_bf16 v[28:31], a[232:235], a[172:175], v[28:31]
  ds_read_b64_tr_b16 a[232:233], v237 offset:0
  ds_read_b64_tr_b16 a[234:235], v237 offset:2048
  s_waitcnt lgkmcnt(13)
  v_mfma_f32_16x16x32_bf16 v[32:35], a[192:195], a[176:179], v[32:35]
  buffer_load_dwordx4 v[144:147], v252, s[4:7], s40 offen offset:0 sc1
  v_rcp_f32 v173, v173
  v_mfma_f32_16x16x32_bf16 v[32:35], a[196:199], a[184:187], v[32:35]
  s_barrier
  v_mfma_f32_16x16x32_bf16 v[48:51], a[192:195], a[180:183], v[48:51]
  ds_read_b64_tr_b16 a[192:193], v233 offset:12288
  ds_read_b64_tr_b16 a[194:195], v233 offset:14336
  v_mfma_f32_16x16x32_bf16 v[48:51], a[196:199], a[188:191], v[48:51]
  ds_read_b64_tr_b16 a[196:197], v238 offset:0
  ds_read_b64_tr_b16 a[198:199], v238 offset:2048
  v_rcp_f32 v174, v174
  v_mfma_f32_16x16x32_bf16 v[36:39], a[200:203], a[176:179], v[36:39]
  buffer_load_dwordx4 v[148:151], v252, s[4:7], s40 offen offset:1024 sc1
  v_mfma_f32_16x16x32_bf16 v[36:39], a[204:207], a[184:187], v[36:39]
  s_mov_b32 s40, 20447232
  v_rcp_f32 v175, v175
  v_mfma_f32_16x16x32_bf16 v[52:55], a[200:203], a[180:183], v[52:55]
  ds_read_b64_tr_b16 a[200:201], v234 offset:12288
  ds_read_b64_tr_b16 a[202:203], v234 offset:14336
  v_mul_f32 v168, v168, v184
  v_mfma_f32_16x16x32_bf16 v[52:55], a[204:207], a[188:191], v[52:55]
  ds_read_b64_tr_b16 a[204:205], v239 offset:0
  ds_read_b64_tr_b16 a[206:207], v239 offset:2048
  v_mul_f32 v169, v169, v185
  s_waitcnt lgkmcnt(13)
  v_mfma_f32_16x16x32_bf16 v[40:43], a[208:211], a[176:179], v[40:43]
  buffer_load_dwordx4 v[160:163], v252, s[4:7], s40 offen offset:0 sc1
  v_mul_f32 v170, v170, v186
  v_mfma_f32_16x16x32_bf16 v[40:43], a[212:215], a[184:187], v[40:43]
  v_mul_f32 v171, v171, v187
  v_mul_f32 v172, v172, v188
  v_mfma_f32_16x16x32_bf16 v[56:59], a[208:211], a[180:183], v[56:59]
  ds_read_b64_tr_b16 a[208:209], v235 offset:12288
  ds_read_b64_tr_b16 a[210:211], v235 offset:14336
  v_mfma_f32_16x16x32_bf16 v[56:59], a[212:215], a[188:191], v[56:59]
  ds_read_b64_tr_b16 a[212:213], v232 offset:8192
  ds_read_b64_tr_b16 a[214:215], v232 offset:10240
  v_mfma_f32_16x16x32_bf16 v[44:47], a[216:219], a[176:179], v[44:47]
  buffer_load_dwordx4 v[164:167], v252, s[4:7], s40 offen offset:1024 sc1
  v_mul_f32 v173, v173, v189
  v_mfma_f32_16x16x32_bf16 v[44:47], a[220:223], a[184:187], v[44:47]
  s_mov_b32 s40, 20578304
  v_mul_f32 v174, v174, v190
  v_mfma_f32_16x16x32_bf16 v[60:63], a[216:219], a[180:183], v[60:63]
  ds_read_b64_tr_b16 a[216:217], v232 offset:20480
  ds_read_b64_tr_b16 a[218:219], v232 offset:22528
  v_mfma_f32_16x16x32_bf16 v[60:63], a[220:223], a[188:191], v[60:63]
  ds_read_b64_tr_b16 a[220:221], v233 offset:8192
  ds_read_b64_tr_b16 a[222:223], v233 offset:10240
  v_mul_f32 v175, v175, v191
  s_waitcnt lgkmcnt(13)
  v_mfma_f32_16x16x32_bf16 v[0:3], a[224:227], a[176:179], v[0:3]
  buffer_load_dwordx4 v[176:179], v252, s[4:7], s40 offen offset:0 sc1
  v_cvt_pk_bf16_f32 v168, v168, v169
  v_mfma_f32_16x16x32_bf16 v[0:3], a[228:231], a[184:187], v[0:3]
  v_cvt_pk_bf16_f32 v169, v170, v171
  v_cvt_pk_bf16_f32 v170, v172, v173
  v_mfma_f32_16x16x32_bf16 v[16:19], a[224:227], a[180:183], v[16:19]
  ds_read_b64_tr_b16 a[224:225], v233 offset:20480
  ds_read_b64_tr_b16 a[226:227], v233 offset:22528
  v_mfma_f32_16x16x32_bf16 v[16:19], a[228:231], a[188:191], v[16:19]
  ds_read_b64_tr_b16 a[228:229], v234 offset:8192
  ds_read_b64_tr_b16 a[230:231], v234 offset:10240
  v_mfma_f32_16x16x32_bf16 v[4:7], a[232:235], a[176:179], v[4:7]
  buffer_load_dwordx4 v[180:183], v252, s[4:7], s40 offen offset:1024 sc1
  v_cvt_pk_bf16_f32 v171, v174, v175
  v_mfma_f32_16x16x32_bf16 v[4:7], a[192:195], a[184:187], v[4:7]
  s_mov_b32 s40, 20709376
  v_mfma_f32_16x16x32_bf16 v[20:23], a[232:235], a[180:183], v[20:23]
  ds_read_b64_tr_b16 a[232:233], v234 offset:20480
  ds_read_b64_tr_b16 a[234:235], v234 offset:22528
  v_mfma_f32_16x16x32_bf16 v[20:23], a[192:195], a[188:191], v[20:23]
  ds_read_b64_tr_b16 a[192:193], v235 offset:8192
  ds_read_b64_tr_b16 a[194:195], v235 offset:10240
  s_waitcnt lgkmcnt(13)
  v_mfma_f32_16x16x32_bf16 v[8:11], a[196:199], a[176:179], v[8:11]
  buffer_load_dwordx4 v[192:195], v252, s[4:7], s40 offen offset:0 sc1
  buffer_store_dwordx4 v[168:171], v225, s[4:7], s21 offen offset:2048 sc1
  v_mul_f32 v200, s43, v200
  v_mfma_f32_16x16x32_bf16 v[8:11], a[200:203], a[184:187], v[8:11]
  v_mul_f32 v201, s43, v201
  v_mul_f32 v202, s43, v202
  v_mfma_f32_16x16x32_bf16 v[24:27], a[196:199], a[180:183], v[24:27]
  ds_read_b64_tr_b16 a[196:197], v235 offset:20480
  ds_read_b64_tr_b16 a[198:199], v235 offset:22528
  v_mfma_f32_16x16x32_bf16 v[24:27], a[200:203], a[188:191], v[24:27]
  ds_read_b64_tr_b16 a[200:201], v232 offset:36864
  ds_read_b64_tr_b16 a[202:203], v232 offset:38912
  v_mfma_f32_16x16x32_bf16 v[12:15], a[204:207], a[176:179], v[12:15]
  s_waitcnt vmcnt(10)
  v_swap_b32 v98, v100
  v_swap_b32 v99, v101
  v_swap_b32 v114, v116
  v_swap_b32 v115, v117
  buffer_load_dwordx4 v[196:199], v252, s[4:7], s40 offen offset:1024 sc1
  v_mul_f32 v203, s43, v203
  v_mfma_f32_16x16x32_bf16 v[12:15], a[208:211], a[184:187], v[12:15]
  s_mov_b32 s40, 20840448
  v_mul_f32 v204, s43, v204
  v_mfma_f32_16x16x32_bf16 v[28:31], a[204:207], a[180:183], v[28:31]
  ds_read_b64_tr_b16 a[204:205], v232 offset:32768
  ds_read_b64_tr_b16 a[206:207], v232 offset:34816
  v_mfma_f32_16x16x32_bf16 v[28:31], a[208:211], a[188:191], v[28:31]
  ds_read_b64_tr_b16 a[208:209], v233 offset:36864
  ds_read_b64_tr_b16 a[210:211], v233 offset:38912
  v_mul_f32 v205, s43, v205
  s_waitcnt lgkmcnt(13)
  v_mfma_f32_16x16x32_bf16 v[32:35], a[212:215], v[96:99], v[32:35]
  buffer_load_dwordx4 v[208:211], v252, s[4:7], s40 offen offset:0 sc1
  v_mul_f32 v206, s43, v206
  v_mfma_f32_16x16x32_bf16 v[32:35], a[216:219], v[112:115], v[32:35]
  s_barrier
  v_mfma_f32_16x16x32_bf16 v[48:51], a[212:215], v[100:103], v[48:51]
  ds_read_b64_tr_b16 a[212:213], v233 offset:32768
  ds_read_b64_tr_b16 a[214:215], v233 offset:34816
  v_mul_f32 v207, s43, v207
  v_mfma_f32_16x16x32_bf16 v[48:51], a[216:219], v[116:119], v[48:51]
  ds_read_b64_tr_b16 a[216:217], v234 offset:36864
  ds_read_b64_tr_b16 a[218:219], v234 offset:38912
  v_mfma_f32_16x16x32_bf16 v[36:39], a[220:223], v[96:99], v[36:39]
  buffer_load_dwordx4 v[212:215], v252, s[4:7], s40 offen offset:1024 sc1
  v_mfma_f32_16x16x32_bf16 v[36:39], a[224:227], v[112:115], v[36:39]
  s_mov_b32 s41, 262144
  s_add_u32 m0, s42, 36864
  v_mfma_f32_16x16x32_bf16 v[52:55], a[220:223], v[100:103], v[52:55]
  ds_read_b64_tr_b16 a[220:221], v234 offset:32768
  ds_read_b64_tr_b16 a[222:223], v234 offset:34816
  v_exp_f32 v200, v200
  v_mfma_f32_16x16x32_bf16 v[52:55], a[224:227], v[116:119], v[52:55]
  ds_read_b64_tr_b16 a[224:225], v235 offset:36864
  ds_read_b64_tr_b16 a[226:227], v235 offset:38912
  s_waitcnt lgkmcnt(13)
  v_mfma_f32_16x16x32_bf16 v[40:43], a[228:231], v[96:99], v[40:43]
  buffer_load_dwordx4 v253, s[44:47], s41 offen offset:0 lds
  v_exp_f32 v201, v201
  v_mfma_f32_16x16x32_bf16 v[40:43], a[232:235], v[112:115], v[40:43]
  s_mov_b32 s41, 524288
  s_add_u32 m0, s42, 49152
  v_mfma_f32_16x16x32_bf16 v[56:59], a[228:231], v[100:103], v[56:59]
  ds_read_b64_tr_b16 a[228:229], v235 offset:32768
  ds_read_b64_tr_b16 a[230:231], v235 offset:34816
  v_mfma_f32_16x16x32_bf16 v[56:59], a[232:235], v[116:119], v[56:59]
  ds_read_b64_tr_b16 a[232:233], v232 offset:45056
  ds_read_b64_tr_b16 a[234:235], v232 offset:47104
  v_exp_f32 v202, v202
  v_mfma_f32_16x16x32_bf16 v[44:47], a[192:195], v[96:99], v[44:47]
  buffer_load_dwordx4 v242, s[44:47], s41 offen offset:0 lds
  v_mfma_f32_16x16x32_bf16 v[44:47], a[196:199], v[112:115], v[44:47]
  s_mov_b32 s41, 786432
  s_add_u32 m0, s42, 32768
  v_mfma_f32_16x16x32_bf16 v[60:63], a[192:195], v[100:103], v[60:63]
  ds_read_b64_tr_b16 a[192:193], v232 offset:61440
  ds_read_b64_tr_b16 a[194:195], v232 offset:63488
  v_exp_f32 v203, v203
  v_mfma_f32_16x16x32_bf16 v[60:63], a[196:199], v[116:119], v[60:63]
  ds_read_b64_tr_b16 a[196:197], v233 offset:45056
  ds_read_b64_tr_b16 a[198:199], v233 offset:47104
  s_waitcnt lgkmcnt(13)
  v_mfma_f32_16x16x32_bf16 v[0:3], a[200:203], v[96:99], v[0:3]
  buffer_load_dwordx4 v242, s[44:47], s41 offen offset:0 lds
  v_exp_f32 v204, v204
  v_mfma_f32_16x16x32_bf16 v[0:3], a[204:207], v[112:115], v[0:3]
  s_mov_b32 s41, 524288
  s_add_u32 m0, s42, 40960
  v_mfma_f32_16x16x32_bf16 v[16:19], a[200:203], v[100:103], v[16:19]
  ds_read_b64_tr_b16 a[200:201], v233 offset:61440
  ds_read_b64_tr_b16 a[202:203], v233 offset:63488
  v_mfma_f32_16x16x32_bf16 v[16:19], a[204:207], v[116:119], v[16:19]
  ds_read_b64_tr_b16 a[204:205], v234 offset:45056
  ds_read_b64_tr_b16 a[206:207], v234 offset:47104
  v_exp_f32 v205, v205
  v_mfma_f32_16x16x32_bf16 v[4:7], a[208:211], v[96:99], v[4:7]
  buffer_load_dwordx4 v253, s[44:47], s41 offen offset:0 lds
  v_mfma_f32_16x16x32_bf16 v[4:7], a[212:215], v[112:115], v[4:7]
  s_mov_b32 s41, 786432
  s_add_u32 m0, s42, 53248
  v_mfma_f32_16x16x32_bf16 v[20:23], a[208:211], v[100:103], v[20:23]
  ds_read_b64_tr_b16 a[208:209], v234 offset:61440
  ds_read_b64_tr_b16 a[210:211], v234 offset:63488
  v_exp_f32 v206, v206
  v_mfma_f32_16x16x32_bf16 v[20:23], a[212:215], v[116:119], v[20:23]
  ds_read_b64_tr_b16 a[212:213], v235 offset:45056
  ds_read_b64_tr_b16 a[214:215], v235 offset:47104
  buffer_load_dword v244, v243, s[4:7], s91 offen sc1
  s_waitcnt lgkmcnt(13)
  v_mfma_f32_16x16x32_bf16 v[8:11], a[216:219], v[96:99], v[8:11]
  v_exp_f32 v207, v207
  v_add_f32 v200, 1.0, v200
  v_mfma_f32_16x16x32_bf16 v[8:11], a[220:223], v[112:115], v[8:11]
  buffer_load_dwordx4 v253, s[44:47], s41 offen offset:0 lds
  v_mfma_f32_16x16x32_bf16 v[24:27], a[216:219], v[100:103], v[24:27]
  ds_read_b64_tr_b16 a[216:217], v235 offset:61440
  ds_read_b64_tr_b16 a[218:219], v235 offset:63488
  v_add_f32 v201, 1.0, v201
  v_mfma_f32_16x16x32_bf16 v[24:27], a[220:223], v[116:119], v[24:27]
  ds_read_b64_tr_b16 a[220:221], v232 offset:57344
  ds_read_b64_tr_b16 a[222:223], v232 offset:59392
L_wk1_9:
  s_cbranch_vccnz L_wk1_end
  v_add_f32 v202, 1.0, v202
  v_mfma_f32_16x16x32_bf16 v[12:15], a[224:227], v[96:99], v[12:15]
  s_waitcnt vmcnt(15)
  v_swap_b32 v130, v132
  v_swap_b32 v131, v133
  v_swap_b32 v146, v148
  v_swap_b32 v147, v149
  s_mov_b32 s41, 917504
  s_add_u32 m0, s42, 57344
  v_add_f32 v203, 1.0, v203
  v_mfma_f32_16x16x32_bf16 v[12:15], a[228:231], v[112:115], v[12:15]
  buffer_load_dwordx4 v242, s[44:47], s41 offen offset:0 lds
  v_mfma_f32_16x16x32_bf16 v[28:31], a[224:227], v[100:103], v[28:31]
  ds_read_b64_tr_b16 a[224:225], v236 offset:4096
  ds_read_b64_tr_b16 a[226:227], v236 offset:6144
  v_add_f32 v204, 1.0, v204
  v_mfma_f32_16x16x32_bf16 v[28:31], a[228:231], v[116:119], v[28:31]
  ds_read_b64_tr_b16 a[228:229], v233 offset:57344
  ds_read_b64_tr_b16 a[230:231], v233 offset:59392
  v_add_f32 v205, 1.0, v205
  s_waitcnt lgkmcnt(13)
  v_mfma_f32_16x16x32_bf16 v[32:35], a[232:235], v[128:131], v[32:35]
  s_mov_b32 s41, 1179648
  s_add_u32 m0, s42, 65536
  v_add_f32 v206, 1.0, v206
  v_mfma_f32_16x16x32_bf16 v[32:35], a[192:195], v[144:147], v[32:35]
  s_barrier
  v_mfma_f32_16x16x32_bf16 v[48:51], a[232:235], v[132:135], v[48:51]
  buffer_load_dwordx4 v242, s[44:47], s41 offen offset:0 lds
  v_add_f32 v207, 1.0, v207
  v_mfma_f32_16x16x32_bf16 v[48:51], a[192:195], v[148:151], v[48:51]
  ds_read_b64_tr_b16 a[232:233], v237 offset:4096
  ds_read_b64_tr_b16 a[234:235], v237 offset:6144
  v_mfma_f32_16x16x32_bf16 v[36:39], a[196:199], v[128:131], v[36:39]
  ds_read_b64_tr_b16 a[192:193], v234 offset:57344
  ds_read_b64_tr_b16 a[194:195], v234 offset:59392
  v_mfma_f32_16x16x32_bf16 v[36:39], a[200:203], v[144:147], v[36:39]
  s_mov_b32 s41, 917504
  s_add_u32 m0, s42, 94208
  v_mfma_f32_16x16x32_bf16 v[52:55], a[196:199], v[132:135], v[52:55]
  buffer_load_dwordx4 v253, s[44:47], s41 offen offset:0 lds
  v_rcp_f32 v200, v200
  v_mfma_f32_16x16x32_bf16 v[52:55], a[200:203], v[148:151], v[52:55]
  ds_read_b64_tr_b16 a[196:197], v238 offset:4096
  ds_read_b64_tr_b16 a[198:199], v238 offset:6144
  s_waitcnt lgkmcnt(13)
  v_mfma_f32_16x16x32_bf16 v[40:43], a[204:207], v[128:131], v[40:43]
  ds_read_b64_tr_b16 a[200:201], v235 offset:57344
  ds_read_b64_tr_b16 a[202:203], v235 offset:59392
  v_rcp_f32 v201, v201
  v_mfma_f32_16x16x32_bf16 v[40:43], a[208:211], v[144:147], v[40:43]
  s_mov_b32 s41, 1179648
  s_add_u32 m0, s42, 106496
  v_mfma_f32_16x16x32_bf16 v[56:59], a[204:207], v[132:135], v[56:59]
  buffer_load_dwordx4 v253, s[44:47], s41 offen offset:0 lds
  v_mfma_f32_16x16x32_bf16 v[56:59], a[208:211], v[148:151], v[56:59]
  ds_read_b64_tr_b16 a[204:205], v239 offset:4096
  ds_read_b64_tr_b16 a[206:207], v239 offset:6144
  v_rcp_f32 v202, v202
  v_mfma_f32_16x16x32_bf16 v[44:47], a[212:215], v[128:131], v[44:47]
  ds_read_b64_tr_b16 a[208:209], v236 offset:20480
  ds_read_b64_tr_b16 a[210:211], v236 offset:22528
  s_waitcnt lgkmcnt(13)
  v_mfma_f32_16x16x32_bf16 v[44:47], a[216:219], v[144:147], v[44:47]
  s_mov_b32 s41, 1441792
  s_add_u32 m0, s42, 114688
  v_mfma_f32_16x16x32_bf16 v[60:63], a[212:215], v[132:135], v[60:63]
  buffer_load_dwordx4 v242, s[44:47], s41 offen offset:0 lds
  v_rcp_f32 v203, v203
  v_mfma_f32_16x16x32_bf16 v[60:63], a[216:219], v[148:151], v[60:63]
  ds_read_b64_tr_b16 a[212:213], v236 offset:16384
  ds_read_b64_tr_b16 a[214:215], v236 offset:18432
  v_mfma_f32_16x16x32_bf16 v[0:3], a[220:223], v[128:131], v[0:3]
  ds_read_b64_tr_b16 a[216:217], v237 offset:20480
  ds_read_b64_tr_b16 a[218:219], v237 offset:22528
  v_rcp_f32 v204, v204
  v_mfma_f32_16x16x32_bf16 v[0:3], a[224:227], v[144:147], v[0:3]
  s_mov_b32 s41, 1703936
  s_add_u32 m0, s42, 143360
  v_mfma_f32_16x16x32_bf16 v[16:19], a[220:223], v[132:135], v[16:19]
  buffer_load_dwordx4 v242, s[44:47], s41 offen offset:0 lds
  v_mfma_f32_16x16x32_bf16 v[16:19], a[224:227], v[148:151], v[16:19]
  ds_read_b64_tr_b16 a[220:221], v237 offset:16384
  ds_read_b64_tr_b16 a[222:223], v237 offset:18432
  v_rcp_f32 v205, v205
  s_waitcnt lgkmcnt(13)
  v_mfma_f32_16x16x32_bf16 v[4:7], a[228:231], v[128:131], v[4:7]
  ds_read_b64_tr_b16 a[224:225], v238 offset:20480
  ds_read_b64_tr_b16 a[226:227], v238 offset:22528
  v_mfma_f32_16x16x32_bf16 v[4:7], a[232:235], v[144:147], v[4:7]
  s_mov_b32 s41, 1441792
  s_add_u32 m0, s42, 69632
  v_mfma_f32_16x16x32_bf16 v[20:23], a[228:231], v[132:135], v[20:23]
  buffer_load_dwordx4 v253, s[44:47], s41 offen offset:0 lds
  v_rcp_f32 v206, v206
  v_mfma_f32_16x16x32_bf16 v[20:23], a[232:235], v[148:151], v[20:23]
  ds_read_b64_tr_b16 a[228:229], v238 offset:16384
  ds_read_b64_tr_b16 a[230:231], v238 offset:18432
  v_mfma_f32_16x16x32_bf16 v[8:11], a[192:195], v[128:131], v[8:11]
  ds_read_b64_tr_b16 a[232:233], v239 offset:20480
  ds_read_b64_tr_b16 a[234:235], v239 offset:22528
  v_rcp_f32 v207, v207
  v_mul_f32 v200, v200, v216
  s_waitcnt lgkmcnt(13)
  v_mfma_f32_16x16x32_bf16 v[8:11], a[196:199], v[144:147], v[8:11]
  s_mov_b32 s41, 1703936
  s_add_u32 m0, s42, 81920
  v_mfma_f32_16x16x32_bf16 v[24:27], a[192:195], v[132:135], v[24:27]
  buffer_load_dwordx4 v253, s[44:47], s41 offen offset:0 lds
  v_mul_f32 v201, v201, v217
  v_mfma_f32_16x16x32_bf16 v[24:27], a[196:199], v[148:151], v[24:27]
  ds_read_b64_tr_b16 a[192:193], v239 offset:16384
  ds_read_b64_tr_b16 a[194:195], v239 offset:18432
  v_mul_f32 v202, v202, v218
  v_mfma_f32_16x16x32_bf16 v[12:15], a[200:203], v[128:131], v[12:15]
  s_waitcnt vmcnt(19)
  v_swap_b32 v162, v164
  v_swap_b32 v163, v165
  v_swap_b32 v178, v180
  v_swap_b32 v179, v181
  ds_read_b64_tr_b16 a[196:197], v236 offset:28672
  ds_read_b64_tr_b16 a[198:199], v236 offset:30720
  v_mul_f32 v203, v203, v219
  v_mfma_f32_16x16x32_bf16 v[12:15], a[204:207], v[144:147], v[12:15]
  s_mov_b32 s41, 1835008
  s_add_u32 m0, s42, 61440
  v_mfma_f32_16x16x32_bf16 v[28:31], a[200:203], v[132:135], v[28:31]
  buffer_load_dwordx4 v242, s[44:47], s41 offen offset:0 lds
  v_mul_f32 v204, v204, v220
  v_mfma_f32_16x16x32_bf16 v[28:31], a[204:207], v[148:151], v[28:31]
  ds_read_b64_tr_b16 a[200:201], v228 offset:16384
  ds_read_b64_tr_b16 a[202:203], v228 offset:18432
  s_waitcnt vmcnt(10)
  v_subrev_u32 v244, s100, v244
  v_mul_f32 v205, v205, v221
  s_waitcnt lgkmcnt(13)
  v_mfma_f32_16x16x32_bf16 v[32:35], a[208:211], v[160:163], v[32:35]
  ds_read_b64_tr_b16 a[204:205], v237 offset:28672
  ds_read_b64_tr_b16 a[206:207], v237 offset:30720
  v_subrev_u32 v244, 2, v244
  v_cmp_lt_u32 s[68:69], 5, v244
  v_mul_f32 v206, v206, v222
  v_mfma_f32_16x16x32_bf16 v[32:35], a[212:215], v[176:179], v[32:35]
  s_barrier
  s_cmp_lg_u64 s[68:69], 0
  s_cbranch_scc1 L_slow_33
L_back_34:
  v_mfma_f32_16x16x32_bf16 v[48:51], a[208:211], v[164:167], v[48:51]
  ds_read_b64_tr_b16 a[208:209], v229 offset:16384
  ds_read_b64_tr_b16 a[210:211], v229 offset:18432
  v_mul_f32 v207, v207, v223
  v_mfma_f32_16x16x32_bf16 v[48:51], a[212:215], v[180:183], v[48:51]
  ds_read_b64_tr_b16 a[212:213], v238 offset:28672
  ds_read_b64_tr_b16 a[214:215], v238 offset:30720
  v_cvt_pk_bf16_f32 v200, v200, v201
  v_mfma_f32_16x16x32_bf16 v[36:39], a[216:219], v[160:163], v[36:39]
  s_mov_b32 s41, 2097152
  s_add_u32 m0, s42, 90112
  v_cvt_pk_bf16_f32 v201, v202, v203
  s_waitcnt lgkmcnt(13)
  v_mfma_f32_16x16x32_bf16 v[36:39], a[220:223], v[176:179], v[36:39]
  buffer_load_dwordx4 v242, s[44:47], s41 offen offset:0 lds
  v_mfma_f32_16x16x32_bf16 v[52:55], a[216:219], v[164:167], v[52:55]
  ds_read_b64_tr_b16 a[216:217], v230 offset:16384
  ds_read_b64_tr_b16 a[218:219], v230 offset:18432
  v_cvt_pk_bf16_f32 v202, v204, v205
  v_mfma_f32_16x16x32_bf16 v[52:55], a[220:223], v[180:183], v[52:55]
  ds_read_b64_tr_b16 a[220:221], v239 offset:28672
  ds_read_b64_tr_b16 a[222:223], v239 offset:30720
  v_cvt_pk_bf16_f32 v203, v206, v207
  v_mfma_f32_16x16x32_bf16 v[40:43], a[224:227], v[160:163], v[40:43]
  s_mov_b32 s40, 20971520
  v_mfma_f32_16x16x32_bf16 v[40:43], a[228:231], v[176:179], v[40:43]
  buffer_load_dwordx4 a[64:67], v252, s[4:7], s40 offen offset:0 sc1
  v_mfma_f32_16x16x32_bf16 v[56:59], a[224:227], v[164:167], v[56:59]
  ds_read_b64_tr_b16 a[224:225], v231 offset:16384
  ds_read_b64_tr_b16 a[226:227], v231 offset:18432
  v_mfma_f32_16x16x32_bf16 v[56:59], a[228:231], v[180:183], v[56:59]
  ds_read_b64_tr_b16 a[228:229], v228 offset:28672
  ds_read_b64_tr_b16 a[230:231], v228 offset:30720
  buffer_store_dwordx4 v[200:203], v225, s[4:7], s21 offen offset:3072 sc1
  s_waitcnt lgkmcnt(13)
  v_mfma_f32_16x16x32_bf16 v[44:47], a[232:235], v[160:163], v[44:47]
  v_mfma_f32_16x16x32_bf16 v[44:47], a[192:195], v[176:179], v[44:47]
  buffer_load_dwordx4 a[68:71], v252, s[4:7], s40 offen offset:1024 sc1
  v_mfma_f32_16x16x32_bf16 v[60:63], a[232:235], v[164:167], v[60:63]
  ds_read_b64_tr_b16 a[232:233], v236 offset:8192
  ds_read_b64_tr_b16 a[234:235], v236 offset:10240
  v_mfma_f32_16x16x32_bf16 v[60:63], a[192:195], v[180:183], v[60:63]
  ds_read_b64_tr_b16 a[192:193], v229 offset:28672
  ds_read_b64_tr_b16 a[194:195], v229 offset:30720
  v_mfma_f32_16x16x32_bf16 v[0:3], a[196:199], v[160:163], v[0:3]
  s_mov_b32 s40, 21102592
  v_mfma_f32_16x16x32_bf16 v[0:3], a[200:203], v[176:179], v[0:3]
  buffer_load_dwordx4 a[72:75], v252, s[4:7], s40 offen offset:0 sc1
  v_mfma_f32_16x16x32_bf16 v[16:19], a[196:199], v[164:167], v[16:19]
  ds_read_b64_tr_b16 a[196:197], v237 offset:8192
  ds_read_b64_tr_b16 a[198:199], v237 offset:10240
  v_mfma_f32_16x16x32_bf16 v[16:19], a[200:203], v[180:183], v[16:19]
  ds_read_b64_tr_b16 a[200:201], v230 offset:28672
  ds_read_b64_tr_b16 a[202:203], v230 offset:30720
  s_waitcnt lgkmcnt(13)
  v_mfma_f32_16x16x32_bf16 v[4:7], a[204:207], v[160:163], v[4:7]
  buffer_load_dwordx4 a[76:79], v252, s[4:7], s40 offen offset:1024 sc1
  v_mfma_f32_16x16x32_bf16 v[4:7], a[208:211], v[176:179], v[4:7]
  s_mov_b32 s40, 21233664
  v_mfma_f32_16x16x32_bf16 v[20:23], a[204:207], v[164:167], v[20:23]
  ds_read_b64_tr_b16 a[204:205], v238 offset:8192
  ds_read_b64_tr_b16 a[206:207], v238 offset:10240
  v_mfma_f32_16x16x32_bf16 v[20:23], a[208:211], v[180:183], v[20:23]
  ds_read_b64_tr_b16 a[208:209], v231 offset:28672
  ds_read_b64_tr_b16 a[210:211], v231 offset:30720
  v_mfma_f32_16x16x32_bf16 v[8:11], a[212:215], v[160:163], v[8:11]
  buffer_load_dwordx4 a[80:83], v252, s[4:7], s40 offen offset:0 sc1
  v_mfma_f32_16x16x32_bf16 v[8:11], a[216:219], v[176:179], v[8:11]
  v_mfma_f32_16x16x32_bf16 v[24:27], a[212:215], v[164:167], v[24:27]
  ds_read_b64_tr_b16 a[212:213], v239 offset:8192
  ds_read_b64_tr_b16 a[214:215], v239 offset:10240
  v_mfma_f32_16x16x32_bf16 v[24:27], a[216:219], v[180:183], v[24:27]
  ds_read_b64_tr_b16 a[216:217], v236 offset:24576
  ds_read_b64_tr_b16 a[218:219], v236 offset:26624
  s_waitcnt lgkmcnt(13)
  v_mfma_f32_16x16x32_bf16 v[12:15], a[220:223], v[160:163], v[12:15]
  v_swap_b32 v194, v196
  v_swap_b32 v195, v197
  v_swap_b32 v210, v212
  v_swap_b32 v211, v213
  buffer_load_dwordx4 a[84:87], v252, s[4:7], s40 offen offset:1024 sc1
  v_mfma_f32_16x16x32_bf16 v[12:15], a[224:227], v[176:179], v[12:15]
  s_mov_b32 s40, 21364736
  v_mfma_f32_16x16x32_bf16 v[28:31], a[220:223], v[164:167], v[28:31]
  ds_read_b64_tr_b16 a[220:221], v228 offset:20480
  ds_read_b64_tr_b16 a[222:223], v228 offset:22528
  v_mfma_f32_16x16x32_bf16 v[28:31], a[224:227], v[180:183], v[28:31]
  ds_read_b64_tr_b16 a[224:225], v237 offset:24576
  ds_read_b64_tr_b16 a[226:227], v237 offset:26624
  v_mfma_f32_16x16x32_bf16 v[32:35], a[228:231], v[192:195], v[32:35]
  buffer_load_dwordx4 a[88:91], v252, s[4:7], s40 offen offset:0 sc1
  v_mfma_f32_16x16x32_bf16 v[32:35], a[232:235], v[208:211], v[32:35]
  s_barrier
  v_mfma_f32_16x16x32_bf16 v[48:51], a[228:231], v[196:199], v[48:51]
  ds_read_b64_tr_b16 a[228:229], v229 offset:20480
  ds_read_b64_tr_b16 a[230:231], v229 offset:22528
  v_mfma_f32_16x16x32_bf16 v[48:51], a[232:235], v[212:215], v[48:51]
  ds_read_b64_tr_b16 a[232:233], v238 offset:24576
  ds_read_b64_tr_b16 a[234:235], v238 offset:26624
  s_waitcnt lgkmcnt(13)
  v_mfma_f32_16x16x32_bf16 v[36:39], a[192:195], v[192:195], v[36:39]
  buffer_load_dwordx4 a[92:95], v252, s[4:7], s40 offen offset:1024 sc1
  v_mfma_f32_16x16x32_bf16 v[36:39], a[196:199], v[208:211], v[36:39]
  s_mov_b32 s40, 21495808
  v_mfma_f32_16x16x32_bf16 v[52:55], a[192:195], v[196:199], v[52:55]
  ds_read_b64_tr_b16 a[192:193], v230 offset:20480
  ds_read_b64_tr_b16 a[194:195], v230 offset:22528
  v_mfma_f32_16x16x32_bf16 v[52:55], a[196:199], v[212:215], v[52:55]
  ds_read_b64_tr_b16 a[196:197], v239 offset:24576
  ds_read_b64_tr_b16 a[198:199], v239 offset:26624
  v_mfma_f32_16x16x32_bf16 v[40:43], a[200:203], v[192:195], v[40:43]
  buffer_load_dwordx4 a[96:99], v252, s[4:7], s40 offen offset:0 sc1
  v_mfma_f32_16x16x32_bf16 v[40:43], a[204:207], v[208:211], v[40:43]
  v_mfma_f32_16x16x32_bf16 v[56:59], a[200:203], v[196:199], v[56:59]
  ds_read_b64_tr_b16 a[200:201], v231 offset:20480
  ds_read_b64_tr_b16 a[202:203], v231 offset:22528
  v_mfma_f32_16x16x32_bf16 v[56:59], a[204:207], v[212:215], v[56:59]
  ds_read_b64_tr_b16 a[204:205], v228 offset:12288
  ds_read_b64_tr_b16 a[206:207], v228 offset:14336
  s_waitcnt lgkmcnt(13)
  v_mfma_f32_16x16x32_bf16 v[44:47], a[208:211], v[192:195], v[44:47]
  buffer_load_dwordx4 a[100:103], v252, s[4:7], s40 offen offset:1024 sc1
  v_mfma_f32_16x16x32_bf16 v[44:47], a[212:215], v[208:211], v[44:47]
  s_mov_b32 s40, 21626880
  v_mfma_f32_16x16x32_bf16 v[60:63], a[208:211], v[196:199], v[60:63]
  ds_read_b64_tr_b16 a[208:209], v228 offset:24576
  ds_read_b64_tr_b16 a[210:211], v228 offset:26624
  v_mfma_f32_16x16x32_bf16 v[60:63], a[212:215], v[212:215], v[60:63]
  ds_read_b64_tr_b16 a[212:213], v229 offset:12288
  ds_read_b64_tr_b16 a[214:215], v229 offset:14336
  v_mfma_f32_16x16x32_bf16 v[0:3], a[216:219], v[192:195], v[0:3]
  buffer_load_dwordx4 a[104:107], v252, s[4:7], s40 offen offset:0 sc1
  v_mfma_f32_16x16x32_bf16 v[0:3], a[220:223], v[208:211], v[0:3]
  v_mfma_f32_16x16x32_bf16 v[16:19], a[216:219], v[196:199], v[16:19]
  ds_read_b64_tr_b16 a[216:217], v229 offset:24576
  ds_read_b64_tr_b16 a[218:219], v229 offset:26624
  v_mfma_f32_16x16x32_bf16 v[16:19], a[220:223], v[212:215], v[16:19]
  ds_read_b64_tr_b16 a[220:221], v230 offset:12288
  ds_read_b64_tr_b16 a[222:223], v230 offset:14336
  s_waitcnt lgkmcnt(13)
  v_mfma_f32_16x16x32_bf16 v[4:7], a[224:227], v[192:195], v[4:7]
  buffer_load_dwordx4 a[108:111], v252, s[4:7], s40 offen offset:1024 sc1
  v_mfma_f32_16x16x32_bf16 v[4:7], a[228:231], v[208:211], v[4:7]
  s_mov_b32 s40, 21757952
  v_mfma_f32_16x16x32_bf16 v[20:23], a[224:227], v[196:199], v[20:23]
  ds_read_b64_tr_b16 a[224:225], v230 offset:24576
  ds_read_b64_tr_b16 a[226:227], v230 offset:26624
  v_mfma_f32_16x16x32_bf16 v[20:23], a[228:231], v[212:215], v[20:23]
  ds_read_b64_tr_b16 a[228:229], v231 offset:12288
  ds_read_b64_tr_b16 a[230:231], v231 offset:14336
  v_mfma_f32_16x16x32_bf16 v[8:11], a[232:235], v[192:195], v[8:11]
  buffer_load_dwordx4 a[112:115], v252, s[4:7], s40 offen offset:0 sc1
  v_mfma_f32_16x16x32_bf16 v[8:11], a[192:195], v[208:211], v[8:11]
  v_mfma_f32_16x16x32_bf16 v[24:27], a[232:235], v[196:199], v[24:27]
  ds_read_b64_tr_b16 a[232:233], v231 offset:24576
  ds_read_b64_tr_b16 a[234:235], v231 offset:26624
  v_mfma_f32_16x16x32_bf16 v[24:27], a[192:195], v[212:215], v[24:27]
  ds_read_b64_tr_b16 a[192:193], v228 offset:45056
  ds_read_b64_tr_b16 a[194:195], v228 offset:47104
  s_waitcnt lgkmcnt(13)
  v_mfma_f32_16x16x32_bf16 v[12:15], a[196:199], v[192:195], v[12:15]
  buffer_load_dwordx4 a[116:119], v252, s[4:7], s40 offen offset:1024 sc1
  v_mfma_f32_16x16x32_bf16 v[12:15], a[200:203], v[208:211], v[12:15]
  s_mov_b32 s40, 21889024
  v_mfma_f32_16x16x32_bf16 v[28:31], a[196:199], v[196:199], v[28:31]
  ds_read_b64_tr_b16 a[196:197], v228 offset:36864
  ds_read_b64_tr_b16 a[198:199], v228 offset:38912
  v_mfma_f32_16x16x32_bf16 v[28:31], a[200:203], v[212:215], v[28:31]
  ds_read_b64_tr_b16 a[200:201], v229 offset:45056
  ds_read_b64_tr_b16 a[202:203], v229 offset:47104
  s_waitcnt vmcnt(10)
  v_mfma_f32_16x16x32_bf16 v[32:35], a[204:207], a[64:67], v[32:35]
  buffer_load_dwordx4 a[120:123], v252, s[4:7], s40 offen offset:0 sc1
  v_mfma_f32_16x16x32_bf16 v[32:35], a[208:211], a[72:75], v[32:35]
  s_barrier
  v_mfma_f32_16x16x32_bf16 v[48:51], a[204:207], a[68:71], v[48:51]
  ds_read_b64_tr_b16 a[204:205], v229 offset:36864
  ds_read_b64_tr_b16 a[206:207], v229 offset:38912
  v_mfma_f32_16x16x32_bf16 v[48:51], a[208:211], a[76:79], v[48:51]
  ds_read_b64_tr_b16 a[208:209], v230 offset:45056
  ds_read_b64_tr_b16 a[210:211], v230 offset:47104
  s_waitcnt lgkmcnt(13)
  v_mfma_f32_16x16x32_bf16 v[36:39], a[212:215], a[64:67], v[36:39]
  buffer_load_dwordx4 a[124:127], v252, s[4:7], s40 offen offset:1024 sc1
  v_mfma_f32_16x16x32_bf16 v[36:39], a[216:219], a[72:75], v[36:39]
  s_mov_b32 s41, 1835008
  s_add_u32 m0, s42, 118784
  v_mfma_f32_16x16x32_bf16 v[52:55], a[212:215], a[68:71], v[52:55]
  ds_read_b64_tr_b16 a[212:213], v230 offset:36864
  ds_read_b64_tr_b16 a[214:215], v230 offset:38912
  v_mfma_f32_16x16x32_bf16 v[52:55], a[216:219], a[76:79], v[52:55]
  ds_read_b64_tr_b16 a[216:217], v231 offset:45056
  ds_read_b64_tr_b16 a[218:219], v231 offset:47104
  v_mfma_f32_16x16x32_bf16 v[40:43], a[220:223], a[64:67], v[40:43]
  buffer_load_dwordx4 v253, s[44:47], s41 offen offset:0 lds
  v_add_u32 v248, 3, v245
  buffer_store_dword v248, v246, s[4:7], s90 offen sc1
  v_mfma_f32_16x16x32_bf16 v[40:43], a[224:227], a[72:75], v[40:43]
  s_mov_b32 s41, 2097152
  s_add_u32 m0, s42, 131072
  v_mfma_f32_16x16x32_bf16 v[56:59], a[220:223], a[68:71], v[56:59]
  ds_read_b64_tr_b16 a[220:221], v231 offset:36864
  ds_read_b64_tr_b16 a[222:223], v231 offset:38912
  v_mfma_f32_16x16x32_bf16 v[56:59], a[224:227], a[76:79], v[56:59]
  ds_read_b64_tr_b16 a[224:225], v228 offset:49152
  ds_read_b64_tr_b16 a[226:227], v228 offset:51200
  s_waitcnt lgkmcnt(13)
  v_mfma_f32_16x16x32_bf16 v[44:47], a[228:231], a[64:67], v[44:47]
  buffer_load_dwordx4 v253, s[44:47], s41 offen offset:0 lds
  v_mfma_f32_16x16x32_bf16 v[44:47], a[232:235], a[72:75], v[44:47]
  s_mov_b32 s40, 22020096
  v_mfma_f32_16x16x32_bf16 v[60:63], a[228:231], a[68:71], v[60:63]
  ds_read_b64_tr_b16 a[228:229], v228 offset:32768
  ds_read_b64_tr_b16 a[230:231], v228 offset:34816
  v_mfma_f32_16x16x32_bf16 v[60:63], a[232:235], a[76:79], v[60:63]
  ds_read_b64_tr_b16 a[232:233], v229 offset:49152
  ds_read_b64_tr_b16 a[234:235], v229 offset:51200
  v_mfma_f32_16x16x32_bf16 v[0:3], a[192:195], a[64:67], v[0:3]
  buffer_load_dwordx4 a[128:131], v252, s[4:7], s40 offen offset:0 sc1
  v_mfma_f32_16x16x32_bf16 v[0:3], a[196:199], a[72:75], v[0:3]
  v_mfma_f32_16x16x32_bf16 v[16:19], a[192:195], a[68:71], v[16:19]
  ds_read_b64_tr_b16 a[192:193], v229 offset:32768
  ds_read_b64_tr_b16 a[194:195], v229 offset:34816
  v_mfma_f32_16x16x32_bf16 v[16:19], a[196:199], a[76:79], v[16:19]
  ds_read_b64_tr_b16 a[196:197], v230 offset:49152
  ds_read_b64_tr_b16 a[198:199], v230 offset:51200
  s_waitcnt lgkmcnt(13)
  v_mfma_f32_16x16x32_bf16 v[4:7], a[200:203], a[64:67], v[4:7]
  buffer_load_dwordx4 a[132:135], v252, s[4:7], s40 offen offset:1024 sc1
  v_mfma_f32_16x16x32_bf16 v[4:7], a[204:207], a[72:75], v[4:7]
  s_mov_b32 s40, 22151168
  v_mfma_f32_16x16x32_bf16 v[20:23], a[200:203], a[68:71], v[20:23]
  ds_read_b64_tr_b16 a[200:201], v230 offset:32768
  ds_read_b64_tr_b16 a[202:203], v230 offset:34816
  v_mfma_f32_16x16x32_bf16 v[20:23], a[204:207], a[76:79], v[20:23]
  ds_read_b64_tr_b16 a[204:205], v231 offset:49152
  ds_read_b64_tr_b16 a[206:207], v231 offset:51200
  v_mfma_f32_16x16x32_bf16 v[8:11], a[208:211], a[64:67], v[8:11]
  buffer_load_dwordx4 a[136:139], v252, s[4:7], s40 offen offset:0 sc1
  v_mfma_f32_16x16x32_bf16 v[8:11], a[212:215], a[72:75], v[8:11]
  v_mfma_f32_16x16x32_bf16 v[24:27], a[208:211], a[68:71], v[24:27]
  ds_read_b64_tr_b16 a[208:209], v231 offset:32768
  ds_read_b64_tr_b16 a[210:211], v231 offset:34816
  v_mfma_f32_16x16x32_bf16 v[24:27], a[212:215], a[76:79], v[24:27]
  ds_read_b64_tr_b16 a[212:213], v228 offset:40960
  ds_read_b64_tr_b16 a[214:215], v228 offset:43008
  s_waitcnt lgkmcnt(13)
  v_mfma_f32_16x16x32_bf16 v[12:15], a[216:219], a[64:67], v[12:15]
  buffer_load_dwordx4 a[140:143], v252, s[4:7], s40 offen offset:1024 sc1
  v_mfma_f32_16x16x32_bf16 v[12:15], a[220:223], a[72:75], v[12:15]
  s_mov_b32 s41, 2359296
  s_add_u32 m0, s42, 77824
  v_mfma_f32_16x16x32_bf16 v[28:31], a[216:219], a[68:71], v[28:31]
  ds_read_b64_tr_b16 a[216:217], v228 offset:53248
  ds_read_b64_tr_b16 a[218:219], v228 offset:55296
  v_mfma_f32_16x16x32_bf16 v[28:31], a[220:223], a[76:79], v[28:31]
  ds_read_b64_tr_b16 a[220:221], v229 offset:40960
  ds_read_b64_tr_b16 a[222:223], v229 offset:43008
  s_waitcnt vmcnt(15)
  v_mfma_f32_16x16x32_bf16 v[32:35], a[224:227], a[80:83], v[32:35]
  buffer_load_dwordx4 v242, s[44:47], s41 offen offset:0 lds
  v_mfma_f32_16x16x32_bf16 v[32:35], a[228:231], a[88:91], v[32:35]
  s_barrier
  v_mfma_f32_16x16x32_bf16 v[48:51], a[224:227], a[84:87], v[48:51]
  ds_read_b64_tr_b16 a[224:225], v229 offset:53248
  ds_read_b64_tr_b16 a[226:227], v229 offset:55296
  v_mfma_f32_16x16x32_bf16 v[48:51], a[228:231], a[92:95], v[48:51]
  ds_read_b64_tr_b16 a[228:229], v230 offset:40960
  ds_read_b64_tr_b16 a[230:231], v230 offset:43008
  s_waitcnt lgkmcnt(13)
  v_mfma_f32_16x16x32_bf16 v[36:39], a[232:235], a[80:83], v[36:39]
  s_mov_b32 s41, 2621440
  s_add_u32 m0, s42, 73728
  v_mfma_f32_16x16x32_bf16 v[36:39], a[192:195], a[88:91], v[36:39]
  buffer_load_dwordx4 v242, s[44:47], s41 offen offset:0 lds
  v_mfma_f32_16x16x32_bf16 v[52:55], a[232:235], a[84:87], v[52:55]
  ds_read_b64_tr_b16 a[232:233], v230 offset:53248
  ds_read_b64_tr_b16 a[234:235], v230 offset:55296
  v_mfma_f32_16x16x32_bf16 v[52:55], a[192:195], a[92:95], v[52:55]
  ds_read_b64_tr_b16 a[192:193], v231 offset:40960
  ds_read_b64_tr_b16 a[194:195], v231 offset:43008
  v_mfma_f32_16x16x32_bf16 v[40:43], a[196:199], a[80:83], v[40:43]
  s_mov_b32 s41, 2359296
  s_add_u32 m0, s42, 86016
  v_mfma_f32_16x16x32_bf16 v[40:43], a[200:203], a[88:91], v[40:43]
  buffer_load_dwordx4 v253, s[44:47], s41 offen offset:0 lds
  v_mfma_f32_16x16x32_bf16 v[56:59], a[196:199], a[84:87], v[56:59]
  ds_read_b64_tr_b16 a[196:197], v231 offset:53248
  ds_read_b64_tr_b16 a[198:199], v231 offset:55296
  v_mfma_f32_16x16x32_bf16 v[56:59], a[200:203], a[92:95], v[56:59]
  ds_read_b64_tr_b16 a[200:201], v228 offset:57344
  ds_read_b64_tr_b16 a[202:203], v228 offset:59392
  s_waitcnt lgkmcnt(13)
  v_mfma_f32_16x16x32_bf16 v[44:47], a[204:207], a[80:83], v[44:47]
  s_mov_b32 s41, 2621440
  s_add_u32 m0, s42, 102400
  v_mfma_f32_16x16x32_bf16 v[44:47], a[208:211], a[88:91], v[44:47]
  buffer_load_dwordx4 v253, s[44:47], s41 offen offset:0 lds
  v_mfma_f32_16x16x32_bf16 v[60:63], a[204:207], a[84:87], v[60:63]
  ds_read_b64_tr_b16 a[204:205], v232 offset:0
  ds_read_b64_tr_b16 a[206:207], v232 offset:2048
  v_mfma_f32_16x16x32_bf16 v[60:63], a[208:211], a[92:95], v[60:63]
  ds_read_b64_tr_b16 a[208:209], v229 offset:57344
  ds_read_b64_tr_b16 a[210:211], v229 offset:59392
  v_mfma_f32_16x16x32_bf16 v[0:3], a[212:215], a[80:83], v[0:3]
  s_mov_b32 s40, 22282240
  v_mfma_f32_16x16x32_bf16 v[0:3], a[216:219], a[88:91], v[0:3]
  buffer_load_dwordx4 a[144:147], v252, s[4:7], s40 offen offset:0 sc1
  v_mfma_f32_16x16x32_bf16 v[16:19], a[212:215], a[84:87], v[16:19]
  ds_read_b64_tr_b16 a[212:213], v233 offset:0
  ds_read_b64_tr_b16 a[214:215], v233 offset:2048
  v_mfma_f32_16x16x32_bf16 v[16:19], a[216:219], a[92:95], v[16:19]
  ds_read_b64_tr_b16 a[216:217], v230 offset:57344
  ds_read_b64_tr_b16 a[218:219], v230 offset:59392
  s_waitcnt lgkmcnt(13)
  v_mfma_f32_16x16x32_bf16 v[4:7], a[220:223], a[80:83], v[4:7]
  buffer_load_dwordx4 a[148:151], v252, s[4:7], s40 offen offset:1024 sc1
  v_mfma_f32_16x16x32_bf16 v[4:7], a[224:227], a[88:91], v[4:7]
  s_mov_b32 s40, 22413312
  v_mfma_f32_16x16x32_bf16 v[20:23], a[220:223], a[84:87], v[20:23]
  ds_read_b64_tr_b16 a[220:221], v234 offset:0
  ds_read_b64_tr_b16 a[222:223], v234 offset:2048
  v_mfma_f32_16x16x32_bf16 v[20:23], a[224:227], a[92:95], v[20:23]
  ds_read_b64_tr_b16 a[224:225], v231 offset:57344
  ds_read_b64_tr_b16 a[226:227], v231 offset:59392
  v_mfma_f32_16x16x32_bf16 v[8:11], a[228:231], a[80:83], v[8:11]
  buffer_load_dwordx4 a[152:155], v252, s[4:7], s40 offen offset:0 sc1
  v_mfma_f32_16x16x32_bf16 v[8:11], a[232:235], a[88:91], v[8:11]
  v_mfma_f32_16x16x32_bf16 v[24:27], a[228:231], a[84:87], v[24:27]
  ds_read_b64_tr_b16 a[228:229], v235 offset:0
  ds_read_b64_tr_b16 a[230:231], v235 offset:2048
  v_mfma_f32_16x16x32_bf16 v[24:27], a[232:235], a[92:95], v[24:27]
  ds_read_b64_tr_b16 a[232:233], v232 offset:28672
  ds_read_b64_tr_b16 a[234:235], v232 offset:30720
  s_waitcnt lgkmcnt(13)
  v_mfma_f32_16x16x32_bf16 v[12:15], a[192:195], a[80:83], v[12:15]
  buffer_load_dwordx4 a[156:159], v252, s[4:7], s40 offen offset:1024 sc1
  v_mfma_f32_16x16x32_bf16 v[12:15], a[196:199], a[88:91], v[12:15]
  s_mov_b32 s41, 2752512
  s_add_u32 m0, s42, 98304
  v_mfma_f32_16x16x32_bf16 v[28:31], a[192:195], a[84:87], v[28:31]
  ds_read_b64_tr_b16 a[192:193], v232 offset:40960
  ds_read_b64_tr_b16 a[194:195], v232 offset:43008
  v_mfma_f32_16x16x32_bf16 v[28:31], a[196:199], a[92:95], v[28:31]
  ds_read_b64_tr_b16 a[196:197], v233 offset:28672
  ds_read_b64_tr_b16 a[198:199], v233 offset:30720
  s_waitcnt vmcnt(19)
  v_mfma_f32_16x16x32_bf16 v[32:35], a[200:203], a[96:99], v[32:35]
  buffer_load_dwordx4 v242, s[44:47], s41 offen offset:0 lds
  v_mfma_f32_16x16x32_bf16 v[32:35], a[204:207], a[104:107], v[32:35]
  s_barrier
  v_mfma_f32_16x16x32_bf16 v[48:51], a[200:203], a[100:103], v[48:51]
  ds_read_b64_tr_b16 a[200:201], v233 offset:40960
  ds_read_b64_tr_b16 a[202:203], v233 offset:43008
  v_mfma_f32_16x16x32_bf16 v[48:51], a[204:207], a[108:111], v[48:51]
  ds_read_b64_tr_b16 a[204:205], v234 offset:28672
  ds_read_b64_tr_b16 a[206:207], v234 offset:30720
  s_waitcnt lgkmcnt(13)
  v_mfma_f32_16x16x32_bf16 v[36:39], a[208:211], a[96:99], v[36:39]
  s_mov_b32 s41, 3014656
  s_add_u32 m0, s42, 110592
  v_mfma_f32_16x16x32_bf16 v[36:39], a[212:215], a[104:107], v[36:39]
  buffer_load_dwordx4 v242, s[44:47], s41 offen offset:0 lds
  v_mfma_f32_16x16x32_bf16 v[52:55], a[208:211], a[100:103], v[52:55]
  ds_read_b64_tr_b16 a[208:209], v234 offset:40960
  ds_read_b64_tr_b16 a[210:211], v234 offset:43008
  v_mfma_f32_16x16x32_bf16 v[52:55], a[212:215], a[108:111], v[52:55]
  ds_read_b64_tr_b16 a[212:213], v235 offset:28672
  ds_read_b64_tr_b16 a[214:215], v235 offset:30720
  v_mfma_f32_16x16x32_bf16 v[40:43], a[216:219], a[96:99], v[40:43]
  s_mov_b32 s41, 2752512
  s_add_u32 m0, s42, 126976
  v_mfma_f32_16x16x32_bf16 v[40:43], a[220:223], a[104:107], v[40:43]
  buffer_load_dwordx4 v253, s[44:47], s41 offen offset:0 lds
  v_mfma_f32_16x16x32_bf16 v[56:59], a[216:219], a[100:103], v[56:59]
  ds_read_b64_tr_b16 a[216:217], v235 offset:40960
  ds_read_b64_tr_b16 a[218:219], v235 offset:43008
  v_mfma_f32_16x16x32_bf16 v[56:59], a[220:223], a[108:111], v[56:59]
  ds_read_b64_tr_b16 a[220:221], v232 offset:49152
  ds_read_b64_tr_b16 a[222:223], v232 offset:51200
  s_waitcnt lgkmcnt(13)
  v_mfma_f32_16x16x32_bf16 v[44:47], a[224:227], a[96:99], v[44:47]
  s_mov_b32 s41, 3014656
  s_add_u32 m0, s42, 122880
  v_mfma_f32_16x16x32_bf16 v[44:47], a[228:231], a[104:107], v[44:47]
  buffer_load_dwordx4 v253, s[44:47], s41 offen offset:0 lds
  v_mfma_f32_16x16x32_bf16 v[60:63], a[224:227], a[100:103], v[60:63]
  ds_read_b64_tr_b16 a[224:225], v236 offset:12288
  ds_read_b64_tr_b16 a[226:227], v236 offset:14336
  v_mfma_f32_16x16x32_bf16 v[60:63], a[228:231], a[108:111], v[60:63]
  ds_read_b64_tr_b16 a[228:229], v233 offset:49152
  ds_read_b64_tr_b16 a[230:231], v233 offset:51200
  v_mfma_f32_16x16x32_bf16 v[0:3], a[232:235], a[96:99], v[0:3]
  s_mov_b32 s40, 22544384
  v_mfma_f32_16x16x32_bf16 v[0:3], a[192:195], a[104:107], v[0:3]
  buffer_load_dwordx4 a[160:163], v252, s[4:7], s40 offen offset:0 sc1
  v_mfma_f32_16x16x32_bf16 v[16:19], a[232:235], a[100:103], v[16:19]
  ds_read_b64_tr_b16 a[232:233], v237 offset:12288
  ds_read_b64_tr_b16 a[234:235], v237 offset:14336
  v_mfma_f32_16x16x32_bf16 v[16:19], a[192:195], a[108:111], v[16:19]
  ds_read_b64_tr_b16 a[192:193], v234 offset:49152
  ds_read_b64_tr_b16 a[194:195], v234 offset:51200
  s_waitcnt lgkmcnt(13)
  v_mfma_f32_16x16x32_bf16 v[4:7], a[196:199], a[96:99], v[4:7]
L_wk1_10:
  s_cbranch_vccnz L_wk1_end
  buffer_load_dwordx4 a[164:167], v252, s[4:7], s40 offen offset:1024 sc1
  v_mfma_f32_16x16x32_bf16 v[4:7], a[200:203], a[104:107], v[4:7]
  s_mov_b32 s40, 22675456
  v_mfma_f32_16x16x32_bf16 v[20:23], a[196:199], a[100:103], v[20:23]
  ds_read_b64_tr_b16 a[196:197], v238 offset:12288
  ds_read_b64_tr_b16 a[198:199], v238 offset:14336
  v_mfma_f32_16x16x32_bf16 v[20:23], a[200:203], a[108:111], v[20:23]
  ds_read_b64_tr_b16 a[200:201], v235 offset:49152
  ds_read_b64_tr_b16 a[202:203], v235 offset:51200
  v_mfma_f32_16x16x32_bf16 v[8:11], a[204:207], a[96:99], v[8:11]
  buffer_load_dwordx4 a[168:171], v252, s[4:7], s40 offen offset:0 sc1
  v_mfma_f32_16x16x32_bf16 v[8:11], a[208:211], a[104:107], v[8:11]
  v_mfma_f32_16x16x32_bf16 v[24:27], a[204:207], a[100:103], v[24:27]
  ds_read_b64_tr_b16 a[204:205], v239 offset:12288
  ds_read_b64_tr_b16 a[206:207], v239 offset:14336
  v_mfma_f32_16x16x32_bf16 v[24:27], a[208:211], a[108:111], v[24:27]
  ds_read_b64_tr_b16 a[208:209], v232 offset:4096
  ds_read_b64_tr_b16 a[210:211], v232 offset:6144
  s_waitcnt lgkmcnt(13)
  v_mfma_f32_16x16x32_bf16 v[12:15], a[212:215], a[96:99], v[12:15]
  buffer_load_dwordx4 a[172:175], v252, s[4:7], s40 offen offset:1024 sc1
  v_mfma_f32_16x16x32_bf16 v[12:15], a[216:219], a[104:107], v[12:15]
  s_mov_b32 s41, 3276800
  s_add_u32 m0, s42, 135168
  v_mfma_f32_16x16x32_bf16 v[28:31], a[212:215], a[100:103], v[28:31]
  ds_read_b64_tr_b16 a[212:213], v232 offset:16384
  ds_read_b64_tr_b16 a[214:215], v232 offset:18432
  v_mfma_f32_16x16x32_bf16 v[28:31], a[216:219], a[108:111], v[28:31]
  ds_read_b64_tr_b16 a[216:217], v233 offset:4096
  ds_read_b64_tr_b16 a[218:219], v233 offset:6144
  s_waitcnt vmcnt(23)
  v_mfma_f32_16x16x32_bf16 v[32:35], a[220:223], a[112:115], v[32:35]
  buffer_load_dwordx4 v242, s[44:47], s41 offen offset:0 lds
  v_mfma_f32_16x16x32_bf16 v[32:35], a[224:227], a[120:123], v[32:35]
  s_waitcnt vmcnt(21)
  s_barrier
  v_mfma_f32_16x16x32_bf16 v[48:51], a[220:223], a[116:119], v[48:51]
  ds_read_b64_tr_b16 a[220:221], v233 offset:16384
  ds_read_b64_tr_b16 a[222:223], v233 offset:18432
  v_mfma_f32_16x16x32_bf16 v[48:51], a[224:227], a[124:127], v[48:51]
  ds_read_b64_tr_b16 a[224:225], v234 offset:4096
  ds_read_b64_tr_b16 a[226:227], v234 offset:6144
  s_waitcnt lgkmcnt(13)
  v_mfma_f32_16x16x32_bf16 v[36:39], a[228:231], a[112:115], v[36:39]
  s_mov_b32 s41, 3538944
  s_add_u32 m0, s42, 151552
  v_mfma_f32_16x16x32_bf16 v[36:39], a[232:235], a[120:123], v[36:39]
  buffer_load_dwordx4 v242, s[44:47], s41 offen offset:0 lds
  v_mfma_f32_16x16x32_bf16 v[52:55], a[228:231], a[116:119], v[52:55]
  ds_read_b64_tr_b16 a[228:229], v234 offset:16384
  ds_read_b64_tr_b16 a[230:231], v234 offset:18432
  v_mfma_f32_16x16x32_bf16 v[52:55], a[232:235], a[124:127], v[52:55]
  ds_read_b64_tr_b16 a[232:233], v235 offset:4096
  ds_read_b64_tr_b16 a[234:235], v235 offset:6144
  v_mfma_f32_16x16x32_bf16 v[40:43], a[192:195], a[112:115], v[40:43]
  s_mov_b32 s41, 3276800
  s_add_u32 m0, s42, 147456
  v_mfma_f32_16x16x32_bf16 v[40:43], a[196:199], a[120:123], v[40:43]
  buffer_load_dwordx4 v253, s[44:47], s41 offen offset:0 lds
  v_mfma_f32_16x16x32_bf16 v[56:59], a[192:195], a[116:119], v[56:59]
  ds_read_b64_tr_b16 a[192:193], v235 offset:16384
  ds_read_b64_tr_b16 a[194:195], v235 offset:18432
  v_mfma_f32_16x16x32_bf16 v[56:59], a[196:199], a[124:127], v[56:59]
  ds_read_b64_tr_b16 a[196:197], v228 offset:61440
  ds_read_b64_tr_b16 a[198:199], v228 offset:63488
  s_waitcnt lgkmcnt(13)
  v_mfma_f32_16x16x32_bf16 v[44:47], a[200:203], a[112:115], v[44:47]
  s_mov_b32 s41, 3538944
  s_add_u32 m0, s42, 159744
  v_mfma_f32_16x16x32_bf16 v[44:47], a[204:207], a[120:123], v[44:47]
  buffer_load_dwordx4 v253, s[44:47], s41 offen offset:0 lds
  v_mfma_f32_16x16x32_bf16 v[60:63], a[200:203], a[116:119], v[60:63]
  ds_read_b64_tr_b16 a[200:201], v232 offset:24576
  ds_read_b64_tr_b16 a[202:203], v232 offset:26624
  v_mfma_f32_16x16x32_bf16 v[60:63], a[204:207], a[124:127], v[60:63]
  ds_read_b64_tr_b16 a[204:205], v229 offset:61440
  ds_read_b64_tr_b16 a[206:207], v229 offset:63488
  v_mfma_f32_16x16x32_bf16 v[0:3], a[208:211], a[112:115], v[0:3]
  s_mov_b32 s40, 22806528
  v_mfma_f32_16x16x32_bf16 v[0:3], a[212:215], a[120:123], v[0:3]
  buffer_load_dwordx4 a[176:179], v252, s[4:7], s40 offen offset:0 sc1
  v_mfma_f32_16x16x32_bf16 v[16:19], a[208:211], a[116:119], v[16:19]
  ds_read_b64_tr_b16 a[208:209], v233 offset:24576
  ds_read_b64_tr_b16 a[210:211], v233 offset:26624
  v_mfma_f32_16x16x32_bf16 v[16:19], a[212:215], a[124:127], v[16:19]
  ds_read_b64_tr_b16 a[212:213], v230 offset:61440
  ds_read_b64_tr_b16 a[214:215], v230 offset:63488
  s_waitcnt lgkmcnt(13)
  v_mfma_f32_16x16x32_bf16 v[4:7], a[216:219], a[112:115], v[4:7]
  buffer_load_dwordx4 a[180:183], v252, s[4:7], s40 offen offset:1024 sc1
  v_mfma_f32_16x16x32_bf16 v[4:7], a[220:223], a[120:123], v[4:7]
  s_mov_b32 s40, 22937600
  v_mfma_f32_16x16x32_bf16 v[20:23], a[216:219], a[116:119], v[20:23]
  ds_read_b64_tr_b16 a[216:217], v234 offset:24576
  ds_read_b64_tr_b16 a[218:219], v234 offset:26624
  v_mfma_f32_16x16x32_bf16 v[20:23], a[220:223], a[124:127], v[20:23]
  ds_read_b64_tr_b16 a[220:221], v231 offset:61440
  ds_read_b64_tr_b16 a[222:223], v231 offset:63488
  v_mfma_f32_16x16x32_bf16 v[8:11], a[224:227], a[112:115], v[8:11]
  buffer_load_dwordx4 a[184:187], v252, s[4:7], s40 offen offset:0 sc1
  v_mfma_f32_16x16x32_bf16 v[8:11], a[228:231], a[120:123], v[8:11]
  v_mfma_f32_16x16x32_bf16 v[24:27], a[224:227], a[116:119], v[24:27]
  ds_read_b64_tr_b16 a[224:225], v235 offset:24576
  ds_read_b64_tr_b16 a[226:227], v235 offset:26624
  v_mfma_f32_16x16x32_bf16 v[24:27], a[228:231], a[124:127], v[24:27]
  ds_read_b64_tr_b16 a[228:229], v232 offset:53248
  ds_read_b64_tr_b16 a[230:231], v232 offset:55296
  s_waitcnt lgkmcnt(13)
  v_mfma_f32_16x16x32_bf16 v[12:15], a[232:235], a[112:115], v[12:15]
  buffer_load_dwordx4 a[188:191], v252, s[4:7], s40 offen offset:1024 sc1
  v_mfma_f32_16x16x32_bf16 v[12:15], a[192:195], a[120:123], v[12:15]
  s_mov_b32 s41, 65536
  s_add_u32 m0, s42, 16384
  v_mfma_f32_16x16x32_bf16 v[28:31], a[232:235], a[116:119], v[28:31]
  ds_read_b64_tr_b16 a[232:233], v236 offset:0
  ds_read_b64_tr_b16 a[234:235], v236 offset:2048
  v_mfma_f32_16x16x32_bf16 v[28:31], a[192:195], a[124:127], v[28:31]
  ds_read_b64_tr_b16 a[192:193], v233 offset:53248
  ds_read_b64_tr_b16 a[194:195], v233 offset:55296
  s_waitcnt vmcnt(24)
  v_mfma_f32_16x16x32_bf16 v[32:35], a[196:199], a[128:131], v[32:35]
  buffer_load_dwordx4 v242, s[44:47], s41 offen offset:0 lds
  v_mfma_f32_16x16x32_bf16 v[32:35], a[200:203], a[136:139], v[32:35]
  s_waitcnt vmcnt(21)
  s_barrier
  v_mfma_f32_16x16x32_bf16 v[48:51], a[196:199], a[132:135], v[48:51]
  ds_read_b64_tr_b16 a[196:197], v237 offset:0
  ds_read_b64_tr_b16 a[198:199], v237 offset:2048
  v_mfma_f32_16x16x32_bf16 v[48:51], a[200:203], a[140:143], v[48:51]
  ds_read_b64_tr_b16 a[200:201], v234 offset:53248
  ds_read_b64_tr_b16 a[202:203], v234 offset:55296
  s_waitcnt lgkmcnt(13)
  v_mfma_f32_16x16x32_bf16 v[36:39], a[204:207], a[128:131], v[36:39]
  s_mov_b32 s41, 327680
  s_add_u32 m0, s42, 28672
  v_mfma_f32_16x16x32_bf16 v[36:39], a[208:211], a[136:139], v[36:39]
  buffer_load_dwordx4 v242, s[44:47], s41 offen offset:0 lds
  v_mfma_f32_16x16x32_bf16 v[52:55], a[204:207], a[132:135], v[52:55]
  ds_read_b64_tr_b16 a[204:205], v238 offset:0
  ds_read_b64_tr_b16 a[206:207], v238 offset:2048
  v_mfma_f32_16x16x32_bf16 v[52:55], a[208:211], a[140:143], v[52:55]
  ds_read_b64_tr_b16 a[208:209], v235 offset:53248
  ds_read_b64_tr_b16 a[210:211], v235 offset:55296
  v_mfma_f32_16x16x32_bf16 v[40:43], a[212:215], a[128:131], v[40:43]
  s_mov_b32 s41, 65536
  s_add_u32 m0, s42, 139264
  v_mfma_f32_16x16x32_bf16 v[40:43], a[216:219], a[136:139], v[40:43]
  buffer_load_dwordx4 v253, s[44:47], s41 offen offset:0 lds
  v_mfma_f32_16x16x32_bf16 v[56:59], a[212:215], a[132:135], v[56:59]
  ds_read_b64_tr_b16 a[212:213], v239 offset:0
  ds_read_b64_tr_b16 a[214:215], v239 offset:2048
  v_mfma_f32_16x16x32_bf16 v[56:59], a[216:219], a[140:143], v[56:59]
  ds_read_b64_tr_b16 a[216:217], v232 offset:12288
  ds_read_b64_tr_b16 a[218:219], v232 offset:14336
  s_waitcnt lgkmcnt(13)
  v_mfma_f32_16x16x32_bf16 v[44:47], a[220:223], a[128:131], v[44:47]
  s_mov_b32 s41, 327680
  s_add_u32 m0, s42, 155648
  v_mfma_f32_16x16x32_bf16 v[44:47], a[224:227], a[136:139], v[44:47]
  buffer_load_dwordx4 v253, s[44:47], s41 offen offset:0 lds
  v_mfma_f32_16x16x32_bf16 v[60:63], a[220:223], a[132:135], v[60:63]
  ds_read_b64_tr_b16 a[220:221], v232 offset:8192
  ds_read_b64_tr_b16 a[222:223], v232 offset:10240
  v_mfma_f32_16x16x32_bf16 v[60:63], a[224:227], a[140:143], v[60:63]
  ds_read_b64_tr_b16 a[224:225], v233 offset:12288
  ds_read_b64_tr_b16 a[226:227], v233 offset:14336
  v_mfma_f32_16x16x32_bf16 v[0:3], a[228:231], a[128:131], v[0:3]
  s_mov_b32 s41, 589824
  s_add_u32 m0, s42, 20480
  v_mfma_f32_16x16x32_bf16 v[0:3], a[232:235], a[136:139], v[0:3]
  buffer_load_dwordx4 v242, s[44:47], s41 offen offset:0 lds
  v_mfma_f32_16x16x32_bf16 v[16:19], a[228:231], a[132:135], v[16:19]
  ds_read_b64_tr_b16 a[228:229], v233 offset:8192
  ds_read_b64_tr_b16 a[230:231], v233 offset:10240
  v_mfma_f32_16x16x32_bf16 v[16:19], a[232:235], a[140:143], v[16:19]
  ds_read_b64_tr_b16 a[232:233], v234 offset:12288
  ds_read_b64_tr_b16 a[234:235], v234 offset:14336
  s_waitcnt lgkmcnt(13)
  v_mfma_f32_16x16x32_bf16 v[4:7], a[192:195], a[128:131], v[4:7]
  s_mov_b32 s41, 851968
  s_add_u32 m0, s42, 12288
  v_mfma_f32_16x16x32_bf16 v[4:7], a[196:199], a[136:139], v[4:7]
  buffer_load_dwordx4 v242, s[44:47], s41 offen offset:0 lds
  v_mfma_f32_16x16x32_bf16 v[20:23], a[192:195], a[132:135], v[20:23]
  ds_read_b64_tr_b16 a[192:193], v234 offset:8192
  ds_read_b64_tr_b16 a[194:195], v234 offset:10240
  v_mfma_f32_16x16x32_bf16 v[20:23], a[196:199], a[140:143], v[20:23]
  ds_read_b64_tr_b16 a[196:197], v235 offset:12288
  ds_read_b64_tr_b16 a[198:199], v235 offset:14336
  buffer_load_dword v244, v243, s[4:7], s91 offen sc1
  v_mfma_f32_16x16x32_bf16 v[8:11], a[200:203], a[128:131], v[8:11]
  s_mov_b32 s41, 589824
  s_add_u32 m0, s42, 24576
  v_mfma_f32_16x16x32_bf16 v[8:11], a[204:207], a[136:139], v[8:11]
  buffer_load_dwordx4 v253, s[44:47], s41 offen offset:0 lds
  v_mfma_f32_16x16x32_bf16 v[24:27], a[200:203], a[132:135], v[24:27]
  ds_read_b64_tr_b16 a[200:201], v235 offset:8192
  ds_read_b64_tr_b16 a[202:203], v235 offset:10240
  v_mfma_f32_16x16x32_bf16 v[24:27], a[204:207], a[140:143], v[24:27]
  ds_read_b64_tr_b16 a[204:205], v232 offset:20480
  ds_read_b64_tr_b16 a[206:207], v232 offset:22528
  s_waitcnt lgkmcnt(13)
  v_mfma_f32_16x16x32_bf16 v[12:15], a[208:211], a[128:131], v[12:15]
  s_mov_b32 s41, 851968
  s_add_u32 m0, s42, 45056
  v_mfma_f32_16x16x32_bf16 v[12:15], a[212:215], a[136:139], v[12:15]
  buffer_load_dwordx4 v253, s[44:47], s41 offen offset:0 lds
  v_mfma_f32_16x16x32_bf16 v[28:31], a[208:211], a[132:135], v[28:31]
  ds_read_b64_tr_b16 a[208:209], v232 offset:36864
  ds_read_b64_tr_b16 a[210:211], v232 offset:38912
  v_mfma_f32_16x16x32_bf16 v[28:31], a[212:215], a[140:143], v[28:31]
  ds_read_b64_tr_b16 a[212:213], v233 offset:20480
  ds_read_b64_tr_b16 a[214:215], v233 offset:22528
  s_waitcnt vmcnt(25)
  v_mfma_f32_16x16x32_bf16 v[32:35], a[216:219], a[144:147], v[32:35]
  s_mov_b32 s41, 983040
  s_add_u32 m0, s42, 36864
  v_mfma_f32_16x16x32_bf16 v[32:35], a[220:223], a[152:155], v[32:35]
  s_waitcnt vmcnt(21)
  s_barrier
  v_mfma_f32_16x16x32_bf16 v[48:51], a[216:219], a[148:151], v[48:51]
  buffer_load_dwordx4 v242, s[44:47], s41 offen offset:0 lds
  v_mfma_f32_16x16x32_bf16 v[48:51], a[220:223], a[156:159], v[48:51]
  ds_read_b64_tr_b16 a[216:217], v233 offset:36864
  ds_read_b64_tr_b16 a[218:219], v233 offset:38912
  s_waitcnt lgkmcnt(13)
  v_mfma_f32_16x16x32_bf16 v[36:39], a[224:227], a[144:147], v[36:39]
  ds_read_b64_tr_b16 a[220:221], v234 offset:20480
  ds_read_b64_tr_b16 a[222:223], v234 offset:22528
  v_mfma_f32_16x16x32_bf16 v[36:39], a[228:231], a[152:155], v[36:39]
  s_mov_b32 s41, 1245184
  s_add_u32 m0, s42, 49152
  v_mfma_f32_16x16x32_bf16 v[52:55], a[224:227], a[148:151], v[52:55]
  buffer_load_dwordx4 v242, s[44:47], s41 offen offset:0 lds
  v_mfma_f32_16x16x32_bf16 v[52:55], a[228:231], a[156:159], v[52:55]
  ds_read_b64_tr_b16 a[224:225], v234 offset:36864
  ds_read_b64_tr_b16 a[226:227], v234 offset:38912
  v_mfma_f32_16x16x32_bf16 v[40:43], a[232:235], a[144:147], v[40:43]
  ds_read_b64_tr_b16 a[228:229], v235 offset:20480
  ds_read_b64_tr_b16 a[230:231], v235 offset:22528
  s_waitcnt lgkmcnt(13)
  v_mfma_f32_16x16x32_bf16 v[40:43], a[192:195], a[152:155], v[40:43]
  s_mov_b32 s41, 983040
  s_add_u32 m0, s42, 32768
  v_mfma_f32_16x16x32_bf16 v[56:59], a[232:235], a[148:151], v[56:59]
  buffer_load_dwordx4 v253, s[44:47], s41 offen offset:0 lds
  v_mfma_f32_16x16x32_bf16 v[56:59], a[192:195], a[156:159], v[56:59]
  ds_read_b64_tr_b16 a[232:233], v235 offset:36864
  ds_read_b64_tr_b16 a[234:235], v235 offset:38912
  v_mfma_f32_16x16x32_bf16 v[44:47], a[196:199], a[144:147], v[44:47]
  ds_read_b64_tr_b16 a[192:193], v232 offset:32768
  ds_read_b64_tr_b16 a[194:195], v232 offset:34816
  v_mfma_f32_16x16x32_bf16 v[44:47], a[200:203], a[152:155], v[44:47]
  s_mov_b32 s41, 1245184
  s_add_u32 m0, s42, 40960
  v_mfma_f32_16x16x32_bf16 v[60:63], a[196:199], a[148:151], v[60:63]
  buffer_load_dwordx4 v253, s[44:47], s41 offen offset:0 lds
  v_mfma_f32_16x16x32_bf16 v[60:63], a[200:203], a[156:159], v[60:63]
  ds_read_b64_tr_b16 a[196:197], v232 offset:45056
  ds_read_b64_tr_b16 a[198:199], v232 offset:47104
  s_waitcnt lgkmcnt(13)
  v_mfma_f32_16x16x32_bf16 v[0:3], a[204:207], a[144:147], v[0:3]
  ds_read_b64_tr_b16 a[200:201], v233 offset:32768
  ds_read_b64_tr_b16 a[202:203], v233 offset:34816
  v_mfma_f32_16x16x32_bf16 v[0:3], a[208:211], a[152:155], v[0:3]
  s_mov_b32 s41, 1507328
  s_add_u32 m0, s42, 53248
  v_mfma_f32_16x16x32_bf16 v[16:19], a[204:207], a[148:151], v[16:19]
  buffer_load_dwordx4 v242, s[44:47], s41 offen offset:0 lds
  v_mfma_f32_16x16x32_bf16 v[16:19], a[208:211], a[156:159], v[16:19]
  ds_read_b64_tr_b16 a[204:205], v233 offset:45056
  ds_read_b64_tr_b16 a[206:207], v233 offset:47104
  v_mfma_f32_16x16x32_bf16 v[4:7], a[212:215], a[144:147], v[4:7]
  ds_read_b64_tr_b16 a[208:209], v234 offset:32768
  ds_read_b64_tr_b16 a[210:211], v234 offset:34816
  s_waitcnt lgkmcnt(13)
  v_mfma_f32_16x16x32_bf16 v[4:7], a[216:219], a[152:155], v[4:7]
  s_mov_b32 s41, 1769472
  s_add_u32 m0, s42, 57344
  v_mfma_f32_16x16x32_bf16 v[20:23], a[212:215], a[148:151], v[20:23]
  buffer_load_dwordx4 v242, s[44:47], s41 offen offset:0 lds
  v_mfma_f32_16x16x32_bf16 v[20:23], a[216:219], a[156:159], v[20:23]
  ds_read_b64_tr_b16 a[212:213], v234 offset:45056
  ds_read_b64_tr_b16 a[214:215], v234 offset:47104
  v_mfma_f32_16x16x32_bf16 v[8:11], a[220:223], a[144:147], v[8:11]
  ds_read_b64_tr_b16 a[216:217], v235 offset:32768
  ds_read_b64_tr_b16 a[218:219], v235 offset:34816
  v_mfma_f32_16x16x32_bf16 v[8:11], a[224:227], a[152:155], v[8:11]
  s_mov_b32 s41, 1507328
  s_add_u32 m0, s42, 65536
  v_mfma_f32_16x16x32_bf16 v[24:27], a[220:223], a[148:151], v[24:27]
  buffer_load_dwordx4 v253, s[44:47], s41 offen offset:0 lds
  v_mfma_f32_16x16x32_bf16 v[24:27], a[224:227], a[156:159], v[24:27]
  ds_read_b64_tr_b16 a[220:221], v235 offset:45056
  ds_read_b64_tr_b16 a[222:223], v235 offset:47104
  s_waitcnt lgkmcnt(13)
  v_mfma_f32_16x16x32_bf16 v[12:15], a[228:231], a[144:147], v[12:15]
  ds_read_b64_tr_b16 a[224:225], v232 offset:61440
  ds_read_b64_tr_b16 a[226:227], v232 offset:63488
  v_mfma_f32_16x16x32_bf16 v[12:15], a[232:235], a[152:155], v[12:15]
  s_mov_b32 s41, 1769472
  s_add_u32 m0, s42, 94208
  v_mfma_f32_16x16x32_bf16 v[28:31], a[228:231], a[148:151], v[28:31]
  buffer_load_dwordx4 v253, s[44:47], s41 offen offset:0 lds
  v_mfma_f32_16x16x32_bf16 v[28:31], a[232:235], a[156:159], v[28:31]
  ds_read_b64_tr_b16 a[228:229], v232 offset:57344
  ds_read_b64_tr_b16 a[230:231], v232 offset:59392
  s_waitcnt vmcnt(10)
  v_subrev_u32 v244, s100, v244
  v_mfma_f32_16x16x32_bf16 v[32:35], a[192:195], a[160:163], v[32:35]
  ds_read_b64_tr_b16 a[232:233], v233 offset:61440
  ds_read_b64_tr_b16 a[234:235], v233 offset:63488
  v_subrev_u32 v244, 3, v244
  v_cmp_lt_u32 s[68:69], 4, v244
  s_waitcnt lgkmcnt(13)
  v_mfma_f32_16x16x32_bf16 v[32:35], a[196:199], a[168:171], v[32:35]
  s_barrier
  s_cmp_lg_u64 s[68:69], 0
  s_cbranch_scc1 L_slow_35
L_back_36:
  v_mfma_f32_16x16x32_bf16 v[48:51], a[192:195], a[164:167], v[48:51]
  ds_read_b64_tr_b16 a[192:193], v233 offset:57344
  ds_read_b64_tr_b16 a[194:195], v233 offset:59392
  v_mfma_f32_16x16x32_bf16 v[48:51], a[196:199], a[172:175], v[48:51]
  ds_read_b64_tr_b16 a[196:197], v234 offset:61440
  ds_read_b64_tr_b16 a[198:199], v234 offset:63488
  v_mfma_f32_16x16x32_bf16 v[36:39], a[200:203], a[160:163], v[36:39]
  s_mov_b32 s41, 1900544
  s_add_u32 m0, s42, 106496
  v_mfma_f32_16x16x32_bf16 v[36:39], a[204:207], a[168:171], v[36:39]
  buffer_load_dwordx4 v242, s[44:47], s41 offen offset:0 lds
  v_mfma_f32_16x16x32_bf16 v[52:55], a[200:203], a[164:167], v[52:55]
  ds_read_b64_tr_b16 a[200:201], v234 offset:57344
  ds_read_b64_tr_b16 a[202:203], v234 offset:59392
  v_mfma_f32_16x16x32_bf16 v[52:55], a[204:207], a[172:175], v[52:55]
  ds_read_b64_tr_b16 a[204:205], v235 offset:61440
  ds_read_b64_tr_b16 a[206:207], v235 offset:63488
  s_waitcnt lgkmcnt(13)
  v_mfma_f32_16x16x32_bf16 v[40:43], a[208:211], a[160:163], v[40:43]
  s_mov_b32 s40, 23068672
  v_mfma_f32_16x16x32_bf16 v[40:43], a[212:215], a[168:171], v[40:43]
  buffer_load_dwordx4 a[0:3], v252, s[4:7], s40 offen offset:0 sc1
  v_mfma_f32_16x16x32_bf16 v[56:59], a[208:211], a[164:167], v[56:59]
  ds_read_b64_tr_b16 a[208:209], v235 offset:57344
  ds_read_b64_tr_b16 a[210:211], v235 offset:59392
  v_mfma_f32_16x16x32_bf16 v[56:59], a[212:215], a[172:175], v[56:59]
  ds_read_b64_tr_b16 a[212:213], v236 offset:4096
  ds_read_b64_tr_b16 a[214:215], v236 offset:6144
  v_mfma_f32_16x16x32_bf16 v[44:47], a[216:219], a[160:163], v[44:47]
  buffer_load_dwordx4 a[4:7], v252, s[4:7], s40 offen offset:1024 sc1
  v_mfma_f32_16x16x32_bf16 v[44:47], a[220:223], a[168:171], v[44:47]
  s_mov_b32 s40, 23199744
  v_mfma_f32_16x16x32_bf16 v[60:63], a[216:219], a[164:167], v[60:63]
  ds_read_b64_tr_b16 a[216:217], v236 offset:20480
  ds_read_b64_tr_b16 a[218:219], v236 offset:22528
  v_mfma_f32_16x16x32_bf16 v[60:63], a[220:223], a[172:175], v[60:63]
  ds_read_b64_tr_b16 a[220:221], v237 offset:4096
  ds_read_b64_tr_b16 a[222:223], v237 offset:6144
  s_waitcnt lgkmcnt(13)
  v_mfma_f32_16x16x32_bf16 v[0:3], a[224:227], a[160:163], v[0:3]
  buffer_load_dwordx4 a[8:11], v252, s[4:7], s40 offen offset:0 sc1
  v_mfma_f32_16x16x32_bf16 v[0:3], a[228:231], a[168:171], v[0:3]
  v_mfma_f32_16x16x32_bf16 v[16:19], a[224:227], a[164:167], v[16:19]
  ds_read_b64_tr_b16 a[224:225], v237 offset:20480
  ds_read_b64_tr_b16 a[226:227], v237 offset:22528
  v_mfma_f32_16x16x32_bf16 v[16:19], a[228:231], a[172:175], v[16:19]
  ds_read_b64_tr_b16 a[228:229], v238 offset:4096
  ds_read_b64_tr_b16 a[230:231], v238 offset:6144
  v_mfma_f32_16x16x32_bf16 v[4:7], a[232:235], a[160:163], v[4:7]
  buffer_load_dwordx4 a[12:15], v252, s[4:7], s40 offen offset:1024 sc1
  v_mfma_f32_16x16x32_bf16 v[4:7], a[192:195], a[168:171], v[4:7]
  s_mov_b32 s40, 23330816
  v_mfma_f32_16x16x32_bf16 v[20:23], a[232:235], a[164:167], v[20:23]
  ds_read_b64_tr_b16 a[232:233], v238 offset:20480
  ds_read_b64_tr_b16 a[234:235], v238 offset:22528
  v_mfma_f32_16x16x32_bf16 v[20:23], a[192:195], a[172:175], v[20:23]
  ds_read_b64_tr_b16 a[192:193], v239 offset:4096
  ds_read_b64_tr_b16 a[194:195], v239 offset:6144
  s_waitcnt lgkmcnt(13)
  v_mfma_f32_16x16x32_bf16 v[8:11], a[196:199], a[160:163], v[8:11]
  buffer_load_dwordx4 a[16:19], v252, s[4:7], s40 offen offset:0 sc1
  v_mfma_f32_16x16x32_bf16 v[8:11], a[200:203], a[168:171], v[8:11]
  v_mfma_f32_16x16x32_bf16 v[24:27], a[196:199], a[164:167], v[24:27]
  ds_read_b64_tr_b16 a[196:197], v239 offset:20480
  ds_read_b64_tr_b16 a[198:199], v239 offset:22528
  v_mfma_f32_16x16x32_bf16 v[24:27], a[200:203], a[172:175], v[24:27]
  ds_read_b64_tr_b16 a[200:201], v236 offset:16384
  ds_read_b64_tr_b16 a[202:203], v236 offset:18432
  v_mfma_f32_16x16x32_bf16 v[12:15], a[204:207], a[160:163], v[12:15]
  buffer_load_dwordx4 a[20:23], v252, s[4:7], s40 offen offset:1024 sc1
  v_mfma_f32_16x16x32_bf16 v[12:15], a[208:211], a[168:171], v[12:15]
  s_mov_b32 s40, 23461888
  v_mfma_f32_16x16x32_bf16 v[28:31], a[204:207], a[164:167], v[28:31]
  ds_read_b64_tr_b16 a[204:205], v236 offset:28672
  ds_read_b64_tr_b16 a[206:207], v236 offset:30720
  v_mfma_f32_16x16x32_bf16 v[28:31], a[208:211], a[172:175], v[28:31]
  ds_read_b64_tr_b16 a[208:209], v237 offset:16384
  ds_read_b64_tr_b16 a[210:211], v237 offset:18432
  s_waitcnt lgkmcnt(13)
  v_mfma_f32_16x16x32_bf16 v[32:35], a[212:215], a[176:179], v[32:35]
  buffer_load_dwordx4 a[24:27], v252, s[4:7], s40 offen offset:0 sc1
  v_mfma_f32_16x16x32_bf16 v[32:35], a[216:219], a[184:187], v[32:35]
  s_barrier
  v_mfma_f32_16x16x32_bf16 v[48:51], a[212:215], a[180:183], v[48:51]
  ds_read_b64_tr_b16 a[212:213], v237 offset:28672
  ds_read_b64_tr_b16 a[214:215], v237 offset:30720
  v_mfma_f32_16x16x32_bf16 v[48:51], a[216:219], a[188:191], v[48:51]
  ds_read_b64_tr_b16 a[216:217], v238 offset:16384
  ds_read_b64_tr_b16 a[218:219], v238 offset:18432
  v_mfma_f32_16x16x32_bf16 v[36:39], a[220:223], a[176:179], v[36:39]
  buffer_load_dwordx4 a[28:31], v252, s[4:7], s40 offen offset:1024 sc1
  v_mfma_f32_16x16x32_bf16 v[36:39], a[224:227], a[184:187], v[36:39]
  s_mov_b32 s40, 23592960
  v_mfma_f32_16x16x32_bf16 v[52:55], a[220:223], a[180:183], v[52:55]
  ds_read_b64_tr_b16 a[220:221], v238 offset:28672
  ds_read_b64_tr_b16 a[222:223], v238 offset:30720
  v_mfma_f32_16x16x32_bf16 v[52:55], a[224:227], a[188:191], v[52:55]
  ds_read_b64_tr_b16 a[224:225], v239 offset:16384
  ds_read_b64_tr_b16 a[226:227], v239 offset:18432
  s_waitcnt lgkmcnt(13)
  v_mfma_f32_16x16x32_bf16 v[40:43], a[228:231], a[176:179], v[40:43]
  buffer_load_dwordx4 a[32:35], v252, s[4:7], s40 offen offset:0 sc1
  v_mfma_f32_16x16x32_bf16 v[40:43], a[232:235], a[184:187], v[40:43]
  v_mfma_f32_16x16x32_bf16 v[56:59], a[228:231], a[180:183], v[56:59]
  ds_read_b64_tr_b16 a[228:229], v239 offset:28672
  ds_read_b64_tr_b16 a[230:231], v239 offset:30720
  v_mfma_f32_16x16x32_bf16 v[56:59], a[232:235], a[188:191], v[56:59]
  ds_read_b64_tr_b16 a[232:233], v228 offset:16384
  ds_read_b64_tr_b16 a[234:235], v228 offset:18432
  v_mfma_f32_16x16x32_bf16 v[44:47], a[192:195], a[176:179], v[44:47]
  buffer_load_dwordx4 a[36:39], v252, s[4:7], s40 offen offset:1024 sc1
  v_mfma_f32_16x16x32_bf16 v[44:47], a[196:199], a[184:187], v[44:47]
  s_mov_b32 s40, 23724032
  v_mfma_f32_16x16x32_bf16 v[60:63], a[192:195], a[180:183], v[60:63]
  ds_read_b64_tr_b16 a[192:193], v228 offset:28672
  ds_read_b64_tr_b16 a[194:195], v228 offset:30720
  v_mfma_f32_16x16x32_bf16 v[60:63], a[196:199], a[188:191], v[60:63]
  ds_read_b64_tr_b16 a[196:197], v229 offset:16384
  ds_read_b64_tr_b16 a[198:199], v229 offset:18432
  s_waitcnt lgkmcnt(13)
  v_mfma_f32_16x16x32_bf16 v[0:3], a[200:203], a[176:179], v[0:3]
  buffer_load_dwordx4 a[40:43], v252, s[4:7], s40 offen offset:0 sc1
  v_mfma_f32_16x16x32_bf16 v[0:3], a[204:207], a[184:187], v[0:3]
  v_mfma_f32_16x16x32_bf16 v[16:19], a[200:203], a[180:183], v[16:19]
  ds_read_b64_tr_b16 a[200:201], v229 offset:28672
  ds_read_b64_tr_b16 a[202:203], v229 offset:30720
  v_mfma_f32_16x16x32_bf16 v[16:19], a[204:207], a[188:191], v[16:19]
  ds_read_b64_tr_b16 a[204:205], v230 offset:16384
  ds_read_b64_tr_b16 a[206:207], v230 offset:18432
  v_mfma_f32_16x16x32_bf16 v[4:7], a[208:211], a[176:179], v[4:7]
  buffer_load_dwordx4 a[44:47], v252, s[4:7], s40 offen offset:1024 sc1
  v_mfma_f32_16x16x32_bf16 v[4:7], a[212:215], a[184:187], v[4:7]
  s_mov_b32 s40, 23855104
  v_mfma_f32_16x16x32_bf16 v[20:23], a[208:211], a[180:183], v[20:23]
  ds_read_b64_tr_b16 a[208:209], v230 offset:28672
  ds_read_b64_tr_b16 a[210:211], v230 offset:30720
  v_mfma_f32_16x16x32_bf16 v[20:23], a[212:215], a[188:191], v[20:23]
  ds_read_b64_tr_b16 a[212:213], v231 offset:16384
  ds_read_b64_tr_b16 a[214:215], v231 offset:18432
  s_waitcnt lgkmcnt(13)
  v_mfma_f32_16x16x32_bf16 v[8:11], a[216:219], a[176:179], v[8:11]
  buffer_load_dwordx4 a[48:51], v252, s[4:7], s40 offen offset:0 sc1
  v_mfma_f32_16x16x32_bf16 v[8:11], a[220:223], a[184:187], v[8:11]
  v_mfma_f32_16x16x32_bf16 v[24:27], a[216:219], a[180:183], v[24:27]
  ds_read_b64_tr_b16 a[216:217], v231 offset:28672
  ds_read_b64_tr_b16 a[218:219], v231 offset:30720
  v_mfma_f32_16x16x32_bf16 v[24:27], a[220:223], a[188:191], v[24:27]
  ds_read_b64_tr_b16 a[220:221], v236 offset:8192
  ds_read_b64_tr_b16 a[222:223], v236 offset:10240
  v_mfma_f32_16x16x32_bf16 v[12:15], a[224:227], a[176:179], v[12:15]
  buffer_load_dwordx4 a[52:55], v252, s[4:7], s40 offen offset:1024 sc1
  v_mfma_f32_16x16x32_bf16 v[12:15], a[228:231], a[184:187], v[12:15]
  s_mov_b32 s40, 23986176
  v_mfma_f32_16x16x32_bf16 v[28:31], a[224:227], a[180:183], v[28:31]
  ds_read_b64_tr_b16 a[224:225], v236 offset:24576
  ds_read_b64_tr_b16 a[226:227], v236 offset:26624
  v_mfma_f32_16x16x32_bf16 v[28:31], a[228:231], a[188:191], v[28:31]
  ds_read_b64_tr_b16 a[228:229], v237 offset:8192
  ds_read_b64_tr_b16 a[230:231], v237 offset:10240
  s_waitcnt vmcnt(10) lgkmcnt(13)
  v_mfma_f32_16x16x32_bf16 v[32:35], a[232:235], a[0:3], v[32:35]
  buffer_load_dwordx4 a[56:59], v252, s[4:7], s40 offen offset:0 sc1
  v_mfma_f32_16x16x32_bf16 v[32:35], a[192:195], a[8:11], v[32:35]
  s_barrier
  v_mfma_f32_16x16x32_bf16 v[48:51], a[232:235], a[4:7], v[48:51]
  ds_read_b64_tr_b16 a[232:233], v237 offset:24576
  ds_read_b64_tr_b16 a[234:235], v237 offset:26624
  v_mfma_f32_16x16x32_bf16 v[48:51], a[192:195], a[12:15], v[48:51]
  ds_read_b64_tr_b16 a[192:193], v238 offset:8192
  ds_read_b64_tr_b16 a[194:195], v238 offset:10240
  v_mfma_f32_16x16x32_bf16 v[36:39], a[196:199], a[0:3], v[36:39]
  buffer_load_dwordx4 a[60:63], v252, s[4:7], s40 offen offset:1024 sc1
  v_mfma_f32_16x16x32_bf16 v[36:39], a[200:203], a[8:11], v[36:39]
  s_mov_b32 s41, 2162688
  s_add_u32 m0, s42, 114688
  v_mfma_f32_16x16x32_bf16 v[52:55], a[196:199], a[4:7], v[52:55]
  ds_read_b64_tr_b16 a[196:197], v238 offset:24576
  ds_read_b64_tr_b16 a[198:199], v238 offset:26624
  v_mfma_f32_16x16x32_bf16 v[52:55], a[200:203], a[12:15], v[52:55]
  ds_read_b64_tr_b16 a[200:201], v239 offset:8192
  ds_read_b64_tr_b16 a[202:203], v239 offset:10240
  s_waitcnt lgkmcnt(13)
  v_mfma_f32_16x16x32_bf16 v[40:43], a[204:207], a[0:3], v[40:43]
  buffer_load_dwordx4 v242, s[44:47], s41 offen offset:0 lds
  v_mfma_f32_16x16x32_bf16 v[40:43], a[208:211], a[8:11], v[40:43]
  s_mov_b32 s41, 2424832
  s_add_u32 m0, s42, 143360
  v_mfma_f32_16x16x32_bf16 v[56:59], a[204:207], a[4:7], v[56:59]
  ds_read_b64_tr_b16 a[204:205], v239 offset:24576
  ds_read_b64_tr_b16 a[206:207], v239 offset:26624
  v_mfma_f32_16x16x32_bf16 v[56:59], a[208:211], a[12:15], v[56:59]
  ds_read_b64_tr_b16 a[208:209], v228 offset:20480
  ds_read_b64_tr_b16 a[210:211], v228 offset:22528
  v_mfma_f32_16x16x32_bf16 v[44:47], a[212:215], a[0:3], v[44:47]
  buffer_load_dwordx4 v242, s[44:47], s41 offen offset:0 lds
  v_mfma_f32_16x16x32_bf16 v[44:47], a[216:219], a[8:11], v[44:47]
  s_mov_b32 s41, 2686976
  s_add_u32 m0, s42, 69632
  v_mfma_f32_16x16x32_bf16 v[60:63], a[212:215], a[4:7], v[60:63]
  ds_read_b64_tr_b16 a[212:213], v228 offset:12288
  ds_read_b64_tr_b16 a[214:215], v228 offset:14336
  v_mfma_f32_16x16x32_bf16 v[60:63], a[216:219], a[12:15], v[60:63]
  ds_read_b64_tr_b16 a[216:217], v229 offset:20480
  ds_read_b64_tr_b16 a[218:219], v229 offset:22528
  s_waitcnt lgkmcnt(13)
  v_mfma_f32_16x16x32_bf16 v[0:3], a[220:223], a[0:3], v[0:3]
  buffer_load_dwordx4 v242, s[44:47], s41 offen offset:0 lds
  v_mfma_f32_16x16x32_bf16 v[0:3], a[224:227], a[8:11], v[0:3]
  s_mov_b32 s40, 24117248
  v_mfma_f32_16x16x32_bf16 v[16:19], a[220:223], a[4:7], v[16:19]
  ds_read_b64_tr_b16 a[220:221], v229 offset:12288
  ds_read_b64_tr_b16 a[222:223], v229 offset:14336
  v_mfma_f32_16x16x32_bf16 v[16:19], a[224:227], a[12:15], v[16:19]
L_wk1_11:
  s_cbranch_vccnz L_wk1_end
  ds_read_b64_tr_b16 a[224:225], v230 offset:20480
  ds_read_b64_tr_b16 a[226:227], v230 offset:22528
  v_mfma_f32_16x16x32_bf16 v[4:7], a[228:231], a[0:3], v[4:7]
  buffer_load_dwordx4 a[64:67], v252, s[4:7], s40 offen offset:0 sc1
  v_mfma_f32_16x16x32_bf16 v[4:7], a[232:235], a[8:11], v[4:7]
  v_mfma_f32_16x16x32_bf16 v[20:23], a[228:231], a[4:7], v[20:23]
  ds_read_b64_tr_b16 a[228:229], v230 offset:12288
  ds_read_b64_tr_b16 a[230:231], v230 offset:14336
  v_mfma_f32_16x16x32_bf16 v[20:23], a[232:235], a[12:15], v[20:23]
  ds_read_b64_tr_b16 a[232:233], v231 offset:20480
  ds_read_b64_tr_b16 a[234:235], v231 offset:22528
  s_waitcnt lgkmcnt(13)
  v_mfma_f32_16x16x32_bf16 v[8:11], a[192:195], a[0:3], v[8:11]
  buffer_load_dwordx4 a[68:71], v252, s[4:7], s40 offen offset:1024 sc1
  v_mfma_f32_16x16x32_bf16 v[8:11], a[196:199], a[8:11], v[8:11]
  s_mov_b32 s40, 24248320
  v_mfma_f32_16x16x32_bf16 v[24:27], a[192:195], a[4:7], v[24:27]
  ds_read_b64_tr_b16 a[192:193], v231 offset:12288
  ds_read_b64_tr_b16 a[194:195], v231 offset:14336
  v_mfma_f32_16x16x32_bf16 v[24:27], a[196:199], a[12:15], v[24:27]
  ds_read_b64_tr_b16 a[196:197], v228 offset:24576
  ds_read_b64_tr_b16 a[198:199], v228 offset:26624
  v_mfma_f32_16x16x32_bf16 v[12:15], a[200:203], a[0:3], v[12:15]
  buffer_load_dwordx4 a[72:75], v252, s[4:7], s40 offen offset:0 sc1
  v_mfma_f32_16x16x32_bf16 v[12:15], a[204:207], a[8:11], v[12:15]
  v_mfma_f32_16x16x32_bf16 v[28:31], a[200:203], a[4:7], v[28:31]
  ds_read_b64_tr_b16 a[200:201], v228 offset:45056
  ds_read_b64_tr_b16 a[202:203], v228 offset:47104
  v_mfma_f32_16x16x32_bf16 v[28:31], a[204:207], a[12:15], v[28:31]
  ds_read_b64_tr_b16 a[204:205], v229 offset:24576
  ds_read_b64_tr_b16 a[206:207], v229 offset:26624
  s_waitcnt vmcnt(14) lgkmcnt(13)
  v_mfma_f32_16x16x32_bf16 v[32:35], a[208:211], a[16:19], v[32:35]
  buffer_load_dwordx4 a[76:79], v252, s[4:7], s40 offen offset:1024 sc1
  v_mfma_f32_16x16x32_bf16 v[32:35], a[212:215], a[24:27], v[32:35]
  s_barrier
  v_mfma_f32_16x16x32_bf16 v[48:51], a[208:211], a[20:23], v[48:51]
  ds_read_b64_tr_b16 a[208:209], v229 offset:45056
  ds_read_b64_tr_b16 a[210:211], v229 offset:47104
  v_mfma_f32_16x16x32_bf16 v[48:51], a[212:215], a[28:31], v[48:51]
  ds_read_b64_tr_b16 a[212:213], v230 offset:24576
  ds_read_b64_tr_b16 a[214:215], v230 offset:26624
  v_mfma_f32_16x16x32_bf16 v[36:39], a[216:219], a[16:19], v[36:39]
  s_mov_b32 s41, 2818048
  s_add_u32 m0, s42, 81920
  v_mfma_f32_16x16x32_bf16 v[36:39], a[220:223], a[24:27], v[36:39]
  buffer_load_dwordx4 v242, s[44:47], s41 offen offset:0 lds
  v_mfma_f32_16x16x32_bf16 v[52:55], a[216:219], a[20:23], v[52:55]
  ds_read_b64_tr_b16 a[216:217], v230 offset:45056
  ds_read_b64_tr_b16 a[218:219], v230 offset:47104
  v_mfma_f32_16x16x32_bf16 v[52:55], a[220:223], a[28:31], v[52:55]
  ds_read_b64_tr_b16 a[220:221], v231 offset:24576
  ds_read_b64_tr_b16 a[222:223], v231 offset:26624
  s_waitcnt lgkmcnt(13)
  v_mfma_f32_16x16x32_bf16 v[40:43], a[224:227], a[16:19], v[40:43]
  s_mov_b32 s41, 3080192
  s_add_u32 m0, s42, 61440
  v_mfma_f32_16x16x32_bf16 v[40:43], a[228:231], a[24:27], v[40:43]
  buffer_load_dwordx4 v242, s[44:47], s41 offen offset:0 lds
  v_mfma_f32_16x16x32_bf16 v[56:59], a[224:227], a[20:23], v[56:59]
  ds_read_b64_tr_b16 a[224:225], v231 offset:45056
  ds_read_b64_tr_b16 a[226:227], v231 offset:47104
  v_mfma_f32_16x16x32_bf16 v[56:59], a[228:231], a[28:31], v[56:59]
  ds_read_b64_tr_b16 a[228:229], v228 offset:36864
  ds_read_b64_tr_b16 a[230:231], v228 offset:38912
  v_mfma_f32_16x16x32_bf16 v[44:47], a[232:235], a[16:19], v[44:47]
  s_mov_b32 s41, 3342336
  s_add_u32 m0, s42, 90112
  v_mfma_f32_16x16x32_bf16 v[44:47], a[192:195], a[24:27], v[44:47]
  buffer_load_dwordx4 v242, s[44:47], s41 offen offset:0 lds
  v_mfma_f32_16x16x32_bf16 v[60:63], a[232:235], a[20:23], v[60:63]
  ds_read_b64_tr_b16 a[232:233], v228 offset:49152
  ds_read_b64_tr_b16 a[234:235], v228 offset:51200
  v_mfma_f32_16x16x32_bf16 v[60:63], a[192:195], a[28:31], v[60:63]
  ds_read_b64_tr_b16 a[192:193], v229 offset:36864
  ds_read_b64_tr_b16 a[194:195], v229 offset:38912
  s_waitcnt lgkmcnt(13)
  v_mfma_f32_16x16x32_bf16 v[0:3], a[196:199], a[16:19], v[0:3]
  s_mov_b32 s41, 3604480
  s_add_u32 m0, s42, 118784
  v_mfma_f32_16x16x32_bf16 v[0:3], a[200:203], a[24:27], v[0:3]
  buffer_load_dwordx4 v242, s[44:47], s41 offen offset:0 lds
  v_mfma_f32_16x16x32_bf16 v[16:19], a[196:199], a[20:23], v[16:19]
  ds_read_b64_tr_b16 a[196:197], v229 offset:49152
  ds_read_b64_tr_b16 a[198:199], v229 offset:51200
  v_mfma_f32_16x16x32_bf16 v[16:19], a[200:203], a[28:31], v[16:19]
  ds_read_b64_tr_b16 a[200:201], v230 offset:36864
  ds_read_b64_tr_b16 a[202:203], v230 offset:38912
  v_mfma_f32_16x16x32_bf16 v[4:7], a[204:207], a[16:19], v[4:7]
  s_mov_b32 s40, 24379392
  v_mfma_f32_16x16x32_bf16 v[4:7], a[208:211], a[24:27], v[4:7]
  buffer_load_dwordx4 a[80:83], v252, s[4:7], s40 offen offset:0 sc1
  v_mfma_f32_16x16x32_bf16 v[20:23], a[204:207], a[20:23], v[20:23]
  ds_read_b64_tr_b16 a[204:205], v230 offset:49152
  ds_read_b64_tr_b16 a[206:207], v230 offset:51200
  v_mfma_f32_16x16x32_bf16 v[20:23], a[208:211], a[28:31], v[20:23]
  ds_read_b64_tr_b16 a[208:209], v231 offset:36864
  ds_read_b64_tr_b16 a[210:211], v231 offset:38912
  s_waitcnt lgkmcnt(13)
  v_mfma_f32_16x16x32_bf16 v[8:11], a[212:215], a[16:19], v[8:11]
  buffer_load_dwordx4 a[84:87], v252, s[4:7], s40 offen offset:1024 sc1
  v_mfma_f32_16x16x32_bf16 v[8:11], a[216:219], a[24:27], v[8:11]
  s_mov_b32 s40, 24510464
  v_mfma_f32_16x16x32_bf16 v[24:27], a[212:215], a[20:23], v[24:27]
  ds_read_b64_tr_b16 a[212:213], v231 offset:49152
  ds_read_b64_tr_b16 a[214:215], v231 offset:51200
  v_mfma_f32_16x16x32_bf16 v[24:27], a[216:219], a[28:31], v[24:27]
  ds_read_b64_tr_b16 a[216:217], v228 offset:32768
  ds_read_b64_tr_b16 a[218:219], v228 offset:34816
  v_mfma_f32_16x16x32_bf16 v[12:15], a[220:223], a[16:19], v[12:15]
  buffer_load_dwordx4 a[88:91], v252, s[4:7], s40 offen offset:0 sc1
  v_mfma_f32_16x16x32_bf16 v[12:15], a[224:227], a[24:27], v[12:15]
  v_mfma_f32_16x16x32_bf16 v[28:31], a[220:223], a[20:23], v[28:31]
  ds_read_b64_tr_b16 a[220:221], v228 offset:40960
  ds_read_b64_tr_b16 a[222:223], v228 offset:43008
  v_mfma_f32_16x16x32_bf16 v[28:31], a[224:227], a[28:31], v[28:31]
  ds_read_b64_tr_b16 a[224:225], v229 offset:32768
  ds_read_b64_tr_b16 a[226:227], v229 offset:34816
  s_waitcnt vmcnt(18) lgkmcnt(13)
  v_mfma_f32_16x16x32_bf16 v[32:35], a[228:231], a[32:35], v[32:35]
  buffer_load_dwordx4 a[92:95], v252, s[4:7], s40 offen offset:1024 sc1
  v_mfma_f32_16x16x32_bf16 v[32:35], a[232:235], a[40:43], v[32:35]
  s_barrier
  v_mfma_f32_16x16x32_bf16 v[48:51], a[228:231], a[36:39], v[48:51]
  ds_read_b64_tr_b16 a[228:229], v229 offset:40960
  ds_read_b64_tr_b16 a[230:231], v229 offset:43008
  v_mfma_f32_16x16x32_bf16 v[48:51], a[232:235], a[44:47], v[48:51]
  ds_read_b64_tr_b16 a[232:233], v230 offset:32768
  ds_read_b64_tr_b16 a[234:235], v230 offset:34816
  v_mfma_f32_16x16x32_bf16 v[36:39], a[192:195], a[32:35], v[36:39]
  s_mov_b32 s40, 24641536
  v_mfma_f32_16x16x32_bf16 v[36:39], a[196:199], a[40:43], v[36:39]
  buffer_load_dwordx4 a[96:99], v252, s[4:7], s40 offen offset:0 sc1
  v_mfma_f32_16x16x32_bf16 v[52:55], a[192:195], a[36:39], v[52:55]
  ds_read_b64_tr_b16 a[192:193], v230 offset:40960
  ds_read_b64_tr_b16 a[194:195], v230 offset:43008
  v_mfma_f32_16x16x32_bf16 v[52:55], a[196:199], a[44:47], v[52:55]
  ds_read_b64_tr_b16 a[196:197], v231 offset:32768
  ds_read_b64_tr_b16 a[198:199], v231 offset:34816
  s_waitcnt lgkmcnt(13)
  v_mfma_f32_16x16x32_bf16 v[40:43], a[200:203], a[32:35], v[40:43]
  buffer_load_dwordx4 a[100:103], v252, s[4:7], s40 offen offset:1024 sc1
  v_mfma_f32_16x16x32_bf16 v[40:43], a[204:207], a[40:43], v[40:43]
  s_mov_b32 s40, 24772608
  v_mfma_f32_16x16x32_bf16 v[56:59], a[200:203], a[36:39], v[56:59]
  ds_read_b64_tr_b16 a[200:201], v231 offset:40960
  ds_read_b64_tr_b16 a[202:203], v231 offset:43008
  v_mfma_f32_16x16x32_bf16 v[56:59], a[204:207], a[44:47], v[56:59]
  ds_read_b64_tr_b16 a[204:205], v228 offset:53248
  ds_read_b64_tr_b16 a[206:207], v228 offset:55296
  v_mfma_f32_16x16x32_bf16 v[44:47], a[208:211], a[32:35], v[44:47]
  buffer_load_dwordx4 a[104:107], v252, s[4:7], s40 offen offset:0 sc1
  v_mfma_f32_16x16x32_bf16 v[44:47], a[212:215], a[40:43], v[44:47]
  v_mfma_f32_16x16x32_bf16 v[60:63], a[208:211], a[36:39], v[60:63]
  ds_read_b64_tr_b16 a[208:209], v228 offset:57344
  ds_read_b64_tr_b16 a[210:211], v228 offset:59392
  v_mfma_f32_16x16x32_bf16 v[60:63], a[212:215], a[44:47], v[60:63]
  ds_read_b64_tr_b16 a[212:213], v229 offset:53248
  ds_read_b64_tr_b16 a[214:215], v229 offset:55296
  s_waitcnt lgkmcnt(13)
  v_mfma_f32_16x16x32_bf16 v[0:3], a[216:219], a[32:35], v[0:3]
  buffer_load_dwordx4 a[108:111], v252, s[4:7], s40 offen offset:1024 sc1
  v_mfma_f32_16x16x32_bf16 v[0:3], a[220:223], a[40:43], v[0:3]
  s_mov_b32 s41, 1900544
  s_add_u32 m0, s42, 131072
  v_mfma_f32_16x16x32_bf16 v[16:19], a[216:219], a[36:39], v[16:19]
  ds_read_b64_tr_b16 a[216:217], v229 offset:57344
  ds_read_b64_tr_b16 a[218:219], v229 offset:59392
  v_mfma_f32_16x16x32_bf16 v[16:19], a[220:223], a[44:47], v[16:19]
  ds_read_b64_tr_b16 a[220:221], v230 offset:53248
  ds_read_b64_tr_b16 a[222:223], v230 offset:55296
  v_mfma_f32_16x16x32_bf16 v[4:7], a[224:227], a[32:35], v[4:7]
  buffer_load_dwordx4 v253, s[44:47], s41 offen offset:0 lds
  v_mfma_f32_16x16x32_bf16 v[4:7], a[228:231], a[40:43], v[4:7]
  s_mov_b32 s41, 2162688
  s_add_u32 m0, s42, 77824
  v_mfma_f32_16x16x32_bf16 v[20:23], a[224:227], a[36:39], v[20:23]
  ds_read_b64_tr_b16 a[224:225], v230 offset:57344
  ds_read_b64_tr_b16 a[226:227], v230 offset:59392
  v_mfma_f32_16x16x32_bf16 v[20:23], a[228:231], a[44:47], v[20:23]
  ds_read_b64_tr_b16 a[228:229], v231 offset:53248
  ds_read_b64_tr_b16 a[230:231], v231 offset:55296
  s_waitcnt lgkmcnt(13)
  v_mfma_f32_16x16x32_bf16 v[8:11], a[232:235], a[32:35], v[8:11]
  buffer_load_dwordx4 v253, s[44:47], s41 offen offset:0 lds
  v_mfma_f32_16x16x32_bf16 v[8:11], a[192:195], a[40:43], v[8:11]
  s_mov_b32 s41, 2424832
  s_add_u32 m0, s42, 73728
  v_mfma_f32_16x16x32_bf16 v[24:27], a[232:235], a[36:39], v[24:27]
  ds_read_b64_tr_b16 a[232:233], v231 offset:57344
  ds_read_b64_tr_b16 a[234:235], v231 offset:59392
  v_mfma_f32_16x16x32_bf16 v[24:27], a[192:195], a[44:47], v[24:27]
  ds_read_b64_tr_b16 a[192:193], v232 offset:0
  ds_read_b64_tr_b16 a[194:195], v232 offset:2048
  v_mfma_f32_16x16x32_bf16 v[12:15], a[196:199], a[32:35], v[12:15]
  buffer_load_dwordx4 v253, s[44:47], s41 offen offset:0 lds
  v_mfma_f32_16x16x32_bf16 v[12:15], a[200:203], a[40:43], v[12:15]
  s_mov_b32 s41, 2686976
  s_add_u32 m0, s42, 86016
  v_mfma_f32_16x16x32_bf16 v[28:31], a[196:199], a[36:39], v[28:31]
  ds_read_b64_tr_b16 a[196:197], v232 offset:28672
  ds_read_b64_tr_b16 a[198:199], v232 offset:30720
  v_mfma_f32_16x16x32_bf16 v[28:31], a[200:203], a[44:47], v[28:31]
  ds_read_b64_tr_b16 a[200:201], v233 offset:0
  ds_read_b64_tr_b16 a[202:203], v233 offset:2048
  s_waitcnt vmcnt(22) lgkmcnt(13)
  v_mfma_f32_16x16x32_bf16 v[32:35], a[204:207], a[48:51], v[32:35]
  buffer_load_dwordx4 v253, s[44:47], s41 offen offset:0 lds
  v_mfma_f32_16x16x32_bf16 v[32:35], a[208:211], a[56:59], v[32:35]
  s_waitcnt vmcnt(20)
  s_barrier
  v_mfma_f32_16x16x32_bf16 v[48:51], a[204:207], a[52:55], v[48:51]
  ds_read_b64_tr_b16 a[204:205], v233 offset:28672
  ds_read_b64_tr_b16 a[206:207], v233 offset:30720
  v_mfma_f32_16x16x32_bf16 v[48:51], a[208:211], a[60:63], v[48:51]
  ds_read_b64_tr_b16 a[208:209], v234 offset:0
  ds_read_b64_tr_b16 a[210:211], v234 offset:2048
  v_mfma_f32_16x16x32_bf16 v[36:39], a[212:215], a[48:51], v[36:39]
  s_mov_b32 s40, 24903680
  v_mfma_f32_16x16x32_bf16 v[36:39], a[216:219], a[56:59], v[36:39]
  buffer_load_dwordx4 a[112:115], v252, s[4:7], s40 offen offset:0 sc1
  v_mfma_f32_16x16x32_bf16 v[52:55], a[212:215], a[52:55], v[52:55]
  ds_read_b64_tr_b16 a[212:213], v234 offset:28672
  ds_read_b64_tr_b16 a[214:215], v234 offset:30720
  v_mfma_f32_16x16x32_bf16 v[52:55], a[216:219], a[60:63], v[52:55]
  ds_read_b64_tr_b16 a[216:217], v235 offset:0
  ds_read_b64_tr_b16 a[218:219], v235 offset:2048
  s_waitcnt lgkmcnt(13)
  v_mfma_f32_16x16x32_bf16 v[40:43], a[220:223], a[48:51], v[40:43]
  buffer_load_dwordx4 a[116:119], v252, s[4:7], s40 offen offset:1024 sc1
  v_mfma_f32_16x16x32_bf16 v[40:43], a[224:227], a[56:59], v[40:43]
  s_mov_b32 s40, 25034752
  v_mfma_f32_16x16x32_bf16 v[56:59], a[220:223], a[52:55], v[56:59]
  ds_read_b64_tr_b16 a[220:221], v235 offset:28672
  ds_read_b64_tr_b16 a[222:223], v235 offset:30720
  v_mfma_f32_16x16x32_bf16 v[56:59], a[224:227], a[60:63], v[56:59]
  ds_read_b64_tr_b16 a[224:225], v232 offset:40960
  ds_read_b64_tr_b16 a[226:227], v232 offset:43008
  v_mfma_f32_16x16x32_bf16 v[44:47], a[228:231], a[48:51], v[44:47]
  buffer_load_dwordx4 a[120:123], v252, s[4:7], s40 offen offset:0 sc1
  v_mfma_f32_16x16x32_bf16 v[44:47], a[232:235], a[56:59], v[44:47]
  v_mfma_f32_16x16x32_bf16 v[60:63], a[228:231], a[52:55], v[60:63]
  ds_read_b64_tr_b16 a[228:229], v232 offset:49152
  ds_read_b64_tr_b16 a[230:231], v232 offset:51200
  v_mfma_f32_16x16x32_bf16 v[60:63], a[232:235], a[60:63], v[60:63]
  ds_read_b64_tr_b16 a[232:233], v233 offset:40960
  ds_read_b64_tr_b16 a[234:235], v233 offset:43008
  s_waitcnt lgkmcnt(13)
  v_mfma_f32_16x16x32_bf16 v[0:3], a[192:195], a[48:51], v[0:3]
  buffer_load_dwordx4 a[124:127], v252, s[4:7], s40 offen offset:1024 sc1
  v_mfma_f32_16x16x32_bf16 v[0:3], a[196:199], a[56:59], v[0:3]
  s_mov_b32 s41, 2818048
  s_add_u32 m0, s42, 102400
  v_mfma_f32_16x16x32_bf16 v[16:19], a[192:195], a[52:55], v[16:19]
  ds_read_b64_tr_b16 a[192:193], v233 offset:49152
  ds_read_b64_tr_b16 a[194:195], v233 offset:51200
  v_mfma_f32_16x16x32_bf16 v[16:19], a[196:199], a[60:63], v[16:19]
  ds_read_b64_tr_b16 a[196:197], v234 offset:40960
  ds_read_b64_tr_b16 a[198:199], v234 offset:43008
  v_mfma_f32_16x16x32_bf16 v[4:7], a[200:203], a[48:51], v[4:7]
  buffer_load_dwordx4 v253, s[44:47], s41 offen offset:0 lds
  v_mfma_f32_16x16x32_bf16 v[4:7], a[204:207], a[56:59], v[4:7]
  s_mov_b32 s41, 3080192
  s_add_u32 m0, s42, 98304
  v_mfma_f32_16x16x32_bf16 v[20:23], a[200:203], a[52:55], v[20:23]
  ds_read_b64_tr_b16 a[200:201], v234 offset:49152
  ds_read_b64_tr_b16 a[202:203], v234 offset:51200
  v_mfma_f32_16x16x32_bf16 v[20:23], a[204:207], a[60:63], v[20:23]
  ds_read_b64_tr_b16 a[204:205], v235 offset:40960
  ds_read_b64_tr_b16 a[206:207], v235 offset:43008
  s_waitcnt lgkmcnt(13)
  v_mfma_f32_16x16x32_bf16 v[8:11], a[208:211], a[48:51], v[8:11]
  buffer_load_dwordx4 v253, s[44:47], s41 offen offset:0 lds
  v_mfma_f32_16x16x32_bf16 v[8:11], a[212:215], a[56:59], v[8:11]
  s_mov_b32 s41, 3342336
  s_add_u32 m0, s42, 110592
  v_mfma_f32_16x16x32_bf16 v[24:27], a[208:211], a[52:55], v[24:27]
  ds_read_b64_tr_b16 a[208:209], v235 offset:49152
  ds_read_b64_tr_b16 a[210:211], v235 offset:51200
  v_mfma_f32_16x16x32_bf16 v[24:27], a[212:215], a[60:63], v[24:27]
  ds_read_b64_tr_b16 a[212:213], v236 offset:12288
  ds_read_b64_tr_b16 a[214:215], v236 offset:14336
  v_mfma_f32_16x16x32_bf16 v[12:15], a[216:219], a[48:51], v[12:15]
  buffer_load_dwordx4 v253, s[44:47], s41 offen offset:0 lds
  v_mfma_f32_16x16x32_bf16 v[12:15], a[220:223], a[56:59], v[12:15]
  s_mov_b32 s41, 3604480
  s_add_u32 m0, s42, 126976
  v_mfma_f32_16x16x32_bf16 v[28:31], a[216:219], a[52:55], v[28:31]
  ds_read_b64_tr_b16 a[216:217], v232 offset:4096
  ds_read_b64_tr_b16 a[218:219], v232 offset:6144
  v_mfma_f32_16x16x32_bf16 v[28:31], a[220:223], a[60:63], v[28:31]
  ds_read_b64_tr_b16 a[220:221], v237 offset:12288
  ds_read_b64_tr_b16 a[222:223], v237 offset:14336
  s_waitcnt vmcnt(23) lgkmcnt(13)
  v_mfma_f32_16x16x32_bf16 v[32:35], a[224:227], a[64:67], v[32:35]
  buffer_load_dwordx4 v253, s[44:47], s41 offen offset:0 lds
  v_mfma_f32_16x16x32_bf16 v[32:35], a[228:231], a[72:75], v[32:35]
  s_waitcnt vmcnt(20)
  s_barrier
  v_mfma_f32_16x16x32_bf16 v[48:51], a[224:227], a[68:71], v[48:51]
  ds_read_b64_tr_b16 a[224:225], v233 offset:4096
  ds_read_b64_tr_b16 a[226:227], v233 offset:6144
  v_mfma_f32_16x16x32_bf16 v[48:51], a[228:231], a[76:79], v[48:51]
  ds_read_b64_tr_b16 a[228:229], v238 offset:12288
  ds_read_b64_tr_b16 a[230:231], v238 offset:14336
  v_mfma_f32_16x16x32_bf16 v[36:39], a[232:235], a[64:67], v[36:39]
  v_mfma_f32_16x16x32_bf16 v[36:39], a[192:195], a[72:75], v[36:39]
  v_mfma_f32_16x16x32_bf16 v[52:55], a[232:235], a[68:71], v[52:55]
  ds_read_b64_tr_b16 a[232:233], v234 offset:4096
  ds_read_b64_tr_b16 a[234:235], v234 offset:6144
  v_mfma_f32_16x16x32_bf16 v[52:55], a[192:195], a[76:79], v[52:55]
  ds_read_b64_tr_b16 a[192:193], v239 offset:12288
  ds_read_b64_tr_b16 a[194:195], v239 offset:14336
  s_waitcnt lgkmcnt(13)
  v_mfma_f32_16x16x32_bf16 v[40:43], a[196:199], a[64:67], v[40:43]
  v_mfma_f32_16x16x32_bf16 v[40:43], a[200:203], a[72:75], v[40:43]
  v_mfma_f32_16x16x32_bf16 v[56:59], a[196:199], a[68:71], v[56:59]
  ds_read_b64_tr_b16 a[196:197], v235 offset:4096
  ds_read_b64_tr_b16 a[198:199], v235 offset:6144
  v_mfma_f32_16x16x32_bf16 v[56:59], a[200:203], a[76:79], v[56:59]
  ds_read_b64_tr_b16 a[200:201], v232 offset:16384
  ds_read_b64_tr_b16 a[202:203], v232 offset:18432
  v_mfma_f32_16x16x32_bf16 v[44:47], a[204:207], a[64:67], v[44:47]
  v_mfma_f32_16x16x32_bf16 v[44:47], a[208:211], a[72:75], v[44:47]
  v_mfma_f32_16x16x32_bf16 v[60:63], a[204:207], a[68:71], v[60:63]
  ds_read_b64_tr_b16 a[204:205], v228 offset:61440
  ds_read_b64_tr_b16 a[206:207], v228 offset:63488
  v_mfma_f32_16x16x32_bf16 v[60:63], a[208:211], a[76:79], v[60:63]
  ds_read_b64_tr_b16 a[208:209], v233 offset:16384
  ds_read_b64_tr_b16 a[210:211], v233 offset:18432
  s_waitcnt vmcnt(16) lgkmcnt(13)
  v_mfma_f32_16x16x32_bf16 v[32:35], a[212:215], a[80:83], v[32:35]
  v_mfma_f32_16x16x32_bf16 v[32:35], a[216:219], a[88:91], v[32:35]
  v_mfma_f32_16x16x32_bf16 v[48:51], a[212:215], a[84:87], v[48:51]
  ds_read_b64_tr_b16 a[212:213], v229 offset:61440
  ds_read_b64_tr_b16 a[214:215], v229 offset:63488
  v_mfma_f32_16x16x32_bf16 v[48:51], a[216:219], a[92:95], v[48:51]
  ds_read_b64_tr_b16 a[216:217], v234 offset:16384
  ds_read_b64_tr_b16 a[218:219], v234 offset:18432
  v_mfma_f32_16x16x32_bf16 v[36:39], a[220:223], a[80:83], v[36:39]
  v_mfma_f32_16x16x32_bf16 v[36:39], a[224:227], a[88:91], v[36:39]
  v_mfma_f32_16x16x32_bf16 v[52:55], a[220:223], a[84:87], v[52:55]
  ds_read_b64_tr_b16 a[220:221], v230 offset:61440
  ds_read_b64_tr_b16 a[222:223], v230 offset:63488
  v_mfma_f32_16x16x32_bf16 v[52:55], a[224:227], a[92:95], v[52:55]
  ds_read_b64_tr_b16 a[224:225], v235 offset:16384
  ds_read_b64_tr_b16 a[226:227], v235 offset:18432
  s_waitcnt lgkmcnt(13)
  v_mfma_f32_16x16x32_bf16 v[40:43], a[228:231], a[80:83], v[40:43]
  v_mfma_f32_16x16x32_bf16 v[40:43], a[232:235], a[88:91], v[40:43]
  v_mfma_f32_16x16x32_bf16 v[56:59], a[228:231], a[84:87], v[56:59]
  ds_read_b64_tr_b16 a[228:229], v231 offset:61440
  ds_read_b64_tr_b16 a[230:231], v231 offset:63488
  v_mfma_f32_16x16x32_bf16 v[56:59], a[232:235], a[92:95], v[56:59]
  ds_read_b64_tr_b16 a[232:233], v232 offset:24576
  ds_read_b64_tr_b16 a[234:235], v232 offset:26624
  v_mfma_f32_16x16x32_bf16 v[44:47], a[192:195], a[80:83], v[44:47]
  v_mfma_f32_16x16x32_bf16 v[44:47], a[196:199], a[88:91], v[44:47]
  v_mfma_f32_16x16x32_bf16 v[60:63], a[192:195], a[84:87], v[60:63]
  ds_read_b64_tr_b16 a[192:193], v232 offset:53248
  ds_read_b64_tr_b16 a[194:195], v232 offset:55296
  v_mfma_f32_16x16x32_bf16 v[60:63], a[196:199], a[92:95], v[60:63]
  ds_read_b64_tr_b16 a[196:197], v233 offset:24576
  ds_read_b64_tr_b16 a[198:199], v233 offset:26624
  s_waitcnt vmcnt(12) lgkmcnt(13)
  v_mfma_f32_16x16x32_bf16 v[32:35], a[200:203], a[96:99], v[32:35]
  v_mfma_f32_16x16x32_bf16 v[32:35], a[204:207], a[104:107], v[32:35]
  s_waitcnt vmcnt(8)
  s_barrier
  v_mfma_f32_16x16x32_bf16 v[48:51], a[200:203], a[100:103], v[48:51]
  ds_read_b64_tr_b16 a[200:201], v233 offset:53248
  ds_read_b64_tr_b16 a[202:203], v233 offset:55296
  v_mfma_f32_16x16x32_bf16 v[48:51], a[204:207], a[108:111], v[48:51]
  ds_read_b64_tr_b16 a[204:205], v234 offset:24576
  ds_read_b64_tr_b16 a[206:207], v234 offset:26624
  v_mfma_f32_16x16x32_bf16 v[36:39], a[208:211], a[96:99], v[36:39]
  v_mfma_f32_16x16x32_bf16 v[36:39], a[212:215], a[104:107], v[36:39]
  v_mfma_f32_16x16x32_bf16 v[52:55], a[208:211], a[100:103], v[52:55]
  ds_read_b64_tr_b16 a[208:209], v234 offset:53248
  ds_read_b64_tr_b16 a[210:211], v234 offset:55296
  v_mfma_f32_16x16x32_bf16 v[52:55], a[212:215], a[108:111], v[52:55]
  ds_read_b64_tr_b16 a[212:213], v235 offset:24576
  ds_read_b64_tr_b16 a[214:215], v235 offset:26624
  s_waitcnt lgkmcnt(13)
  v_mfma_f32_16x16x32_bf16 v[40:43], a[216:219], a[96:99], v[40:43]
  v_mfma_f32_16x16x32_bf16 v[40:43], a[220:223], a[104:107], v[40:43]
  v_mfma_f32_16x16x32_bf16 v[56:59], a[216:219], a[100:103], v[56:59]
  ds_read_b64_tr_b16 a[216:217], v235 offset:53248
  ds_read_b64_tr_b16 a[218:219], v235 offset:55296
  v_mfma_f32_16x16x32_bf16 v[56:59], a[220:223], a[108:111], v[56:59]
  ds_read_b64_tr_b16 a[220:221], v236 offset:0
  ds_read_b64_tr_b16 a[222:223], v236 offset:2048
  v_mfma_f32_16x16x32_bf16 v[44:47], a[224:227], a[96:99], v[44:47]
  v_mfma_f32_16x16x32_bf16 v[44:47], a[228:231], a[104:107], v[44:47]
  v_mfma_f32_16x16x32_bf16 v[60:63], a[224:227], a[100:103], v[60:63]
  ds_read_b64_tr_b16 a[224:225], v232 offset:12288
  ds_read_b64_tr_b16 a[226:227], v232 offset:14336
  v_mfma_f32_16x16x32_bf16 v[60:63], a[228:231], a[108:111], v[60:63]
  ds_read_b64_tr_b16 a[228:229], v237 offset:0
  ds_read_b64_tr_b16 a[230:231], v237 offset:2048
  s_waitcnt vmcnt(4) lgkmcnt(13)
  v_mfma_f32_16x16x32_bf16 v[32:35], a[232:235], a[112:115], v[32:35]
  v_mfma_f32_16x16x32_bf16 v[32:35], a[192:195], a[120:123], v[32:35]
  v_mfma_f32_16x16x32_bf16 v[48:51], a[232:235], a[116:119], v[48:51]
  ds_read_b64_tr_b16 a[232:233], v233 offset:12288
  ds_read_b64_tr_b16 a[234:235], v233 offset:14336
  v_mfma_f32_16x16x32_bf16 v[48:51], a[192:195], a[124:127], v[48:51]
  ds_read_b64_tr_b16 a[192:193], v238 offset:0
  ds_read_b64_tr_b16 a[194:195], v238 offset:2048
  v_mfma_f32_16x16x32_bf16 v[36:39], a[196:199], a[112:115], v[36:39]
  v_mfma_f32_16x16x32_bf16 v[36:39], a[200:203], a[120:123], v[36:39]
  v_mfma_f32_16x16x32_bf16 v[52:55], a[196:199], a[116:119], v[52:55]
  ds_read_b64_tr_b16 a[196:197], v234 offset:12288
  ds_read_b64_tr_b16 a[198:199], v234 offset:14336
  v_mfma_f32_16x16x32_bf16 v[52:55], a[200:203], a[124:127], v[52:55]
  ds_read_b64_tr_b16 a[200:201], v239 offset:0
  ds_read_b64_tr_b16 a[202:203], v239 offset:2048
  v_cvt_pk_bf16_f32 v64, v32, v33
  v_cvt_pk_bf16_f32 v65, v34, v35
  s_waitcnt lgkmcnt(13)
  v_mfma_f32_16x16x32_bf16 v[40:43], a[204:207], a[112:115], v[40:43]
  v_cvt_pk_bf16_f32 v66, v36, v37
  v_cvt_pk_bf16_f32 v67, v38, v39
  buffer_store_dwordx4 v[64:67], v251, s[4:7], s97 offen offset:0 sc1
  v_mfma_f32_16x16x32_bf16 v[40:43], a[208:211], a[120:123], v[40:43]
  v_cvt_pk_bf16_f32 v72, v48, v49
  v_cvt_pk_bf16_f32 v73, v50, v51
  v_cvt_pk_bf16_f32 v74, v52, v53
  v_cvt_pk_bf16_f32 v75, v54, v55
  v_mfma_f32_16x16x32_bf16 v[56:59], a[204:207], a[116:119], v[56:59]
  ds_read_b64_tr_b16 a[204:205], v235 offset:12288
  ds_read_b64_tr_b16 a[206:207], v235 offset:14336
  buffer_store_dwordx4 v[72:75], v251, s[4:7], s97 offen offset:2048 sc1
  v_mfma_f32_16x16x32_bf16 v[56:59], a[208:211], a[124:127], v[56:59]
  ds_read_b64_tr_b16 a[208:209], v232 offset:8192
  ds_read_b64_tr_b16 a[210:211], v232 offset:10240
  v_mfma_f32_16x16x32_bf16 v[44:47], a[212:215], a[112:115], v[44:47]
  v_mfma_f32_16x16x32_bf16 v[44:47], a[216:219], a[120:123], v[44:47]
  v_mfma_f32_16x16x32_bf16 v[60:63], a[212:215], a[116:119], v[60:63]
  ds_read_b64_tr_b16 a[212:213], v232 offset:20480
  ds_read_b64_tr_b16 a[214:215], v232 offset:22528
  v_mfma_f32_16x16x32_bf16 v[60:63], a[216:219], a[124:127], v[60:63]
  ds_read_b64_tr_b16 a[216:217], v233 offset:8192
  ds_read_b64_tr_b16 a[218:219], v233 offset:10240
  v_cvt_pk_bf16_f32 v68, v40, v41
  v_cvt_pk_bf16_f32 v69, v42, v43
  s_waitcnt lgkmcnt(13)
  v_mfma_f32_16x16x32_bf16 v[0:3], a[220:223], a[64:67], v[0:3]
  v_cvt_pk_bf16_f32 v70, v44, v45
  v_cvt_pk_bf16_f32 v71, v46, v47
  buffer_store_dwordx4 v[68:71], v251, s[4:7], s97 offen offset:1024 sc1
  v_mfma_f32_16x16x32_bf16 v[0:3], a[224:227], a[72:75], v[0:3]
  s_waitcnt vmcnt(3)
  s_barrier
  v_cvt_pk_bf16_f32 v76, v56, v57
  v_cvt_pk_bf16_f32 v77, v58, v59
  v_mfma_f32_16x16x32_bf16 v[16:19], a[220:223], a[68:71], v[16:19]
  ds_read_b64_tr_b16 a[220:221], v233 offset:20480
  ds_read_b64_tr_b16 a[222:223], v233 offset:22528
  v_cvt_pk_bf16_f32 v78, v60, v61
  v_cvt_pk_bf16_f32 v79, v62, v63
  v_mfma_f32_16x16x32_bf16 v[16:19], a[224:227], a[76:79], v[16:19]
  ds_read_b64_tr_b16 a[224:225], v234 offset:8192
  ds_read_b64_tr_b16 a[226:227], v234 offset:10240
  buffer_store_dwordx4 v[76:79], v251, s[4:7], s97 offen offset:3072 sc1
  v_mfma_f32_16x16x32_bf16 v[4:7], a[228:231], a[64:67], v[4:7]
  v_accvgpr_read_b32 v80, a236
  v_accvgpr_read_b32 v81, a237
  v_accvgpr_read_b32 v82, a238
  v_accvgpr_read_b32 v83, a239
  v_mfma_f32_16x16x32_bf16 v[4:7], a[232:235], a[72:75], v[4:7]
  v_accvgpr_read_b32 v84, a240
  v_accvgpr_read_b32 v85, a241
  v_accvgpr_read_b32 v86, a242
  v_accvgpr_read_b32 v87, a243
  v_mfma_f32_16x16x32_bf16 v[20:23], a[228:231], a[68:71], v[20:23]
  ds_read_b64_tr_b16 a[228:229], v234 offset:20480
  ds_read_b64_tr_b16 a[230:231], v234 offset:22528
  v_accvgpr_read_b32 v88, a244
  v_accvgpr_read_b32 v89, a245
  v_mfma_f32_16x16x32_bf16 v[20:23], a[232:235], a[76:79], v[20:23]
  ds_read_b64_tr_b16 a[232:233], v235 offset:8192
  ds_read_b64_tr_b16 a[234:235], v235 offset:10240
  v_accvgpr_read_b32 v90, a246
  v_accvgpr_read_b32 v91, a247
  s_waitcnt lgkmcnt(13)
  v_mfma_f32_16x16x32_bf16 v[8:11], a[192:195], a[64:67], v[8:11]
  v_accvgpr_read_b32 v92, a248
  v_accvgpr_read_b32 v93, a249
  v_accvgpr_read_b32 v94, a250
  v_accvgpr_read_b32 v95, a251
  v_mfma_f32_16x16x32_bf16 v[8:11], a[196:199], a[72:75], v[8:11]
  v_lshlrev_b32 v96, 16, v80
  v_and_b32 v97, 0xffff0000, v80
  v_lshlrev_b32 v98, 16, v81
  v_and_b32 v99, 0xffff0000, v81
  v_mfma_f32_16x16x32_bf16 v[24:27], a[192:195], a[68:71], v[24:27]
  ds_read_b64_tr_b16 a[192:193], v235 offset:20480
  ds_read_b64_tr_b16 a[194:195], v235 offset:22528
  v_lshlrev_b32 v100, 16, v82
  v_and_b32 v101, 0xffff0000, v82
  v_mfma_f32_16x16x32_bf16 v[24:27], a[196:199], a[76:79], v[24:27]
  ds_read_b64_tr_b16 a[196:197], v232 offset:36864
  ds_read_b64_tr_b16 a[198:199], v232 offset:38912
  v_lshlrev_b32 v102, 16, v83
  v_and_b32 v103, 0xffff0000, v83
  v_mfma_f32_16x16x32_bf16 v[12:15], a[200:203], a[64:67], v[12:15]
  v_lshlrev_b32 v104, 16, v84
  v_and_b32 v105, 0xffff0000, v84
  v_lshlrev_b32 v106, 16, v85
  v_and_b32 v107, 0xffff0000, v85
  v_mfma_f32_16x16x32_bf16 v[12:15], a[204:207], a[72:75], v[12:15]
  v_lshlrev_b32 v108, 16, v86
  v_and_b32 v109, 0xffff0000, v86
  v_lshlrev_b32 v110, 16, v87
  v_and_b32 v111, 0xffff0000, v87
  v_mfma_f32_16x16x32_bf16 v[28:31], a[200:203], a[68:71], v[28:31]
  ds_read_b64_tr_b16 a[200:201], v232 offset:32768
  ds_read_b64_tr_b16 a[202:203], v232 offset:34816
  v_lshlrev_b32 v112, 16, v88
  v_and_b32 v113, 0xffff0000, v88
  v_mfma_f32_16x16x32_bf16 v[28:31], a[204:207], a[76:79], v[28:31]
  ds_read_b64_tr_b16 a[204:205], v233 offset:36864
  ds_read_b64_tr_b16 a[206:207], v233 offset:38912
  v_lshlrev_b32 v114, 16, v89
  v_and_b32 v115, 0xffff0000, v89
  s_waitcnt lgkmcnt(13)
  v_mfma_f32_16x16x32_bf16 v[0:3], a[208:211], a[80:83], v[0:3]
  v_lshlrev_b32 v116, 16, v90
  v_and_b32 v117, 0xffff0000, v90
  v_lshlrev_b32 v118, 16, v91
  v_and_b32 v119, 0xffff0000, v91
  v_mfma_f32_16x16x32_bf16 v[0:3], a[212:215], a[88:91], v[0:3]
  v_lshlrev_b32 v120, 16, v92
  v_and_b32 v121, 0xffff0000, v92
L_wk1_12:
  s_cbranch_vccnz L_wk1_end
  v_lshlrev_b32 v122, 16, v93
  v_and_b32 v123, 0xffff0000, v93
  v_mfma_f32_16x16x32_bf16 v[16:19], a[208:211], a[84:87], v[16:19]
  ds_read_b64_tr_b16 a[208:209], v233 offset:32768
  ds_read_b64_tr_b16 a[210:211], v233 offset:34816
  v_lshlrev_b32 v124, 16, v94
  v_and_b32 v125, 0xffff0000, v94
  v_mfma_f32_16x16x32_bf16 v[16:19], a[212:215], a[92:95], v[16:19]
  ds_read_b64_tr_b16 a[212:213], v234 offset:36864
  ds_read_b64_tr_b16 a[214:215], v234 offset:38912
  v_lshlrev_b32 v126, 16, v95
  v_and_b32 v127, 0xffff0000, v95
  v_mfma_f32_16x16x32_bf16 v[4:7], a[216:219], a[80:83], v[4:7]
  ds_read_b128 v[128:131], v250 offset:11008
  ds_read_b128 v[132:135], v250 offset:11072
  ds_read_b128 v[136:139], v250 offset:11136
  ds_read_b128 v[140:143], v250 offset:11200
  v_mfma_f32_16x16x32_bf16 v[4:7], a[220:223], a[88:91], v[4:7]
  v_mfma_f32_16x16x32_bf16 v[20:23], a[216:219], a[84:87], v[20:23]
  ds_read_b64_tr_b16 a[216:217], v234 offset:32768
  ds_read_b64_tr_b16 a[218:219], v234 offset:34816
  v_mfma_f32_16x16x32_bf16 v[20:23], a[220:223], a[92:95], v[20:23]
  ds_read_b64_tr_b16 a[220:221], v235 offset:36864
  ds_read_b64_tr_b16 a[222:223], v235 offset:38912
  s_waitcnt lgkmcnt(13)
  v_mfma_f32_16x16x32_bf16 v[8:11], a[224:227], a[80:83], v[8:11]
  v_mfma_f32_16x16x32_bf16 v[8:11], a[228:231], a[88:91], v[8:11]
  v_mfma_f32_16x16x32_bf16 v[24:27], a[224:227], a[84:87], v[24:27]
  ds_read_b64_tr_b16 a[224:225], v235 offset:32768
  ds_read_b64_tr_b16 a[226:227], v235 offset:34816
  v_mfma_f32_16x16x32_bf16 v[24:27], a[228:231], a[92:95], v[24:27]
  ds_read_b64_tr_b16 a[228:229], v232 offset:45056
  ds_read_b64_tr_b16 a[230:231], v232 offset:47104
  v_mfma_f32_16x16x32_bf16 v[12:15], a[232:235], a[80:83], v[12:15]
  v_mfma_f32_16x16x32_bf16 v[12:15], a[192:195], a[88:91], v[12:15]
  v_mfma_f32_16x16x32_bf16 v[28:31], a[232:235], a[84:87], v[28:31]
  ds_read_b64_tr_b16 a[232:233], v232 offset:61440
  ds_read_b64_tr_b16 a[234:235], v232 offset:63488
  v_mfma_f32_16x16x32_bf16 v[28:31], a[192:195], a[92:95], v[28:31]
  ds_read_b64_tr_b16 a[192:193], v233 offset:45056
  ds_read_b64_tr_b16 a[194:195], v233 offset:47104
  v_mfma_f32_16x16x32_bf16 v[0:3], a[196:199], a[96:99], v[0:3]
  v_mfma_f32_16x16x32_bf16 v[0:3], a[200:203], a[104:107], v[0:3]
  s_barrier
  v_mfma_f32_16x16x32_bf16 v[16:19], a[196:199], a[100:103], v[16:19]
  ds_read_b64_tr_b16 a[196:197], v233 offset:61440
  ds_read_b64_tr_b16 a[198:199], v233 offset:63488
  v_mfma_f32_16x16x32_bf16 v[16:19], a[200:203], a[108:111], v[16:19]
  ds_read_b64_tr_b16 a[200:201], v234 offset:45056
  ds_read_b64_tr_b16 a[202:203], v234 offset:47104
  s_waitcnt lgkmcnt(13)
  v_mfma_f32_16x16x32_bf16 v[4:7], a[204:207], a[96:99], v[4:7]
  v_mfma_f32_16x16x32_bf16 v[4:7], a[208:211], a[104:107], v[4:7]
  v_mfma_f32_16x16x32_bf16 v[20:23], a[204:207], a[100:103], v[20:23]
  ds_read_b64_tr_b16 a[204:205], v234 offset:61440
  ds_read_b64_tr_b16 a[206:207], v234 offset:63488
  v_mfma_f32_16x16x32_bf16 v[20:23], a[208:211], a[108:111], v[20:23]
  ds_read_b64_tr_b16 a[208:209], v235 offset:45056
  ds_read_b64_tr_b16 a[210:211], v235 offset:47104
  v_mfma_f32_16x16x32_bf16 v[8:11], a[212:215], a[96:99], v[8:11]
  v_mfma_f32_16x16x32_bf16 v[8:11], a[216:219], a[104:107], v[8:11]
  v_mfma_f32_16x16x32_bf16 v[24:27], a[212:215], a[100:103], v[24:27]
  ds_read_b64_tr_b16 a[212:213], v235 offset:61440
  ds_read_b64_tr_b16 a[214:215], v235 offset:63488
  v_mfma_f32_16x16x32_bf16 v[24:27], a[216:219], a[108:111], v[24:27]
  s_waitcnt lgkmcnt(13)
  v_mfma_f32_16x16x32_bf16 v[12:15], a[220:223], a[96:99], v[12:15]
  v_mfma_f32_16x16x32_bf16 v[12:15], a[224:227], a[104:107], v[12:15]
  v_mfma_f32_16x16x32_bf16 v[28:31], a[220:223], a[100:103], v[28:31]
  v_mfma_f32_16x16x32_bf16 v[28:31], a[224:227], a[108:111], v[28:31]
  v_mfma_f32_16x16x32_bf16 v[0:3], a[228:231], a[112:115], v[0:3]
  s_waitcnt lgkmcnt(12)
  v_mfma_f32_16x16x32_bf16 v[0:3], a[232:235], a[120:123], v[0:3]
  v_mfma_f32_16x16x32_bf16 v[16:19], a[228:231], a[116:119], v[16:19]
  v_mfma_f32_16x16x32_bf16 v[16:19], a[232:235], a[124:127], v[16:19]
  buffer_load_dwordx4 v[64:67], v251, s[4:7], s96 offen offset:0 sc1
  s_waitcnt lgkmcnt(10)
  v_mfma_f32_16x16x32_bf16 v[4:7], a[192:195], a[112:115], v[4:7]
  s_waitcnt lgkmcnt(8)
  v_mfma_f32_16x16x32_bf16 v[4:7], a[196:199], a[120:123], v[4:7]
  buffer_load_dwordx4 v[68:71], v251, s[4:7], s96 offen offset:1024 sc1
  v_mfma_f32_16x16x32_bf16 v[20:23], a[192:195], a[116:119], v[20:23]
  v_mfma_f32_16x16x32_bf16 v[20:23], a[196:199], a[124:127], v[20:23]
  buffer_load_dwordx4 v[72:75], v251, s[4:7], s96 offen offset:2048 sc1
  s_waitcnt lgkmcnt(6)
  v_mfma_f32_16x16x32_bf16 v[8:11], a[200:203], a[112:115], v[8:11]
  s_waitcnt lgkmcnt(4)
  v_mfma_f32_16x16x32_bf16 v[8:11], a[204:207], a[120:123], v[8:11]
  buffer_load_dwordx4 v[76:79], v251, s[4:7], s96 offen offset:3072 sc1
  v_mfma_f32_16x16x32_bf16 v[24:27], a[200:203], a[116:119], v[24:27]
  v_mfma_f32_16x16x32_bf16 v[24:27], a[204:207], a[124:127], v[24:27]
  s_waitcnt lgkmcnt(2)
  v_mfma_f32_16x16x32_bf16 v[12:15], a[208:211], a[112:115], v[12:15]
  s_waitcnt lgkmcnt(0)
  v_mfma_f32_16x16x32_bf16 v[12:15], a[212:215], a[120:123], v[12:15]
  v_mfma_f32_16x16x32_bf16 v[28:31], a[208:211], a[116:119], v[28:31]
  v_mfma_f32_16x16x32_bf16 v[28:31], a[212:215], a[124:127], v[28:31]
  v_pk_fma_f32 v[96:97], v[0:1], v[128:129], v[96:97]
  v_pk_fma_f32 v[98:99], v[2:3], v[130:131], v[98:99]
  v_pk_fma_f32 v[100:101], v[4:5], v[132:133], v[100:101]
  v_pk_fma_f32 v[102:103], v[6:7], v[134:135], v[102:103]
  v_pk_fma_f32 v[104:105], v[8:9], v[136:137], v[104:105]
  v_pk_fma_f32 v[106:107], v[10:11], v[138:139], v[106:107]
  v_pk_fma_f32 v[108:109], v[12:13], v[140:141], v[108:109]
  v_pk_fma_f32 v[110:111], v[14:15], v[142:143], v[110:111]
  v_pk_fma_f32 v[112:113], v[16:17], v[128:129], v[112:113]
  v_pk_fma_f32 v[114:115], v[18:19], v[130:131], v[114:115]
  v_pk_fma_f32 v[116:117], v[20:21], v[132:133], v[116:117]
  v_pk_fma_f32 v[118:119], v[22:23], v[134:135], v[118:119]
  v_pk_fma_f32 v[120:121], v[24:25], v[136:137], v[120:121]
  v_pk_fma_f32 v[122:123], v[26:27], v[138:139], v[122:123]
  v_pk_fma_f32 v[124:125], v[28:29], v[140:141], v[124:125]
  v_pk_fma_f32 v[126:127], v[30:31], v[142:143], v[126:127]
  s_mov_b32 s33, 262144
  s_branch L_chk_39
L_poll_37:
  buffer_load_dwordx4 v[64:67], v251, s[4:7], s96 offen offset:0 sc1
  buffer_load_dwordx4 v[68:71], v251, s[4:7], s96 offen offset:1024 sc1
  buffer_load_dwordx4 v[72:75], v251, s[4:7], s96 offen offset:2048 sc1
  buffer_load_dwordx4 v[76:79], v251, s[4:7], s96 offen offset:3072 sc1
L_chk_39:
  s_waitcnt vmcnt(3)
  v_max3_u32 v32, v64, v65, v66
  v_max_u32 v32, v32, v67
  s_waitcnt vmcnt(2)
  v_max3_u32 v32, v32, v68, v69
  v_max3_u32 v32, v32, v70, v71
  s_waitcnt vmcnt(1)
  v_max3_u32 v32, v32, v72, v73
  v_max3_u32 v32, v32, v74, v75
  s_waitcnt vmcnt(0)
  v_max3_u32 v32, v32, v76, v77
  v_max3_u32 v32, v32, v78, v79
  v_cmp_eq_u32 s[68:69], -1, v32
  s_nop 1
  s_cmp_eq_u64 s[68:69], 0
  s_cbranch_scc1 L_ready_38
  s_sub_u32 s33, s33, 1
  s_cmp_lg_u32 s33, 0
  s_cbranch_scc1 L_poll_37
L_ready_38:
  v_lshlrev_b32 v144, 16, v64
  v_and_b32 v145, 0xffff0000, v64
  v_lshlrev_b32 v146, 16, v65
  v_and_b32 v147, 0xffff0000, v65
  v_pk_fma_f32 v[96:97], v[144:145], v[128:129], v[96:97]
  v_pk_fma_f32 v[98:99], v[146:147], v[130:131], v[98:99]
  v_cvt_pk_bf16_f32 v80, v96, v97
  v_cvt_pk_bf16_f32 v81, v98, v99
  v_lshlrev_b32 v148, 16, v66
  v_and_b32 v149, 0xffff0000, v66
  v_lshlrev_b32 v150, 16, v67
  v_and_b32 v151, 0xffff0000, v67
  v_pk_fma_f32 v[100:101], v[148:149], v[132:133], v[100:101]
  v_pk_fma_f32 v[102:103], v[150:151], v[134:135], v[102:103]
  v_cvt_pk_bf16_f32 v82, v100, v101
  v_cvt_pk_bf16_f32 v83, v102, v103
  s_nop 0
  v_permlane16_swap_b32 v80, v82
  v_permlane16_swap_b32 v81, v83
  s_nop 1
  buffer_store_dwordx4 v[80:83], v249, s[52:55], 0 offen offset:0 sc1
  v_lshlrev_b32 v152, 16, v68
  v_and_b32 v153, 0xffff0000, v68
  v_lshlrev_b32 v154, 16, v69
  v_and_b32 v155, 0xffff0000, v69
  v_pk_fma_f32 v[104:105], v[152:153], v[136:137], v[104:105]
  v_pk_fma_f32 v[106:107], v[154:155], v[138:139], v[106:107]
  v_cvt_pk_bf16_f32 v84, v104, v105
  v_cvt_pk_bf16_f32 v85, v106, v107
  v_lshlrev_b32 v156, 16, v70
  v_and_b32 v157, 0xffff0000, v70
  v_lshlrev_b32 v158, 16, v71
  v_and_b32 v159, 0xffff0000, v71
  v_pk_fma_f32 v[108:109], v[156:157], v[140:141], v[108:109]
  v_pk_fma_f32 v[110:111], v[158:159], v[142:143], v[110:111]
  v_cvt_pk_bf16_f32 v86, v108, v109
  v_cvt_pk_bf16_f32 v87, v110, v111
  s_nop 0
  v_permlane16_swap_b32 v84, v86
  v_permlane16_swap_b32 v85, v87
  s_nop 1
  buffer_store_dwordx4 v[84:87], v249, s[52:55], 0 offen offset:64 sc1
  v_lshlrev_b32 v160, 16, v72
  v_and_b32 v161, 0xffff0000, v72
  v_lshlrev_b32 v162, 16, v73
  v_and_b32 v163, 0xffff0000, v73
  v_pk_fma_f32 v[112:113], v[160:161], v[128:129], v[112:113]
  v_pk_fma_f32 v[114:115], v[162:163], v[130:131], v[114:115]
  v_cvt_pk_bf16_f32 v88, v112, v113
  v_cvt_pk_bf16_f32 v89, v114, v115
  v_lshlrev_b32 v164, 16, v74
  v_and_b32 v165, 0xffff0000, v74
  v_lshlrev_b32 v166, 16, v75
  v_and_b32 v167, 0xffff0000, v75
  v_pk_fma_f32 v[116:117], v[164:165], v[132:133], v[116:117]
  v_pk_fma_f32 v[118:119], v[166:167], v[134:135], v[118:119]
  v_cvt_pk_bf16_f32 v90, v116, v117
  v_cvt_pk_bf16_f32 v91, v118, v119
  s_nop 0
  v_permlane16_swap_b32 v88, v90
  v_permlane16_swap_b32 v89, v91
  s_nop 1
  buffer_store_dwordx4 v[88:91], v249, s[52:55], s38 offen offset:0 sc1
  v_lshlrev_b32 v168, 16, v76
  v_and_b32 v169, 0xffff0000, v76
  v_lshlrev_b32 v170, 16, v77
  v_and_b32 v171, 0xffff0000, v77
  v_pk_fma_f32 v[120:121], v[168:169], v[136:137], v[120:121]
  v_pk_fma_f32 v[122:123], v[170:171], v[138:139], v[122:123]
  v_cvt_pk_bf16_f32 v92, v120, v121
  v_cvt_pk_bf16_f32 v93, v122, v123
  v_lshlrev_b32 v172, 16, v78
  v_and_b32 v173, 0xffff0000, v78
  v_lshlrev_b32 v174, 16, v79
  v_and_b32 v175, 0xffff0000, v79
  v_pk_fma_f32 v[124:125], v[172:173], v[140:141], v[124:125]
  v_pk_fma_f32 v[126:127], v[174:175], v[142:143], v[126:127]
  v_cvt_pk_bf16_f32 v94, v124, v125
  v_cvt_pk_bf16_f32 v95, v126, v127
  s_nop 0
  v_permlane16_swap_b32 v92, v94
  v_permlane16_swap_b32 v93, v95
  s_nop 1
  buffer_store_dwordx4 v[92:95], v249, s[52:55], s38 offen offset:64 sc1
L_hot_end:
  s_endpgm
L_slow_12:
  s_mov_b32 s33, 262144
L_spin_40:
  buffer_load_dword v244, v189, s[4:7], 0 offen sc1
  s_waitcnt vmcnt(0)
  v_subrev_u32 v244, s100, v244
  v_subrev_u32 v244, 1, v244
  v_cmp_lt_u32 s[68:69], 6, v244
  s_nop 1
  s_cmp_eq_u64 s[68:69], 0
  s_cbranch_scc1 L_back_13
  s_sub_u32 s33, s33, 1
  s_cmp_lg_u32 s33, 0
  s_cbranch_scc1 L_spin_40
  s_branch L_back_13
L_slow_14:
  s_mov_b32 s33, 262144
L_spin_41:
  buffer_load_dword v244, v243, s[4:7], s88 offen sc1
  s_waitcnt vmcnt(0)
  v_subrev_u32 v244, s100, v244
  v_cmp_lt_u32 s[68:69], 7, v244
  s_nop 1
  s_cmp_eq_u64 s[68:69], 0
  s_cbranch_scc1 L_back_15
  s_sub_u32 s33, s33, 1
  s_cmp_lg_u32 s33, 0
  s_cbranch_scc1 L_spin_41
  s_branch L_back_15
L_slow_16:
  s_mov_b32 s33, 262144
L_spin_42:
  buffer_load_dword v244, v243, s[4:7], s88 offen sc1
  s_waitcnt vmcnt(0)
  v_subrev_u32 v244, s100, v244
  v_subrev_u32 v244, 1, v244
  v_cmp_lt_u32 s[68:69], 6, v244
  s_nop 1
  s_cmp_eq_u64 s[68:69], 0
  s_cbranch_scc1 L_back_17
  s_sub_u32 s33, s33, 1
  s_cmp_lg_u32 s33, 0
  s_cbranch_scc1 L_spin_42
  s_branch L_back_17
L_slow_18:
  s_mov_b32 s33, 262144
L_spin_43:
  buffer_load_dwordx4 v[96:99], v210, s[4:7], s101 offen sc1
  s_waitcnt vmcnt(0)
  v_xor_b32 v96, s84, v96
  v_xor_b32 v97, s85, v97
  v_or_b32 v100, v96, v97
  v_xor_b32 v98, s86, v98
  v_xor_b32 v99, s87, v99
  v_or3_b32 v100, v100, v98, v99
  v_and_b32 v100, 0xff, v100
  v_cmp_ne_u32 s[68:69], 0, v100
  s_nop 1
  s_cmp_eq_u64 s[68:69], 0
  s_cbranch_scc1 L_back_19
  s_sub_u32 s33, s33, 1
  s_cmp_lg_u32 s33, 0
  s_cbranch_scc1 L_spin_43
  s_branch L_back_19
L_slow_24:
  s_mov_b32 s33, 262144
L_spin_44:
  buffer_load_dword v244, v254, s[4:7], s93 offen sc1
  s_waitcnt vmcnt(0)
  v_subrev_u32 v244, s100, v244
  v_cmp_lt_u32 s[68:69], 7, v244
  s_nop 1
  s_cmp_eq_u64 s[68:69], 0
  s_cbranch_scc1 L_back_25
  s_sub_u32 s33, s33, 1
  s_cmp_lg_u32 s33, 0
  s_cbranch_scc1 L_spin_44
  s_branch L_back_25
L_slow_26:
  s_mov_b32 s33, 262144
L_spin_45:
  buffer_load_dword v244, v254, s[4:7], s32 offen sc1
  s_waitcnt vmcnt(0)
  v_subrev_u32 v244, s100, v244
  v_cmp_lt_u32 s[68:69], 7, v244
  s_nop 1
  s_cmp_eq_u64 s[68:69], 0
  s_cbranch_scc1 L_back_27
  s_sub_u32 s33, s33, 1
  s_cmp_lg_u32 s33, 0
  s_cbranch_scc1 L_spin_45
  s_branch L_back_27
L_slow_29:
  s_mov_b32 s33, 262144
L_spin_46:
  buffer_load_dword v244, v243, s[4:7], s91 offen sc1
  s_waitcnt vmcnt(0)
  v_subrev_u32 v244, s100, v244
  v_cmp_lt_u32 s[68:69], 7, v244
  s_nop 1
  s_cmp_eq_u64 s[68:69], 0
  s_cbranch_scc1 L_back_30
  s_sub_u32 s33, s33, 1
  s_cmp_lg_u32 s33, 0
  s_cbranch_scc1 L_spin_46
  s_branch L_back_30
L_slow_31:
  s_mov_b32 s33, 262144
L_spin_47:
  buffer_load_dword v244, v243, s[4:7], s91 offen sc1
  s_waitcnt vmcnt(0)
  v_subrev_u32 v244, s100, v244
  v_subrev_u32 v244, 1, v244
  v_cmp_lt_u32 s[68:69], 6, v244
  s_nop 1
  s_cmp_eq_u64 s[68:69], 0
  s_cbranch_scc1 L_back_32
  s_sub_u32 s33, s33, 1
  s_cmp_lg_u32 s33, 0
  s_cbranch_scc1 L_spin_47
  s_branch L_back_32
L_slow_33:
  s_mov_b32 s33, 262144
L_spin_48:
  buffer_load_dword v244, v243, s[4:7], s91 offen sc1
  s_waitcnt vmcnt(0)
  v_subrev_u32 v244, s100, v244
  v_subrev_u32 v244, 2, v244
  v_cmp_lt_u32 s[68:69], 5, v244
  s_nop 1
  s_cmp_eq_u64 s[68:69], 0
  s_cbranch_scc1 L_back_34
  s_sub_u32 s33, s33, 1
  s_cmp_lg_u32 s33, 0
  s_cbranch_scc1 L_spin_48
  s_branch L_back_34
L_slow_35:
  s_mov_b32 s33, 262144
L_spin_49:
  buffer_load_dword v244, v243, s[4:7], s91 offen sc1
  s_waitcnt vmcnt(0)
  v_subrev_u32 v244, s100, v244
  v_subrev_u32 v244, 3, v244
  v_cmp_lt_u32 s[68:69], 4, v244
  s_nop 1
  s_cmp_eq_u64 s[68:69], 0
  s_cbranch_scc1 L_back_36
  s_sub_u32 s33, s33, 1
  s_cmp_lg_u32 s33, 0
  s_cbranch_scc1 L_spin_49
  s_branch L_back_36
L_end_1:
  s_endpgm
L_code_end:
  s_endpgm
.section .rodata,"a"
.p2align 6
.amdhsa_kernel blk_kernel
  .amdhsa_next_free_vgpr 512
  .amdhsa_next_free_sgpr 102
  .amdhsa_accum_offset 256
  .amdhsa_group_segment_fixed_size 0
  .amdhsa_kernarg_size 96
  .amdhsa_user_sgpr_count 2
  .amdhsa_user_sgpr_kernarg_segment_ptr 1
  .amdhsa_system_sgpr_workgroup_id_x 1
  .amdhsa_float_denorm_mode_32 3
.end_amdhsa_kernel
```

```asm
; @launch grid=(256,1,1) block=(256,1,1) lds=163840
.amdgcn_target "amdgcn-amd-amdhsa--gfx950"
.text
.globl adaLN_cond__sliding_local_dilated__glu_gated_glu__prompt_kernel
.p2align 8
.type adaLN_cond__sliding_local_dilated__glu_gated_glu__prompt_kernel,@function
adaLN_cond__sliding_local_dilated__glu_gated_glu__prompt_kernel:
  s_cmp_ge_u32 s2, 256
  s_cbranch_scc1 L_end_1
  s_load_dwordx2 s[4:5], s[0:1], 88
  s_load_dwordx2 s[48:49], s[0:1], 0
  s_load_dwordx2 s[64:65], s[0:1], 56
  s_load_dwordx2 s[60:61], s[0:1], 64
  v_lshrrev_b32 v200, 6, v0
  v_and_b32 v224, 63, v0
  v_readfirstlane_b32 s3, v200
  s_getpc_b64 s[30:31]
L_pc_6:
  s_lshr_b32 s32, s2, 4
  s_lshl_b32 s32, s32, 2
  s_add_u32 s32, s32, s3
  s_lshl_b32 s32, s32, 13
  v_lshlrev_b32 v200, 7, v224
  v_add_u32 v200, s32, v200
  v_min_u32 v200, L_code_end-L_pc_6-4, v200
  global_load_dword v223, v200, s[30:31]
  v_lshlrev_b32 v251, 4, v224
  s_lshr_b32 s36, s2, 4
  s_lshl_b32 s36, s36, 3
  s_and_b32 s30, s2, 7
  s_add_u32 s36, s36, s30
  s_lshl_b32 s42, s3, 10
  v_lshrrev_b32 v206, 3, v0
  v_and_b32 v207, 6, v206
  v_and_b32 v202, 7, v224
  v_xor_b32 v207, v207, v202
  s_and_b32 s35, s2, 3
  s_movk_i32 s30, 12288
  v_mul_u32_u24 v217, s30, v206
  v_lshl_add_u32 v217, v207, 4, v217
  s_mul_i32 s30, s35, 3145728
  v_add_u32 v217, s30, v217
  s_lshr_b32 s34, s36, 2
  s_lshl_b32 s31, s34, 7
  v_lshlrev_b32 v220, 1, v0
  s_lshl_b32 s30, s35, 9
  v_bfe_u32 v114, v224, 4, 1
  v_lshlrev_b32 v222, 5, v114
  v_lshrrev_b32 v114, 5, v224
  v_lshl_add_u32 v222, v114, 4, v222
  v_and_b32 v114, 15, v224
  v_lshl_add_u32 v1, v114, 11, v222
  s_lshl_b32 s33, s36, 15
  s_lshl_b32 s32, s3, 7
  s_add_u32 s33, s33, s32
  s_mov_b32 s66, 0x800
  s_mov_b32 s67, 0x20000
  s_mov_b32 s62, 0xc00000
  s_mov_b32 s63, 0x20000
  s_mov_b32 s50, 0x400000
  s_mov_b32 s51, 0x20000
  s_mov_b32 s6, 0x2800000
  s_mov_b32 s7, 0x20000
  s_bitcmp1_b32 s2, 3
  s_waitcnt lgkmcnt(0)
  buffer_load_ushort v196, v220, s[64:67], s30 offen
  s_cbranch_scc1 L_l1_2
  s_add_u32 m0, s42, 131072
  s_nop 0
  buffer_load_dwordx4 v217, s[60:63], s31 offen nt lds
  s_add_u32 m0, s42, 135168
  s_add_u32 s31, s31, 393216
  buffer_load_dwordx4 v217, s[60:63], s31 offen nt lds
  s_add_u32 m0, s42, 139264
  s_add_u32 s31, s31, 393216
  buffer_load_dwordx4 v217, s[60:63], s31 offen nt lds
  s_add_u32 m0, s42, 143360
  s_add_u32 s31, s31, 393216
  buffer_load_dwordx4 v217, s[60:63], s31 offen nt lds
  s_add_u32 m0, s42, 147456
  s_add_u32 s31, s31, 393216
  buffer_load_dwordx4 v217, s[60:63], s31 offen nt lds
  s_add_u32 m0, s42, 151552
  s_add_u32 s31, s31, 393216
  buffer_load_dwordx4 v217, s[60:63], s31 offen nt lds
  s_add_u32 m0, s42, 155648
  s_add_u32 s31, s31, 393216
  buffer_load_dwordx4 v217, s[60:63], s31 offen nt lds
  s_add_u32 m0, s42, 159744
  s_add_u32 s31, s31, 393216
  buffer_load_dwordx4 v217, s[60:63], s31 offen nt lds
  s_branch L_j1_3
L_l1_2:
  buffer_load_dwordx4 v[8:11], v1, s[48:51], s33 offen offset:0
  buffer_load_dwordx4 v[12:15], v1, s[48:51], s33 offen offset:64
  buffer_load_dwordx4 v[16:19], v1, s[48:51], s33 offen offset:512
  buffer_load_dwordx4 v[20:23], v1, s[48:51], s33 offen offset:576
  buffer_load_dwordx4 v[24:27], v1, s[48:51], s33 offen offset:1024
  buffer_load_dwordx4 v[28:31], v1, s[48:51], s33 offen offset:1088
  buffer_load_dwordx4 v[32:35], v1, s[48:51], s33 offen offset:1536
  buffer_load_dwordx4 v[36:39], v1, s[48:51], s33 offen offset:1600
L_j1_3:
  s_load_dword s100, s[4:5], 0xd2d00
  s_load_dwordx2 s[80:81], s[0:1], 8
  s_load_dwordx2 s[8:9], s[0:1], 16
  s_load_dwordx2 s[12:13], s[0:1], 32
  s_load_dwordx2 s[16:17], s[0:1], 40
  s_load_dwordx2 s[44:45], s[0:1], 48
  s_load_dwordx2 s[52:53], s[0:1], 72
  v_lshrrev_b32 v199, 4, v224
  s_movk_i32 s30, 6144
  v_mul_u32_u24 v199, s30, v199
  v_and_b32 v200, 15, v224
  v_min_u32 v200, 11, v200
  v_and_b32 v201, 3, v200
  v_lshl_add_u32 v199, v201, 7, v199
  v_lshrrev_b32 v200, 2, v200
  v_lshl_add_u32 v199, v200, 11, v199
  s_lshr_b32 s32, s2, 4
  s_lshl_b32 s30, s3, 4
  s_add_u32 s32, s32, s30
  s_mul_i32 s32, s32, 24576
  s_bfe_u32 s30, s2, 0x20001
  s_lshl_b32 s30, s30, 9
  s_add_u32 s32, s32, s30
  v_add_u32 v199, s32, v199
  s_and_b32 s22, s2, 1
  s_lshl_b32 s22, s22, 3
  s_bfe_u32 s30, s2, 0x30003
  s_add_u32 s22, s22, s30
  s_bfe_u32 s23, s2, 0x20001
  s_lshl_b32 s23, s23, 2
  s_lshr_b32 s30, s2, 6
  s_add_u32 s23, s23, s30
  v_lshrrev_b32 v200, 2, v0
  s_movk_i32 s30, 6144
  v_mul_u32_u24 v200, s30, v200
  v_bfe_u32 v201, v224, 4, 1
  v_lshlrev_b32 v202, 1, v201
  v_and_b32 v203, 3, v224
  v_xor_b32 v202, v202, v203
  v_lshl_add_u32 v200, v202, 4, v200
  s_lshl_b32 s30, s23, 7
  v_add_u32 v185, s30, v200
  v_add_u32 v186, 4096, v185
  v_lshrrev_b32 v200, 2, v224
  v_lshlrev_b32 v200, 6, v200
  v_lshl_add_u32 v200, v201, 5, v200
  v_lshl_add_u32 v176, v203, 3, v200
  v_xor_b32 v177, 32, v176
  s_and_b32 s30, s3, 1
  s_lshl_b32 s30, s30, 5
  v_xor_b32 v182, s30, v176
  s_lshr_b32 s31, s3, 1
  s_lshl_b32 s30, s31, 11
  v_add_u32 v182, s30, v182
  v_add_u32 v178, 0x10000, v176
  v_add_u32 v179, 0x10000, v177
  v_add_u32 v183, 0x10000, v182
  v_add_u32 v180, 0x20000, v176
  v_add_u32 v181, 0x20000, v177
  v_add_u32 v184, 0x20000, v182
  s_lshl_b32 s30, s22, 13
  s_lshl_b32 s32, s3, 11
  s_add_u32 s30, s30, s32
  v_add_u32 v187, s30, v251
  s_lshl_b32 s32, s22, 3
  s_max_u32 s32, s32, 1
  s_sub_u32 s32, s32, 1
  s_lshl_b32 s30, s32, 10
  s_lshl_b32 s31, s31, 17
  s_add_u32 s30, s30, s31
  v_add_u32 v188, s30, v251
  s_lshl_b32 s30, s22, 3
  s_lshl_b32 s31, s3, 1
  s_add_u32 s30, s30, s31
  s_lshl_b32 s30, s30, 2
  s_lshl_b32 s32, s32, 2
  v_add_u32 v200, s32, v203
  v_add_u32 v189, s30, v224
  v_cmp_lt_u32 vcc, 7, v224
  s_nop 1
  v_cndmask_b32 v189, v189, v200, vcc
  v_lshlrev_b32 v189, 6, v189
  v_add_u32 v189, 0xc0000, v189
  v_cmp_ne_u32 vcc, 0, v224
  v_mov_b32 v200, 0x40000000
  s_nop 0
  v_cndmask_b32 v246, 0, v200, vcc
  v_lshrrev_b32 v200, 2, v224
  v_lshlrev_b32 v200, 7, v200
  v_bfe_u32 v201, v224, 3, 2
  v_lshl_add_u32 v200, v201, 5, v200
  v_lshl_add_u32 v228, v203, 3, v200
  s_waitcnt lgkmcnt(0)
  s_add_u32 s100, s100, 0x9e3779b8
  s_and_b32 s100, s100, -8
  v_mov_b32 v245, s100
  s_mov_b32 s82, 0x600000
  s_mov_b32 s83, 0x20000
  s_bfe_u32 s84, s100, 0x80000
  s_bfe_u32 s85, s100, 0x80008
  s_bfe_u32 s86, s100, 0x80010
  s_bfe_u32 s87, s100, 0x80018
  s_bitcmp1_b32 s2, 3
  s_cselect_b32 s30, 0, 0x40000000
  buffer_load_dword v223, v199, s[80:83], s30 offen
  s_mul_i32 s35, s35, 24576
  s_lshl_b32 s30, s3, 6
  s_add_u32 s35, s35, s30
  s_lshl_b32 s30, s34, 8
  s_add_u32 s66, s35, s30
  s_lshr_b32 s30, s2, 2
  s_lshl_b32 s31, s30, 8
  s_add_u32 s35, s35, s31
  s_add_u32 s35, s35, 8192
  s_lshl_b32 s30, s30, 7
  s_add_u32 s30, s30, 4096
  v_add_u32 v217, s30, v217
  v_lshrrev_b32 v201, 4, v224
  v_lshlrev_b32 v250, 4, v201
  v_and_b32 v202, 15, v224
  v_cmp_ne_u32 vcc, 0, v202
  v_mov_b32 v6, 0x40000000
  s_nop 0
  v_cndmask_b32 v6, v250, v6, vcc
  v_add_u32 v218, s35, v6
  s_lshl_b32 s30, s3, 5
  v_xor_b32 v214, s30, v228
  v_add_u32 v215, 0x10000, v214
  v_add_u32 v216, 0x20000, v214
  s_lshl_b32 s0, s36, 2
  s_add_u32 s0, s0, s3
  s_lshl_b32 s0, s0, 6
  s_add_u32 s0, s0, 0xc0000
  s_lshl_b32 s1, s3, 18
  s_lshl_b32 s30, s36, 10
  s_add_u32 s1, s1, s30
  s_add_u32 s1, s1, 0x100000
  v_lshrrev_b32 v200, 5, v0
  v_lshlrev_b32 v200, 6, v200
  v_bfe_u32 v201, v0, 2, 2
  v_lshl_add_u32 v200, v201, 4, v200
  v_bfe_u32 v201, v0, 4, 1
  v_lshl_add_u32 v200, v201, 3, v200
  v_lshl_add_u32 v200, v203, 1, v200
  s_waitcnt vmcnt(9)
  v_lshlrev_b32 v196, 16, v196
  v_mul_f32 v197, 0xbfb8aa3b, v196
  v_exp_f32 v197, v197
  s_nop 0
  v_add_f32 v197, 1.0, v197
  v_rcp_f32 v197, v197
  s_nop 0
  v_mul_f32 v196, v196, v197
  v_cvt_pk_bf16_f32 v196, v196, v196
  ds_write_b16 v200, v196 offset:11264
  s_mov_b32 s10, 0x200000
  s_mov_b32 s11, 0x20000
  s_mov_b32 s14, 0x700000
  s_mov_b32 s15, 0x20000
  s_mov_b32 s18, 0x700000
  s_mov_b32 s19, 0x20000
  s_mov_b32 s46, 0x700000
  s_mov_b32 s47, 0x20000
  s_mov_b32 s54, 0x400000
  s_mov_b32 s55, 0x20000
  s_lshl_b32 s30, s23, 17
  s_add_u32 s78, s30, 0x500000
  s_lshl_b32 s30, s22, 2
  s_add_u32 s30, s30, s3
  s_lshl_b32 s30, s30, 4
  s_add_u32 s30, s30, s23
  s_lshl_b32 s30, s30, 6
  s_add_u32 s79, s30, 0x90000
  s_lshl_b32 s30, s22, 14
  s_lshl_b32 s31, s23, 10
  s_add_u32 s30, s30, s31
  s_lshl_b32 s31, s3, 8
  s_add_u32 s30, s30, s31
  s_add_u32 s89, s30, 0x40000
  s_xor_b32 s30, s3, 2
  s_lshl_b32 s30, s30, 11
  v_add_u32 v191, s30, v251
  v_xor_b32 v192, 0x1000, v191
  s_and_b32 s30, s3, 1
  s_lshl_b32 s30, s30, 3
  s_add_u32 s30, s30, 8192
  v_add_u32 v208, s30, v251
  s_sub_u32 s30, s3, 1
  s_xor_b32 s30, s30, 2
  s_lshl_b32 s30, s30, 11
  s_cmp_eq_u32 s3, 0
  s_cselect_b32 s30, 8192, s30
  v_add_u32 v209, s30, v251
  s_or_b32 s33, s22, s3
  s_and_b32 s24, s2, 1
  s_lshr_b32 s29, s2, 3
  s_bfe_u32 s25, s2, 0x20001
  s_lshl_b32 s25, s25, 2
  s_and_b32 s30, s29, 3
  s_add_u32 s25, s25, s30
  s_lshr_b32 s26, s29, 2
  s_xor_b32 s26, s26, 2
  s_lshl_b32 s26, s26, 1
  s_add_u32 s26, s26, s24
  s_lshl_b32 s30, s25, 13
  s_lshl_b32 s31, s3, 11
  s_add_u32 s30, s30, s31
  v_add_u32 v240, s30, v251
  v_lshlrev_b32 v202, 11, v206
  v_lshl_add_u32 v202, v207, 4, v202
  s_lshl_b32 s30, s26, 7
  v_add_u32 v241, s30, v202
  s_mul_i32 s30, s24, 3670016
  v_add_u32 v253, s30, v241
  v_xor_b32 v242, 128, v253
  s_mul_i32 s30, s24, 7340032
  v_add_u32 v252, s30, v240
  s_lshl_b32 s27, s24, 2
  s_and_b32 s30, s29, 3
  s_add_u32 s27, s27, s30
  s_bfe_u32 s28, s2, 0x20001
  s_lshl_b32 s28, s28, 3
  s_lshr_b32 s30, s29, 2
  s_add_u32 s28, s28, s30
  s_lshl_b32 s30, s27, 14
  s_lshl_b32 s31, s3, 12
  s_add_u32 s30, s30, s31
  v_add_u32 v225, s30, v251
  s_movk_i32 s30, 7168
  v_mul_u32_u24 v202, s30, v206
  v_lshl_add_u32 v202, v207, 4, v202
  s_lshr_b32 s30, s28, 2
  s_mul_i32 s30, s30, 896
  s_and_b32 s31, s28, 3
  s_lshl_b32 s32, s31, 8
  s_add_u32 s32, s32, s30
  v_add_u32 v226, s32, v202
  s_lshl_b32 s31, s31, 3
  s_lshr_b32 s32, 0x160e0c04, s31
  s_and_b32 s32, s32, 255
  s_lshl_b32 s32, s32, 5
  s_add_u32 s32, s32, s30
  v_mov_b32 v203, s32
  s_lshr_b32 s32, 0x15140706, s31
  s_and_b32 s32, s32, 255
  s_lshl_b32 s32, s32, 5
  s_add_u32 s32, s32, s30
  s_sub_u32 s32, s32, 64
  v_mov_b32 v204, s32
  v_cmp_lt_u32 vcc, 3, v207
  s_nop 1
  v_cndmask_b32 v203, v203, v204, vcc
  v_mov_b32 v204, 0x40000000
  v_cmp_lt_u32 vcc, 5, v207
  s_nop 1
  v_cndmask_b32 v203, v203, v204, vcc
  v_add_u32 v227, v203, v202
  v_xor_b32 v229, 32, v228
  v_xor_b32 v230, 64, v228
  v_xor_b32 v231, 96, v228
  v_add_u32 v232, 0x10000, v228
  v_add_u32 v233, 0x10000, v229
  v_add_u32 v234, 0x10000, v230
  v_add_u32 v235, 0x10000, v231
  v_add_u32 v236, 0x20000, v228
  v_add_u32 v237, 0x20000, v229
  v_add_u32 v238, 0x20000, v230
  v_add_u32 v239, 0x20000, v231
  s_lshr_b32 s30, s28, 4
  s_mul_i32 s30, s30, 56
  s_and_b32 s31, s28, 15
  s_add_u32 s32, s30, s31
  s_lshl_b32 s32, s32, 17
  s_add_u32 s64, s32, 17825792
  s_lshr_b32 s32, s31, 1
  s_add_u32 s32, s32, s30
  s_lshl_b32 s32, s32, 17
  s_and_b32 s31, s31, 1
  s_lshl_b32 s31, s31, 10
  s_add_u32 s32, s32, s31
  s_add_u32 s65, s32, 19922944
  s_add_u32 s20, s64, 3145728
  s_add_u32 s21, s64, 5242880
  s_lshl_b32 s30, s27, 2
  s_add_u32 s30, s30, s3
  s_lshl_b32 s30, s30, 5
  s_lshl_b32 s31, s30, 6
  s_add_u32 s93, s31, 720896
  s_add_u32 s30, s30, s28
  s_lshl_b32 s30, s30, 6
  s_add_u32 s90, s30, 524288
  s_lshl_b32 s30, s25, 1
  s_lshr_b32 s31, s3, 1
  s_add_u32 s30, s30, s31
  s_lshl_b32 s30, s30, 1
  s_add_u32 s30, s30, s24
  s_lshl_b32 s30, s30, 10
  s_add_u32 s91, s30, 524288
  s_lshl_b32 s30, s25, 2
  s_add_u32 s30, s30, s3
  s_lshl_b32 s30, s30, 10
  s_add_u32 s88, s30, 589824
  s_lshl_b32 s31, s26, 6
  s_add_u32 s30, s30, s31
  s_add_u32 s92, s30, 720896
  v_and_b32 v254, 31, v224
  v_lshlrev_b32 v254, 6, v254
  v_and_b32 v243, 960, v254
  s_lshl_b32 s30, s25, 14
  s_lshl_b32 s31, s3, 8
  s_add_u32 s30, s30, s31
  s_add_u32 s94, s30, 262144
  s_lshl_b32 s31, s26, 10
  s_add_u32 s95, s94, s31
  s_lshl_b32 s30, s2, 2
  s_add_u32 s30, s30, s3
  s_lshl_b32 s22, s30, 7
  s_xor_b32 s31, s30, 4
  s_lshl_b32 s30, s30, 12
  s_lshl_b32 s31, s31, 12
  s_add_u32 s96, s30, 13631488
  s_add_u32 s97, s31, 13631488
  s_lshl_b32 s30, s26, 18
  s_add_u32 s98, s30, 9437184
  s_add_u32 s99, s30, 9568256
  s_mov_b32 s38, 0x8000
  s_mov_b32 s43, 0xbfb8aa3b
  v_and_b32 v200, 15, v224
  v_lshlrev_b32 v249, 11, v200
  v_bfe_u32 v202, v224, 4, 1
  v_lshl_add_u32 v249, v202, 5, v249
  v_lshrrev_b32 v202, 5, v224
  v_lshl_add_u32 v249, v202, 4, v249
  s_lshl_b32 s30, s25, 18
  s_lshl_b32 s31, s3, 16
  s_add_u32 s30, s30, s31
  s_lshl_b32 s31, s26, 7
  s_add_u32 s30, s30, s31
  v_add_u32 v249, s30, v249
  v_lshrrev_b32 v201, 4, v224
  v_lshlrev_b32 v250, 4, v201
  s_bitcmp1_b32 s3, 0
  s_cselect_b32 s56, s16, s12
  s_cselect_b32 s57, s17, s13
  s_mov_b32 s58, 0x700000
  s_mov_b32 s59, 0x20000
  s_lshr_b32 s30, s2, 6
  s_lshl_b32 s30, s30, 5
  s_and_b32 s31, s2, 31
  s_add_u32 s30, s30, s31
  s_lshl_b32 s30, s30, 1
  s_lshr_b32 s31, s3, 1
  s_add_u32 s30, s30, s31
  s_lshl_b32 s30, s30, 11
  s_add_u32 s31, s28, 1
  s_bitcmp1_b32 s31, 1
  s_cselect_b32 s30, 0x40000000, s30
  v_lshrrev_b32 v247, 2, v224
  v_lshlrev_b32 v247, 7, v247
  v_add_u32 v247, s30, v247
  s_movk_i32 s30, 24576
  v_mul_u32_u24 v210, s30, v201
  v_lshl_add_u32 v210, v200, 4, v210
  s_lshl_b32 s30, s26, 8
  s_lshl_b32 s31, s3, 12
  s_add_u32 s30, s30, s31
  s_add_u32 s101, s30, 8192
  v_lshlrev_b32 v213, 4, v200
  s_lshl_b32 s30, s3, 8
  v_add_u32 v213, s30, v213
  v_lshlrev_b32 v211, 3, v224
  v_lshlrev_b32 v212, 12, v201
  v_lshl_add_u32 v212, v200, 3, v212
  v_cmp_gt_u32 s[34:35], 16, v224
  s_cmp_eq_u32 s3, 2
  s_cselect_b32 s39, 1.0, 0
  v_and_b32 v202, 14, v224
  v_lshlrev_b32 v201, 2, v201
  v_cmp_le_u32 s[24:25], v201, v202
  v_add_u32 v201, 2, v201
  v_cmp_le_u32 s[26:27], v201, v202
  v_and_b32 v202, 1, v224
  v_cmp_eq_u32 s[28:29], 1, v202
  v_lshlrev_b32 v195, 4, v202
  s_cmp_eq_u32 s33, 0
  s_cselect_b32 s33, 0xf149f2ca, 0
  v_mov_b32 v200, s33
  v_cndmask_b32_e64 v193, v200, 0, s[24:25]
  v_cndmask_b32_e64 v194, v200, 0, s[26:27]
  s_add_u32 s23, s22, 60
  s_add_u32 s36, s23, s8
  s_addc_u32 s37, s9, 0
  s_bitcmp1_b32 s2, 3
  s_cbranch_scc1 L_l2_4
  v_add_u32 v5, 0x20000, v214
  v_mov_b32 v7, 0xff
  s_waitcnt lgkmcnt(0)
  s_barrier
  ds_read_b128 v[16:19], v250 offset:11264
  ds_read_b128 v[20:23], v250 offset:11328
  ds_read_b128 v[24:27], v250 offset:11392
  ds_read_b128 v[28:31], v250 offset:11456
  ds_read_b128 v[32:35], v250 offset:11520
  ds_read_b128 v[36:39], v250 offset:11584
  ds_read_b128 v[40:43], v250 offset:11648
  ds_read_b128 v[44:47], v250 offset:11712
  s_waitcnt vmcnt(1)
  s_barrier
  ds_read_b64_tr_b16 v[48:49], v5 offset:0
  ds_read_b64_tr_b16 v[50:51], v5 offset:2048
  ds_read_b64_tr_b16 v[52:53], v5 offset:4096
  ds_read_b64_tr_b16 v[54:55], v5 offset:6144
  ds_read_b64_tr_b16 v[56:57], v5 offset:8192
  ds_read_b64_tr_b16 v[58:59], v5 offset:10240
  ds_read_b64_tr_b16 v[60:61], v5 offset:12288
  ds_read_b64_tr_b16 v[62:63], v5 offset:14336
  ds_read_b64_tr_b16 v[64:65], v5 offset:16384
  ds_read_b64_tr_b16 v[66:67], v5 offset:18432
  ds_read_b64_tr_b16 v[68:69], v5 offset:20480
  ds_read_b64_tr_b16 v[70:71], v5 offset:22528
  ds_read_b64_tr_b16 v[72:73], v5 offset:24576
  ds_read_b64_tr_b16 v[74:75], v5 offset:26624
  ds_read_b64_tr_b16 v[76:77], v5 offset:28672
  ds_read_b64_tr_b16 v[78:79], v5 offset:30720
  s_waitcnt lgkmcnt(14)
  v_mfma_f32_16x16x32_bf16 v[80:83], v[48:51], v[16:19], 0
  s_waitcnt lgkmcnt(12)
  v_mfma_f32_16x16x32_bf16 v[80:83], v[52:55], v[20:23], v[80:83]
  s_waitcnt lgkmcnt(10)
  v_mfma_f32_16x16x32_bf16 v[80:83], v[56:59], v[24:27], v[80:83]
  s_waitcnt lgkmcnt(8)
  v_mfma_f32_16x16x32_bf16 v[80:83], v[60:63], v[28:31], v[80:83]
  s_waitcnt lgkmcnt(6)
  v_mfma_f32_16x16x32_bf16 v[80:83], v[64:67], v[32:35], v[80:83]
  s_waitcnt lgkmcnt(4)
  v_mfma_f32_16x16x32_bf16 v[80:83], v[68:71], v[36:39], v[80:83]
  s_waitcnt lgkmcnt(2)
  v_mfma_f32_16x16x32_bf16 v[80:83], v[72:75], v[40:43], v[80:83]
  s_waitcnt lgkmcnt(0)
  v_mfma_f32_16x16x32_bf16 v[80:83], v[76:79], v[44:47], v[80:83]
  s_nop 7
  v_bfi_b32 v80, v7, s84, v80
  v_bfi_b32 v81, v7, s85, v81
  v_bfi_b32 v82, v7, s86, v82
  v_bfi_b32 v83, v7, s87, v83
  buffer_store_dwordx4 v[80:83], v6, s[4:7], s66 offen sc1
  s_mov_b32 s30, 1572864
  buffer_load_dword v223, v199, s[80:83], s30 offen
  s_mov_b32 s30, 3145728
  buffer_load_dword v223, v199, s[80:83], s30 offen
  s_mov_b32 s30, 4718592
  buffer_load_dword v223, v199, s[80:83], s30 offen
  s_mov_b32 s41, 0
  s_add_u32 m0, s42, 10240
  s_nop 0
  buffer_load_dwordx4 v185, s[80:83], s41 offen offset:2048 lds
  s_mov_b32 s41, 0
  s_add_u32 m0, s42, 14272
  s_nop 0
  buffer_load_dwordx4 v185, s[80:83], s41 offen offset:2112 lds
  s_mov_b32 s41, 0
  s_add_u32 m0, s42, 20480
  s_nop 0
  buffer_load_dwordx4 v186, s[80:83], s41 offen offset:0 lds
  s_mov_b32 s41, 0
  s_add_u32 m0, s42, 24512
  s_nop 0
  buffer_load_dwordx4 v186, s[80:83], s41 offen offset:64 lds
  s_mov_b32 s41, 0
  s_add_u32 m0, s42, 28672
  s_nop 0
  buffer_load_dwordx4 v185, s[80:83], s41 offen offset:0 lds
  s_mov_b32 s41, 0
  s_add_u32 m0, s42, 32704
  s_nop 0
  buffer_load_dwordx4 v185, s[80:83], s41 offen offset:64 lds
  s_mov_b32 s41, 393216
  s_add_u32 m0, s42, 34816
  s_nop 0
  buffer_load_dwordx4 v185, s[80:83], s41 offen offset:2048 lds
  s_mov_b32 s41, 393216
  s_add_u32 m0, s42, 38848
  s_nop 0
  buffer_load_dwordx4 v185, s[80:83], s41 offen offset:2112 lds
  s_mov_b32 s41, 393216
  s_add_u32 m0, s42, 45056
  s_nop 0
  buffer_load_dwordx4 v186, s[80:83], s41 offen offset:0 lds
  s_mov_b32 s41, 393216
  s_add_u32 m0, s42, 49088
  s_nop 0
  buffer_load_dwordx4 v186, s[80:83], s41 offen offset:64 lds
  s_mov_b32 s41, 393216
  s_add_u32 m0, s42, 53248
  s_nop 0
  buffer_load_dwordx4 v185, s[80:83], s41 offen offset:0 lds
  s_mov_b32 s41, 393216
  s_add_u32 m0, s42, 57280
  s_nop 0
  buffer_load_dwordx4 v185, s[80:83], s41 offen offset:64 lds
  s_mov_b32 s41, 786432
  s_add_u32 m0, s42, 59392
  s_nop 0
  buffer_load_dwordx4 v185, s[80:83], s41 offen offset:2048 lds
  s_mov_b32 s41, 786432
  s_add_u32 m0, s42, 63424
  s_nop 0
  buffer_load_dwordx4 v185, s[80:83], s41 offen offset:2112 lds
  s_mov_b32 s41, 786432
  s_add_u32 m0, s42, 69632
  s_nop 0
  buffer_load_dwordx4 v186, s[80:83], s41 offen offset:0 lds
  s_mov_b32 s41, 786432
  s_add_u32 m0, s42, 73664
  s_nop 0
  buffer_load_dwordx4 v186, s[80:83], s41 offen offset:64 lds
  s_mov_b32 s41, 786432
  s_add_u32 m0, s42, 77824
  s_nop 0
  buffer_load_dwordx4 v185, s[80:83], s41 offen offset:0 lds
  s_mov_b32 s41, 786432
  s_add_u32 m0, s42, 81856
  s_nop 0
  buffer_load_dwordx4 v185, s[80:83], s41 offen offset:64 lds
  s_mov_b32 s41, 1179648
  s_add_u32 m0, s42, 83968
  s_nop 0
  buffer_load_dwordx4 v185, s[80:83], s41 offen offset:2048 lds
  s_mov_b32 s41, 1179648
  s_add_u32 m0, s42, 88000
  s_nop 0
  buffer_load_dwordx4 v185, s[80:83], s41 offen offset:2112 lds
  s_mov_b32 s41, 1179648
  s_add_u32 m0, s42, 94208
  s_nop 0
  buffer_load_dwordx4 v186, s[80:83], s41 offen offset:0 lds
  s_mov_b32 s41, 1179648
  s_add_u32 m0, s42, 98240
  s_nop 0
  buffer_load_dwordx4 v186, s[80:83], s41 offen offset:64 lds
  s_mov_b32 s41, 1179648
  s_add_u32 m0, s42, 102400
  s_nop 0
  buffer_load_dwordx4 v185, s[80:83], s41 offen offset:0 lds
  s_mov_b32 s41, 1179648
  s_add_u32 m0, s42, 106432
  s_nop 0
  buffer_load_dwordx4 v185, s[80:83], s41 offen offset:64 lds
  s_mov_b32 s41, 1572864
  s_add_u32 m0, s42, 108544
  s_nop 0
  buffer_load_dwordx4 v185, s[80:83], s41 offen offset:2048 lds
  s_mov_b32 s41, 1572864
  s_add_u32 m0, s42, 112576
  s_nop 0
  buffer_load_dwordx4 v185, s[80:83], s41 offen offset:2112 lds
  s_mov_b32 s41, 1572864
  s_add_u32 m0, s42, 118784
  s_nop 0
  buffer_load_dwordx4 v186, s[80:83], s41 offen offset:0 lds
  s_mov_b32 s41, 1572864
  s_add_u32 m0, s42, 122816
  s_nop 0
  buffer_load_dwordx4 v186, s[80:83], s41 offen offset:64 lds
  s_mov_b32 s41, 1572864
  s_add_u32 m0, s42, 126976
  s_nop 0
  buffer_load_dwordx4 v185, s[80:83], s41 offen offset:0 lds
  s_barrier
  s_mov_b32 s41, 1572864
  s_add_u32 m0, s42, 131008
  s_nop 0
  buffer_load_dwordx4 v185, s[80:83], s41 offen offset:64 lds
  s_mov_b32 s41, 1966080
  s_add_u32 m0, s42, 133120
  s_nop 0
  buffer_load_dwordx4 v185, s[80:83], s41 offen offset:2048 lds
  s_mov_b32 s41, 1966080
  s_add_u32 m0, s42, 137152
  s_nop 0
  buffer_load_dwordx4 v185, s[80:83], s41 offen offset:2112 lds
  s_mov_b32 s41, 1966080
  s_add_u32 m0, s42, 143360
  s_nop 0
  buffer_load_dwordx4 v186, s[80:83], s41 offen offset:0 lds
  s_mov_b32 s41, 1966080
  s_add_u32 m0, s42, 147392
  s_nop 0
  buffer_load_dwordx4 v186, s[80:83], s41 offen offset:64 lds
  s_mov_b32 s41, 1966080
  s_add_u32 m0, s42, 151552
  s_nop 0
  buffer_load_dwordx4 v185, s[80:83], s41 offen offset:0 lds
  s_mov_b32 s41, 1966080
  s_add_u32 m0, s42, 155584
  s_nop 0
  buffer_load_dwordx4 v185, s[80:83], s41 offen offset:64 lds
  s_branch L_j2_5
L_l2_4:
  s_lshl_b32 s33, s3, 11
  v_lshlrev_b32 v222, 1, v222
  v_add_u32 v222, s33, v222
  v_add_u32 v3, s33, v251
  v_lshrrev_b32 v4, 4, v224
  v_lshlrev_b32 v4, 10, v4
  v_and_b32 v114, 15, v224
  v_lshl_add_u32 v4, v114, 4, v4
  s_lshl_b32 s33, s3, 8
  v_add_u32 v4, s33, v4
  v_add_u32 v5, 4096, v4
  v_mul_u32_u24 v6, 48, v114
  s_lshl_b32 s33, s3, 3
  v_add_u32 v7, s33, v6
  s_waitcnt vmcnt(8)
  v_lshlrev_b32 v40, 16, v8
  v_and_b32 v41, 0xffff0000, v8
  v_lshlrev_b32 v42, 16, v9
  v_and_b32 v43, 0xffff0000, v9
  v_lshlrev_b32 v44, 16, v10
  v_and_b32 v45, 0xffff0000, v10
  v_lshlrev_b32 v46, 16, v11
  v_and_b32 v47, 0xffff0000, v11
  v_pk_add_f32 v[114:115], v[40:41], v[42:43]
  v_pk_add_f32 v[116:117], v[44:45], v[46:47]
  s_waitcnt vmcnt(7)
  v_lshlrev_b32 v48, 16, v12
  v_and_b32 v49, 0xffff0000, v12
  v_lshlrev_b32 v50, 16, v13
  v_and_b32 v51, 0xffff0000, v13
  v_lshlrev_b32 v52, 16, v14
  v_and_b32 v53, 0xffff0000, v14
  v_lshlrev_b32 v54, 16, v15
  v_and_b32 v55, 0xffff0000, v15
  v_pk_add_f32 v[114:115], v[114:115], v[48:49]
  v_pk_add_f32 v[116:117], v[116:117], v[50:51]
  v_pk_add_f32 v[114:115], v[114:115], v[52:53]
  v_pk_add_f32 v[116:117], v[116:117], v[54:55]
  s_waitcnt vmcnt(6)
  v_lshlrev_b32 v56, 16, v16
  v_and_b32 v57, 0xffff0000, v16
  v_lshlrev_b32 v58, 16, v17
  v_and_b32 v59, 0xffff0000, v17
  v_lshlrev_b32 v60, 16, v18
  v_and_b32 v61, 0xffff0000, v18
  v_lshlrev_b32 v62, 16, v19
  v_and_b32 v63, 0xffff0000, v19
  v_pk_add_f32 v[114:115], v[114:115], v[56:57]
  v_pk_add_f32 v[116:117], v[116:117], v[58:59]
  v_pk_add_f32 v[114:115], v[114:115], v[60:61]
  v_pk_add_f32 v[116:117], v[116:117], v[62:63]
  s_waitcnt vmcnt(5)
  v_lshlrev_b32 v64, 16, v20
  v_and_b32 v65, 0xffff0000, v20
  v_lshlrev_b32 v66, 16, v21
  v_and_b32 v67, 0xffff0000, v21
  v_lshlrev_b32 v68, 16, v22
  v_and_b32 v69, 0xffff0000, v22
  v_lshlrev_b32 v70, 16, v23
  v_and_b32 v71, 0xffff0000, v23
  v_pk_add_f32 v[114:115], v[114:115], v[64:65]
  v_pk_add_f32 v[116:117], v[116:117], v[66:67]
  v_pk_add_f32 v[114:115], v[114:115], v[68:69]
  v_pk_add_f32 v[116:117], v[116:117], v[70:71]
  s_waitcnt vmcnt(4)
  v_lshlrev_b32 v72, 16, v24
  v_and_b32 v73, 0xffff0000, v24
  v_lshlrev_b32 v74, 16, v25
  v_and_b32 v75, 0xffff0000, v25
  v_lshlrev_b32 v76, 16, v26
  v_and_b32 v77, 0xffff0000, v26
  v_lshlrev_b32 v78, 16, v27
  v_and_b32 v79, 0xffff0000, v27
  v_pk_add_f32 v[114:115], v[114:115], v[72:73]
  v_pk_add_f32 v[116:117], v[116:117], v[74:75]
  v_pk_add_f32 v[114:115], v[114:115], v[76:77]
  v_pk_add_f32 v[116:117], v[116:117], v[78:79]
  s_waitcnt vmcnt(3)
  v_lshlrev_b32 v80, 16, v28
  v_and_b32 v81, 0xffff0000, v28
  v_lshlrev_b32 v82, 16, v29
  v_and_b32 v83, 0xffff0000, v29
  v_lshlrev_b32 v84, 16, v30
  v_and_b32 v85, 0xffff0000, v30
  v_lshlrev_b32 v86, 16, v31
  v_and_b32 v87, 0xffff0000, v31
  v_pk_add_f32 v[114:115], v[114:115], v[80:81]
  v_pk_add_f32 v[116:117], v[116:117], v[82:83]
  v_pk_add_f32 v[114:115], v[114:115], v[84:85]
  v_pk_add_f32 v[116:117], v[116:117], v[86:87]
  s_waitcnt vmcnt(2)
  v_lshlrev_b32 v88, 16, v32
  v_and_b32 v89, 0xffff0000, v32
  v_lshlrev_b32 v90, 16, v33
  v_and_b32 v91, 0xffff0000, v33
  v_lshlrev_b32 v92, 16, v34
  v_and_b32 v93, 0xffff0000, v34
  v_lshlrev_b32 v94, 16, v35
  v_and_b32 v95, 0xffff0000, v35
  v_pk_add_f32 v[114:115], v[114:115], v[88:89]
  v_pk_add_f32 v[116:117], v[116:117], v[90:91]
  v_pk_add_f32 v[114:115], v[114:115], v[92:93]
  v_pk_add_f32 v[116:117], v[116:117], v[94:95]
  s_waitcnt vmcnt(1)
  v_lshlrev_b32 v96, 16, v36
  v_and_b32 v97, 0xffff0000, v36
  v_lshlrev_b32 v98, 16, v37
  v_and_b32 v99, 0xffff0000, v37
  v_lshlrev_b32 v100, 16, v38
  v_and_b32 v101, 0xffff0000, v38
  v_lshlrev_b32 v102, 16, v39
  v_and_b32 v103, 0xffff0000, v39
  v_pk_add_f32 v[114:115], v[114:115], v[96:97]
  v_pk_add_f32 v[116:117], v[116:117], v[98:99]
  v_pk_add_f32 v[114:115], v[114:115], v[100:101]
  v_pk_add_f32 v[116:117], v[116:117], v[102:103]
  s_mov_b32 s41, 0
  s_add_u32 m0, s42, 10240
  s_nop 0
  buffer_load_dwordx4 v185, s[80:83], s41 offen offset:2048 lds
  s_mov_b32 s41, 0
  s_add_u32 m0, s42, 14272
  s_nop 0
  buffer_load_dwordx4 v185, s[80:83], s41 offen offset:2112 lds
  s_mov_b32 s41, 0
  s_add_u32 m0, s42, 20480
  s_nop 0
  buffer_load_dwordx4 v186, s[80:83], s41 offen offset:0 lds
  s_mov_b32 s41, 0
  s_add_u32 m0, s42, 24512
  s_nop 0
  buffer_load_dwordx4 v186, s[80:83], s41 offen offset:64 lds
  s_mov_b32 s41, 0
  s_add_u32 m0, s42, 28672
  s_nop 0
  buffer_load_dwordx4 v185, s[80:83], s41 offen offset:0 lds
  s_mov_b32 s41, 0
  s_add_u32 m0, s42, 32704
  s_nop 0
  buffer_load_dwordx4 v185, s[80:83], s41 offen offset:64 lds
  s_mov_b32 s41, 393216
  s_add_u32 m0, s42, 34816
  s_nop 0
  buffer_load_dwordx4 v185, s[80:83], s41 offen offset:2048 lds
  s_mov_b32 s41, 393216
  s_add_u32 m0, s42, 38848
  s_nop 0
  buffer_load_dwordx4 v185, s[80:83], s41 offen offset:2112 lds
  s_mov_b32 s41, 393216
  s_add_u32 m0, s42, 45056
  s_nop 0
  buffer_load_dwordx4 v186, s[80:83], s41 offen offset:0 lds
  s_mov_b32 s41, 393216
  s_add_u32 m0, s42, 49088
  s_nop 0
  buffer_load_dwordx4 v186, s[80:83], s41 offen offset:64 lds
  s_mov_b32 s41, 393216
  s_add_u32 m0, s42, 53248
  s_nop 0
  buffer_load_dwordx4 v185, s[80:83], s41 offen offset:0 lds
  s_mov_b32 s41, 393216
  s_add_u32 m0, s42, 57280
  s_nop 0
  buffer_load_dwordx4 v185, s[80:83], s41 offen offset:64 lds
  s_mov_b32 s41, 786432
  s_add_u32 m0, s42, 59392
  s_nop 0
  buffer_load_dwordx4 v185, s[80:83], s41 offen offset:2048 lds
  s_mov_b32 s41, 786432
  s_add_u32 m0, s42, 63424
  s_nop 0
  buffer_load_dwordx4 v185, s[80:83], s41 offen offset:2112 lds
  s_mov_b32 s41, 786432
  s_add_u32 m0, s42, 69632
  s_nop 0
  buffer_load_dwordx4 v186, s[80:83], s41 offen offset:0 lds
  s_mov_b32 s41, 786432
  s_add_u32 m0, s42, 73664
  s_nop 0
  buffer_load_dwordx4 v186, s[80:83], s41 offen offset:64 lds
  s_mov_b32 s41, 786432
  s_add_u32 m0, s42, 77824
  s_nop 0
  buffer_load_dwordx4 v185, s[80:83], s41 offen offset:0 lds
  s_mov_b32 s41, 786432
  s_add_u32 m0, s42, 81856
  s_nop 0
  buffer_load_dwordx4 v185, s[80:83], s41 offen offset:64 lds
  s_mov_b32 s41, 1179648
  s_add_u32 m0, s42, 83968
  s_nop 0
  buffer_load_dwordx4 v185, s[80:83], s41 offen offset:2048 lds
  s_mov_b32 s41, 1179648
  s_add_u32 m0, s42, 88000
  s_nop 0
  buffer_load_dwordx4 v185, s[80:83], s41 offen offset:2112 lds
  s_mov_b32 s41, 1179648
  s_add_u32 m0, s42, 94208
  s_nop 0
  buffer_load_dwordx4 v186, s[80:83], s41 offen offset:0 lds
  s_mov_b32 s41, 1179648
  s_add_u32 m0, s42, 98240
  s_nop 0
  buffer_load_dwordx4 v186, s[80:83], s41 offen offset:64 lds
  s_mov_b32 s41, 1179648
  s_add_u32 m0, s42, 102400
  s_nop 0
  buffer_load_dwordx4 v185, s[80:83], s41 offen offset:0 lds
  s_mov_b32 s41, 1179648
  s_add_u32 m0, s42, 106432
  s_nop 0
  buffer_load_dwordx4 v185, s[80:83], s41 offen offset:64 lds
  v_pk_add_f32 v[114:115], v[114:115], v[116:117]
  v_add_f32 v114, v114, v115
  v_mov_b32 v115, v114
  s_nop 1
  v_permlane16_swap_b32 v115, v114
  s_nop 1
  v_add_f32 v114, v114, v115
  v_mov_b32 v115, v114
  s_nop 1
  v_permlane32_swap_b32 v115, v114
  s_nop 1
  v_add_f32 v114, v114, v115
  v_mul_f32 v104, 0x3b800000, v114
  v_mov_b32 v105, v104
  v_pk_add_f32 v[108:109], v[40:41], v[104:105] neg_lo:[0,1] neg_hi:[0,1]
  v_pk_mul_f32 v[114:115], v[108:109], v[108:109]
  v_pk_add_f32 v[110:111], v[42:43], v[104:105] neg_lo:[0,1] neg_hi:[0,1]
  v_pk_mul_f32 v[116:117], v[110:111], v[110:111]
  v_pk_add_f32 v[108:109], v[44:45], v[104:105] neg_lo:[0,1] neg_hi:[0,1]
  v_pk_fma_f32 v[114:115], v[108:109], v[108:109], v[114:115]
  v_pk_add_f32 v[110:111], v[46:47], v[104:105] neg_lo:[0,1] neg_hi:[0,1]
  v_pk_fma_f32 v[116:117], v[110:111], v[110:111], v[116:117]
  v_pk_add_f32 v[108:109], v[48:49], v[104:105] neg_lo:[0,1] neg_hi:[0,1]
  v_pk_fma_f32 v[114:115], v[108:109], v[108:109], v[114:115]
  v_pk_add_f32 v[110:111], v[50:51], v[104:105] neg_lo:[0,1] neg_hi:[0,1]
  v_pk_fma_f32 v[116:117], v[110:111], v[110:111], v[116:117]
  v_pk_add_f32 v[108:109], v[52:53], v[104:105] neg_lo:[0,1] neg_hi:[0,1]
  v_pk_fma_f32 v[114:115], v[108:109], v[108:109], v[114:115]
  v_pk_add_f32 v[110:111], v[54:55], v[104:105] neg_lo:[0,1] neg_hi:[0,1]
  v_pk_fma_f32 v[116:117], v[110:111], v[110:111], v[116:117]
  v_pk_add_f32 v[108:109], v[56:57], v[104:105] neg_lo:[0,1] neg_hi:[0,1]
  v_pk_fma_f32 v[114:115], v[108:109], v[108:109], v[114:115]
  v_pk_add_f32 v[110:111], v[58:59], v[104:105] neg_lo:[0,1] neg_hi:[0,1]
  v_pk_fma_f32 v[116:117], v[110:111], v[110:111], v[116:117]
  v_pk_add_f32 v[108:109], v[60:61], v[104:105] neg_lo:[0,1] neg_hi:[0,1]
  v_pk_fma_f32 v[114:115], v[108:109], v[108:109], v[114:115]
  v_pk_add_f32 v[110:111], v[62:63], v[104:105] neg_lo:[0,1] neg_hi:[0,1]
  v_pk_fma_f32 v[116:117], v[110:111], v[110:111], v[116:117]
  v_pk_add_f32 v[108:109], v[64:65], v[104:105] neg_lo:[0,1] neg_hi:[0,1]
  v_pk_fma_f32 v[114:115], v[108:109], v[108:109], v[114:115]
  v_pk_add_f32 v[110:111], v[66:67], v[104:105] neg_lo:[0,1] neg_hi:[0,1]
  v_pk_fma_f32 v[116:117], v[110:111], v[110:111], v[116:117]
  v_pk_add_f32 v[108:109], v[68:69], v[104:105] neg_lo:[0,1] neg_hi:[0,1]
  v_pk_fma_f32 v[114:115], v[108:109], v[108:109], v[114:115]
  v_pk_add_f32 v[110:111], v[70:71], v[104:105] neg_lo:[0,1] neg_hi:[0,1]
  v_pk_fma_f32 v[116:117], v[110:111], v[110:111], v[116:117]
  v_pk_add_f32 v[108:109], v[72:73], v[104:105] neg_lo:[0,1] neg_hi:[0,1]
  v_pk_fma_f32 v[114:115], v[108:109], v[108:109], v[114:115]
  v_pk_add_f32 v[110:111], v[74:75], v[104:105] neg_lo:[0,1] neg_hi:[0,1]
  v_pk_fma_f32 v[116:117], v[110:111], v[110:111], v[116:117]
  v_pk_add_f32 v[108:109], v[76:77], v[104:105] neg_lo:[0,1] neg_hi:[0,1]
  v_pk_fma_f32 v[114:115], v[108:109], v[108:109], v[114:115]
  v_pk_add_f32 v[110:111], v[78:79], v[104:105] neg_lo:[0,1] neg_hi:[0,1]
  v_pk_fma_f32 v[116:117], v[110:111], v[110:111], v[116:117]
  v_pk_add_f32 v[108:109], v[80:81], v[104:105] neg_lo:[0,1] neg_hi:[0,1]
  v_pk_fma_f32 v[114:115], v[108:109], v[108:109], v[114:115]
  v_pk_add_f32 v[110:111], v[82:83], v[104:105] neg_lo:[0,1] neg_hi:[0,1]
  v_pk_fma_f32 v[116:117], v[110:111], v[110:111], v[116:117]
  v_pk_add_f32 v[108:109], v[84:85], v[104:105] neg_lo:[0,1] neg_hi:[0,1]
  v_pk_fma_f32 v[114:115], v[108:109], v[108:109], v[114:115]
  v_pk_add_f32 v[110:111], v[86:87], v[104:105] neg_lo:[0,1] neg_hi:[0,1]
  v_pk_fma_f32 v[116:117], v[110:111], v[110:111], v[116:117]
  v_pk_add_f32 v[108:109], v[88:89], v[104:105] neg_lo:[0,1] neg_hi:[0,1]
  v_pk_fma_f32 v[114:115], v[108:109], v[108:109], v[114:115]
  v_pk_add_f32 v[110:111], v[90:91], v[104:105] neg_lo:[0,1] neg_hi:[0,1]
  v_pk_fma_f32 v[116:117], v[110:111], v[110:111], v[116:117]
  v_pk_add_f32 v[108:109], v[92:93], v[104:105] neg_lo:[0,1] neg_hi:[0,1]
  v_pk_fma_f32 v[114:115], v[108:109], v[108:109], v[114:115]
  v_pk_add_f32 v[110:111], v[94:95], v[104:105] neg_lo:[0,1] neg_hi:[0,1]
  v_pk_fma_f32 v[116:117], v[110:111], v[110:111], v[116:117]
  v_pk_add_f32 v[108:109], v[96:97], v[104:105] neg_lo:[0,1] neg_hi:[0,1]
  v_pk_fma_f32 v[114:115], v[108:109], v[108:109], v[114:115]
  v_pk_add_f32 v[110:111], v[98:99], v[104:105] neg_lo:[0,1] neg_hi:[0,1]
  v_pk_fma_f32 v[116:117], v[110:111], v[110:111], v[116:117]
  v_pk_add_f32 v[108:109], v[100:101], v[104:105] neg_lo:[0,1] neg_hi:[0,1]
  v_pk_fma_f32 v[114:115], v[108:109], v[108:109], v[114:115]
  v_pk_add_f32 v[110:111], v[102:103], v[104:105] neg_lo:[0,1] neg_hi:[0,1]
  v_pk_fma_f32 v[116:117], v[110:111], v[110:111], v[116:117]
  v_pk_add_f32 v[114:115], v[114:115], v[116:117]
  v_add_f32 v105, v114, v115
  v_mov_b32 v115, v105
  s_nop 1
  v_permlane16_swap_b32 v115, v105
  s_nop 1
  v_add_f32 v105, v105, v115
  v_mov_b32 v115, v105
  s_nop 1
  v_permlane32_swap_b32 v115, v105
  s_nop 1
  v_add_f32 v105, v105, v115
  ds_write_b64 v7, v[104:105] offset:8192
  s_waitcnt lgkmcnt(0)
  s_barrier
  ds_read_b128 v[120:123], v6 offset:8192
  ds_read_b128 v[124:127], v6 offset:8208
  s_waitcnt lgkmcnt(0)
  v_pk_add_f32 v[114:115], v[120:121], v[122:123]
  v_pk_add_f32 v[116:117], v[124:125], v[126:127]
  v_pk_add_f32 v[114:115], v[114:115], v[116:117]
  v_mul_f32 v104, 0x3e800000, v114
  v_sub_f32 v120, v120, v104
  v_sub_f32 v122, v122, v104
  v_sub_f32 v124, v124, v104
  v_sub_f32 v126, v126, v104
  v_mul_f32 v116, v120, v120
  v_fmac_f32 v116, v122, v122
  v_fmac_f32 v116, v124, v124
  v_fmac_f32 v116, v126, v126
  v_mul_f32 v108, 0x3a800000, v115
  v_fmac_f32 v108, 0x3e800000, v116
  s_mov_b32 s30, 0
  buffer_load_dwordx4 v[120:123], v4, s[4:7], s30 offen sc1
  buffer_load_dwordx4 v[136:139], v5, s[4:7], s30 offen sc1
  s_mov_b32 s30, 24576
  buffer_load_dwordx4 v[124:127], v4, s[4:7], s30 offen sc1
  buffer_load_dwordx4 v[140:143], v5, s[4:7], s30 offen sc1
  s_mov_b32 s30, 49152
  buffer_load_dwordx4 v[128:131], v4, s[4:7], s30 offen sc1
  buffer_load_dwordx4 v[144:147], v5, s[4:7], s30 offen sc1
  s_mov_b32 s30, 73728
  buffer_load_dwordx4 v[132:135], v4, s[4:7], s30 offen sc1
  buffer_load_dwordx4 v[148:151], v5, s[4:7], s30 offen sc1
  v_cvt_pk_bf16_f32 v112, v104, v108
  v_lshlrev_b32 v104, 16, v112
  v_and_b32 v108, 0xffff0000, v112
  v_add_f32 v108, 0x3727c5ac, v108
  v_cvt_pk_bf16_f32 v112, v108, v109
  v_lshlrev_b32 v108, 16, v112
  v_and_b32 v109, 0xffff0000, v112
  v_sqrt_f32 v108, v108
  s_nop 0
  v_cvt_pk_bf16_f32 v112, v108, v109
  v_lshlrev_b32 v108, 16, v112
  v_and_b32 v109, 0xffff0000, v112
  v_rcp_f32 v108, v108
  v_mov_b32 v105, v104
  v_mov_b32 v109, v108
  v_pk_add_f32 v[40:41], v[40:41], v[104:105] neg_lo:[0,1] neg_hi:[0,1]
  v_pk_add_f32 v[42:43], v[42:43], v[104:105] neg_lo:[0,1] neg_hi:[0,1]
  v_pk_add_f32 v[44:45], v[44:45], v[104:105] neg_lo:[0,1] neg_hi:[0,1]
  v_pk_add_f32 v[46:47], v[46:47], v[104:105] neg_lo:[0,1] neg_hi:[0,1]
  v_pk_add_f32 v[48:49], v[48:49], v[104:105] neg_lo:[0,1] neg_hi:[0,1]
  v_pk_add_f32 v[50:51], v[50:51], v[104:105] neg_lo:[0,1] neg_hi:[0,1]
  v_pk_add_f32 v[52:53], v[52:53], v[104:105] neg_lo:[0,1] neg_hi:[0,1]
  v_pk_add_f32 v[54:55], v[54:55], v[104:105] neg_lo:[0,1] neg_hi:[0,1]
  v_pk_add_f32 v[56:57], v[56:57], v[104:105] neg_lo:[0,1] neg_hi:[0,1]
  v_pk_add_f32 v[58:59], v[58:59], v[104:105] neg_lo:[0,1] neg_hi:[0,1]
  v_pk_add_f32 v[60:61], v[60:61], v[104:105] neg_lo:[0,1] neg_hi:[0,1]
  v_pk_add_f32 v[62:63], v[62:63], v[104:105] neg_lo:[0,1] neg_hi:[0,1]
  v_pk_add_f32 v[64:65], v[64:65], v[104:105] neg_lo:[0,1] neg_hi:[0,1]
  v_pk_add_f32 v[66:67], v[66:67], v[104:105] neg_lo:[0,1] neg_hi:[0,1]
  v_pk_add_f32 v[68:69], v[68:69], v[104:105] neg_lo:[0,1] neg_hi:[0,1]
  v_pk_add_f32 v[70:71], v[70:71], v[104:105] neg_lo:[0,1] neg_hi:[0,1]
  v_pk_add_f32 v[72:73], v[72:73], v[104:105] neg_lo:[0,1] neg_hi:[0,1]
  v_pk_add_f32 v[74:75], v[74:75], v[104:105] neg_lo:[0,1] neg_hi:[0,1]
  v_pk_add_f32 v[76:77], v[76:77], v[104:105] neg_lo:[0,1] neg_hi:[0,1]
  v_pk_add_f32 v[78:79], v[78:79], v[104:105] neg_lo:[0,1] neg_hi:[0,1]
  v_pk_add_f32 v[80:81], v[80:81], v[104:105] neg_lo:[0,1] neg_hi:[0,1]
  v_pk_add_f32 v[82:83], v[82:83], v[104:105] neg_lo:[0,1] neg_hi:[0,1]
  v_pk_add_f32 v[84:85], v[84:85], v[104:105] neg_lo:[0,1] neg_hi:[0,1]
  v_pk_add_f32 v[86:87], v[86:87], v[104:105] neg_lo:[0,1] neg_hi:[0,1]
  v_pk_add_f32 v[88:89], v[88:89], v[104:105] neg_lo:[0,1] neg_hi:[0,1]
  v_pk_add_f32 v[90:91], v[90:91], v[104:105] neg_lo:[0,1] neg_hi:[0,1]
  v_pk_add_f32 v[92:93], v[92:93], v[104:105] neg_lo:[0,1] neg_hi:[0,1]
  v_pk_add_f32 v[94:95], v[94:95], v[104:105] neg_lo:[0,1] neg_hi:[0,1]
  v_pk_add_f32 v[96:97], v[96:97], v[104:105] neg_lo:[0,1] neg_hi:[0,1]
  v_pk_add_f32 v[98:99], v[98:99], v[104:105] neg_lo:[0,1] neg_hi:[0,1]
  v_pk_add_f32 v[100:101], v[100:101], v[104:105] neg_lo:[0,1] neg_hi:[0,1]
  v_pk_add_f32 v[102:103], v[102:103], v[104:105] neg_lo:[0,1] neg_hi:[0,1]
  v_pk_mul_f32 v[40:41], v[40:41], v[108:109]
  v_pk_mul_f32 v[42:43], v[42:43], v[108:109]
  v_pk_mul_f32 v[44:45], v[44:45], v[108:109]
  v_pk_mul_f32 v[46:47], v[46:47], v[108:109]
  v_pk_mul_f32 v[48:49], v[48:49], v[108:109]
  v_pk_mul_f32 v[50:51], v[50:51], v[108:109]
  v_pk_mul_f32 v[52:53], v[52:53], v[108:109]
  v_pk_mul_f32 v[54:55], v[54:55], v[108:109]
  v_pk_mul_f32 v[56:57], v[56:57], v[108:109]
  v_pk_mul_f32 v[58:59], v[58:59], v[108:109]
  v_pk_mul_f32 v[60:61], v[60:61], v[108:109]
  v_pk_mul_f32 v[62:63], v[62:63], v[108:109]
  v_pk_mul_f32 v[64:65], v[64:65], v[108:109]
  v_pk_mul_f32 v[66:67], v[66:67], v[108:109]
  v_pk_mul_f32 v[68:69], v[68:69], v[108:109]
  v_pk_mul_f32 v[70:71], v[70:71], v[108:109]
  v_pk_mul_f32 v[72:73], v[72:73], v[108:109]
  v_pk_mul_f32 v[74:75], v[74:75], v[108:109]
  v_pk_mul_f32 v[76:77], v[76:77], v[108:109]
  v_pk_mul_f32 v[78:79], v[78:79], v[108:109]
  v_pk_mul_f32 v[80:81], v[80:81], v[108:109]
  v_pk_mul_f32 v[82:83], v[82:83], v[108:109]
  v_pk_mul_f32 v[84:85], v[84:85], v[108:109]
  v_pk_mul_f32 v[86:87], v[86:87], v[108:109]
  v_pk_mul_f32 v[88:89], v[88:89], v[108:109]
  v_pk_mul_f32 v[90:91], v[90:91], v[108:109]
  v_pk_mul_f32 v[92:93], v[92:93], v[108:109]
  v_pk_mul_f32 v[94:95], v[94:95], v[108:109]
  v_pk_mul_f32 v[96:97], v[96:97], v[108:109]
  v_pk_mul_f32 v[98:99], v[98:99], v[108:109]
  v_pk_mul_f32 v[100:101], v[100:101], v[108:109]
  v_pk_mul_f32 v[102:103], v[102:103], v[108:109]
  s_mov_b32 s33, 262144
  s_branch L_mchk_9
L_mod_7:
  s_mov_b32 s30, 0
  buffer_load_dwordx4 v[120:123], v4, s[4:7], s30 offen sc1
  buffer_load_dwordx4 v[136:139], v5, s[4:7], s30 offen sc1
  s_mov_b32 s30, 24576
  buffer_load_dwordx4 v[124:127], v4, s[4:7], s30 offen sc1
  buffer_load_dwordx4 v[140:143], v5, s[4:7], s30 offen sc1
  s_mov_b32 s30, 49152
  buffer_load_dwordx4 v[128:131], v4, s[4:7], s30 offen sc1
  buffer_load_dwordx4 v[144:147], v5, s[4:7], s30 offen sc1
  s_mov_b32 s30, 73728
  buffer_load_dwordx4 v[132:135], v4, s[4:7], s30 offen sc1
  buffer_load_dwordx4 v[148:151], v5, s[4:7], s30 offen sc1
L_mchk_9:
  s_waitcnt vmcnt(0)
  v_xor_b32 v120, s84, v120
  v_xor_b32 v121, s85, v121
  v_or_b32 v114, v120, v121
  v_xor_b32 v122, s86, v122
  v_xor_b32 v123, s87, v123
  v_or3_b32 v114, v114, v122, v123
  v_xor_b32 v124, s84, v124
  v_xor_b32 v125, s85, v125
  v_or3_b32 v114, v114, v124, v125
  v_xor_b32 v126, s86, v126
  v_xor_b32 v127, s87, v127
  v_or3_b32 v114, v114, v126, v127
  v_xor_b32 v128, s84, v128
  v_xor_b32 v129, s85, v129
  v_or3_b32 v114, v114, v128, v129
  v_xor_b32 v130, s86, v130
  v_xor_b32 v131, s87, v131
  v_or3_b32 v114, v114, v130, v131
  v_xor_b32 v132, s84, v132
  v_xor_b32 v133, s85, v133
  v_or3_b32 v114, v114, v132, v133
  v_xor_b32 v134, s86, v134
  v_xor_b32 v135, s87, v135
  v_or3_b32 v114, v114, v134, v135
  v_xor_b32 v136, s84, v136
  v_xor_b32 v137, s85, v137
  v_or3_b32 v114, v114, v136, v137
  v_xor_b32 v138, s86, v138
  v_xor_b32 v139, s87, v139
  v_or3_b32 v114, v114, v138, v139
  v_xor_b32 v140, s84, v140
  v_xor_b32 v141, s85, v141
  v_or3_b32 v114, v114, v140, v141
  v_xor_b32 v142, s86, v142
  v_xor_b32 v143, s87, v143
  v_or3_b32 v114, v114, v142, v143
  v_xor_b32 v144, s84, v144
  v_xor_b32 v145, s85, v145
  v_or3_b32 v114, v114, v144, v145
  v_xor_b32 v146, s86, v146
  v_xor_b32 v147, s87, v147
  v_or3_b32 v114, v114, v146, v147
  v_xor_b32 v148, s84, v148
  v_xor_b32 v149, s85, v149
  v_or3_b32 v114, v114, v148, v149
  v_xor_b32 v150, s86, v150
  v_xor_b32 v151, s87, v151
  v_or3_b32 v114, v114, v150, v151
  v_and_b32 v114, 0xff, v114
  v_cmp_ne_u32 s[68:69], 0, v114
  s_nop 1
  s_cmp_eq_u64 s[68:69], 0
  s_cbranch_scc1 L_mok_8
  s_sub_u32 s33, s33, 1
  s_cmp_lg_u32 s33, 0
  s_cbranch_scc1 L_mod_7
L_mok_8:
  v_pk_add_f32 v[120:121], v[120:121], v[124:125]
  v_pk_add_f32 v[128:129], v[128:129], v[132:133]
  v_pk_add_f32 v[122:123], v[122:123], v[126:127]
  v_pk_add_f32 v[130:131], v[130:131], v[134:135]
  v_pk_add_f32 v[136:137], v[136:137], v[140:141]
  v_pk_add_f32 v[144:145], v[144:145], v[148:149]
  v_pk_add_f32 v[138:139], v[138:139], v[142:143]
  v_pk_add_f32 v[146:147], v[146:147], v[150:151]
  v_pk_add_f32 v[120:121], v[120:121], v[128:129]
  v_pk_add_f32 v[122:123], v[122:123], v[130:131]
  v_pk_add_f32 v[136:137], v[136:137], v[144:145]
  v_pk_add_f32 v[138:139], v[138:139], v[146:147]
  v_cvt_pk_bf16_f32 v124, v120, v121
  v_lshlrev_b32 v120, 16, v124
  v_and_b32 v121, 0xffff0000, v124
  v_cvt_pk_bf16_f32 v126, v122, v123
  v_lshlrev_b32 v122, 16, v126
  v_and_b32 v123, 0xffff0000, v126
  v_cvt_pk_bf16_f32 v140, v136, v137
  v_lshlrev_b32 v136, 16, v140
  v_and_b32 v137, 0xffff0000, v140
  v_cvt_pk_bf16_f32 v142, v138, v139
  v_lshlrev_b32 v138, 16, v142
  v_and_b32 v139, 0xffff0000, v142
  ds_write_b128 v3, v[120:123]
  v_add_f32 v136, 1.0, v136
  v_add_f32 v137, 1.0, v137
  v_add_f32 v138, 1.0, v138
  v_add_f32 v139, 1.0, v139
  v_cvt_pk_bf16_f32 v140, v136, v137
  v_lshlrev_b32 v136, 16, v140
  v_and_b32 v137, 0xffff0000, v140
  v_cvt_pk_bf16_f32 v142, v138, v139
  v_lshlrev_b32 v138, 16, v142
  v_and_b32 v139, 0xffff0000, v142
  ds_write_b128 v3, v[136:139] offset:1024
  ds_read_b128 v[144:147], v222 offset:0
  ds_read_b128 v[148:151], v222 offset:16
  ds_read_b128 v[152:155], v222 offset:1024
  ds_read_b128 v[156:159], v222 offset:1040
  ds_read_b128 v[160:163], v222 offset:128
  ds_read_b128 v[164:167], v222 offset:144
  ds_read_b128 v[168:171], v222 offset:1152
  ds_read_b128 v[172:175], v222 offset:1168
  ds_read_b128 v[128:131], v222 offset:256
  ds_read_b128 v[132:135], v222 offset:272
  ds_read_b128 v[136:139], v222 offset:1280
  ds_read_b128 v[140:143], v222 offset:1296
  s_waitcnt lgkmcnt(8)
  v_pk_fma_f32 v[40:41], v[40:41], v[152:153], v[144:145]
  v_pk_fma_f32 v[42:43], v[42:43], v[154:155], v[146:147]
  v_pk_fma_f32 v[44:45], v[44:45], v[156:157], v[148:149]
  v_pk_fma_f32 v[46:47], v[46:47], v[158:159], v[150:151]
  v_cvt_pk_bf16_f32 v8, v40, v41
  v_cvt_pk_bf16_f32 v9, v42, v43
  v_cvt_pk_bf16_f32 v10, v44, v45
  v_cvt_pk_bf16_f32 v11, v46, v47
  s_add_u32 s33, s1, 0
  v_permlane16_swap_b32 v8, v10
  v_permlane16_swap_b32 v9, v11
  s_nop 1
  buffer_store_dwordx4 v[8:11], v251, s[4:7], s33 offen sc1
  ds_read_b128 v[144:147], v222 offset:384
  ds_read_b128 v[148:151], v222 offset:400
  ds_read_b128 v[152:155], v222 offset:1408
  ds_read_b128 v[156:159], v222 offset:1424
  s_waitcnt lgkmcnt(8)
  v_pk_fma_f32 v[48:49], v[48:49], v[168:169], v[160:161]
  v_pk_fma_f32 v[50:51], v[50:51], v[170:171], v[162:163]
  v_pk_fma_f32 v[52:53], v[52:53], v[172:173], v[164:165]
  v_pk_fma_f32 v[54:55], v[54:55], v[174:175], v[166:167]
  v_cvt_pk_bf16_f32 v12, v48, v49
  v_cvt_pk_bf16_f32 v13, v50, v51
  v_cvt_pk_bf16_f32 v14, v52, v53
  v_cvt_pk_bf16_f32 v15, v54, v55
  s_add_u32 s33, s1, 131072
  v_permlane16_swap_b32 v12, v14
  v_permlane16_swap_b32 v13, v15
  s_nop 1
  buffer_store_dwordx4 v[12:15], v251, s[4:7], s33 offen sc1
  ds_read_b128 v[160:163], v222 offset:512
  ds_read_b128 v[164:167], v222 offset:528
  ds_read_b128 v[168:171], v222 offset:1536
  ds_read_b128 v[172:175], v222 offset:1552
  s_waitcnt lgkmcnt(8)
  v_pk_fma_f32 v[56:57], v[56:57], v[136:137], v[128:129]
  v_pk_fma_f32 v[58:59], v[58:59], v[138:139], v[130:131]
  v_pk_fma_f32 v[60:61], v[60:61], v[140:141], v[132:133]
  v_pk_fma_f32 v[62:63], v[62:63], v[142:143], v[134:135]
  v_cvt_pk_bf16_f32 v16, v56, v57
  v_cvt_pk_bf16_f32 v17, v58, v59
  v_cvt_pk_bf16_f32 v18, v60, v61
  v_cvt_pk_bf16_f32 v19, v62, v63
  s_add_u32 s33, s1, 1048576
  v_permlane16_swap_b32 v16, v18
  v_permlane16_swap_b32 v17, v19
  s_nop 1
  buffer_store_dwordx4 v[16:19], v251, s[4:7], s33 offen sc1
  ds_read_b128 v[128:131], v222 offset:640
  ds_read_b128 v[132:135], v222 offset:656
  ds_read_b128 v[136:139], v222 offset:1664
  ds_read_b128 v[140:143], v222 offset:1680
  s_waitcnt lgkmcnt(8)
  v_pk_fma_f32 v[64:65], v[64:65], v[152:153], v[144:145]
  v_pk_fma_f32 v[66:67], v[66:67], v[154:155], v[146:147]
  v_pk_fma_f32 v[68:69], v[68:69], v[156:157], v[148:149]
  v_pk_fma_f32 v[70:71], v[70:71], v[158:159], v[150:151]
  v_cvt_pk_bf16_f32 v20, v64, v65
  v_cvt_pk_bf16_f32 v21, v66, v67
  v_cvt_pk_bf16_f32 v22, v68, v69
  v_cvt_pk_bf16_f32 v23, v70, v71
  s_add_u32 s33, s1, 1179648
  v_permlane16_swap_b32 v20, v22
  v_permlane16_swap_b32 v21, v23
  s_nop 1
  buffer_store_dwordx4 v[20:23], v251, s[4:7], s33 offen sc1
  ds_read_b128 v[144:147], v222 offset:768
  ds_read_b128 v[148:151], v222 offset:784
  ds_read_b128 v[152:155], v222 offset:1792
  ds_read_b128 v[156:159], v222 offset:1808
  s_waitcnt lgkmcnt(8)
  v_pk_fma_f32 v[72:73], v[72:73], v[168:169], v[160:161]
  v_pk_fma_f32 v[74:75], v[74:75], v[170:171], v[162:163]
  v_pk_fma_f32 v[76:77], v[76:77], v[172:173], v[164:165]
  v_pk_fma_f32 v[78:79], v[78:79], v[174:175], v[166:167]
  v_cvt_pk_bf16_f32 v24, v72, v73
  v_cvt_pk_bf16_f32 v25, v74, v75
  v_cvt_pk_bf16_f32 v26, v76, v77
  v_cvt_pk_bf16_f32 v27, v78, v79
  s_add_u32 s33, s1, 2097152
  v_permlane16_swap_b32 v24, v26
  v_permlane16_swap_b32 v25, v27
  s_nop 1
  buffer_store_dwordx4 v[24:27], v251, s[4:7], s33 offen sc1
  ds_read_b128 v[160:163], v222 offset:896
  ds_read_b128 v[164:167], v222 offset:912
  ds_read_b128 v[168:171], v222 offset:1920
  ds_read_b128 v[172:175], v222 offset:1936
  s_waitcnt lgkmcnt(8)
  v_pk_fma_f32 v[80:81], v[80:81], v[136:137], v[128:129]
  v_pk_fma_f32 v[82:83], v[82:83], v[138:139], v[130:131]
  v_pk_fma_f32 v[84:85], v[84:85], v[140:141], v[132:133]
  v_pk_fma_f32 v[86:87], v[86:87], v[142:143], v[134:135]
  v_cvt_pk_bf16_f32 v28, v80, v81
  v_cvt_pk_bf16_f32 v29, v82, v83
  v_cvt_pk_bf16_f32 v30, v84, v85
  v_cvt_pk_bf16_f32 v31, v86, v87
  s_add_u32 s33, s1, 2228224
  v_permlane16_swap_b32 v28, v30
  v_permlane16_swap_b32 v29, v31
  s_nop 1
  buffer_store_dwordx4 v[28:31], v251, s[4:7], s33 offen sc1
  s_waitcnt lgkmcnt(4)
  v_pk_fma_f32 v[88:89], v[88:89], v[152:153], v[144:145]
  v_pk_fma_f32 v[90:91], v[90:91], v[154:155], v[146:147]
  v_pk_fma_f32 v[92:93], v[92:93], v[156:157], v[148:149]
  v_pk_fma_f32 v[94:95], v[94:95], v[158:159], v[150:151]
  v_cvt_pk_bf16_f32 v32, v88, v89
  v_cvt_pk_bf16_f32 v33, v90, v91
  v_cvt_pk_bf16_f32 v34, v92, v93
  v_cvt_pk_bf16_f32 v35, v94, v95
  s_add_u32 s33, s1, 3145728
  v_permlane16_swap_b32 v32, v34
  v_permlane16_swap_b32 v33, v35
  s_nop 1
  buffer_store_dwordx4 v[32:35], v251, s[4:7], s33 offen sc1
  s_waitcnt lgkmcnt(0)
  v_pk_fma_f32 v[96:97], v[96:97], v[168:169], v[160:161]
  v_pk_fma_f32 v[98:99], v[98:99], v[170:171], v[162:163]
  v_pk_fma_f32 v[100:101], v[100:101], v[172:173], v[164:165]
  v_pk_fma_f32 v[102:103], v[102:103], v[174:175], v[166:167]
  v_cvt_pk_bf16_f32 v36, v96, v97
  v_cvt_pk_bf16_f32 v37, v98, v99
  v_cvt_pk_bf16_f32 v38, v100, v101
  v_cvt_pk_bf16_f32 v39, v102, v103
  s_add_u32 s33, s1, 3276800
  v_permlane16_swap_b32 v36, v38
  v_permlane16_swap_b32 v37, v39
  s_nop 1
  buffer_store_dwordx4 v[36:39], v251, s[4:7], s33 offen sc1
  s_waitcnt vmcnt(6)
  v_add_u32 v248, 0, v245
  buffer_store_dword v248, v246, s[4:7], s0 offen sc1
  s_waitcnt vmcnt(1)
  v_add_u32 v248, 1, v245
  buffer_store_dword v248, v246, s[4:7], s0 offen sc1
  s_mov_b32 s41, 1572864
  s_add_u32 m0, s42, 108544
  s_nop 0
  buffer_load_dwordx4 v185, s[80:83], s41 offen offset:2048 lds
  s_mov_b32 s41, 1572864
  s_add_u32 m0, s42, 112576
  s_nop 0
  buffer_load_dwordx4 v185, s[80:83], s41 offen offset:2112 lds
  s_mov_b32 s41, 1572864
  s_add_u32 m0, s42, 118784
  s_nop 0
  buffer_load_dwordx4 v186, s[80:83], s41 offen offset:0 lds
  s_mov_b32 s41, 1572864
  s_add_u32 m0, s42, 122816
  s_nop 0
  buffer_load_dwordx4 v186, s[80:83], s41 offen offset:64 lds
  s_mov_b32 s41, 1572864
  s_add_u32 m0, s42, 126976
  s_nop 0
  buffer_load_dwordx4 v185, s[80:83], s41 offen offset:0 lds
  s_mov_b32 s41, 1572864
  s_add_u32 m0, s42, 131008
  s_nop 0
  buffer_load_dwordx4 v185, s[80:83], s41 offen offset:64 lds
  s_mov_b32 s41, 1966080
  s_add_u32 m0, s42, 133120
  s_nop 0
  buffer_load_dwordx4 v185, s[80:83], s41 offen offset:2048 lds
  s_mov_b32 s41, 1966080
  s_add_u32 m0, s42, 137152
  s_nop 0
  buffer_load_dwordx4 v185, s[80:83], s41 offen offset:2112 lds
  s_mov_b32 s41, 1966080
  s_add_u32 m0, s42, 143360
  s_nop 0
  buffer_load_dwordx4 v186, s[80:83], s41 offen offset:0 lds
  s_mov_b32 s41, 1966080
  s_add_u32 m0, s42, 147392
  s_nop 0
  buffer_load_dwordx4 v186, s[80:83], s41 offen offset:64 lds
  s_mov_b32 s41, 1966080
  s_add_u32 m0, s42, 151552
  s_nop 0
  buffer_load_dwordx4 v185, s[80:83], s41 offen offset:0 lds
  s_mov_b32 s41, 1966080
  s_add_u32 m0, s42, 155584
  s_nop 0
  buffer_load_dwordx4 v185, s[80:83], s41 offen offset:64 lds
L_j2_5:
  s_mov_b64 vcc, 0
  s_mov_b64 vcc, -1
  s_cmp_eq_u32 s3, 0
  s_cbranch_scc1 L_wk0_0
  s_cmp_eq_u32 s3, 1
  s_cbranch_scc1 L_wk0_1
  s_cmp_eq_u32 s3, 2
  s_cbranch_scc1 L_wk0_2
  s_branch L_wk0_3
L_wk0_end:
  s_mov_b64 vcc, 0
  s_branch L_hot
  .p2align 12
L_hot:
  s_mov_b32 s33, 262144
L_spin_10:
  buffer_load_dword v244, v189, s[4:7], 0 offen sc1
  s_waitcnt vmcnt(0)
  v_subrev_u32 v244, s100, v244
  v_cmp_lt_u32 s[68:69], 7, v244
  s_nop 1
  s_cmp_eq_u64 s[68:69], 0
  s_cbranch_scc1 L_ok_11
  s_sub_u32 s33, s33, 1
  s_cmp_lg_u32 s33, 0
  s_cbranch_scc1 L_spin_10
L_ok_11:
  s_mov_b32 s40, 1048576
  buffer_load_dwordx4 v[112:115], v188, s[4:7], s40 offen sc1
  buffer_load_dwordx4 a[0:3], v187, s[4:7], s40 offen offset:0 sc1
  buffer_load_dwordx4 a[4:7], v187, s[4:7], s40 offen offset:1024 sc1
  s_mov_b32 s40, 1179648
  buffer_load_dwordx4 a[8:11], v187, s[4:7], s40 offen offset:0 sc1
  buffer_load_dwordx4 a[12:15], v187, s[4:7], s40 offen offset:1024 sc1
  s_mov_b32 s40, 1310720
  buffer_load_dwordx4 v[116:119], v188, s[4:7], s40 offen sc1
  buffer_load_dwordx4 a[16:19], v187, s[4:7], s40 offen offset:0 sc1
  buffer_load_dwordx4 a[20:23], v187, s[4:7], s40 offen offset:1024 sc1
  s_mov_b32 s40, 1441792
  buffer_load_dwordx4 a[24:27], v187, s[4:7], s40 offen offset:0 sc1
  buffer_load_dwordx4 a[28:31], v187, s[4:7], s40 offen offset:1024 sc1
  s_barrier
  ds_read_b64_tr_b16 a[192:193], v182 offset:12288
  ds_read_b64_tr_b16 a[194:195], v182 offset:13312
  ds_read_b64_tr_b16 a[196:197], v182 offset:20480
  ds_read_b64_tr_b16 a[198:199], v182 offset:21504
  ds_read_b64_tr_b16 a[200:201], v176 offset:12288
  ds_read_b64_tr_b16 a[202:203], v176 offset:13312
  ds_read_b64_tr_b16 a[204:205], v176 offset:14336
  ds_read_b64_tr_b16 a[206:207], v176 offset:15360
  ds_read_b64_tr_b16 a[208:209], v177 offset:12288
  ds_read_b64_tr_b16 a[210:211], v177 offset:13312
  ds_read_b64_tr_b16 a[212:213], v177 offset:14336
  ds_read_b64_tr_b16 a[214:215], v177 offset:15360
  ds_read_b64_tr_b16 a[216:217], v176 offset:20480
  ds_read_b64_tr_b16 a[218:219], v176 offset:21504
  ds_read_b64_tr_b16 a[220:221], v176 offset:22528
  ds_read_b64_tr_b16 a[222:223], v176 offset:23552
  ds_read_b64_tr_b16 a[224:225], v177 offset:20480
  ds_read_b64_tr_b16 a[226:227], v177 offset:21504
  ds_read_b64_tr_b16 a[228:229], v177 offset:22528
  ds_read_b64_tr_b16 a[230:231], v177 offset:23552
  ds_read_b64_tr_b16 a[232:233], v176 offset:28672
  ds_read_b64_tr_b16 a[234:235], v176 offset:29696
  s_mov_b32 s40, 1572864
  buffer_load_dword v244, v189, s[4:7], 0 offen sc1
  s_waitcnt vmcnt(6) lgkmcnt(13)
  v_mfma_f32_16x16x32_bf16 v[96:99], a[192:195], v[112:115], 0
  ds_read_b64_tr_b16 a[192:193], v176 offset:30720
  ds_read_b64_tr_b16 a[194:195], v176 offset:31744
  v_mfma_f32_16x16x32_bf16 v[100:103], v[112:115], a[196:199], 0
  buffer_load_dwordx4 v[120:123], v188, s[4:7], s40 offen sc1
  v_mfma_f32_16x16x32_bf16 v[8:11], a[200:203], a[0:3], 0
  ds_read_b64_tr_b16 a[196:197], v177 offset:28672
  ds_read_b64_tr_b16 a[198:199], v177 offset:29696
  v_mfma_f32_16x16x32_bf16 v[8:11], a[204:207], a[8:11], v[8:11]
  v_mfma_f32_16x16x32_bf16 v[32:35], a[200:203], a[4:7], 0
  buffer_load_dwordx4 a[32:35], v187, s[4:7], s40 offen offset:0 sc1
  v_mfma_f32_16x16x32_bf16 v[32:35], a[204:207], a[12:15], v[32:35]
  ds_read_b64_tr_b16 a[200:201], v177 offset:30720
  ds_read_b64_tr_b16 a[202:203], v177 offset:31744
  s_waitcnt lgkmcnt(13)
  v_mfma_f32_16x16x32_bf16 v[36:39], a[208:211], a[4:7], 0
  ds_read_b64_tr_b16 a[204:205], v182 offset:16384
  ds_read_b64_tr_b16 a[206:207], v182 offset:17408
  v_mfma_f32_16x16x32_bf16 v[36:39], a[212:215], a[12:15], v[36:39]
  v_mfma_f32_16x16x32_bf16 v[12:15], a[208:211], a[0:3], 0
  buffer_load_dwordx4 a[36:39], v187, s[4:7], s40 offen offset:1024 sc1
  s_mov_b32 s40, 1703936
  v_mfma_f32_16x16x32_bf16 v[12:15], a[212:215], a[8:11], v[12:15]
  ds_read_b64_tr_b16 a[208:209], v182 offset:24576
  ds_read_b64_tr_b16 a[210:211], v182 offset:25600
  v_mfma_f32_16x16x32_bf16 v[16:19], a[0:3], a[216:219], 0
  ds_read_b64_tr_b16 a[212:213], v176 offset:16384
  ds_read_b64_tr_b16 a[214:215], v176 offset:17408
  s_waitcnt lgkmcnt(13)
  v_mfma_f32_16x16x32_bf16 v[16:19], a[8:11], a[220:223], v[16:19]
  v_mfma_f32_16x16x32_bf16 v[40:43], a[4:7], a[216:219], 0
  buffer_load_dwordx4 a[40:43], v187, s[4:7], s40 offen offset:0 sc1
  v_mfma_f32_16x16x32_bf16 v[40:43], a[12:15], a[220:223], v[40:43]
  ds_read_b64_tr_b16 a[216:217], v176 offset:18432
  ds_read_b64_tr_b16 a[218:219], v176 offset:19456
  v_mfma_f32_16x16x32_bf16 v[44:47], a[4:7], a[224:227], 0
  ds_read_b64_tr_b16 a[220:221], v177 offset:16384
  ds_read_b64_tr_b16 a[222:223], v177 offset:17408
  v_mfma_f32_16x16x32_bf16 v[44:47], a[12:15], a[228:231], v[44:47]
  v_mfma_f32_16x16x32_bf16 v[20:23], a[0:3], a[224:227], 0
  buffer_load_dwordx4 a[44:47], v187, s[4:7], s40 offen offset:1024 sc1
  v_mfma_f32_16x16x32_bf16 v[20:23], a[8:11], a[228:231], v[20:23]
  ds_read_b64_tr_b16 a[224:225], v177 offset:18432
  ds_read_b64_tr_b16 a[226:227], v177 offset:19456
  s_mov_b32 s40, 1835008
  s_waitcnt lgkmcnt(13)
  v_mfma_f32_16x16x32_bf16 v[0:3], a[232:235], a[0:3], 0
  ds_read_b64_tr_b16 a[228:229], v176 offset:24576
  ds_read_b64_tr_b16 a[230:231], v176 offset:25600
  v_mfma_f32_16x16x32_bf16 v[0:3], a[192:195], a[8:11], v[0:3]
  v_mfma_f32_16x16x32_bf16 v[24:27], a[232:235], a[4:7], 0
  buffer_load_dwordx4 v[124:127], v188, s[4:7], s40 offen sc1
  v_mfma_f32_16x16x32_bf16 v[24:27], a[192:195], a[12:15], v[24:27]
  ds_read_b64_tr_b16 a[232:233], v176 offset:26624
  ds_read_b64_tr_b16 a[234:235], v176 offset:27648
  v_mfma_f32_16x16x32_bf16 v[28:31], a[196:199], a[4:7], 0
  ds_read_b64_tr_b16 a[192:193], v177 offset:24576
  ds_read_b64_tr_b16 a[194:195], v177 offset:25600
  s_waitcnt lgkmcnt(13)
  v_mfma_f32_16x16x32_bf16 v[28:31], a[200:203], a[12:15], v[28:31]
  v_mfma_f32_16x16x32_bf16 v[4:7], a[196:199], a[0:3], 0
  buffer_load_dwordx4 a[48:51], v187, s[4:7], s40 offen offset:0 sc1
  v_mfma_f32_16x16x32_bf16 v[4:7], a[200:203], a[8:11], v[4:7]
  s_barrier
  ds_read_b64_tr_b16 a[196:197], v177 offset:26624
  v_mfma_f32_16x16x32_bf16 v[104:107], a[204:207], v[112:115], 0
  ds_read_b64_tr_b16 a[198:199], v177 offset:27648
  ds_read_b64_tr_b16 a[200:201], v176 offset:32768
  v_mfma_f32_16x16x32_bf16 v[108:111], v[112:115], a[208:211], 0
  ds_read_b64_tr_b16 a[202:203], v176 offset:33792
  ds_read_b64_tr_b16 a[204:205], v176 offset:34816
  s_waitcnt vmcnt(7)
  v_subrev_u32 v244, s100, v244
  v_subrev_u32 v244, 1, v244
  s_waitcnt lgkmcnt(13)
  v_mfma_f32_16x16x32_bf16 v[56:59], a[212:215], a[0:3], 0
  buffer_load_dwordx4 a[52:55], v187, s[4:7], s40 offen offset:1024 sc1
  s_mov_b32 s40, 1966080
  v_cmp_lt_u32 s[68:69], 6, v244
  v_mfma_f32_16x16x32_bf16 v[56:59], a[216:219], a[8:11], v[56:59]
  ds_read_b64_tr_b16 a[206:207], v176 offset:35840
  ds_read_b64_tr_b16 a[208:209], v177 offset:32768
  s_cmp_lg_u64 s[68:69], 0
  s_cbranch_scc1 L_slow_12
L_back_13:
  v_mfma_f32_16x16x32_bf16 v[80:83], a[212:215], a[4:7], 0
  ds_read_b64_tr_b16 a[210:211], v177 offset:33792
  ds_read_b64_tr_b16 a[212:213], v177 offset:34816
  s_load_dwordx2 s[66:67], s[36:37], 0x0
  v_mfma_f32_16x16x32_bf16 v[80:83], a[216:219], a[12:15], v[80:83]
  ds_read_b64_tr_b16 a[214:215], v177 offset:35840
  ds_read_b64_tr_b16 a[216:217], v182 offset:36864
  v_mfma_f32_16x16x32_bf16 v[84:87], a[220:223], a[4:7], 0
  buffer_load_dwordx4 a[56:59], v187, s[4:7], s40 offen offset:0 sc1
  s_waitcnt lgkmcnt(13)
  v_mfma_f32_16x16x32_bf16 v[84:87], a[224:227], a[12:15], v[84:87]
  ds_read_b64_tr_b16 a[218:219], v182 offset:37888
  v_mfma_f32_16x16x32_bf16 v[60:63], a[220:223], a[0:3], 0
  ds_read_b64_tr_b16 a[220:221], v182 offset:45056
  ds_read_b64_tr_b16 a[222:223], v182 offset:46080
  v_mfma_f32_16x16x32_bf16 v[60:63], a[224:227], a[8:11], v[60:63]
  ds_read_b64_tr_b16 a[224:225], v176 offset:36864
  ds_read_b64_tr_b16 a[226:227], v176 offset:37888
  v_mfma_f32_16x16x32_bf16 v[64:67], a[0:3], a[228:231], 0
  buffer_load_dwordx4 a[60:63], v187, s[4:7], s40 offen offset:1024 sc1
  v_mfma_f32_16x16x32_bf16 v[64:67], a[8:11], a[232:235], v[64:67]
  s_mov_b32 s40, 2097152
  v_mfma_f32_16x16x32_bf16 v[88:91], a[4:7], a[228:231], 0
  ds_read_b64_tr_b16 a[228:229], v176 offset:38912
  ds_read_b64_tr_b16 a[230:231], v176 offset:39936
  v_mfma_f32_16x16x32_bf16 v[88:91], a[12:15], a[232:235], v[88:91]
  ds_read_b64_tr_b16 a[232:233], v177 offset:36864
  ds_read_b64_tr_b16 a[234:235], v177 offset:37888
  s_waitcnt lgkmcnt(13)
  v_mfma_f32_16x16x32_bf16 v[92:95], a[4:7], a[192:195], 0
  buffer_load_dwordx4 v[128:131], v188, s[4:7], s40 offen sc1
  v_mfma_f32_16x16x32_bf16 v[92:95], a[12:15], a[196:199], v[92:95]
  v_mfma_f32_16x16x32_bf16 v[68:71], a[0:3], a[192:195], 0
  ds_read_b64_tr_b16 a[192:193], v177 offset:38912
  ds_read_b64_tr_b16 a[194:195], v177 offset:39936
  s_load_dwordx2 s[66:67], s[36:37], 0x20000
  v_mfma_f32_16x16x32_bf16 v[68:71], a[8:11], a[196:199], v[68:71]
  ds_read_b64_tr_b16 a[196:197], v176 offset:45056
  ds_read_b64_tr_b16 a[198:199], v176 offset:46080
  v_mfma_f32_16x16x32_bf16 v[48:51], a[200:203], a[0:3], 0
  buffer_load_dwordx4 a[64:67], v187, s[4:7], s40 offen offset:0 sc1
  v_mfma_f32_16x16x32_bf16 v[48:51], a[204:207], a[8:11], v[48:51]
  v_mfma_f32_16x16x32_bf16 v[72:75], a[200:203], a[4:7], 0
  ds_read_b64_tr_b16 a[200:201], v176 offset:47104
  ds_read_b64_tr_b16 a[202:203], v176 offset:48128
  v_mfma_f32_16x16x32_bf16 v[72:75], a[204:207], a[12:15], v[72:75]
  ds_read_b64_tr_b16 a[204:205], v177 offset:45056
  ds_read_b64_tr_b16 a[206:207], v177 offset:46080
  s_waitcnt lgkmcnt(13)
  v_mfma_f32_16x16x32_bf16 v[76:79], a[208:211], a[4:7], 0
  buffer_load_dwordx4 a[68:71], v187, s[4:7], s40 offen offset:1024 sc1
  s_mov_b32 s40, 2228224
  v_mfma_f32_16x16x32_bf16 v[76:79], a[212:215], a[12:15], v[76:79]
  v_mfma_f32_16x16x32_bf16 v[52:55], a[208:211], a[0:3], 0
  ds_read_b64_tr_b16 a[208:209], v177 offset:47104
  ds_read_b64_tr_b16 a[210:211], v177 offset:48128
  v_mfma_f32_16x16x32_bf16 v[52:55], a[212:215], a[8:11], v[52:55]
  s_barrier
  ds_read_b64_tr_b16 a[212:213], v176 offset:53248
  v_mfma_f32_16x16x32_bf16 v[96:99], a[216:219], v[116:119], v[96:99]
  buffer_load_dwordx4 a[72:75], v187, s[4:7], s40 offen offset:0 sc1
  v_mfma_f32_16x16x32_bf16 v[100:103], v[116:119], a[220:223], v[100:103]
  ds_read_b64_tr_b16 a[214:215], v176 offset:54272
  ds_read_b64_tr_b16 a[216:217], v176 offset:55296
  s_waitcnt lgkmcnt(13)
  v_mfma_f32_16x16x32_bf16 v[8:11], a[224:227], a[16:19], v[8:11]
  ds_read_b64_tr_b16 a[218:219], v176 offset:56320
  ds_read_b64_tr_b16 a[220:221], v177 offset:53248
  s_load_dwordx2 s[66:67], s[36:37], 0x40000
  v_mfma_f32_16x16x32_bf16 v[8:11], a[228:231], a[24:27], v[8:11]
  ds_read_b64_tr_b16 a[222:223], v177 offset:54272
  v_mfma_f32_16x16x32_bf16 v[32:35], a[224:227], a[20:23], v[32:35]
  buffer_load_dwordx4 a[76:79], v187, s[4:7], s40 offen offset:1024 sc1
  v_mfma_f32_16x16x32_bf16 v[32:35], a[228:231], a[28:31], v[32:35]
  ds_read_b64_tr_b16 a[224:225], v177 offset:55296
  ds_read_b64_tr_b16 a[226:227], v177 offset:56320
  s_mov_b32 s40, 2359296
  v_mfma_f32_16x16x32_bf16 v[36:39], a[232:235], a[20:23], v[36:39]
  ds_read_b64_tr_b16 a[228:229], v182 offset:40960
  ds_read_b64_tr_b16 a[230:231], v182 offset:41984
  s_waitcnt lgkmcnt(13)
  v_mfma_f32_16x16x32_bf16 v[36:39], a[192:195], a[28:31], v[36:39]
  v_mfma_f32_16x16x32_bf16 v[12:15], a[232:235], a[16:19], v[12:15]
  buffer_load_dwordx4 v[132:135], v188, s[4:7], s40 offen sc1
  v_mfma_f32_16x16x32_bf16 v[12:15], a[192:195], a[24:27], v[12:15]
  ds_read_b64_tr_b16 a[232:233], v182 offset:49152
  ds_read_b64_tr_b16 a[234:235], v182 offset:50176
  v_mfma_f32_16x16x32_bf16 v[16:19], a[16:19], a[196:199], v[16:19]
  ds_read_b64_tr_b16 a[192:193], v176 offset:40960
  ds_read_b64_tr_b16 a[194:195], v176 offset:41984
  v_mfma_f32_16x16x32_bf16 v[16:19], a[24:27], a[200:203], v[16:19]
  v_mfma_f32_16x16x32_bf16 v[40:43], a[20:23], a[196:199], v[40:43]
  buffer_load_dwordx4 a[80:83], v187, s[4:7], s40 offen offset:0 sc1
  v_mfma_f32_16x16x32_bf16 v[40:43], a[28:31], a[200:203], v[40:43]
  ds_read_b64_tr_b16 a[196:197], v176 offset:43008
  ds_read_b64_tr_b16 a[198:199], v176 offset:44032
  s_waitcnt lgkmcnt(13)
  v_mfma_f32_16x16x32_bf16 v[44:47], a[20:23], a[204:207], v[44:47]
  ds_read_b64_tr_b16 a[200:201], v177 offset:40960
  ds_read_b64_tr_b16 a[202:203], v177 offset:41984
  s_load_dwordx2 s[66:67], s[36:37], 0x60000
  v_mfma_f32_16x16x32_bf16 v[44:47], a[28:31], a[208:211], v[44:47]
  v_mfma_f32_16x16x32_bf16 v[20:23], a[16:19], a[204:207], v[20:23]
  buffer_load_dwordx4 a[84:87], v187, s[4:7], s40 offen offset:1024 sc1
  s_mov_b32 s40, 2490368
  v_mfma_f32_16x16x32_bf16 v[20:23], a[24:27], a[208:211], v[20:23]
  ds_read_b64_tr_b16 a[204:205], v177 offset:43008
  ds_read_b64_tr_b16 a[206:207], v177 offset:44032
  v_mfma_f32_16x16x32_bf16 v[0:3], a[212:215], a[16:19], v[0:3]
  ds_read_b64_tr_b16 a[208:209], v176 offset:49152
  ds_read_b64_tr_b16 a[210:211], v176 offset:50176
  s_waitcnt lgkmcnt(13)
  v_mfma_f32_16x16x32_bf16 v[0:3], a[216:219], a[24:27], v[0:3]
  v_mfma_f32_16x16x32_bf16 v[24:27], a[212:215], a[20:23], v[24:27]
  buffer_load_dwordx4 a[88:91], v187, s[4:7], s40 offen offset:0 sc1
  v_mfma_f32_16x16x32_bf16 v[24:27], a[216:219], a[28:31], v[24:27]
  ds_read_b64_tr_b16 a[212:213], v176 offset:51200
  ds_read_b64_tr_b16 a[214:215], v176 offset:52224
  v_mfma_f32_16x16x32_bf16 v[28:31], a[220:223], a[20:23], v[28:31]
  ds_read_b64_tr_b16 a[216:217], v177 offset:49152
  ds_read_b64_tr_b16 a[218:219], v177 offset:50176
  v_mfma_f32_16x16x32_bf16 v[28:31], a[224:227], a[28:31], v[28:31]
  v_mfma_f32_16x16x32_bf16 v[4:7], a[220:223], a[16:19], v[4:7]
  buffer_load_dwordx4 a[92:95], v187, s[4:7], s40 offen offset:1024 sc1
  v_mfma_f32_16x16x32_bf16 v[4:7], a[224:227], a[24:27], v[4:7]
  s_barrier
  ds_read_b64_tr_b16 a[220:221], v177 offset:51200
  s_waitcnt lgkmcnt(13)
  v_mfma_f32_16x16x32_bf16 v[104:107], a[228:231], v[116:119], v[104:107]
  ds_read_b64_tr_b16 a[222:223], v177 offset:52224
  ds_read_b64_tr_b16 a[224:225], v176 offset:57344
  s_mov_b32 s41, 2359296
  s_load_dwordx2 s[66:67], s[36:37], 0x80000
  v_mfma_f32_16x16x32_bf16 v[108:111], v[116:119], a[232:235], v[108:111]
  ds_read_b64_tr_b16 a[226:227], v176 offset:58368
  ds_read_b64_tr_b16 a[228:229], v176 offset:59392
  s_add_u32 m0, s42, 157696
  v_mfma_f32_16x16x32_bf16 v[56:59], a[192:195], a[16:19], v[56:59]
  buffer_load_dwordx4 v185, s[80:83], s41 offen offset:2048 lds
  s_add_u32 m0, s42, 10176
  s_waitcnt lgkmcnt(13)
  v_mfma_f32_16x16x32_bf16 v[56:59], a[196:199], a[24:27], v[56:59]
  ds_read_b64_tr_b16 a[230:231], v176 offset:60416
  ds_read_b64_tr_b16 a[232:233], v177 offset:57344
  v_mfma_f32_16x16x32_bf16 v[80:83], a[192:195], a[20:23], v[80:83]
  ds_read_b64_tr_b16 a[234:235], v177 offset:58368
  ds_read_b64_tr_b16 a[192:193], v177 offset:59392
  v_mfma_f32_16x16x32_bf16 v[80:83], a[196:199], a[28:31], v[80:83]
  ds_read_b64_tr_b16 a[194:195], v177 offset:60416
  ds_read_b64_tr_b16 a[196:197], v182 offset:61440
  v_mfma_f32_16x16x32_bf16 v[84:87], a[200:203], a[20:23], v[84:87]
  buffer_load_dwordx4 v185, s[80:83], s41 offen offset:2112 lds
  s_waitcnt lgkmcnt(13)
  v_mfma_f32_16x16x32_bf16 v[84:87], a[204:207], a[28:31], v[84:87]
  ds_read_b64_tr_b16 a[198:199], v182 offset:62464
  s_add_u32 m0, s42, 20480
  v_mfma_f32_16x16x32_bf16 v[60:63], a[200:203], a[16:19], v[60:63]
  ds_read_b64_tr_b16 a[200:201], v183 offset:4096
  ds_read_b64_tr_b16 a[202:203], v183 offset:5120
  v_mfma_f32_16x16x32_bf16 v[60:63], a[204:207], a[24:27], v[60:63]
  ds_read_b64_tr_b16 a[204:205], v176 offset:61440
  ds_read_b64_tr_b16 a[206:207], v176 offset:62464
  v_mfma_f32_16x16x32_bf16 v[64:67], a[16:19], a[208:211], v[64:67]
  buffer_load_dwordx4 v186, s[80:83], s41 offen offset:0 lds
  s_add_u32 m0, s42, 28608
  v_mfma_f32_16x16x32_bf16 v[64:67], a[24:27], a[212:215], v[64:67]
  v_mfma_f32_16x16x32_bf16 v[88:91], a[20:23], a[208:211], v[88:91]
  ds_read_b64_tr_b16 a[208:209], v176 offset:63488
  ds_read_b64_tr_b16 a[210:211], v176 offset:64512
  s_load_dwordx2 s[66:67], s[36:37], 0xa0000
  v_mfma_f32_16x16x32_bf16 v[88:91], a[28:31], a[212:215], v[88:91]
  ds_read_b64_tr_b16 a[212:213], v177 offset:61440
  ds_read_b64_tr_b16 a[214:215], v177 offset:62464
  s_waitcnt lgkmcnt(13)
  v_mfma_f32_16x16x32_bf16 v[92:95], a[20:23], a[216:219], v[92:95]
  buffer_load_dwordx4 v186, s[80:83], s41 offen offset:64 lds
  v_mfma_f32_16x16x32_bf16 v[92:95], a[28:31], a[220:223], v[92:95]
  s_add_u32 m0, s42, 16384
  v_mfma_f32_16x16x32_bf16 v[68:71], a[16:19], a[216:219], v[68:71]
  ds_read_b64_tr_b16 a[216:217], v177 offset:63488
  ds_read_b64_tr_b16 a[218:219], v177 offset:64512
  v_mfma_f32_16x16x32_bf16 v[68:71], a[24:27], a[220:223], v[68:71]
  ds_read_b64_tr_b16 a[220:221], v178 offset:4096
  ds_read_b64_tr_b16 a[222:223], v178 offset:5120
  v_mfma_f32_16x16x32_bf16 v[48:51], a[224:227], a[16:19], v[48:51]
  buffer_load_dwordx4 v185, s[80:83], s41 offen offset:0 lds
  s_add_u32 m0, s42, 24512
  v_mfma_f32_16x16x32_bf16 v[48:51], a[228:231], a[24:27], v[48:51]
  v_mfma_f32_16x16x32_bf16 v[72:75], a[224:227], a[20:23], v[72:75]
  ds_read_b64_tr_b16 a[224:225], v178 offset:6144
  ds_read_b64_tr_b16 a[226:227], v178 offset:7168
  v_mfma_f32_16x16x32_bf16 v[72:75], a[228:231], a[28:31], v[72:75]
  ds_read_b64_tr_b16 a[228:229], v179 offset:4096
  ds_read_b64_tr_b16 a[230:231], v179 offset:5120
  s_waitcnt lgkmcnt(13)
  v_mfma_f32_16x16x32_bf16 v[76:79], a[232:235], a[20:23], v[76:79]
  buffer_load_dwordx4 v185, s[80:83], s41 offen offset:64 lds
  v_mfma_f32_16x16x32_bf16 v[76:79], a[192:195], a[28:31], v[76:79]
  s_mov_b32 s40, 2621440
  v_mfma_f32_16x16x32_bf16 v[52:55], a[232:235], a[16:19], v[52:55]
  ds_read_b64_tr_b16 a[232:233], v179 offset:6144
  ds_read_b64_tr_b16 a[234:235], v179 offset:7168
  s_load_dwordx2 s[66:67], s[36:37], 0xc0000
  v_mfma_f32_16x16x32_bf16 v[52:55], a[192:195], a[24:27], v[52:55]
  s_barrier
  ds_read_b64_tr_b16 a[192:193], v178 offset:12288
  s_waitcnt vmcnt(21)
  v_mfma_f32_16x16x32_bf16 v[96:99], a[196:199], v[120:123], v[96:99]
  buffer_load_dwordx4 v[136:139], v188, s[4:7], s40 offen sc1
  v_mfma_f32_16x16x32_bf16 v[100:103], v[120:123], a[200:203], v[100:103]
  ds_read_b64_tr_b16 a[194:195], v178 offset:13312
  ds_read_b64_tr_b16 a[196:197], v178 offset:14336
  s_waitcnt lgkmcnt(13)
  v_mfma_f32_16x16x32_bf16 v[8:11], a[204:207], a[32:35], v[8:11]
  ds_read_b64_tr_b16 a[198:199], v178 offset:15360
  ds_read_b64_tr_b16 a[200:201], v179 offset:12288
  v_mfma_f32_16x16x32_bf16 v[8:11], a[208:211], a[40:43], v[8:11]
  ds_read_b64_tr_b16 a[202:203], v179 offset:13312
  v_mfma_f32_16x16x32_bf16 v[32:35], a[204:207], a[36:39], v[32:35]
  buffer_load_dwordx4 a[96:99], v187, s[4:7], s40 offen offset:0 sc1
  v_mfma_f32_16x16x32_bf16 v[32:35], a[208:211], a[44:47], v[32:35]
  ds_read_b64_tr_b16 a[204:205], v179 offset:14336
  ds_read_b64_tr_b16 a[206:207], v179 offset:15360
  v_mfma_f32_16x16x32_bf16 v[36:39], a[212:215], a[36:39], v[36:39]
  ds_read_b64_tr_b16 a[208:209], v183 offset:0
  ds_read_b64_tr_b16 a[210:211], v183 offset:1024
  s_waitcnt lgkmcnt(13)
  v_mfma_f32_16x16x32_bf16 v[36:39], a[216:219], a[44:47], v[36:39]
  v_mfma_f32_16x16x32_bf16 v[12:15], a[212:215], a[32:35], v[12:15]
  buffer_load_dwordx4 a[100:103], v187, s[4:7], s40 offen offset:1024 sc1
  s_mov_b32 s40, 2752512
  v_mfma_f32_16x16x32_bf16 v[12:15], a[216:219], a[40:43], v[12:15]
  ds_read_b64_tr_b16 a[212:213], v183 offset:8192
  ds_read_b64_tr_b16 a[214:215], v183 offset:9216
  v_mfma_f32_16x16x32_bf16 v[16:19], a[32:35], a[220:223], v[16:19]
  ds_read_b64_tr_b16 a[216:217], v178 offset:0
  ds_read_b64_tr_b16 a[218:219], v178 offset:1024
  s_load_dwordx2 s[66:67], s[36:37], 0xe0000
  s_add_u32 s36, s36, 0x100000
  s_addc_u32 s37, s37, 0
  v_mfma_f32_16x16x32_bf16 v[16:19], a[40:43], a[224:227], v[16:19]
  v_mfma_f32_16x16x32_bf16 v[40:43], a[36:39], a[220:223], v[40:43]
  buffer_load_dwordx4 a[104:107], v187, s[4:7], s40 offen offset:0 sc1
  v_mfma_f32_16x16x32_bf16 v[40:43], a[44:47], a[224:227], v[40:43]
  ds_read_b64_tr_b16 a[220:221], v178 offset:2048
  ds_read_b64_tr_b16 a[222:223], v178 offset:3072
  s_waitcnt lgkmcnt(13)
  v_mfma_f32_16x16x32_bf16 v[44:47], a[36:39], a[228:231], v[44:47]
  ds_read_b64_tr_b16 a[224:225], v179 offset:0
  ds_read_b64_tr_b16 a[226:227], v179 offset:1024
  v_mfma_f32_16x16x32_bf16 v[44:47], a[44:47], a[232:235], v[44:47]
  v_mfma_f32_16x16x32_bf16 v[20:23], a[32:35], a[228:231], v[20:23]
  buffer_load_dwordx4 a[108:111], v187, s[4:7], s40 offen offset:1024 sc1
  v_mfma_f32_16x16x32_bf16 v[20:23], a[40:43], a[232:235], v[20:23]
  ds_read_b64_tr_b16 a[228:229], v179 offset:2048
  ds_read_b64_tr_b16 a[230:231], v179 offset:3072
  s_mov_b32 s41, 2752512
  v_mfma_f32_16x16x32_bf16 v[0:3], a[192:195], a[32:35], v[0:3]
  ds_read_b64_tr_b16 a[232:233], v178 offset:8192
  ds_read_b64_tr_b16 a[234:235], v178 offset:9216
  s_add_u32 m0, s42, 30720
  s_waitcnt lgkmcnt(13)
  v_mfma_f32_16x16x32_bf16 v[0:3], a[196:199], a[40:43], v[0:3]
  v_mfma_f32_16x16x32_bf16 v[24:27], a[192:195], a[36:39], v[24:27]
  buffer_load_dwordx4 v185, s[80:83], s41 offen offset:2048 lds
  s_add_u32 m0, s42, 34752
  v_mfma_f32_16x16x32_bf16 v[24:27], a[196:199], a[44:47], v[24:27]
  ds_read_b64_tr_b16 a[192:193], v178 offset:10240
  ds_read_b64_tr_b16 a[194:195], v178 offset:11264
  v_mfma_f32_16x16x32_bf16 v[28:31], a[200:203], a[36:39], v[28:31]
  ds_read_b64_tr_b16 a[196:197], v179 offset:8192
  ds_read_b64_tr_b16 a[198:199], v179 offset:9216
  s_load_dwordx2 s[66:67], s[36:37], 0x0
  v_mfma_f32_16x16x32_bf16 v[28:31], a[204:207], a[44:47], v[28:31]
  v_mfma_f32_16x16x32_bf16 v[4:7], a[200:203], a[32:35], v[4:7]
  buffer_load_dwordx4 v185, s[80:83], s41 offen offset:2112 lds
  v_mfma_f32_16x16x32_bf16 v[4:7], a[204:207], a[40:43], v[4:7]
  s_barrier
  ds_read_b64_tr_b16 a[200:201], v179 offset:10240
  s_waitcnt lgkmcnt(13)
  v_mfma_f32_16x16x32_bf16 v[104:107], a[208:211], v[120:123], v[104:107]
  ds_read_b64_tr_b16 a[202:203], v179 offset:11264
  ds_read_b64_tr_b16 a[204:205], v178 offset:16384
  s_add_u32 m0, s42, 45056
  v_mfma_f32_16x16x32_bf16 v[108:111], v[120:123], a[212:215], v[108:111]
  ds_read_b64_tr_b16 a[206:207], v178 offset:17408
  ds_read_b64_tr_b16 a[208:209], v178 offset:18432
  v_mfma_f32_16x16x32_bf16 v[56:59], a[216:219], a[32:35], v[56:59]
  buffer_load_dwordx4 v186, s[80:83], s41 offen offset:0 lds
  s_add_u32 m0, s42, 53184
  s_waitcnt lgkmcnt(13)
  v_mfma_f32_16x16x32_bf16 v[56:59], a[220:223], a[40:43], v[56:59]
  ds_read_b64_tr_b16 a[210:211], v178 offset:19456
  ds_read_b64_tr_b16 a[212:213], v179 offset:16384
  v_mfma_f32_16x16x32_bf16 v[80:83], a[216:219], a[36:39], v[80:83]
  ds_read_b64_tr_b16 a[214:215], v179 offset:17408
  ds_read_b64_tr_b16 a[216:217], v179 offset:18432
  v_mfma_f32_16x16x32_bf16 v[80:83], a[220:223], a[44:47], v[80:83]
  ds_read_b64_tr_b16 a[218:219], v179 offset:19456
  ds_read_b64_tr_b16 a[220:221], v183 offset:20480
  v_mfma_f32_16x16x32_bf16 v[84:87], a[224:227], a[36:39], v[84:87]
  buffer_load_dwordx4 v186, s[80:83], s41 offen offset:64 lds
  s_waitcnt lgkmcnt(13)
  v_mfma_f32_16x16x32_bf16 v[84:87], a[228:231], a[44:47], v[84:87]
  ds_read_b64_tr_b16 a[222:223], v183 offset:21504
  s_add_u32 m0, s42, 40960
  v_mfma_f32_16x16x32_bf16 v[60:63], a[224:227], a[32:35], v[60:63]
  ds_read_b64_tr_b16 a[224:225], v183 offset:28672
  ds_read_b64_tr_b16 a[226:227], v183 offset:29696
  s_load_dwordx2 s[66:67], s[36:37], 0x20000
  v_mfma_f32_16x16x32_bf16 v[60:63], a[228:231], a[40:43], v[60:63]
  ds_read_b64_tr_b16 a[228:229], v178 offset:20480
  ds_read_b64_tr_b16 a[230:231], v178 offset:21504
  v_mfma_f32_16x16x32_bf16 v[64:67], a[32:35], a[232:235], v[64:67]
  buffer_load_dwordx4 v185, s[80:83], s41 offen offset:0 lds
  s_add_u32 m0, s42, 49088
  v_mfma_f32_16x16x32_bf16 v[64:67], a[40:43], a[192:195], v[64:67]
  v_mfma_f32_16x16x32_bf16 v[88:91], a[36:39], a[232:235], v[88:91]
  ds_read_b64_tr_b16 a[232:233], v178 offset:22528
  ds_read_b64_tr_b16 a[234:235], v178 offset:23552
  v_mfma_f32_16x16x32_bf16 v[88:91], a[44:47], a[192:195], v[88:91]
  ds_read_b64_tr_b16 a[192:193], v179 offset:20480
  ds_read_b64_tr_b16 a[194:195], v179 offset:21504
  s_waitcnt lgkmcnt(13)
  v_mfma_f32_16x16x32_bf16 v[92:95], a[36:39], a[196:199], v[92:95]
  buffer_load_dwordx4 v185, s[80:83], s41 offen offset:64 lds
  v_mfma_f32_16x16x32_bf16 v[92:95], a[44:47], a[200:203], v[92:95]
  s_mov_b32 s40, 2883584
  v_mfma_f32_16x16x32_bf16 v[68:71], a[32:35], a[196:199], v[68:71]
  ds_read_b64_tr_b16 a[196:197], v179 offset:22528
  ds_read_b64_tr_b16 a[198:199], v179 offset:23552
  v_mfma_f32_16x16x32_bf16 v[68:71], a[40:43], a[200:203], v[68:71]
  ds_read_b64_tr_b16 a[200:201], v178 offset:28672
  ds_read_b64_tr_b16 a[202:203], v178 offset:29696
  v_mfma_f32_16x16x32_bf16 v[48:51], a[204:207], a[32:35], v[48:51]
  buffer_load_dwordx4 v[140:143], v188, s[4:7], s40 offen sc1
  v_mfma_f32_16x16x32_bf16 v[48:51], a[208:211], a[40:43], v[48:51]
  v_mfma_f32_16x16x32_bf16 v[72:75], a[204:207], a[36:39], v[72:75]
  ds_read_b64_tr_b16 a[204:205], v178 offset:30720
  ds_read_b64_tr_b16 a[206:207], v178 offset:31744
  s_load_dwordx2 s[66:67], s[36:37], 0x40000
  v_mfma_f32_16x16x32_bf16 v[72:75], a[208:211], a[44:47], v[72:75]
  ds_read_b64_tr_b16 a[208:209], v179 offset:28672
  ds_read_b64_tr_b16 a[210:211], v179 offset:29696
  s_waitcnt lgkmcnt(13)
  v_mfma_f32_16x16x32_bf16 v[76:79], a[212:215], a[36:39], v[76:79]
  buffer_load_dwordx4 a[112:115], v187, s[4:7], s40 offen offset:0 sc1
  v_mfma_f32_16x16x32_bf16 v[76:79], a[216:219], a[44:47], v[76:79]
  v_mfma_f32_16x16x32_bf16 v[52:55], a[212:215], a[32:35], v[52:55]
  ds_read_b64_tr_b16 a[212:213], v179 offset:30720
  ds_read_b64_tr_b16 a[214:215], v179 offset:31744
  v_mfma_f32_16x16x32_bf16 v[52:55], a[216:219], a[40:43], v[52:55]
  s_barrier
  ds_read_b64_tr_b16 a[216:217], v178 offset:36864
  s_waitcnt vmcnt(29)
  v_mfma_f32_16x16x32_bf16 v[96:99], a[220:223], v[124:127], v[96:99]
  buffer_load_dwordx4 a[116:119], v187, s[4:7], s40 offen offset:1024 sc1
  s_mov_b32 s40, 3014656
  v_mfma_f32_16x16x32_bf16 v[100:103], v[124:127], a[224:227], v[100:103]
  ds_read_b64_tr_b16 a[218:219], v178 offset:37888
  ds_read_b64_tr_b16 a[220:221], v178 offset:38912
  s_waitcnt lgkmcnt(13)
  v_mfma_f32_16x16x32_bf16 v[8:11], a[228:231], a[48:51], v[8:11]
  ds_read_b64_tr_b16 a[222:223], v178 offset:39936
  ds_read_b64_tr_b16 a[224:225], v179 offset:36864
  v_mfma_f32_16x16x32_bf16 v[8:11], a[232:235], a[56:59], v[8:11]
  ds_read_b64_tr_b16 a[226:227], v179 offset:37888
  v_mfma_f32_16x16x32_bf16 v[32:35], a[228:231], a[52:55], v[32:35]
  buffer_load_dwordx4 a[120:123], v187, s[4:7], s40 offen offset:0 sc1
  v_mfma_f32_16x16x32_bf16 v[32:35], a[232:235], a[60:63], v[32:35]
  ds_read_b64_tr_b16 a[228:229], v179 offset:38912
  ds_read_b64_tr_b16 a[230:231], v179 offset:39936
  v_mfma_f32_16x16x32_bf16 v[36:39], a[192:195], a[52:55], v[36:39]
  ds_read_b64_tr_b16 a[232:233], v183 offset:24576
  ds_read_b64_tr_b16 a[234:235], v183 offset:25600
  s_load_dwordx2 s[66:67], s[36:37], 0x60000
  s_waitcnt lgkmcnt(13)
  v_mfma_f32_16x16x32_bf16 v[36:39], a[196:199], a[60:63], v[36:39]
  v_mfma_f32_16x16x32_bf16 v[12:15], a[192:195], a[48:51], v[12:15]
  buffer_load_dwordx4 a[124:127], v187, s[4:7], s40 offen offset:1024 sc1
  v_mfma_f32_16x16x32_bf16 v[12:15], a[196:199], a[56:59], v[12:15]
  ds_read_b64_tr_b16 a[192:193], v183 offset:32768
  ds_read_b64_tr_b16 a[194:195], v183 offset:33792
  s_mov_b32 s41, 3145728
  v_mfma_f32_16x16x32_bf16 v[16:19], a[48:51], a[200:203], v[16:19]
  ds_read_b64_tr_b16 a[196:197], v178 offset:24576
  ds_read_b64_tr_b16 a[198:199], v178 offset:25600
  s_add_u32 m0, s42, 55296
  v_mfma_f32_16x16x32_bf16 v[16:19], a[56:59], a[204:207], v[16:19]
  v_mfma_f32_16x16x32_bf16 v[40:43], a[52:55], a[200:203], v[40:43]
  buffer_load_dwordx4 v185, s[80:83], s41 offen offset:2048 lds
  s_add_u32 m0, s42, 59328
  v_mfma_f32_16x16x32_bf16 v[40:43], a[60:63], a[204:207], v[40:43]
  ds_read_b64_tr_b16 a[200:201], v178 offset:26624
  ds_read_b64_tr_b16 a[202:203], v178 offset:27648
  s_waitcnt lgkmcnt(13)
  v_mfma_f32_16x16x32_bf16 v[44:47], a[52:55], a[208:211], v[44:47]
  ds_read_b64_tr_b16 a[204:205], v179 offset:24576
  ds_read_b64_tr_b16 a[206:207], v179 offset:25600
  v_mfma_f32_16x16x32_bf16 v[44:47], a[60:63], a[212:215], v[44:47]
  v_mfma_f32_16x16x32_bf16 v[20:23], a[48:51], a[208:211], v[20:23]
  buffer_load_dwordx4 v185, s[80:83], s41 offen offset:2112 lds
  v_mfma_f32_16x16x32_bf16 v[20:23], a[56:59], a[212:215], v[20:23]
  ds_read_b64_tr_b16 a[208:209], v179 offset:26624
L_wk0_0:
  s_cbranch_vccnz L_wk0_4
  ds_read_b64_tr_b16 a[210:211], v179 offset:27648
  s_add_u32 m0, s42, 69632
  v_mfma_f32_16x16x32_bf16 v[0:3], a[216:219], a[48:51], v[0:3]
  ds_read_b64_tr_b16 a[212:213], v178 offset:32768
  ds_read_b64_tr_b16 a[214:215], v178 offset:33792
  s_load_dwordx2 s[66:67], s[36:37], 0x80000
  s_waitcnt lgkmcnt(13)
  v_mfma_f32_16x16x32_bf16 v[0:3], a[220:223], a[56:59], v[0:3]
  v_mfma_f32_16x16x32_bf16 v[24:27], a[216:219], a[52:55], v[24:27]
  buffer_load_dwordx4 v186, s[80:83], s41 offen offset:0 lds
  s_add_u32 m0, s42, 77760
  v_mfma_f32_16x16x32_bf16 v[24:27], a[220:223], a[60:63], v[24:27]
  ds_read_b64_tr_b16 a[216:217], v178 offset:34816
  ds_read_b64_tr_b16 a[218:219], v178 offset:35840
  v_mfma_f32_16x16x32_bf16 v[28:31], a[224:227], a[52:55], v[28:31]
  ds_read_b64_tr_b16 a[220:221], v179 offset:32768
  ds_read_b64_tr_b16 a[222:223], v179 offset:33792
  v_mfma_f32_16x16x32_bf16 v[28:31], a[228:231], a[60:63], v[28:31]
  v_mfma_f32_16x16x32_bf16 v[4:7], a[224:227], a[48:51], v[4:7]
  buffer_load_dwordx4 v186, s[80:83], s41 offen offset:64 lds
  v_mfma_f32_16x16x32_bf16 v[4:7], a[228:231], a[56:59], v[4:7]
  s_barrier
  ds_read_b64_tr_b16 a[224:225], v179 offset:34816
  s_waitcnt lgkmcnt(13)
  v_mfma_f32_16x16x32_bf16 v[104:107], a[232:235], v[124:127], v[104:107]
  ds_read_b64_tr_b16 a[226:227], v179 offset:35840
  ds_read_b64_tr_b16 a[228:229], v178 offset:40960
  s_add_u32 m0, s42, 65536
  v_mfma_f32_16x16x32_bf16 v[108:111], v[124:127], a[192:195], v[108:111]
  ds_read_b64_tr_b16 a[230:231], v178 offset:41984
  ds_read_b64_tr_b16 a[232:233], v178 offset:43008
  v_mfma_f32_16x16x32_bf16 v[56:59], a[196:199], a[48:51], v[56:59]
  buffer_load_dwordx4 v185, s[80:83], s41 offen offset:0 lds
  s_add_u32 m0, s42, 73664
  s_waitcnt lgkmcnt(13)
  v_mfma_f32_16x16x32_bf16 v[56:59], a[200:203], a[56:59], v[56:59]
  ds_read_b64_tr_b16 a[234:235], v178 offset:44032
  ds_read_b64_tr_b16 a[192:193], v179 offset:40960
  v_mfma_f32_16x16x32_bf16 v[80:83], a[196:199], a[52:55], v[80:83]
  ds_read_b64_tr_b16 a[194:195], v179 offset:41984
  ds_read_b64_tr_b16 a[196:197], v179 offset:43008
  s_load_dwordx2 s[66:67], s[36:37], 0xa0000
  v_mfma_f32_16x16x32_bf16 v[80:83], a[200:203], a[60:63], v[80:83]
  ds_read_b64_tr_b16 a[198:199], v179 offset:44032
  ds_read_b64_tr_b16 a[200:201], v183 offset:45056
  v_mfma_f32_16x16x32_bf16 v[84:87], a[204:207], a[52:55], v[84:87]
  buffer_load_dwordx4 v185, s[80:83], s41 offen offset:64 lds
  s_waitcnt lgkmcnt(13)
  v_mfma_f32_16x16x32_bf16 v[84:87], a[208:211], a[60:63], v[84:87]
  ds_read_b64_tr_b16 a[202:203], v183 offset:46080
  s_mov_b32 s41, 3538944
  s_add_u32 m0, s42, 79872
  v_mfma_f32_16x16x32_bf16 v[60:63], a[204:207], a[48:51], v[60:63]
  ds_read_b64_tr_b16 a[204:205], v183 offset:53248
  ds_read_b64_tr_b16 a[206:207], v183 offset:54272
  v_mfma_f32_16x16x32_bf16 v[60:63], a[208:211], a[56:59], v[60:63]
  ds_read_b64_tr_b16 a[208:209], v178 offset:45056
  ds_read_b64_tr_b16 a[210:211], v178 offset:46080
  v_mfma_f32_16x16x32_bf16 v[64:67], a[48:51], a[212:215], v[64:67]
  buffer_load_dwordx4 v185, s[80:83], s41 offen offset:2048 lds
  s_add_u32 m0, s42, 83904
  v_mfma_f32_16x16x32_bf16 v[64:67], a[56:59], a[216:219], v[64:67]
  v_mfma_f32_16x16x32_bf16 v[88:91], a[52:55], a[212:215], v[88:91]
  ds_read_b64_tr_b16 a[212:213], v178 offset:47104
  ds_read_b64_tr_b16 a[214:215], v178 offset:48128
  v_mfma_f32_16x16x32_bf16 v[88:91], a[60:63], a[216:219], v[88:91]
  ds_read_b64_tr_b16 a[216:217], v179 offset:45056
  ds_read_b64_tr_b16 a[218:219], v179 offset:46080
  s_waitcnt lgkmcnt(13)
  v_mfma_f32_16x16x32_bf16 v[92:95], a[52:55], a[220:223], v[92:95]
  buffer_load_dwordx4 v185, s[80:83], s41 offen offset:2112 lds
  v_mfma_f32_16x16x32_bf16 v[92:95], a[60:63], a[224:227], v[92:95]
  s_add_u32 m0, s42, 94208
  v_mfma_f32_16x16x32_bf16 v[68:71], a[48:51], a[220:223], v[68:71]
  ds_read_b64_tr_b16 a[220:221], v179 offset:47104
  ds_read_b64_tr_b16 a[222:223], v179 offset:48128
  s_load_dwordx2 s[66:67], s[36:37], 0xc0000
  v_mfma_f32_16x16x32_bf16 v[68:71], a[56:59], a[224:227], v[68:71]
  ds_read_b64_tr_b16 a[224:225], v178 offset:53248
  ds_read_b64_tr_b16 a[226:227], v178 offset:54272
  v_mfma_f32_16x16x32_bf16 v[48:51], a[228:231], a[48:51], v[48:51]
  buffer_load_dwordx4 v186, s[80:83], s41 offen offset:0 lds
  s_add_u32 m0, s42, 102336
  v_mfma_f32_16x16x32_bf16 v[48:51], a[232:235], a[56:59], v[48:51]
  v_mfma_f32_16x16x32_bf16 v[72:75], a[228:231], a[52:55], v[72:75]
  ds_read_b64_tr_b16 a[228:229], v178 offset:55296
  ds_read_b64_tr_b16 a[230:231], v178 offset:56320
  v_mfma_f32_16x16x32_bf16 v[72:75], a[232:235], a[60:63], v[72:75]
  ds_read_b64_tr_b16 a[232:233], v179 offset:53248
  ds_read_b64_tr_b16 a[234:235], v179 offset:54272
  s_waitcnt lgkmcnt(13)
  v_mfma_f32_16x16x32_bf16 v[76:79], a[192:195], a[52:55], v[76:79]
  buffer_load_dwordx4 v186, s[80:83], s41 offen offset:64 lds
  v_mfma_f32_16x16x32_bf16 v[76:79], a[196:199], a[60:63], v[76:79]
  s_mov_b32 s40, 3145728
  v_mfma_f32_16x16x32_bf16 v[52:55], a[192:195], a[48:51], v[52:55]
  ds_read_b64_tr_b16 a[192:193], v179 offset:55296
  ds_read_b64_tr_b16 a[194:195], v179 offset:56320
  v_mfma_f32_16x16x32_bf16 v[52:55], a[196:199], a[56:59], v[52:55]
  s_barrier
  ds_read_b64_tr_b16 a[196:197], v178 offset:61440
  s_waitcnt vmcnt(37)
  v_mfma_f32_16x16x32_bf16 v[96:99], a[200:203], v[128:131], v[96:99]
  buffer_load_dwordx4 v[144:147], v188, s[4:7], s40 offen sc1
  v_mfma_f32_16x16x32_bf16 v[100:103], v[128:131], a[204:207], v[100:103]
  ds_read_b64_tr_b16 a[198:199], v178 offset:62464
  ds_read_b64_tr_b16 a[200:201], v178 offset:63488
  s_waitcnt lgkmcnt(13)
  v_mfma_f32_16x16x32_bf16 v[8:11], a[208:211], a[64:67], v[8:11]
  ds_read_b64_tr_b16 a[202:203], v178 offset:64512
  ds_read_b64_tr_b16 a[204:205], v179 offset:61440
  s_load_dwordx2 s[66:67], s[36:37], 0xe0000
  v_mfma_f32_16x16x32_bf16 v[8:11], a[212:215], a[72:75], v[8:11]
  ds_read_b64_tr_b16 a[206:207], v179 offset:62464
  s_lshr_b32 s36, s22, 8
  s_lshl_b32 s36, s36, 7
  s_add_u32 s36, s36, 60
  s_add_u32 s36, s36, s56
  s_addc_u32 s37, s57, 0
  v_mfma_f32_16x16x32_bf16 v[32:35], a[208:211], a[68:71], v[32:35]
  buffer_load_dwordx4 a[128:131], v187, s[4:7], s40 offen offset:0 sc1
  v_mfma_f32_16x16x32_bf16 v[32:35], a[212:215], a[76:79], v[32:35]
  ds_read_b64_tr_b16 a[208:209], v179 offset:63488
  ds_read_b64_tr_b16 a[210:211], v179 offset:64512
  v_mfma_f32_16x16x32_bf16 v[36:39], a[216:219], a[68:71], v[36:39]
  ds_read_b64_tr_b16 a[212:213], v183 offset:49152
  ds_read_b64_tr_b16 a[214:215], v183 offset:50176
  s_waitcnt lgkmcnt(13)
  v_mfma_f32_16x16x32_bf16 v[36:39], a[220:223], a[76:79], v[36:39]
  v_mfma_f32_16x16x32_bf16 v[12:15], a[216:219], a[64:67], v[12:15]
  buffer_load_dwordx4 a[132:135], v187, s[4:7], s40 offen offset:1024 sc1
  s_mov_b32 s40, 3276800
  v_mfma_f32_16x16x32_bf16 v[12:15], a[220:223], a[72:75], v[12:15]
  ds_read_b64_tr_b16 a[216:217], v183 offset:57344
  ds_read_b64_tr_b16 a[218:219], v183 offset:58368
  v_mfma_f32_16x16x32_bf16 v[16:19], a[64:67], a[224:227], v[16:19]
  ds_read_b64_tr_b16 a[220:221], v178 offset:49152
  ds_read_b64_tr_b16 a[222:223], v178 offset:50176
  v_mfma_f32_16x16x32_bf16 v[16:19], a[72:75], a[228:231], v[16:19]
  v_mfma_f32_16x16x32_bf16 v[40:43], a[68:71], a[224:227], v[40:43]
  buffer_load_dwordx4 a[136:139], v187, s[4:7], s40 offen offset:0 sc1
  v_mfma_f32_16x16x32_bf16 v[40:43], a[76:79], a[228:231], v[40:43]
  ds_read_b64_tr_b16 a[224:225], v178 offset:51200
  ds_read_b64_tr_b16 a[226:227], v178 offset:52224
  s_waitcnt lgkmcnt(13)
  v_mfma_f32_16x16x32_bf16 v[44:47], a[68:71], a[232:235], v[44:47]
  ds_read_b64_tr_b16 a[228:229], v179 offset:49152
  ds_read_b64_tr_b16 a[230:231], v179 offset:50176
  v_mfma_f32_16x16x32_bf16 v[44:47], a[76:79], a[192:195], v[44:47]
  s_load_dwordx2 s[66:67], s[36:37], 0x0
  v_mfma_f32_16x16x32_bf16 v[20:23], a[64:67], a[232:235], v[20:23]
  buffer_load_dwordx4 a[140:143], v187, s[4:7], s40 offen offset:1024 sc1
  v_mfma_f32_16x16x32_bf16 v[20:23], a[72:75], a[192:195], v[20:23]
  ds_read_b64_tr_b16 a[232:233], v179 offset:51200
  ds_read_b64_tr_b16 a[234:235], v179 offset:52224
  s_add_u32 m0, s42, 90112
  v_mfma_f32_16x16x32_bf16 v[0:3], a[196:199], a[64:67], v[0:3]
  ds_read_b64_tr_b16 a[192:193], v178 offset:57344
  ds_read_b64_tr_b16 a[194:195], v178 offset:58368
  s_waitcnt lgkmcnt(13)
  v_mfma_f32_16x16x32_bf16 v[0:3], a[200:203], a[72:75], v[0:3]
  v_mfma_f32_16x16x32_bf16 v[24:27], a[196:199], a[68:71], v[24:27]
  buffer_load_dwordx4 v185, s[80:83], s41 offen offset:0 lds
  s_add_u32 m0, s42, 98240
  v_mfma_f32_16x16x32_bf16 v[24:27], a[200:203], a[76:79], v[24:27]
  ds_read_b64_tr_b16 a[196:197], v178 offset:59392
  ds_read_b64_tr_b16 a[198:199], v178 offset:60416
  v_mfma_f32_16x16x32_bf16 v[28:31], a[204:207], a[68:71], v[28:31]
  ds_read_b64_tr_b16 a[200:201], v179 offset:57344
  ds_read_b64_tr_b16 a[202:203], v179 offset:58368
  v_mfma_f32_16x16x32_bf16 v[28:31], a[208:211], a[76:79], v[28:31]
  v_mfma_f32_16x16x32_bf16 v[4:7], a[204:207], a[64:67], v[4:7]
  buffer_load_dwordx4 v185, s[80:83], s41 offen offset:64 lds
  v_mfma_f32_16x16x32_bf16 v[4:7], a[208:211], a[72:75], v[4:7]
  s_barrier
  ds_read_b64_tr_b16 a[204:205], v179 offset:59392
  s_waitcnt lgkmcnt(13)
  v_mfma_f32_16x16x32_bf16 v[104:107], a[212:215], v[128:131], v[104:107]
  ds_read_b64_tr_b16 a[206:207], v179 offset:60416
  ds_read_b64_tr_b16 a[208:209], v180 offset:0
  s_mov_b32 s41, 3932160
  v_mfma_f32_16x16x32_bf16 v[108:111], v[128:131], a[216:219], v[108:111]
  ds_read_b64_tr_b16 a[210:211], v180 offset:1024
  ds_read_b64_tr_b16 a[212:213], v180 offset:2048
  s_add_u32 m0, s42, 104448
  s_load_dwordx2 s[66:67], s[36:37], 0x10000
  v_mfma_f32_16x16x32_bf16 v[56:59], a[220:223], a[64:67], v[56:59]
  buffer_load_dwordx4 v185, s[80:83], s41 offen offset:2048 lds
  s_add_u32 m0, s42, 108480
  s_waitcnt lgkmcnt(13)
  v_mfma_f32_16x16x32_bf16 v[56:59], a[224:227], a[72:75], v[56:59]
  ds_read_b64_tr_b16 a[214:215], v180 offset:3072
  ds_read_b64_tr_b16 a[216:217], v181 offset:0
  v_mfma_f32_16x16x32_bf16 v[80:83], a[220:223], a[68:71], v[80:83]
  ds_read_b64_tr_b16 a[218:219], v181 offset:1024
  ds_read_b64_tr_b16 a[220:221], v181 offset:2048
  v_mfma_f32_16x16x32_bf16 v[80:83], a[224:227], a[76:79], v[80:83]
  ds_read_b64_tr_b16 a[222:223], v181 offset:3072
  ds_read_b64_tr_b16 a[224:225], v184 offset:4096
  v_mfma_f32_16x16x32_bf16 v[84:87], a[228:231], a[68:71], v[84:87]
  buffer_load_dwordx4 v185, s[80:83], s41 offen offset:2112 lds
  s_waitcnt lgkmcnt(13)
  v_mfma_f32_16x16x32_bf16 v[84:87], a[232:235], a[76:79], v[84:87]
  ds_read_b64_tr_b16 a[226:227], v184 offset:5120
  s_add_u32 m0, s42, 118784
  v_mfma_f32_16x16x32_bf16 v[60:63], a[228:231], a[64:67], v[60:63]
  ds_read_b64_tr_b16 a[228:229], v184 offset:12288
  ds_read_b64_tr_b16 a[230:231], v184 offset:13312
  v_mfma_f32_16x16x32_bf16 v[60:63], a[232:235], a[72:75], v[60:63]
  ds_read_b64_tr_b16 a[232:233], v180 offset:4096
  ds_read_b64_tr_b16 a[234:235], v180 offset:5120
  v_mfma_f32_16x16x32_bf16 v[64:67], a[64:67], a[192:195], v[64:67]
  buffer_load_dwordx4 v186, s[80:83], s41 offen offset:0 lds
  s_add_u32 m0, s42, 126912
  v_mfma_f32_16x16x32_bf16 v[64:67], a[72:75], a[196:199], v[64:67]
  v_mfma_f32_16x16x32_bf16 v[88:91], a[68:71], a[192:195], v[88:91]
  ds_read_b64_tr_b16 a[192:193], v180 offset:6144
  ds_read_b64_tr_b16 a[194:195], v180 offset:7168
  v_mfma_f32_16x16x32_bf16 v[88:91], a[76:79], a[196:199], v[88:91]
  ds_read_b64_tr_b16 a[196:197], v181 offset:4096
  ds_read_b64_tr_b16 a[198:199], v181 offset:5120
  s_load_dwordx2 s[66:67], s[36:37], 0x20000
  s_waitcnt lgkmcnt(13)
  v_mfma_f32_16x16x32_bf16 v[92:95], a[68:71], a[200:203], v[92:95]
  buffer_load_dwordx4 v186, s[80:83], s41 offen offset:64 lds
  v_mfma_f32_16x16x32_bf16 v[92:95], a[76:79], a[204:207], v[92:95]
  s_mov_b32 s40, 3407872
  v_mfma_f32_16x16x32_bf16 v[68:71], a[64:67], a[200:203], v[68:71]
  ds_read_b64_tr_b16 a[200:201], v181 offset:6144
  ds_read_b64_tr_b16 a[202:203], v181 offset:7168
  v_mfma_f32_16x16x32_bf16 v[68:71], a[72:75], a[204:207], v[68:71]
  ds_read_b64_tr_b16 a[204:205], v180 offset:12288
  ds_read_b64_tr_b16 a[206:207], v180 offset:13312
  v_mfma_f32_16x16x32_bf16 v[48:51], a[208:211], a[64:67], v[48:51]
  buffer_load_dwordx4 v[148:151], v188, s[4:7], s40 offen sc1
  v_mfma_f32_16x16x32_bf16 v[48:51], a[212:215], a[72:75], v[48:51]
  v_mfma_f32_16x16x32_bf16 v[72:75], a[208:211], a[68:71], v[72:75]
  ds_read_b64_tr_b16 a[208:209], v180 offset:14336
  ds_read_b64_tr_b16 a[210:211], v180 offset:15360
  v_mfma_f32_16x16x32_bf16 v[72:75], a[212:215], a[76:79], v[72:75]
  ds_read_b64_tr_b16 a[212:213], v181 offset:12288
  ds_read_b64_tr_b16 a[214:215], v181 offset:13312
  s_waitcnt lgkmcnt(13)
  v_mfma_f32_16x16x32_bf16 v[76:79], a[216:219], a[68:71], v[76:79]
  buffer_load_dwordx4 a[144:147], v187, s[4:7], s40 offen offset:0 sc1
  v_mfma_f32_16x16x32_bf16 v[76:79], a[220:223], a[76:79], v[76:79]
  v_mfma_f32_16x16x32_bf16 v[52:55], a[216:219], a[64:67], v[52:55]
  ds_read_b64_tr_b16 a[216:217], v181 offset:14336
  ds_read_b64_tr_b16 a[218:219], v181 offset:15360
  v_mfma_f32_16x16x32_bf16 v[52:55], a[220:223], a[72:75], v[52:55]
  s_barrier
  ds_read_b64_tr_b16 a[220:221], v180 offset:20480
  s_load_dwordx2 s[66:67], s[36:37], 0x30000
  s_waitcnt vmcnt(45)
  v_mfma_f32_16x16x32_bf16 v[96:99], a[224:227], v[132:135], v[96:99]
  buffer_load_dwordx4 a[148:151], v187, s[4:7], s40 offen offset:1024 sc1
  s_mov_b32 s40, 3538944
  v_mfma_f32_16x16x32_bf16 v[100:103], v[132:135], a[228:231], v[100:103]
  ds_read_b64_tr_b16 a[222:223], v180 offset:21504
  ds_read_b64_tr_b16 a[224:225], v180 offset:22528
  s_waitcnt lgkmcnt(13)
  v_mfma_f32_16x16x32_bf16 v[8:11], a[232:235], a[80:83], v[8:11]
  ds_read_b64_tr_b16 a[226:227], v180 offset:23552
  ds_read_b64_tr_b16 a[228:229], v181 offset:20480
  v_mfma_f32_16x16x32_bf16 v[8:11], a[192:195], a[88:91], v[8:11]
  ds_read_b64_tr_b16 a[230:231], v181 offset:21504
  v_mfma_f32_16x16x32_bf16 v[32:35], a[232:235], a[84:87], v[32:35]
  buffer_load_dwordx4 a[152:155], v187, s[4:7], s40 offen offset:0 sc1
  v_mfma_f32_16x16x32_bf16 v[32:35], a[192:195], a[92:95], v[32:35]
  ds_read_b64_tr_b16 a[232:233], v181 offset:22528
  ds_read_b64_tr_b16 a[234:235], v181 offset:23552
  v_mfma_f32_16x16x32_bf16 v[36:39], a[196:199], a[84:87], v[36:39]
  ds_read_b64_tr_b16 a[192:193], v184 offset:8192
  ds_read_b64_tr_b16 a[194:195], v184 offset:9216
  s_waitcnt lgkmcnt(13)
  v_mfma_f32_16x16x32_bf16 v[36:39], a[200:203], a[92:95], v[36:39]
  v_mfma_f32_16x16x32_bf16 v[12:15], a[196:199], a[80:83], v[12:15]
  buffer_load_dwordx4 a[156:159], v187, s[4:7], s40 offen offset:1024 sc1
  v_mfma_f32_16x16x32_bf16 v[12:15], a[200:203], a[88:91], v[12:15]
  ds_read_b64_tr_b16 a[196:197], v184 offset:16384
  ds_read_b64_tr_b16 a[198:199], v184 offset:17408
  s_add_u32 m0, s42, 114688
  v_mfma_f32_16x16x32_bf16 v[16:19], a[80:83], a[204:207], v[16:19]
  ds_read_b64_tr_b16 a[200:201], v180 offset:8192
  ds_read_b64_tr_b16 a[202:203], v180 offset:9216
  v_mfma_f32_16x16x32_bf16 v[16:19], a[88:91], a[208:211], v[16:19]
  s_load_dwordx2 s[66:67], s[36:37], 0x40000
  v_mfma_f32_16x16x32_bf16 v[40:43], a[84:87], a[204:207], v[40:43]
  buffer_load_dwordx4 v185, s[80:83], s41 offen offset:0 lds
  s_add_u32 m0, s42, 122816
  v_mfma_f32_16x16x32_bf16 v[40:43], a[92:95], a[208:211], v[40:43]
  ds_read_b64_tr_b16 a[204:205], v180 offset:10240
  ds_read_b64_tr_b16 a[206:207], v180 offset:11264
  s_waitcnt lgkmcnt(13)
  v_mfma_f32_16x16x32_bf16 v[44:47], a[84:87], a[212:215], v[44:47]
  ds_read_b64_tr_b16 a[208:209], v181 offset:8192
  ds_read_b64_tr_b16 a[210:211], v181 offset:9216
  v_mfma_f32_16x16x32_bf16 v[44:47], a[92:95], a[216:219], v[44:47]
  v_mfma_f32_16x16x32_bf16 v[20:23], a[80:83], a[212:215], v[20:23]
  buffer_load_dwordx4 v185, s[80:83], s41 offen offset:64 lds
  v_mfma_f32_16x16x32_bf16 v[20:23], a[88:91], a[216:219], v[20:23]
  ds_read_b64_tr_b16 a[212:213], v181 offset:10240
  ds_read_b64_tr_b16 a[214:215], v181 offset:11264
  s_mov_b32 s40, 3670016
  v_mfma_f32_16x16x32_bf16 v[0:3], a[220:223], a[80:83], v[0:3]
  ds_read_b64_tr_b16 a[216:217], v180 offset:16384
  ds_read_b64_tr_b16 a[218:219], v180 offset:17408
  s_waitcnt lgkmcnt(13)
  v_mfma_f32_16x16x32_bf16 v[0:3], a[224:227], a[88:91], v[0:3]
  v_mfma_f32_16x16x32_bf16 v[24:27], a[220:223], a[84:87], v[24:27]
  buffer_load_dwordx4 v[152:155], v188, s[4:7], s40 offen sc1
  v_mfma_f32_16x16x32_bf16 v[24:27], a[224:227], a[92:95], v[24:27]
  ds_read_b64_tr_b16 a[220:221], v180 offset:18432
  ds_read_b64_tr_b16 a[222:223], v180 offset:19456
  v_mfma_f32_16x16x32_bf16 v[28:31], a[228:231], a[84:87], v[28:31]
  ds_read_b64_tr_b16 a[224:225], v181 offset:16384
  ds_read_b64_tr_b16 a[226:227], v181 offset:17408
  v_mfma_f32_16x16x32_bf16 v[28:31], a[232:235], a[92:95], v[28:31]
  s_load_dwordx2 s[66:67], s[36:37], 0x50000
  v_mfma_f32_16x16x32_bf16 v[4:7], a[228:231], a[80:83], v[4:7]
  buffer_load_dwordx4 a[160:163], v187, s[4:7], s40 offen offset:0 sc1
  v_mfma_f32_16x16x32_bf16 v[4:7], a[232:235], a[88:91], v[4:7]
  s_waitcnt vmcnt(49)
  s_barrier
  ds_read_b64_tr_b16 a[228:229], v181 offset:18432
  s_waitcnt lgkmcnt(13)
  v_mfma_f32_16x16x32_bf16 v[104:107], a[192:195], v[132:135], v[104:107]
  ds_read_b64_tr_b16 a[230:231], v181 offset:19456
  ds_read_b64_tr_b16 a[232:233], v180 offset:24576
  v_mfma_f32_16x16x32_bf16 v[108:111], v[132:135], a[196:199], v[108:111]
  ds_read_b64_tr_b16 a[234:235], v180 offset:25600
  ds_read_b64_tr_b16 a[192:193], v180 offset:26624
  v_mfma_f32_16x16x32_bf16 v[56:59], a[200:203], a[80:83], v[56:59]
  buffer_load_dwordx4 a[164:167], v187, s[4:7], s40 offen offset:1024 sc1
  s_mov_b32 s40, 3801088
  s_waitcnt lgkmcnt(13)
  v_mfma_f32_16x16x32_bf16 v[56:59], a[204:207], a[88:91], v[56:59]
  ds_read_b64_tr_b16 a[194:195], v180 offset:27648
  ds_read_b64_tr_b16 a[196:197], v181 offset:24576
  v_mfma_f32_16x16x32_bf16 v[80:83], a[200:203], a[84:87], v[80:83]
  ds_read_b64_tr_b16 a[198:199], v181 offset:25600
  ds_read_b64_tr_b16 a[200:201], v181 offset:26624
  v_mfma_f32_16x16x32_bf16 v[80:83], a[204:207], a[92:95], v[80:83]
  ds_read_b64_tr_b16 a[202:203], v181 offset:27648
  ds_read_b64_tr_b16 a[204:205], v184 offset:28672
  v_mfma_f32_16x16x32_bf16 v[84:87], a[208:211], a[84:87], v[84:87]
  buffer_load_dwordx4 a[168:171], v187, s[4:7], s40 offen offset:0 sc1
  s_waitcnt lgkmcnt(13)
  v_mfma_f32_16x16x32_bf16 v[84:87], a[212:215], a[92:95], v[84:87]
  ds_read_b64_tr_b16 a[206:207], v184 offset:29696
  v_mfma_f32_16x16x32_bf16 v[60:63], a[208:211], a[80:83], v[60:63]
  ds_read_b64_tr_b16 a[208:209], v182 offset:20480
  ds_read_b64_tr_b16 a[210:211], v182 offset:21504
  v_mfma_f32_16x16x32_bf16 v[60:63], a[212:215], a[88:91], v[60:63]
  ds_read_b64_tr_b16 a[212:213], v180 offset:28672
  ds_read_b64_tr_b16 a[214:215], v180 offset:29696
  s_load_dwordx2 s[66:67], s[36:37], 0x60000
  v_mfma_f32_16x16x32_bf16 v[64:67], a[80:83], a[216:219], v[64:67]
  buffer_load_dwordx4 a[172:175], v187, s[4:7], s40 offen offset:1024 sc1
  v_mfma_f32_16x16x32_bf16 v[64:67], a[88:91], a[220:223], v[64:67]
  s_mov_b32 s41, 4325376
  s_add_u32 m0, s42, 129024
  v_mfma_f32_16x16x32_bf16 v[88:91], a[84:87], a[216:219], v[88:91]
  ds_read_b64_tr_b16 a[216:217], v180 offset:30720
  ds_read_b64_tr_b16 a[218:219], v180 offset:31744
  v_mfma_f32_16x16x32_bf16 v[88:91], a[92:95], a[220:223], v[88:91]
  ds_read_b64_tr_b16 a[220:221], v181 offset:28672
  ds_read_b64_tr_b16 a[222:223], v181 offset:29696
  s_waitcnt lgkmcnt(13)
  v_mfma_f32_16x16x32_bf16 v[92:95], a[84:87], a[224:227], v[92:95]
  buffer_load_dwordx4 v185, s[80:83], s41 offen offset:2048 lds
  s_add_u32 m0, s42, 133056
  v_mfma_f32_16x16x32_bf16 v[92:95], a[92:95], a[228:231], v[92:95]
  v_mfma_f32_16x16x32_bf16 v[68:71], a[80:83], a[224:227], v[68:71]
  ds_read_b64_tr_b16 a[224:225], v181 offset:30720
  ds_read_b64_tr_b16 a[226:227], v181 offset:31744
  v_mfma_f32_16x16x32_bf16 v[68:71], a[88:91], a[228:231], v[68:71]
  ds_read_b64_tr_b16 a[228:229], v176 offset:20480
  ds_read_b64_tr_b16 a[230:231], v176 offset:21504
  v_mfma_f32_16x16x32_bf16 v[48:51], a[232:235], a[80:83], v[48:51]
  buffer_load_dwordx4 v185, s[80:83], s41 offen offset:2112 lds
  v_mfma_f32_16x16x32_bf16 v[48:51], a[192:195], a[88:91], v[48:51]
  s_add_u32 m0, s42, 143360
  v_mfma_f32_16x16x32_bf16 v[72:75], a[232:235], a[84:87], v[72:75]
  ds_read_b64_tr_b16 a[232:233], v176 offset:22528
  ds_read_b64_tr_b16 a[234:235], v176 offset:23552
  v_mfma_f32_16x16x32_bf16 v[72:75], a[192:195], a[92:95], v[72:75]
  ds_read_b64_tr_b16 a[192:193], v177 offset:20480
  ds_read_b64_tr_b16 a[194:195], v177 offset:21504
  s_load_dwordx2 s[66:67], s[36:37], 0x70000
  s_waitcnt lgkmcnt(13)
  v_mfma_f32_16x16x32_bf16 v[76:79], a[196:199], a[84:87], v[76:79]
  buffer_load_dwordx4 v186, s[80:83], s41 offen offset:0 lds
  s_add_u32 m0, s42, 151488
  v_mfma_f32_16x16x32_bf16 v[76:79], a[200:203], a[92:95], v[76:79]
  v_mfma_f32_16x16x32_bf16 v[52:55], a[196:199], a[80:83], v[52:55]
  ds_read_b64_tr_b16 a[196:197], v177 offset:22528
  ds_read_b64_tr_b16 a[198:199], v177 offset:23552
  v_mfma_f32_16x16x32_bf16 v[52:55], a[200:203], a[88:91], v[52:55]
  s_waitcnt vmcnt(53)
  s_barrier
  ds_read_b64_tr_b16 a[200:201], v176 offset:16384
  s_waitcnt vmcnt(47)
  v_mfma_f32_16x16x32_bf16 v[96:99], a[204:207], v[136:139], v[96:99]
  buffer_load_dwordx4 v186, s[80:83], s41 offen offset:64 lds
  v_mfma_f32_16x16x32_bf16 v[100:103], v[136:139], a[208:211], v[100:103]
  ds_read_b64_tr_b16 a[202:203], v176 offset:17408
  ds_read_b64_tr_b16 a[204:205], v176 offset:18432
  s_add_u32 m0, s42, 139264
  s_waitcnt lgkmcnt(13)
  v_mfma_f32_16x16x32_bf16 v[8:11], a[212:215], a[96:99], v[8:11]
  ds_read_b64_tr_b16 a[206:207], v176 offset:19456
  ds_read_b64_tr_b16 a[208:209], v177 offset:16384
  v_mfma_f32_16x16x32_bf16 v[8:11], a[216:219], a[104:107], v[8:11]
  ds_read_b64_tr_b16 a[210:211], v177 offset:17408
  v_mfma_f32_16x16x32_bf16 v[32:35], a[212:215], a[100:103], v[32:35]
  buffer_load_dwordx4 v185, s[80:83], s41 offen offset:0 lds
  s_add_u32 m0, s42, 147392
  v_mfma_f32_16x16x32_bf16 v[32:35], a[216:219], a[108:111], v[32:35]
  ds_read_b64_tr_b16 a[212:213], v177 offset:18432
  ds_read_b64_tr_b16 a[214:215], v177 offset:19456
  v_mfma_f32_16x16x32_bf16 v[36:39], a[220:223], a[100:103], v[36:39]
  ds_read_b64_tr_b16 a[216:217], v182 offset:12288
  ds_read_b64_tr_b16 a[218:219], v182 offset:13312
  s_waitcnt lgkmcnt(13)
  v_mfma_f32_16x16x32_bf16 v[36:39], a[224:227], a[108:111], v[36:39]
  s_load_dwordx2 s[66:67], s[36:37], 0x80000
  v_mfma_f32_16x16x32_bf16 v[12:15], a[220:223], a[96:99], v[12:15]
  buffer_load_dwordx4 v185, s[80:83], s41 offen offset:64 lds
  v_mfma_f32_16x16x32_bf16 v[12:15], a[224:227], a[104:107], v[12:15]
  ds_read_b64_tr_b16 a[220:221], v182 offset:28672
  ds_read_b64_tr_b16 a[222:223], v182 offset:29696
  s_mov_b32 s40, 3932160
  v_mfma_f32_16x16x32_bf16 v[16:19], a[96:99], a[228:231], v[16:19]
  ds_read_b64_tr_b16 a[224:225], v176 offset:12288
  ds_read_b64_tr_b16 a[226:227], v176 offset:13312
  v_mfma_f32_16x16x32_bf16 v[16:19], a[104:107], a[232:235], v[16:19]
  v_mfma_f32_16x16x32_bf16 v[40:43], a[100:103], a[228:231], v[40:43]
  buffer_load_dwordx4 v[156:159], v188, s[4:7], s40 offen sc1
  v_mfma_f32_16x16x32_bf16 v[40:43], a[108:111], a[232:235], v[40:43]
  ds_read_b64_tr_b16 a[228:229], v176 offset:14336
  ds_read_b64_tr_b16 a[230:231], v176 offset:15360
  s_waitcnt lgkmcnt(13)
  v_mfma_f32_16x16x32_bf16 v[44:47], a[100:103], a[192:195], v[44:47]
  ds_read_b64_tr_b16 a[232:233], v177 offset:12288
  ds_read_b64_tr_b16 a[234:235], v177 offset:13312
  v_mfma_f32_16x16x32_bf16 v[44:47], a[108:111], a[196:199], v[44:47]
  v_mfma_f32_16x16x32_bf16 v[20:23], a[96:99], a[192:195], v[20:23]
  buffer_load_dwordx4 a[176:179], v187, s[4:7], s40 offen offset:0 sc1
  v_mfma_f32_16x16x32_bf16 v[20:23], a[104:107], a[196:199], v[20:23]
  ds_read_b64_tr_b16 a[192:193], v177 offset:14336
  ds_read_b64_tr_b16 a[194:195], v177 offset:15360
  v_mfma_f32_16x16x32_bf16 v[0:3], a[200:203], a[96:99], v[0:3]
  ds_read_b64_tr_b16 a[196:197], v176 offset:28672
  ds_read_b64_tr_b16 a[198:199], v176 offset:29696
  s_waitcnt lgkmcnt(13)
  v_mfma_f32_16x16x32_bf16 v[0:3], a[204:207], a[104:107], v[0:3]
  s_load_dwordx2 s[66:67], s[36:37], 0x90000
  v_mfma_f32_16x16x32_bf16 v[24:27], a[200:203], a[100:103], v[24:27]
  buffer_load_dwordx4 a[180:183], v187, s[4:7], s40 offen offset:1024 sc1
  s_mov_b32 s40, 4063232
  v_mfma_f32_16x16x32_bf16 v[24:27], a[204:207], a[108:111], v[24:27]
  ds_read_b64_tr_b16 a[200:201], v176 offset:30720
  ds_read_b64_tr_b16 a[202:203], v176 offset:31744
  v_mfma_f32_16x16x32_bf16 v[28:31], a[208:211], a[100:103], v[28:31]
  ds_read_b64_tr_b16 a[204:205], v177 offset:28672
  ds_read_b64_tr_b16 a[206:207], v177 offset:29696
  v_mfma_f32_16x16x32_bf16 v[28:31], a[212:215], a[108:111], v[28:31]
  v_mfma_f32_16x16x32_bf16 v[4:7], a[208:211], a[96:99], v[4:7]
  buffer_load_dwordx4 a[184:187], v187, s[4:7], s40 offen offset:0 sc1
  v_mfma_f32_16x16x32_bf16 v[4:7], a[212:215], a[104:107], v[4:7]
  s_waitcnt vmcnt(51)
  s_barrier
  ds_read_b64_tr_b16 a[208:209], v177 offset:30720
  s_waitcnt lgkmcnt(13)
  v_mfma_f32_16x16x32_bf16 v[104:107], a[216:219], v[136:139], v[104:107]
  ds_read_b64_tr_b16 a[210:211], v177 offset:31744
  ds_read_b64_tr_b16 a[212:213], v176 offset:24576
  v_mfma_f32_16x16x32_bf16 v[108:111], v[136:139], a[220:223], v[108:111]
  ds_read_b64_tr_b16 a[214:215], v176 offset:25600
  ds_read_b64_tr_b16 a[216:217], v176 offset:26624
  v_mfma_f32_16x16x32_bf16 v[56:59], a[224:227], a[96:99], v[56:59]
  buffer_load_dwordx4 a[188:191], v187, s[4:7], s40 offen offset:1024 sc1
  s_waitcnt lgkmcnt(13)
  v_mfma_f32_16x16x32_bf16 v[56:59], a[228:231], a[104:107], v[56:59]
  ds_read_b64_tr_b16 a[218:219], v176 offset:27648
  ds_read_b64_tr_b16 a[220:221], v177 offset:24576
  s_mov_b32 s41, 4718592
  v_mfma_f32_16x16x32_bf16 v[80:83], a[224:227], a[100:103], v[80:83]
  ds_read_b64_tr_b16 a[222:223], v177 offset:25600
  ds_read_b64_tr_b16 a[224:225], v177 offset:26624
  s_add_u32 m0, s42, 153600
  v_mfma_f32_16x16x32_bf16 v[80:83], a[228:231], a[108:111], v[80:83]
  ds_read_b64_tr_b16 a[226:227], v177 offset:27648
  ds_read_b64_tr_b16 a[228:229], v182 offset:32768
  s_load_dwordx2 s[66:67], s[36:37], 0xa0000
  v_mfma_f32_16x16x32_bf16 v[84:87], a[232:235], a[100:103], v[84:87]
  buffer_load_dwordx4 v185, s[80:83], s41 offen offset:2048 lds
  s_add_u32 m0, s42, 157632
  s_waitcnt lgkmcnt(13)
  v_mfma_f32_16x16x32_bf16 v[84:87], a[192:195], a[108:111], v[84:87]
  ds_read_b64_tr_b16 a[230:231], v182 offset:33792
  v_mfma_f32_16x16x32_bf16 v[60:63], a[232:235], a[96:99], v[60:63]
  ds_read_b64_tr_b16 a[232:233], v182 offset:45056
  ds_read_b64_tr_b16 a[234:235], v182 offset:46080
  v_mfma_f32_16x16x32_bf16 v[60:63], a[192:195], a[104:107], v[60:63]
  ds_read_b64_tr_b16 a[192:193], v176 offset:32768
  ds_read_b64_tr_b16 a[194:195], v176 offset:33792
  v_mfma_f32_16x16x32_bf16 v[64:67], a[96:99], a[196:199], v[64:67]
  buffer_load_dwordx4 v185, s[80:83], s41 offen offset:2112 lds
  v_mfma_f32_16x16x32_bf16 v[64:67], a[104:107], a[200:203], v[64:67]
  s_add_u32 m0, s42, 20480
  v_mfma_f32_16x16x32_bf16 v[88:91], a[100:103], a[196:199], v[88:91]
  ds_read_b64_tr_b16 a[196:197], v176 offset:34816
  ds_read_b64_tr_b16 a[198:199], v176 offset:35840
  v_mfma_f32_16x16x32_bf16 v[88:91], a[108:111], a[200:203], v[88:91]
  ds_read_b64_tr_b16 a[200:201], v177 offset:32768
  ds_read_b64_tr_b16 a[202:203], v177 offset:33792
  s_waitcnt lgkmcnt(13)
  v_mfma_f32_16x16x32_bf16 v[92:95], a[100:103], a[204:207], v[92:95]
  buffer_load_dwordx4 v186, s[80:83], s41 offen offset:0 lds
  s_add_u32 m0, s42, 16320
  v_mfma_f32_16x16x32_bf16 v[92:95], a[108:111], a[208:211], v[92:95]
  v_mfma_f32_16x16x32_bf16 v[68:71], a[96:99], a[204:207], v[68:71]
  ds_read_b64_tr_b16 a[204:205], v177 offset:34816
  ds_read_b64_tr_b16 a[206:207], v177 offset:35840
  v_mfma_f32_16x16x32_bf16 v[68:71], a[104:107], a[208:211], v[68:71]
  ds_read_b64_tr_b16 a[208:209], v176 offset:45056
  ds_read_b64_tr_b16 a[210:211], v176 offset:46080
  s_load_dwordx2 s[66:67], s[36:37], 0xb0000
  v_mfma_f32_16x16x32_bf16 v[48:51], a[212:215], a[96:99], v[48:51]
  buffer_load_dwordx4 v186, s[80:83], s41 offen offset:64 lds
  v_mfma_f32_16x16x32_bf16 v[48:51], a[216:219], a[104:107], v[48:51]
  s_mov_b32 s40, 4194304
  v_mfma_f32_16x16x32_bf16 v[72:75], a[212:215], a[100:103], v[72:75]
  ds_read_b64_tr_b16 a[212:213], v176 offset:47104
L_wk0_1:
  s_cbranch_vccnz L_wk0_5
  ds_read_b64_tr_b16 a[214:215], v176 offset:48128
  v_mfma_f32_16x16x32_bf16 v[72:75], a[216:219], a[108:111], v[72:75]
  ds_read_b64_tr_b16 a[216:217], v177 offset:45056
  ds_read_b64_tr_b16 a[218:219], v177 offset:46080
  s_waitcnt lgkmcnt(13)
  v_mfma_f32_16x16x32_bf16 v[76:79], a[220:223], a[100:103], v[76:79]
  buffer_load_dwordx4 v[160:163], v188, s[4:7], s40 offen sc1
  v_mfma_f32_16x16x32_bf16 v[76:79], a[224:227], a[108:111], v[76:79]
  v_mfma_f32_16x16x32_bf16 v[52:55], a[220:223], a[96:99], v[52:55]
  ds_read_b64_tr_b16 a[220:221], v177 offset:47104
  ds_read_b64_tr_b16 a[222:223], v177 offset:48128
  v_mfma_f32_16x16x32_bf16 v[52:55], a[224:227], a[104:107], v[52:55]
  s_waitcnt vmcnt(55)
  s_barrier
  ds_read_b64_tr_b16 a[224:225], v176 offset:40960
  s_waitcnt vmcnt(49)
  v_mfma_f32_16x16x32_bf16 v[96:99], a[228:231], v[140:143], v[96:99]
  buffer_load_dwordx4 a[0:3], v187, s[4:7], s40 offen offset:0 sc1
  v_mfma_f32_16x16x32_bf16 v[100:103], v[140:143], a[232:235], v[100:103]
  ds_read_b64_tr_b16 a[226:227], v176 offset:41984
  ds_read_b64_tr_b16 a[228:229], v176 offset:43008
  s_waitcnt lgkmcnt(13)
  v_mfma_f32_16x16x32_bf16 v[8:11], a[192:195], a[112:115], v[8:11]
  ds_read_b64_tr_b16 a[230:231], v176 offset:44032
  ds_read_b64_tr_b16 a[232:233], v177 offset:40960
  v_mfma_f32_16x16x32_bf16 v[8:11], a[196:199], a[120:123], v[8:11]
  ds_read_b64_tr_b16 a[234:235], v177 offset:41984
  s_load_dwordx2 s[66:67], s[36:37], 0xc0000
  v_mfma_f32_16x16x32_bf16 v[32:35], a[192:195], a[116:119], v[32:35]
  buffer_load_dwordx4 a[4:7], v187, s[4:7], s40 offen offset:1024 sc1
  s_mov_b32 s40, 4325376
  v_mfma_f32_16x16x32_bf16 v[32:35], a[196:199], a[124:127], v[32:35]
  ds_read_b64_tr_b16 a[192:193], v177 offset:43008
  ds_read_b64_tr_b16 a[194:195], v177 offset:44032
  v_mfma_f32_16x16x32_bf16 v[36:39], a[200:203], a[116:119], v[36:39]
  ds_read_b64_tr_b16 a[196:197], v182 offset:36864
  ds_read_b64_tr_b16 a[198:199], v182 offset:37888
  s_waitcnt lgkmcnt(13)
  v_mfma_f32_16x16x32_bf16 v[36:39], a[204:207], a[124:127], v[36:39]
  v_mfma_f32_16x16x32_bf16 v[12:15], a[200:203], a[112:115], v[12:15]
  buffer_load_dwordx4 a[8:11], v187, s[4:7], s40 offen offset:0 sc1
  v_mfma_f32_16x16x32_bf16 v[12:15], a[204:207], a[120:123], v[12:15]
  ds_read_b64_tr_b16 a[200:201], v182 offset:53248
  ds_read_b64_tr_b16 a[202:203], v182 offset:54272
  v_mfma_f32_16x16x32_bf16 v[16:19], a[112:115], a[208:211], v[16:19]
  ds_read_b64_tr_b16 a[204:205], v176 offset:36864
  ds_read_b64_tr_b16 a[206:207], v176 offset:37888
  v_mfma_f32_16x16x32_bf16 v[16:19], a[120:123], a[212:215], v[16:19]
  v_mfma_f32_16x16x32_bf16 v[40:43], a[116:119], a[208:211], v[40:43]
  buffer_load_dwordx4 a[12:15], v187, s[4:7], s40 offen offset:1024 sc1
  v_mfma_f32_16x16x32_bf16 v[40:43], a[124:127], a[212:215], v[40:43]
  ds_read_b64_tr_b16 a[208:209], v176 offset:38912
  ds_read_b64_tr_b16 a[210:211], v176 offset:39936
  s_add_u32 m0, s42, 12288
  s_waitcnt lgkmcnt(13)
  v_mfma_f32_16x16x32_bf16 v[44:47], a[116:119], a[216:219], v[44:47]
  ds_read_b64_tr_b16 a[212:213], v177 offset:36864
  ds_read_b64_tr_b16 a[214:215], v177 offset:37888
  v_mfma_f32_16x16x32_bf16 v[44:47], a[124:127], a[220:223], v[44:47]
  s_load_dwordx2 s[66:67], s[36:37], 0xd0000
  v_mfma_f32_16x16x32_bf16 v[20:23], a[112:115], a[216:219], v[20:23]
  buffer_load_dwordx4 v185, s[80:83], s41 offen offset:0 lds
  s_add_u32 m0, s42, 28608
  v_mfma_f32_16x16x32_bf16 v[20:23], a[120:123], a[220:223], v[20:23]
  ds_read_b64_tr_b16 a[216:217], v177 offset:38912
  ds_read_b64_tr_b16 a[218:219], v177 offset:39936
  v_mfma_f32_16x16x32_bf16 v[0:3], a[224:227], a[112:115], v[0:3]
  ds_read_b64_tr_b16 a[220:221], v176 offset:53248
  ds_read_b64_tr_b16 a[222:223], v176 offset:54272
  s_waitcnt lgkmcnt(13)
  v_mfma_f32_16x16x32_bf16 v[0:3], a[228:231], a[120:123], v[0:3]
  v_mfma_f32_16x16x32_bf16 v[24:27], a[224:227], a[116:119], v[24:27]
  buffer_load_dwordx4 v185, s[80:83], s41 offen offset:64 lds
  v_mfma_f32_16x16x32_bf16 v[24:27], a[228:231], a[124:127], v[24:27]
  ds_read_b64_tr_b16 a[224:225], v176 offset:55296
  ds_read_b64_tr_b16 a[226:227], v176 offset:56320
  s_mov_b32 s40, 4456448
  v_mfma_f32_16x16x32_bf16 v[28:31], a[232:235], a[116:119], v[28:31]
  ds_read_b64_tr_b16 a[228:229], v177 offset:53248
  ds_read_b64_tr_b16 a[230:231], v177 offset:54272
  v_mfma_f32_16x16x32_bf16 v[28:31], a[192:195], a[124:127], v[28:31]
  v_mfma_f32_16x16x32_bf16 v[4:7], a[232:235], a[112:115], v[4:7]
  buffer_load_dwordx4 v[164:167], v188, s[4:7], s40 offen sc1
  v_mfma_f32_16x16x32_bf16 v[4:7], a[192:195], a[120:123], v[4:7]
  s_waitcnt vmcnt(53)
  s_barrier
  ds_read_b64_tr_b16 a[232:233], v177 offset:55296
  s_waitcnt lgkmcnt(13)
  v_mfma_f32_16x16x32_bf16 v[104:107], a[196:199], v[140:143], v[104:107]
  ds_read_b64_tr_b16 a[234:235], v177 offset:56320
  ds_read_b64_tr_b16 a[192:193], v176 offset:49152
  v_mfma_f32_16x16x32_bf16 v[108:111], v[140:143], a[200:203], v[108:111]
  ds_read_b64_tr_b16 a[194:195], v176 offset:50176
  ds_read_b64_tr_b16 a[196:197], v176 offset:51200
  s_load_dwordx2 s[66:67], s[36:37], 0xe0000
  v_mfma_f32_16x16x32_bf16 v[56:59], a[204:207], a[112:115], v[56:59]
  buffer_load_dwordx4 a[16:19], v187, s[4:7], s40 offen offset:0 sc1
  s_waitcnt lgkmcnt(13)
  v_mfma_f32_16x16x32_bf16 v[56:59], a[208:211], a[120:123], v[56:59]
  ds_read_b64_tr_b16 a[198:199], v176 offset:52224
  ds_read_b64_tr_b16 a[200:201], v177 offset:49152
  v_mfma_f32_16x16x32_bf16 v[80:83], a[204:207], a[116:119], v[80:83]
  ds_read_b64_tr_b16 a[202:203], v177 offset:50176
  ds_read_b64_tr_b16 a[204:205], v177 offset:51200
  v_mfma_f32_16x16x32_bf16 v[80:83], a[208:211], a[124:127], v[80:83]
  ds_read_b64_tr_b16 a[206:207], v177 offset:52224
  ds_read_b64_tr_b16 a[208:209], v182 offset:57344
  v_mfma_f32_16x16x32_bf16 v[84:87], a[212:215], a[116:119], v[84:87]
  buffer_load_dwordx4 a[20:23], v187, s[4:7], s40 offen offset:1024 sc1
  s_mov_b32 s40, 4587520
  s_waitcnt lgkmcnt(13)
  v_mfma_f32_16x16x32_bf16 v[84:87], a[216:219], a[124:127], v[84:87]
  ds_read_b64_tr_b16 a[210:211], v182 offset:58368
  v_mfma_f32_16x16x32_bf16 v[60:63], a[212:215], a[112:115], v[60:63]
  ds_read_b64_tr_b16 a[212:213], v183 offset:4096
  ds_read_b64_tr_b16 a[214:215], v183 offset:5120
  v_mfma_f32_16x16x32_bf16 v[60:63], a[216:219], a[120:123], v[60:63]
  ds_read_b64_tr_b16 a[216:217], v176 offset:57344
  ds_read_b64_tr_b16 a[218:219], v176 offset:58368
  v_mfma_f32_16x16x32_bf16 v[64:67], a[112:115], a[220:223], v[64:67]
  buffer_load_dwordx4 a[24:27], v187, s[4:7], s40 offen offset:0 sc1
  v_mfma_f32_16x16x32_bf16 v[64:67], a[120:123], a[224:227], v[64:67]
  v_mfma_f32_16x16x32_bf16 v[88:91], a[116:119], a[220:223], v[88:91]
  ds_read_b64_tr_b16 a[220:221], v176 offset:59392
  ds_read_b64_tr_b16 a[222:223], v176 offset:60416
  v_mfma_f32_16x16x32_bf16 v[88:91], a[124:127], a[224:227], v[88:91]
  ds_read_b64_tr_b16 a[224:225], v177 offset:57344
  ds_read_b64_tr_b16 a[226:227], v177 offset:58368
  s_load_dwordx2 s[66:67], s[36:37], 0xf0000
  s_add_u32 s36, s36, 0x100000
  s_addc_u32 s37, s37, 0
  s_waitcnt lgkmcnt(13)
  v_mfma_f32_16x16x32_bf16 v[92:95], a[116:119], a[228:231], v[92:95]
  buffer_load_dwordx4 a[28:31], v187, s[4:7], s40 offen offset:1024 sc1
  v_mfma_f32_16x16x32_bf16 v[92:95], a[124:127], a[232:235], v[92:95]
  s_mov_b32 s41, 5111808
  s_add_u32 m0, s42, 22528
  v_mfma_f32_16x16x32_bf16 v[68:71], a[112:115], a[228:231], v[68:71]
  ds_read_b64_tr_b16 a[228:229], v177 offset:59392
  ds_read_b64_tr_b16 a[230:231], v177 offset:60416
  v_mfma_f32_16x16x32_bf16 v[68:71], a[120:123], a[232:235], v[68:71]
  ds_read_b64_tr_b16 a[232:233], v178 offset:4096
  ds_read_b64_tr_b16 a[234:235], v178 offset:5120
  v_mfma_f32_16x16x32_bf16 v[48:51], a[192:195], a[112:115], v[48:51]
  buffer_load_dwordx4 v185, s[80:83], s41 offen offset:2048 lds
  s_add_u32 m0, s42, 30656
  v_mfma_f32_16x16x32_bf16 v[48:51], a[196:199], a[120:123], v[48:51]
  v_mfma_f32_16x16x32_bf16 v[72:75], a[192:195], a[116:119], v[72:75]
  ds_read_b64_tr_b16 a[192:193], v178 offset:6144
  ds_read_b64_tr_b16 a[194:195], v178 offset:7168
  v_mfma_f32_16x16x32_bf16 v[72:75], a[196:199], a[124:127], v[72:75]
  ds_read_b64_tr_b16 a[196:197], v179 offset:4096
  ds_read_b64_tr_b16 a[198:199], v179 offset:5120
  s_waitcnt lgkmcnt(13)
  v_mfma_f32_16x16x32_bf16 v[76:79], a[200:203], a[116:119], v[76:79]
  buffer_load_dwordx4 v185, s[80:83], s41 offen offset:2112 lds
  v_mfma_f32_16x16x32_bf16 v[76:79], a[204:207], a[124:127], v[76:79]
  s_add_u32 m0, s42, 45056
  v_mfma_f32_16x16x32_bf16 v[52:55], a[200:203], a[112:115], v[52:55]
  ds_read_b64_tr_b16 a[200:201], v179 offset:6144
  ds_read_b64_tr_b16 a[202:203], v179 offset:7168
  v_mfma_f32_16x16x32_bf16 v[52:55], a[204:207], a[120:123], v[52:55]
  s_waitcnt vmcnt(53)
  s_barrier
  ds_read_b64_tr_b16 a[204:205], v178 offset:0
  s_load_dwordx2 s[66:67], s[36:37], 0x0
  s_waitcnt vmcnt(47)
  v_mfma_f32_16x16x32_bf16 v[96:99], a[208:211], v[144:147], v[96:99]
  buffer_load_dwordx4 v186, s[80:83], s41 offen offset:0 lds
  s_add_u32 m0, s42, 40896
  v_mfma_f32_16x16x32_bf16 v[100:103], v[144:147], a[212:215], v[100:103]
  ds_read_b64_tr_b16 a[206:207], v178 offset:1024
  ds_read_b64_tr_b16 a[208:209], v178 offset:2048
  s_waitcnt lgkmcnt(13)
  v_mfma_f32_16x16x32_bf16 v[8:11], a[216:219], a[128:131], v[8:11]
  ds_read_b64_tr_b16 a[210:211], v178 offset:3072
  ds_read_b64_tr_b16 a[212:213], v179 offset:0
  v_mfma_f32_16x16x32_bf16 v[8:11], a[220:223], a[136:139], v[8:11]
  ds_read_b64_tr_b16 a[214:215], v179 offset:1024
  v_mfma_f32_16x16x32_bf16 v[32:35], a[216:219], a[132:135], v[32:35]
  buffer_load_dwordx4 v186, s[80:83], s41 offen offset:64 lds
  v_mfma_f32_16x16x32_bf16 v[32:35], a[220:223], a[140:143], v[32:35]
  ds_read_b64_tr_b16 a[216:217], v179 offset:2048
  ds_read_b64_tr_b16 a[218:219], v179 offset:3072
  s_add_u32 m0, s42, 36864
  v_mfma_f32_16x16x32_bf16 v[36:39], a[224:227], a[132:135], v[36:39]
  ds_read_b64_tr_b16 a[220:221], v183 offset:16384
  ds_read_b64_tr_b16 a[222:223], v183 offset:17408
  s_waitcnt lgkmcnt(13)
  v_mfma_f32_16x16x32_bf16 v[36:39], a[228:231], a[140:143], v[36:39]
  v_mfma_f32_16x16x32_bf16 v[12:15], a[224:227], a[128:131], v[12:15]
  buffer_load_dwordx4 v185, s[80:83], s41 offen offset:0 lds
  s_add_u32 m0, s42, 53184
  v_mfma_f32_16x16x32_bf16 v[12:15], a[228:231], a[136:139], v[12:15]
  ds_read_b64_tr_b16 a[224:225], v183 offset:28672
  ds_read_b64_tr_b16 a[226:227], v183 offset:29696
  v_mfma_f32_16x16x32_bf16 v[16:19], a[128:131], a[232:235], v[16:19]
  ds_read_b64_tr_b16 a[228:229], v178 offset:16384
  ds_read_b64_tr_b16 a[230:231], v178 offset:17408
  v_mfma_f32_16x16x32_bf16 v[16:19], a[136:139], a[192:195], v[16:19]
  s_load_dwordx2 s[66:67], s[36:37], 0x10000
  v_mfma_f32_16x16x32_bf16 v[40:43], a[132:135], a[232:235], v[40:43]
  buffer_load_dwordx4 v185, s[80:83], s41 offen offset:64 lds
  v_mfma_f32_16x16x32_bf16 v[40:43], a[140:143], a[192:195], v[40:43]
  ds_read_b64_tr_b16 a[232:233], v178 offset:18432
  ds_read_b64_tr_b16 a[234:235], v178 offset:19456
  s_mov_b32 s40, 4718592
  s_waitcnt lgkmcnt(13)
  v_mfma_f32_16x16x32_bf16 v[44:47], a[132:135], a[196:199], v[44:47]
  ds_read_b64_tr_b16 a[192:193], v179 offset:16384
  ds_read_b64_tr_b16 a[194:195], v179 offset:17408
  v_mfma_f32_16x16x32_bf16 v[44:47], a[140:143], a[200:203], v[44:47]
  v_mfma_f32_16x16x32_bf16 v[20:23], a[128:131], a[196:199], v[20:23]
  buffer_load_dwordx4 v[168:171], v188, s[4:7], s40 offen sc1
  v_mfma_f32_16x16x32_bf16 v[20:23], a[136:139], a[200:203], v[20:23]
  ds_read_b64_tr_b16 a[196:197], v179 offset:18432
  ds_read_b64_tr_b16 a[198:199], v179 offset:19456
  v_mfma_f32_16x16x32_bf16 v[0:3], a[204:207], a[128:131], v[0:3]
  ds_read_b64_tr_b16 a[200:201], v178 offset:28672
  ds_read_b64_tr_b16 a[202:203], v178 offset:29696
  s_waitcnt lgkmcnt(13)
  v_mfma_f32_16x16x32_bf16 v[0:3], a[208:211], a[136:139], v[0:3]
  v_mfma_f32_16x16x32_bf16 v[24:27], a[204:207], a[132:135], v[24:27]
  buffer_load_dwordx4 a[32:35], v187, s[4:7], s40 offen offset:0 sc1
  v_mfma_f32_16x16x32_bf16 v[24:27], a[208:211], a[140:143], v[24:27]
  ds_read_b64_tr_b16 a[204:205], v178 offset:30720
  ds_read_b64_tr_b16 a[206:207], v178 offset:31744
  v_mfma_f32_16x16x32_bf16 v[28:31], a[212:215], a[132:135], v[28:31]
  ds_read_b64_tr_b16 a[208:209], v179 offset:28672
  ds_read_b64_tr_b16 a[210:211], v179 offset:29696
  v_mfma_f32_16x16x32_bf16 v[28:31], a[216:219], a[140:143], v[28:31]
  s_load_dwordx2 s[66:67], s[36:37], 0x20000
  v_mfma_f32_16x16x32_bf16 v[4:7], a[212:215], a[128:131], v[4:7]
  buffer_load_dwordx4 a[36:39], v187, s[4:7], s40 offen offset:1024 sc1
  s_mov_b32 s40, 4849664
  v_mfma_f32_16x16x32_bf16 v[4:7], a[216:219], a[136:139], v[4:7]
  s_waitcnt vmcnt(49)
  s_barrier
  ds_read_b64_tr_b16 a[212:213], v179 offset:30720
  s_waitcnt vmcnt(43) lgkmcnt(13)
  v_mfma_f32_16x16x32_bf16 v[96:99], a[220:223], v[148:151], v[96:99]
  ds_read_b64_tr_b16 a[214:215], v179 offset:31744
  ds_read_b64_tr_b16 a[216:217], v178 offset:24576
  v_mfma_f32_16x16x32_bf16 v[100:103], v[148:151], a[224:227], v[100:103]
  ds_read_b64_tr_b16 a[218:219], v178 offset:25600
  ds_read_b64_tr_b16 a[220:221], v178 offset:26624
  v_mfma_f32_16x16x32_bf16 v[8:11], a[228:231], a[144:147], v[8:11]
  buffer_load_dwordx4 a[40:43], v187, s[4:7], s40 offen offset:0 sc1
  s_waitcnt lgkmcnt(13)
  v_mfma_f32_16x16x32_bf16 v[8:11], a[232:235], a[152:155], v[8:11]
  ds_read_b64_tr_b16 a[222:223], v178 offset:27648
  ds_read_b64_tr_b16 a[224:225], v179 offset:24576
  v_mfma_f32_16x16x32_bf16 v[32:35], a[228:231], a[148:151], v[32:35]
  ds_read_b64_tr_b16 a[226:227], v179 offset:25600
  ds_read_b64_tr_b16 a[228:229], v179 offset:26624
  v_mfma_f32_16x16x32_bf16 v[32:35], a[232:235], a[156:159], v[32:35]
  ds_read_b64_tr_b16 a[230:231], v179 offset:27648
  ds_read_b64_tr_b16 a[232:233], v183 offset:40960
  v_mfma_f32_16x16x32_bf16 v[36:39], a[192:195], a[148:151], v[36:39]
  buffer_load_dwordx4 a[44:47], v187, s[4:7], s40 offen offset:1024 sc1
  s_waitcnt lgkmcnt(13)
  v_mfma_f32_16x16x32_bf16 v[36:39], a[196:199], a[156:159], v[36:39]
  ds_read_b64_tr_b16 a[234:235], v183 offset:41984
  s_mov_b32 s41, 5505024
  s_add_u32 m0, s42, 47104
  v_mfma_f32_16x16x32_bf16 v[12:15], a[192:195], a[144:147], v[12:15]
  ds_read_b64_tr_b16 a[192:193], v183 offset:53248
  ds_read_b64_tr_b16 a[194:195], v183 offset:54272
  v_mfma_f32_16x16x32_bf16 v[12:15], a[196:199], a[152:155], v[12:15]
  ds_read_b64_tr_b16 a[196:197], v178 offset:40960
  ds_read_b64_tr_b16 a[198:199], v178 offset:41984
  s_load_dwordx2 s[66:67], s[36:37], 0x30000
  v_mfma_f32_16x16x32_bf16 v[16:19], a[144:147], a[200:203], v[16:19]
  buffer_load_dwordx4 v185, s[80:83], s41 offen offset:2048 lds
  s_add_u32 m0, s42, 55232
  v_mfma_f32_16x16x32_bf16 v[16:19], a[152:155], a[204:207], v[16:19]
  v_mfma_f32_16x16x32_bf16 v[40:43], a[148:151], a[200:203], v[40:43]
  ds_read_b64_tr_b16 a[200:201], v178 offset:43008
  ds_read_b64_tr_b16 a[202:203], v178 offset:44032
  v_mfma_f32_16x16x32_bf16 v[40:43], a[156:159], a[204:207], v[40:43]
  ds_read_b64_tr_b16 a[204:205], v179 offset:40960
  ds_read_b64_tr_b16 a[206:207], v179 offset:41984
  s_waitcnt lgkmcnt(13)
  v_mfma_f32_16x16x32_bf16 v[44:47], a[148:151], a[208:211], v[44:47]
  buffer_load_dwordx4 v185, s[80:83], s41 offen offset:2112 lds
  v_mfma_f32_16x16x32_bf16 v[44:47], a[156:159], a[212:215], v[44:47]
  s_add_u32 m0, s42, 69632
  v_mfma_f32_16x16x32_bf16 v[20:23], a[144:147], a[208:211], v[20:23]
  ds_read_b64_tr_b16 a[208:209], v179 offset:43008
  ds_read_b64_tr_b16 a[210:211], v179 offset:44032
  v_mfma_f32_16x16x32_bf16 v[20:23], a[152:155], a[212:215], v[20:23]
  ds_read_b64_tr_b16 a[212:213], v178 offset:53248
  ds_read_b64_tr_b16 a[214:215], v178 offset:54272
  v_mov_b32 v200, -1
  v_mfma_f32_16x16x32_bf16 v[0:3], a[216:219], a[144:147], v[0:3]
  buffer_load_dwordx4 v186, s[80:83], s41 offen offset:0 lds
  s_add_u32 m0, s42, 65472
  v_mfma_f32_16x16x32_bf16 v[0:3], a[220:223], a[152:155], v[0:3]
  v_mov_b32 v201, -1
  v_mov_b32 v202, -1
  v_mov_b32 v203, -1
  v_mfma_f32_16x16x32_bf16 v[24:27], a[216:219], a[148:151], v[24:27]
  ds_read_b64_tr_b16 a[216:217], v178 offset:55296
  ds_read_b64_tr_b16 a[218:219], v178 offset:56320
  v_lshlrev_b32 v204, 2, v224
  v_mfma_f32_16x16x32_bf16 v[24:27], a[220:223], a[156:159], v[24:27]
  ds_read_b64_tr_b16 a[220:221], v179 offset:53248
  ds_read_b64_tr_b16 a[222:223], v179 offset:54272
  s_load_dwordx2 s[66:67], s[36:37], 0x40000
  s_waitcnt lgkmcnt(13)
  v_mfma_f32_16x16x32_bf16 v[28:31], a[224:227], a[148:151], v[28:31]
  buffer_load_dwordx4 v186, s[80:83], s41 offen offset:64 lds
  v_mfma_f32_16x16x32_bf16 v[28:31], a[228:231], a[156:159], v[28:31]
  s_mov_b32 s40, 4980736
  s_sub_u32 s30, s78, 0x500000
  s_lshr_b32 s31, s30, 18
  s_lshl_b32 s31, s31, 17
  s_bfe_u32 s32, s30, 0x10011
  s_lshl_b32 s32, s32, 10
  s_add_u32 s31, s31, s32
  s_add_u32 s31, s31, 0x900000
  s_cmp_lt_u32 s30, 0x80000
  s_cselect_b32 s31, s31, 0x40000000
  buffer_store_dwordx4 v[200:203], v187, s[4:7], s31 offen sc1
  v_mfma_f32_16x16x32_bf16 v[4:7], a[224:227], a[144:147], v[4:7]
  ds_read_b64_tr_b16 a[224:225], v179 offset:55296
  ds_read_b64_tr_b16 a[226:227], v179 offset:56320
  v_mfma_f32_16x16x32_bf16 v[4:7], a[228:231], a[152:155], v[4:7]
  s_waitcnt vmcnt(40)
  s_barrier
  ds_read_b64_tr_b16 a[228:229], v178 offset:49152
  v_mfma_f32_16x16x32_bf16 v[96:99], a[232:235], v[152:155], v[96:99]
  buffer_load_dwordx4 v[172:175], v188, s[4:7], s40 offen sc1
  v_mfma_f32_16x16x32_bf16 v[100:103], v[152:155], a[192:195], v[100:103]
  ds_read_b64_tr_b16 a[230:231], v178 offset:50176
  ds_read_b64_tr_b16 a[232:233], v178 offset:51200
  s_waitcnt lgkmcnt(13)
  v_mfma_f32_16x16x32_bf16 v[8:11], a[196:199], a[160:163], v[8:11]
  ds_read_b64_tr_b16 a[234:235], v178 offset:52224
  ds_read_b64_tr_b16 a[192:193], v179 offset:49152
  v_mfma_f32_16x16x32_bf16 v[8:11], a[200:203], a[168:171], v[8:11]
  ds_read_b64_tr_b16 a[194:195], v179 offset:50176
  buffer_store_dword v200, v204, s[4:7], s89 offen sc1
  v_mfma_f32_16x16x32_bf16 v[32:35], a[196:199], a[164:167], v[32:35]
  ds_read_b64_tr_b16 a[196:197], v179 offset:51200
  ds_read_b64_tr_b16 a[198:199], v179 offset:52224
  v_mfma_f32_16x16x32_bf16 v[32:35], a[200:203], a[172:175], v[32:35]
  buffer_load_dwordx4 a[48:51], v187, s[4:7], s40 offen offset:0 sc1
  v_mfma_f32_16x16x32_bf16 v[36:39], a[204:207], a[164:167], v[36:39]
  ds_read_b64_tr_b16 a[200:201], v184 offset:0
  ds_read_b64_tr_b16 a[202:203], v184 offset:1024
  s_waitcnt lgkmcnt(13)
  v_mfma_f32_16x16x32_bf16 v[36:39], a[208:211], a[172:175], v[36:39]
  s_load_dwordx2 s[66:67], s[36:37], 0x50000
  v_mfma_f32_16x16x32_bf16 v[12:15], a[204:207], a[160:163], v[12:15]
  buffer_load_dwordx4 a[52:55], v187, s[4:7], s40 offen offset:1024 sc1
  s_mov_b32 s40, 5111808
  v_mfma_f32_16x16x32_bf16 v[12:15], a[208:211], a[168:171], v[12:15]
  ds_read_b64_tr_b16 a[204:205], v184 offset:12288
  ds_read_b64_tr_b16 a[206:207], v184 offset:13312
  v_mfma_f32_16x16x32_bf16 v[16:19], a[160:163], a[212:215], v[16:19]
  ds_read_b64_tr_b16 a[208:209], v180 offset:0
  ds_read_b64_tr_b16 a[210:211], v180 offset:1024
  v_mfma_f32_16x16x32_bf16 v[16:19], a[168:171], a[216:219], v[16:19]
  v_mfma_f32_16x16x32_bf16 v[40:43], a[164:167], a[212:215], v[40:43]
  buffer_load_dwordx4 a[56:59], v187, s[4:7], s40 offen offset:0 sc1
  v_mfma_f32_16x16x32_bf16 v[40:43], a[172:175], a[216:219], v[40:43]
  ds_read_b64_tr_b16 a[212:213], v180 offset:2048
  ds_read_b64_tr_b16 a[214:215], v180 offset:3072
  s_waitcnt lgkmcnt(13)
  v_mfma_f32_16x16x32_bf16 v[44:47], a[164:167], a[220:223], v[44:47]
  ds_read_b64_tr_b16 a[216:217], v181 offset:0
  ds_read_b64_tr_b16 a[218:219], v181 offset:1024
  v_mfma_f32_16x16x32_bf16 v[44:47], a[172:175], a[224:227], v[44:47]
  v_mfma_f32_16x16x32_bf16 v[20:23], a[160:163], a[220:223], v[20:23]
  buffer_load_dwordx4 a[60:63], v187, s[4:7], s40 offen offset:1024 sc1
  v_mfma_f32_16x16x32_bf16 v[20:23], a[168:171], a[224:227], v[20:23]
  ds_read_b64_tr_b16 a[220:221], v181 offset:2048
  ds_read_b64_tr_b16 a[222:223], v181 offset:3072
  s_add_u32 m0, s42, 81920
  v_mfma_f32_16x16x32_bf16 v[0:3], a[228:231], a[160:163], v[0:3]
  ds_read_b64_tr_b16 a[224:225], v180 offset:12288
  ds_read_b64_tr_b16 a[226:227], v180 offset:13312
  s_waitcnt lgkmcnt(13)
  v_mfma_f32_16x16x32_bf16 v[0:3], a[232:235], a[168:171], v[0:3]
  s_load_dwordx2 s[66:67], s[36:37], 0x60000
  v_mfma_f32_16x16x32_bf16 v[24:27], a[228:231], a[164:167], v[24:27]
  buffer_load_dwordx4 v185, s[80:83], s41 offen offset:0 lds
  s_add_u32 m0, s42, 94144
  v_mfma_f32_16x16x32_bf16 v[24:27], a[232:235], a[172:175], v[24:27]
  ds_read_b64_tr_b16 a[228:229], v180 offset:14336
  ds_read_b64_tr_b16 a[230:231], v180 offset:15360
  v_mfma_f32_16x16x32_bf16 v[28:31], a[192:195], a[164:167], v[28:31]
  ds_read_b64_tr_b16 a[232:233], v181 offset:12288
  ds_read_b64_tr_b16 a[234:235], v181 offset:13312
  v_mfma_f32_16x16x32_bf16 v[28:31], a[196:199], a[172:175], v[28:31]
  v_mfma_f32_16x16x32_bf16 v[4:7], a[192:195], a[160:163], v[4:7]
  buffer_load_dwordx4 v185, s[80:83], s41 offen offset:64 lds
  v_mfma_f32_16x16x32_bf16 v[4:7], a[196:199], a[168:171], v[4:7]
  s_waitcnt vmcnt(37)
  s_barrier
  ds_read_b64_tr_b16 a[192:193], v181 offset:14336
  s_waitcnt lgkmcnt(13)
  v_mfma_f32_16x16x32_bf16 v[96:99], a[200:203], v[156:159], v[96:99]
  ds_read_b64_tr_b16 a[194:195], v181 offset:15360
  ds_read_b64_tr_b16 a[196:197], v180 offset:8192
  s_mov_b32 s41, 5898240
  v_mfma_f32_16x16x32_bf16 v[100:103], v[156:159], a[204:207], v[100:103]
  ds_read_b64_tr_b16 a[198:199], v180 offset:9216
  ds_read_b64_tr_b16 a[200:201], v180 offset:10240
  s_add_u32 m0, s42, 88064
  v_mfma_f32_16x16x32_bf16 v[8:11], a[208:211], a[176:179], v[8:11]
  buffer_load_dwordx4 v185, s[80:83], s41 offen offset:2048 lds
  s_add_u32 m0, s42, 104384
  s_waitcnt lgkmcnt(13)
  v_mfma_f32_16x16x32_bf16 v[8:11], a[212:215], a[184:187], v[8:11]
  ds_read_b64_tr_b16 a[202:203], v180 offset:11264
  ds_read_b64_tr_b16 a[204:205], v181 offset:8192
  v_mfma_f32_16x16x32_bf16 v[32:35], a[208:211], a[180:183], v[32:35]
  ds_read_b64_tr_b16 a[206:207], v181 offset:9216
  ds_read_b64_tr_b16 a[208:209], v181 offset:10240
  v_mfma_f32_16x16x32_bf16 v[32:35], a[212:215], a[188:191], v[32:35]
  ds_read_b64_tr_b16 a[210:211], v181 offset:11264
  ds_read_b64_tr_b16 a[212:213], v184 offset:24576
  s_load_dwordx2 s[66:67], s[36:37], 0x70000
  v_mfma_f32_16x16x32_bf16 v[36:39], a[216:219], a[180:183], v[36:39]
  buffer_load_dwordx4 v185, s[80:83], s41 offen offset:2112 lds
  s_waitcnt lgkmcnt(13)
  v_mfma_f32_16x16x32_bf16 v[36:39], a[220:223], a[188:191], v[36:39]
  ds_read_b64_tr_b16 a[214:215], v184 offset:25600
  s_add_u32 m0, s42, 118784
  v_mfma_f32_16x16x32_bf16 v[12:15], a[216:219], a[176:179], v[12:15]
  ds_read_b64_tr_b16 a[216:217], v182 offset:20480
  ds_read_b64_tr_b16 a[218:219], v182 offset:21504
  v_mfma_f32_16x16x32_bf16 v[12:15], a[220:223], a[184:187], v[12:15]
  ds_read_b64_tr_b16 a[220:221], v180 offset:24576
  ds_read_b64_tr_b16 a[222:223], v180 offset:25600
  v_mfma_f32_16x16x32_bf16 v[16:19], a[176:179], a[224:227], v[16:19]
  buffer_load_dwordx4 v186, s[80:83], s41 offen offset:0 lds
  s_add_u32 m0, s42, 114624
  v_mfma_f32_16x16x32_bf16 v[16:19], a[184:187], a[228:231], v[16:19]
  v_mfma_f32_16x16x32_bf16 v[40:43], a[180:183], a[224:227], v[40:43]
  ds_read_b64_tr_b16 a[224:225], v180 offset:26624
  ds_read_b64_tr_b16 a[226:227], v180 offset:27648
  v_mfma_f32_16x16x32_bf16 v[40:43], a[188:191], a[228:231], v[40:43]
  ds_read_b64_tr_b16 a[228:229], v181 offset:24576
  ds_read_b64_tr_b16 a[230:231], v181 offset:25600
  s_waitcnt lgkmcnt(13)
  v_mfma_f32_16x16x32_bf16 v[44:47], a[180:183], a[232:235], v[44:47]
  buffer_load_dwordx4 v186, s[80:83], s41 offen offset:64 lds
  v_mfma_f32_16x16x32_bf16 v[44:47], a[188:191], a[192:195], v[44:47]
  v_mfma_f32_16x16x32_bf16 v[20:23], a[176:179], a[232:235], v[20:23]
  ds_read_b64_tr_b16 a[232:233], v181 offset:26624
  ds_read_b64_tr_b16 a[234:235], v181 offset:27648
  v_mfma_f32_16x16x32_bf16 v[20:23], a[184:187], a[192:195], v[20:23]
  ds_read_b64_tr_b16 a[192:193], v176 offset:20480
  ds_read_b64_tr_b16 a[194:195], v176 offset:21504
  s_load_dwordx2 s[66:67], s[36:37], 0x80000
  v_mfma_f32_16x16x32_bf16 v[0:3], a[196:199], a[176:179], v[0:3]
  v_mfma_f32_16x16x32_bf16 v[0:3], a[200:203], a[184:187], v[0:3]
  v_mfma_f32_16x16x32_bf16 v[24:27], a[196:199], a[180:183], v[24:27]
  ds_read_b64_tr_b16 a[196:197], v176 offset:22528
  ds_read_b64_tr_b16 a[198:199], v176 offset:23552
  v_mfma_f32_16x16x32_bf16 v[24:27], a[200:203], a[188:191], v[24:27]
  ds_read_b64_tr_b16 a[200:201], v177 offset:20480
  ds_read_b64_tr_b16 a[202:203], v177 offset:21504
  s_waitcnt lgkmcnt(13)
  v_mfma_f32_16x16x32_bf16 v[28:31], a[204:207], a[180:183], v[28:31]
  v_mfma_f32_16x16x32_bf16 v[28:31], a[208:211], a[188:191], v[28:31]
  v_mfma_f32_16x16x32_bf16 v[4:7], a[204:207], a[176:179], v[4:7]
  ds_read_b64_tr_b16 a[204:205], v177 offset:22528
  ds_read_b64_tr_b16 a[206:207], v177 offset:23552
  v_mfma_f32_16x16x32_bf16 v[4:7], a[208:211], a[184:187], v[4:7]
  s_waitcnt vmcnt(25)
  s_barrier
  ds_read_b64_tr_b16 a[208:209], v176 offset:12288
  v_mfma_f32_16x16x32_bf16 v[96:99], a[212:215], v[160:163], v[96:99]
  ds_read_b64_tr_b16 a[210:211], v176 offset:13312
  ds_read_b64_tr_b16 a[212:213], v176 offset:14336
  s_add_u32 m0, s42, 131072
  v_mfma_f32_16x16x32_bf16 v[100:103], v[160:163], a[216:219], v[100:103]
  buffer_load_dwordx4 v185, s[80:83], s41 offen offset:0 lds
  s_add_u32 m0, s42, 143296
  s_waitcnt lgkmcnt(13)
  v_mfma_f32_16x16x32_bf16 v[8:11], a[220:223], a[0:3], v[8:11]
  ds_read_b64_tr_b16 a[214:215], v176 offset:15360
  ds_read_b64_tr_b16 a[216:217], v177 offset:12288
  v_mfma_f32_16x16x32_bf16 v[8:11], a[224:227], a[8:11], v[8:11]
  ds_read_b64_tr_b16 a[218:219], v177 offset:13312
  s_load_dwordx2 s[66:67], s[36:37], 0x90000
  v_mfma_f32_16x16x32_bf16 v[32:35], a[220:223], a[4:7], v[32:35]
  buffer_load_dwordx4 v185, s[80:83], s41 offen offset:64 lds
  v_mfma_f32_16x16x32_bf16 v[32:35], a[224:227], a[12:15], v[32:35]
  ds_read_b64_tr_b16 a[220:221], v177 offset:14336
  ds_read_b64_tr_b16 a[222:223], v177 offset:15360
  s_mov_b32 s41, 0
  v_mfma_f32_16x16x32_bf16 v[36:39], a[228:231], a[4:7], v[36:39]
  ds_read_b64_tr_b16 a[224:225], v182 offset:24576
  ds_read_b64_tr_b16 a[226:227], v182 offset:25600
  s_add_u32 m0, s42, 139264
  s_waitcnt lgkmcnt(13)
  v_mfma_f32_16x16x32_bf16 v[36:39], a[232:235], a[12:15], v[36:39]
  v_mfma_f32_16x16x32_bf16 v[12:15], a[228:231], a[0:3], v[12:15]
  buffer_load_dwordx4 v217, s[60:63], s41 offen offset:0 nt lds
  v_mfma_f32_16x16x32_bf16 v[12:15], a[232:235], a[8:11], v[12:15]
  ds_read_b64_tr_b16 a[228:229], v182 offset:45056
  ds_read_b64_tr_b16 a[230:231], v182 offset:46080
  v_mfma_f32_16x16x32_bf16 v[16:19], a[0:3], a[192:195], v[16:19]
  ds_read_b64_tr_b16 a[232:233], v176 offset:24576
  ds_read_b64_tr_b16 a[234:235], v176 offset:25600
  v_mfma_f32_16x16x32_bf16 v[16:19], a[8:11], a[196:199], v[16:19]
  v_mfma_f32_16x16x32_bf16 v[40:43], a[4:7], a[192:195], v[40:43]
  ds_read_b64_tr_b16 a[192:193], v176 offset:26624
  ds_read_b64_tr_b16 a[194:195], v176 offset:27648
  v_mfma_f32_16x16x32_bf16 v[40:43], a[12:15], a[196:199], v[40:43]
  ds_read_b64_tr_b16 a[196:197], v177 offset:24576
  ds_read_b64_tr_b16 a[198:199], v177 offset:25600
  s_waitcnt lgkmcnt(13)
  v_mfma_f32_16x16x32_bf16 v[44:47], a[4:7], a[200:203], v[44:47]
  v_mfma_f32_16x16x32_bf16 v[44:47], a[12:15], a[204:207], v[44:47]
  s_load_dwordx2 s[66:67], s[36:37], 0xa0000
  v_mfma_f32_16x16x32_bf16 v[20:23], a[0:3], a[200:203], v[20:23]
  ds_read_b64_tr_b16 a[200:201], v177 offset:26624
  ds_read_b64_tr_b16 a[202:203], v177 offset:27648
  v_mfma_f32_16x16x32_bf16 v[20:23], a[8:11], a[204:207], v[20:23]
  ds_read_b64_tr_b16 a[204:205], v176 offset:45056
  ds_read_b64_tr_b16 a[206:207], v176 offset:46080
  v_mfma_f32_16x16x32_bf16 v[0:3], a[208:211], a[0:3], v[0:3]
  v_mfma_f32_16x16x32_bf16 v[0:3], a[212:215], a[8:11], v[0:3]
  v_mfma_f32_16x16x32_bf16 v[24:27], a[208:211], a[4:7], v[24:27]
  ds_read_b64_tr_b16 a[208:209], v176 offset:47104
  ds_read_b64_tr_b16 a[210:211], v176 offset:48128
  v_mfma_f32_16x16x32_bf16 v[24:27], a[212:215], a[12:15], v[24:27]
  ds_read_b64_tr_b16 a[212:213], v177 offset:45056
  ds_read_b64_tr_b16 a[214:215], v177 offset:46080
  s_waitcnt lgkmcnt(13)
  v_mfma_f32_16x16x32_bf16 v[28:31], a[216:219], a[4:7], v[28:31]
  v_mfma_f32_16x16x32_bf16 v[28:31], a[220:223], a[12:15], v[28:31]
  v_mfma_f32_16x16x32_bf16 v[4:7], a[216:219], a[0:3], v[4:7]
  ds_read_b64_tr_b16 a[216:217], v177 offset:47104
  ds_read_b64_tr_b16 a[218:219], v177 offset:48128
  v_mfma_f32_16x16x32_bf16 v[4:7], a[220:223], a[8:11], v[4:7]
L_wk0_2:
  s_cbranch_vccnz L_wk0_end
  s_waitcnt vmcnt(4)
  s_barrier
  ds_read_b64_tr_b16 a[220:221], v176 offset:36864
  v_mfma_f32_16x16x32_bf16 v[96:99], a[224:227], v[164:167], v[96:99]
  ds_read_b64_tr_b16 a[222:223], v176 offset:37888
  ds_read_b64_tr_b16 a[224:225], v176 offset:38912
  s_mov_b32 s41, 393216
  v_mfma_f32_16x16x32_bf16 v[100:103], v[164:167], a[228:231], v[100:103]
  ds_read_b64_tr_b16 a[226:227], v176 offset:39936
  ds_read_b64_tr_b16 a[228:229], v177 offset:36864
  s_add_u32 m0, s42, 155648
  s_load_dwordx2 s[66:67], s[36:37], 0xb0000
  s_waitcnt lgkmcnt(13)
  v_mfma_f32_16x16x32_bf16 v[8:11], a[232:235], a[16:19], v[8:11]
  buffer_load_dwordx4 v217, s[60:63], s41 offen offset:0 nt lds
  v_mfma_f32_16x16x32_bf16 v[8:11], a[192:195], a[24:27], v[8:11]
  ds_read_b64_tr_b16 a[230:231], v177 offset:37888
  s_mov_b32 s41, 786432
  s_add_u32 m0, s42, 20480
  v_mfma_f32_16x16x32_bf16 v[32:35], a[232:235], a[20:23], v[32:35]
  ds_read_b64_tr_b16 a[232:233], v177 offset:38912
  ds_read_b64_tr_b16 a[234:235], v177 offset:39936
  v_mfma_f32_16x16x32_bf16 v[32:35], a[192:195], a[28:31], v[32:35]
  buffer_load_dwordx4 v217, s[60:63], s41 offen offset:0 nt lds
  v_mfma_f32_16x16x32_bf16 v[36:39], a[196:199], a[20:23], v[36:39]
  ds_read_b64_tr_b16 a[192:193], v182 offset:49152
  ds_read_b64_tr_b16 a[194:195], v182 offset:50176
  s_mov_b32 s41, 1179648
  v_mfma_f32_16x16x32_bf16 v[36:39], a[200:203], a[28:31], v[36:39]
  s_add_u32 m0, s42, 12288
  v_mfma_f32_16x16x32_bf16 v[12:15], a[196:199], a[16:19], v[12:15]
  ds_read_b64_tr_b16 a[196:197], v183 offset:4096
  ds_read_b64_tr_b16 a[198:199], v183 offset:5120
  v_mfma_f32_16x16x32_bf16 v[12:15], a[200:203], a[24:27], v[12:15]
  buffer_load_dwordx4 v217, s[60:63], s41 offen offset:0 nt lds
  s_waitcnt lgkmcnt(13)
  v_mfma_f32_16x16x32_bf16 v[16:19], a[16:19], a[204:207], v[16:19]
  ds_read_b64_tr_b16 a[200:201], v183 offset:24576
  ds_read_b64_tr_b16 a[202:203], v183 offset:25600
  v_mfma_f32_16x16x32_bf16 v[16:19], a[24:27], a[208:211], v[16:19]
  v_mfma_f32_16x16x32_bf16 v[40:43], a[20:23], a[204:207], v[40:43]
  ds_read_b64_tr_b16 a[204:205], v183 offset:53248
  ds_read_b64_tr_b16 a[206:207], v183 offset:54272
  v_mfma_f32_16x16x32_bf16 v[40:43], a[28:31], a[208:211], v[40:43]
  ds_read_b64_tr_b16 a[208:209], v176 offset:49152
  ds_read_b64_tr_b16 a[210:211], v176 offset:50176
  s_load_dwordx2 s[66:67], s[36:37], 0xc0000
  v_mfma_f32_16x16x32_bf16 v[44:47], a[20:23], a[212:215], v[44:47]
  s_waitcnt lgkmcnt(13)
  v_mfma_f32_16x16x32_bf16 v[44:47], a[28:31], a[216:219], v[44:47]
  v_mfma_f32_16x16x32_bf16 v[20:23], a[16:19], a[212:215], v[20:23]
  ds_read_b64_tr_b16 a[212:213], v176 offset:51200
  ds_read_b64_tr_b16 a[214:215], v176 offset:52224
  v_mfma_f32_16x16x32_bf16 v[20:23], a[24:27], a[216:219], v[20:23]
  ds_read_b64_tr_b16 a[216:217], v177 offset:49152
  ds_read_b64_tr_b16 a[218:219], v177 offset:50176
  v_mfma_f32_16x16x32_bf16 v[0:3], a[220:223], a[16:19], v[0:3]
  v_mfma_f32_16x16x32_bf16 v[0:3], a[224:227], a[24:27], v[0:3]
  v_mfma_f32_16x16x32_bf16 v[24:27], a[220:223], a[20:23], v[24:27]
  ds_read_b64_tr_b16 a[220:221], v177 offset:51200
  ds_read_b64_tr_b16 a[222:223], v177 offset:52224
  v_mfma_f32_16x16x32_bf16 v[24:27], a[224:227], a[28:31], v[24:27]
  ds_read_b64_tr_b16 a[224:225], v178 offset:4096
  ds_read_b64_tr_b16 a[226:227], v178 offset:5120
  s_waitcnt lgkmcnt(13)
  v_mfma_f32_16x16x32_bf16 v[28:31], a[228:231], a[20:23], v[28:31]
  v_mfma_f32_16x16x32_bf16 v[28:31], a[232:235], a[28:31], v[28:31]
  v_mfma_f32_16x16x32_bf16 v[4:7], a[228:231], a[16:19], v[4:7]
  ds_read_b64_tr_b16 a[228:229], v178 offset:6144
  ds_read_b64_tr_b16 a[230:231], v178 offset:7168
  v_mfma_f32_16x16x32_bf16 v[4:7], a[232:235], a[24:27], v[4:7]
  s_barrier
  ds_read_b64_tr_b16 a[232:233], v179 offset:4096
  s_load_dwordx2 s[66:67], s[36:37], 0xd0000
  v_mfma_f32_16x16x32_bf16 v[96:99], a[192:195], v[168:171], v[96:99]
  ds_read_b64_tr_b16 a[234:235], v179 offset:5120
  ds_read_b64_tr_b16 a[192:193], v179 offset:6144
  s_mov_b32 s41, 1572864
  v_mfma_f32_16x16x32_bf16 v[100:103], v[168:171], a[196:199], v[100:103]
  ds_read_b64_tr_b16 a[194:195], v179 offset:7168
  ds_read_b64_tr_b16 a[196:197], v178 offset:16384
  s_add_u32 m0, s42, 24576
  s_waitcnt lgkmcnt(13)
  v_mfma_f32_16x16x32_bf16 v[96:99], a[200:203], v[172:175], v[96:99]
  buffer_load_dwordx4 v217, s[60:63], s41 offen offset:0 nt lds
  v_mfma_f32_16x16x32_bf16 v[100:103], v[172:175], a[204:207], v[100:103]
  ds_read_b64_tr_b16 a[198:199], v178 offset:17408
  ds_read_b64_tr_b16 a[200:201], v178 offset:18432
  s_mov_b32 s41, 1966080
  v_mfma_f32_16x16x32_bf16 v[8:11], a[208:211], a[32:35], v[8:11]
  ds_read_b64_tr_b16 a[202:203], v178 offset:19456
  ds_read_b64_tr_b16 a[204:205], v179 offset:16384
  s_add_u32 m0, s42, 45056
  ds_write_b128 v192, v[96:99] offset:0
  ds_write_b128 v192, v[100:103] offset:1024
  v_mfma_f32_16x16x32_bf16 v[8:11], a[212:215], a[40:43], v[8:11]
  buffer_load_dwordx4 v217, s[60:63], s41 offen offset:0 nt lds
  v_mfma_f32_16x16x32_bf16 v[32:35], a[208:211], a[36:39], v[32:35]
  ds_read_b64_tr_b16 a[206:207], v179 offset:17408
  ds_read_b64_tr_b16 a[208:209], v179 offset:18432
  s_mov_b32 s41, 2359296
  v_mfma_f32_16x16x32_bf16 v[32:35], a[212:215], a[44:47], v[32:35]
  ds_read_b64_tr_b16 a[210:211], v179 offset:19456
  ds_read_b64_tr_b16 a[212:213], v178 offset:24576
  s_add_u32 m0, s42, 36864
  s_waitcnt lgkmcnt(13)
  v_mfma_f32_16x16x32_bf16 v[36:39], a[216:219], a[36:39], v[36:39]
  ds_read_b64_tr_b16 a[214:215], v178 offset:25600
  v_mfma_f32_16x16x32_bf16 v[36:39], a[220:223], a[44:47], v[36:39]
  buffer_load_dwordx4 v217, s[60:63], s41 offen offset:0 nt lds
  v_mfma_f32_16x16x32_bf16 v[12:15], a[216:219], a[32:35], v[12:15]
  ds_read_b64_tr_b16 a[216:217], v178 offset:26624
  ds_read_b64_tr_b16 a[218:219], v178 offset:27648
  v_mfma_f32_16x16x32_bf16 v[12:15], a[220:223], a[40:43], v[12:15]
  ds_read_b64_tr_b16 a[220:221], v179 offset:24576
  ds_read_b64_tr_b16 a[222:223], v179 offset:25600
  s_waitcnt lgkmcnt(9)
  s_load_dwordx2 s[66:67], s[36:37], 0xe0000
  v_mfma_f32_16x16x32_bf16 v[16:19], a[32:35], a[224:227], v[16:19]
  v_mfma_f32_16x16x32_bf16 v[16:19], a[40:43], a[228:231], v[16:19]
  v_mfma_f32_16x16x32_bf16 v[40:43], a[36:39], a[224:227], v[40:43]
  ds_read_b64_tr_b16 a[224:225], v179 offset:26624
  ds_read_b64_tr_b16 a[226:227], v179 offset:27648
  v_mfma_f32_16x16x32_bf16 v[40:43], a[44:47], a[228:231], v[40:43]
  ds_read_b64_tr_b16 a[228:229], v178 offset:53248
  ds_read_b64_tr_b16 a[230:231], v178 offset:54272
  v_mfma_f32_16x16x32_bf16 v[44:47], a[36:39], a[232:235], v[44:47]
  v_mfma_f32_16x16x32_bf16 v[44:47], a[44:47], a[192:195], v[44:47]
  v_mfma_f32_16x16x32_bf16 v[20:23], a[32:35], a[232:235], v[20:23]
  ds_read_b64_tr_b16 a[232:233], v178 offset:55296
  ds_read_b64_tr_b16 a[234:235], v178 offset:56320
  v_mfma_f32_16x16x32_bf16 v[20:23], a[40:43], a[192:195], v[20:23]
  ds_read_b64_tr_b16 a[192:193], v179 offset:53248
  ds_read_b64_tr_b16 a[194:195], v179 offset:54272
  v_mfma_f32_16x16x32_bf16 v[0:3], a[196:199], a[32:35], v[0:3]
  v_mfma_f32_16x16x32_bf16 v[0:3], a[200:203], a[40:43], v[0:3]
  v_mfma_f32_16x16x32_bf16 v[24:27], a[196:199], a[36:39], v[24:27]
  ds_read_b64_tr_b16 a[196:197], v179 offset:55296
  ds_read_b64_tr_b16 a[198:199], v179 offset:56320
  v_mfma_f32_16x16x32_bf16 v[24:27], a[200:203], a[44:47], v[24:27]
  s_load_dwordx2 s[66:67], s[36:37], 0xf0000
  s_add_u32 s36, s36, 0x100000
  s_addc_u32 s37, s37, 0
  s_waitcnt lgkmcnt(13)
  v_mfma_f32_16x16x32_bf16 v[28:31], a[204:207], a[36:39], v[28:31]
  v_mfma_f32_16x16x32_bf16 v[28:31], a[208:211], a[44:47], v[28:31]
  v_mfma_f32_16x16x32_bf16 v[4:7], a[204:207], a[32:35], v[4:7]
  v_mfma_f32_16x16x32_bf16 v[4:7], a[208:211], a[40:43], v[4:7]
  s_waitcnt vmcnt(8)
  s_barrier
  ds_read_b64_tr_b16 a[200:201], v180 offset:0
  ds_read_b128 v[200:203], v191 offset:0
  ds_read_b128 v[204:207], v191 offset:1024
  v_mfma_f32_16x16x32_bf16 v[8:11], a[212:215], a[48:51], v[8:11]
  ds_read_b64_tr_b16 a[202:203], v180 offset:1024
  ds_read_b64_tr_b16 a[204:205], v180 offset:2048
  s_mov_b32 s41, 2752512
  s_waitcnt lgkmcnt(13)
  v_mfma_f32_16x16x32_bf16 v[8:11], a[216:219], a[56:59], v[8:11]
  ds_read_b64_tr_b16 a[206:207], v180 offset:3072
  ds_read_b64_tr_b16 a[208:209], v181 offset:0
  s_add_u32 m0, s42, 49152
  v_mfma_f32_16x16x32_bf16 v[32:35], a[212:215], a[52:55], v[32:35]
  buffer_load_dwordx4 v217, s[60:63], s41 offen offset:0 nt lds
  v_mfma_f32_16x16x32_bf16 v[32:35], a[216:219], a[60:63], v[32:35]
  ds_read_b64_tr_b16 a[210:211], v181 offset:1024
  ds_read_b64_tr_b16 a[212:213], v181 offset:2048
  s_mov_b32 s41, 0
  v_mfma_f32_16x16x32_bf16 v[36:39], a[220:223], a[52:55], v[36:39]
  ds_read_b64_tr_b16 a[214:215], v181 offset:3072
  ds_read_b64_tr_b16 a[216:217], v182 offset:61440
  s_add_u32 m0, s42, 69632
  s_waitcnt lgkmcnt(8)
  v_add_f32 v200, v200, v96
  v_add_f32 v201, v201, v97
  v_add_f32 v202, v202, v98
  v_add_f32 v203, v203, v99
  v_add_f32 v204, v204, v100
  v_add_f32 v205, v205, v101
  v_add_f32 v206, v206, v102
  v_add_f32 v207, v207, v103
  v_cvt_pk_bf16_f32 v196, v200, v201
  v_cvt_pk_bf16_f32 v197, v202, v203
  v_mfma_f32_16x16x32_bf16 v[36:39], a[224:227], a[60:63], v[36:39]
  buffer_load_dwordx4 v241, s[8:11], s41 offen offset:0 lds
  v_cvt_pk_bf16_f32 v198, v204, v205
  v_cvt_pk_bf16_f32 v199, v206, v207
  ds_write_b64 v208, v[196:197] offset:0
  ds_write_b64 v208, v[198:199] offset:1024
  v_mfma_f32_16x16x32_bf16 v[12:15], a[220:223], a[48:51], v[12:15]
  ds_read_b64_tr_b16 a[218:219], v182 offset:62464
  ds_read_b64_tr_b16 a[220:221], v183 offset:12288
  s_mov_b32 s41, 131072
  v_mfma_f32_16x16x32_bf16 v[12:15], a[224:227], a[56:59], v[12:15]
  ds_read_b64_tr_b16 a[222:223], v183 offset:13312
  ds_read_b64_tr_b16 a[224:225], v176 offset:61440
  s_add_u32 m0, s42, 81920
  v_cvt_pk_bf16_f32 v128, v32, v33
  v_cvt_pk_bf16_f32 v129, v34, v35
  v_cvt_pk_bf16_f32 v130, v36, v37
  v_cvt_pk_bf16_f32 v131, v38, v39
  ds_write_b128 v191, v[128:131]
  v_cvt_pk_bf16_f32 v124, v8, v9
  v_cvt_pk_bf16_f32 v125, v10, v11
  v_cvt_pk_bf16_f32 v126, v12, v13
  s_load_dwordx2 s[66:67], s[36:37], 0x0
  v_mfma_f32_16x16x32_bf16 v[16:19], a[48:51], a[228:231], v[16:19]
  ds_read_b64_tr_b16 a[226:227], v176 offset:62464
  v_cvt_pk_bf16_f32 v127, v14, v15
  v_mfma_f32_16x16x32_bf16 v[16:19], a[56:59], a[232:235], v[16:19]
  buffer_load_dwordx4 v241, s[8:11], s41 offen offset:0 lds
  v_mfma_f32_16x16x32_bf16 v[40:43], a[52:55], a[228:231], v[40:43]
  ds_read_b64_tr_b16 a[228:229], v176 offset:63488
  ds_read_b64_tr_b16 a[230:231], v176 offset:64512
  v_mfma_f32_16x16x32_bf16 v[40:43], a[60:63], a[232:235], v[40:43]
  ds_read_b64_tr_b16 a[232:233], v177 offset:61440
  ds_read_b64_tr_b16 a[234:235], v177 offset:62464
  v_mfma_f32_16x16x32_bf16 v[44:47], a[52:55], a[192:195], v[44:47]
  v_mfma_f32_16x16x32_bf16 v[44:47], a[60:63], a[196:199], v[44:47]
  v_mfma_f32_16x16x32_bf16 v[20:23], a[48:51], a[192:195], v[20:23]
  ds_read_b64_tr_b16 a[192:193], v177 offset:63488
  ds_read_b64_tr_b16 a[194:195], v177 offset:64512
  v_mfma_f32_16x16x32_bf16 v[20:23], a[56:59], a[196:199], v[20:23]
  ds_read_b64_tr_b16 a[196:197], v178 offset:12288
  ds_read_b64_tr_b16 a[198:199], v178 offset:13312
  v_cvt_pk_bf16_f32 v136, v40, v41
  v_cvt_pk_bf16_f32 v137, v42, v43
  v_cvt_pk_bf16_f32 v142, v44, v45
  v_cvt_pk_bf16_f32 v143, v46, v47
  ds_write_b64 v191, v[136:137] offset:1024
  ds_write_b64 v191, v[142:143] offset:1032
  v_cvt_pk_bf16_f32 v134, v16, v17
  v_cvt_pk_bf16_f32 v135, v18, v19
  v_cvt_pk_bf16_f32 v140, v20, v21
  v_cvt_pk_bf16_f32 v141, v22, v23
  s_waitcnt lgkmcnt(13)
  v_mfma_f32_16x16x32_bf16 v[0:3], a[200:203], a[48:51], v[0:3]
  v_mfma_f32_16x16x32_bf16 v[0:3], a[204:207], a[56:59], v[0:3]
  v_mfma_f32_16x16x32_bf16 v[24:27], a[200:203], a[52:55], v[24:27]
  ds_read_b64_tr_b16 a[200:201], v178 offset:14336
  ds_read_b64_tr_b16 a[202:203], v178 offset:15360
  v_mfma_f32_16x16x32_bf16 v[24:27], a[204:207], a[60:63], v[24:27]
  ds_read_b64_tr_b16 a[204:205], v179 offset:12288
  ds_read_b64_tr_b16 a[206:207], v179 offset:13312
  s_load_dwordx2 s[66:67], s[36:37], 0x10000
  v_mfma_f32_16x16x32_bf16 v[28:31], a[208:211], a[52:55], v[28:31]
  v_mfma_f32_16x16x32_bf16 v[28:31], a[212:215], a[60:63], v[28:31]
  v_mfma_f32_16x16x32_bf16 v[4:7], a[208:211], a[48:51], v[4:7]
  ds_read_b64_tr_b16 a[208:209], v179 offset:14336
  ds_read_b64_tr_b16 a[210:211], v179 offset:15360
  v_mfma_f32_16x16x32_bf16 v[4:7], a[212:215], a[56:59], v[4:7]
  ds_read_b64_tr_b16 a[212:213], v178 offset:8192
  ds_read_b64_tr_b16 a[214:215], v178 offset:9216
  v_cvt_pk_bf16_f32 v116, v24, v25
  v_cvt_pk_bf16_f32 v117, v26, v27
  v_cvt_pk_bf16_f32 v118, v28, v29
  v_cvt_pk_bf16_f32 v119, v30, v31
  v_cvt_pk_bf16_f32 v112, v0, v1
  v_cvt_pk_bf16_f32 v113, v2, v3
  v_cvt_pk_bf16_f32 v114, v4, v5
  v_mfma_f32_16x16x32_bf16 v[104:107], a[216:219], v[144:147], v[104:107]
  ds_read_b64_tr_b16 a[216:217], v178 offset:10240
  ds_read_b64_tr_b16 a[218:219], v178 offset:11264
  v_cvt_pk_bf16_f32 v115, v6, v7
  s_waitcnt lgkmcnt(10)
  v_mfma_f32_16x16x32_bf16 v[108:111], v[144:147], a[220:223], v[108:111]
  ds_read_b64_tr_b16 a[220:221], v179 offset:8192
  ds_read_b64_tr_b16 a[222:223], v179 offset:9216
  ds_read_b128 v[24:27], v250 offset:11264
  v_mfma_f32_16x16x32_bf16 v[56:59], a[224:227], a[128:131], v[56:59]
  ds_read_b128 v[28:31], v250 offset:11328
  ds_read_b128 v[32:35], v250 offset:11392
  ds_read_b128 v[36:39], v250 offset:11456
  v_mfma_f32_16x16x32_bf16 v[56:59], a[228:231], a[136:139], v[56:59]
  ds_read_b128 v[40:43], v250 offset:11520
  ds_read_b128 v[44:47], v250 offset:11584
  ds_read_b128 v[96:99], v250 offset:11648
  v_mfma_f32_16x16x32_bf16 v[80:83], a[224:227], a[132:135], v[80:83]
  ds_read_b64_tr_b16 a[224:225], v179 offset:10240
  ds_read_b64_tr_b16 a[226:227], v179 offset:11264
  ds_read_b128 v[100:103], v250 offset:11712
  v_mfma_f32_16x16x32_bf16 v[80:83], a[228:231], a[140:143], v[80:83]
  s_barrier
  ds_read_b64_tr_b16 a[228:229], v183 offset:20480
  ds_read_b128 v[120:123], v209
  ds_read_b64 v[132:133], v209 offset:1024
  ds_read_b64 v[138:139], v209 offset:1032
  v_mfma_f32_16x16x32_bf16 v[4:7], v[128:131], v[116:119], 0
  v_mfma_f32_16x16x32_bf16 v[84:87], a[232:235], a[132:135], v[84:87]
  ds_read_b64_tr_b16 a[230:231], v183 offset:21504
  s_mov_b32 s41, 262144
  s_add_u32 m0, s42, 61440
  v_mfma_f32_16x16x32_bf16 v[0:3], v[124:127], v[116:119], 0
  v_mfma_f32_16x16x32_bf16 v[84:87], a[192:195], a[140:143], v[84:87]
  buffer_load_dwordx4 v241, s[8:11], s41 offen offset:0 lds
  v_mfma_f32_16x16x32_bf16 v[12:15], v[124:127], v[112:115], 0
  s_load_dwordx2 s[66:67], s[36:37], 0x20000
  v_mfma_f32_16x16x32_bf16 v[60:63], a[232:235], a[128:131], v[60:63]
  ds_read_b64_tr_b16 a[232:233], v183 offset:36864
  ds_read_b64_tr_b16 a[234:235], v183 offset:37888
  s_mov_b32 s41, 393216
  v_mfma_f32_16x16x32_bf16 v[60:63], a[192:195], a[136:139], v[60:63]
  ds_read_b64_tr_b16 a[192:193], v178 offset:20480
  ds_read_b64_tr_b16 a[194:195], v178 offset:21504
  s_add_u32 m0, s42, 90112
  v_mfma_f32_16x16x32_bf16 v[64:67], a[128:131], a[196:199], v[64:67]
  buffer_load_dwordx4 v241, s[8:11], s41 offen offset:0 lds
  s_waitcnt lgkmcnt(13)
  v_mfma_f32_16x16x32_bf16 v[64:67], a[136:139], a[200:203], v[64:67]
  s_mov_b32 s41, 524288
  s_add_u32 m0, s42, 118784
  v_mfma_f32_16x16x32_bf16 v[88:91], a[132:135], a[196:199], v[88:91]
  ds_read_b64_tr_b16 a[196:197], v178 offset:22528
  ds_read_b64_tr_b16 a[198:199], v178 offset:23552
  v_mfma_f32_16x16x32_bf16 v[88:91], a[140:143], a[200:203], v[88:91]
  ds_read_b64_tr_b16 a[200:201], v179 offset:20480
  ds_read_b64_tr_b16 a[202:203], v179 offset:21504
  s_waitcnt lgkmcnt(9)
  v_mfma_f32_16x16x32_bf16 v[8:11], v[120:123], v[112:115], 0
  v_cndmask_b32_e64 v0, v0, v1, s[28:29]
  v_cndmask_b32_e64 v2, v2, v3, s[28:29]
  v_cndmask_b32_e64 v4, v4, v5, s[28:29]
  v_cndmask_b32_e64 v6, v6, v7, s[28:29]
  v_mfma_f32_16x16x32_bf16 v[92:95], a[132:135], a[204:207], v[92:95]
  buffer_load_dwordx4 v241, s[8:11], s41 offen offset:0 lds
  v_mfma_f32_16x16x32_bf16 v[92:95], a[140:143], a[208:211], v[92:95]
  s_mov_b32 s41, 655360
  s_add_u32 m0, s42, 131072
  v_cndmask_b32_e64 v8, v8, v9, s[28:29]
  v_cndmask_b32_e64 v10, v10, v11, s[28:29]
  v_cndmask_b32_e64 v12, v12, v13, s[28:29]
  v_cndmask_b32_e64 v14, v14, v15, s[28:29]
  v_cndmask_b32_e64 v0, v0, v4, s[24:25]
  v_cndmask_b32_e64 v1, v2, v6, s[26:27]
  v_cndmask_b32_e64 v8, v8, v12, s[24:25]
  v_cndmask_b32_e64 v9, v10, v14, s[26:27]
  v_mfma_f32_16x16x32_bf16 v[68:71], a[128:131], a[204:207], v[68:71]
  ds_read_b64_tr_b16 a[204:205], v179 offset:22528
  ds_read_b64_tr_b16 a[206:207], v179 offset:23552
  s_mov_b32 s33, 0x3e8293ee
  v_mul_f32 v0, s33, v0
  v_mul_f32 v1, s33, v1
  v_fma_f32 v8, v8, s33, v193
  v_fma_f32 v9, v9, s33, v194
  v_max_f32 v16, v0, v1
  v_max_f32 v17, v8, v9
  v_mov_b32 v20, v16
  v_mov_b32 v21, v17
  v_mfma_f32_16x16x32_bf16 v[68:71], a[136:139], a[208:211], v[68:71]
  ds_read_b64_tr_b16 a[208:209], v178 offset:36864
  ds_read_b64_tr_b16 a[210:211], v178 offset:37888
  v_permlane16_swap_b32 v20, v16
  v_permlane16_swap_b32 v21, v17
  v_mfma_f32_16x16x32_bf16 v[48:51], a[212:215], a[128:131], v[48:51]
  buffer_load_dwordx4 v241, s[8:11], s41 offen offset:0 lds
  v_max_f32 v16, v16, v20
  v_max_f32 v17, v17, v21
  v_mov_b32 v20, v16
  v_mov_b32 v21, v17
  v_mfma_f32_16x16x32_bf16 v[48:51], a[216:219], a[136:139], v[48:51]
  v_permlane32_swap_b32 v20, v16
  v_permlane32_swap_b32 v21, v17
  s_load_dwordx2 s[66:67], s[36:37], 0x30000
  v_mfma_f32_16x16x32_bf16 v[72:75], a[212:215], a[132:135], v[72:75]
  ds_read_b64_tr_b16 a[212:213], v178 offset:38912
  ds_read_b64_tr_b16 a[214:215], v178 offset:39936
  v_max_f32 v16, v16, v20
  v_max_f32 v17, v17, v21
  v_sub_f32 v0, v0, v16
  v_sub_f32 v1, v1, v16
  v_sub_f32 v8, v8, v17
  v_sub_f32 v9, v9, v17
  v_exp_f32 v0, v0
  v_exp_f32 v1, v1
  v_mfma_f32_16x16x32_bf16 v[72:75], a[216:219], a[140:143], v[72:75]
  ds_read_b64_tr_b16 a[216:217], v179 offset:36864
  ds_read_b64_tr_b16 a[218:219], v179 offset:37888
  v_exp_f32 v8, v8
  v_exp_f32 v9, v9
  v_add_f32 v16, v0, v1
  v_add_f32 v17, v8, v9
  v_mov_b32 v20, v16
  v_mfma_f32_16x16x32_bf16 v[76:79], a[220:223], a[132:135], v[76:79]
  v_mov_b32 v21, v17
  v_permlane16_swap_b32 v20, v16
  v_mfma_f32_16x16x32_bf16 v[76:79], a[224:227], a[140:143], v[76:79]
  v_permlane16_swap_b32 v21, v17
  v_add_f32 v16, v16, v20
  v_mfma_f32_16x16x32_bf16 v[52:55], a[220:223], a[128:131], v[52:55]
  ds_read_b64_tr_b16 a[220:221], v179 offset:38912
  ds_read_b64_tr_b16 a[222:223], v179 offset:39936
  v_add_f32 v17, v17, v21
  v_mov_b32 v20, v16
  v_mov_b32 v21, v17
  v_mfma_f32_16x16x32_bf16 v[52:55], a[224:227], a[136:139], v[52:55]
  s_barrier
  ds_read_b64_tr_b16 a[224:225], v178 offset:32768
  v_permlane32_swap_b32 v20, v16
  v_permlane32_swap_b32 v21, v17
  s_waitcnt lgkmcnt(13)
  v_mfma_f32_16x16x32_bf16 v[104:107], a[228:231], v[148:151], v[104:107]
  ds_read_b64_tr_b16 a[226:227], v178 offset:33792
  ds_read_b64_tr_b16 a[228:229], v178 offset:34816
  s_mov_b32 s41, 786432
  v_add_f32 v16, v16, v20
  v_add_f32 v17, v17, v21
  v_rcp_f32 v16, v16
  v_rcp_f32 v17, v17
  v_mul_f32 v0, v0, v16
  v_mul_f32 v1, v1, v16
  v_mul_f32 v8, v8, v17
  v_mul_f32 v9, v9, v17
  v_cvt_pk_bf16_f32 v0, v0, 0
  v_mfma_f32_16x16x32_bf16 v[108:111], v[148:151], a[232:235], v[108:111]
  ds_read_b64_tr_b16 a[230:231], v178 offset:35840
  ds_read_b64_tr_b16 a[232:233], v179 offset:32768
  s_add_u32 m0, s42, 77824
  v_cvt_pk_bf16_f32 v1, v1, 0
  v_cvt_pk_bf16_f32 v8, v8, 0
  v_cvt_pk_bf16_f32 v9, v9, 0
  v_lshlrev_b32 v0, v195, v0
  v_lshlrev_b32 v1, v195, v1
  v_lshlrev_b32 v8, v195, v8
  v_mfma_f32_16x16x32_bf16 v[56:59], a[192:195], a[144:147], v[56:59]
  buffer_load_dwordx4 v241, s[8:11], s41 offen offset:0 lds
  v_lshlrev_b32 v9, v195, v9
  v_cndmask_b32_e64 v112, v0, 0, s[24:25]
  v_cndmask_b32_e64 v114, 0, v0, s[24:25]
  v_cndmask_b32_e64 v113, v1, 0, s[26:27]
  v_cndmask_b32_e64 v115, 0, v1, s[26:27]
  v_cndmask_b32_e64 v116, v8, 0, s[24:25]
  v_mfma_f32_16x16x32_bf16 v[56:59], a[196:199], a[152:155], v[56:59]
  ds_read_b64_tr_b16 a[234:235], v179 offset:33792
  s_mov_b32 s41, 917504
  s_add_u32 m0, s42, 73728
  v_cndmask_b32_e64 v118, 0, v8, s[24:25]
  v_cndmask_b32_e64 v117, v9, 0, s[26:27]
  v_cndmask_b32_e64 v119, 0, v9, s[26:27]
  v_mfma_f32_16x16x32_bf16 v[80:83], a[192:195], a[148:151], v[80:83]
  ds_read_b64_tr_b16 a[192:193], v179 offset:34816
  ds_read_b64_tr_b16 a[194:195], v179 offset:35840
  v_mfma_f32_16x16x32_bf16 v[0:3], v[134:137], v[112:115], 0
  v_mfma_f32_16x16x32_bf16 v[80:83], a[196:199], a[156:159], v[80:83]
  buffer_load_dwordx4 v241, s[8:11], s41 offen offset:0 lds
  v_mfma_f32_16x16x32_bf16 v[4:7], v[140:143], v[112:115], 0
  v_mfma_f32_16x16x32_bf16 v[8:11], v[132:135], v[116:119], 0
  s_load_dwordx2 s[66:67], s[36:37], 0x40000
  s_waitcnt lgkmcnt(13)
  v_mfma_f32_16x16x32_bf16 v[84:87], a[200:203], a[148:151], v[84:87]
  ds_read_b64_tr_b16 a[196:197], v183 offset:45056
  ds_read_b64_tr_b16 a[198:199], v183 offset:46080
  v_mfma_f32_16x16x32_bf16 v[12:15], v[138:141], v[116:119], 0
  v_cvt_pk_bf16_f32 v120, v0, v1
  v_cvt_pk_bf16_f32 v121, v2, v3
  v_cvt_pk_bf16_f32 v122, v4, v5
  v_cvt_pk_bf16_f32 v123, v6, v7
  v_mfma_f32_16x16x32_bf16 v[84:87], a[204:207], a[156:159], v[84:87]
  buffer_store_dwordx4 v[120:123], v187, s[4:7], s78 offen offset:1024 sc1
  v_cvt_pk_bf16_f32 v124, v8, v9
  v_cvt_pk_bf16_f32 v125, v10, v11
  v_cvt_pk_bf16_f32 v126, v12, v13
  v_cvt_pk_bf16_f32 v127, v14, v15
  v_mfma_f32_16x16x32_bf16 v[60:63], a[200:203], a[144:147], v[60:63]
  ds_read_b64_tr_b16 a[200:201], v183 offset:61440
  ds_read_b64_tr_b16 a[202:203], v183 offset:62464
  buffer_store_dwordx4 v[124:127], v187, s[4:7], s78 offen offset:0 sc1
  s_add_u32 s78, s78, 2097152
  v_mfma_f32_16x16x32_bf16 v[60:63], a[204:207], a[152:155], v[60:63]
  ds_read_b64_tr_b16 a[204:205], v178 offset:45056
  ds_read_b64_tr_b16 a[206:207], v178 offset:46080
  v_mfma_f32_16x16x32_bf16 v[64:67], a[144:147], a[208:211], v[64:67]
  s_waitcnt lgkmcnt(13)
  v_mfma_f32_16x16x32_bf16 v[64:67], a[152:155], a[212:215], v[64:67]
  v_mfma_f32_16x16x32_bf16 v[88:91], a[148:151], a[208:211], v[88:91]
  ds_read_b64_tr_b16 a[208:209], v178 offset:47104
  ds_read_b64_tr_b16 a[210:211], v178 offset:48128
  v_mfma_f32_16x16x32_bf16 v[88:91], a[156:159], a[212:215], v[88:91]
  ds_read_b64_tr_b16 a[212:213], v179 offset:45056
  ds_read_b64_tr_b16 a[214:215], v179 offset:46080
  v_mfma_f32_16x16x32_bf16 v[92:95], a[148:151], a[216:219], v[92:95]
  v_mfma_f32_16x16x32_bf16 v[92:95], a[156:159], a[220:223], v[92:95]
  v_mfma_f32_16x16x32_bf16 v[68:71], a[144:147], a[216:219], v[68:71]
  ds_read_b64_tr_b16 a[216:217], v179 offset:47104
  ds_read_b64_tr_b16 a[218:219], v179 offset:48128
  v_mfma_f32_16x16x32_bf16 v[68:71], a[152:155], a[220:223], v[68:71]
  ds_read_b64_tr_b16 a[220:221], v178 offset:61440
  ds_read_b64_tr_b16 a[222:223], v178 offset:62464
  s_load_dwordx2 s[66:67], s[36:37], 0x50000
  s_waitcnt lgkmcnt(13)
  v_mfma_f32_16x16x32_bf16 v[48:51], a[224:227], a[144:147], v[48:51]
  v_mfma_f32_16x16x32_bf16 v[48:51], a[228:231], a[152:155], v[48:51]
  v_mfma_f32_16x16x32_bf16 v[72:75], a[224:227], a[148:151], v[72:75]
  ds_read_b64_tr_b16 a[224:225], v178 offset:63488
  ds_read_b64_tr_b16 a[226:227], v178 offset:64512
  v_mfma_f32_16x16x32_bf16 v[72:75], a[228:231], a[156:159], v[72:75]
  ds_read_b64_tr_b16 a[228:229], v179 offset:61440
  ds_read_b64_tr_b16 a[230:231], v179 offset:62464
  v_mfma_f32_16x16x32_bf16 v[76:79], a[232:235], a[148:151], v[76:79]
  v_mfma_f32_16x16x32_bf16 v[76:79], a[192:195], a[156:159], v[76:79]
  v_mfma_f32_16x16x32_bf16 v[52:55], a[232:235], a[144:147], v[52:55]
  ds_read_b64_tr_b16 a[232:233], v179 offset:63488
  ds_read_b64_tr_b16 a[234:235], v179 offset:64512
  v_mfma_f32_16x16x32_bf16 v[52:55], a[192:195], a[152:155], v[52:55]
  s_barrier
  ds_read_b64_tr_b16 a[192:193], v178 offset:57344
  s_waitcnt lgkmcnt(13)
  v_mfma_f32_16x16x32_bf16 v[104:107], a[196:199], v[152:155], v[104:107]
  ds_read_b64_tr_b16 a[194:195], v178 offset:58368
  ds_read_b64_tr_b16 a[196:197], v178 offset:59392
  s_mov_b32 s41, 1048576
  v_mfma_f32_16x16x32_bf16 v[108:111], v[152:155], a[200:203], v[108:111]
  ds_read_b64_tr_b16 a[198:199], v178 offset:60416
  ds_read_b64_tr_b16 a[200:201], v179 offset:57344
  s_add_u32 m0, s42, 86016
  v_mfma_f32_16x16x32_bf16 v[56:59], a[204:207], a[160:163], v[56:59]
  buffer_load_dwordx4 v241, s[8:11], s41 offen offset:0 lds
  v_mfma_f32_16x16x32_bf16 v[56:59], a[208:211], a[168:171], v[56:59]
  ds_read_b64_tr_b16 a[202:203], v179 offset:58368
  s_mov_b32 s41, 1179648
  s_add_u32 m0, s42, 102400
  s_load_dwordx2 s[66:67], s[36:37], 0x60000
  v_mfma_f32_16x16x32_bf16 v[80:83], a[204:207], a[164:167], v[80:83]
  ds_read_b64_tr_b16 a[204:205], v179 offset:59392
  ds_read_b64_tr_b16 a[206:207], v179 offset:60416
  v_mfma_f32_16x16x32_bf16 v[80:83], a[208:211], a[172:175], v[80:83]
  buffer_load_dwordx4 v241, s[8:11], s41 offen offset:0 lds
  s_waitcnt lgkmcnt(13)
  v_mfma_f32_16x16x32_bf16 v[84:87], a[212:215], a[164:167], v[84:87]
  ds_read_b64_tr_b16 a[208:209], v184 offset:4096
  ds_read_b64_tr_b16 a[210:211], v184 offset:5120
  s_mov_b32 s41, 1310720
  v_mfma_f32_16x16x32_bf16 v[84:87], a[216:219], a[172:175], v[84:87]
  s_add_u32 m0, s42, 98304
  v_mfma_f32_16x16x32_bf16 v[60:63], a[212:215], a[160:163], v[60:63]
  ds_read_b64_tr_b16 a[212:213], v184 offset:20480
  ds_read_b64_tr_b16 a[214:215], v184 offset:21504
  v_mfma_f32_16x16x32_bf16 v[60:63], a[216:219], a[168:171], v[60:63]
  buffer_load_dwordx4 v241, s[8:11], s41 offen offset:0 lds
  v_mfma_f32_16x16x32_bf16 v[64:67], a[160:163], a[220:223], v[64:67]
  ds_read_b64_tr_b16 a[216:217], v180 offset:4096
  ds_read_b64_tr_b16 a[218:219], v180 offset:5120
  s_waitcnt lgkmcnt(13)
  v_mfma_f32_16x16x32_bf16 v[64:67], a[168:171], a[224:227], v[64:67]
  v_mfma_f32_16x16x32_bf16 v[88:91], a[164:167], a[220:223], v[88:91]
  ds_read_b64_tr_b16 a[220:221], v180 offset:6144
  ds_read_b64_tr_b16 a[222:223], v180 offset:7168
  v_mfma_f32_16x16x32_bf16 v[88:91], a[172:175], a[224:227], v[88:91]
  ds_read_b64_tr_b16 a[224:225], v181 offset:4096
  ds_read_b64_tr_b16 a[226:227], v181 offset:5120
  v_mfma_f32_16x16x32_bf16 v[92:95], a[164:167], a[228:231], v[92:95]
  v_mfma_f32_16x16x32_bf16 v[92:95], a[172:175], a[232:235], v[92:95]
  s_load_dwordx2 s[66:67], s[36:37], 0x70000
  s_add_u32 s36, s23, s44
  s_addc_u32 s37, s45, 0
  v_mfma_f32_16x16x32_bf16 v[68:71], a[160:163], a[228:231], v[68:71]
  ds_read_b64_tr_b16 a[228:229], v181 offset:6144
L_wk0_3:
  s_cbranch_vccnz L_wk0_end
  ds_read_b64_tr_b16 a[230:231], v181 offset:7168
  v_mfma_f32_16x16x32_bf16 v[68:71], a[168:171], a[232:235], v[68:71]
  ds_read_b64_tr_b16 a[232:233], v180 offset:20480
  ds_read_b64_tr_b16 a[234:235], v180 offset:21504
  s_waitcnt lgkmcnt(13)
  v_mfma_f32_16x16x32_bf16 v[48:51], a[192:195], a[160:163], v[48:51]
  v_mfma_f32_16x16x32_bf16 v[48:51], a[196:199], a[168:171], v[48:51]
  v_mfma_f32_16x16x32_bf16 v[72:75], a[192:195], a[164:167], v[72:75]
  ds_read_b64_tr_b16 a[192:193], v180 offset:22528
  ds_read_b64_tr_b16 a[194:195], v180 offset:23552
  v_mfma_f32_16x16x32_bf16 v[72:75], a[196:199], a[172:175], v[72:75]
  ds_read_b64_tr_b16 a[196:197], v181 offset:20480
  ds_read_b64_tr_b16 a[198:199], v181 offset:21504
  v_mfma_f32_16x16x32_bf16 v[76:79], a[200:203], a[164:167], v[76:79]
  v_mfma_f32_16x16x32_bf16 v[76:79], a[204:207], a[172:175], v[76:79]
  v_mfma_f32_16x16x32_bf16 v[52:55], a[200:203], a[160:163], v[52:55]
  ds_read_b64_tr_b16 a[200:201], v181 offset:22528
  ds_read_b64_tr_b16 a[202:203], v181 offset:23552
  v_mfma_f32_16x16x32_bf16 v[52:55], a[204:207], a[168:171], v[52:55]
  s_waitcnt vmcnt(13)
  s_barrier
  ds_read_b64_tr_b16 a[204:205], v180 offset:16384
  s_waitcnt lgkmcnt(13)
  v_mfma_f32_16x16x32_bf16 v[104:107], a[208:211], v[156:159], v[104:107]
  ds_read_b64_tr_b16 a[206:207], v180 offset:17408
  ds_read_b64_tr_b16 a[208:209], v180 offset:18432
  s_mov_b32 s41, 1441792
  s_waitcnt vmcnt(3)
  v_add_u32 v248, 0, v245
  buffer_store_dword v248, v246, s[4:7], s79 offen sc1
  v_mfma_f32_16x16x32_bf16 v[108:111], v[156:159], a[212:215], v[108:111]
  ds_read_b64_tr_b16 a[210:211], v180 offset:19456
  ds_read_b64_tr_b16 a[212:213], v181 offset:16384
  s_add_u32 m0, s42, 110592
  v_mfma_f32_16x16x32_bf16 v[56:59], a[216:219], a[176:179], v[56:59]
  buffer_load_dwordx4 v241, s[8:11], s41 offen offset:0 lds
  v_mfma_f32_16x16x32_bf16 v[56:59], a[220:223], a[184:187], v[56:59]
  ds_read_b64_tr_b16 a[214:215], v181 offset:17408
  s_mov_b32 s41, 1572864
  s_add_u32 m0, s42, 126976
  v_mfma_f32_16x16x32_bf16 v[80:83], a[216:219], a[180:183], v[80:83]
  ds_read_b64_tr_b16 a[216:217], v181 offset:18432
  ds_read_b64_tr_b16 a[218:219], v181 offset:19456
  v_mfma_f32_16x16x32_bf16 v[80:83], a[220:223], a[188:191], v[80:83]
  buffer_load_dwordx4 v241, s[8:11], s41 offen offset:0 lds
  s_waitcnt lgkmcnt(13)
  v_mfma_f32_16x16x32_bf16 v[84:87], a[224:227], a[180:183], v[84:87]
  ds_read_b64_tr_b16 a[220:221], v216 offset:8192
  ds_read_b64_tr_b16 a[222:223], v216 offset:10240
  s_mov_b32 s41, 1703936
  v_mfma_f32_16x16x32_bf16 v[84:87], a[228:231], a[188:191], v[84:87]
  s_add_u32 m0, s42, 122880
  v_mfma_f32_16x16x32_bf16 v[60:63], a[224:227], a[176:179], v[60:63]
  ds_read_b64_tr_b16 a[224:225], v216 offset:24576
  ds_read_b64_tr_b16 a[226:227], v216 offset:26624
  v_mfma_f32_16x16x32_bf16 v[60:63], a[228:231], a[184:187], v[60:63]
  buffer_load_dwordx4 v241, s[8:11], s41 offen offset:0 lds
  v_mfma_f32_16x16x32_bf16 v[64:67], a[176:179], a[232:235], v[64:67]
  ds_read_b64_tr_b16 a[228:229], v214 offset:20480
  ds_read_b64_tr_b16 a[230:231], v214 offset:22528
  s_waitcnt lgkmcnt(13)
  v_mfma_f32_16x16x32_bf16 v[64:67], a[184:187], a[192:195], v[64:67]
  v_mfma_f32_16x16x32_bf16 v[88:91], a[180:183], a[232:235], v[88:91]
  ds_read_b64_tr_b16 a[232:233], v214 offset:12288
  ds_read_b64_tr_b16 a[234:235], v214 offset:14336
  v_mfma_f32_16x16x32_bf16 v[88:91], a[188:191], a[192:195], v[88:91]
  ds_read_b64_tr_b16 a[192:193], v214 offset:24576
  ds_read_b64_tr_b16 a[194:195], v214 offset:26624
  v_mfma_f32_16x16x32_bf16 v[92:95], a[180:183], a[196:199], v[92:95]
  v_mfma_f32_16x16x32_bf16 v[92:95], a[188:191], a[200:203], v[92:95]
  v_mfma_f32_16x16x32_bf16 v[68:71], a[176:179], a[196:199], v[68:71]
  ds_read_b64_tr_b16 a[196:197], v214 offset:45056
  ds_read_b64_tr_b16 a[198:199], v214 offset:47104
  v_mfma_f32_16x16x32_bf16 v[68:71], a[184:187], a[200:203], v[68:71]
  ds_read_b64_tr_b16 a[200:201], v214 offset:36864
  ds_read_b64_tr_b16 a[202:203], v214 offset:38912
  s_waitcnt lgkmcnt(13)
  v_mfma_f32_16x16x32_bf16 v[48:51], a[204:207], a[176:179], v[48:51]
  v_mfma_f32_16x16x32_bf16 v[48:51], a[208:211], a[184:187], v[48:51]
  v_mfma_f32_16x16x32_bf16 v[72:75], a[204:207], a[180:183], v[72:75]
  ds_read_b64_tr_b16 a[204:205], v214 offset:49152
  ds_read_b64_tr_b16 a[206:207], v214 offset:51200
  v_mfma_f32_16x16x32_bf16 v[72:75], a[208:211], a[188:191], v[72:75]
  ds_read_b64_tr_b16 a[208:209], v184 offset:28672
  ds_read_b64_tr_b16 a[210:211], v184 offset:29696
  v_mfma_f32_16x16x32_bf16 v[76:79], a[212:215], a[180:183], v[76:79]
  v_mfma_f32_16x16x32_bf16 v[76:79], a[216:219], a[188:191], v[76:79]
  v_mfma_f32_16x16x32_bf16 v[52:55], a[212:215], a[176:179], v[52:55]
  ds_read_b64_tr_b16 a[212:213], v182 offset:16384
  ds_read_b64_tr_b16 a[214:215], v182 offset:17408
  v_mfma_f32_16x16x32_bf16 v[52:55], a[216:219], a[184:187], v[52:55]
  s_barrier
  ds_read_b64_tr_b16 a[216:217], v180 offset:28672
  s_waitcnt lgkmcnt(13)
  v_mfma_f32_16x16x32_bf16 v[220:223], a[220:223], v[24:27], 0
  ds_read_b64_tr_b16 a[218:219], v180 offset:29696
  ds_read_b64_tr_b16 a[220:221], v180 offset:30720
  s_mov_b32 s41, 1835008
  v_mfma_f32_16x16x32_bf16 v[220:223], a[224:227], v[28:31], v[220:223]
  ds_read_b64_tr_b16 a[222:223], v180 offset:31744
  ds_read_b64_tr_b16 a[224:225], v181 offset:28672
  s_add_u32 m0, s42, 135168
  v_mfma_f32_16x16x32_bf16 v[220:223], a[228:231], v[32:35], v[220:223]
  buffer_load_dwordx4 v241, s[8:11], s41 offen offset:0 lds
  v_mfma_f32_16x16x32_bf16 v[220:223], a[232:235], v[36:39], v[220:223]
  ds_read_b64_tr_b16 a[226:227], v181 offset:29696
  ds_read_b64_tr_b16 a[228:229], v181 offset:30720
  s_mov_b32 s41, 1966080
  s_waitcnt lgkmcnt(13)
  v_mfma_f32_16x16x32_bf16 v[220:223], a[192:195], v[40:43], v[220:223]
  ds_read_b64_tr_b16 a[230:231], v181 offset:31744
  ds_read_b64_tr_b16 a[232:233], v176 offset:16384
  s_add_u32 m0, s42, 151552
  v_mfma_f32_16x16x32_bf16 v[220:223], a[196:199], v[44:47], v[220:223]
  buffer_load_dwordx4 v241, s[8:11], s41 offen offset:0 lds
  v_mfma_f32_16x16x32_bf16 v[220:223], a[200:203], v[96:99], v[220:223]
  ds_read_b64_tr_b16 a[234:235], v176 offset:17408
  ds_read_b64_tr_b16 a[192:193], v176 offset:18432
  s_mov_b32 s41, 65536
  s_waitcnt lgkmcnt(13)
  v_mfma_f32_16x16x32_bf16 v[220:223], a[204:207], v[100:103], v[220:223]
  ds_read_b64_tr_b16 a[194:195], v176 offset:19456
  ds_read_b64_tr_b16 a[196:197], v177 offset:16384
  s_add_u32 m0, s42, 147456
  v_mfma_f32_16x16x32_bf16 v[104:107], a[208:211], v[160:163], v[104:107]
  ds_read_b64_tr_b16 a[198:199], v177 offset:17408
  ds_read_b64_tr_b16 a[200:201], v177 offset:18432
  v_mov_b32 v217, 0xff
  s_waitcnt lgkmcnt(13)
  v_mfma_f32_16x16x32_bf16 v[108:111], v[160:163], a[212:215], v[108:111]
  buffer_load_dwordx4 v241, s[8:11], s41 offen offset:0 lds
  v_bfi_b32 v220, v217, s84, v220
  v_mfma_f32_16x16x32_bf16 v[56:59], a[216:219], a[0:3], v[56:59]
  ds_read_b64_tr_b16 a[202:203], v177 offset:19456
  ds_read_b64_tr_b16 a[204:205], v176 offset:28672
  v_bfi_b32 v221, v217, s85, v221
  s_waitcnt lgkmcnt(13)
  v_mfma_f32_16x16x32_bf16 v[56:59], a[220:223], a[8:11], v[56:59]
  ds_read_b64_tr_b16 a[206:207], v176 offset:29696
  ds_read_b64_tr_b16 a[208:209], v176 offset:30720
  buffer_load_dword v244, v243, s[4:7], s88 offen sc1
  v_mfma_f32_16x16x32_bf16 v[80:83], a[216:219], a[4:7], v[80:83]
  ds_read_b64_tr_b16 a[210:211], v176 offset:31744
  ds_read_b64_tr_b16 a[212:213], v177 offset:28672
  v_bfi_b32 v222, v217, s86, v222
  v_mfma_f32_16x16x32_bf16 v[80:83], a[220:223], a[12:15], v[80:83]
  ds_read_b64_tr_b16 a[214:215], v177 offset:29696
  ds_read_b64_tr_b16 a[216:217], v177 offset:30720
  v_bfi_b32 v223, v217, s87, v223
  s_waitcnt lgkmcnt(13)
  v_mfma_f32_16x16x32_bf16 v[84:87], a[224:227], a[4:7], v[84:87]
  ds_read_b64_tr_b16 a[218:219], v177 offset:31744
  ds_read_b64_tr_b16 a[220:221], v182 offset:32768
  v_mfma_f32_16x16x32_bf16 v[84:87], a[228:231], a[12:15], v[84:87]
  ds_read_b64_tr_b16 a[222:223], v182 offset:33792
  buffer_store_dwordx4 v[220:223], v218, s[4:7], 0 offen sc1
  v_mfma_f32_16x16x32_bf16 v[60:63], a[224:227], a[0:3], v[60:63]
  ds_read_b64_tr_b16 a[224:225], v182 offset:40960
  ds_read_b64_tr_b16 a[226:227], v182 offset:41984
  v_mfma_f32_16x16x32_bf16 v[60:63], a[228:231], a[8:11], v[60:63]
  ds_read_b64_tr_b16 a[228:229], v176 offset:32768
  ds_read_b64_tr_b16 a[230:231], v176 offset:33792
  v_mfma_f32_16x16x32_bf16 v[64:67], a[0:3], a[232:235], v[64:67]
  s_waitcnt lgkmcnt(13)
  v_mfma_f32_16x16x32_bf16 v[64:67], a[8:11], a[192:195], v[64:67]
  buffer_load_dwordx4 v[32:35], v249, s[48:51], 0 offen offset:0
  v_mfma_f32_16x16x32_bf16 v[88:91], a[4:7], a[232:235], v[88:91]
  ds_read_b64_tr_b16 a[232:233], v176 offset:34816
  ds_read_b64_tr_b16 a[234:235], v176 offset:35840
  v_mfma_f32_16x16x32_bf16 v[88:91], a[12:15], a[192:195], v[88:91]
  ds_read_b64_tr_b16 a[192:193], v177 offset:32768
  ds_read_b64_tr_b16 a[194:195], v177 offset:33792
  v_mfma_f32_16x16x32_bf16 v[92:95], a[4:7], a[196:199], v[92:95]
  v_mfma_f32_16x16x32_bf16 v[92:95], a[12:15], a[200:203], v[92:95]
  buffer_load_dwordx4 v[36:39], v249, s[48:51], 0 offen offset:64
  v_mfma_f32_16x16x32_bf16 v[68:71], a[0:3], a[196:199], v[68:71]
  ds_read_b64_tr_b16 a[196:197], v177 offset:34816
  ds_read_b64_tr_b16 a[198:199], v177 offset:35840
  v_mfma_f32_16x16x32_bf16 v[68:71], a[8:11], a[200:203], v[68:71]
  ds_read_b64_tr_b16 a[200:201], v176 offset:40960
  ds_read_b64_tr_b16 a[202:203], v176 offset:41984
  s_waitcnt lgkmcnt(13)
  v_mfma_f32_16x16x32_bf16 v[48:51], a[204:207], a[0:3], v[48:51]
  v_mfma_f32_16x16x32_bf16 v[48:51], a[208:211], a[8:11], v[48:51]
  buffer_load_dwordx4 v[40:43], v249, s[48:51], s38 offen offset:0
  v_mfma_f32_16x16x32_bf16 v[72:75], a[204:207], a[4:7], v[72:75]
  ds_read_b64_tr_b16 a[204:205], v176 offset:43008
  ds_read_b64_tr_b16 a[206:207], v176 offset:44032
  v_mfma_f32_16x16x32_bf16 v[72:75], a[208:211], a[12:15], v[72:75]
  ds_read_b64_tr_b16 a[208:209], v177 offset:40960
  ds_read_b64_tr_b16 a[210:211], v177 offset:41984
  v_mfma_f32_16x16x32_bf16 v[76:79], a[212:215], a[4:7], v[76:79]
  v_mfma_f32_16x16x32_bf16 v[76:79], a[216:219], a[12:15], v[76:79]
  buffer_load_dwordx4 v[44:47], v249, s[48:51], s38 offen offset:64
  v_mfma_f32_16x16x32_bf16 v[52:55], a[212:215], a[0:3], v[52:55]
  ds_read_b64_tr_b16 a[212:213], v177 offset:43008
  ds_read_b64_tr_b16 a[214:215], v177 offset:44032
  v_mfma_f32_16x16x32_bf16 v[52:55], a[216:219], a[8:11], v[52:55]
  s_barrier
  ds_read_b64_tr_b16 a[216:217], v176 offset:53248
  s_waitcnt lgkmcnt(13)
  v_mfma_f32_16x16x32_bf16 v[104:107], a[220:223], v[164:167], v[104:107]
  ds_read_b64_tr_b16 a[218:219], v176 offset:54272
  ds_read_b64_tr_b16 a[220:221], v176 offset:55296
  s_mov_b32 s41, 196608
  v_mfma_f32_16x16x32_bf16 v[108:111], v[164:167], a[224:227], v[108:111]
  ds_read_b64_tr_b16 a[222:223], v176 offset:56320
  ds_read_b64_tr_b16 a[224:225], v177 offset:53248
  s_add_u32 m0, s42, 159744
  v_mfma_f32_16x16x32_bf16 v[56:59], a[228:231], a[16:19], v[56:59]
  buffer_load_dwordx4 v241, s[8:11], s41 offen offset:0 lds
  v_mfma_f32_16x16x32_bf16 v[56:59], a[232:235], a[24:27], v[56:59]
  ds_read_b64_tr_b16 a[226:227], v177 offset:54272
  s_mov_b32 s41, 327680
  s_add_u32 m0, s42, 16384
  v_mfma_f32_16x16x32_bf16 v[80:83], a[228:231], a[20:23], v[80:83]
  ds_read_b64_tr_b16 a[228:229], v177 offset:55296
  ds_read_b64_tr_b16 a[230:231], v177 offset:56320
  v_mfma_f32_16x16x32_bf16 v[80:83], a[232:235], a[28:31], v[80:83]
  buffer_load_dwordx4 v241, s[8:11], s41 offen offset:0 lds
  s_waitcnt lgkmcnt(13)
  v_mfma_f32_16x16x32_bf16 v[84:87], a[192:195], a[20:23], v[84:87]
  ds_read_b64_tr_b16 a[232:233], v182 offset:57344
  ds_read_b64_tr_b16 a[234:235], v182 offset:58368
  s_mov_b32 s41, 458752
  v_mfma_f32_16x16x32_bf16 v[84:87], a[196:199], a[28:31], v[84:87]
  s_add_u32 m0, s42, 28672
  v_mfma_f32_16x16x32_bf16 v[60:63], a[192:195], a[16:19], v[60:63]
  ds_read_b64_tr_b16 a[192:193], v183 offset:0
  ds_read_b64_tr_b16 a[194:195], v183 offset:1024
  v_mfma_f32_16x16x32_bf16 v[60:63], a[196:199], a[24:27], v[60:63]
  buffer_load_dwordx4 v241, s[8:11], s41 offen offset:0 lds
  v_mfma_f32_16x16x32_bf16 v[64:67], a[16:19], a[200:203], v[64:67]
  ds_read_b64_tr_b16 a[196:197], v183 offset:40960
  ds_read_b64_tr_b16 a[198:199], v183 offset:41984
  s_mov_b32 s41, 589824
  s_waitcnt lgkmcnt(13)
  v_mfma_f32_16x16x32_bf16 v[64:67], a[24:27], a[204:207], v[64:67]
  s_add_u32 m0, s42, 139264
  v_mfma_f32_16x16x32_bf16 v[88:91], a[20:23], a[200:203], v[88:91]
  ds_read_b64_tr_b16 a[200:201], v183 offset:49152
  ds_read_b64_tr_b16 a[202:203], v183 offset:50176
  v_mfma_f32_16x16x32_bf16 v[88:91], a[28:31], a[204:207], v[88:91]
  buffer_load_dwordx4 v241, s[8:11], s41 offen offset:0 lds
  v_mfma_f32_16x16x32_bf16 v[92:95], a[20:23], a[208:211], v[92:95]
  ds_read_b64_tr_b16 a[204:205], v176 offset:57344
  ds_read_b64_tr_b16 a[206:207], v176 offset:58368
  s_mov_b32 s41, 720896
  v_mfma_f32_16x16x32_bf16 v[92:95], a[28:31], a[212:215], v[92:95]
  s_add_u32 m0, s42, 155648
  v_mfma_f32_16x16x32_bf16 v[68:71], a[16:19], a[208:211], v[68:71]
  ds_read_b64_tr_b16 a[208:209], v176 offset:59392
  ds_read_b64_tr_b16 a[210:211], v176 offset:60416
  v_mfma_f32_16x16x32_bf16 v[68:71], a[24:27], a[212:215], v[68:71]
  buffer_load_dwordx4 v241, s[8:11], s41 offen offset:0 lds
  s_waitcnt vmcnt(10)
  v_subrev_u32 v244, s100, v244
  v_cmp_lt_u32 s[68:69], 7, v244
  s_waitcnt lgkmcnt(13)
  v_mfma_f32_16x16x32_bf16 v[48:51], a[216:219], a[16:19], v[48:51]
  ds_read_b64_tr_b16 a[212:213], v177 offset:57344
  ds_read_b64_tr_b16 a[214:215], v177 offset:58368
  s_mov_b32 s41, 851968
  s_cmp_lg_u64 s[68:69], 0
  s_cbranch_scc1 L_slow_14
L_back_15:
  v_mfma_f32_16x16x32_bf16 v[48:51], a[220:223], a[24:27], v[48:51]
  s_add_u32 m0, s42, 20480
  v_mfma_f32_16x16x32_bf16 v[72:75], a[216:219], a[20:23], v[72:75]
  ds_read_b64_tr_b16 a[216:217], v177 offset:59392
  ds_read_b64_tr_b16 a[218:219], v177 offset:60416
  v_mfma_f32_16x16x32_bf16 v[72:75], a[220:223], a[28:31], v[72:75]
  buffer_load_dwordx4 v241, s[8:11], s41 offen offset:0 lds
  v_mfma_f32_16x16x32_bf16 v[76:79], a[224:227], a[20:23], v[76:79]
  ds_read_b64_tr_b16 a[220:221], v178 offset:0
  ds_read_b64_tr_b16 a[222:223], v178 offset:1024
  s_mov_b32 s40, 5242880
  s_waitcnt lgkmcnt(13)
  v_mfma_f32_16x16x32_bf16 v[76:79], a[228:231], a[28:31], v[76:79]
  v_mfma_f32_16x16x32_bf16 v[52:55], a[224:227], a[16:19], v[52:55]
  ds_read_b64_tr_b16 a[224:225], v178 offset:2048
  ds_read_b64_tr_b16 a[226:227], v178 offset:3072
  v_mfma_f32_16x16x32_bf16 v[52:55], a[228:231], a[24:27], v[52:55]
  s_barrier
  ds_read_b64_tr_b16 a[228:229], v179 offset:0
  v_mfma_f32_16x16x32_bf16 v[104:107], a[232:235], v[168:171], v[104:107]
  buffer_load_dwordx4 a[64:67], v240, s[4:7], s40 offen offset:0 sc1
  v_mfma_f32_16x16x32_bf16 v[108:111], v[168:171], a[192:195], v[108:111]
  ds_read_b64_tr_b16 a[230:231], v179 offset:1024
  ds_read_b64_tr_b16 a[232:233], v179 offset:2048
  s_waitcnt lgkmcnt(13)
  v_mfma_f32_16x16x32_bf16 v[104:107], a[196:199], v[172:175], v[104:107]
  ds_read_b64_tr_b16 a[234:235], v179 offset:3072
  ds_read_b64_tr_b16 a[192:193], v178 offset:28672
  v_mfma_f32_16x16x32_bf16 v[108:111], v[172:175], a[200:203], v[108:111]
  buffer_load_dwordx4 a[68:71], v240, s[4:7], s40 offen offset:1024 sc1
  s_mov_b32 s40, 5373952
  v_mfma_f32_16x16x32_bf16 v[56:59], a[204:207], a[32:35], v[56:59]
  ds_read_b64_tr_b16 a[194:195], v178 offset:29696
  ds_read_b64_tr_b16 a[196:197], v178 offset:30720
  ds_write_b128 v192, v[104:107] offset:0
  s_waitcnt lgkmcnt(13)
  v_mfma_f32_16x16x32_bf16 v[56:59], a[208:211], a[40:43], v[56:59]
  ds_read_b64_tr_b16 a[198:199], v178 offset:31744
  ds_read_b64_tr_b16 a[200:201], v179 offset:28672
  ds_write_b128 v192, v[108:111] offset:1024
  v_mfma_f32_16x16x32_bf16 v[80:83], a[204:207], a[36:39], v[80:83]
  ds_read_b64_tr_b16 a[202:203], v179 offset:29696
  ds_read_b64_tr_b16 a[204:205], v179 offset:30720
  v_mfma_f32_16x16x32_bf16 v[80:83], a[208:211], a[44:47], v[80:83]
  buffer_load_dwordx4 a[72:75], v240, s[4:7], s40 offen offset:0 sc1
  v_mfma_f32_16x16x32_bf16 v[84:87], a[212:215], a[36:39], v[84:87]
  ds_read_b64_tr_b16 a[206:207], v179 offset:31744
  ds_read_b64_tr_b16 a[208:209], v178 offset:40960
  s_waitcnt lgkmcnt(13)
  v_mfma_f32_16x16x32_bf16 v[84:87], a[216:219], a[44:47], v[84:87]
  ds_read_b64_tr_b16 a[210:211], v178 offset:41984
  v_mfma_f32_16x16x32_bf16 v[60:63], a[212:215], a[32:35], v[60:63]
  ds_read_b64_tr_b16 a[212:213], v178 offset:43008
  ds_read_b64_tr_b16 a[214:215], v178 offset:44032
  v_mfma_f32_16x16x32_bf16 v[60:63], a[216:219], a[40:43], v[60:63]
  buffer_load_dwordx4 a[76:79], v240, s[4:7], s40 offen offset:1024 sc1
  v_mfma_f32_16x16x32_bf16 v[64:67], a[32:35], a[220:223], v[64:67]
  ds_read_b64_tr_b16 a[216:217], v179 offset:40960
  ds_read_b64_tr_b16 a[218:219], v179 offset:41984
  s_mov_b32 s40, 5505024
  s_waitcnt lgkmcnt(9)
  v_mfma_f32_16x16x32_bf16 v[64:67], a[40:43], a[224:227], v[64:67]
  v_mfma_f32_16x16x32_bf16 v[88:91], a[36:39], a[220:223], v[88:91]
  ds_read_b64_tr_b16 a[220:221], v179 offset:43008
  ds_read_b64_tr_b16 a[222:223], v179 offset:44032
  v_mfma_f32_16x16x32_bf16 v[88:91], a[44:47], a[224:227], v[88:91]
  buffer_load_dwordx4 a[80:83], v240, s[4:7], s40 offen offset:0 sc1
  v_mfma_f32_16x16x32_bf16 v[92:95], a[36:39], a[228:231], v[92:95]
  ds_read_b64_tr_b16 a[224:225], v178 offset:49152
  ds_read_b64_tr_b16 a[226:227], v178 offset:50176
  v_mfma_f32_16x16x32_bf16 v[92:95], a[44:47], a[232:235], v[92:95]
  v_mfma_f32_16x16x32_bf16 v[68:71], a[32:35], a[228:231], v[68:71]
  ds_read_b64_tr_b16 a[228:229], v178 offset:51200
  ds_read_b64_tr_b16 a[230:231], v178 offset:52224
  v_mfma_f32_16x16x32_bf16 v[68:71], a[40:43], a[232:235], v[68:71]
  buffer_load_dwordx4 a[84:87], v240, s[4:7], s40 offen offset:1024 sc1
  s_mov_b32 s40, 5636096
  v_mfma_f32_16x16x32_bf16 v[48:51], a[192:195], a[32:35], v[48:51]
  ds_read_b64_tr_b16 a[232:233], v179 offset:49152
  ds_read_b64_tr_b16 a[234:235], v179 offset:50176
  v_mfma_f32_16x16x32_bf16 v[48:51], a[196:199], a[40:43], v[48:51]
  v_mfma_f32_16x16x32_bf16 v[72:75], a[192:195], a[36:39], v[72:75]
  ds_read_b64_tr_b16 a[192:193], v179 offset:51200
  ds_read_b64_tr_b16 a[194:195], v179 offset:52224
  v_mfma_f32_16x16x32_bf16 v[72:75], a[196:199], a[44:47], v[72:75]
  buffer_load_dwordx4 a[88:91], v240, s[4:7], s40 offen offset:0 sc1
  s_waitcnt lgkmcnt(13)
  v_mfma_f32_16x16x32_bf16 v[76:79], a[200:203], a[36:39], v[76:79]
  ds_read_b64_tr_b16 a[196:197], v180 offset:12288
  ds_read_b64_tr_b16 a[198:199], v180 offset:13312
  v_mfma_f32_16x16x32_bf16 v[76:79], a[204:207], a[44:47], v[76:79]
  v_mfma_f32_16x16x32_bf16 v[52:55], a[200:203], a[32:35], v[52:55]
  ds_read_b64_tr_b16 a[200:201], v180 offset:14336
  ds_read_b64_tr_b16 a[202:203], v180 offset:15360
  v_mfma_f32_16x16x32_bf16 v[52:55], a[204:207], a[40:43], v[52:55]
  s_barrier
  ds_read_b64_tr_b16 a[204:205], v181 offset:12288
  ds_read_b128 v[200:203], v191 offset:0
  ds_read_b128 v[204:207], v191 offset:1024
  v_mfma_f32_16x16x32_bf16 v[56:59], a[208:211], a[48:51], v[56:59]
  buffer_load_dwordx4 a[92:95], v240, s[4:7], s40 offen offset:1024 sc1
  s_waitcnt lgkmcnt(13)
  v_mfma_f32_16x16x32_bf16 v[56:59], a[212:215], a[56:59], v[56:59]
  ds_read_b64_tr_b16 a[206:207], v181 offset:13312
  s_mov_b32 s40, 5767168
  v_mfma_f32_16x16x32_bf16 v[80:83], a[208:211], a[52:55], v[80:83]
  ds_read_b64_tr_b16 a[208:209], v181 offset:14336
  ds_read_b64_tr_b16 a[210:211], v181 offset:15360
  v_mfma_f32_16x16x32_bf16 v[80:83], a[212:215], a[60:63], v[80:83]
  buffer_load_dwordx4 a[96:99], v240, s[4:7], s40 offen offset:0 sc1
  v_mfma_f32_16x16x32_bf16 v[84:87], a[216:219], a[52:55], v[84:87]
  ds_read_b64_tr_b16 a[212:213], v232 offset:4096
  ds_read_b64_tr_b16 a[214:215], v232 offset:6144
  v_mfma_f32_16x16x32_bf16 v[84:87], a[220:223], a[60:63], v[84:87]
  v_mfma_f32_16x16x32_bf16 v[60:63], a[216:219], a[48:51], v[60:63]
  ds_read_b64_tr_b16 a[216:217], v232 offset:16384
  ds_read_b64_tr_b16 a[218:219], v232 offset:18432
  v_mfma_f32_16x16x32_bf16 v[60:63], a[220:223], a[56:59], v[60:63]
  buffer_load_dwordx4 a[100:103], v240, s[4:7], s40 offen offset:1024 sc1
  s_mov_b32 s40, 5898240
  v_mfma_f32_16x16x32_bf16 v[64:67], a[48:51], a[224:227], v[64:67]
  ds_read_b64_tr_b16 a[220:221], v233 offset:4096
  ds_read_b64_tr_b16 a[222:223], v233 offset:6144
  s_waitcnt lgkmcnt(9)
  v_add_f32 v200, v200, v104
  v_add_f32 v201, v201, v105
  v_add_f32 v202, v202, v106
  v_add_f32 v203, v203, v107
  v_add_f32 v204, v204, v108
  v_add_f32 v205, v205, v109
  v_add_f32 v206, v206, v110
  v_add_f32 v207, v207, v111
  v_cvt_pk_bf16_f32 v196, v200, v201
  v_cvt_pk_bf16_f32 v197, v202, v203
  v_mfma_f32_16x16x32_bf16 v[64:67], a[56:59], a[228:231], v[64:67]
  v_cvt_pk_bf16_f32 v198, v204, v205
  v_cvt_pk_bf16_f32 v199, v206, v207
  ds_write_b64 v208, v[196:197] offset:0
  ds_write_b64 v208, v[198:199] offset:1024
  v_cvt_pk_bf16_f32 v128, v80, v81
  v_cvt_pk_bf16_f32 v129, v82, v83
  v_mfma_f32_16x16x32_bf16 v[88:91], a[52:55], a[224:227], v[88:91]
  ds_read_b64_tr_b16 a[224:225], v233 offset:16384
  ds_read_b64_tr_b16 a[226:227], v233 offset:18432
  v_cvt_pk_bf16_f32 v130, v84, v85
  v_cvt_pk_bf16_f32 v131, v86, v87
  ds_write_b128 v191, v[128:131]
  v_cvt_pk_bf16_f32 v124, v56, v57
  v_cvt_pk_bf16_f32 v125, v58, v59
  v_cvt_pk_bf16_f32 v126, v60, v61
  v_mfma_f32_16x16x32_bf16 v[88:91], a[60:63], a[228:231], v[88:91]
  buffer_load_dwordx4 a[104:107], v240, s[4:7], s40 offen offset:0 sc1
  v_cvt_pk_bf16_f32 v127, v62, v63
  v_mfma_f32_16x16x32_bf16 v[92:95], a[52:55], a[232:235], v[92:95]
  ds_read_b64_tr_b16 a[228:229], v234 offset:4096
  ds_read_b64_tr_b16 a[230:231], v234 offset:6144
  v_mfma_f32_16x16x32_bf16 v[92:95], a[60:63], a[192:195], v[92:95]
  v_mfma_f32_16x16x32_bf16 v[68:71], a[48:51], a[232:235], v[68:71]
  ds_read_b64_tr_b16 a[232:233], v234 offset:16384
  ds_read_b64_tr_b16 a[234:235], v234 offset:18432
  v_mfma_f32_16x16x32_bf16 v[68:71], a[56:59], a[192:195], v[68:71]
  buffer_load_dwordx4 a[108:111], v240, s[4:7], s40 offen offset:1024 sc1
  v_cvt_pk_bf16_f32 v136, v88, v89
  v_cvt_pk_bf16_f32 v137, v90, v91
  v_mfma_f32_16x16x32_bf16 v[48:51], a[196:199], a[48:51], v[48:51]
  ds_read_b64_tr_b16 a[192:193], v235 offset:4096
  ds_read_b64_tr_b16 a[194:195], v235 offset:6144
  s_mov_b32 s40, 6029312
  v_cvt_pk_bf16_f32 v142, v92, v93
  v_cvt_pk_bf16_f32 v143, v94, v95
  ds_write_b64 v191, v[136:137] offset:1024
  ds_write_b64 v191, v[142:143] offset:1032
  v_cvt_pk_bf16_f32 v134, v64, v65
  v_cvt_pk_bf16_f32 v135, v66, v67
  v_cvt_pk_bf16_f32 v140, v68, v69
  v_cvt_pk_bf16_f32 v141, v70, v71
  v_mfma_f32_16x16x32_bf16 v[48:51], a[200:203], a[56:59], v[48:51]
  v_mfma_f32_16x16x32_bf16 v[72:75], a[196:199], a[52:55], v[72:75]
  ds_read_b64_tr_b16 a[196:197], v235 offset:16384
  ds_read_b64_tr_b16 a[198:199], v235 offset:18432
  v_mfma_f32_16x16x32_bf16 v[72:75], a[200:203], a[60:63], v[72:75]
  buffer_load_dwordx4 a[112:115], v240, s[4:7], s40 offen offset:0 sc1
  s_waitcnt lgkmcnt(13)
  v_mfma_f32_16x16x32_bf16 v[76:79], a[204:207], a[52:55], v[76:79]
  ds_read_b64_tr_b16 a[200:201], v228 offset:61440
  ds_read_b64_tr_b16 a[202:203], v228 offset:63488
  v_mfma_f32_16x16x32_bf16 v[76:79], a[208:211], a[60:63], v[76:79]
  v_mfma_f32_16x16x32_bf16 v[52:55], a[204:207], a[48:51], v[52:55]
  ds_read_b64_tr_b16 a[204:205], v232 offset:24576
  ds_read_b64_tr_b16 a[206:207], v232 offset:26624
  v_mfma_f32_16x16x32_bf16 v[52:55], a[208:211], a[56:59], v[52:55]
  v_cvt_pk_bf16_f32 v116, v72, v73
  v_cvt_pk_bf16_f32 v117, v74, v75
  s_nop 1
  v_cvt_pk_bf16_f32 v118, v76, v77
  v_cvt_pk_bf16_f32 v119, v78, v79
  v_cvt_pk_bf16_f32 v112, v48, v49
  buffer_load_dwordx4 a[116:119], v240, s[4:7], s40 offen offset:1024 sc1
  v_cvt_pk_bf16_f32 v113, v50, v51
  v_cvt_pk_bf16_f32 v114, v52, v53
  v_cvt_pk_bf16_f32 v115, v54, v55
  s_waitcnt lgkmcnt(6)
  s_barrier
  ds_read_b128 v[120:123], v209
  s_mov_b32 s40, 6160384
  buffer_load_dwordx4 a[120:123], v240, s[4:7], s40 offen offset:0 sc1
  ds_read_b64 v[132:133], v209 offset:1024
  ds_read_b64 v[138:139], v209 offset:1032
  v_mfma_f32_16x16x32_bf16 v[52:55], v[128:131], v[116:119], 0
  v_mfma_f32_16x16x32_bf16 v[48:51], v[124:127], v[116:119], 0
  v_mfma_f32_16x16x32_bf16 v[60:63], v[124:127], v[112:115], 0
  buffer_load_dwordx4 a[124:127], v240, s[4:7], s40 offen offset:1024 sc1
  s_waitcnt lgkmcnt(0)
  v_mfma_f32_16x16x32_bf16 v[56:59], v[120:123], v[112:115], 0
  s_nop 3
  v_cndmask_b32_e64 v48, v48, v49, s[28:29]
  v_cndmask_b32_e64 v50, v50, v51, s[28:29]
  v_cndmask_b32_e64 v52, v52, v53, s[28:29]
  v_cndmask_b32_e64 v54, v54, v55, s[28:29]
  s_mov_b32 s40, 6291456
  buffer_load_dwordx4 a[128:131], v240, s[4:7], s40 offen offset:0 sc1
  v_cndmask_b32_e64 v56, v56, v57, s[28:29]
  v_cndmask_b32_e64 v58, v58, v59, s[28:29]
  v_cndmask_b32_e64 v60, v60, v61, s[28:29]
  v_cndmask_b32_e64 v62, v62, v63, s[28:29]
  v_cndmask_b32_e64 v48, v48, v52, s[24:25]
  buffer_load_dwordx4 a[132:135], v240, s[4:7], s40 offen offset:1024 sc1
  v_cndmask_b32_e64 v49, v50, v54, s[26:27]
  v_cndmask_b32_e64 v56, v56, v60, s[24:25]
  v_cndmask_b32_e64 v57, v58, v62, s[26:27]
  s_mov_b32 s33, 0x3e8293ee
  v_mul_f32 v48, s33, v48
  v_mul_f32 v49, s33, v49
  v_fma_f32 v56, v56, s33, v193
  v_fma_f32 v57, v57, s33, v194
  v_max_f32 v64, v48, v49
  s_mov_b32 s40, 6422528
  buffer_load_dwordx4 a[136:139], v240, s[4:7], s40 offen offset:0 sc1
  v_max_f32 v65, v56, v57
  v_mov_b32 v68, v64
  v_mov_b32 v69, v65
  s_nop 0
  v_permlane16_swap_b32 v68, v64
  v_permlane16_swap_b32 v69, v65
  buffer_load_dwordx4 a[140:143], v240, s[4:7], s40 offen offset:1024 sc1
  v_max_f32 v64, v64, v68
  v_max_f32 v65, v65, v69
  v_mov_b32 v68, v64
  v_mov_b32 v69, v65
  s_nop 0
  v_permlane32_swap_b32 v68, v64
  s_mov_b32 s40, 6553600
  buffer_load_dwordx4 a[144:147], v240, s[4:7], s40 offen offset:0 sc1
  v_permlane32_swap_b32 v69, v65
  v_max_f32 v64, v64, v68
  s_nop 0
  v_max_f32 v65, v65, v69
  v_sub_f32 v48, v48, v64
  v_sub_f32 v49, v49, v64
  buffer_load_dwordx4 a[148:151], v240, s[4:7], s40 offen offset:1024 sc1
  v_sub_f32 v56, v56, v65
  v_sub_f32 v57, v57, v65
  v_exp_f32 v48, v48
  v_exp_f32 v49, v49
  v_exp_f32 v56, v56
  s_mov_b32 s40, 6684672
  buffer_load_dwordx4 a[152:155], v240, s[4:7], s40 offen offset:0 sc1
  v_exp_f32 v57, v57
  v_add_f32 v64, v48, v49
  v_add_f32 v65, v56, v57
  v_mov_b32 v68, v64
  v_mov_b32 v69, v65
  buffer_load_dwordx4 a[156:159], v240, s[4:7], s40 offen offset:1024 sc1
  v_permlane16_swap_b32 v68, v64
  v_permlane16_swap_b32 v69, v65
  s_nop 0
  v_add_f32 v64, v64, v68
  v_add_f32 v65, v65, v69
  v_mov_b32 v68, v64
  s_mov_b32 s40, 6815744
  buffer_load_dwordx4 a[160:163], v240, s[4:7], s40 offen offset:0 sc1
  v_mov_b32 v69, v65
  v_permlane32_swap_b32 v68, v64
  s_nop 0
  v_permlane32_swap_b32 v69, v65
  v_add_f32 v64, v64, v68
  s_nop 0
  v_add_f32 v65, v65, v69
  buffer_load_dwordx4 a[164:167], v240, s[4:7], s40 offen offset:1024 sc1
  v_rcp_f32 v64, v64
  v_rcp_f32 v65, v65
  v_mul_f32 v48, v48, v64
  v_mul_f32 v49, v49, v64
  v_mul_f32 v56, v56, v65
  s_mov_b32 s40, 6946816
  buffer_load_dwordx4 a[168:171], v240, s[4:7], s40 offen offset:0 sc1
L_wk0_4:
  s_cbranch_vccnz L_wk0_end
  v_mul_f32 v57, v57, v65
  v_cvt_pk_bf16_f32 v48, v48, 0
  v_cvt_pk_bf16_f32 v49, v49, 0
  v_cvt_pk_bf16_f32 v56, v56, 0
  v_cvt_pk_bf16_f32 v57, v57, 0
  buffer_load_dwordx4 a[172:175], v240, s[4:7], s40 offen offset:1024 sc1
  v_lshlrev_b32 v48, v195, v48
  v_lshlrev_b32 v49, v195, v49
  v_lshlrev_b32 v56, v195, v56
  v_lshlrev_b32 v57, v195, v57
  v_cndmask_b32_e64 v112, v48, 0, s[24:25]
  s_mov_b32 s40, 7077888
  buffer_load_dwordx4 a[176:179], v240, s[4:7], s40 offen offset:0 sc1
  v_cndmask_b32_e64 v114, 0, v48, s[24:25]
  v_cndmask_b32_e64 v113, v49, 0, s[26:27]
  v_cndmask_b32_e64 v115, 0, v49, s[26:27]
  v_cndmask_b32_e64 v116, v56, 0, s[24:25]
  v_cndmask_b32_e64 v118, 0, v56, s[24:25]
  v_cndmask_b32_e64 v117, v57, 0, s[26:27]
  v_cndmask_b32_e64 v119, 0, v57, s[26:27]
  v_mfma_f32_16x16x32_bf16 v[48:51], v[134:137], v[112:115], 0
  v_mfma_f32_16x16x32_bf16 v[52:55], v[140:143], v[112:115], 0
  v_mfma_f32_16x16x32_bf16 v[56:59], v[132:135], v[116:119], 0
  v_mfma_f32_16x16x32_bf16 v[60:63], v[138:141], v[116:119], 0
  s_nop 4
  v_cvt_pk_bf16_f32 v120, v48, v49
  v_cvt_pk_bf16_f32 v121, v50, v51
  v_cvt_pk_bf16_f32 v122, v52, v53
  v_cvt_pk_bf16_f32 v123, v54, v55
  buffer_store_dwordx4 v[120:123], v187, s[4:7], s78 offen offset:1024 sc1
  v_cvt_pk_bf16_f32 v124, v56, v57
  v_cvt_pk_bf16_f32 v125, v58, v59
  v_cvt_pk_bf16_f32 v126, v60, v61
  v_cvt_pk_bf16_f32 v127, v62, v63
  buffer_store_dwordx4 v[124:127], v187, s[4:7], s78 offen offset:0 sc1
  s_add_u32 s78, s78, 2097152
  ds_read_b64_tr_b16 a[208:209], v229 offset:61440
  ds_read_b64_tr_b16 a[210:211], v229 offset:63488
  s_waitcnt vmcnt(27)
  v_mfma_f32_16x16x32_bf16 v[0:3], a[212:215], a[64:67], 0
  v_mfma_f32_16x16x32_bf16 v[0:3], a[216:219], a[72:75], v[0:3]
  v_mfma_f32_16x16x32_bf16 v[16:19], a[212:215], a[68:71], 0
  ds_read_b64_tr_b16 a[212:213], v233 offset:24576
  ds_read_b64_tr_b16 a[214:215], v233 offset:26624
  v_mfma_f32_16x16x32_bf16 v[16:19], a[216:219], a[76:79], v[16:19]
  ds_read_b64_tr_b16 a[216:217], v230 offset:61440
  ds_read_b64_tr_b16 a[218:219], v230 offset:63488
  v_mfma_f32_16x16x32_bf16 v[20:23], a[220:223], a[68:71], 0
  v_mfma_f32_16x16x32_bf16 v[20:23], a[224:227], a[76:79], v[20:23]
  v_mfma_f32_16x16x32_bf16 v[4:7], a[220:223], a[64:67], 0
  ds_read_b64_tr_b16 a[220:221], v234 offset:24576
  ds_read_b64_tr_b16 a[222:223], v234 offset:26624
  v_mfma_f32_16x16x32_bf16 v[4:7], a[224:227], a[72:75], v[4:7]
  ds_read_b64_tr_b16 a[224:225], v231 offset:61440
  ds_read_b64_tr_b16 a[226:227], v231 offset:63488
  v_mfma_f32_16x16x32_bf16 v[8:11], a[228:231], a[64:67], 0
  v_mfma_f32_16x16x32_bf16 v[8:11], a[232:235], a[72:75], v[8:11]
  v_mfma_f32_16x16x32_bf16 v[24:27], a[228:231], a[68:71], 0
  ds_read_b64_tr_b16 a[228:229], v235 offset:24576
  ds_read_b64_tr_b16 a[230:231], v235 offset:26624
  v_mfma_f32_16x16x32_bf16 v[24:27], a[232:235], a[76:79], v[24:27]
  ds_read_b64_tr_b16 a[232:233], v232 offset:53248
  ds_read_b64_tr_b16 a[234:235], v232 offset:55296
  v_mfma_f32_16x16x32_bf16 v[28:31], a[192:195], a[68:71], 0
  v_mfma_f32_16x16x32_bf16 v[28:31], a[196:199], a[76:79], v[28:31]
  v_mfma_f32_16x16x32_bf16 v[12:15], a[192:195], a[64:67], 0
  ds_read_b64_tr_b16 a[192:193], v236 offset:0
  ds_read_b64_tr_b16 a[194:195], v236 offset:2048
  v_mfma_f32_16x16x32_bf16 v[12:15], a[196:199], a[72:75], v[12:15]
  s_barrier
  ds_read_b64_tr_b16 a[196:197], v233 offset:53248
  s_waitcnt vmcnt(23)
  v_mfma_f32_16x16x32_bf16 v[0:3], a[200:203], a[80:83], v[0:3]
  ds_read_b64_tr_b16 a[198:199], v233 offset:55296
  v_mfma_f32_16x16x32_bf16 v[0:3], a[204:207], a[88:91], v[0:3]
  v_mfma_f32_16x16x32_bf16 v[16:19], a[200:203], a[84:87], v[16:19]
  ds_read_b64_tr_b16 a[200:201], v237 offset:0
  ds_read_b64_tr_b16 a[202:203], v237 offset:2048
  v_mfma_f32_16x16x32_bf16 v[16:19], a[204:207], a[92:95], v[16:19]
  ds_read_b64_tr_b16 a[204:205], v234 offset:53248
  ds_read_b64_tr_b16 a[206:207], v234 offset:55296
  s_waitcnt lgkmcnt(13)
  v_mfma_f32_16x16x32_bf16 v[20:23], a[208:211], a[84:87], v[20:23]
  v_mfma_f32_16x16x32_bf16 v[20:23], a[212:215], a[92:95], v[20:23]
  v_mfma_f32_16x16x32_bf16 v[4:7], a[208:211], a[80:83], v[4:7]
  ds_read_b64_tr_b16 a[208:209], v238 offset:0
  ds_read_b64_tr_b16 a[210:211], v238 offset:2048
  v_mfma_f32_16x16x32_bf16 v[4:7], a[212:215], a[88:91], v[4:7]
  ds_read_b64_tr_b16 a[212:213], v235 offset:53248
  ds_read_b64_tr_b16 a[214:215], v235 offset:55296
  v_mfma_f32_16x16x32_bf16 v[8:11], a[216:219], a[80:83], v[8:11]
  v_mfma_f32_16x16x32_bf16 v[8:11], a[220:223], a[88:91], v[8:11]
  v_mfma_f32_16x16x32_bf16 v[24:27], a[216:219], a[84:87], v[24:27]
  ds_read_b64_tr_b16 a[216:217], v239 offset:0
  ds_read_b64_tr_b16 a[218:219], v239 offset:2048
  v_mfma_f32_16x16x32_bf16 v[24:27], a[220:223], a[92:95], v[24:27]
  ds_read_b64_tr_b16 a[220:221], v232 offset:12288
  ds_read_b64_tr_b16 a[222:223], v232 offset:14336
  s_waitcnt lgkmcnt(13)
  v_mfma_f32_16x16x32_bf16 v[28:31], a[224:227], a[84:87], v[28:31]
  v_mfma_f32_16x16x32_bf16 v[28:31], a[228:231], a[92:95], v[28:31]
  v_mfma_f32_16x16x32_bf16 v[12:15], a[224:227], a[80:83], v[12:15]
  ds_read_b64_tr_b16 a[224:225], v232 offset:8192
  ds_read_b64_tr_b16 a[226:227], v232 offset:10240
  v_mfma_f32_16x16x32_bf16 v[12:15], a[228:231], a[88:91], v[12:15]
  s_barrier
  ds_read_b64_tr_b16 a[228:229], v233 offset:12288
  s_waitcnt vmcnt(19)
  v_mfma_f32_16x16x32_bf16 v[0:3], a[232:235], a[96:99], v[0:3]
  ds_read_b64_tr_b16 a[230:231], v233 offset:14336
  v_mfma_f32_16x16x32_bf16 v[0:3], a[192:195], a[104:107], v[0:3]
  v_mfma_f32_16x16x32_bf16 v[16:19], a[232:235], a[100:103], v[16:19]
  ds_read_b64_tr_b16 a[232:233], v233 offset:8192
  ds_read_b64_tr_b16 a[234:235], v233 offset:10240
  v_mfma_f32_16x16x32_bf16 v[16:19], a[192:195], a[108:111], v[16:19]
  ds_read_b64_tr_b16 a[192:193], v234 offset:12288
  ds_read_b64_tr_b16 a[194:195], v234 offset:14336
  s_waitcnt lgkmcnt(13)
  v_mfma_f32_16x16x32_bf16 v[20:23], a[196:199], a[100:103], v[20:23]
  v_mfma_f32_16x16x32_bf16 v[20:23], a[200:203], a[108:111], v[20:23]
  v_mfma_f32_16x16x32_bf16 v[4:7], a[196:199], a[96:99], v[4:7]
  ds_read_b64_tr_b16 a[196:197], v234 offset:8192
  ds_read_b64_tr_b16 a[198:199], v234 offset:10240
  v_mfma_f32_16x16x32_bf16 v[4:7], a[200:203], a[104:107], v[4:7]
  buffer_load_dwordx4 a[180:183], v240, s[4:7], s40 offen offset:1024 sc1
  s_mov_b32 s40, 7208960
  s_waitcnt vmcnt(1)
  v_add_u32 v248, 1, v245
  buffer_store_dword v248, v246, s[4:7], s79 offen sc1
  v_mfma_f32_16x16x32_bf16 v[8:11], a[204:207], a[96:99], v[8:11]
  ds_read_b64_tr_b16 a[200:201], v235 offset:12288
  ds_read_b64_tr_b16 a[202:203], v235 offset:14336
  v_mfma_f32_16x16x32_bf16 v[8:11], a[208:211], a[104:107], v[8:11]
  v_mfma_f32_16x16x32_bf16 v[24:27], a[204:207], a[100:103], v[24:27]
  buffer_load_dwordx4 a[184:187], v240, s[4:7], s40 offen offset:0 sc1
  v_mfma_f32_16x16x32_bf16 v[24:27], a[208:211], a[108:111], v[24:27]
  ds_read_b64_tr_b16 a[204:205], v235 offset:8192
  ds_read_b64_tr_b16 a[206:207], v235 offset:10240
  s_waitcnt lgkmcnt(13)
  v_mfma_f32_16x16x32_bf16 v[28:31], a[212:215], a[100:103], v[28:31]
  ds_read_b64_tr_b16 a[208:209], v232 offset:20480
  ds_read_b64_tr_b16 a[210:211], v232 offset:22528
  v_mfma_f32_16x16x32_bf16 v[28:31], a[216:219], a[108:111], v[28:31]
  buffer_load_dwordx4 a[188:191], v240, s[4:7], s40 offen offset:1024 sc1
  v_mfma_f32_16x16x32_bf16 v[12:15], a[212:215], a[96:99], v[12:15]
  ds_read_b64_tr_b16 a[212:213], v232 offset:36864
  ds_read_b64_tr_b16 a[214:215], v232 offset:38912
  s_mov_b32 s41, 983040
  v_mfma_f32_16x16x32_bf16 v[12:15], a[216:219], a[104:107], v[12:15]
  s_barrier
  ds_read_b64_tr_b16 a[216:217], v233 offset:20480
  v_mfma_f32_16x16x32_bf16 v[0:3], a[220:223], a[112:115], v[0:3]
  ds_read_b64_tr_b16 a[218:219], v233 offset:22528
  s_add_u32 m0, s42, 12288
  s_waitcnt lgkmcnt(13)
  v_mfma_f32_16x16x32_bf16 v[0:3], a[224:227], a[120:123], v[0:3]
  buffer_load_dwordx4 v241, s[8:11], s41 offen offset:0 lds
  v_permlane16_swap_b32 v32, v34
  v_mfma_f32_16x16x32_bf16 v[16:19], a[220:223], a[116:119], v[16:19]
  ds_read_b64_tr_b16 a[220:221], v233 offset:36864
  ds_read_b64_tr_b16 a[222:223], v233 offset:38912
  s_mov_b32 s41, 1114112
  v_mfma_f32_16x16x32_bf16 v[16:19], a[224:227], a[124:127], v[16:19]
  ds_read_b64_tr_b16 a[224:225], v234 offset:20480
  ds_read_b64_tr_b16 a[226:227], v234 offset:22528
  s_add_u32 m0, s42, 24576
  v_permlane16_swap_b32 v33, v35
  v_mfma_f32_16x16x32_bf16 v[20:23], a[228:231], a[116:119], v[20:23]
  buffer_load_dwordx4 v241, s[8:11], s41 offen offset:0 lds
  v_permlane16_swap_b32 v36, v38
  v_mfma_f32_16x16x32_bf16 v[20:23], a[232:235], a[124:127], v[20:23]
  s_mov_b32 s41, 1245184
  s_add_u32 m0, s42, 45056
  v_permlane16_swap_b32 v37, v39
  v_mfma_f32_16x16x32_bf16 v[4:7], a[228:231], a[112:115], v[4:7]
  buffer_load_dwordx4 v241, s[8:11], s41 offen offset:0 lds
  v_permlane16_swap_b32 v40, v42
  v_mfma_f32_16x16x32_bf16 v[4:7], a[232:235], a[120:123], v[4:7]
  ds_read_b64_tr_b16 a[228:229], v234 offset:36864
  ds_read_b64_tr_b16 a[230:231], v234 offset:38912
  s_mov_b32 s41, 1376256
  v_permlane16_swap_b32 v41, v43
  s_waitcnt lgkmcnt(13)
  v_mfma_f32_16x16x32_bf16 v[8:11], a[192:195], a[112:115], v[8:11]
  ds_read_b64_tr_b16 a[232:233], v235 offset:20480
  ds_read_b64_tr_b16 a[234:235], v235 offset:22528
  s_add_u32 m0, s42, 36864
  v_permlane16_swap_b32 v44, v46
  v_mfma_f32_16x16x32_bf16 v[8:11], a[196:199], a[120:123], v[8:11]
  buffer_load_dwordx4 v241, s[8:11], s41 offen offset:0 lds
  v_permlane16_swap_b32 v45, v47
  v_mfma_f32_16x16x32_bf16 v[24:27], a[192:195], a[116:119], v[24:27]
  ds_read_b64_tr_b16 a[192:193], v235 offset:36864
  ds_read_b64_tr_b16 a[194:195], v235 offset:38912
  s_mov_b32 s41, 1507328
  v_lshlrev_b32 v160, 16, v32
  v_mfma_f32_16x16x32_bf16 v[24:27], a[196:199], a[124:127], v[24:27]
  ds_read_b64_tr_b16 a[196:197], v232 offset:32768
  ds_read_b64_tr_b16 a[198:199], v232 offset:34816
  s_add_u32 m0, s42, 49152
  buffer_load_dword v244, v243, s[4:7], s88 offen sc1
  v_and_b32 v161, 0xffff0000, v32
  v_mfma_f32_16x16x32_bf16 v[28:31], a[200:203], a[116:119], v[28:31]
  v_lshlrev_b32 v162, 16, v33
  v_and_b32 v163, 0xffff0000, v33
  v_lshlrev_b32 v164, 16, v34
  s_waitcnt lgkmcnt(13)
  v_mfma_f32_16x16x32_bf16 v[28:31], a[204:207], a[124:127], v[28:31]
  buffer_load_dwordx4 v241, s[8:11], s41 offen offset:0 lds
  v_and_b32 v165, 0xffff0000, v34
  v_mfma_f32_16x16x32_bf16 v[12:15], a[200:203], a[112:115], v[12:15]
  ds_read_b64_tr_b16 a[200:201], v232 offset:45056
  ds_read_b64_tr_b16 a[202:203], v232 offset:47104
  s_mov_b32 s41, 1638400
  v_mfma_f32_16x16x32_bf16 v[12:15], a[204:207], a[120:123], v[12:15]
  s_barrier
  ds_read_b64_tr_b16 a[204:205], v233 offset:32768
  v_mfma_f32_16x16x32_bf16 v[0:3], a[208:211], a[128:131], v[0:3]
  ds_read_b64_tr_b16 a[206:207], v233 offset:34816
  s_add_u32 m0, s42, 32768
  v_lshlrev_b32 v166, 16, v35
  v_mfma_f32_16x16x32_bf16 v[0:3], a[212:215], a[136:139], v[0:3]
  buffer_load_dwordx4 v241, s[8:11], s41 offen offset:0 lds
  v_and_b32 v167, 0xffff0000, v35
  v_mfma_f32_16x16x32_bf16 v[16:19], a[208:211], a[132:135], v[16:19]
  ds_read_b64_tr_b16 a[208:209], v233 offset:45056
  ds_read_b64_tr_b16 a[210:211], v233 offset:47104
  s_mov_b32 s41, 1769472
  v_lshlrev_b32 v168, 16, v36
  v_mfma_f32_16x16x32_bf16 v[16:19], a[212:215], a[140:143], v[16:19]
  ds_read_b64_tr_b16 a[212:213], v234 offset:32768
  ds_read_b64_tr_b16 a[214:215], v234 offset:34816
  s_add_u32 m0, s42, 40960
  v_and_b32 v169, 0xffff0000, v36
  s_waitcnt lgkmcnt(13)
  v_mfma_f32_16x16x32_bf16 v[20:23], a[216:219], a[132:135], v[20:23]
  buffer_load_dwordx4 v241, s[8:11], s41 offen offset:0 lds
  v_lshlrev_b32 v170, 16, v37
  v_mfma_f32_16x16x32_bf16 v[20:23], a[220:223], a[140:143], v[20:23]
  s_mov_b32 s41, 1900544
  s_add_u32 m0, s42, 53248
  v_and_b32 v171, 0xffff0000, v37
  v_mfma_f32_16x16x32_bf16 v[4:7], a[216:219], a[128:131], v[4:7]
  buffer_load_dwordx4 v241, s[8:11], s41 offen offset:0 lds
  v_lshlrev_b32 v172, 16, v38
  v_mfma_f32_16x16x32_bf16 v[4:7], a[220:223], a[136:139], v[4:7]
  ds_read_b64_tr_b16 a[216:217], v234 offset:45056
  ds_read_b64_tr_b16 a[218:219], v234 offset:47104
  s_mov_b32 s41, 2031616
  v_and_b32 v173, 0xffff0000, v38
  v_mfma_f32_16x16x32_bf16 v[8:11], a[224:227], a[128:131], v[8:11]
  ds_read_b64_tr_b16 a[220:221], v235 offset:32768
  ds_read_b64_tr_b16 a[222:223], v235 offset:34816
  s_add_u32 m0, s42, 57344
  v_lshlrev_b32 v174, 16, v39
  v_mfma_f32_16x16x32_bf16 v[8:11], a[228:231], a[136:139], v[8:11]
  buffer_load_dwordx4 v241, s[8:11], s41 offen offset:0 lds
  v_and_b32 v175, 0xffff0000, v39
  v_mfma_f32_16x16x32_bf16 v[24:27], a[224:227], a[132:135], v[24:27]
  ds_read_b64_tr_b16 a[224:225], v235 offset:45056
  ds_read_b64_tr_b16 a[226:227], v235 offset:47104
  v_lshlrev_b32 v176, 16, v40
  v_mfma_f32_16x16x32_bf16 v[24:27], a[228:231], a[140:143], v[24:27]
  ds_read_b64_tr_b16 a[228:229], v232 offset:61440
  ds_read_b64_tr_b16 a[230:231], v232 offset:63488
  v_and_b32 v177, 0xffff0000, v40
  s_waitcnt lgkmcnt(13)
  v_mfma_f32_16x16x32_bf16 v[28:31], a[232:235], a[132:135], v[28:31]
  v_lshlrev_b32 v178, 16, v41
  v_and_b32 v179, 0xffff0000, v41
  v_lshlrev_b32 v180, 16, v42
  v_mfma_f32_16x16x32_bf16 v[28:31], a[192:195], a[140:143], v[28:31]
  v_and_b32 v181, 0xffff0000, v42
  v_lshlrev_b32 v182, 16, v43
  v_and_b32 v183, 0xffff0000, v43
  v_mfma_f32_16x16x32_bf16 v[12:15], a[232:235], a[128:131], v[12:15]
  ds_read_b64_tr_b16 a[232:233], v232 offset:57344
  ds_read_b64_tr_b16 a[234:235], v232 offset:59392
  v_lshlrev_b32 v184, 16, v44
  v_mfma_f32_16x16x32_bf16 v[12:15], a[192:195], a[136:139], v[12:15]
  s_barrier
  ds_read_b64_tr_b16 a[192:193], v233 offset:61440
  v_mfma_f32_16x16x32_bf16 v[0:3], a[196:199], a[144:147], v[0:3]
  ds_read_b64_tr_b16 a[194:195], v233 offset:63488
  v_and_b32 v185, 0xffff0000, v44
  v_lshlrev_b32 v186, 16, v45
  v_mfma_f32_16x16x32_bf16 v[0:3], a[200:203], a[152:155], v[0:3]
  v_and_b32 v187, 0xffff0000, v45
  v_lshlrev_b32 v188, 16, v46
  v_and_b32 v189, 0xffff0000, v46
  v_mfma_f32_16x16x32_bf16 v[16:19], a[196:199], a[148:151], v[16:19]
  ds_read_b64_tr_b16 a[196:197], v233 offset:57344
  ds_read_b64_tr_b16 a[198:199], v233 offset:59392
  v_lshlrev_b32 v190, 16, v47
  v_mfma_f32_16x16x32_bf16 v[16:19], a[200:203], a[156:159], v[16:19]
  ds_read_b64_tr_b16 a[200:201], v234 offset:61440
  ds_read_b64_tr_b16 a[202:203], v234 offset:63488
  v_and_b32 v191, 0xffff0000, v47
  s_waitcnt lgkmcnt(13)
  v_mfma_f32_16x16x32_bf16 v[20:23], a[204:207], a[148:151], v[20:23]
  v_mfma_f32_16x16x32_bf16 v[20:23], a[208:211], a[156:159], v[20:23]
  v_mfma_f32_16x16x32_bf16 v[4:7], a[204:207], a[144:147], v[4:7]
  ds_read_b64_tr_b16 a[204:205], v234 offset:57344
  ds_read_b64_tr_b16 a[206:207], v234 offset:59392
  v_mfma_f32_16x16x32_bf16 v[4:7], a[208:211], a[152:155], v[4:7]
  ds_read_b64_tr_b16 a[208:209], v235 offset:61440
  ds_read_b64_tr_b16 a[210:211], v235 offset:63488
  v_mfma_f32_16x16x32_bf16 v[8:11], a[212:215], a[144:147], v[8:11]
  v_mfma_f32_16x16x32_bf16 v[8:11], a[216:219], a[152:155], v[8:11]
  s_waitcnt vmcnt(5)
  v_subrev_u32 v244, s100, v244
  v_subrev_u32 v244, 1, v244
  v_cmp_lt_u32 s[68:69], 6, v244
  v_mfma_f32_16x16x32_bf16 v[24:27], a[212:215], a[148:151], v[24:27]
  ds_read_b64_tr_b16 a[212:213], v235 offset:57344
  ds_read_b64_tr_b16 a[214:215], v235 offset:59392
  s_cmp_lg_u64 s[68:69], 0
  s_cbranch_scc1 L_slow_16
L_back_17:
  v_and_b32 v192, 1216, v254
  v_mfma_f32_16x16x32_bf16 v[24:27], a[216:219], a[156:159], v[24:27]
  ds_read_b64_tr_b16 a[216:217], v236 offset:4096
  ds_read_b64_tr_b16 a[218:219], v236 offset:6144
  s_mov_b32 s40, 7340032
  s_sub_u32 s89, s93, 0x20000
  s_waitcnt lgkmcnt(13)
  v_mfma_f32_16x16x32_bf16 v[28:31], a[220:223], a[148:151], v[28:31]
  buffer_load_dwordx4 a[0:3], v240, s[4:7], s40 offen offset:0 sc1
  v_mfma_f32_16x16x32_bf16 v[28:31], a[224:227], a[156:159], v[28:31]
  v_mfma_f32_16x16x32_bf16 v[12:15], a[220:223], a[144:147], v[12:15]
  buffer_load_dwordx4 a[4:7], v240, s[4:7], s40 offen offset:1024 sc1
  s_mov_b32 s40, 7471104
  v_mfma_f32_16x16x32_bf16 v[12:15], a[224:227], a[152:155], v[12:15]
  s_barrier
  ds_read_b64_tr_b16 a[220:221], v236 offset:20480
  buffer_load_dword v244, v192, s[4:7], s89 offen sc1
  v_mfma_f32_16x16x32_bf16 v[0:3], a[228:231], a[160:163], v[0:3]
  ds_read_b64_tr_b16 a[222:223], v236 offset:22528
  ds_read_b64_tr_b16 a[224:225], v237 offset:4096
  v_mfma_f32_16x16x32_bf16 v[0:3], a[232:235], a[168:171], v[0:3]
  buffer_load_dwordx4 a[8:11], v240, s[4:7], s40 offen offset:0 sc1
  v_mfma_f32_16x16x32_bf16 v[16:19], a[228:231], a[164:167], v[16:19]
  ds_read_b64_tr_b16 a[226:227], v237 offset:6144
  ds_read_b64_tr_b16 a[228:229], v237 offset:20480
  v_mfma_f32_16x16x32_bf16 v[16:19], a[232:235], a[172:175], v[16:19]
  ds_read_b64_tr_b16 a[230:231], v237 offset:22528
  ds_read_b64_tr_b16 a[232:233], v238 offset:4096
  s_waitcnt lgkmcnt(13)
  v_mfma_f32_16x16x32_bf16 v[20:23], a[192:195], a[164:167], v[20:23]
  buffer_load_dwordx4 a[12:15], v240, s[4:7], s40 offen offset:1024 sc1
  buffer_load_dwordx4 v[96:99], v210, s[4:7], s101 offen sc1
  v_mfma_f32_16x16x32_bf16 v[20:23], a[196:199], a[172:175], v[20:23]
  ds_read_b64_tr_b16 a[234:235], v238 offset:6144
  s_mov_b32 s40, 7602176
  v_mfma_f32_16x16x32_bf16 v[4:7], a[192:195], a[160:163], v[4:7]
  ds_read_b64_tr_b16 a[192:193], v238 offset:20480
  ds_read_b64_tr_b16 a[194:195], v238 offset:22528
  v_mfma_f32_16x16x32_bf16 v[4:7], a[196:199], a[168:171], v[4:7]
  buffer_load_dwordx4 a[16:19], v240, s[4:7], s40 offen offset:0 sc1
  v_mfma_f32_16x16x32_bf16 v[8:11], a[200:203], a[160:163], v[8:11]
  ds_read_b64_tr_b16 a[196:197], v239 offset:4096
  ds_read_b64_tr_b16 a[198:199], v239 offset:6144
  v_mfma_f32_16x16x32_bf16 v[8:11], a[204:207], a[168:171], v[8:11]
  v_mfma_f32_16x16x32_bf16 v[24:27], a[200:203], a[164:167], v[24:27]
  buffer_load_dwordx4 a[20:23], v240, s[4:7], s40 offen offset:1024 sc1
  s_mov_b32 s40, 7733248
  v_mfma_f32_16x16x32_bf16 v[24:27], a[204:207], a[172:175], v[24:27]
  ds_read_b64_tr_b16 a[200:201], v239 offset:20480
  ds_read_b64_tr_b16 a[202:203], v239 offset:22528
  s_waitcnt lgkmcnt(13)
  v_mfma_f32_16x16x32_bf16 v[28:31], a[208:211], a[164:167], v[28:31]
  ds_read_b64_tr_b16 a[204:205], v236 offset:16384
  ds_read_b64_tr_b16 a[206:207], v236 offset:18432
  v_mfma_f32_16x16x32_bf16 v[28:31], a[212:215], a[172:175], v[28:31]
  buffer_load_dwordx4 a[24:27], v240, s[4:7], s40 offen offset:0 sc1
  v_mfma_f32_16x16x32_bf16 v[12:15], a[208:211], a[160:163], v[12:15]
  ds_read_b64_tr_b16 a[208:209], v236 offset:28672
  ds_read_b64_tr_b16 a[210:211], v236 offset:30720
  v_mfma_f32_16x16x32_bf16 v[12:15], a[212:215], a[168:171], v[12:15]
  s_barrier
  ds_read_b64_tr_b16 a[212:213], v237 offset:16384
  v_mfma_f32_16x16x32_bf16 v[0:3], a[216:219], a[176:179], v[0:3]
  buffer_load_dwordx4 a[28:31], v240, s[4:7], s40 offen offset:1024 sc1
  s_waitcnt lgkmcnt(13)
  v_mfma_f32_16x16x32_bf16 v[0:3], a[220:223], a[184:187], v[0:3]
  ds_read_b64_tr_b16 a[214:215], v237 offset:18432
  s_mov_b32 s40, 7864320
  v_mfma_f32_16x16x32_bf16 v[16:19], a[216:219], a[180:183], v[16:19]
  ds_read_b64_tr_b16 a[216:217], v237 offset:28672
  ds_read_b64_tr_b16 a[218:219], v237 offset:30720
  v_mfma_f32_16x16x32_bf16 v[16:19], a[220:223], a[188:191], v[16:19]
  buffer_load_dwordx4 a[32:35], v240, s[4:7], s40 offen offset:0 sc1
  v_mfma_f32_16x16x32_bf16 v[20:23], a[224:227], a[180:183], v[20:23]
  ds_read_b64_tr_b16 a[220:221], v238 offset:16384
  ds_read_b64_tr_b16 a[222:223], v238 offset:18432
  v_mfma_f32_16x16x32_bf16 v[20:23], a[228:231], a[188:191], v[20:23]
  v_mfma_f32_16x16x32_bf16 v[4:7], a[224:227], a[176:179], v[4:7]
  buffer_load_dwordx4 a[36:39], v240, s[4:7], s40 offen offset:1024 sc1
  s_mov_b32 s40, 7995392
  v_mfma_f32_16x16x32_bf16 v[4:7], a[228:231], a[184:187], v[4:7]
  ds_read_b64_tr_b16 a[224:225], v238 offset:28672
  ds_read_b64_tr_b16 a[226:227], v238 offset:30720
  s_waitcnt lgkmcnt(13)
  v_mfma_f32_16x16x32_bf16 v[8:11], a[232:235], a[176:179], v[8:11]
  ds_read_b64_tr_b16 a[228:229], v239 offset:16384
  ds_read_b64_tr_b16 a[230:231], v239 offset:18432
  v_mfma_f32_16x16x32_bf16 v[8:11], a[192:195], a[184:187], v[8:11]
  buffer_load_dwordx4 a[40:43], v240, s[4:7], s40 offen offset:0 sc1
  v_mfma_f32_16x16x32_bf16 v[24:27], a[232:235], a[180:183], v[24:27]
  ds_read_b64_tr_b16 a[232:233], v239 offset:28672
  ds_read_b64_tr_b16 a[234:235], v239 offset:30720
  v_mfma_f32_16x16x32_bf16 v[24:27], a[192:195], a[188:191], v[24:27]
  ds_read_b64_tr_b16 a[192:193], v228 offset:16384
  ds_read_b64_tr_b16 a[194:195], v228 offset:18432
  v_mfma_f32_16x16x32_bf16 v[28:31], a[196:199], a[180:183], v[28:31]
  buffer_load_dwordx4 a[44:47], v240, s[4:7], s40 offen offset:1024 sc1
  s_waitcnt lgkmcnt(13)
  v_mfma_f32_16x16x32_bf16 v[28:31], a[200:203], a[188:191], v[28:31]
  s_mov_b32 s40, 8126464
  v_mfma_f32_16x16x32_bf16 v[12:15], a[196:199], a[176:179], v[12:15]
  ds_read_b64_tr_b16 a[196:197], v228 offset:28672
  ds_read_b64_tr_b16 a[198:199], v228 offset:30720
  v_mfma_f32_16x16x32_bf16 v[12:15], a[200:203], a[184:187], v[12:15]
  s_barrier
  ds_read_b64_tr_b16 a[200:201], v229 offset:16384
  s_waitcnt vmcnt(9)
  v_mfma_f32_16x16x32_bf16 v[0:3], a[204:207], a[0:3], v[0:3]
  buffer_load_dwordx4 a[48:51], v240, s[4:7], s40 offen offset:0 sc1
  v_mfma_f32_16x16x32_bf16 v[0:3], a[208:211], a[8:11], v[0:3]
  ds_read_b64_tr_b16 a[202:203], v229 offset:18432
  v_mfma_f32_16x16x32_bf16 v[16:19], a[204:207], a[4:7], v[16:19]
  buffer_load_dwordx4 a[52:55], v240, s[4:7], s40 offen offset:1024 sc1
  s_mov_b32 s40, 8257536
  v_mfma_f32_16x16x32_bf16 v[16:19], a[208:211], a[12:15], v[16:19]
  ds_read_b64_tr_b16 a[204:205], v229 offset:28672
  ds_read_b64_tr_b16 a[206:207], v229 offset:30720
  s_waitcnt lgkmcnt(13)
  v_mfma_f32_16x16x32_bf16 v[20:23], a[212:215], a[4:7], v[20:23]
  ds_read_b64_tr_b16 a[208:209], v230 offset:16384
  ds_read_b64_tr_b16 a[210:211], v230 offset:18432
  v_mfma_f32_16x16x32_bf16 v[20:23], a[216:219], a[12:15], v[20:23]
  buffer_load_dwordx4 a[56:59], v240, s[4:7], s40 offen offset:0 sc1
  v_mfma_f32_16x16x32_bf16 v[4:7], a[212:215], a[0:3], v[4:7]
  ds_read_b64_tr_b16 a[212:213], v230 offset:28672
  ds_read_b64_tr_b16 a[214:215], v230 offset:30720
  v_mfma_f32_16x16x32_bf16 v[4:7], a[216:219], a[8:11], v[4:7]
  ds_read_b64_tr_b16 a[216:217], v231 offset:16384
  ds_read_b64_tr_b16 a[218:219], v231 offset:18432
  v_mfma_f32_16x16x32_bf16 v[8:11], a[220:223], a[0:3], v[8:11]
  buffer_load_dwordx4 a[60:63], v240, s[4:7], s40 offen offset:1024 sc1
  s_waitcnt lgkmcnt(13)
  v_mfma_f32_16x16x32_bf16 v[8:11], a[224:227], a[8:11], v[8:11]
  s_mov_b32 s40, 8388608
  v_mfma_f32_16x16x32_bf16 v[24:27], a[220:223], a[4:7], v[24:27]
  ds_read_b64_tr_b16 a[220:221], v231 offset:28672
  ds_read_b64_tr_b16 a[222:223], v231 offset:30720
  v_mfma_f32_16x16x32_bf16 v[24:27], a[224:227], a[12:15], v[24:27]
  buffer_load_dwordx4 a[64:67], v240, s[4:7], s40 offen offset:0 sc1
  v_subrev_u32 v244, s100, v244
  v_cmp_lt_u32 s[68:69], 7, v244
  v_mfma_f32_16x16x32_bf16 v[28:31], a[228:231], a[4:7], v[28:31]
  ds_read_b64_tr_b16 a[224:225], v236 offset:8192
  ds_read_b64_tr_b16 a[226:227], v236 offset:10240
  s_cmp_lg_u64 s[68:69], 0
  s_cbranch_scc1 L_slow_18
L_back_19:
  s_waitcnt vmcnt(13)
  v_xor_b32 v96, s84, v96
  v_mfma_f32_16x16x32_bf16 v[28:31], a[232:235], a[12:15], v[28:31]
  v_xor_b32 v97, s85, v97
  v_or_b32 v100, v96, v97
  v_xor_b32 v98, s86, v98
  v_mfma_f32_16x16x32_bf16 v[12:15], a[228:231], a[0:3], v[12:15]
  buffer_load_dwordx4 a[68:71], v240, s[4:7], s40 offen offset:1024 sc1
  s_mov_b32 s40, 8519680
  v_mfma_f32_16x16x32_bf16 v[12:15], a[232:235], a[8:11], v[12:15]
  s_barrier
  ds_read_b64_tr_b16 a[228:229], v236 offset:24576
  v_xor_b32 v99, s87, v99
  s_waitcnt vmcnt(10) lgkmcnt(13)
  v_mfma_f32_16x16x32_bf16 v[0:3], a[192:195], a[16:19], v[0:3]
  ds_read_b64_tr_b16 a[230:231], v236 offset:26624
  ds_read_b64_tr_b16 a[232:233], v237 offset:8192
  v_or3_b32 v100, v100, v98, v99
  v_mfma_f32_16x16x32_bf16 v[0:3], a[196:199], a[24:27], v[0:3]
  buffer_load_dwordx4 a[72:75], v240, s[4:7], s40 offen offset:0 sc1
  v_and_b32 v100, 0xff, v100
  v_cmp_ne_u32 s[68:69], 0, v100
  v_mfma_f32_16x16x32_bf16 v[16:19], a[192:195], a[20:23], v[16:19]
  ds_read_b64_tr_b16 a[234:235], v237 offset:10240
  ds_read_b64_tr_b16 a[192:193], v237 offset:24576
  v_mfma_f32_16x16x32_bf16 v[16:19], a[196:199], a[28:31], v[16:19]
  ds_read_b64_tr_b16 a[194:195], v237 offset:26624
  ds_read_b64_tr_b16 a[196:197], v238 offset:8192
  s_cmp_lg_u64 s[68:69], 0
  s_cbranch_scc1 L_slow_20
L_back_21:
  v_mov_b32 v100, v96
  v_mfma_f32_16x16x32_bf16 v[20:23], a[200:203], a[20:23], v[20:23]
  buffer_load_dwordx4 a[76:79], v240, s[4:7], s40 offen offset:1024 sc1
  v_mov_b32 v101, v97
  s_waitcnt lgkmcnt(13)
  v_mfma_f32_16x16x32_bf16 v[20:23], a[204:207], a[28:31], v[20:23]
  ds_read_b64_tr_b16 a[198:199], v238 offset:10240
  s_mov_b32 s40, 8650752
  v_mov_b32 v102, v98
  v_mov_b32 v103, v99
  v_mfma_f32_16x16x32_bf16 v[4:7], a[200:203], a[16:19], v[4:7]
  ds_read_b64_tr_b16 a[200:201], v238 offset:24576
  ds_read_b64_tr_b16 a[202:203], v238 offset:26624
  v_permlane16_swap_b32 v100, v96
  v_mfma_f32_16x16x32_bf16 v[4:7], a[204:207], a[24:27], v[4:7]
  buffer_load_dwordx4 a[80:83], v240, s[4:7], s40 offen offset:0 sc1
  v_permlane16_swap_b32 v101, v97
  v_permlane16_swap_b32 v102, v98
  v_mfma_f32_16x16x32_bf16 v[8:11], a[208:211], a[16:19], v[8:11]
  ds_read_b64_tr_b16 a[204:205], v239 offset:8192
  ds_read_b64_tr_b16 a[206:207], v239 offset:10240
  v_permlane16_swap_b32 v103, v99
  v_mfma_f32_16x16x32_bf16 v[8:11], a[212:215], a[24:27], v[8:11]
  v_add_f32 v96, v96, v100
  v_add_f32 v97, v97, v101
  v_add_f32 v98, v98, v102
  v_mfma_f32_16x16x32_bf16 v[24:27], a[208:211], a[20:23], v[24:27]
  buffer_load_dwordx4 a[84:87], v240, s[4:7], s40 offen offset:1024 sc1
  s_mov_b32 s40, 8781824
  v_mfma_f32_16x16x32_bf16 v[24:27], a[212:215], a[28:31], v[24:27]
  ds_read_b64_tr_b16 a[208:209], v239 offset:24576
  ds_read_b64_tr_b16 a[210:211], v239 offset:26624
  v_add_f32 v99, v99, v103
  v_mov_b32 v100, v96
  s_waitcnt lgkmcnt(13)
  v_mfma_f32_16x16x32_bf16 v[28:31], a[216:219], a[20:23], v[28:31]
  ds_read_b64_tr_b16 a[212:213], v228 offset:20480
  ds_read_b64_tr_b16 a[214:215], v228 offset:22528
  v_mov_b32 v101, v97
  v_mfma_f32_16x16x32_bf16 v[28:31], a[220:223], a[28:31], v[28:31]
  buffer_load_dwordx4 a[88:91], v240, s[4:7], s40 offen offset:0 sc1
  v_mov_b32 v102, v98
  v_mov_b32 v103, v99
  v_mfma_f32_16x16x32_bf16 v[12:15], a[216:219], a[16:19], v[12:15]
  ds_read_b64_tr_b16 a[216:217], v228 offset:12288
  ds_read_b64_tr_b16 a[218:219], v228 offset:14336
  v_permlane32_swap_b32 v100, v96
  v_mfma_f32_16x16x32_bf16 v[12:15], a[220:223], a[24:27], v[12:15]
  s_barrier
  ds_read_b64_tr_b16 a[220:221], v229 offset:20480
  v_permlane32_swap_b32 v101, v97
  v_permlane32_swap_b32 v102, v98
  s_waitcnt vmcnt(11)
  v_mfma_f32_16x16x32_bf16 v[0:3], a[224:227], a[32:35], v[0:3]
  buffer_load_dwordx4 a[92:95], v240, s[4:7], s40 offen offset:1024 sc1
  v_permlane32_swap_b32 v103, v99
  s_waitcnt lgkmcnt(13)
  v_mfma_f32_16x16x32_bf16 v[0:3], a[228:231], a[40:43], v[0:3]
  ds_read_b64_tr_b16 a[222:223], v229 offset:22528
  s_mov_b32 s41, 0
  s_add_u32 m0, s42, 65536
  v_add_f32 v96, v96, v100
  v_add_f32 v97, v97, v101
  v_mfma_f32_16x16x32_bf16 v[16:19], a[224:227], a[36:39], v[16:19]
  ds_read_b64_tr_b16 a[224:225], v229 offset:12288
  ds_read_b64_tr_b16 a[226:227], v229 offset:14336
  v_add_f32 v98, v98, v102
  v_mfma_f32_16x16x32_bf16 v[16:19], a[228:231], a[44:47], v[16:19]
  buffer_load_dwordx4 v227, s[12:15], s41 offen offset:0 lds
  v_add_f32 v99, v99, v103
  v_cvt_pk_bf16_f32 v100, v96, v97
  v_mfma_f32_16x16x32_bf16 v[20:23], a[232:235], a[36:39], v[20:23]
  ds_read_b64_tr_b16 a[228:229], v230 offset:20480
L_wk0_5:
  s_cbranch_vccnz L_wk0_end
  ds_read_b64_tr_b16 a[230:231], v230 offset:22528
  s_mov_b32 s41, 229376
  v_lshlrev_b32 v96, 16, v100
  v_mfma_f32_16x16x32_bf16 v[20:23], a[192:195], a[44:47], v[20:23]
  s_add_u32 m0, s42, 94208
  v_and_b32 v97, 0xffff0000, v100
  v_cvt_pk_bf16_f32 v101, v98, v99
  v_mfma_f32_16x16x32_bf16 v[4:7], a[232:235], a[32:35], v[4:7]
  buffer_load_dwordx4 v227, s[12:15], s41 offen offset:0 lds
  v_lshlrev_b32 v98, 16, v101
  v_mfma_f32_16x16x32_bf16 v[4:7], a[192:195], a[40:43], v[4:7]
  ds_read_b64_tr_b16 a[232:233], v230 offset:12288
  ds_read_b64_tr_b16 a[234:235], v230 offset:14336
  s_mov_b32 s40, 8912896
  v_and_b32 v99, 0xffff0000, v101
  v_add_f32 v96, s39, v96
  s_waitcnt lgkmcnt(13)
  v_mfma_f32_16x16x32_bf16 v[8:11], a[196:199], a[32:35], v[8:11]
  ds_read_b64_tr_b16 a[192:193], v231 offset:20480
  ds_read_b64_tr_b16 a[194:195], v231 offset:22528
  v_add_f32 v97, s39, v97
  v_mfma_f32_16x16x32_bf16 v[8:11], a[200:203], a[40:43], v[8:11]
  buffer_load_dwordx4 a[96:99], v240, s[4:7], s40 offen offset:0 sc1
  v_add_f32 v98, s39, v98
  v_add_f32 v99, s39, v99
  v_mfma_f32_16x16x32_bf16 v[24:27], a[196:199], a[36:39], v[24:27]
  ds_read_b64_tr_b16 a[196:197], v231 offset:12288
  ds_read_b64_tr_b16 a[198:199], v231 offset:14336
  v_cvt_pk_bf16_f32 v100, v96, v97
  v_mfma_f32_16x16x32_bf16 v[24:27], a[200:203], a[44:47], v[24:27]
  ds_read_b64_tr_b16 a[200:201], v228 offset:24576
  ds_read_b64_tr_b16 a[202:203], v228 offset:26624
  v_lshlrev_b32 v96, 16, v100
  v_and_b32 v97, 0xffff0000, v100
  v_mfma_f32_16x16x32_bf16 v[28:31], a[204:207], a[36:39], v[28:31]
  buffer_load_dwordx4 a[100:103], v240, s[4:7], s40 offen offset:1024 sc1
  s_mov_b32 s40, 9043968
  v_cvt_pk_bf16_f32 v101, v98, v99
  s_waitcnt lgkmcnt(13)
  v_mfma_f32_16x16x32_bf16 v[28:31], a[208:211], a[44:47], v[28:31]
  v_lshlrev_b32 v98, 16, v101
  v_and_b32 v99, 0xffff0000, v101
  ds_write_b128 v213, v[96:99] offset:10240
  v_mfma_f32_16x16x32_bf16 v[12:15], a[204:207], a[32:35], v[12:15]
  ds_read_b64_tr_b16 a[204:205], v228 offset:45056
  ds_read_b64_tr_b16 a[206:207], v228 offset:47104
  v_mfma_f32_16x16x32_bf16 v[12:15], a[208:211], a[40:43], v[12:15]
  s_barrier
  ds_read_b64_tr_b16 a[208:209], v229 offset:24576
  s_waitcnt vmcnt(12)
  v_mfma_f32_16x16x32_bf16 v[0:3], a[212:215], a[48:51], v[0:3]
  buffer_load_dwordx4 a[104:107], v240, s[4:7], s40 offen offset:0 sc1
  v_mfma_f32_16x16x32_bf16 v[0:3], a[216:219], a[56:59], v[0:3]
  ds_read_b64_tr_b16 a[210:211], v229 offset:26624
  v_mfma_f32_16x16x32_bf16 v[16:19], a[212:215], a[52:55], v[16:19]
  buffer_load_dwordx4 a[108:111], v240, s[4:7], s40 offen offset:1024 sc1
  v_mfma_f32_16x16x32_bf16 v[16:19], a[216:219], a[60:63], v[16:19]
  ds_read_b64_tr_b16 a[212:213], v229 offset:45056
  ds_read_b64_tr_b16 a[214:215], v229 offset:47104
  s_mov_b32 s41, 0
  s_waitcnt lgkmcnt(6)
  v_mfma_f32_16x16x32_bf16 v[20:23], a[220:223], a[52:55], v[20:23]
  ds_read_b64_tr_b16 a[216:217], v230 offset:24576
  ds_read_b64_tr_b16 a[218:219], v230 offset:26624
  s_add_u32 m0, s42, 106496
  v_mfma_f32_16x16x32_bf16 v[20:23], a[224:227], a[60:63], v[20:23]
  buffer_load_dwordx4 v227, s[16:19], s41 offen offset:0 lds
  v_mfma_f32_16x16x32_bf16 v[4:7], a[220:223], a[48:51], v[4:7]
  ds_read_b64_tr_b16 a[220:221], v230 offset:45056
  ds_read_b64_tr_b16 a[222:223], v230 offset:47104
  s_mov_b32 s41, 229376
  v_mfma_f32_16x16x32_bf16 v[4:7], a[224:227], a[56:59], v[4:7]
  ds_read_b64_tr_b16 a[224:225], v231 offset:24576
  ds_read_b64_tr_b16 a[226:227], v231 offset:26624
  s_add_u32 m0, s42, 114688
  v_mfma_f32_16x16x32_bf16 v[8:11], a[228:231], a[48:51], v[8:11]
  buffer_load_dwordx4 v227, s[16:19], s41 offen offset:0 lds
  v_mfma_f32_16x16x32_bf16 v[8:11], a[232:235], a[56:59], v[8:11]
  s_mov_b32 s40, 9175040
  v_mfma_f32_16x16x32_bf16 v[24:27], a[228:231], a[52:55], v[24:27]
  ds_read_b64_tr_b16 a[228:229], v231 offset:45056
  ds_read_b64_tr_b16 a[230:231], v231 offset:47104
  v_mfma_f32_16x16x32_bf16 v[24:27], a[232:235], a[60:63], v[24:27]
  buffer_load_dwordx4 a[112:115], v240, s[4:7], s40 offen offset:0 sc1
  v_mfma_f32_16x16x32_bf16 v[28:31], a[192:195], a[52:55], v[28:31]
  ds_read_b64_tr_b16 a[232:233], v228 offset:36864
  ds_read_b64_tr_b16 a[234:235], v228 offset:38912
  v_mfma_f32_16x16x32_bf16 v[28:31], a[196:199], a[60:63], v[28:31]
  v_mfma_f32_16x16x32_bf16 v[12:15], a[192:195], a[48:51], v[12:15]
  buffer_load_dwordx4 a[116:119], v240, s[4:7], s40 offen offset:1024 sc1
  s_mov_b32 s40, 9306112
  v_mfma_f32_16x16x32_bf16 v[12:15], a[196:199], a[56:59], v[12:15]
  s_barrier
  ds_read_b64_tr_b16 a[192:193], v228 offset:49152
  ds_read_b128 v[64:67], v250 offset:10240
  s_waitcnt vmcnt(14)
  v_mfma_f32_16x16x32_bf16 v[0:3], a[200:203], a[64:67], v[0:3]
  ds_read_b64_tr_b16 a[194:195], v228 offset:51200
  ds_read_b64_tr_b16 a[196:197], v229 offset:36864
  ds_read_b128 v[68:71], v250 offset:10304
  s_waitcnt lgkmcnt(13)
  v_mfma_f32_16x16x32_bf16 v[0:3], a[204:207], a[72:75], v[0:3]
  buffer_load_dwordx4 a[120:123], v240, s[4:7], s40 offen offset:0 sc1
  ds_read_b128 v[72:75], v250 offset:10368
  v_mfma_f32_16x16x32_bf16 v[16:19], a[200:203], a[68:71], v[16:19]
  ds_read_b64_tr_b16 a[198:199], v229 offset:38912
  ds_read_b64_tr_b16 a[200:201], v229 offset:49152
  ds_read_b128 v[76:79], v250 offset:10432
  v_mfma_f32_16x16x32_bf16 v[16:19], a[204:207], a[76:79], v[16:19]
  ds_read_b64_tr_b16 a[202:203], v229 offset:51200
  ds_read_b64_tr_b16 a[204:205], v230 offset:36864
  ds_read_b128 v[96:99], v250 offset:10496
  v_mfma_f32_16x16x32_bf16 v[20:23], a[208:211], a[68:71], v[20:23]
  buffer_load_dwordx4 a[124:127], v240, s[4:7], s40 offen offset:1024 sc1
  ds_read_b128 v[100:103], v250 offset:10560
  v_mfma_f32_16x16x32_bf16 v[20:23], a[212:215], a[76:79], v[20:23]
  ds_read_b64_tr_b16 a[206:207], v230 offset:38912
  s_mov_b32 s41, 0
  s_add_u32 m0, s42, 143360
  ds_read_b128 v[104:107], v250 offset:10624
  v_mfma_f32_16x16x32_bf16 v[4:7], a[208:211], a[64:67], v[4:7]
  ds_read_b64_tr_b16 a[208:209], v230 offset:49152
  ds_read_b64_tr_b16 a[210:211], v230 offset:51200
  ds_read_b128 v[108:111], v250 offset:10688
  v_mfma_f32_16x16x32_bf16 v[4:7], a[212:215], a[72:75], v[4:7]
  buffer_load_dwordx4 v226, s[12:15], s41 offen offset:0 lds
  ds_read_b128 v[144:147], v250 offset:10752
  v_mfma_f32_16x16x32_bf16 v[8:11], a[216:219], a[64:67], v[8:11]
  ds_read_b64_tr_b16 a[212:213], v231 offset:36864
  ds_read_b64_tr_b16 a[214:215], v231 offset:38912
  s_mov_b32 s41, 229376
  ds_read_b128 v[148:151], v250 offset:10816
  s_waitcnt lgkmcnt(13)
  v_mfma_f32_16x16x32_bf16 v[8:11], a[220:223], a[72:75], v[8:11]
  s_add_u32 m0, s42, 69632
  ds_read_b128 v[152:155], v250 offset:10880
  v_mfma_f32_16x16x32_bf16 v[24:27], a[216:219], a[68:71], v[24:27]
  buffer_load_dwordx4 v226, s[12:15], s41 offen offset:0 lds
  ds_read_b128 v[156:159], v250 offset:10944
  v_mfma_f32_16x16x32_bf16 v[24:27], a[220:223], a[76:79], v[24:27]
  ds_read_b64_tr_b16 a[216:217], v231 offset:49152
  ds_read_b64_tr_b16 a[218:219], v231 offset:51200
  s_mov_b32 s41, 0
  v_mfma_f32_16x16x32_bf16 v[28:31], a[224:227], a[68:71], v[28:31]
  ds_read_b64_tr_b16 a[220:221], v228 offset:32768
  ds_read_b64_tr_b16 a[222:223], v228 offset:34816
  s_add_u32 m0, s42, 81920
  v_mfma_f32_16x16x32_bf16 v[28:31], a[228:231], a[76:79], v[28:31]
  buffer_load_dwordx4 v226, s[16:19], s41 offen offset:0 lds
  v_mfma_f32_16x16x32_bf16 v[12:15], a[224:227], a[64:67], v[12:15]
  ds_read_b64_tr_b16 a[224:225], v228 offset:40960
  ds_read_b64_tr_b16 a[226:227], v228 offset:43008
  s_mov_b32 s41, 229376
  v_mfma_f32_16x16x32_bf16 v[12:15], a[228:231], a[72:75], v[12:15]
  s_barrier
  ds_read_b64_tr_b16 a[228:229], v229 offset:32768
  s_waitcnt vmcnt(15)
  v_mfma_f32_16x16x32_bf16 v[0:3], a[232:235], a[80:83], v[0:3]
  ds_read_b64_tr_b16 a[230:231], v229 offset:34816
  s_add_u32 m0, s42, 61440
  v_mfma_f32_16x16x32_bf16 v[0:3], a[192:195], a[88:91], v[0:3]
  buffer_load_dwordx4 v226, s[16:19], s41 offen offset:0 lds
  v_mfma_f32_16x16x32_bf16 v[16:19], a[232:235], a[84:87], v[16:19]
  ds_read_b64_tr_b16 a[232:233], v229 offset:40960
  ds_read_b64_tr_b16 a[234:235], v229 offset:43008
  s_mov_b32 s41, 458752
  v_mfma_f32_16x16x32_bf16 v[16:19], a[192:195], a[92:95], v[16:19]
  ds_read_b64_tr_b16 a[192:193], v230 offset:32768
  ds_read_b64_tr_b16 a[194:195], v230 offset:34816
  s_add_u32 m0, s42, 90112
  v_mfma_f32_16x16x32_bf16 v[20:23], a[196:199], a[84:87], v[20:23]
  buffer_load_dwordx4 v227, s[12:15], s41 offen offset:0 lds
  s_waitcnt lgkmcnt(13)
  v_mfma_f32_16x16x32_bf16 v[20:23], a[200:203], a[92:95], v[20:23]
  s_mov_b32 s41, 688128
  s_add_u32 m0, s42, 118784
  v_mfma_f32_16x16x32_bf16 v[4:7], a[196:199], a[80:83], v[4:7]
  buffer_load_dwordx4 v227, s[12:15], s41 offen offset:0 lds
  v_mfma_f32_16x16x32_bf16 v[4:7], a[200:203], a[88:91], v[4:7]
  ds_read_b64_tr_b16 a[196:197], v230 offset:40960
  ds_read_b64_tr_b16 a[198:199], v230 offset:43008
  s_mov_b32 s41, 458752
  v_mfma_f32_16x16x32_bf16 v[8:11], a[204:207], a[80:83], v[8:11]
  ds_read_b64_tr_b16 a[200:201], v231 offset:32768
  ds_read_b64_tr_b16 a[202:203], v231 offset:34816
  s_add_u32 m0, s42, 131072
  v_mfma_f32_16x16x32_bf16 v[8:11], a[208:211], a[88:91], v[8:11]
  buffer_load_dwordx4 v227, s[16:19], s41 offen offset:0 lds
  v_mfma_f32_16x16x32_bf16 v[24:27], a[204:207], a[84:87], v[24:27]
  ds_read_b64_tr_b16 a[204:205], v231 offset:40960
  ds_read_b64_tr_b16 a[206:207], v231 offset:43008
  s_mov_b32 s41, 688128
  v_mfma_f32_16x16x32_bf16 v[24:27], a[208:211], a[92:95], v[24:27]
  ds_read_b64_tr_b16 a[208:209], v228 offset:53248
  ds_read_b64_tr_b16 a[210:211], v228 offset:55296
  s_add_u32 m0, s42, 77824
  v_mfma_f32_16x16x32_bf16 v[28:31], a[212:215], a[84:87], v[28:31]
  buffer_load_dwordx4 v227, s[16:19], s41 offen offset:0 lds
  s_waitcnt lgkmcnt(13)
  v_mfma_f32_16x16x32_bf16 v[28:31], a[216:219], a[92:95], v[28:31]
  s_mov_b32 s41, 458752
  s_add_u32 m0, s42, 73728
  v_mfma_f32_16x16x32_bf16 v[12:15], a[212:215], a[80:83], v[12:15]
  ds_read_b64_tr_b16 a[212:213], v228 offset:57344
  ds_read_b64_tr_b16 a[214:215], v228 offset:59392
  v_mfma_f32_16x16x32_bf16 v[12:15], a[216:219], a[88:91], v[12:15]
  s_waitcnt vmcnt(19)
  s_barrier
  ds_read_b64_tr_b16 a[216:217], v229 offset:53248
  s_waitcnt vmcnt(14)
  v_mfma_f32_16x16x32_bf16 v[0:3], a[220:223], a[96:99], v[0:3]
  buffer_load_dwordx4 v226, s[12:15], s41 offen offset:0 lds
  v_mfma_f32_16x16x32_bf16 v[0:3], a[224:227], a[104:107], v[0:3]
  ds_read_b64_tr_b16 a[218:219], v229 offset:55296
  s_mov_b32 s41, 688128
  s_add_u32 m0, s42, 86016
  v_mfma_f32_16x16x32_bf16 v[16:19], a[220:223], a[100:103], v[16:19]
  buffer_load_dwordx4 v226, s[12:15], s41 offen offset:0 lds
  v_mfma_f32_16x16x32_bf16 v[16:19], a[224:227], a[108:111], v[16:19]
  ds_read_b64_tr_b16 a[220:221], v229 offset:57344
  ds_read_b64_tr_b16 a[222:223], v229 offset:59392
  s_mov_b32 s41, 458752
  s_waitcnt lgkmcnt(13)
  v_mfma_f32_16x16x32_bf16 v[20:23], a[228:231], a[100:103], v[20:23]
  ds_read_b64_tr_b16 a[224:225], v230 offset:53248
  ds_read_b64_tr_b16 a[226:227], v230 offset:55296
  s_add_u32 m0, s42, 102400
  v_mfma_f32_16x16x32_bf16 v[20:23], a[232:235], a[108:111], v[20:23]
  buffer_load_dwordx4 v226, s[16:19], s41 offen offset:0 lds
  v_mfma_f32_16x16x32_bf16 v[4:7], a[228:231], a[96:99], v[4:7]
  ds_read_b64_tr_b16 a[228:229], v230 offset:57344
  ds_read_b64_tr_b16 a[230:231], v230 offset:59392
  s_mov_b32 s41, 688128
  v_mfma_f32_16x16x32_bf16 v[4:7], a[232:235], a[104:107], v[4:7]
  ds_read_b64_tr_b16 a[232:233], v231 offset:53248
  ds_read_b64_tr_b16 a[234:235], v231 offset:55296
  s_add_u32 m0, s42, 98304
  v_mfma_f32_16x16x32_bf16 v[8:11], a[192:195], a[96:99], v[8:11]
  buffer_load_dwordx4 v226, s[16:19], s41 offen offset:0 lds
  s_waitcnt lgkmcnt(13)
  v_mfma_f32_16x16x32_bf16 v[8:11], a[196:199], a[104:107], v[8:11]
  s_mov_b32 s41, 917504
  s_add_u32 m0, s42, 110592
  v_mfma_f32_16x16x32_bf16 v[24:27], a[192:195], a[100:103], v[24:27]
  ds_read_b64_tr_b16 a[192:193], v231 offset:57344
  ds_read_b64_tr_b16 a[194:195], v231 offset:59392
  v_mfma_f32_16x16x32_bf16 v[24:27], a[196:199], a[108:111], v[24:27]
  buffer_load_dwordx4 v227, s[12:15], s41 offen offset:0 lds
  v_mfma_f32_16x16x32_bf16 v[28:31], a[200:203], a[100:103], v[28:31]
  ds_read_b64_tr_b16 a[196:197], v232 offset:0
  ds_read_b64_tr_b16 a[198:199], v232 offset:2048
  s_mov_b32 s41, 1146880
  v_mfma_f32_16x16x32_bf16 v[28:31], a[204:207], a[108:111], v[28:31]
  s_add_u32 m0, s42, 126976
  v_mfma_f32_16x16x32_bf16 v[12:15], a[200:203], a[96:99], v[12:15]
  buffer_load_dwordx4 v227, s[12:15], s41 offen offset:0 lds
  v_mfma_f32_16x16x32_bf16 v[12:15], a[204:207], a[104:107], v[12:15]
  s_barrier
  ds_read_b64_tr_b16 a[200:201], v232 offset:28672
  s_waitcnt vmcnt(14) lgkmcnt(13)
  v_mfma_f32_16x16x32_bf16 v[0:3], a[208:211], a[112:115], v[0:3]
  ds_read_b64_tr_b16 a[202:203], v232 offset:30720
  ds_read_b64_tr_b16 a[204:205], v233 offset:0
  s_mov_b32 s41, 917504
  v_mfma_f32_16x16x32_bf16 v[0:3], a[212:215], a[120:123], v[0:3]
  ds_read_b64_tr_b16 a[206:207], v233 offset:2048
  s_add_u32 m0, s42, 122880
  v_mfma_f32_16x16x32_bf16 v[16:19], a[208:211], a[116:119], v[16:19]
  buffer_load_dwordx4 v227, s[16:19], s41 offen offset:0 lds
  v_mfma_f32_16x16x32_bf16 v[16:19], a[212:215], a[124:127], v[16:19]
  ds_read_b64_tr_b16 a[208:209], v233 offset:28672
  ds_read_b64_tr_b16 a[210:211], v233 offset:30720
  s_mov_b32 s41, 1146880
  v_mfma_f32_16x16x32_bf16 v[20:23], a[216:219], a[116:119], v[20:23]
  s_add_u32 m0, s42, 135168
  s_waitcnt lgkmcnt(13)
  v_mfma_f32_16x16x32_bf16 v[20:23], a[220:223], a[124:127], v[20:23]
  buffer_load_dwordx4 v227, s[16:19], s41 offen offset:0 lds
  v_mfma_f32_16x16x32_bf16 v[4:7], a[216:219], a[112:115], v[4:7]
  v_mfma_f32_16x16x32_bf16 v[4:7], a[220:223], a[120:123], v[4:7]
  v_mfma_f32_16x16x32_bf16 v[8:11], a[224:227], a[112:115], v[8:11]
  s_waitcnt lgkmcnt(12)
  v_mfma_f32_16x16x32_bf16 v[8:11], a[228:231], a[120:123], v[8:11]
  v_mfma_f32_16x16x32_bf16 v[24:27], a[224:227], a[116:119], v[24:27]
  v_mfma_f32_16x16x32_bf16 v[24:27], a[228:231], a[124:127], v[24:27]
  s_waitcnt lgkmcnt(10)
  v_mfma_f32_16x16x32_bf16 v[28:31], a[232:235], a[116:119], v[28:31]
  s_waitcnt lgkmcnt(8)
  v_mfma_f32_16x16x32_bf16 v[28:31], a[192:195], a[124:127], v[28:31]
  v_mfma_f32_16x16x32_bf16 v[12:15], a[232:235], a[112:115], v[12:15]
  v_mfma_f32_16x16x32_bf16 v[12:15], a[192:195], a[120:123], v[12:15]
  v_pk_fma_f32 v[160:161], v[0:1], v[64:65], v[160:161]
  v_pk_fma_f32 v[162:163], v[2:3], v[66:67], v[162:163]
  v_pk_fma_f32 v[164:165], v[4:5], v[68:69], v[164:165]
  v_pk_fma_f32 v[166:167], v[6:7], v[70:71], v[166:167]
  v_pk_fma_f32 v[168:169], v[8:9], v[72:73], v[168:169]
  v_pk_fma_f32 v[170:171], v[10:11], v[74:75], v[170:171]
  s_nop 1
  v_pk_fma_f32 v[172:173], v[12:13], v[76:77], v[172:173]
  v_pk_fma_f32 v[174:175], v[14:15], v[78:79], v[174:175]
  v_pk_fma_f32 v[176:177], v[16:17], v[64:65], v[176:177]
  v_pk_fma_f32 v[178:179], v[18:19], v[66:67], v[178:179]
  v_pk_fma_f32 v[180:181], v[20:21], v[68:69], v[180:181]
  v_pk_fma_f32 v[182:183], v[22:23], v[70:71], v[182:183]
  v_pk_fma_f32 v[184:185], v[24:25], v[72:73], v[184:185]
  v_pk_fma_f32 v[186:187], v[26:27], v[74:75], v[186:187]
  v_pk_fma_f32 v[188:189], v[28:29], v[76:77], v[188:189]
  v_pk_fma_f32 v[190:191], v[30:31], v[78:79], v[190:191]
  v_pk_mul_f32 v[84:85], v[160:161], v[160:161]
  v_pk_mul_f32 v[86:87], v[176:177], v[176:177]
  v_pk_fma_f32 v[84:85], v[162:163], v[162:163], v[84:85]
  v_pk_add_f32 v[80:81], v[160:161], v[162:163]
  v_pk_fma_f32 v[86:87], v[178:179], v[178:179], v[86:87]
  v_pk_add_f32 v[82:83], v[176:177], v[178:179]
  v_pk_fma_f32 v[84:85], v[164:165], v[164:165], v[84:85]
  v_pk_add_f32 v[80:81], v[80:81], v[164:165]
  v_pk_fma_f32 v[86:87], v[180:181], v[180:181], v[86:87]
  v_pk_add_f32 v[82:83], v[82:83], v[180:181]
  v_pk_fma_f32 v[84:85], v[166:167], v[166:167], v[84:85]
  v_pk_add_f32 v[80:81], v[80:81], v[166:167]
  v_pk_fma_f32 v[86:87], v[182:183], v[182:183], v[86:87]
  v_pk_add_f32 v[82:83], v[82:83], v[182:183]
  v_pk_fma_f32 v[84:85], v[168:169], v[168:169], v[84:85]
  v_pk_add_f32 v[80:81], v[80:81], v[168:169]
  v_pk_fma_f32 v[86:87], v[184:185], v[184:185], v[86:87]
  v_pk_add_f32 v[82:83], v[82:83], v[184:185]
  v_pk_fma_f32 v[84:85], v[170:171], v[170:171], v[84:85]
  v_pk_add_f32 v[80:81], v[80:81], v[170:171]
  v_pk_fma_f32 v[86:87], v[186:187], v[186:187], v[86:87]
  v_pk_add_f32 v[82:83], v[82:83], v[186:187]
  v_pk_fma_f32 v[84:85], v[172:173], v[172:173], v[84:85]
  v_pk_add_f32 v[80:81], v[80:81], v[172:173]
  v_pk_fma_f32 v[86:87], v[188:189], v[188:189], v[86:87]
  v_pk_add_f32 v[82:83], v[82:83], v[188:189]
  v_pk_fma_f32 v[84:85], v[174:175], v[174:175], v[84:85]
  v_pk_add_f32 v[80:81], v[80:81], v[174:175]
  v_pk_fma_f32 v[86:87], v[190:191], v[190:191], v[86:87]
  v_pk_add_f32 v[82:83], v[82:83], v[190:191]
  v_add_f32 v80, v80, v81
  v_add_f32 v81, v84, v85
  v_add_f32 v82, v82, v83
  v_add_f32 v83, v86, v87
  v_mov_b32 v84, v80
  v_mov_b32 v85, v81
  v_mov_b32 v86, v82
  v_mov_b32 v87, v83
  v_permlane16_swap_b32 v84, v80
  v_permlane16_swap_b32 v85, v81
  v_permlane16_swap_b32 v86, v82
  v_permlane16_swap_b32 v87, v83
  v_add_f32 v80, v80, v84
  v_add_f32 v81, v81, v85
  v_add_f32 v82, v82, v86
  v_add_f32 v83, v83, v87
  v_mov_b32 v84, v80
  v_mov_b32 v85, v81
  v_mov_b32 v86, v82
  v_mov_b32 v87, v83
  v_permlane32_swap_b32 v84, v80
  v_permlane32_swap_b32 v85, v81
  v_permlane32_swap_b32 v86, v82
  v_permlane32_swap_b32 v87, v83
  v_add_f32 v80, v80, v84
  v_add_f32 v81, v81, v85
  v_add_f32 v82, v82, v86
  v_add_f32 v83, v83, v87
  v_cndmask_b32_e64 v84, v82, v80, s[34:35]
  v_cndmask_b32_e64 v85, v83, v81, s[34:35]
  v_and_b32 v84, -2, v84
  v_and_b32 v85, 0x7fffffff, v85
  s_mov_b32 exec_hi, 0
  buffer_store_dwordx2 v[84:85], v211, s[4:7], s95 offen sc1
  s_mov_b64 exec, -1
  v_cvt_pk_bf16_f32 v32, v160, v161
  v_cvt_pk_bf16_f32 v33, v162, v163
  v_cvt_pk_bf16_f32 v34, v164, v165
  v_cvt_pk_bf16_f32 v35, v166, v167
  v_cvt_pk_bf16_f32 v36, v168, v169
  v_cvt_pk_bf16_f32 v37, v170, v171
  v_cvt_pk_bf16_f32 v38, v172, v173
  v_cvt_pk_bf16_f32 v39, v174, v175
  v_cvt_pk_bf16_f32 v40, v176, v177
  v_cvt_pk_bf16_f32 v41, v178, v179
  v_cvt_pk_bf16_f32 v42, v180, v181
  v_cvt_pk_bf16_f32 v43, v182, v183
  v_cvt_pk_bf16_f32 v44, v184, v185
  v_cvt_pk_bf16_f32 v45, v186, v187
  v_cvt_pk_bf16_f32 v46, v188, v189
  v_cvt_pk_bf16_f32 v47, v190, v191
  v_accvgpr_write_b32 a236, v32
  v_lshlrev_b32 v0, 16, v32
  v_and_b32 v1, 0xffff0000, v32
  v_accvgpr_write_b32 a237, v33
  v_lshlrev_b32 v2, 16, v33
  v_and_b32 v3, 0xffff0000, v33
  v_accvgpr_write_b32 a238, v34
  v_lshlrev_b32 v4, 16, v34
  v_and_b32 v5, 0xffff0000, v34
  v_accvgpr_write_b32 a239, v35
  v_lshlrev_b32 v6, 16, v35
  v_and_b32 v7, 0xffff0000, v35
  v_accvgpr_write_b32 a240, v36
  v_lshlrev_b32 v8, 16, v36
  v_and_b32 v9, 0xffff0000, v36
  v_accvgpr_write_b32 a241, v37
  v_lshlrev_b32 v10, 16, v37
  v_and_b32 v11, 0xffff0000, v37
  v_accvgpr_write_b32 a242, v38
  v_lshlrev_b32 v12, 16, v38
  v_and_b32 v13, 0xffff0000, v38
  v_accvgpr_write_b32 a243, v39
  v_lshlrev_b32 v14, 16, v39
  v_and_b32 v15, 0xffff0000, v39
  v_accvgpr_write_b32 a244, v40
  v_lshlrev_b32 v16, 16, v40
  v_and_b32 v17, 0xffff0000, v40
  v_accvgpr_write_b32 a245, v41
  v_lshlrev_b32 v18, 16, v41
  v_and_b32 v19, 0xffff0000, v41
  v_accvgpr_write_b32 a246, v42
  v_lshlrev_b32 v20, 16, v42
  v_and_b32 v21, 0xffff0000, v42
  v_accvgpr_write_b32 a247, v43
  v_lshlrev_b32 v22, 16, v43
  v_and_b32 v23, 0xffff0000, v43
  v_accvgpr_write_b32 a248, v44
  v_lshlrev_b32 v24, 16, v44
  v_and_b32 v25, 0xffff0000, v44
  v_accvgpr_write_b32 a249, v45
  v_lshlrev_b32 v26, 16, v45
  v_and_b32 v27, 0xffff0000, v45
  v_accvgpr_write_b32 a250, v46
  v_lshlrev_b32 v28, 16, v46
  v_and_b32 v29, 0xffff0000, v46
  v_accvgpr_write_b32 a251, v47
  v_lshlrev_b32 v30, 16, v47
  v_and_b32 v31, 0xffff0000, v47
  s_mov_b64 vcc, -1
  s_cmp_eq_u32 s3, 0
  s_cbranch_scc1 L_wk1_0
  s_cmp_eq_u32 s3, 1
  s_cbranch_scc1 L_wk1_1
  s_cmp_eq_u32 s3, 2
  s_cbranch_scc1 L_wk1_2
  s_branch L_wk1_3
L_wk1_end:
  s_mov_b64 vcc, 0
  s_mov_b32 s33, 262144
L_spin_22:
  buffer_load_dwordx2 v[112:113], v212, s[4:7], s94 offen offset:0 sc1
  buffer_load_dwordx2 v[114:115], v212, s[4:7], s94 offen offset:1024 sc1
  buffer_load_dwordx2 v[116:117], v212, s[4:7], s94 offen offset:2048 sc1
  buffer_load_dwordx2 v[118:119], v212, s[4:7], s94 offen offset:3072 sc1
  buffer_load_dwordx2 v[120:121], v212, s[4:7], s94 offen offset:128 sc1
  buffer_load_dwordx2 v[122:123], v212, s[4:7], s94 offen offset:1152 sc1
  buffer_load_dwordx2 v[124:125], v212, s[4:7], s94 offen offset:2176 sc1
  buffer_load_dwordx2 v[126:127], v212, s[4:7], s94 offen offset:3200 sc1
  s_waitcnt vmcnt(0)
  v_max3_u32 v88, v112, v113, v114
  v_max3_u32 v88, v88, v115, v116
  v_max3_u32 v88, v88, v117, v118
  v_max3_u32 v88, v88, v119, v120
  v_max3_u32 v88, v88, v121, v122
  v_max3_u32 v88, v88, v123, v124
  v_max3_u32 v88, v88, v125, v126
  v_max_u32 v88, v88, v127
  v_cmp_eq_u32 s[68:69], -1, v88
  s_nop 1
  s_cmp_eq_u64 s[68:69], 0
  s_cbranch_scc1 L_ok_23
  s_sub_u32 s33, s33, 1
  s_cmp_lg_u32 s33, 0
  s_cbranch_scc1 L_spin_22
L_ok_23:
  v_pk_add_f32 v[80:81], v[112:113], v[114:115]
  v_pk_add_f32 v[84:85], v[116:117], v[118:119]
  v_pk_add_f32 v[82:83], v[120:121], v[122:123]
  v_pk_add_f32 v[86:87], v[124:125], v[126:127]
  v_pk_add_f32 v[80:81], v[80:81], v[84:85]
  v_pk_add_f32 v[82:83], v[82:83], v[86:87]
  v_mov_b32 v84, v80
  v_mov_b32 v85, v81
  v_mov_b32 v86, v82
  v_mov_b32 v87, v83
  v_permlane16_swap_b32 v84, v80
  v_permlane16_swap_b32 v85, v81
  v_permlane16_swap_b32 v86, v82
  v_permlane16_swap_b32 v87, v83
  v_add_f32 v80, v80, v84
  v_add_f32 v81, v81, v85
  v_add_f32 v82, v82, v86
  v_add_f32 v83, v83, v87
  v_mov_b32 v84, v80
  v_mov_b32 v85, v81
  v_mov_b32 v86, v82
  v_mov_b32 v87, v83
  v_permlane32_swap_b32 v84, v80
  v_permlane32_swap_b32 v85, v81
  v_permlane32_swap_b32 v86, v82
  v_permlane32_swap_b32 v87, v83
  v_add_f32 v80, v80, v84
  v_add_f32 v81, v81, v85
  v_add_f32 v82, v82, v86
  v_add_f32 v83, v83, v87
  v_mul_f32 v160, 0x3a800000, v80
  v_mul_f32 v164, 0x3a800000, v81
  v_mul_f32 v172, 0x3a800000, v82
  v_mul_f32 v176, 0x3a800000, v83
  v_fma_f32 v164, -v160, v160, v164
  v_fma_f32 v176, -v172, v172, v176
  v_max_f32 v164, 0, v164
  v_max_f32 v176, 0, v176
  v_cvt_pk_bf16_f32 v168, v160, v164
  v_cvt_pk_bf16_f32 v180, v172, v176
  v_lshlrev_b32 v160, 16, v168
  v_lshlrev_b32 v172, 16, v180
  v_and_b32 v164, 0xffff0000, v168
  v_and_b32 v176, 0xffff0000, v180
  v_add_f32 v164, 0x3727c5ac, v164
  v_add_f32 v176, 0x3727c5ac, v176
  v_cvt_pk_bf16_f32 v168, v164, v165
  v_cvt_pk_bf16_f32 v180, v176, v177
  v_lshlrev_b32 v164, 16, v168
  v_lshlrev_b32 v176, 16, v180
  v_and_b32 v165, 0xffff0000, v168
  v_and_b32 v177, 0xffff0000, v180
  v_sqrt_f32 v164, v164
  v_sqrt_f32 v176, v176
  v_cvt_pk_bf16_f32 v168, v164, v165
  v_cvt_pk_bf16_f32 v180, v176, v177
  v_lshlrev_b32 v164, 16, v168
  v_lshlrev_b32 v176, 16, v180
  v_and_b32 v165, 0xffff0000, v168
  v_and_b32 v177, 0xffff0000, v180
  v_rcp_f32 v164, v164
  v_rcp_f32 v176, v176
  v_mov_b32 v161, v160
  v_mov_b32 v173, v172
  v_mov_b32 v165, v164
  v_mov_b32 v177, v176
  v_pk_add_f32 v[0:1], v[0:1], v[160:161] neg_lo:[0,1] neg_hi:[0,1]
  v_pk_add_f32 v[2:3], v[2:3], v[160:161] neg_lo:[0,1] neg_hi:[0,1]
  v_pk_add_f32 v[4:5], v[4:5], v[160:161] neg_lo:[0,1] neg_hi:[0,1]
  v_pk_add_f32 v[6:7], v[6:7], v[160:161] neg_lo:[0,1] neg_hi:[0,1]
  v_pk_add_f32 v[8:9], v[8:9], v[160:161] neg_lo:[0,1] neg_hi:[0,1]
  v_pk_add_f32 v[10:11], v[10:11], v[160:161] neg_lo:[0,1] neg_hi:[0,1]
  v_pk_add_f32 v[12:13], v[12:13], v[160:161] neg_lo:[0,1] neg_hi:[0,1]
  v_pk_add_f32 v[14:15], v[14:15], v[160:161] neg_lo:[0,1] neg_hi:[0,1]
  v_pk_mul_f32 v[0:1], v[0:1], v[164:165]
  v_pk_mul_f32 v[2:3], v[2:3], v[164:165]
  v_pk_mul_f32 v[4:5], v[4:5], v[164:165]
  v_pk_mul_f32 v[6:7], v[6:7], v[164:165]
  v_pk_mul_f32 v[8:9], v[8:9], v[164:165]
  v_pk_mul_f32 v[10:11], v[10:11], v[164:165]
  v_pk_mul_f32 v[12:13], v[12:13], v[164:165]
  v_pk_mul_f32 v[14:15], v[14:15], v[164:165]
  v_pk_fma_f32 v[0:1], v[0:1], v[144:145], v[96:97]
  v_pk_fma_f32 v[2:3], v[2:3], v[146:147], v[98:99]
  v_pk_fma_f32 v[4:5], v[4:5], v[148:149], v[100:101]
  v_pk_fma_f32 v[6:7], v[6:7], v[150:151], v[102:103]
  v_pk_fma_f32 v[8:9], v[8:9], v[152:153], v[104:105]
  v_pk_fma_f32 v[10:11], v[10:11], v[154:155], v[106:107]
  v_pk_fma_f32 v[12:13], v[12:13], v[156:157], v[108:109]
  v_pk_fma_f32 v[14:15], v[14:15], v[158:159], v[110:111]
  v_cvt_pk_bf16_f32 v112, v0, v1
  v_cvt_pk_bf16_f32 v113, v2, v3
  v_cvt_pk_bf16_f32 v114, v4, v5
  v_cvt_pk_bf16_f32 v115, v6, v7
  v_cvt_pk_bf16_f32 v116, v8, v9
  v_cvt_pk_bf16_f32 v117, v10, v11
  v_cvt_pk_bf16_f32 v118, v12, v13
  v_cvt_pk_bf16_f32 v119, v14, v15
  buffer_store_dwordx4 v[112:115], v240, s[4:7], s98 offen offset:0 sc1
  buffer_store_dwordx4 v[116:119], v240, s[4:7], s99 offen offset:0 sc1
  v_pk_add_f32 v[16:17], v[16:17], v[172:173] neg_lo:[0,1] neg_hi:[0,1]
  v_pk_add_f32 v[18:19], v[18:19], v[172:173] neg_lo:[0,1] neg_hi:[0,1]
  v_pk_add_f32 v[20:21], v[20:21], v[172:173] neg_lo:[0,1] neg_hi:[0,1]
  v_pk_add_f32 v[22:23], v[22:23], v[172:173] neg_lo:[0,1] neg_hi:[0,1]
  v_pk_add_f32 v[24:25], v[24:25], v[172:173] neg_lo:[0,1] neg_hi:[0,1]
  v_pk_add_f32 v[26:27], v[26:27], v[172:173] neg_lo:[0,1] neg_hi:[0,1]
  v_pk_add_f32 v[28:29], v[28:29], v[172:173] neg_lo:[0,1] neg_hi:[0,1]
  v_pk_add_f32 v[30:31], v[30:31], v[172:173] neg_lo:[0,1] neg_hi:[0,1]
  v_pk_mul_f32 v[16:17], v[16:17], v[176:177]
  v_pk_mul_f32 v[18:19], v[18:19], v[176:177]
L_wk1_0:
  s_cbranch_vccnz L_wk1_4
  v_pk_mul_f32 v[20:21], v[20:21], v[176:177]
  v_pk_mul_f32 v[22:23], v[22:23], v[176:177]
  v_pk_mul_f32 v[24:25], v[24:25], v[176:177]
  v_pk_mul_f32 v[26:27], v[26:27], v[176:177]
  v_pk_mul_f32 v[28:29], v[28:29], v[176:177]
  v_pk_mul_f32 v[30:31], v[30:31], v[176:177]
  v_pk_fma_f32 v[16:17], v[16:17], v[144:145], v[96:97]
  v_pk_fma_f32 v[18:19], v[18:19], v[146:147], v[98:99]
  v_pk_fma_f32 v[20:21], v[20:21], v[148:149], v[100:101]
  v_pk_fma_f32 v[22:23], v[22:23], v[150:151], v[102:103]
  v_pk_fma_f32 v[24:25], v[24:25], v[152:153], v[104:105]
  v_pk_fma_f32 v[26:27], v[26:27], v[154:155], v[106:107]
  v_pk_fma_f32 v[28:29], v[28:29], v[156:157], v[108:109]
  v_pk_fma_f32 v[30:31], v[30:31], v[158:159], v[110:111]
  v_cvt_pk_bf16_f32 v120, v16, v17
  v_cvt_pk_bf16_f32 v121, v18, v19
  v_cvt_pk_bf16_f32 v122, v20, v21
  v_cvt_pk_bf16_f32 v123, v22, v23
  v_cvt_pk_bf16_f32 v124, v24, v25
  v_cvt_pk_bf16_f32 v125, v26, v27
  v_cvt_pk_bf16_f32 v126, v28, v29
  v_cvt_pk_bf16_f32 v127, v30, v31
  buffer_store_dwordx4 v[120:123], v240, s[4:7], s98 offen offset:1024 sc1
  buffer_store_dwordx4 v[124:127], v240, s[4:7], s99 offen offset:1024 sc1
  v_and_b32 v80, 1088, v254
  s_barrier
  ds_read_b64_tr_b16 a[212:213], v232 offset:40960
  ds_read_b64_tr_b16 a[214:215], v232 offset:43008
  ds_read_b64_tr_b16 a[216:217], v232 offset:49152
  ds_read_b64_tr_b16 a[218:219], v232 offset:51200
  ds_read_b64_tr_b16 a[220:221], v233 offset:40960
  ds_read_b64_tr_b16 a[222:223], v233 offset:43008
  ds_read_b64_tr_b16 a[224:225], v233 offset:49152
  ds_read_b64_tr_b16 a[226:227], v233 offset:51200
  ds_read_b64_tr_b16 a[228:229], v234 offset:0
  ds_read_b64_tr_b16 a[230:231], v234 offset:2048
  ds_read_b64_tr_b16 a[232:233], v234 offset:28672
  ds_read_b64_tr_b16 a[234:235], v234 offset:30720
  ds_read_b64_tr_b16 a[192:193], v234 offset:40960
  ds_read_b64_tr_b16 a[194:195], v234 offset:43008
  s_waitcnt vmcnt(0)
  v_add_u32 v248, 0, v245
  buffer_store_dword v248, v246, s[4:7], s92 offen sc1
  s_mov_b32 s33, 262144
L_spin_24:
  s_mov_b32 s30, 9437184
  buffer_load_dwordx4 v[128:131], v225, s[4:7], s30 offen offset:0 sc1
  buffer_load_dwordx4 v[132:135], v225, s[4:7], s30 offen offset:1024 sc1
  buffer_load_dwordx4 v[136:139], v225, s[4:7], s30 offen offset:2048 sc1
  buffer_load_dwordx4 v[140:143], v225, s[4:7], s30 offen offset:3072 sc1
  s_mov_b32 s30, 9568256
  buffer_load_dwordx4 v[144:147], v225, s[4:7], s30 offen offset:0 sc1
  buffer_load_dwordx4 v[148:151], v225, s[4:7], s30 offen offset:1024 sc1
  buffer_load_dwordx4 v[152:155], v225, s[4:7], s30 offen offset:2048 sc1
  buffer_load_dwordx4 v[156:159], v225, s[4:7], s30 offen offset:3072 sc1
  s_waitcnt vmcnt(7)
  v_max3_u32 v80, v128, v129, v130
  v_max_u32 v80, v80, v131
  v_accvgpr_write_b32 a128, v128
  v_accvgpr_write_b32 a129, v129
  v_accvgpr_write_b32 a130, v130
  v_accvgpr_write_b32 a131, v131
  s_waitcnt vmcnt(6)
  v_max3_u32 v80, v80, v132, v133
  v_max3_u32 v80, v80, v134, v135
  v_accvgpr_write_b32 a132, v132
  v_accvgpr_write_b32 a133, v133
  v_accvgpr_write_b32 a134, v134
  v_accvgpr_write_b32 a135, v135
  s_waitcnt vmcnt(5)
  v_max3_u32 v80, v80, v136, v137
  v_max3_u32 v80, v80, v138, v139
  v_accvgpr_write_b32 a136, v136
  v_accvgpr_write_b32 a137, v137
  v_accvgpr_write_b32 a138, v138
  v_accvgpr_write_b32 a139, v139
  s_waitcnt vmcnt(4)
  v_max3_u32 v80, v80, v140, v141
  v_max3_u32 v80, v80, v142, v143
  v_accvgpr_write_b32 a140, v140
  v_accvgpr_write_b32 a141, v141
  v_accvgpr_write_b32 a142, v142
  v_accvgpr_write_b32 a143, v143
  s_waitcnt vmcnt(3)
  v_max3_u32 v80, v80, v144, v145
  v_max3_u32 v80, v80, v146, v147
  v_accvgpr_write_b32 a144, v144
  v_accvgpr_write_b32 a145, v145
  v_accvgpr_write_b32 a146, v146
  v_accvgpr_write_b32 a147, v147
  s_waitcnt vmcnt(2)
  v_max3_u32 v80, v80, v148, v149
  v_max3_u32 v80, v80, v150, v151
  v_accvgpr_write_b32 a148, v148
  v_accvgpr_write_b32 a149, v149
  v_accvgpr_write_b32 a150, v150
  v_accvgpr_write_b32 a151, v151
  s_waitcnt vmcnt(1)
  v_max3_u32 v80, v80, v152, v153
  v_max3_u32 v80, v80, v154, v155
  v_accvgpr_write_b32 a152, v152
  v_accvgpr_write_b32 a153, v153
  v_accvgpr_write_b32 a154, v154
  v_accvgpr_write_b32 a155, v155
  s_waitcnt vmcnt(0)
  v_max3_u32 v80, v80, v156, v157
  v_max3_u32 v80, v80, v158, v159
  v_accvgpr_write_b32 a156, v156
  v_accvgpr_write_b32 a157, v157
  v_accvgpr_write_b32 a158, v158
  v_accvgpr_write_b32 a159, v159
  v_cmp_eq_u32 s[68:69], -1, v80
  s_nop 1
  s_cmp_eq_u64 s[68:69], 0
  s_cbranch_scc1 L_ok_25
  s_sub_u32 s33, s33, 1
  s_cmp_lg_u32 s33, 0
  s_cbranch_scc1 L_spin_24
L_ok_25:
  s_waitcnt lgkmcnt(13)
  v_mfma_f32_16x16x32_bf16 v[0:3], a[196:199], a[128:131], 0
  v_mfma_f32_16x16x32_bf16 v[0:3], a[200:203], a[144:147], v[0:3]
  v_mfma_f32_16x16x32_bf16 v[16:19], a[196:199], a[132:135], 0
  v_mfma_f32_16x16x32_bf16 v[16:19], a[200:203], a[148:151], v[16:19]
  s_load_dwordx2 s[66:67], s[36:37], 0x0
  v_mfma_f32_16x16x32_bf16 v[32:35], a[196:199], a[136:139], 0
  v_mfma_f32_16x16x32_bf16 v[32:35], a[200:203], a[152:155], v[32:35]
  v_mfma_f32_16x16x32_bf16 v[48:51], a[196:199], a[140:143], 0
  ds_read_b64_tr_b16 a[196:197], v234 offset:49152
  v_mfma_f32_16x16x32_bf16 v[48:51], a[200:203], a[156:159], v[48:51]
  ds_read_b64_tr_b16 a[198:199], v234 offset:51200
  s_mov_b32 s41, 917504
  v_mfma_f32_16x16x32_bf16 v[52:55], a[204:207], a[140:143], 0
  ds_read_b64_tr_b16 a[200:201], v236 offset:12288
  s_add_u32 m0, s42, 151552
  v_mfma_f32_16x16x32_bf16 v[52:55], a[208:211], a[156:159], v[52:55]
  buffer_load_dwordx4 v226, s[12:15], s41 offen offset:0 lds
  v_mfma_f32_16x16x32_bf16 v[36:39], a[204:207], a[136:139], 0
  ds_read_b64_tr_b16 a[202:203], v236 offset:14336
  v_mfma_f32_16x16x32_bf16 v[36:39], a[208:211], a[152:155], v[36:39]
  v_mfma_f32_16x16x32_bf16 v[20:23], a[204:207], a[132:135], 0
  v_mfma_f32_16x16x32_bf16 v[20:23], a[208:211], a[148:151], v[20:23]
  buffer_load_dword v244, v254, s[4:7], s93 offen sc1
  v_mfma_f32_16x16x32_bf16 v[4:7], a[204:207], a[128:131], 0
  ds_read_b64_tr_b16 a[204:205], v232 offset:4096
  s_mov_b32 s41, 1146880
  v_mfma_f32_16x16x32_bf16 v[4:7], a[208:211], a[144:147], v[4:7]
  ds_read_b64_tr_b16 a[206:207], v232 offset:6144
  s_add_u32 m0, s42, 147456
  s_waitcnt lgkmcnt(13)
  v_mfma_f32_16x16x32_bf16 v[8:11], a[212:215], a[128:131], 0
  buffer_load_dwordx4 v226, s[12:15], s41 offen offset:0 lds
  v_mfma_f32_16x16x32_bf16 v[8:11], a[216:219], a[144:147], v[8:11]
  s_barrier
  v_mfma_f32_16x16x32_bf16 v[24:27], a[212:215], a[132:135], 0
  ds_read_b64_tr_b16 a[208:209], v237 offset:12288
  ds_read_b64_tr_b16 a[210:211], v237 offset:14336
  v_mfma_f32_16x16x32_bf16 v[24:27], a[216:219], a[148:151], v[24:27]
  v_mfma_f32_16x16x32_bf16 v[40:43], a[212:215], a[136:139], 0
  v_mfma_f32_16x16x32_bf16 v[40:43], a[216:219], a[152:155], v[40:43]
  v_mfma_f32_16x16x32_bf16 v[56:59], a[212:215], a[140:143], 0
  ds_read_b64_tr_b16 a[212:213], v233 offset:4096
  v_mfma_f32_16x16x32_bf16 v[56:59], a[216:219], a[156:159], v[56:59]
  ds_read_b64_tr_b16 a[214:215], v233 offset:6144
  v_mfma_f32_16x16x32_bf16 v[60:63], a[220:223], a[140:143], 0
  ds_read_b64_tr_b16 a[216:217], v238 offset:12288
  s_waitcnt lgkmcnt(13)
  v_mfma_f32_16x16x32_bf16 v[60:63], a[224:227], a[156:159], v[60:63]
  ds_read_b64_tr_b16 a[218:219], v238 offset:14336
  s_load_dwordx2 s[66:67], s[36:37], 0x20000
  v_mfma_f32_16x16x32_bf16 v[44:47], a[220:223], a[136:139], 0
  v_mfma_f32_16x16x32_bf16 v[44:47], a[224:227], a[152:155], v[44:47]
  v_mfma_f32_16x16x32_bf16 v[28:31], a[220:223], a[132:135], 0
  v_mfma_f32_16x16x32_bf16 v[28:31], a[224:227], a[148:151], v[28:31]
  v_mfma_f32_16x16x32_bf16 v[12:15], a[220:223], a[128:131], 0
  ds_read_b64_tr_b16 a[220:221], v234 offset:4096
  v_mfma_f32_16x16x32_bf16 v[12:15], a[224:227], a[144:147], v[12:15]
  ds_read_b64_tr_b16 a[222:223], v234 offset:6144
  v_mfma_f32_16x16x32_bf16 v[64:67], a[228:231], a[128:131], 0
  ds_read_b64_tr_b16 a[224:225], v239 offset:12288
  v_mfma_f32_16x16x32_bf16 v[64:67], a[232:235], a[144:147], v[64:67]
  ds_read_b64_tr_b16 a[226:227], v239 offset:14336
  v_mfma_f32_16x16x32_bf16 v[72:75], a[228:231], a[132:135], 0
  v_mfma_f32_16x16x32_bf16 v[72:75], a[232:235], a[148:151], v[72:75]
  v_mfma_f32_16x16x32_bf16 v[80:83], a[228:231], a[136:139], 0
  v_mfma_f32_16x16x32_bf16 v[80:83], a[232:235], a[152:155], v[80:83]
  v_mfma_f32_16x16x32_bf16 v[88:91], a[228:231], a[140:143], 0
  ds_read_b64_tr_b16 a[228:229], v235 offset:4096
  v_mfma_f32_16x16x32_bf16 v[88:91], a[232:235], a[156:159], v[88:91]
  ds_read_b64_tr_b16 a[230:231], v235 offset:6144
  s_mov_b32 s41, 917504
  s_waitcnt lgkmcnt(13)
  v_mfma_f32_16x16x32_bf16 v[92:95], a[192:195], a[140:143], 0
  ds_read_b64_tr_b16 a[232:233], v232 offset:16384
  s_add_u32 m0, s42, 159744
  v_mfma_f32_16x16x32_bf16 v[92:95], a[196:199], a[156:159], v[92:95]
  buffer_load_dwordx4 v226, s[16:19], s41 offen offset:0 lds
  v_mfma_f32_16x16x32_bf16 v[84:87], a[192:195], a[136:139], 0
  ds_read_b64_tr_b16 a[234:235], v232 offset:18432
  v_mfma_f32_16x16x32_bf16 v[84:87], a[196:199], a[152:155], v[84:87]
  v_mfma_f32_16x16x32_bf16 v[76:79], a[192:195], a[132:135], 0
  v_mfma_f32_16x16x32_bf16 v[76:79], a[196:199], a[148:151], v[76:79]
  v_mfma_f32_16x16x32_bf16 v[68:71], a[192:195], a[128:131], 0
  ds_read_b64_tr_b16 a[192:193], v228 offset:61440
  s_mov_b32 s41, 1146880
  v_mfma_f32_16x16x32_bf16 v[68:71], a[196:199], a[144:147], v[68:71]
  ds_read_b64_tr_b16 a[194:195], v228 offset:63488
  s_add_u32 m0, s42, 16384
  s_load_dwordx2 s[66:67], s[36:37], 0x40000
  v_mfma_f32_16x16x32_bf16 v[96:99], a[200:203], a[128:131], 0
  buffer_load_dwordx4 v226, s[16:19], s41 offen offset:0 lds
  s_waitcnt lgkmcnt(13)
  v_mfma_f32_16x16x32_bf16 v[96:99], a[204:207], a[144:147], v[96:99]
  ds_read_b64_tr_b16 a[196:197], v233 offset:16384
  ds_read_b64_tr_b16 a[198:199], v233 offset:18432
  s_waitcnt vmcnt(3)
  v_subrev_u32 v244, s100, v244
  v_mfma_f32_16x16x32_bf16 v[128:131], a[200:203], a[132:135], 0
  v_cmp_lt_u32 s[68:69], 7, v244
  v_mfma_f32_16x16x32_bf16 v[128:131], a[204:207], a[148:151], v[128:131]
  v_mfma_f32_16x16x32_bf16 v[160:163], a[200:203], a[136:139], 0
  s_cmp_lg_u64 s[68:69], 0
  s_cbranch_scc1 L_slow_26
L_back_27:
  v_mfma_f32_16x16x32_bf16 v[160:163], a[204:207], a[152:155], v[160:163]
  s_mov_b32 s40, 9699328
  v_mfma_f32_16x16x32_bf16 v[192:195], a[200:203], a[140:143], 0
  buffer_load_dwordx4 a[160:163], v225, s[4:7], s40 offen offset:0 sc1
  v_mfma_f32_16x16x32_bf16 v[192:195], a[204:207], a[156:159], v[192:195]
  ds_read_b64_tr_b16 a[200:201], v229 offset:61440
  v_mfma_f32_16x16x32_bf16 v[196:199], a[208:211], a[140:143], 0
  buffer_load_dwordx4 a[164:167], v225, s[4:7], s40 offen offset:1024 sc1
  s_waitcnt lgkmcnt(13)
  v_mfma_f32_16x16x32_bf16 v[196:199], a[212:215], a[156:159], v[196:199]
  ds_read_b64_tr_b16 a[202:203], v229 offset:63488
  ds_read_b64_tr_b16 a[204:205], v234 offset:16384
  v_mfma_f32_16x16x32_bf16 v[164:167], a[208:211], a[136:139], 0
  buffer_load_dwordx4 a[168:171], v225, s[4:7], s40 offen offset:2048 sc1
  v_mfma_f32_16x16x32_bf16 v[164:167], a[212:215], a[152:155], v[164:167]
  ds_read_b64_tr_b16 a[206:207], v234 offset:18432
  s_mov_b32 s78, 2621440
  v_mfma_f32_16x16x32_bf16 v[132:135], a[208:211], a[132:135], 0
  buffer_load_dwordx4 a[172:175], v225, s[4:7], s40 offen offset:3072 sc1
  v_mfma_f32_16x16x32_bf16 v[132:135], a[212:215], a[148:151], v[132:135]
  s_mov_b32 s40, 9830400
  v_mfma_f32_16x16x32_bf16 v[100:103], a[208:211], a[128:131], 0
  buffer_load_dwordx4 a[176:179], v225, s[4:7], s40 offen offset:0 sc1
  v_mfma_f32_16x16x32_bf16 v[100:103], a[212:215], a[144:147], v[100:103]
  ds_read_b64_tr_b16 a[208:209], v230 offset:61440
  v_mfma_f32_16x16x32_bf16 v[104:107], a[216:219], a[128:131], 0
  buffer_load_dwordx4 a[180:183], v225, s[4:7], s40 offen offset:1024 sc1
  s_waitcnt lgkmcnt(13)
  v_mfma_f32_16x16x32_bf16 v[104:107], a[220:223], a[144:147], v[104:107]
  ds_read_b64_tr_b16 a[210:211], v230 offset:63488
  ds_read_b64_tr_b16 a[212:213], v235 offset:16384
  v_mfma_f32_16x16x32_bf16 v[136:139], a[216:219], a[132:135], 0
  buffer_load_dwordx4 a[184:187], v225, s[4:7], s40 offen offset:2048 sc1
  v_mfma_f32_16x16x32_bf16 v[136:139], a[220:223], a[148:151], v[136:139]
  ds_read_b64_tr_b16 a[214:215], v235 offset:18432
  v_mfma_f32_16x16x32_bf16 v[168:171], a[216:219], a[136:139], 0
  buffer_load_dwordx4 a[188:191], v225, s[4:7], s40 offen offset:3072 sc1
  v_mfma_f32_16x16x32_bf16 v[168:171], a[220:223], a[152:155], v[168:171]
  s_mov_b32 s40, 9961472
  s_load_dwordx2 s[66:67], s[36:37], 0x60000
  v_mfma_f32_16x16x32_bf16 v[200:203], a[216:219], a[140:143], 0
  ds_read_b64_tr_b16 a[216:217], v231 offset:61440
  v_mfma_f32_16x16x32_bf16 v[200:203], a[220:223], a[156:159], v[200:203]
  ds_read_b64_tr_b16 a[218:219], v231 offset:63488
  v_mfma_f32_16x16x32_bf16 v[204:207], a[224:227], a[140:143], 0
  ds_read_b64_tr_b16 a[220:221], v232 offset:24576
  s_waitcnt lgkmcnt(13)
  v_mfma_f32_16x16x32_bf16 v[204:207], a[228:231], a[156:159], v[204:207]
  s_barrier
  v_mfma_f32_16x16x32_bf16 v[172:175], a[224:227], a[136:139], 0
  ds_read_b64_tr_b16 a[222:223], v232 offset:26624
  v_mfma_f32_16x16x32_bf16 v[172:175], a[228:231], a[152:155], v[172:175]
  buffer_load_dwordx4 a[0:3], v225, s[4:7], s40 offen offset:0 sc1
  v_mfma_f32_16x16x32_bf16 v[140:143], a[224:227], a[132:135], 0
  buffer_load_dword v241, v247, s[56:59], s78 offen
  v_mfma_f32_16x16x32_bf16 v[140:143], a[228:231], a[148:151], v[140:143]
  v_mfma_f32_16x16x32_bf16 v[108:111], a[224:227], a[128:131], 0
  ds_read_b64_tr_b16 a[224:225], v232 offset:53248
  v_mfma_f32_16x16x32_bf16 v[108:111], a[228:231], a[144:147], v[108:111]
  ds_read_b64_tr_b16 a[226:227], v232 offset:55296
  v_mfma_f32_16x16x32_bf16 v[112:115], a[232:235], a[128:131], 0
  ds_read_b64_tr_b16 a[228:229], v233 offset:24576
  v_mfma_f32_16x16x32_bf16 v[112:115], a[192:195], a[144:147], v[112:115]
  buffer_load_dwordx4 a[4:7], v225, s[4:7], s40 offen offset:1024 sc1
  v_mfma_f32_16x16x32_bf16 v[144:147], a[232:235], a[132:135], 0
  ds_read_b64_tr_b16 a[230:231], v233 offset:26624
  v_mfma_f32_16x16x32_bf16 v[144:147], a[192:195], a[148:151], v[144:147]
  v_mfma_f32_16x16x32_bf16 v[176:179], a[232:235], a[136:139], 0
  v_mfma_f32_16x16x32_bf16 v[176:179], a[192:195], a[152:155], v[176:179]
  v_mfma_f32_16x16x32_bf16 v[208:211], a[232:235], a[140:143], 0
  ds_read_b64_tr_b16 a[232:233], v233 offset:53248
  v_mfma_f32_16x16x32_bf16 v[208:211], a[192:195], a[156:159], v[208:211]
  buffer_load_dwordx4 a[8:11], v225, s[4:7], s40 offen offset:2048 sc1
  s_waitcnt lgkmcnt(13)
  v_mfma_f32_16x16x32_bf16 v[212:215], a[196:199], a[140:143], 0
  ds_read_b64_tr_b16 a[234:235], v233 offset:55296
  v_mfma_f32_16x16x32_bf16 v[212:215], a[200:203], a[156:159], v[212:215]
  ds_read_b64_tr_b16 a[192:193], v236 offset:0
  ds_read_b64_tr_b16 a[194:195], v236 offset:2048
  v_mfma_f32_16x16x32_bf16 v[180:183], a[196:199], a[136:139], 0
  v_mfma_f32_16x16x32_bf16 v[180:183], a[200:203], a[152:155], v[180:183]
  s_load_dwordx2 s[66:67], s[36:37], 0x80000
  v_mfma_f32_16x16x32_bf16 v[148:151], a[196:199], a[132:135], 0
  v_mfma_f32_16x16x32_bf16 v[148:151], a[200:203], a[148:151], v[148:151]
  buffer_load_dwordx4 a[12:15], v225, s[4:7], s40 offen offset:3072 sc1
  v_mfma_f32_16x16x32_bf16 v[116:119], a[196:199], a[128:131], 0
  ds_read_b64_tr_b16 a[196:197], v232 offset:12288
  s_mov_b32 s40, 10092544
  v_mfma_f32_16x16x32_bf16 v[116:119], a[200:203], a[144:147], v[116:119]
  ds_read_b64_tr_b16 a[198:199], v232 offset:14336
  v_mfma_f32_16x16x32_bf16 v[120:123], a[204:207], a[128:131], 0
  ds_read_b64_tr_b16 a[200:201], v237 offset:0
  s_waitcnt lgkmcnt(13)
  v_mfma_f32_16x16x32_bf16 v[120:123], a[208:211], a[144:147], v[120:123]
  ds_read_b64_tr_b16 a[202:203], v237 offset:2048
  v_mfma_f32_16x16x32_bf16 v[152:155], a[204:207], a[132:135], 0
  v_mfma_f32_16x16x32_bf16 v[152:155], a[208:211], a[148:151], v[152:155]
  buffer_load_dwordx4 a[16:19], v225, s[4:7], s40 offen offset:0 sc1
  v_mfma_f32_16x16x32_bf16 v[184:187], a[204:207], a[136:139], 0
  v_mfma_f32_16x16x32_bf16 v[184:187], a[208:211], a[152:155], v[184:187]
  v_mfma_f32_16x16x32_bf16 v[216:219], a[204:207], a[140:143], 0
  ds_read_b64_tr_b16 a[204:205], v233 offset:12288
  v_mfma_f32_16x16x32_bf16 v[216:219], a[208:211], a[156:159], v[216:219]
  ds_read_b64_tr_b16 a[206:207], v233 offset:14336
  v_mfma_f32_16x16x32_bf16 v[220:223], a[212:215], a[140:143], 0
  ds_read_b64_tr_b16 a[208:209], v234 offset:24576
  v_mfma_f32_16x16x32_bf16 v[220:223], a[216:219], a[156:159], v[220:223]
  buffer_load_dwordx4 a[20:23], v225, s[4:7], s40 offen offset:1024 sc1
  v_mfma_f32_16x16x32_bf16 v[188:191], a[212:215], a[136:139], 0
  ds_read_b64_tr_b16 a[210:211], v234 offset:26624
  v_mfma_f32_16x16x32_bf16 v[188:191], a[216:219], a[152:155], v[188:191]
  v_mfma_f32_16x16x32_bf16 v[156:159], a[212:215], a[132:135], 0
  v_mfma_f32_16x16x32_bf16 v[156:159], a[216:219], a[148:151], v[156:159]
  v_mfma_f32_16x16x32_bf16 v[124:127], a[212:215], a[128:131], 0
  ds_read_b64_tr_b16 a[212:213], v234 offset:53248
  v_mfma_f32_16x16x32_bf16 v[124:127], a[216:219], a[144:147], v[124:127]
  buffer_load_dwordx4 a[24:27], v225, s[4:7], s40 offen offset:2048 sc1
  s_waitcnt vmcnt(12) lgkmcnt(13)
  v_mfma_f32_16x16x32_bf16 v[0:3], a[220:223], a[160:163], v[0:3]
  ds_read_b64_tr_b16 a[214:215], v234 offset:55296
  s_waitcnt vmcnt(8)
  v_mfma_f32_16x16x32_bf16 v[0:3], a[224:227], a[176:179], v[0:3]
  ds_read_b64_tr_b16 a[216:217], v238 offset:0
  ds_read_b64_tr_b16 a[218:219], v238 offset:2048
  s_load_dwordx2 s[66:67], s[36:37], 0xa0000
  v_mfma_f32_16x16x32_bf16 v[16:19], a[220:223], a[164:167], v[16:19]
  v_mfma_f32_16x16x32_bf16 v[16:19], a[224:227], a[180:183], v[16:19]
  v_mfma_f32_16x16x32_bf16 v[32:35], a[220:223], a[168:171], v[32:35]
  v_mfma_f32_16x16x32_bf16 v[32:35], a[224:227], a[184:187], v[32:35]
  buffer_load_dwordx4 a[28:31], v225, s[4:7], s40 offen offset:3072 sc1
  v_mfma_f32_16x16x32_bf16 v[48:51], a[220:223], a[172:175], v[48:51]
  ds_read_b64_tr_b16 a[220:221], v234 offset:12288
  s_mov_b32 s41, 1376256
  v_mfma_f32_16x16x32_bf16 v[48:51], a[224:227], a[188:191], v[48:51]
  ds_read_b64_tr_b16 a[222:223], v234 offset:14336
  s_add_u32 m0, s42, 28672
  v_mfma_f32_16x16x32_bf16 v[52:55], a[228:231], a[172:175], v[52:55]
  ds_read_b64_tr_b16 a[224:225], v232 offset:8192
  s_waitcnt lgkmcnt(13)
  v_mfma_f32_16x16x32_bf16 v[52:55], a[232:235], a[188:191], v[52:55]
  ds_read_b64_tr_b16 a[226:227], v232 offset:10240
  v_mfma_f32_16x16x32_bf16 v[36:39], a[228:231], a[168:171], v[36:39]
  v_mfma_f32_16x16x32_bf16 v[36:39], a[232:235], a[184:187], v[36:39]
  buffer_load_dwordx4 v227, s[12:15], s41 offen offset:0 lds
  v_mfma_f32_16x16x32_bf16 v[20:23], a[228:231], a[164:167], v[20:23]
  s_mov_b32 s41, 1605632
  s_add_u32 m0, s42, 139264
  v_mfma_f32_16x16x32_bf16 v[20:23], a[232:235], a[180:183], v[20:23]
  v_mfma_f32_16x16x32_bf16 v[4:7], a[228:231], a[160:163], v[4:7]
  ds_read_b64_tr_b16 a[228:229], v232 offset:20480
  v_mfma_f32_16x16x32_bf16 v[4:7], a[232:235], a[176:179], v[4:7]
  ds_read_b64_tr_b16 a[230:231], v232 offset:22528
  v_mfma_f32_16x16x32_bf16 v[8:11], a[192:195], a[160:163], v[8:11]
  ds_read_b64_tr_b16 a[232:233], v233 offset:8192
  v_mfma_f32_16x16x32_bf16 v[8:11], a[196:199], a[176:179], v[8:11]
  s_barrier
  v_mfma_f32_16x16x32_bf16 v[24:27], a[192:195], a[164:167], v[24:27]
  buffer_load_dwordx4 v227, s[12:15], s41 offen offset:0 lds
  v_mfma_f32_16x16x32_bf16 v[24:27], a[196:199], a[180:183], v[24:27]
  ds_read_b64_tr_b16 a[234:235], v233 offset:10240
  s_mov_b32 s41, 1376256
  v_mfma_f32_16x16x32_bf16 v[40:43], a[192:195], a[168:171], v[40:43]
  s_add_u32 m0, s42, 155648
  v_mfma_f32_16x16x32_bf16 v[40:43], a[196:199], a[184:187], v[40:43]
  v_mfma_f32_16x16x32_bf16 v[56:59], a[192:195], a[172:175], v[56:59]
  ds_read_b64_tr_b16 a[192:193], v233 offset:20480
  v_mfma_f32_16x16x32_bf16 v[56:59], a[196:199], a[188:191], v[56:59]
  buffer_load_dwordx4 v227, s[16:19], s41 offen offset:0 lds
  s_load_dwordx2 s[66:67], s[36:37], 0xc0000
  s_waitcnt lgkmcnt(13)
  v_mfma_f32_16x16x32_bf16 v[60:63], a[200:203], a[172:175], v[60:63]
  ds_read_b64_tr_b16 a[194:195], v233 offset:22528
  s_mov_b32 s41, 1605632
  v_mfma_f32_16x16x32_bf16 v[60:63], a[204:207], a[188:191], v[60:63]
  ds_read_b64_tr_b16 a[196:197], v234 offset:8192
  ds_read_b64_tr_b16 a[198:199], v234 offset:10240
  v_mfma_f32_16x16x32_bf16 v[44:47], a[200:203], a[168:171], v[44:47]
  s_add_u32 m0, s42, 20480
  v_mfma_f32_16x16x32_bf16 v[44:47], a[204:207], a[184:187], v[44:47]
  v_mfma_f32_16x16x32_bf16 v[28:31], a[200:203], a[164:167], v[28:31]
  v_mfma_f32_16x16x32_bf16 v[28:31], a[204:207], a[180:183], v[28:31]
  buffer_load_dwordx4 v227, s[16:19], s41 offen offset:0 lds
  v_mfma_f32_16x16x32_bf16 v[12:15], a[200:203], a[160:163], v[12:15]
  ds_read_b64_tr_b16 a[200:201], v234 offset:20480
  s_mov_b32 s41, 1376256
  v_mfma_f32_16x16x32_bf16 v[12:15], a[204:207], a[176:179], v[12:15]
  ds_read_b64_tr_b16 a[202:203], v234 offset:22528
  s_add_u32 m0, s42, 12288
  v_mfma_f32_16x16x32_bf16 v[64:67], a[208:211], a[160:163], v[64:67]
  ds_read_b64_tr_b16 a[204:205], v235 offset:8192
  s_waitcnt lgkmcnt(13)
  v_mfma_f32_16x16x32_bf16 v[64:67], a[212:215], a[176:179], v[64:67]
  ds_read_b64_tr_b16 a[206:207], v235 offset:10240
  v_mfma_f32_16x16x32_bf16 v[72:75], a[208:211], a[164:167], v[72:75]
  v_mfma_f32_16x16x32_bf16 v[72:75], a[212:215], a[180:183], v[72:75]
  buffer_load_dwordx4 v226, s[12:15], s41 offen offset:0 lds
  v_mfma_f32_16x16x32_bf16 v[80:83], a[208:211], a[168:171], v[80:83]
  s_mov_b32 s41, 1605632
  s_add_u32 m0, s42, 24576
  v_mfma_f32_16x16x32_bf16 v[80:83], a[212:215], a[184:187], v[80:83]
  v_mfma_f32_16x16x32_bf16 v[88:91], a[208:211], a[172:175], v[88:91]
  ds_read_b64_tr_b16 a[208:209], v235 offset:20480
  v_mfma_f32_16x16x32_bf16 v[88:91], a[212:215], a[188:191], v[88:91]
  ds_read_b64_tr_b16 a[210:211], v235 offset:22528
  v_mfma_f32_16x16x32_bf16 v[92:95], a[216:219], a[172:175], v[92:95]
  ds_read_b64_tr_b16 a[212:213], v232 offset:36864
  v_mfma_f32_16x16x32_bf16 v[92:95], a[220:223], a[188:191], v[92:95]
  buffer_load_dwordx4 v226, s[12:15], s41 offen offset:0 lds
  v_mfma_f32_16x16x32_bf16 v[84:87], a[216:219], a[168:171], v[84:87]
  ds_read_b64_tr_b16 a[214:215], v232 offset:38912
  s_mov_b32 s40, 10223616
  v_mfma_f32_16x16x32_bf16 v[84:87], a[220:223], a[184:187], v[84:87]
  v_mfma_f32_16x16x32_bf16 v[76:79], a[216:219], a[164:167], v[76:79]
  v_mfma_f32_16x16x32_bf16 v[76:79], a[220:223], a[180:183], v[76:79]
  s_load_dwordx2 s[66:67], s[36:37], 0xe0000
  s_add_u32 s36, s36, 0x100000
  s_addc_u32 s37, s37, 0
  v_mfma_f32_16x16x32_bf16 v[68:71], a[216:219], a[160:163], v[68:71]
  ds_read_b64_tr_b16 a[216:217], v232 offset:32768
  v_mfma_f32_16x16x32_bf16 v[68:71], a[220:223], a[176:179], v[68:71]
  buffer_load_dwordx4 a[32:35], v225, s[4:7], s40 offen offset:0 sc1
  s_waitcnt lgkmcnt(13)
  v_mfma_f32_16x16x32_bf16 v[96:99], a[224:227], a[160:163], v[96:99]
  ds_read_b64_tr_b16 a[218:219], v232 offset:34816
  s_mov_b32 s78, 3145728
  v_mfma_f32_16x16x32_bf16 v[96:99], a[228:231], a[176:179], v[96:99]
  ds_read_b64_tr_b16 a[220:221], v233 offset:36864
  ds_read_b64_tr_b16 a[222:223], v233 offset:38912
  v_mfma_f32_16x16x32_bf16 v[128:131], a[224:227], a[164:167], v[128:131]
  buffer_load_dword v241, v247, s[56:59], s78 offen
  v_mfma_f32_16x16x32_bf16 v[128:131], a[228:231], a[180:183], v[128:131]
  v_mfma_f32_16x16x32_bf16 v[160:163], a[224:227], a[168:171], v[160:163]
  v_mfma_f32_16x16x32_bf16 v[160:163], a[228:231], a[184:187], v[160:163]
  buffer_load_dwordx4 a[36:39], v225, s[4:7], s40 offen offset:1024 sc1
  v_mfma_f32_16x16x32_bf16 v[192:195], a[224:227], a[172:175], v[192:195]
  ds_read_b64_tr_b16 a[224:225], v233 offset:32768
  v_mfma_f32_16x16x32_bf16 v[192:195], a[228:231], a[188:191], v[192:195]
  ds_read_b64_tr_b16 a[226:227], v233 offset:34816
  v_mfma_f32_16x16x32_bf16 v[196:199], a[232:235], a[172:175], v[196:199]
  ds_read_b64_tr_b16 a[228:229], v234 offset:36864
  s_waitcnt lgkmcnt(13)
  v_mfma_f32_16x16x32_bf16 v[196:199], a[192:195], a[188:191], v[196:199]
  ds_read_b64_tr_b16 a[230:231], v234 offset:38912
  v_mfma_f32_16x16x32_bf16 v[164:167], a[232:235], a[168:171], v[164:167]
  v_mfma_f32_16x16x32_bf16 v[164:167], a[192:195], a[184:187], v[164:167]
  buffer_load_dwordx4 a[40:43], v225, s[4:7], s40 offen offset:2048 sc1
  v_mfma_f32_16x16x32_bf16 v[132:135], a[232:235], a[164:167], v[132:135]
  v_mfma_f32_16x16x32_bf16 v[132:135], a[192:195], a[180:183], v[132:135]
  v_mfma_f32_16x16x32_bf16 v[100:103], a[232:235], a[160:163], v[100:103]
  ds_read_b64_tr_b16 a[232:233], v234 offset:32768
  v_mfma_f32_16x16x32_bf16 v[100:103], a[192:195], a[176:179], v[100:103]
  ds_read_b64_tr_b16 a[234:235], v234 offset:34816
  v_mfma_f32_16x16x32_bf16 v[104:107], a[196:199], a[160:163], v[104:107]
  ds_read_b64_tr_b16 a[192:193], v235 offset:36864
  v_mfma_f32_16x16x32_bf16 v[104:107], a[200:203], a[176:179], v[104:107]
  buffer_load_dwordx4 a[44:47], v225, s[4:7], s40 offen offset:3072 sc1
  v_mfma_f32_16x16x32_bf16 v[136:139], a[196:199], a[164:167], v[136:139]
  ds_read_b64_tr_b16 a[194:195], v235 offset:38912
  s_mov_b32 s40, 10354688
  v_mfma_f32_16x16x32_bf16 v[136:139], a[200:203], a[180:183], v[136:139]
  s_load_dwordx2 s[66:67], s[36:37], 0x0
  v_mfma_f32_16x16x32_bf16 v[168:171], a[196:199], a[168:171], v[168:171]
  v_mfma_f32_16x16x32_bf16 v[168:171], a[200:203], a[184:187], v[168:171]
  v_mfma_f32_16x16x32_bf16 v[200:203], a[196:199], a[172:175], v[200:203]
  ds_read_b64_tr_b16 a[196:197], v235 offset:32768
  v_mfma_f32_16x16x32_bf16 v[200:203], a[200:203], a[188:191], v[200:203]
  buffer_load_dwordx4 a[48:51], v225, s[4:7], s40 offen offset:0 sc1
  s_waitcnt lgkmcnt(13)
  v_mfma_f32_16x16x32_bf16 v[204:207], a[204:207], a[172:175], v[204:207]
  ds_read_b64_tr_b16 a[198:199], v235 offset:34816
  v_mfma_f32_16x16x32_bf16 v[204:207], a[208:211], a[188:191], v[204:207]
  s_barrier
  v_mfma_f32_16x16x32_bf16 v[172:175], a[204:207], a[168:171], v[172:175]
  ds_read_b64_tr_b16 a[200:201], v232 offset:45056
  ds_read_b64_tr_b16 a[202:203], v232 offset:47104
  v_mfma_f32_16x16x32_bf16 v[172:175], a[208:211], a[184:187], v[172:175]
  v_mfma_f32_16x16x32_bf16 v[140:143], a[204:207], a[164:167], v[140:143]
  v_mfma_f32_16x16x32_bf16 v[140:143], a[208:211], a[180:183], v[140:143]
  buffer_load_dwordx4 a[52:55], v225, s[4:7], s40 offen offset:1024 sc1
  v_mfma_f32_16x16x32_bf16 v[108:111], a[204:207], a[160:163], v[108:111]
  ds_read_b64_tr_b16 a[204:205], v232 offset:61440
  v_mfma_f32_16x16x32_bf16 v[108:111], a[208:211], a[176:179], v[108:111]
  ds_read_b64_tr_b16 a[206:207], v232 offset:63488
  v_mfma_f32_16x16x32_bf16 v[112:115], a[212:215], a[160:163], v[112:115]
  ds_read_b64_tr_b16 a[208:209], v233 offset:45056
  s_waitcnt lgkmcnt(13)
  v_mfma_f32_16x16x32_bf16 v[112:115], a[216:219], a[176:179], v[112:115]
  ds_read_b64_tr_b16 a[210:211], v233 offset:47104
  v_mfma_f32_16x16x32_bf16 v[144:147], a[212:215], a[164:167], v[144:147]
  v_mfma_f32_16x16x32_bf16 v[144:147], a[216:219], a[180:183], v[144:147]
  buffer_load_dwordx4 a[56:59], v225, s[4:7], s40 offen offset:2048 sc1
  v_mfma_f32_16x16x32_bf16 v[176:179], a[212:215], a[168:171], v[176:179]
  v_mfma_f32_16x16x32_bf16 v[176:179], a[216:219], a[184:187], v[176:179]
  v_mfma_f32_16x16x32_bf16 v[208:211], a[212:215], a[172:175], v[208:211]
  ds_read_b64_tr_b16 a[212:213], v233 offset:61440
  v_mfma_f32_16x16x32_bf16 v[208:211], a[216:219], a[188:191], v[208:211]
  ds_read_b64_tr_b16 a[214:215], v233 offset:63488
  v_mfma_f32_16x16x32_bf16 v[212:215], a[220:223], a[172:175], v[212:215]
  ds_read_b64_tr_b16 a[216:217], v232 offset:57344
  v_mfma_f32_16x16x32_bf16 v[212:215], a[224:227], a[188:191], v[212:215]
  buffer_load_dwordx4 a[60:63], v225, s[4:7], s40 offen offset:3072 sc1
  s_load_dwordx2 s[66:67], s[36:37], 0x20000
  v_mfma_f32_16x16x32_bf16 v[180:183], a[220:223], a[168:171], v[180:183]
  ds_read_b64_tr_b16 a[218:219], v232 offset:59392
  s_mov_b32 s41, 1376256
  v_mfma_f32_16x16x32_bf16 v[180:183], a[224:227], a[184:187], v[180:183]
  s_add_u32 m0, s42, 45056
  v_mfma_f32_16x16x32_bf16 v[148:151], a[220:223], a[164:167], v[148:151]
  v_mfma_f32_16x16x32_bf16 v[148:151], a[224:227], a[180:183], v[148:151]
  v_mfma_f32_16x16x32_bf16 v[116:119], a[220:223], a[160:163], v[116:119]
  ds_read_b64_tr_b16 a[220:221], v236 offset:4096
  v_mfma_f32_16x16x32_bf16 v[116:119], a[224:227], a[176:179], v[116:119]
  buffer_load_dwordx4 v226, s[16:19], s41 offen offset:0 lds
  s_waitcnt lgkmcnt(13)
L_wk1_1:
  s_cbranch_vccnz L_wk1_5
  v_mfma_f32_16x16x32_bf16 v[120:123], a[228:231], a[160:163], v[120:123]
  ds_read_b64_tr_b16 a[222:223], v236 offset:6144
  s_mov_b32 s41, 1605632
  v_mfma_f32_16x16x32_bf16 v[120:123], a[232:235], a[176:179], v[120:123]
  ds_read_b64_tr_b16 a[224:225], v233 offset:57344
  ds_read_b64_tr_b16 a[226:227], v233 offset:59392
  v_mfma_f32_16x16x32_bf16 v[152:155], a[228:231], a[164:167], v[152:155]
  s_add_u32 m0, s42, 36864
  v_mfma_f32_16x16x32_bf16 v[152:155], a[232:235], a[180:183], v[152:155]
  v_mfma_f32_16x16x32_bf16 v[184:187], a[228:231], a[168:171], v[184:187]
  v_mfma_f32_16x16x32_bf16 v[184:187], a[232:235], a[184:187], v[184:187]
  buffer_load_dwordx4 v226, s[16:19], s41 offen offset:0 lds
  v_mfma_f32_16x16x32_bf16 v[216:219], a[228:231], a[172:175], v[216:219]
  ds_read_b64_tr_b16 a[228:229], v237 offset:4096
  s_mov_b32 s41, 1835008
  v_mfma_f32_16x16x32_bf16 v[216:219], a[232:235], a[188:191], v[216:219]
  ds_read_b64_tr_b16 a[230:231], v237 offset:6144
  s_add_u32 m0, s42, 49152
  v_mfma_f32_16x16x32_bf16 v[220:223], a[192:195], a[172:175], v[220:223]
  ds_read_b64_tr_b16 a[232:233], v234 offset:45056
  s_waitcnt lgkmcnt(13)
  v_mfma_f32_16x16x32_bf16 v[220:223], a[196:199], a[188:191], v[220:223]
  ds_read_b64_tr_b16 a[234:235], v234 offset:47104
  v_mfma_f32_16x16x32_bf16 v[188:191], a[192:195], a[168:171], v[188:191]
  v_mfma_f32_16x16x32_bf16 v[188:191], a[196:199], a[184:187], v[188:191]
  buffer_load_dwordx4 v227, s[12:15], s41 offen offset:0 lds
  v_mfma_f32_16x16x32_bf16 v[156:159], a[192:195], a[164:167], v[156:159]
  s_mov_b32 s41, 2064384
  s_add_u32 m0, s42, 32768
  v_mfma_f32_16x16x32_bf16 v[156:159], a[196:199], a[180:183], v[156:159]
  v_mfma_f32_16x16x32_bf16 v[124:127], a[192:195], a[160:163], v[124:127]
  ds_read_b64_tr_b16 a[192:193], v234 offset:61440
  v_mfma_f32_16x16x32_bf16 v[124:127], a[196:199], a[176:179], v[124:127]
  ds_read_b64_tr_b16 a[194:195], v234 offset:63488
  s_load_dwordx2 s[66:67], s[36:37], 0x40000
  s_waitcnt vmcnt(22)
  v_mfma_f32_16x16x32_bf16 v[0:3], a[200:203], a[0:3], v[0:3]
  ds_read_b64_tr_b16 a[196:197], v234 offset:57344
  s_waitcnt vmcnt(18)
  v_mfma_f32_16x16x32_bf16 v[0:3], a[204:207], a[16:19], v[0:3]
  buffer_load_dwordx4 v227, s[12:15], s41 offen offset:0 lds
  v_mfma_f32_16x16x32_bf16 v[16:19], a[200:203], a[4:7], v[16:19]
  ds_read_b64_tr_b16 a[198:199], v234 offset:59392
  s_mov_b32 s41, 1835008
  v_mfma_f32_16x16x32_bf16 v[16:19], a[204:207], a[20:23], v[16:19]
  s_add_u32 m0, s42, 40960
  v_mfma_f32_16x16x32_bf16 v[32:35], a[200:203], a[8:11], v[32:35]
  v_mfma_f32_16x16x32_bf16 v[32:35], a[204:207], a[24:27], v[32:35]
  v_mfma_f32_16x16x32_bf16 v[48:51], a[200:203], a[12:15], v[48:51]
  ds_read_b64_tr_b16 a[200:201], v238 offset:4096
  v_mfma_f32_16x16x32_bf16 v[48:51], a[204:207], a[28:31], v[48:51]
  buffer_load_dwordx4 v227, s[16:19], s41 offen offset:0 lds
  s_waitcnt lgkmcnt(13)
  v_mfma_f32_16x16x32_bf16 v[52:55], a[208:211], a[12:15], v[52:55]
  ds_read_b64_tr_b16 a[202:203], v238 offset:6144
  s_mov_b32 s41, 2064384
  v_mfma_f32_16x16x32_bf16 v[52:55], a[212:215], a[28:31], v[52:55]
  ds_read_b64_tr_b16 a[204:205], v236 offset:20480
  ds_read_b64_tr_b16 a[206:207], v236 offset:22528
  v_mfma_f32_16x16x32_bf16 v[36:39], a[208:211], a[8:11], v[36:39]
  s_add_u32 m0, s42, 53248
  v_mfma_f32_16x16x32_bf16 v[36:39], a[212:215], a[24:27], v[36:39]
  v_mfma_f32_16x16x32_bf16 v[20:23], a[208:211], a[4:7], v[20:23]
  v_mfma_f32_16x16x32_bf16 v[20:23], a[212:215], a[20:23], v[20:23]
  buffer_load_dwordx4 v227, s[16:19], s41 offen offset:0 lds
  v_mfma_f32_16x16x32_bf16 v[4:7], a[208:211], a[0:3], v[4:7]
  ds_read_b64_tr_b16 a[208:209], v236 offset:16384
  s_mov_b32 s41, 1835008
  v_mfma_f32_16x16x32_bf16 v[4:7], a[212:215], a[16:19], v[4:7]
  ds_read_b64_tr_b16 a[210:211], v236 offset:18432
  s_add_u32 m0, s42, 57344
  v_mfma_f32_16x16x32_bf16 v[8:11], a[216:219], a[0:3], v[8:11]
  ds_read_b64_tr_b16 a[212:213], v237 offset:20480
  s_waitcnt lgkmcnt(13)
  v_mfma_f32_16x16x32_bf16 v[8:11], a[220:223], a[16:19], v[8:11]
  s_waitcnt vmcnt(20)
  s_barrier
  v_mfma_f32_16x16x32_bf16 v[24:27], a[216:219], a[4:7], v[24:27]
  ds_read_b64_tr_b16 a[214:215], v237 offset:22528
  v_mfma_f32_16x16x32_bf16 v[24:27], a[220:223], a[20:23], v[24:27]
  buffer_load_dwordx4 v226, s[12:15], s41 offen offset:0 lds
  v_mfma_f32_16x16x32_bf16 v[40:43], a[216:219], a[8:11], v[40:43]
  s_mov_b32 s41, 2064384
  s_add_u32 m0, s42, 65536
  v_mfma_f32_16x16x32_bf16 v[40:43], a[220:223], a[24:27], v[40:43]
  s_load_dwordx2 s[66:67], s[36:37], 0x60000
  v_mfma_f32_16x16x32_bf16 v[56:59], a[216:219], a[12:15], v[56:59]
  ds_read_b64_tr_b16 a[216:217], v237 offset:16384
  v_mfma_f32_16x16x32_bf16 v[56:59], a[220:223], a[28:31], v[56:59]
  ds_read_b64_tr_b16 a[218:219], v237 offset:18432
  v_mfma_f32_16x16x32_bf16 v[60:63], a[224:227], a[12:15], v[60:63]
  ds_read_b64_tr_b16 a[220:221], v238 offset:20480
  v_mfma_f32_16x16x32_bf16 v[60:63], a[228:231], a[28:31], v[60:63]
  buffer_load_dwordx4 v226, s[12:15], s41 offen offset:0 lds
  v_mfma_f32_16x16x32_bf16 v[44:47], a[224:227], a[8:11], v[44:47]
  ds_read_b64_tr_b16 a[222:223], v238 offset:22528
  s_mov_b32 s40, 10485760
  v_mfma_f32_16x16x32_bf16 v[44:47], a[228:231], a[24:27], v[44:47]
  v_mfma_f32_16x16x32_bf16 v[28:31], a[224:227], a[4:7], v[28:31]
  v_mfma_f32_16x16x32_bf16 v[28:31], a[228:231], a[20:23], v[28:31]
  v_mfma_f32_16x16x32_bf16 v[12:15], a[224:227], a[0:3], v[12:15]
  ds_read_b64_tr_b16 a[224:225], v238 offset:16384
  v_mfma_f32_16x16x32_bf16 v[12:15], a[228:231], a[16:19], v[12:15]
  buffer_load_dwordx4 a[64:67], v225, s[4:7], s40 offen offset:0 sc1
  s_waitcnt lgkmcnt(13)
  v_mfma_f32_16x16x32_bf16 v[64:67], a[232:235], a[0:3], v[64:67]
  ds_read_b64_tr_b16 a[226:227], v238 offset:18432
  v_mfma_f32_16x16x32_bf16 v[64:67], a[192:195], a[16:19], v[64:67]
  ds_read_b64_tr_b16 a[228:229], v239 offset:20480
  ds_read_b64_tr_b16 a[230:231], v239 offset:22528
  v_mfma_f32_16x16x32_bf16 v[72:75], a[232:235], a[4:7], v[72:75]
  v_mfma_f32_16x16x32_bf16 v[72:75], a[192:195], a[20:23], v[72:75]
  s_mov_b32 s78, 3670016
  v_mfma_f32_16x16x32_bf16 v[80:83], a[232:235], a[8:11], v[80:83]
  buffer_load_dword v241, v247, s[56:59], s78 offen
  v_mfma_f32_16x16x32_bf16 v[80:83], a[192:195], a[24:27], v[80:83]
  v_mfma_f32_16x16x32_bf16 v[88:91], a[232:235], a[12:15], v[88:91]
  buffer_load_dwordx4 a[68:71], v225, s[4:7], s40 offen offset:1024 sc1
  v_mfma_f32_16x16x32_bf16 v[88:91], a[192:195], a[28:31], v[88:91]
  ds_read_b64_tr_b16 a[232:233], v239 offset:16384
  v_mfma_f32_16x16x32_bf16 v[92:95], a[196:199], a[12:15], v[92:95]
  ds_read_b64_tr_b16 a[234:235], v239 offset:18432
  s_waitcnt lgkmcnt(13)
  v_mfma_f32_16x16x32_bf16 v[92:95], a[200:203], a[28:31], v[92:95]
  ds_read_b64_tr_b16 a[192:193], v236 offset:28672
  ds_read_b64_tr_b16 a[194:195], v236 offset:30720
  v_mfma_f32_16x16x32_bf16 v[84:87], a[196:199], a[8:11], v[84:87]
  v_mfma_f32_16x16x32_bf16 v[84:87], a[200:203], a[24:27], v[84:87]
  buffer_load_dwordx4 a[72:75], v225, s[4:7], s40 offen offset:2048 sc1
  s_load_dwordx2 s[66:67], s[36:37], 0x80000
  v_mfma_f32_16x16x32_bf16 v[76:79], a[196:199], a[4:7], v[76:79]
  v_mfma_f32_16x16x32_bf16 v[76:79], a[200:203], a[20:23], v[76:79]
  v_mfma_f32_16x16x32_bf16 v[68:71], a[196:199], a[0:3], v[68:71]
  ds_read_b64_tr_b16 a[196:197], v228 offset:16384
  v_mfma_f32_16x16x32_bf16 v[68:71], a[200:203], a[16:19], v[68:71]
  ds_read_b64_tr_b16 a[198:199], v228 offset:18432
  v_mfma_f32_16x16x32_bf16 v[96:99], a[204:207], a[0:3], v[96:99]
  ds_read_b64_tr_b16 a[200:201], v237 offset:28672
  s_waitcnt lgkmcnt(13)
  v_mfma_f32_16x16x32_bf16 v[96:99], a[208:211], a[16:19], v[96:99]
  buffer_load_dwordx4 a[76:79], v225, s[4:7], s40 offen offset:3072 sc1
  v_mfma_f32_16x16x32_bf16 v[128:131], a[204:207], a[4:7], v[128:131]
  ds_read_b64_tr_b16 a[202:203], v237 offset:30720
  s_mov_b32 s40, 10616832
  v_mfma_f32_16x16x32_bf16 v[128:131], a[208:211], a[20:23], v[128:131]
  v_mfma_f32_16x16x32_bf16 v[160:163], a[204:207], a[8:11], v[160:163]
  v_mfma_f32_16x16x32_bf16 v[160:163], a[208:211], a[24:27], v[160:163]
  v_mfma_f32_16x16x32_bf16 v[192:195], a[204:207], a[12:15], v[192:195]
  ds_read_b64_tr_b16 a[204:205], v229 offset:16384
  v_mfma_f32_16x16x32_bf16 v[192:195], a[208:211], a[28:31], v[192:195]
  buffer_load_dwordx4 a[80:83], v225, s[4:7], s40 offen offset:0 sc1
  v_mfma_f32_16x16x32_bf16 v[196:199], a[212:215], a[12:15], v[196:199]
  ds_read_b64_tr_b16 a[206:207], v229 offset:18432
  v_mfma_f32_16x16x32_bf16 v[196:199], a[216:219], a[28:31], v[196:199]
  ds_read_b64_tr_b16 a[208:209], v238 offset:28672
  ds_read_b64_tr_b16 a[210:211], v238 offset:30720
  v_mfma_f32_16x16x32_bf16 v[164:167], a[212:215], a[8:11], v[164:167]
  v_mfma_f32_16x16x32_bf16 v[164:167], a[216:219], a[24:27], v[164:167]
  v_mfma_f32_16x16x32_bf16 v[132:135], a[212:215], a[4:7], v[132:135]
  v_mfma_f32_16x16x32_bf16 v[132:135], a[216:219], a[20:23], v[132:135]
  buffer_load_dwordx4 a[84:87], v225, s[4:7], s40 offen offset:1024 sc1
  v_mfma_f32_16x16x32_bf16 v[100:103], a[212:215], a[0:3], v[100:103]
  ds_read_b64_tr_b16 a[212:213], v230 offset:16384
  v_mfma_f32_16x16x32_bf16 v[100:103], a[216:219], a[16:19], v[100:103]
  ds_read_b64_tr_b16 a[214:215], v230 offset:18432
  s_waitcnt lgkmcnt(13)
  v_mfma_f32_16x16x32_bf16 v[104:107], a[220:223], a[0:3], v[104:107]
  ds_read_b64_tr_b16 a[216:217], v239 offset:28672
  v_mfma_f32_16x16x32_bf16 v[104:107], a[224:227], a[16:19], v[104:107]
  ds_read_b64_tr_b16 a[218:219], v239 offset:30720
  s_load_dwordx2 s[66:67], s[36:37], 0xa0000
  v_mfma_f32_16x16x32_bf16 v[136:139], a[220:223], a[4:7], v[136:139]
  v_mfma_f32_16x16x32_bf16 v[136:139], a[224:227], a[20:23], v[136:139]
  buffer_load_dwordx4 a[88:91], v225, s[4:7], s40 offen offset:2048 sc1
  v_mfma_f32_16x16x32_bf16 v[168:171], a[220:223], a[8:11], v[168:171]
  v_mfma_f32_16x16x32_bf16 v[168:171], a[224:227], a[24:27], v[168:171]
  v_mfma_f32_16x16x32_bf16 v[200:203], a[220:223], a[12:15], v[200:203]
  ds_read_b64_tr_b16 a[220:221], v231 offset:16384
  v_mfma_f32_16x16x32_bf16 v[200:203], a[224:227], a[28:31], v[200:203]
  ds_read_b64_tr_b16 a[222:223], v231 offset:18432
  v_mfma_f32_16x16x32_bf16 v[204:207], a[228:231], a[12:15], v[204:207]
  ds_read_b64_tr_b16 a[224:225], v228 offset:28672
  s_waitcnt lgkmcnt(13)
  v_mfma_f32_16x16x32_bf16 v[204:207], a[232:235], a[28:31], v[204:207]
  s_waitcnt vmcnt(25)
  s_barrier
  v_mfma_f32_16x16x32_bf16 v[172:175], a[228:231], a[8:11], v[172:175]
  buffer_load_dwordx4 a[92:95], v225, s[4:7], s40 offen offset:3072 sc1
  v_mfma_f32_16x16x32_bf16 v[172:175], a[232:235], a[24:27], v[172:175]
  ds_read_b64_tr_b16 a[226:227], v228 offset:30720
  s_mov_b32 s41, 1835008
  v_lshrrev_b32 v254, 4, v224
  v_lshl_add_u32 v254, v254, 12, v243
  v_mfma_f32_16x16x32_bf16 v[140:143], a[228:231], a[4:7], v[140:143]
  s_add_u32 m0, s42, 94208
  s_lshl_b32 s32, s3, 14
  s_add_u32 s32, s32, 0x90000
  v_mfma_f32_16x16x32_bf16 v[140:143], a[232:235], a[20:23], v[140:143]
  s_cmp_eq_u32 s2, 0
  s_cselect_b32 s32, s32, s79
  s_cselect_b32 s31, -1, 0
  v_and_b32 v254, s31, v254
  v_mfma_f32_16x16x32_bf16 v[108:111], a[228:231], a[0:3], v[108:111]
  ds_read_b64_tr_b16 a[228:229], v236 offset:8192
  v_mfma_f32_16x16x32_bf16 v[108:111], a[232:235], a[16:19], v[108:111]
  buffer_load_dwordx4 v226, s[16:19], s41 offen offset:0 lds
  v_mfma_f32_16x16x32_bf16 v[112:115], a[192:195], a[0:3], v[112:115]
  ds_read_b64_tr_b16 a[230:231], v236 offset:10240
  s_mov_b32 s41, 2064384
  v_mfma_f32_16x16x32_bf16 v[112:115], a[196:199], a[16:19], v[112:115]
  ds_read_b64_tr_b16 a[232:233], v229 offset:28672
  ds_read_b64_tr_b16 a[234:235], v229 offset:30720
  v_mfma_f32_16x16x32_bf16 v[144:147], a[192:195], a[4:7], v[144:147]
  s_add_u32 m0, s42, 106496
  v_mfma_f32_16x16x32_bf16 v[144:147], a[196:199], a[20:23], v[144:147]
  v_mfma_f32_16x16x32_bf16 v[176:179], a[192:195], a[8:11], v[176:179]
  v_mfma_f32_16x16x32_bf16 v[176:179], a[196:199], a[24:27], v[176:179]
  buffer_load_dwordx4 v226, s[16:19], s41 offen offset:0 lds
  buffer_load_dword v244, v254, s[4:7], s32 offen sc1
  v_mfma_f32_16x16x32_bf16 v[208:211], a[192:195], a[12:15], v[208:211]
  ds_read_b64_tr_b16 a[192:193], v237 offset:8192
  s_mov_b32 s41, 2293760
  v_mfma_f32_16x16x32_bf16 v[208:211], a[196:199], a[28:31], v[208:211]
  ds_read_b64_tr_b16 a[194:195], v237 offset:10240
  s_add_u32 m0, s42, 114688
  s_load_dwordx2 s[66:67], s[36:37], 0xc0000
  s_waitcnt lgkmcnt(13)
  v_mfma_f32_16x16x32_bf16 v[212:215], a[200:203], a[12:15], v[212:215]
  ds_read_b64_tr_b16 a[196:197], v236 offset:24576
  v_mfma_f32_16x16x32_bf16 v[212:215], a[204:207], a[28:31], v[212:215]
  ds_read_b64_tr_b16 a[198:199], v236 offset:26624
  v_mfma_f32_16x16x32_bf16 v[180:183], a[200:203], a[8:11], v[180:183]
  v_mfma_f32_16x16x32_bf16 v[180:183], a[204:207], a[24:27], v[180:183]
  buffer_load_dwordx4 v227, s[12:15], s41 offen offset:0 lds
  v_mfma_f32_16x16x32_bf16 v[148:151], a[200:203], a[4:7], v[148:151]
  s_mov_b32 s41, 2523136
  s_add_u32 m0, s42, 143360
  v_mfma_f32_16x16x32_bf16 v[148:151], a[204:207], a[20:23], v[148:151]
  v_mfma_f32_16x16x32_bf16 v[116:119], a[200:203], a[0:3], v[116:119]
  ds_read_b64_tr_b16 a[200:201], v228 offset:20480
  v_mfma_f32_16x16x32_bf16 v[116:119], a[204:207], a[16:19], v[116:119]
  ds_read_b64_tr_b16 a[202:203], v228 offset:22528
  v_mfma_f32_16x16x32_bf16 v[120:123], a[208:211], a[0:3], v[120:123]
  ds_read_b64_tr_b16 a[204:205], v237 offset:24576
  s_waitcnt lgkmcnt(13)
  v_mfma_f32_16x16x32_bf16 v[120:123], a[212:215], a[16:19], v[120:123]
  buffer_load_dwordx4 v227, s[12:15], s41 offen offset:0 lds
  v_mfma_f32_16x16x32_bf16 v[152:155], a[208:211], a[4:7], v[152:155]
  ds_read_b64_tr_b16 a[206:207], v237 offset:26624
  s_mov_b32 s41, 2293760
  v_mfma_f32_16x16x32_bf16 v[152:155], a[212:215], a[20:23], v[152:155]
  s_add_u32 m0, s42, 69632
  v_mfma_f32_16x16x32_bf16 v[184:187], a[208:211], a[8:11], v[184:187]
  v_mfma_f32_16x16x32_bf16 v[184:187], a[212:215], a[24:27], v[184:187]
  v_mfma_f32_16x16x32_bf16 v[216:219], a[208:211], a[12:15], v[216:219]
  ds_read_b64_tr_b16 a[208:209], v229 offset:20480
  v_mfma_f32_16x16x32_bf16 v[216:219], a[212:215], a[28:31], v[216:219]
  buffer_load_dwordx4 v227, s[16:19], s41 offen offset:0 lds
  v_mfma_f32_16x16x32_bf16 v[220:223], a[216:219], a[12:15], v[220:223]
  ds_read_b64_tr_b16 a[210:211], v229 offset:22528
  s_mov_b32 s41, 2523136
  v_mfma_f32_16x16x32_bf16 v[220:223], a[220:223], a[28:31], v[220:223]
  ds_read_b64_tr_b16 a[212:213], v230 offset:28672
  ds_read_b64_tr_b16 a[214:215], v230 offset:30720
  v_mfma_f32_16x16x32_bf16 v[188:191], a[216:219], a[8:11], v[188:191]
  s_add_u32 m0, s42, 81920
  v_mfma_f32_16x16x32_bf16 v[188:191], a[220:223], a[24:27], v[188:191]
  v_mfma_f32_16x16x32_bf16 v[156:159], a[216:219], a[4:7], v[156:159]
  v_mfma_f32_16x16x32_bf16 v[156:159], a[220:223], a[20:23], v[156:159]
  buffer_load_dwordx4 v227, s[16:19], s41 offen offset:0 lds
  s_load_dwordx2 s[66:67], s[36:37], 0xe0000
  s_add_u32 s36, s36, 0x100000
  s_addc_u32 s37, s37, 0
  v_mfma_f32_16x16x32_bf16 v[124:127], a[216:219], a[0:3], v[124:127]
  ds_read_b64_tr_b16 a[216:217], v238 offset:8192
  v_mfma_f32_16x16x32_bf16 v[124:127], a[220:223], a[16:19], v[124:127]
  ds_read_b64_tr_b16 a[218:219], v238 offset:10240
  s_mov_b32 s40, 10747904
  s_waitcnt vmcnt(28) lgkmcnt(13)
  v_mfma_f32_16x16x32_bf16 v[0:3], a[224:227], a[32:35], v[0:3]
  ds_read_b64_tr_b16 a[220:221], v238 offset:24576
  s_waitcnt vmcnt(24)
  v_mfma_f32_16x16x32_bf16 v[0:3], a[228:231], a[48:51], v[0:3]
  ds_read_b64_tr_b16 a[222:223], v238 offset:26624
  v_mfma_f32_16x16x32_bf16 v[16:19], a[224:227], a[36:39], v[16:19]
  v_mfma_f32_16x16x32_bf16 v[16:19], a[228:231], a[52:55], v[16:19]
  buffer_load_dwordx4 a[96:99], v225, s[4:7], s40 offen offset:0 sc1
  v_mfma_f32_16x16x32_bf16 v[32:35], a[224:227], a[40:43], v[32:35]
  v_mfma_f32_16x16x32_bf16 v[32:35], a[228:231], a[56:59], v[32:35]
  v_mfma_f32_16x16x32_bf16 v[48:51], a[224:227], a[44:47], v[48:51]
  ds_read_b64_tr_b16 a[224:225], v230 offset:20480
  v_mfma_f32_16x16x32_bf16 v[48:51], a[228:231], a[60:63], v[48:51]
  ds_read_b64_tr_b16 a[226:227], v230 offset:22528
  v_mfma_f32_16x16x32_bf16 v[52:55], a[232:235], a[44:47], v[52:55]
  ds_read_b64_tr_b16 a[228:229], v228 offset:12288
  s_waitcnt lgkmcnt(13)
  v_mfma_f32_16x16x32_bf16 v[52:55], a[192:195], a[60:63], v[52:55]
  buffer_load_dwordx4 a[100:103], v225, s[4:7], s40 offen offset:1024 sc1
  v_mfma_f32_16x16x32_bf16 v[36:39], a[232:235], a[40:43], v[36:39]
  ds_read_b64_tr_b16 a[230:231], v228 offset:14336
  v_mfma_f32_16x16x32_bf16 v[36:39], a[192:195], a[56:59], v[36:39]
  v_mfma_f32_16x16x32_bf16 v[20:23], a[232:235], a[36:39], v[20:23]
  v_mfma_f32_16x16x32_bf16 v[20:23], a[192:195], a[52:55], v[20:23]
  v_mfma_f32_16x16x32_bf16 v[4:7], a[232:235], a[32:35], v[4:7]
  ds_read_b64_tr_b16 a[232:233], v228 offset:24576
  v_mfma_f32_16x16x32_bf16 v[4:7], a[192:195], a[48:51], v[4:7]
  buffer_load_dwordx4 a[104:107], v225, s[4:7], s40 offen offset:2048 sc1
  v_mfma_f32_16x16x32_bf16 v[8:11], a[196:199], a[32:35], v[8:11]
  ds_read_b64_tr_b16 a[234:235], v228 offset:26624
  v_mfma_f32_16x16x32_bf16 v[8:11], a[200:203], a[48:51], v[8:11]
  s_waitcnt vmcnt(24)
  s_barrier
  v_mfma_f32_16x16x32_bf16 v[24:27], a[196:199], a[36:39], v[24:27]
  ds_read_b64_tr_b16 a[192:193], v229 offset:12288
  ds_read_b64_tr_b16 a[194:195], v229 offset:14336
  v_mfma_f32_16x16x32_bf16 v[24:27], a[200:203], a[52:55], v[24:27]
  s_load_dwordx2 s[66:67], s[36:37], 0x0
  v_mfma_f32_16x16x32_bf16 v[40:43], a[196:199], a[40:43], v[40:43]
  v_mfma_f32_16x16x32_bf16 v[40:43], a[200:203], a[56:59], v[40:43]
  buffer_load_dwordx4 a[108:111], v225, s[4:7], s40 offen offset:3072 sc1
  v_mfma_f32_16x16x32_bf16 v[56:59], a[196:199], a[44:47], v[56:59]
  ds_read_b64_tr_b16 a[196:197], v229 offset:24576
  s_mov_b32 s41, 2293760
  v_mfma_f32_16x16x32_bf16 v[56:59], a[200:203], a[60:63], v[56:59]
  ds_read_b64_tr_b16 a[198:199], v229 offset:26624
  s_add_u32 m0, s42, 61440
  s_waitcnt lgkmcnt(13)
  v_mfma_f32_16x16x32_bf16 v[60:63], a[204:207], a[44:47], v[60:63]
  ds_read_b64_tr_b16 a[200:201], v230 offset:12288
  s_mov_b32 s78, 4194304
  v_mfma_f32_16x16x32_bf16 v[60:63], a[208:211], a[60:63], v[60:63]
  ds_read_b64_tr_b16 a[202:203], v230 offset:14336
  v_mfma_f32_16x16x32_bf16 v[44:47], a[204:207], a[40:43], v[44:47]
  buffer_load_dword v241, v247, s[56:59], s78 offen
  v_mfma_f32_16x16x32_bf16 v[44:47], a[208:211], a[56:59], v[44:47]
  v_mfma_f32_16x16x32_bf16 v[28:31], a[204:207], a[36:39], v[28:31]
  buffer_load_dwordx4 v226, s[12:15], s41 offen offset:0 lds
  v_mfma_f32_16x16x32_bf16 v[28:31], a[208:211], a[52:55], v[28:31]
  s_mov_b32 s41, 2523136
  s_add_u32 m0, s42, 90112
  v_mfma_f32_16x16x32_bf16 v[12:15], a[204:207], a[32:35], v[12:15]
  ds_read_b64_tr_b16 a[204:205], v230 offset:24576
  v_mfma_f32_16x16x32_bf16 v[12:15], a[208:211], a[48:51], v[12:15]
  ds_read_b64_tr_b16 a[206:207], v230 offset:26624
  v_mfma_f32_16x16x32_bf16 v[64:67], a[212:215], a[32:35], v[64:67]
  ds_read_b64_tr_b16 a[208:209], v231 offset:12288
  s_waitcnt lgkmcnt(13)
  v_mfma_f32_16x16x32_bf16 v[64:67], a[216:219], a[48:51], v[64:67]
  buffer_load_dwordx4 v226, s[12:15], s41 offen offset:0 lds
  v_mfma_f32_16x16x32_bf16 v[72:75], a[212:215], a[36:39], v[72:75]
  ds_read_b64_tr_b16 a[210:211], v231 offset:14336
  s_mov_b32 s40, 10878976
  v_mfma_f32_16x16x32_bf16 v[72:75], a[216:219], a[52:55], v[72:75]
  v_mfma_f32_16x16x32_bf16 v[80:83], a[212:215], a[40:43], v[80:83]
  v_mfma_f32_16x16x32_bf16 v[80:83], a[216:219], a[56:59], v[80:83]
  v_mfma_f32_16x16x32_bf16 v[88:91], a[212:215], a[44:47], v[88:91]
  ds_read_b64_tr_b16 a[212:213], v231 offset:24576
  v_mfma_f32_16x16x32_bf16 v[88:91], a[216:219], a[60:63], v[88:91]
  buffer_load_dwordx4 a[112:115], v225, s[4:7], s40 offen offset:0 sc1
  v_mfma_f32_16x16x32_bf16 v[92:95], a[220:223], a[44:47], v[92:95]
  ds_read_b64_tr_b16 a[214:215], v231 offset:26624
  v_mfma_f32_16x16x32_bf16 v[92:95], a[224:227], a[60:63], v[92:95]
  ds_read_b64_tr_b16 a[216:217], v228 offset:45056
  ds_read_b64_tr_b16 a[218:219], v228 offset:47104
  s_load_dwordx2 s[66:67], s[36:37], 0x20000
  v_mfma_f32_16x16x32_bf16 v[84:87], a[220:223], a[40:43], v[84:87]
  v_mfma_f32_16x16x32_bf16 v[84:87], a[224:227], a[56:59], v[84:87]
  v_mfma_f32_16x16x32_bf16 v[76:79], a[220:223], a[36:39], v[76:79]
  v_mfma_f32_16x16x32_bf16 v[76:79], a[224:227], a[52:55], v[76:79]
  buffer_load_dwordx4 a[116:119], v225, s[4:7], s40 offen offset:1024 sc1
  v_mfma_f32_16x16x32_bf16 v[68:71], a[220:223], a[32:35], v[68:71]
  ds_read_b64_tr_b16 a[220:221], v228 offset:36864
  v_mfma_f32_16x16x32_bf16 v[68:71], a[224:227], a[48:51], v[68:71]
  ds_read_b64_tr_b16 a[222:223], v228 offset:38912
  s_waitcnt lgkmcnt(13)
  v_mfma_f32_16x16x32_bf16 v[96:99], a[228:231], a[32:35], v[96:99]
  ds_read_b64_tr_b16 a[224:225], v229 offset:45056
  v_mfma_f32_16x16x32_bf16 v[96:99], a[232:235], a[48:51], v[96:99]
  ds_read_b64_tr_b16 a[226:227], v229 offset:47104
  v_mfma_f32_16x16x32_bf16 v[128:131], a[228:231], a[36:39], v[128:131]
  v_mfma_f32_16x16x32_bf16 v[128:131], a[232:235], a[52:55], v[128:131]
  buffer_load_dwordx4 a[120:123], v225, s[4:7], s40 offen offset:2048 sc1
  v_mfma_f32_16x16x32_bf16 v[160:163], a[228:231], a[40:43], v[160:163]
  v_mfma_f32_16x16x32_bf16 v[160:163], a[232:235], a[56:59], v[160:163]
  v_mfma_f32_16x16x32_bf16 v[192:195], a[228:231], a[44:47], v[192:195]
  ds_read_b64_tr_b16 a[228:229], v229 offset:36864
  v_mfma_f32_16x16x32_bf16 v[192:195], a[232:235], a[60:63], v[192:195]
  ds_read_b64_tr_b16 a[230:231], v229 offset:38912
  v_mfma_f32_16x16x32_bf16 v[196:199], a[192:195], a[44:47], v[196:199]
  ds_read_b64_tr_b16 a[232:233], v230 offset:45056
  s_waitcnt lgkmcnt(13)
  v_mfma_f32_16x16x32_bf16 v[196:199], a[196:199], a[60:63], v[196:199]
  buffer_load_dwordx4 a[124:127], v225, s[4:7], s40 offen offset:3072 sc1
  v_mfma_f32_16x16x32_bf16 v[164:167], a[192:195], a[40:43], v[164:167]
  ds_read_b64_tr_b16 a[234:235], v230 offset:47104
  s_mov_b32 s41, 2293760
  v_mfma_f32_16x16x32_bf16 v[164:167], a[196:199], a[56:59], v[164:167]
  s_add_u32 m0, s42, 118784
  v_mfma_f32_16x16x32_bf16 v[132:135], a[192:195], a[36:39], v[132:135]
  v_mfma_f32_16x16x32_bf16 v[132:135], a[196:199], a[52:55], v[132:135]
  v_mfma_f32_16x16x32_bf16 v[100:103], a[192:195], a[32:35], v[100:103]
  ds_read_b64_tr_b16 a[192:193], v230 offset:36864
  v_mfma_f32_16x16x32_bf16 v[100:103], a[196:199], a[48:51], v[100:103]
  buffer_load_dwordx4 v226, s[16:19], s41 offen offset:0 lds
  s_load_dwordx2 s[66:67], s[36:37], 0x40000
  v_mfma_f32_16x16x32_bf16 v[104:107], a[200:203], a[32:35], v[104:107]
  ds_read_b64_tr_b16 a[194:195], v230 offset:38912
  s_mov_b32 s41, 2523136
  v_mfma_f32_16x16x32_bf16 v[104:107], a[204:207], a[48:51], v[104:107]
  ds_read_b64_tr_b16 a[196:197], v231 offset:45056
  ds_read_b64_tr_b16 a[198:199], v231 offset:47104
  v_mfma_f32_16x16x32_bf16 v[136:139], a[200:203], a[36:39], v[136:139]
  s_add_u32 m0, s42, 131072
  v_mfma_f32_16x16x32_bf16 v[136:139], a[204:207], a[52:55], v[136:139]
  v_mfma_f32_16x16x32_bf16 v[168:171], a[200:203], a[40:43], v[168:171]
  v_mfma_f32_16x16x32_bf16 v[168:171], a[204:207], a[56:59], v[168:171]
  buffer_load_dwordx4 v226, s[16:19], s41 offen offset:0 lds
  v_mfma_f32_16x16x32_bf16 v[200:203], a[200:203], a[44:47], v[200:203]
  ds_read_b64_tr_b16 a[200:201], v231 offset:36864
  v_mfma_f32_16x16x32_bf16 v[200:203], a[204:207], a[60:63], v[200:203]
  ds_read_b64_tr_b16 a[202:203], v231 offset:38912
  s_mov_b32 s41, 2752512
  s_waitcnt lgkmcnt(13)
  v_mfma_f32_16x16x32_bf16 v[204:207], a[208:211], a[44:47], v[204:207]
  ds_read_b64_tr_b16 a[204:205], v228 offset:49152
  s_add_u32 m0, s42, 77824
  v_mfma_f32_16x16x32_bf16 v[204:207], a[212:215], a[60:63], v[204:207]
  s_waitcnt vmcnt(29)
  s_barrier
  v_mfma_f32_16x16x32_bf16 v[172:175], a[208:211], a[40:43], v[172:175]
  ds_read_b64_tr_b16 a[206:207], v228 offset:51200
  v_mfma_f32_16x16x32_bf16 v[172:175], a[212:215], a[56:59], v[172:175]
  buffer_load_dwordx4 v227, s[12:15], s41 offen offset:0 lds
  v_mfma_f32_16x16x32_bf16 v[140:143], a[208:211], a[36:39], v[140:143]
  v_mfma_f32_16x16x32_bf16 v[140:143], a[212:215], a[52:55], v[140:143]
  v_mfma_f32_16x16x32_bf16 v[108:111], a[208:211], a[32:35], v[108:111]
  ds_read_b64_tr_b16 a[208:209], v228 offset:32768
  s_mov_b32 s41, 2981888
  v_mfma_f32_16x16x32_bf16 v[108:111], a[212:215], a[48:51], v[108:111]
  ds_read_b64_tr_b16 a[210:211], v228 offset:34816
  s_add_u32 m0, s42, 73728
  v_mfma_f32_16x16x32_bf16 v[112:115], a[216:219], a[32:35], v[112:115]
  ds_read_b64_tr_b16 a[212:213], v229 offset:49152
  s_waitcnt lgkmcnt(13)
  v_mfma_f32_16x16x32_bf16 v[112:115], a[220:223], a[48:51], v[112:115]
  buffer_load_dwordx4 v227, s[12:15], s41 offen offset:0 lds
  v_mfma_f32_16x16x32_bf16 v[144:147], a[216:219], a[36:39], v[144:147]
  ds_read_b64_tr_b16 a[214:215], v229 offset:51200
  v_mfma_f32_16x16x32_bf16 v[144:147], a[220:223], a[52:55], v[144:147]
  v_mfma_f32_16x16x32_bf16 v[176:179], a[216:219], a[40:43], v[176:179]
  v_mfma_f32_16x16x32_bf16 v[176:179], a[220:223], a[56:59], v[176:179]
  s_load_dwordx2 s[66:67], s[36:37], 0x60000
  v_mfma_f32_16x16x32_bf16 v[208:211], a[216:219], a[44:47], v[208:211]
  ds_read_b64_tr_b16 a[216:217], v229 offset:32768
  v_mfma_f32_16x16x32_bf16 v[208:211], a[220:223], a[60:63], v[208:211]
  ds_read_b64_tr_b16 a[218:219], v229 offset:34816
  s_mov_b32 s41, 2752512
  v_mfma_f32_16x16x32_bf16 v[212:215], a[224:227], a[44:47], v[212:215]
  ds_read_b64_tr_b16 a[220:221], v228 offset:40960
  s_add_u32 m0, s42, 86016
  v_mfma_f32_16x16x32_bf16 v[212:215], a[228:231], a[60:63], v[212:215]
  buffer_load_dwordx4 v227, s[16:19], s41 offen offset:0 lds
  v_mfma_f32_16x16x32_bf16 v[180:183], a[224:227], a[40:43], v[180:183]
  ds_read_b64_tr_b16 a[222:223], v228 offset:43008
  v_mfma_f32_16x16x32_bf16 v[180:183], a[228:231], a[56:59], v[180:183]
  v_mfma_f32_16x16x32_bf16 v[148:151], a[224:227], a[36:39], v[148:151]
  v_mfma_f32_16x16x32_bf16 v[148:151], a[228:231], a[52:55], v[148:151]
  v_mfma_f32_16x16x32_bf16 v[116:119], a[224:227], a[32:35], v[116:119]
  ds_read_b64_tr_b16 a[224:225], v228 offset:53248
  s_mov_b32 s41, 2981888
  v_mfma_f32_16x16x32_bf16 v[116:119], a[228:231], a[48:51], v[116:119]
  ds_read_b64_tr_b16 a[226:227], v228 offset:55296
  s_add_u32 m0, s42, 102400
  s_waitcnt lgkmcnt(13)
  v_mfma_f32_16x16x32_bf16 v[120:123], a[232:235], a[32:35], v[120:123]
  buffer_load_dwordx4 v227, s[16:19], s41 offen offset:0 lds
  v_mfma_f32_16x16x32_bf16 v[120:123], a[192:195], a[48:51], v[120:123]
  ds_read_b64_tr_b16 a[228:229], v229 offset:40960
  ds_read_b64_tr_b16 a[230:231], v229 offset:43008
  v_mfma_f32_16x16x32_bf16 v[152:155], a[232:235], a[36:39], v[152:155]
  v_mfma_f32_16x16x32_bf16 v[152:155], a[192:195], a[52:55], v[152:155]
  v_mfma_f32_16x16x32_bf16 v[184:187], a[232:235], a[40:43], v[184:187]
  v_mfma_f32_16x16x32_bf16 v[184:187], a[192:195], a[56:59], v[184:187]
  v_mfma_f32_16x16x32_bf16 v[216:219], a[232:235], a[44:47], v[216:219]
  ds_read_b64_tr_b16 a[232:233], v229 offset:53248
  v_mfma_f32_16x16x32_bf16 v[216:219], a[192:195], a[60:63], v[216:219]
  ds_read_b64_tr_b16 a[234:235], v229 offset:55296
  s_waitcnt vmcnt(21)
  v_subrev_u32 v244, s100, v244
  v_cmp_lt_u32 s[68:69], 7, v244
  v_mfma_f32_16x16x32_bf16 v[220:223], a[196:199], a[44:47], v[220:223]
  ds_read_b64_tr_b16 a[192:193], v230 offset:49152
  s_cmp_lg_u64 s[68:69], 0
  s_cbranch_scc1 L_slow_28
L_back_29:
  s_waitcnt lgkmcnt(13)
  v_mfma_f32_16x16x32_bf16 v[220:223], a[200:203], a[60:63], v[220:223]
  ds_read_b64_tr_b16 a[194:195], v230 offset:51200
  s_or_b32 s32, s2, s3
  s_cselect_b32 s32, 0x40000000, 0
  s_add_u32 s32, s32, 0xd2d00
  v_mfma_f32_16x16x32_bf16 v[188:191], a[196:199], a[40:43], v[188:191]
  v_mfma_f32_16x16x32_bf16 v[188:191], a[200:203], a[56:59], v[188:191]
  s_load_dwordx2 s[66:67], s[36:37], 0x80000
  v_mfma_f32_16x16x32_bf16 v[156:159], a[196:199], a[36:39], v[156:159]
  v_mfma_f32_16x16x32_bf16 v[156:159], a[200:203], a[52:55], v[156:159]
  v_mfma_f32_16x16x32_bf16 v[124:127], a[196:199], a[32:35], v[124:127]
  ds_read_b64_tr_b16 a[196:197], v230 offset:32768
  v_mfma_f32_16x16x32_bf16 v[124:127], a[200:203], a[48:51], v[124:127]
  ds_read_b64_tr_b16 a[198:199], v230 offset:34816
  s_mov_b32 s40, 11010048
  v_mfma_f32_16x16x32_bf16 v[0:3], a[204:207], a[64:67], v[0:3]
  buffer_load_dwordx4 a[128:131], v225, s[4:7], s40 offen offset:0 sc1
  v_mfma_f32_16x16x32_bf16 v[0:3], a[208:211], a[80:83], v[0:3]
  ds_read_b64_tr_b16 a[200:201], v230 offset:40960
  ds_read_b64_tr_b16 a[202:203], v230 offset:43008
  v_mfma_f32_16x16x32_bf16 v[16:19], a[204:207], a[68:71], v[16:19]
  v_mfma_f32_16x16x32_bf16 v[16:19], a[208:211], a[84:87], v[16:19]
  v_mfma_f32_16x16x32_bf16 v[32:35], a[204:207], a[72:75], v[32:35]
  v_mfma_f32_16x16x32_bf16 v[32:35], a[208:211], a[88:91], v[32:35]
  buffer_load_dwordx4 a[132:135], v225, s[4:7], s40 offen offset:1024 sc1
  v_mfma_f32_16x16x32_bf16 v[48:51], a[204:207], a[76:79], v[48:51]
  ds_read_b64_tr_b16 a[204:205], v230 offset:53248
  v_mfma_f32_16x16x32_bf16 v[48:51], a[208:211], a[92:95], v[48:51]
  ds_read_b64_tr_b16 a[206:207], v230 offset:55296
  s_waitcnt lgkmcnt(13)
  v_mfma_f32_16x16x32_bf16 v[52:55], a[212:215], a[76:79], v[52:55]
  ds_read_b64_tr_b16 a[208:209], v228 offset:57344
  v_mfma_f32_16x16x32_bf16 v[52:55], a[216:219], a[92:95], v[52:55]
  ds_read_b64_tr_b16 a[210:211], v228 offset:59392
  v_mfma_f32_16x16x32_bf16 v[36:39], a[212:215], a[72:75], v[36:39]
  v_mfma_f32_16x16x32_bf16 v[36:39], a[216:219], a[88:91], v[36:39]
  buffer_load_dwordx4 a[136:139], v225, s[4:7], s40 offen offset:2048 sc1
  v_mfma_f32_16x16x32_bf16 v[20:23], a[212:215], a[68:71], v[20:23]
  s_mov_b32 s78, 4718592
L_wk1_2:
  s_cbranch_vccnz L_wk1_6
  v_mfma_f32_16x16x32_bf16 v[20:23], a[216:219], a[84:87], v[20:23]
  buffer_load_dword v241, v247, s[56:59], s78 offen
  v_mfma_f32_16x16x32_bf16 v[4:7], a[212:215], a[64:67], v[4:7]
  ds_read_b64_tr_b16 a[212:213], v232 offset:0
  v_mfma_f32_16x16x32_bf16 v[4:7], a[216:219], a[80:83], v[4:7]
  ds_read_b64_tr_b16 a[214:215], v232 offset:2048
  v_mfma_f32_16x16x32_bf16 v[8:11], a[220:223], a[64:67], v[8:11]
  ds_read_b64_tr_b16 a[216:217], v229 offset:57344
  s_waitcnt lgkmcnt(13)
  v_mfma_f32_16x16x32_bf16 v[8:11], a[224:227], a[80:83], v[8:11]
  s_waitcnt vmcnt(24)
  s_barrier
  s_load_dwordx2 s[66:67], s[36:37], 0xa0000
  v_mfma_f32_16x16x32_bf16 v[24:27], a[220:223], a[68:71], v[24:27]
  buffer_load_dwordx4 a[140:143], v225, s[4:7], s40 offen offset:3072 sc1
  buffer_store_dword v245, v246, s[4:7], s32 offen sc1
  v_mfma_f32_16x16x32_bf16 v[24:27], a[224:227], a[84:87], v[24:27]
  ds_read_b64_tr_b16 a[218:219], v229 offset:59392
  s_mov_b32 s41, 2752512
  v_add_u32 v243, s91, v243
  s_mov_b32 s91, 0
  v_mfma_f32_16x16x32_bf16 v[40:43], a[220:223], a[72:75], v[40:43]
  s_add_u32 m0, s42, 98304
  v_accvgpr_write_b32 a252, -1
  v_accvgpr_write_b32 a253, -1
  v_accvgpr_write_b32 a254, -1
  v_mfma_f32_16x16x32_bf16 v[40:43], a[224:227], a[88:91], v[40:43]
  v_accvgpr_write_b32 a255, -1
  v_mfma_f32_16x16x32_bf16 v[56:59], a[220:223], a[76:79], v[56:59]
  ds_read_b64_tr_b16 a[220:221], v233 offset:0
  v_mfma_f32_16x16x32_bf16 v[56:59], a[224:227], a[92:95], v[56:59]
  buffer_load_dwordx4 v226, s[12:15], s41 offen offset:0 lds
  v_mfma_f32_16x16x32_bf16 v[60:63], a[228:231], a[76:79], v[60:63]
  ds_read_b64_tr_b16 a[222:223], v233 offset:2048
  s_mov_b32 s41, 2981888
  v_mfma_f32_16x16x32_bf16 v[60:63], a[232:235], a[92:95], v[60:63]
  ds_read_b64_tr_b16 a[224:225], v230 offset:57344
  ds_read_b64_tr_b16 a[226:227], v230 offset:59392
  v_mfma_f32_16x16x32_bf16 v[44:47], a[228:231], a[72:75], v[44:47]
  s_add_u32 m0, s42, 110592
  v_mfma_f32_16x16x32_bf16 v[44:47], a[232:235], a[88:91], v[44:47]
  v_mfma_f32_16x16x32_bf16 v[28:31], a[228:231], a[68:71], v[28:31]
  v_mfma_f32_16x16x32_bf16 v[28:31], a[232:235], a[84:87], v[28:31]
  buffer_load_dwordx4 v226, s[12:15], s41 offen offset:0 lds
  v_mfma_f32_16x16x32_bf16 v[12:15], a[228:231], a[64:67], v[12:15]
  ds_read_b64_tr_b16 a[228:229], v234 offset:0
  s_mov_b32 s40, 11141120
  v_mfma_f32_16x16x32_bf16 v[12:15], a[232:235], a[80:83], v[12:15]
  ds_read_b64_tr_b16 a[230:231], v234 offset:2048
  s_waitcnt lgkmcnt(13)
  v_mfma_f32_16x16x32_bf16 v[64:67], a[192:195], a[64:67], v[64:67]
  ds_read_b64_tr_b16 a[232:233], v231 offset:57344
  v_mfma_f32_16x16x32_bf16 v[64:67], a[196:199], a[80:83], v[64:67]
  ds_read_b64_tr_b16 a[234:235], v231 offset:59392
  v_mfma_f32_16x16x32_bf16 v[72:75], a[192:195], a[68:71], v[72:75]
  v_mfma_f32_16x16x32_bf16 v[72:75], a[196:199], a[84:87], v[72:75]
  buffer_load_dwordx4 a[144:147], v225, s[4:7], s40 offen offset:0 sc1
  v_mfma_f32_16x16x32_bf16 v[80:83], a[192:195], a[72:75], v[80:83]
  v_mfma_f32_16x16x32_bf16 v[80:83], a[196:199], a[88:91], v[80:83]
  v_mfma_f32_16x16x32_bf16 v[88:91], a[192:195], a[76:79], v[88:91]
  ds_read_b64_tr_b16 a[192:193], v235 offset:0
  v_mfma_f32_16x16x32_bf16 v[88:91], a[196:199], a[92:95], v[88:91]
  ds_read_b64_tr_b16 a[194:195], v235 offset:2048
  s_load_dwordx2 s[66:67], s[36:37], 0xc0000
  v_mfma_f32_16x16x32_bf16 v[92:95], a[200:203], a[76:79], v[92:95]
  ds_read_b64_tr_b16 a[196:197], v232 offset:28672
  s_waitcnt lgkmcnt(13)
  v_mfma_f32_16x16x32_bf16 v[92:95], a[204:207], a[92:95], v[92:95]
  buffer_load_dwordx4 a[148:151], v225, s[4:7], s40 offen offset:1024 sc1
  v_mfma_f32_16x16x32_bf16 v[84:87], a[200:203], a[72:75], v[84:87]
  ds_read_b64_tr_b16 a[198:199], v232 offset:30720
  v_mfma_f32_16x16x32_bf16 v[84:87], a[204:207], a[88:91], v[84:87]
  v_mfma_f32_16x16x32_bf16 v[76:79], a[200:203], a[68:71], v[76:79]
  v_mfma_f32_16x16x32_bf16 v[76:79], a[204:207], a[84:87], v[76:79]
  v_mfma_f32_16x16x32_bf16 v[68:71], a[200:203], a[64:67], v[68:71]
  ds_read_b64_tr_b16 a[200:201], v232 offset:40960
  v_mfma_f32_16x16x32_bf16 v[68:71], a[204:207], a[80:83], v[68:71]
  buffer_load_dwordx4 a[152:155], v225, s[4:7], s40 offen offset:2048 sc1
  v_mfma_f32_16x16x32_bf16 v[96:99], a[208:211], a[64:67], v[96:99]
  ds_read_b64_tr_b16 a[202:203], v232 offset:43008
  v_mfma_f32_16x16x32_bf16 v[96:99], a[212:215], a[80:83], v[96:99]
  ds_read_b64_tr_b16 a[204:205], v233 offset:28672
  ds_read_b64_tr_b16 a[206:207], v233 offset:30720
  v_mfma_f32_16x16x32_bf16 v[128:131], a[208:211], a[68:71], v[128:131]
  v_mfma_f32_16x16x32_bf16 v[128:131], a[212:215], a[84:87], v[128:131]
  v_mfma_f32_16x16x32_bf16 v[160:163], a[208:211], a[72:75], v[160:163]
  v_mfma_f32_16x16x32_bf16 v[160:163], a[212:215], a[88:91], v[160:163]
  buffer_load_dwordx4 a[156:159], v225, s[4:7], s40 offen offset:3072 sc1
  v_mfma_f32_16x16x32_bf16 v[192:195], a[208:211], a[76:79], v[192:195]
  ds_read_b64_tr_b16 a[208:209], v233 offset:40960
  s_mov_b32 s41, 2752512
  v_mfma_f32_16x16x32_bf16 v[192:195], a[212:215], a[92:95], v[192:195]
  ds_read_b64_tr_b16 a[210:211], v233 offset:43008
  s_add_u32 m0, s42, 126976
  s_waitcnt lgkmcnt(13)
  v_mfma_f32_16x16x32_bf16 v[196:199], a[216:219], a[76:79], v[196:199]
  ds_read_b64_tr_b16 a[212:213], v234 offset:28672
  v_mfma_f32_16x16x32_bf16 v[196:199], a[220:223], a[92:95], v[196:199]
  ds_read_b64_tr_b16 a[214:215], v234 offset:30720
  v_mfma_f32_16x16x32_bf16 v[164:167], a[216:219], a[72:75], v[164:167]
  v_mfma_f32_16x16x32_bf16 v[164:167], a[220:223], a[88:91], v[164:167]
  buffer_load_dwordx4 v226, s[16:19], s41 offen offset:0 lds
  v_mfma_f32_16x16x32_bf16 v[132:135], a[216:219], a[68:71], v[132:135]
  s_mov_b32 s41, 2981888
  s_add_u32 m0, s42, 122880
  v_mfma_f32_16x16x32_bf16 v[132:135], a[220:223], a[84:87], v[132:135]
  s_load_dwordx2 s[66:67], s[36:37], 0xe0000
  s_add_u32 s36, s36, 0x100000
  s_addc_u32 s37, s37, 0
  v_mfma_f32_16x16x32_bf16 v[100:103], a[216:219], a[64:67], v[100:103]
  ds_read_b64_tr_b16 a[216:217], v234 offset:40960
  v_mfma_f32_16x16x32_bf16 v[100:103], a[220:223], a[80:83], v[100:103]
  ds_read_b64_tr_b16 a[218:219], v234 offset:43008
  v_mfma_f32_16x16x32_bf16 v[104:107], a[224:227], a[64:67], v[104:107]
  ds_read_b64_tr_b16 a[220:221], v235 offset:28672
  s_waitcnt lgkmcnt(13)
  v_mfma_f32_16x16x32_bf16 v[104:107], a[228:231], a[80:83], v[104:107]
  buffer_load_dwordx4 v226, s[16:19], s41 offen offset:0 lds
  v_mfma_f32_16x16x32_bf16 v[136:139], a[224:227], a[68:71], v[136:139]
  ds_read_b64_tr_b16 a[222:223], v235 offset:30720
  v_mfma_f32_16x16x32_bf16 v[136:139], a[228:231], a[84:87], v[136:139]
  v_mfma_f32_16x16x32_bf16 v[168:171], a[224:227], a[72:75], v[168:171]
  v_mfma_f32_16x16x32_bf16 v[168:171], a[228:231], a[88:91], v[168:171]
  v_mfma_f32_16x16x32_bf16 v[200:203], a[224:227], a[76:79], v[200:203]
  ds_read_b64_tr_b16 a[224:225], v235 offset:40960
  v_mfma_f32_16x16x32_bf16 v[200:203], a[228:231], a[92:95], v[200:203]
  ds_read_b64_tr_b16 a[226:227], v235 offset:43008
  s_mov_b32 s41, 3211264
  v_mfma_f32_16x16x32_bf16 v[204:207], a[232:235], a[76:79], v[204:207]
  ds_read_b64_tr_b16 a[228:229], v232 offset:49152
  s_add_u32 m0, s42, 135168
  v_mfma_f32_16x16x32_bf16 v[204:207], a[192:195], a[92:95], v[204:207]
  s_waitcnt vmcnt(24)
  s_barrier
  v_mfma_f32_16x16x32_bf16 v[172:175], a[232:235], a[72:75], v[172:175]
  buffer_load_dwordx4 v227, s[12:15], s41 offen offset:0 lds
  v_mfma_f32_16x16x32_bf16 v[172:175], a[192:195], a[88:91], v[172:175]
  ds_read_b64_tr_b16 a[230:231], v232 offset:51200
  v_mfma_f32_16x16x32_bf16 v[140:143], a[232:235], a[68:71], v[140:143]
  v_mfma_f32_16x16x32_bf16 v[140:143], a[192:195], a[84:87], v[140:143]
  v_mfma_f32_16x16x32_bf16 v[108:111], a[232:235], a[64:67], v[108:111]
  ds_read_b64_tr_b16 a[232:233], v236 offset:12288
  s_mov_b32 s41, 3440640
  v_mfma_f32_16x16x32_bf16 v[108:111], a[192:195], a[80:83], v[108:111]
  ds_read_b64_tr_b16 a[234:235], v236 offset:14336
  s_add_u32 m0, s42, 151552
  s_waitcnt lgkmcnt(13)
  v_mfma_f32_16x16x32_bf16 v[112:115], a[196:199], a[64:67], v[112:115]
  buffer_load_dwordx4 v227, s[12:15], s41 offen offset:0 lds
  v_mfma_f32_16x16x32_bf16 v[112:115], a[200:203], a[80:83], v[112:115]
  ds_read_b64_tr_b16 a[192:193], v233 offset:49152
  ds_read_b64_tr_b16 a[194:195], v233 offset:51200
  v_mfma_f32_16x16x32_bf16 v[144:147], a[196:199], a[68:71], v[144:147]
  v_mfma_f32_16x16x32_bf16 v[144:147], a[200:203], a[84:87], v[144:147]
  s_load_dwordx2 s[66:67], s[36:37], 0x0
  v_mfma_f32_16x16x32_bf16 v[176:179], a[196:199], a[72:75], v[176:179]
  v_mfma_f32_16x16x32_bf16 v[176:179], a[200:203], a[88:91], v[176:179]
  v_mfma_f32_16x16x32_bf16 v[208:211], a[196:199], a[76:79], v[208:211]
  ds_read_b64_tr_b16 a[196:197], v237 offset:12288
  v_mfma_f32_16x16x32_bf16 v[208:211], a[200:203], a[92:95], v[208:211]
  ds_read_b64_tr_b16 a[198:199], v237 offset:14336
  s_mov_b32 s41, 3211264
  v_mfma_f32_16x16x32_bf16 v[212:215], a[204:207], a[76:79], v[212:215]
  ds_read_b64_tr_b16 a[200:201], v232 offset:4096
  s_add_u32 m0, s42, 147456
  s_waitcnt lgkmcnt(13)
  v_mfma_f32_16x16x32_bf16 v[212:215], a[208:211], a[92:95], v[212:215]
  buffer_load_dwordx4 v227, s[16:19], s41 offen offset:0 lds
  v_mfma_f32_16x16x32_bf16 v[180:183], a[204:207], a[72:75], v[180:183]
  ds_read_b64_tr_b16 a[202:203], v232 offset:6144
  v_mfma_f32_16x16x32_bf16 v[180:183], a[208:211], a[88:91], v[180:183]
  v_mfma_f32_16x16x32_bf16 v[148:151], a[204:207], a[68:71], v[148:151]
  v_mfma_f32_16x16x32_bf16 v[148:151], a[208:211], a[84:87], v[148:151]
  v_mfma_f32_16x16x32_bf16 v[116:119], a[204:207], a[64:67], v[116:119]
  ds_read_b64_tr_b16 a[204:205], v232 offset:16384
  s_mov_b32 s41, 3440640
  v_mfma_f32_16x16x32_bf16 v[116:119], a[208:211], a[80:83], v[116:119]
  ds_read_b64_tr_b16 a[206:207], v232 offset:18432
  s_add_u32 m0, s42, 159744
  v_mfma_f32_16x16x32_bf16 v[120:123], a[212:215], a[64:67], v[120:123]
  buffer_load_dwordx4 v227, s[16:19], s41 offen offset:0 lds
  v_mfma_f32_16x16x32_bf16 v[120:123], a[216:219], a[80:83], v[120:123]
  ds_read_b64_tr_b16 a[208:209], v233 offset:4096
  ds_read_b64_tr_b16 a[210:211], v233 offset:6144
  v_mfma_f32_16x16x32_bf16 v[152:155], a[212:215], a[68:71], v[152:155]
  v_mfma_f32_16x16x32_bf16 v[152:155], a[216:219], a[84:87], v[152:155]
  v_mfma_f32_16x16x32_bf16 v[184:187], a[212:215], a[72:75], v[184:187]
  v_mfma_f32_16x16x32_bf16 v[184:187], a[216:219], a[88:91], v[184:187]
  v_mfma_f32_16x16x32_bf16 v[216:219], a[212:215], a[76:79], v[216:219]
  ds_read_b64_tr_b16 a[212:213], v233 offset:16384
  v_mfma_f32_16x16x32_bf16 v[216:219], a[216:219], a[92:95], v[216:219]
  ds_read_b64_tr_b16 a[214:215], v233 offset:18432
  s_waitcnt lgkmcnt(13)
  v_mfma_f32_16x16x32_bf16 v[220:223], a[220:223], a[76:79], v[220:223]
  ds_read_b64_tr_b16 a[216:217], v234 offset:49152
  v_mfma_f32_16x16x32_bf16 v[220:223], a[224:227], a[92:95], v[220:223]
  ds_read_b64_tr_b16 a[218:219], v234 offset:51200
  s_load_dwordx2 s[66:67], s[36:37], 0x20000
  v_mfma_f32_16x16x32_bf16 v[188:191], a[220:223], a[72:75], v[188:191]
  v_mfma_f32_16x16x32_bf16 v[188:191], a[224:227], a[88:91], v[188:191]
  v_mfma_f32_16x16x32_bf16 v[156:159], a[220:223], a[68:71], v[156:159]
  v_mfma_f32_16x16x32_bf16 v[156:159], a[224:227], a[84:87], v[156:159]
  v_mfma_f32_16x16x32_bf16 v[124:127], a[220:223], a[64:67], v[124:127]
  ds_read_b64_tr_b16 a[220:221], v238 offset:12288
  v_mfma_f32_16x16x32_bf16 v[124:127], a[224:227], a[80:83], v[124:127]
  ds_read_b64_tr_b16 a[222:223], v238 offset:14336
  s_mov_b32 s40, 11272192
  v_mfma_f32_16x16x32_bf16 v[0:3], a[228:231], a[96:99], v[0:3]
  buffer_load_dwordx4 a[160:163], v225, s[4:7], s40 offen offset:0 sc1
  s_waitcnt vmcnt(25) lgkmcnt(13)
  v_mfma_f32_16x16x32_bf16 v[0:3], a[232:235], a[112:115], v[0:3]
  ds_read_b64_tr_b16 a[224:225], v234 offset:4096
  ds_read_b64_tr_b16 a[226:227], v234 offset:6144
  v_mfma_f32_16x16x32_bf16 v[16:19], a[228:231], a[100:103], v[16:19]
  s_mov_b32 s78, 5242880
  v_mfma_f32_16x16x32_bf16 v[16:19], a[232:235], a[116:119], v[16:19]
  buffer_load_dword v241, v247, s[56:59], s78 offen
  v_mfma_f32_16x16x32_bf16 v[32:35], a[228:231], a[104:107], v[32:35]
  v_mfma_f32_16x16x32_bf16 v[32:35], a[232:235], a[120:123], v[32:35]
  buffer_load_dwordx4 a[164:167], v225, s[4:7], s40 offen offset:1024 sc1
  v_mfma_f32_16x16x32_bf16 v[48:51], a[228:231], a[108:111], v[48:51]
  ds_read_b64_tr_b16 a[228:229], v234 offset:16384
  v_mfma_f32_16x16x32_bf16 v[48:51], a[232:235], a[124:127], v[48:51]
  ds_read_b64_tr_b16 a[230:231], v234 offset:18432
  v_mfma_f32_16x16x32_bf16 v[52:55], a[192:195], a[108:111], v[52:55]
  ds_read_b64_tr_b16 a[232:233], v228 offset:61440
  s_waitcnt lgkmcnt(13)
  v_mfma_f32_16x16x32_bf16 v[52:55], a[196:199], a[124:127], v[52:55]
  ds_read_b64_tr_b16 a[234:235], v228 offset:63488
  v_mfma_f32_16x16x32_bf16 v[36:39], a[192:195], a[104:107], v[36:39]
  v_mfma_f32_16x16x32_bf16 v[36:39], a[196:199], a[120:123], v[36:39]
  buffer_load_dwordx4 a[168:171], v225, s[4:7], s40 offen offset:2048 sc1
  v_mfma_f32_16x16x32_bf16 v[20:23], a[192:195], a[100:103], v[20:23]
  v_mfma_f32_16x16x32_bf16 v[20:23], a[196:199], a[116:119], v[20:23]
  v_mfma_f32_16x16x32_bf16 v[4:7], a[192:195], a[96:99], v[4:7]
  ds_read_b64_tr_b16 a[192:193], v232 offset:24576
  v_mfma_f32_16x16x32_bf16 v[4:7], a[196:199], a[112:115], v[4:7]
  ds_read_b64_tr_b16 a[194:195], v232 offset:26624
  s_load_dwordx2 s[66:67], s[36:37], 0x40000
  v_mfma_f32_16x16x32_bf16 v[8:11], a[200:203], a[96:99], v[8:11]
  ds_read_b64_tr_b16 a[196:197], v229 offset:61440
  v_mfma_f32_16x16x32_bf16 v[8:11], a[204:207], a[112:115], v[8:11]
  s_waitcnt vmcnt(25)
  s_barrier
  v_mfma_f32_16x16x32_bf16 v[24:27], a[200:203], a[100:103], v[24:27]
  buffer_load_dwordx4 a[172:175], v225, s[4:7], s40 offen offset:3072 sc1
  v_mfma_f32_16x16x32_bf16 v[24:27], a[204:207], a[116:119], v[24:27]
  ds_read_b64_tr_b16 a[198:199], v229 offset:63488
  s_mov_b32 s41, 3211264
  v_mfma_f32_16x16x32_bf16 v[40:43], a[200:203], a[104:107], v[40:43]
  s_add_u32 m0, s42, 16384
  v_mfma_f32_16x16x32_bf16 v[40:43], a[204:207], a[120:123], v[40:43]
  v_mfma_f32_16x16x32_bf16 v[56:59], a[200:203], a[108:111], v[56:59]
  ds_read_b64_tr_b16 a[200:201], v233 offset:24576
  v_mfma_f32_16x16x32_bf16 v[56:59], a[204:207], a[124:127], v[56:59]
  buffer_load_dwordx4 v226, s[12:15], s41 offen offset:0 lds
  s_waitcnt lgkmcnt(13)
  v_mfma_f32_16x16x32_bf16 v[60:63], a[208:211], a[108:111], v[60:63]
  ds_read_b64_tr_b16 a[202:203], v233 offset:26624
  s_mov_b32 s41, 3440640
  v_mfma_f32_16x16x32_bf16 v[60:63], a[212:215], a[124:127], v[60:63]
  ds_read_b64_tr_b16 a[204:205], v230 offset:61440
  ds_read_b64_tr_b16 a[206:207], v230 offset:63488
  v_mfma_f32_16x16x32_bf16 v[44:47], a[208:211], a[104:107], v[44:47]
  s_add_u32 m0, s42, 28672
  v_mfma_f32_16x16x32_bf16 v[44:47], a[212:215], a[120:123], v[44:47]
  v_mfma_f32_16x16x32_bf16 v[28:31], a[208:211], a[100:103], v[28:31]
  v_mfma_f32_16x16x32_bf16 v[28:31], a[212:215], a[116:119], v[28:31]
  buffer_load_dwordx4 v226, s[12:15], s41 offen offset:0 lds
  v_mfma_f32_16x16x32_bf16 v[12:15], a[208:211], a[96:99], v[12:15]
  ds_read_b64_tr_b16 a[208:209], v234 offset:24576
  s_mov_b32 s40, 11403264
  v_mfma_f32_16x16x32_bf16 v[12:15], a[212:215], a[112:115], v[12:15]
  ds_read_b64_tr_b16 a[210:211], v234 offset:26624
  v_mfma_f32_16x16x32_bf16 v[64:67], a[216:219], a[96:99], v[64:67]
  ds_read_b64_tr_b16 a[212:213], v231 offset:61440
  s_waitcnt lgkmcnt(13)
  v_mfma_f32_16x16x32_bf16 v[64:67], a[220:223], a[112:115], v[64:67]
  ds_read_b64_tr_b16 a[214:215], v231 offset:63488
  v_mfma_f32_16x16x32_bf16 v[72:75], a[216:219], a[100:103], v[72:75]
  v_mfma_f32_16x16x32_bf16 v[72:75], a[220:223], a[116:119], v[72:75]
  buffer_load_dwordx4 a[176:179], v225, s[4:7], s40 offen offset:0 sc1
  v_mfma_f32_16x16x32_bf16 v[80:83], a[216:219], a[104:107], v[80:83]
  v_mfma_f32_16x16x32_bf16 v[80:83], a[220:223], a[120:123], v[80:83]
  s_load_dwordx2 s[66:67], s[36:37], 0x60000
  v_mfma_f32_16x16x32_bf16 v[88:91], a[216:219], a[108:111], v[88:91]
  ds_read_b64_tr_b16 a[216:217], v235 offset:24576
  v_mfma_f32_16x16x32_bf16 v[88:91], a[220:223], a[124:127], v[88:91]
  ds_read_b64_tr_b16 a[218:219], v235 offset:26624
  v_mfma_f32_16x16x32_bf16 v[92:95], a[224:227], a[108:111], v[92:95]
  ds_read_b64_tr_b16 a[220:221], v232 offset:53248
  v_mfma_f32_16x16x32_bf16 v[92:95], a[228:231], a[124:127], v[92:95]
  buffer_load_dwordx4 a[180:183], v225, s[4:7], s40 offen offset:1024 sc1
  v_mfma_f32_16x16x32_bf16 v[84:87], a[224:227], a[104:107], v[84:87]
  ds_read_b64_tr_b16 a[222:223], v232 offset:55296
  v_mfma_f32_16x16x32_bf16 v[84:87], a[228:231], a[120:123], v[84:87]
  v_mfma_f32_16x16x32_bf16 v[76:79], a[224:227], a[100:103], v[76:79]
  v_mfma_f32_16x16x32_bf16 v[76:79], a[228:231], a[116:119], v[76:79]
  v_mfma_f32_16x16x32_bf16 v[68:71], a[224:227], a[96:99], v[68:71]
  ds_read_b64_tr_b16 a[224:225], v236 offset:0
  v_mfma_f32_16x16x32_bf16 v[68:71], a[228:231], a[112:115], v[68:71]
  buffer_load_dwordx4 a[184:187], v225, s[4:7], s40 offen offset:2048 sc1
  s_waitcnt lgkmcnt(13)
  v_mfma_f32_16x16x32_bf16 v[96:99], a[232:235], a[96:99], v[96:99]
  ds_read_b64_tr_b16 a[226:227], v236 offset:2048
  v_mfma_f32_16x16x32_bf16 v[96:99], a[192:195], a[112:115], v[96:99]
  ds_read_b64_tr_b16 a[228:229], v233 offset:53248
  ds_read_b64_tr_b16 a[230:231], v233 offset:55296
  v_mfma_f32_16x16x32_bf16 v[128:131], a[232:235], a[100:103], v[128:131]
  v_mfma_f32_16x16x32_bf16 v[128:131], a[192:195], a[116:119], v[128:131]
  v_mfma_f32_16x16x32_bf16 v[160:163], a[232:235], a[104:107], v[160:163]
  v_mfma_f32_16x16x32_bf16 v[160:163], a[192:195], a[120:123], v[160:163]
  buffer_load_dwordx4 a[188:191], v225, s[4:7], s40 offen offset:3072 sc1
  v_mfma_f32_16x16x32_bf16 v[192:195], a[232:235], a[108:111], v[192:195]
  ds_read_b64_tr_b16 a[232:233], v237 offset:0
  s_mov_b32 s41, 3211264
  v_mfma_f32_16x16x32_bf16 v[192:195], a[192:195], a[124:127], v[192:195]
  ds_read_b64_tr_b16 a[234:235], v237 offset:2048
  s_add_u32 m0, s42, 139264
  v_mfma_f32_16x16x32_bf16 v[196:199], a[196:199], a[108:111], v[196:199]
  ds_read_b64_tr_b16 a[192:193], v234 offset:53248
  s_waitcnt lgkmcnt(13)
  v_mfma_f32_16x16x32_bf16 v[196:199], a[200:203], a[124:127], v[196:199]
  ds_read_b64_tr_b16 a[194:195], v234 offset:55296
  v_mfma_f32_16x16x32_bf16 v[164:167], a[196:199], a[104:107], v[164:167]
  v_mfma_f32_16x16x32_bf16 v[164:167], a[200:203], a[120:123], v[164:167]
  buffer_load_dwordx4 v226, s[16:19], s41 offen offset:0 lds
  s_load_dwordx2 s[66:67], s[36:37], 0x80000
  v_mfma_f32_16x16x32_bf16 v[132:135], a[196:199], a[100:103], v[132:135]
  s_mov_b32 s41, 3440640
  s_add_u32 m0, s42, 155648
  v_mfma_f32_16x16x32_bf16 v[132:135], a[200:203], a[116:119], v[132:135]
  v_mfma_f32_16x16x32_bf16 v[100:103], a[196:199], a[96:99], v[100:103]
  ds_read_b64_tr_b16 a[196:197], v238 offset:0
  v_mfma_f32_16x16x32_bf16 v[100:103], a[200:203], a[112:115], v[100:103]
  ds_read_b64_tr_b16 a[198:199], v238 offset:2048
  v_mfma_f32_16x16x32_bf16 v[104:107], a[204:207], a[96:99], v[104:107]
  ds_read_b64_tr_b16 a[200:201], v235 offset:53248
  v_mfma_f32_16x16x32_bf16 v[104:107], a[208:211], a[112:115], v[104:107]
  buffer_load_dwordx4 v226, s[16:19], s41 offen offset:0 lds
  v_mfma_f32_16x16x32_bf16 v[136:139], a[204:207], a[100:103], v[136:139]
  ds_read_b64_tr_b16 a[202:203], v235 offset:55296
  v_mfma_f32_16x16x32_bf16 v[136:139], a[208:211], a[116:119], v[136:139]
  v_mfma_f32_16x16x32_bf16 v[168:171], a[204:207], a[104:107], v[168:171]
  v_mfma_f32_16x16x32_bf16 v[168:171], a[208:211], a[120:123], v[168:171]
  v_mfma_f32_16x16x32_bf16 v[200:203], a[204:207], a[108:111], v[200:203]
  ds_read_b64_tr_b16 a[204:205], v239 offset:0
  v_mfma_f32_16x16x32_bf16 v[200:203], a[208:211], a[124:127], v[200:203]
  ds_read_b64_tr_b16 a[206:207], v239 offset:2048
  s_mov_b32 s41, 3670016
  s_waitcnt lgkmcnt(13)
  v_mfma_f32_16x16x32_bf16 v[204:207], a[212:215], a[108:111], v[204:207]
  ds_read_b64_tr_b16 a[208:209], v232 offset:12288
  s_add_u32 m0, s42, 20480
  v_mfma_f32_16x16x32_bf16 v[204:207], a[216:219], a[124:127], v[204:207]
  s_waitcnt vmcnt(23)
  s_barrier
  v_mfma_f32_16x16x32_bf16 v[172:175], a[212:215], a[104:107], v[172:175]
  buffer_load_dwordx4 v227, s[12:15], s41 offen offset:0 lds
  v_mfma_f32_16x16x32_bf16 v[172:175], a[216:219], a[120:123], v[172:175]
  ds_read_b64_tr_b16 a[210:211], v232 offset:14336
  v_mfma_f32_16x16x32_bf16 v[140:143], a[212:215], a[100:103], v[140:143]
  v_mfma_f32_16x16x32_bf16 v[140:143], a[216:219], a[116:119], v[140:143]
  v_mfma_f32_16x16x32_bf16 v[108:111], a[212:215], a[96:99], v[108:111]
  ds_read_b64_tr_b16 a[212:213], v232 offset:8192
  s_mov_b32 s41, 3899392
  v_mfma_f32_16x16x32_bf16 v[108:111], a[216:219], a[112:115], v[108:111]
  ds_read_b64_tr_b16 a[214:215], v232 offset:10240
  s_add_u32 m0, s42, 12288
  v_mfma_f32_16x16x32_bf16 v[112:115], a[220:223], a[96:99], v[112:115]
  buffer_load_dwordx4 v227, s[12:15], s41 offen offset:0 lds
  s_waitcnt lgkmcnt(13)
  v_mfma_f32_16x16x32_bf16 v[112:115], a[224:227], a[112:115], v[112:115]
  ds_read_b64_tr_b16 a[216:217], v233 offset:12288
  ds_read_b64_tr_b16 a[218:219], v233 offset:14336
  s_load_dwordx2 s[66:67], s[36:37], 0xa0000
  v_mfma_f32_16x16x32_bf16 v[144:147], a[220:223], a[100:103], v[144:147]
  v_mfma_f32_16x16x32_bf16 v[144:147], a[224:227], a[116:119], v[144:147]
  v_mfma_f32_16x16x32_bf16 v[176:179], a[220:223], a[104:107], v[176:179]
  v_mfma_f32_16x16x32_bf16 v[176:179], a[224:227], a[120:123], v[176:179]
  v_mfma_f32_16x16x32_bf16 v[208:211], a[220:223], a[108:111], v[208:211]
  ds_read_b64_tr_b16 a[220:221], v233 offset:8192
  v_mfma_f32_16x16x32_bf16 v[208:211], a[224:227], a[124:127], v[208:211]
  ds_read_b64_tr_b16 a[222:223], v233 offset:10240
  s_mov_b32 s41, 3670016
  v_mfma_f32_16x16x32_bf16 v[212:215], a[228:231], a[108:111], v[212:215]
  ds_read_b64_tr_b16 a[224:225], v232 offset:20480
  s_add_u32 m0, s42, 24576
  s_waitcnt lgkmcnt(13)
  v_mfma_f32_16x16x32_bf16 v[212:215], a[232:235], a[124:127], v[212:215]
  buffer_load_dwordx4 v227, s[16:19], s41 offen offset:0 lds
  v_mfma_f32_16x16x32_bf16 v[180:183], a[228:231], a[104:107], v[180:183]
  ds_read_b64_tr_b16 a[226:227], v232 offset:22528
  v_mfma_f32_16x16x32_bf16 v[180:183], a[232:235], a[120:123], v[180:183]
  v_mfma_f32_16x16x32_bf16 v[148:151], a[228:231], a[100:103], v[148:151]
  v_mfma_f32_16x16x32_bf16 v[148:151], a[232:235], a[116:119], v[148:151]
  v_mfma_f32_16x16x32_bf16 v[116:119], a[228:231], a[96:99], v[116:119]
  ds_read_b64_tr_b16 a[228:229], v232 offset:36864
  s_mov_b32 s41, 3899392
  v_mfma_f32_16x16x32_bf16 v[116:119], a[232:235], a[112:115], v[116:119]
  ds_read_b64_tr_b16 a[230:231], v232 offset:38912
  s_add_u32 m0, s42, 45056
  v_mfma_f32_16x16x32_bf16 v[120:123], a[192:195], a[96:99], v[120:123]
  buffer_load_dwordx4 v227, s[16:19], s41 offen offset:0 lds
  v_mfma_f32_16x16x32_bf16 v[120:123], a[196:199], a[112:115], v[120:123]
  ds_read_b64_tr_b16 a[232:233], v233 offset:20480
  ds_read_b64_tr_b16 a[234:235], v233 offset:22528
  v_mfma_f32_16x16x32_bf16 v[152:155], a[192:195], a[100:103], v[152:155]
  v_mfma_f32_16x16x32_bf16 v[152:155], a[196:199], a[116:119], v[152:155]
  s_mov_b32 s78, 5767168
  v_mfma_f32_16x16x32_bf16 v[184:187], a[192:195], a[104:107], v[184:187]
  buffer_load_dword v241, v247, s[56:59], s78 offen
  v_mfma_f32_16x16x32_bf16 v[184:187], a[196:199], a[120:123], v[184:187]
  v_mfma_f32_16x16x32_bf16 v[216:219], a[192:195], a[108:111], v[216:219]
  ds_read_b64_tr_b16 a[192:193], v233 offset:36864
  v_mfma_f32_16x16x32_bf16 v[216:219], a[196:199], a[124:127], v[216:219]
  ds_read_b64_tr_b16 a[194:195], v233 offset:38912
  s_load_dwordx2 s[66:67], s[36:37], 0xc0000
  s_waitcnt lgkmcnt(13)
  v_mfma_f32_16x16x32_bf16 v[220:223], a[200:203], a[108:111], v[220:223]
  ds_read_b64_tr_b16 a[196:197], v234 offset:12288
  v_mfma_f32_16x16x32_bf16 v[220:223], a[204:207], a[124:127], v[220:223]
  ds_read_b64_tr_b16 a[198:199], v234 offset:14336
  v_mfma_f32_16x16x32_bf16 v[188:191], a[200:203], a[104:107], v[188:191]
  v_mfma_f32_16x16x32_bf16 v[188:191], a[204:207], a[120:123], v[188:191]
  v_mfma_f32_16x16x32_bf16 v[156:159], a[200:203], a[100:103], v[156:159]
  v_mfma_f32_16x16x32_bf16 v[156:159], a[204:207], a[116:119], v[156:159]
  v_mfma_f32_16x16x32_bf16 v[124:127], a[200:203], a[96:99], v[124:127]
  ds_read_b64_tr_b16 a[200:201], v234 offset:8192
  v_mfma_f32_16x16x32_bf16 v[124:127], a[204:207], a[112:115], v[124:127]
  ds_read_b64_tr_b16 a[202:203], v234 offset:10240
  s_mov_b32 s40, 11534336
  v_mfma_f32_16x16x32_bf16 v[0:3], a[208:211], a[128:131], v[0:3]
  buffer_load_dwordx4 a[0:3], v225, s[4:7], s40 offen offset:0 sc1
  s_waitcnt vmcnt(25) lgkmcnt(13)
  v_mfma_f32_16x16x32_bf16 v[0:3], a[212:215], a[144:147], v[0:3]
  ds_read_b64_tr_b16 a[204:205], v234 offset:20480
  ds_read_b64_tr_b16 a[206:207], v234 offset:22528
  v_mfma_f32_16x16x32_bf16 v[16:19], a[208:211], a[132:135], v[16:19]
  v_mfma_f32_16x16x32_bf16 v[16:19], a[212:215], a[148:151], v[16:19]
  v_mfma_f32_16x16x32_bf16 v[32:35], a[208:211], a[136:139], v[32:35]
  v_mfma_f32_16x16x32_bf16 v[32:35], a[212:215], a[152:155], v[32:35]
  buffer_load_dwordx4 a[4:7], v225, s[4:7], s40 offen offset:1024 sc1
  v_mfma_f32_16x16x32_bf16 v[48:51], a[208:211], a[140:143], v[48:51]
  ds_read_b64_tr_b16 a[208:209], v234 offset:36864
  v_mfma_f32_16x16x32_bf16 v[48:51], a[212:215], a[156:159], v[48:51]
  ds_read_b64_tr_b16 a[210:211], v234 offset:38912
  v_mfma_f32_16x16x32_bf16 v[52:55], a[216:219], a[140:143], v[52:55]
  ds_read_b64_tr_b16 a[212:213], v232 offset:32768
  s_waitcnt lgkmcnt(13)
  v_mfma_f32_16x16x32_bf16 v[52:55], a[220:223], a[156:159], v[52:55]
  ds_read_b64_tr_b16 a[214:215], v232 offset:34816
  v_mfma_f32_16x16x32_bf16 v[36:39], a[216:219], a[136:139], v[36:39]
  v_mfma_f32_16x16x32_bf16 v[36:39], a[220:223], a[152:155], v[36:39]
  buffer_load_dwordx4 a[8:11], v225, s[4:7], s40 offen offset:2048 sc1
  v_mfma_f32_16x16x32_bf16 v[20:23], a[216:219], a[132:135], v[20:23]
  v_mfma_f32_16x16x32_bf16 v[20:23], a[220:223], a[148:151], v[20:23]
  s_load_dwordx2 s[66:67], s[36:37], 0xe0000
  s_add_u32 s36, s36, 0x100000
  s_addc_u32 s37, s37, 0
  v_mfma_f32_16x16x32_bf16 v[4:7], a[216:219], a[128:131], v[4:7]
  ds_read_b64_tr_b16 a[216:217], v232 offset:45056
  v_mfma_f32_16x16x32_bf16 v[4:7], a[220:223], a[144:147], v[4:7]
  ds_read_b64_tr_b16 a[218:219], v232 offset:47104
  v_mfma_f32_16x16x32_bf16 v[8:11], a[224:227], a[128:131], v[8:11]
  ds_read_b64_tr_b16 a[220:221], v233 offset:32768
  v_mfma_f32_16x16x32_bf16 v[8:11], a[228:231], a[144:147], v[8:11]
  s_waitcnt vmcnt(24)
  s_barrier
  v_mfma_f32_16x16x32_bf16 v[24:27], a[224:227], a[132:135], v[24:27]
  buffer_load_dwordx4 a[12:15], v225, s[4:7], s40 offen offset:3072 sc1
  v_mfma_f32_16x16x32_bf16 v[24:27], a[228:231], a[148:151], v[24:27]
  ds_read_b64_tr_b16 a[222:223], v233 offset:34816
  s_mov_b32 s41, 3670016
  v_mfma_f32_16x16x32_bf16 v[40:43], a[224:227], a[136:139], v[40:43]
  s_add_u32 m0, s42, 36864
  v_mfma_f32_16x16x32_bf16 v[40:43], a[228:231], a[152:155], v[40:43]
  v_mfma_f32_16x16x32_bf16 v[56:59], a[224:227], a[140:143], v[56:59]
  ds_read_b64_tr_b16 a[224:225], v233 offset:45056
  v_mfma_f32_16x16x32_bf16 v[56:59], a[228:231], a[156:159], v[56:59]
  buffer_load_dwordx4 v226, s[12:15], s41 offen offset:0 lds
  s_waitcnt lgkmcnt(13)
  v_mfma_f32_16x16x32_bf16 v[60:63], a[232:235], a[140:143], v[60:63]
  ds_read_b64_tr_b16 a[226:227], v233 offset:47104
  s_mov_b32 s41, 3899392
  v_mfma_f32_16x16x32_bf16 v[60:63], a[192:195], a[156:159], v[60:63]
  ds_read_b64_tr_b16 a[228:229], v234 offset:32768
  ds_read_b64_tr_b16 a[230:231], v234 offset:34816
  v_mfma_f32_16x16x32_bf16 v[44:47], a[232:235], a[136:139], v[44:47]
  s_add_u32 m0, s42, 49152
  v_mfma_f32_16x16x32_bf16 v[44:47], a[192:195], a[152:155], v[44:47]
  v_mfma_f32_16x16x32_bf16 v[28:31], a[232:235], a[132:135], v[28:31]
  v_mfma_f32_16x16x32_bf16 v[28:31], a[192:195], a[148:151], v[28:31]
  buffer_load_dwordx4 v226, s[12:15], s41 offen offset:0 lds
  v_mfma_f32_16x16x32_bf16 v[12:15], a[232:235], a[128:131], v[12:15]
  ds_read_b64_tr_b16 a[232:233], v234 offset:45056
  s_mov_b32 s40, 11665408
  v_mfma_f32_16x16x32_bf16 v[12:15], a[192:195], a[144:147], v[12:15]
  ds_read_b64_tr_b16 a[234:235], v234 offset:47104
  v_mfma_f32_16x16x32_bf16 v[64:67], a[196:199], a[128:131], v[64:67]
  ds_read_b64_tr_b16 a[192:193], v235 offset:32768
  s_waitcnt lgkmcnt(13)
  v_mfma_f32_16x16x32_bf16 v[64:67], a[200:203], a[144:147], v[64:67]
  ds_read_b64_tr_b16 a[194:195], v235 offset:34816
  v_mfma_f32_16x16x32_bf16 v[72:75], a[196:199], a[132:135], v[72:75]
  v_mfma_f32_16x16x32_bf16 v[72:75], a[200:203], a[148:151], v[72:75]
  buffer_load_dwordx4 a[16:19], v225, s[4:7], s40 offen offset:0 sc1
  s_load_dwordx2 s[66:67], s[36:37], 0x0
  v_mfma_f32_16x16x32_bf16 v[80:83], a[196:199], a[136:139], v[80:83]
  v_mfma_f32_16x16x32_bf16 v[80:83], a[200:203], a[152:155], v[80:83]
  v_mfma_f32_16x16x32_bf16 v[88:91], a[196:199], a[140:143], v[88:91]
  ds_read_b64_tr_b16 a[196:197], v235 offset:45056
  v_mfma_f32_16x16x32_bf16 v[88:91], a[200:203], a[156:159], v[88:91]
  ds_read_b64_tr_b16 a[198:199], v235 offset:47104
  v_mfma_f32_16x16x32_bf16 v[92:95], a[204:207], a[140:143], v[92:95]
  ds_read_b64_tr_b16 a[200:201], v232 offset:61440
  v_mfma_f32_16x16x32_bf16 v[92:95], a[208:211], a[156:159], v[92:95]
  buffer_load_dwordx4 a[20:23], v225, s[4:7], s40 offen offset:1024 sc1
  v_mfma_f32_16x16x32_bf16 v[84:87], a[204:207], a[136:139], v[84:87]
  ds_read_b64_tr_b16 a[202:203], v232 offset:63488
  v_mfma_f32_16x16x32_bf16 v[84:87], a[208:211], a[152:155], v[84:87]
  v_mfma_f32_16x16x32_bf16 v[76:79], a[204:207], a[132:135], v[76:79]
  v_mfma_f32_16x16x32_bf16 v[76:79], a[208:211], a[148:151], v[76:79]
  v_mfma_f32_16x16x32_bf16 v[68:71], a[204:207], a[128:131], v[68:71]
  ds_read_b64_tr_b16 a[204:205], v232 offset:57344
  v_mfma_f32_16x16x32_bf16 v[68:71], a[208:211], a[144:147], v[68:71]
  buffer_load_dwordx4 a[24:27], v225, s[4:7], s40 offen offset:2048 sc1
  s_waitcnt lgkmcnt(13)
  v_mfma_f32_16x16x32_bf16 v[96:99], a[212:215], a[128:131], v[96:99]
  ds_read_b64_tr_b16 a[206:207], v232 offset:59392
L_wk1_3:
  s_cbranch_vccnz L_wk1_7
  v_mfma_f32_16x16x32_bf16 v[96:99], a[216:219], a[144:147], v[96:99]
  ds_read_b64_tr_b16 a[208:209], v233 offset:61440
  ds_read_b64_tr_b16 a[210:211], v233 offset:63488
  v_mfma_f32_16x16x32_bf16 v[128:131], a[212:215], a[132:135], v[128:131]
  v_mfma_f32_16x16x32_bf16 v[128:131], a[216:219], a[148:151], v[128:131]
  v_mfma_f32_16x16x32_bf16 v[160:163], a[212:215], a[136:139], v[160:163]
  v_mfma_f32_16x16x32_bf16 v[160:163], a[216:219], a[152:155], v[160:163]
  buffer_load_dwordx4 a[28:31], v225, s[4:7], s40 offen offset:3072 sc1
  v_mfma_f32_16x16x32_bf16 v[192:195], a[212:215], a[140:143], v[192:195]
  ds_read_b64_tr_b16 a[212:213], v233 offset:57344
  s_mov_b32 s41, 3670016
  v_mfma_f32_16x16x32_bf16 v[192:195], a[216:219], a[156:159], v[192:195]
  ds_read_b64_tr_b16 a[214:215], v233 offset:59392
  s_add_u32 m0, s42, 32768
  v_mfma_f32_16x16x32_bf16 v[196:199], a[220:223], a[140:143], v[196:199]
  ds_read_b64_tr_b16 a[216:217], v234 offset:61440
  s_waitcnt lgkmcnt(13)
  v_mfma_f32_16x16x32_bf16 v[196:199], a[224:227], a[156:159], v[196:199]
  ds_read_b64_tr_b16 a[218:219], v234 offset:63488
  s_load_dwordx2 s[66:67], s[36:37], 0x20000
  v_mfma_f32_16x16x32_bf16 v[164:167], a[220:223], a[136:139], v[164:167]
  v_mfma_f32_16x16x32_bf16 v[164:167], a[224:227], a[152:155], v[164:167]
  buffer_load_dwordx4 v226, s[16:19], s41 offen offset:0 lds
  v_mfma_f32_16x16x32_bf16 v[132:135], a[220:223], a[132:135], v[132:135]
  s_mov_b32 s41, 3899392
  s_add_u32 m0, s42, 40960
  v_mfma_f32_16x16x32_bf16 v[132:135], a[224:227], a[148:151], v[132:135]
  v_mfma_f32_16x16x32_bf16 v[100:103], a[220:223], a[128:131], v[100:103]
  ds_read_b64_tr_b16 a[220:221], v234 offset:57344
  v_mfma_f32_16x16x32_bf16 v[100:103], a[224:227], a[144:147], v[100:103]
  ds_read_b64_tr_b16 a[222:223], v234 offset:59392
  v_mfma_f32_16x16x32_bf16 v[104:107], a[228:231], a[128:131], v[104:107]
  ds_read_b64_tr_b16 a[224:225], v235 offset:61440
  v_mfma_f32_16x16x32_bf16 v[104:107], a[232:235], a[144:147], v[104:107]
  buffer_load_dwordx4 v226, s[16:19], s41 offen offset:0 lds
  v_mfma_f32_16x16x32_bf16 v[136:139], a[228:231], a[132:135], v[136:139]
  ds_read_b64_tr_b16 a[226:227], v235 offset:63488
  v_mfma_f32_16x16x32_bf16 v[136:139], a[232:235], a[148:151], v[136:139]
  v_mfma_f32_16x16x32_bf16 v[168:171], a[228:231], a[136:139], v[168:171]
  v_mfma_f32_16x16x32_bf16 v[168:171], a[232:235], a[152:155], v[168:171]
  v_mfma_f32_16x16x32_bf16 v[200:203], a[228:231], a[140:143], v[200:203]
  ds_read_b64_tr_b16 a[228:229], v235 offset:57344
  v_mfma_f32_16x16x32_bf16 v[200:203], a[232:235], a[156:159], v[200:203]
  ds_read_b64_tr_b16 a[230:231], v235 offset:59392
  s_mov_b32 s41, 4128768
  s_waitcnt lgkmcnt(13)
  v_mfma_f32_16x16x32_bf16 v[204:207], a[192:195], a[140:143], v[204:207]
  ds_read_b64_tr_b16 a[232:233], v236 offset:4096
  s_add_u32 m0, s42, 53248
  v_mfma_f32_16x16x32_bf16 v[204:207], a[196:199], a[156:159], v[204:207]
  s_waitcnt vmcnt(23)
  s_barrier
  v_mfma_f32_16x16x32_bf16 v[172:175], a[192:195], a[136:139], v[172:175]
  buffer_load_dwordx4 v227, s[12:15], s41 offen offset:0 lds
  v_mfma_f32_16x16x32_bf16 v[172:175], a[196:199], a[152:155], v[172:175]
  ds_read_b64_tr_b16 a[234:235], v236 offset:6144
  v_mfma_f32_16x16x32_bf16 v[140:143], a[192:195], a[132:135], v[140:143]
  v_mfma_f32_16x16x32_bf16 v[140:143], a[196:199], a[148:151], v[140:143]
  v_mfma_f32_16x16x32_bf16 v[108:111], a[192:195], a[128:131], v[108:111]
  ds_read_b64_tr_b16 a[192:193], v236 offset:20480
  s_mov_b32 s41, 4358144
  v_mfma_f32_16x16x32_bf16 v[108:111], a[196:199], a[144:147], v[108:111]
  ds_read_b64_tr_b16 a[194:195], v236 offset:22528
  s_add_u32 m0, s42, 57344
  s_load_dwordx2 s[66:67], s[36:37], 0x40000
  v_mfma_f32_16x16x32_bf16 v[112:115], a[200:203], a[128:131], v[112:115]
  buffer_load_dwordx4 v227, s[12:15], s41 offen offset:0 lds
  s_waitcnt lgkmcnt(13)
  v_mfma_f32_16x16x32_bf16 v[112:115], a[204:207], a[144:147], v[112:115]
  ds_read_b64_tr_b16 a[196:197], v237 offset:4096
  ds_read_b64_tr_b16 a[198:199], v237 offset:6144
  v_mfma_f32_16x16x32_bf16 v[144:147], a[200:203], a[132:135], v[144:147]
  v_mfma_f32_16x16x32_bf16 v[144:147], a[204:207], a[148:151], v[144:147]
  v_mfma_f32_16x16x32_bf16 v[176:179], a[200:203], a[136:139], v[176:179]
  v_mfma_f32_16x16x32_bf16 v[176:179], a[204:207], a[152:155], v[176:179]
  v_mfma_f32_16x16x32_bf16 v[208:211], a[200:203], a[140:143], v[208:211]
  ds_read_b64_tr_b16 a[200:201], v237 offset:20480
  v_mfma_f32_16x16x32_bf16 v[208:211], a[204:207], a[156:159], v[208:211]
  ds_read_b64_tr_b16 a[202:203], v237 offset:22528
  s_mov_b32 s41, 4128768
  v_mfma_f32_16x16x32_bf16 v[212:215], a[208:211], a[140:143], v[212:215]
  ds_read_b64_tr_b16 a[204:205], v236 offset:16384
  s_add_u32 m0, s42, 65536
  s_waitcnt lgkmcnt(13)
  v_mfma_f32_16x16x32_bf16 v[212:215], a[212:215], a[156:159], v[212:215]
  buffer_load_dwordx4 v227, s[16:19], s41 offen offset:0 lds
  v_mfma_f32_16x16x32_bf16 v[180:183], a[208:211], a[136:139], v[180:183]
  ds_read_b64_tr_b16 a[206:207], v236 offset:18432
  s_mov_b32 s78, 6291456
  v_mfma_f32_16x16x32_bf16 v[180:183], a[212:215], a[152:155], v[180:183]
  buffer_load_dword v241, v247, s[56:59], s78 offen
  v_mfma_f32_16x16x32_bf16 v[148:151], a[208:211], a[132:135], v[148:151]
  v_mfma_f32_16x16x32_bf16 v[148:151], a[212:215], a[148:151], v[148:151]
  v_mfma_f32_16x16x32_bf16 v[116:119], a[208:211], a[128:131], v[116:119]
  ds_read_b64_tr_b16 a[208:209], v236 offset:28672
  s_mov_b32 s41, 4358144
  v_mfma_f32_16x16x32_bf16 v[116:119], a[212:215], a[144:147], v[116:119]
  ds_read_b64_tr_b16 a[210:211], v236 offset:30720
  s_add_u32 m0, s42, 94208
  v_mfma_f32_16x16x32_bf16 v[120:123], a[216:219], a[128:131], v[120:123]
  buffer_load_dwordx4 v227, s[16:19], s41 offen offset:0 lds
  v_mfma_f32_16x16x32_bf16 v[120:123], a[220:223], a[144:147], v[120:123]
  ds_read_b64_tr_b16 a[212:213], v237 offset:16384
  ds_read_b64_tr_b16 a[214:215], v237 offset:18432
  v_mfma_f32_16x16x32_bf16 v[152:155], a[216:219], a[132:135], v[152:155]
  v_mfma_f32_16x16x32_bf16 v[152:155], a[220:223], a[148:151], v[152:155]
  v_mfma_f32_16x16x32_bf16 v[184:187], a[216:219], a[136:139], v[184:187]
  v_mfma_f32_16x16x32_bf16 v[184:187], a[220:223], a[152:155], v[184:187]
  s_load_dwordx2 s[66:67], s[36:37], 0x60000
  v_mfma_f32_16x16x32_bf16 v[216:219], a[216:219], a[140:143], v[216:219]
  ds_read_b64_tr_b16 a[216:217], v237 offset:28672
  v_mfma_f32_16x16x32_bf16 v[216:219], a[220:223], a[156:159], v[216:219]
  ds_read_b64_tr_b16 a[218:219], v237 offset:30720
  s_waitcnt lgkmcnt(13)
  v_mfma_f32_16x16x32_bf16 v[220:223], a[224:227], a[140:143], v[220:223]
  ds_read_b64_tr_b16 a[220:221], v238 offset:4096
  v_mfma_f32_16x16x32_bf16 v[220:223], a[228:231], a[156:159], v[220:223]
  ds_read_b64_tr_b16 a[222:223], v238 offset:6144
  v_mfma_f32_16x16x32_bf16 v[188:191], a[224:227], a[136:139], v[188:191]
  v_mfma_f32_16x16x32_bf16 v[188:191], a[228:231], a[152:155], v[188:191]
  v_mfma_f32_16x16x32_bf16 v[156:159], a[224:227], a[132:135], v[156:159]
  v_mfma_f32_16x16x32_bf16 v[156:159], a[228:231], a[148:151], v[156:159]
  v_mfma_f32_16x16x32_bf16 v[124:127], a[224:227], a[128:131], v[124:127]
  ds_read_b64_tr_b16 a[224:225], v238 offset:20480
  v_mfma_f32_16x16x32_bf16 v[124:127], a[228:231], a[144:147], v[124:127]
  ds_read_b64_tr_b16 a[226:227], v238 offset:22528
  s_mov_b32 s40, 11796480
  v_mfma_f32_16x16x32_bf16 v[0:3], a[232:235], a[160:163], v[0:3]
  buffer_load_dwordx4 a[32:35], v225, s[4:7], s40 offen offset:0 sc1
  s_waitcnt vmcnt(25) lgkmcnt(13)
  v_mfma_f32_16x16x32_bf16 v[0:3], a[192:195], a[176:179], v[0:3]
  ds_read_b64_tr_b16 a[228:229], v238 offset:16384
  ds_read_b64_tr_b16 a[230:231], v238 offset:18432
  v_mfma_f32_16x16x32_bf16 v[16:19], a[232:235], a[164:167], v[16:19]
  v_mfma_f32_16x16x32_bf16 v[16:19], a[192:195], a[180:183], v[16:19]
  v_mfma_f32_16x16x32_bf16 v[32:35], a[232:235], a[168:171], v[32:35]
  v_mfma_f32_16x16x32_bf16 v[32:35], a[192:195], a[184:187], v[32:35]
  buffer_load_dwordx4 a[36:39], v225, s[4:7], s40 offen offset:1024 sc1
  v_mfma_f32_16x16x32_bf16 v[48:51], a[232:235], a[172:175], v[48:51]
  ds_read_b64_tr_b16 a[232:233], v238 offset:28672
  v_mfma_f32_16x16x32_bf16 v[48:51], a[192:195], a[188:191], v[48:51]
  ds_read_b64_tr_b16 a[234:235], v238 offset:30720
  v_mfma_f32_16x16x32_bf16 v[52:55], a[196:199], a[172:175], v[52:55]
  ds_read_b64_tr_b16 a[192:193], v228 offset:16384
  s_waitcnt lgkmcnt(13)
  v_mfma_f32_16x16x32_bf16 v[52:55], a[200:203], a[188:191], v[52:55]
  ds_read_b64_tr_b16 a[194:195], v228 offset:18432
  v_mfma_f32_16x16x32_bf16 v[36:39], a[196:199], a[168:171], v[36:39]
  v_mfma_f32_16x16x32_bf16 v[36:39], a[200:203], a[184:187], v[36:39]
  buffer_load_dwordx4 a[40:43], v225, s[4:7], s40 offen offset:2048 sc1
  s_load_dwordx2 s[66:67], s[36:37], 0x80000
  v_mfma_f32_16x16x32_bf16 v[20:23], a[196:199], a[164:167], v[20:23]
  v_mfma_f32_16x16x32_bf16 v[20:23], a[200:203], a[180:183], v[20:23]
  v_mfma_f32_16x16x32_bf16 v[4:7], a[196:199], a[160:163], v[4:7]
  ds_read_b64_tr_b16 a[196:197], v228 offset:28672
  v_mfma_f32_16x16x32_bf16 v[4:7], a[200:203], a[176:179], v[4:7]
  ds_read_b64_tr_b16 a[198:199], v228 offset:30720
  v_mfma_f32_16x16x32_bf16 v[8:11], a[204:207], a[160:163], v[8:11]
  ds_read_b64_tr_b16 a[200:201], v229 offset:16384
  v_mfma_f32_16x16x32_bf16 v[8:11], a[208:211], a[176:179], v[8:11]
  s_waitcnt vmcnt(24)
  s_barrier
  v_mfma_f32_16x16x32_bf16 v[24:27], a[204:207], a[164:167], v[24:27]
  buffer_load_dwordx4 a[44:47], v225, s[4:7], s40 offen offset:3072 sc1
  v_mfma_f32_16x16x32_bf16 v[24:27], a[208:211], a[180:183], v[24:27]
  ds_read_b64_tr_b16 a[202:203], v229 offset:18432
  s_mov_b32 s41, 4128768
  v_mfma_f32_16x16x32_bf16 v[40:43], a[204:207], a[168:171], v[40:43]
  s_add_u32 m0, s42, 106496
  v_mfma_f32_16x16x32_bf16 v[40:43], a[208:211], a[184:187], v[40:43]
  v_mfma_f32_16x16x32_bf16 v[56:59], a[204:207], a[172:175], v[56:59]
  ds_read_b64_tr_b16 a[204:205], v229 offset:28672
  v_mfma_f32_16x16x32_bf16 v[56:59], a[208:211], a[188:191], v[56:59]
  buffer_load_dwordx4 v226, s[12:15], s41 offen offset:0 lds
  s_waitcnt lgkmcnt(13)
  v_mfma_f32_16x16x32_bf16 v[60:63], a[212:215], a[172:175], v[60:63]
  ds_read_b64_tr_b16 a[206:207], v229 offset:30720
  s_mov_b32 s41, 4358144
  v_mfma_f32_16x16x32_bf16 v[60:63], a[216:219], a[188:191], v[60:63]
  ds_read_b64_tr_b16 a[208:209], v230 offset:16384
  ds_read_b64_tr_b16 a[210:211], v230 offset:18432
  v_mfma_f32_16x16x32_bf16 v[44:47], a[212:215], a[168:171], v[44:47]
  s_add_u32 m0, s42, 114688
  v_mfma_f32_16x16x32_bf16 v[44:47], a[216:219], a[184:187], v[44:47]
  v_mfma_f32_16x16x32_bf16 v[28:31], a[212:215], a[164:167], v[28:31]
  v_mfma_f32_16x16x32_bf16 v[28:31], a[216:219], a[180:183], v[28:31]
  buffer_load_dwordx4 v226, s[12:15], s41 offen offset:0 lds
  v_mfma_f32_16x16x32_bf16 v[12:15], a[212:215], a[160:163], v[12:15]
  ds_read_b64_tr_b16 a[212:213], v230 offset:28672
  s_mov_b32 s40, 11927552
  v_mfma_f32_16x16x32_bf16 v[12:15], a[216:219], a[176:179], v[12:15]
  ds_read_b64_tr_b16 a[214:215], v230 offset:30720
  v_mfma_f32_16x16x32_bf16 v[64:67], a[220:223], a[160:163], v[64:67]
  ds_read_b64_tr_b16 a[216:217], v231 offset:16384
  s_waitcnt lgkmcnt(13)
  v_mfma_f32_16x16x32_bf16 v[64:67], a[224:227], a[176:179], v[64:67]
  ds_read_b64_tr_b16 a[218:219], v231 offset:18432
  s_load_dwordx2 s[66:67], s[36:37], 0xa0000
  v_mfma_f32_16x16x32_bf16 v[72:75], a[220:223], a[164:167], v[72:75]
  v_mfma_f32_16x16x32_bf16 v[72:75], a[224:227], a[180:183], v[72:75]
  buffer_load_dwordx4 a[48:51], v225, s[4:7], s40 offen offset:0 sc1
  v_mfma_f32_16x16x32_bf16 v[80:83], a[220:223], a[168:171], v[80:83]
  v_mfma_f32_16x16x32_bf16 v[80:83], a[224:227], a[184:187], v[80:83]
  v_mfma_f32_16x16x32_bf16 v[88:91], a[220:223], a[172:175], v[88:91]
  ds_read_b64_tr_b16 a[220:221], v231 offset:28672
  v_mfma_f32_16x16x32_bf16 v[88:91], a[224:227], a[188:191], v[88:91]
  ds_read_b64_tr_b16 a[222:223], v231 offset:30720
  v_mfma_f32_16x16x32_bf16 v[92:95], a[228:231], a[172:175], v[92:95]
  ds_read_b64_tr_b16 a[224:225], v236 offset:8192
  v_mfma_f32_16x16x32_bf16 v[92:95], a[232:235], a[188:191], v[92:95]
  buffer_load_dwordx4 a[52:55], v225, s[4:7], s40 offen offset:1024 sc1
  v_mfma_f32_16x16x32_bf16 v[84:87], a[228:231], a[168:171], v[84:87]
  ds_read_b64_tr_b16 a[226:227], v236 offset:10240
  v_mfma_f32_16x16x32_bf16 v[84:87], a[232:235], a[184:187], v[84:87]
  v_mfma_f32_16x16x32_bf16 v[76:79], a[228:231], a[164:167], v[76:79]
  v_mfma_f32_16x16x32_bf16 v[76:79], a[232:235], a[180:183], v[76:79]
  v_mfma_f32_16x16x32_bf16 v[68:71], a[228:231], a[160:163], v[68:71]
  ds_read_b64_tr_b16 a[228:229], v236 offset:24576
  v_mfma_f32_16x16x32_bf16 v[68:71], a[232:235], a[176:179], v[68:71]
  buffer_load_dwordx4 a[56:59], v225, s[4:7], s40 offen offset:2048 sc1
  s_waitcnt lgkmcnt(13)
  v_mfma_f32_16x16x32_bf16 v[96:99], a[192:195], a[160:163], v[96:99]
  ds_read_b64_tr_b16 a[230:231], v236 offset:26624
  v_mfma_f32_16x16x32_bf16 v[96:99], a[196:199], a[176:179], v[96:99]
  ds_read_b64_tr_b16 a[232:233], v237 offset:8192
  ds_read_b64_tr_b16 a[234:235], v237 offset:10240
  v_mfma_f32_16x16x32_bf16 v[128:131], a[192:195], a[164:167], v[128:131]
  v_mfma_f32_16x16x32_bf16 v[128:131], a[196:199], a[180:183], v[128:131]
  v_mfma_f32_16x16x32_bf16 v[160:163], a[192:195], a[168:171], v[160:163]
  v_mfma_f32_16x16x32_bf16 v[160:163], a[196:199], a[184:187], v[160:163]
  buffer_load_dwordx4 a[60:63], v225, s[4:7], s40 offen offset:3072 sc1
  v_mfma_f32_16x16x32_bf16 v[192:195], a[192:195], a[172:175], v[192:195]
  ds_read_b64_tr_b16 a[192:193], v237 offset:24576
  s_mov_b32 s41, 4128768
  v_mfma_f32_16x16x32_bf16 v[192:195], a[196:199], a[188:191], v[192:195]
  ds_read_b64_tr_b16 a[194:195], v237 offset:26624
  s_add_u32 m0, s42, 143360
  s_load_dwordx2 s[66:67], s[36:37], 0xc0000
  v_mfma_f32_16x16x32_bf16 v[196:199], a[200:203], a[172:175], v[196:199]
  ds_read_b64_tr_b16 a[196:197], v238 offset:8192
  s_waitcnt lgkmcnt(13)
  v_mfma_f32_16x16x32_bf16 v[196:199], a[204:207], a[188:191], v[196:199]
  ds_read_b64_tr_b16 a[198:199], v238 offset:10240
  v_mfma_f32_16x16x32_bf16 v[164:167], a[200:203], a[168:171], v[164:167]
  v_mfma_f32_16x16x32_bf16 v[164:167], a[204:207], a[184:187], v[164:167]
  buffer_load_dwordx4 v226, s[16:19], s41 offen offset:0 lds
  v_mfma_f32_16x16x32_bf16 v[132:135], a[200:203], a[164:167], v[132:135]
  s_mov_b32 s41, 4358144
  s_add_u32 m0, s42, 69632
  v_mfma_f32_16x16x32_bf16 v[132:135], a[204:207], a[180:183], v[132:135]
  v_mfma_f32_16x16x32_bf16 v[100:103], a[200:203], a[160:163], v[100:103]
  ds_read_b64_tr_b16 a[200:201], v238 offset:24576
  v_mfma_f32_16x16x32_bf16 v[100:103], a[204:207], a[176:179], v[100:103]
  ds_read_b64_tr_b16 a[202:203], v238 offset:26624
  v_mfma_f32_16x16x32_bf16 v[104:107], a[208:211], a[160:163], v[104:107]
  ds_read_b64_tr_b16 a[204:205], v239 offset:8192
  v_mfma_f32_16x16x32_bf16 v[104:107], a[212:215], a[176:179], v[104:107]
  buffer_load_dwordx4 v226, s[16:19], s41 offen offset:0 lds
  v_mfma_f32_16x16x32_bf16 v[136:139], a[208:211], a[164:167], v[136:139]
  ds_read_b64_tr_b16 a[206:207], v239 offset:10240
  v_mfma_f32_16x16x32_bf16 v[136:139], a[212:215], a[180:183], v[136:139]
  v_mfma_f32_16x16x32_bf16 v[168:171], a[208:211], a[168:171], v[168:171]
  v_mfma_f32_16x16x32_bf16 v[168:171], a[212:215], a[184:187], v[168:171]
  v_mfma_f32_16x16x32_bf16 v[200:203], a[208:211], a[172:175], v[200:203]
  ds_read_b64_tr_b16 a[208:209], v239 offset:24576
  v_mfma_f32_16x16x32_bf16 v[200:203], a[212:215], a[188:191], v[200:203]
  ds_read_b64_tr_b16 a[210:211], v239 offset:26624
  s_mov_b32 s41, 4587520
  s_waitcnt lgkmcnt(13)
  v_mfma_f32_16x16x32_bf16 v[204:207], a[216:219], a[172:175], v[204:207]
  ds_read_b64_tr_b16 a[212:213], v228 offset:20480
  s_add_u32 m0, s42, 81920
  v_mfma_f32_16x16x32_bf16 v[204:207], a[220:223], a[188:191], v[204:207]
  s_waitcnt vmcnt(23)
  s_barrier
  v_mfma_f32_16x16x32_bf16 v[172:175], a[216:219], a[168:171], v[172:175]
  buffer_load_dwordx4 v227, s[12:15], s41 offen offset:0 lds
  v_mfma_f32_16x16x32_bf16 v[172:175], a[220:223], a[184:187], v[172:175]
  ds_read_b64_tr_b16 a[214:215], v228 offset:22528
  s_mov_b32 s78, 6815744
  v_mfma_f32_16x16x32_bf16 v[140:143], a[216:219], a[164:167], v[140:143]
  buffer_load_dword v241, v247, s[56:59], s78 offen
  v_mfma_f32_16x16x32_bf16 v[140:143], a[220:223], a[180:183], v[140:143]
  s_load_dwordx2 s[66:67], s[36:37], 0xe0000
  s_add_u32 s36, s36, 0x100000
  s_addc_u32 s37, s37, 0
  v_mfma_f32_16x16x32_bf16 v[108:111], a[216:219], a[160:163], v[108:111]
  ds_read_b64_tr_b16 a[216:217], v228 offset:12288
  s_mov_b32 s41, 4816896
  v_mfma_f32_16x16x32_bf16 v[108:111], a[220:223], a[176:179], v[108:111]
  ds_read_b64_tr_b16 a[218:219], v228 offset:14336
  s_add_u32 m0, s42, 61440
  v_mfma_f32_16x16x32_bf16 v[112:115], a[224:227], a[160:163], v[112:115]
  buffer_load_dwordx4 v227, s[12:15], s41 offen offset:0 lds
  s_waitcnt lgkmcnt(13)
  v_mfma_f32_16x16x32_bf16 v[112:115], a[228:231], a[176:179], v[112:115]
  ds_read_b64_tr_b16 a[220:221], v229 offset:20480
  ds_read_b64_tr_b16 a[222:223], v229 offset:22528
  v_mfma_f32_16x16x32_bf16 v[144:147], a[224:227], a[164:167], v[144:147]
  v_mfma_f32_16x16x32_bf16 v[144:147], a[228:231], a[180:183], v[144:147]
  v_mfma_f32_16x16x32_bf16 v[176:179], a[224:227], a[168:171], v[176:179]
  v_mfma_f32_16x16x32_bf16 v[176:179], a[228:231], a[184:187], v[176:179]
  v_mfma_f32_16x16x32_bf16 v[208:211], a[224:227], a[172:175], v[208:211]
  ds_read_b64_tr_b16 a[224:225], v229 offset:12288
  v_mfma_f32_16x16x32_bf16 v[208:211], a[228:231], a[188:191], v[208:211]
  ds_read_b64_tr_b16 a[226:227], v229 offset:14336
  s_mov_b32 s41, 4587520
  v_mfma_f32_16x16x32_bf16 v[212:215], a[232:235], a[172:175], v[212:215]
  ds_read_b64_tr_b16 a[228:229], v228 offset:24576
  s_add_u32 m0, s42, 90112
  s_waitcnt lgkmcnt(13)
  v_mfma_f32_16x16x32_bf16 v[212:215], a[192:195], a[188:191], v[212:215]
  buffer_load_dwordx4 v227, s[16:19], s41 offen offset:0 lds
  v_mfma_f32_16x16x32_bf16 v[180:183], a[232:235], a[168:171], v[180:183]
  ds_read_b64_tr_b16 a[230:231], v228 offset:26624
  v_mfma_f32_16x16x32_bf16 v[180:183], a[192:195], a[184:187], v[180:183]
  v_mfma_f32_16x16x32_bf16 v[148:151], a[232:235], a[164:167], v[148:151]
  v_mfma_f32_16x16x32_bf16 v[148:151], a[192:195], a[180:183], v[148:151]
  v_mfma_f32_16x16x32_bf16 v[116:119], a[232:235], a[160:163], v[116:119]
  ds_read_b64_tr_b16 a[232:233], v228 offset:45056
  s_mov_b32 s41, 4816896
  v_mfma_f32_16x16x32_bf16 v[116:119], a[192:195], a[176:179], v[116:119]
  ds_read_b64_tr_b16 a[234:235], v228 offset:47104
  s_add_u32 m0, s42, 118784
  v_mfma_f32_16x16x32_bf16 v[120:123], a[196:199], a[160:163], v[120:123]
  buffer_load_dwordx4 v227, s[16:19], s41 offen offset:0 lds
  v_mfma_f32_16x16x32_bf16 v[120:123], a[200:203], a[176:179], v[120:123]
  ds_read_b64_tr_b16 a[192:193], v229 offset:24576
  ds_read_b64_tr_b16 a[194:195], v229 offset:26624
  v_mfma_f32_16x16x32_bf16 v[152:155], a[196:199], a[164:167], v[152:155]
  v_mfma_f32_16x16x32_bf16 v[152:155], a[200:203], a[180:183], v[152:155]
  s_load_dwordx2 s[66:67], s[36:37], 0x0
  v_mfma_f32_16x16x32_bf16 v[184:187], a[196:199], a[168:171], v[184:187]
  v_mfma_f32_16x16x32_bf16 v[184:187], a[200:203], a[184:187], v[184:187]
  v_mfma_f32_16x16x32_bf16 v[216:219], a[196:199], a[172:175], v[216:219]
  ds_read_b64_tr_b16 a[196:197], v229 offset:45056
  v_mfma_f32_16x16x32_bf16 v[216:219], a[200:203], a[188:191], v[216:219]
  ds_read_b64_tr_b16 a[198:199], v229 offset:47104
  s_waitcnt lgkmcnt(13)
  v_mfma_f32_16x16x32_bf16 v[220:223], a[204:207], a[172:175], v[220:223]
  ds_read_b64_tr_b16 a[200:201], v230 offset:20480
  v_mfma_f32_16x16x32_bf16 v[220:223], a[208:211], a[188:191], v[220:223]
  ds_read_b64_tr_b16 a[202:203], v230 offset:22528
  v_mfma_f32_16x16x32_bf16 v[188:191], a[204:207], a[168:171], v[188:191]
  v_mfma_f32_16x16x32_bf16 v[188:191], a[208:211], a[184:187], v[188:191]
  v_mfma_f32_16x16x32_bf16 v[156:159], a[204:207], a[164:167], v[156:159]
  v_mfma_f32_16x16x32_bf16 v[156:159], a[208:211], a[180:183], v[156:159]
  v_mfma_f32_16x16x32_bf16 v[124:127], a[204:207], a[160:163], v[124:127]
  ds_read_b64_tr_b16 a[204:205], v230 offset:12288
  v_mfma_f32_16x16x32_bf16 v[124:127], a[208:211], a[176:179], v[124:127]
  ds_read_b64_tr_b16 a[206:207], v230 offset:14336
  s_mov_b32 s40, 12058624
  v_mfma_f32_16x16x32_bf16 v[0:3], a[212:215], a[0:3], v[0:3]
  buffer_load_dwordx4 a[64:67], v225, s[4:7], s40 offen offset:0 sc1
  s_waitcnt vmcnt(25) lgkmcnt(13)
  v_mfma_f32_16x16x32_bf16 v[0:3], a[216:219], a[16:19], v[0:3]
  ds_read_b64_tr_b16 a[208:209], v230 offset:24576
  ds_read_b64_tr_b16 a[210:211], v230 offset:26624
  v_mfma_f32_16x16x32_bf16 v[16:19], a[212:215], a[4:7], v[16:19]
  v_mfma_f32_16x16x32_bf16 v[16:19], a[216:219], a[20:23], v[16:19]
  v_mfma_f32_16x16x32_bf16 v[32:35], a[212:215], a[8:11], v[32:35]
  v_mfma_f32_16x16x32_bf16 v[32:35], a[216:219], a[24:27], v[32:35]
  buffer_load_dwordx4 a[68:71], v225, s[4:7], s40 offen offset:1024 sc1
  v_mfma_f32_16x16x32_bf16 v[48:51], a[212:215], a[12:15], v[48:51]
  ds_read_b64_tr_b16 a[212:213], v230 offset:45056
  v_mfma_f32_16x16x32_bf16 v[48:51], a[216:219], a[28:31], v[48:51]
  ds_read_b64_tr_b16 a[214:215], v230 offset:47104
  v_mfma_f32_16x16x32_bf16 v[52:55], a[220:223], a[12:15], v[52:55]
  ds_read_b64_tr_b16 a[216:217], v228 offset:36864
  s_waitcnt lgkmcnt(13)
  v_mfma_f32_16x16x32_bf16 v[52:55], a[224:227], a[28:31], v[52:55]
  ds_read_b64_tr_b16 a[218:219], v228 offset:38912
  s_load_dwordx2 s[66:67], s[36:37], 0x20000
  v_mfma_f32_16x16x32_bf16 v[36:39], a[220:223], a[8:11], v[36:39]
  v_mfma_f32_16x16x32_bf16 v[36:39], a[224:227], a[24:27], v[36:39]
  buffer_load_dwordx4 a[72:75], v225, s[4:7], s40 offen offset:2048 sc1
  v_mfma_f32_16x16x32_bf16 v[20:23], a[220:223], a[4:7], v[20:23]
  v_mfma_f32_16x16x32_bf16 v[20:23], a[224:227], a[20:23], v[20:23]
  v_mfma_f32_16x16x32_bf16 v[4:7], a[220:223], a[0:3], v[4:7]
  ds_read_b64_tr_b16 a[220:221], v228 offset:49152
  v_mfma_f32_16x16x32_bf16 v[4:7], a[224:227], a[16:19], v[4:7]
  ds_read_b64_tr_b16 a[222:223], v228 offset:51200
  v_mfma_f32_16x16x32_bf16 v[8:11], a[228:231], a[0:3], v[8:11]
  ds_read_b64_tr_b16 a[224:225], v229 offset:36864
  v_mfma_f32_16x16x32_bf16 v[8:11], a[232:235], a[16:19], v[8:11]
  s_waitcnt vmcnt(24)
  s_barrier
  v_mfma_f32_16x16x32_bf16 v[24:27], a[228:231], a[4:7], v[24:27]
  buffer_load_dwordx4 a[76:79], v225, s[4:7], s40 offen offset:3072 sc1
  v_mfma_f32_16x16x32_bf16 v[24:27], a[232:235], a[20:23], v[24:27]
  ds_read_b64_tr_b16 a[226:227], v229 offset:38912
  s_mov_b32 s41, 4587520
  v_mfma_f32_16x16x32_bf16 v[40:43], a[228:231], a[8:11], v[40:43]
  s_add_u32 m0, s42, 131072
  v_mfma_f32_16x16x32_bf16 v[40:43], a[232:235], a[24:27], v[40:43]
  v_mfma_f32_16x16x32_bf16 v[56:59], a[228:231], a[12:15], v[56:59]
  ds_read_b64_tr_b16 a[228:229], v229 offset:49152
  v_mfma_f32_16x16x32_bf16 v[56:59], a[232:235], a[28:31], v[56:59]
  buffer_load_dwordx4 v226, s[12:15], s41 offen offset:0 lds
  s_waitcnt lgkmcnt(13)
  v_mfma_f32_16x16x32_bf16 v[60:63], a[192:195], a[12:15], v[60:63]
  ds_read_b64_tr_b16 a[230:231], v229 offset:51200
  s_mov_b32 s41, 4816896
  v_mfma_f32_16x16x32_bf16 v[60:63], a[196:199], a[28:31], v[60:63]
  ds_read_b64_tr_b16 a[232:233], v230 offset:36864
  ds_read_b64_tr_b16 a[234:235], v230 offset:38912
  v_mfma_f32_16x16x32_bf16 v[44:47], a[192:195], a[8:11], v[44:47]
  s_add_u32 m0, s42, 77824
  v_mfma_f32_16x16x32_bf16 v[44:47], a[196:199], a[24:27], v[44:47]
  v_mfma_f32_16x16x32_bf16 v[28:31], a[192:195], a[4:7], v[28:31]
  v_mfma_f32_16x16x32_bf16 v[28:31], a[196:199], a[20:23], v[28:31]
  buffer_load_dwordx4 v226, s[12:15], s41 offen offset:0 lds
  v_mfma_f32_16x16x32_bf16 v[12:15], a[192:195], a[0:3], v[12:15]
  ds_read_b64_tr_b16 a[192:193], v230 offset:49152
  s_mov_b32 s40, 12189696
  v_mfma_f32_16x16x32_bf16 v[12:15], a[196:199], a[16:19], v[12:15]
  ds_read_b64_tr_b16 a[194:195], v230 offset:51200
  s_load_dwordx2 s[66:67], s[36:37], 0x40000
  v_mfma_f32_16x16x32_bf16 v[64:67], a[200:203], a[0:3], v[64:67]
  ds_read_b64_tr_b16 a[196:197], v231 offset:36864
  s_waitcnt lgkmcnt(13)
  v_mfma_f32_16x16x32_bf16 v[64:67], a[204:207], a[16:19], v[64:67]
  ds_read_b64_tr_b16 a[198:199], v231 offset:38912
  v_mfma_f32_16x16x32_bf16 v[72:75], a[200:203], a[4:7], v[72:75]
  v_mfma_f32_16x16x32_bf16 v[72:75], a[204:207], a[20:23], v[72:75]
  buffer_load_dwordx4 a[80:83], v225, s[4:7], s40 offen offset:0 sc1
  v_mfma_f32_16x16x32_bf16 v[80:83], a[200:203], a[8:11], v[80:83]
  v_mfma_f32_16x16x32_bf16 v[80:83], a[204:207], a[24:27], v[80:83]
  v_mfma_f32_16x16x32_bf16 v[88:91], a[200:203], a[12:15], v[88:91]
  ds_read_b64_tr_b16 a[200:201], v231 offset:49152
  v_mfma_f32_16x16x32_bf16 v[88:91], a[204:207], a[28:31], v[88:91]
  ds_read_b64_tr_b16 a[202:203], v231 offset:51200
  v_mfma_f32_16x16x32_bf16 v[92:95], a[208:211], a[12:15], v[92:95]
  ds_read_b64_tr_b16 a[204:205], v228 offset:32768
  v_mfma_f32_16x16x32_bf16 v[92:95], a[212:215], a[28:31], v[92:95]
  buffer_load_dwordx4 a[84:87], v225, s[4:7], s40 offen offset:1024 sc1
  v_mfma_f32_16x16x32_bf16 v[84:87], a[208:211], a[8:11], v[84:87]
  ds_read_b64_tr_b16 a[206:207], v228 offset:34816
  v_mfma_f32_16x16x32_bf16 v[84:87], a[212:215], a[24:27], v[84:87]
  v_mfma_f32_16x16x32_bf16 v[76:79], a[208:211], a[4:7], v[76:79]
  v_mfma_f32_16x16x32_bf16 v[76:79], a[212:215], a[20:23], v[76:79]
  v_mfma_f32_16x16x32_bf16 v[68:71], a[208:211], a[0:3], v[68:71]
  ds_read_b64_tr_b16 a[208:209], v228 offset:40960
  v_mfma_f32_16x16x32_bf16 v[68:71], a[212:215], a[16:19], v[68:71]
  buffer_load_dwordx4 a[88:91], v225, s[4:7], s40 offen offset:2048 sc1
  s_waitcnt lgkmcnt(13)
  v_mfma_f32_16x16x32_bf16 v[96:99], a[216:219], a[0:3], v[96:99]
  ds_read_b64_tr_b16 a[210:211], v228 offset:43008
  v_mfma_f32_16x16x32_bf16 v[96:99], a[220:223], a[16:19], v[96:99]
  ds_read_b64_tr_b16 a[212:213], v229 offset:32768
  ds_read_b64_tr_b16 a[214:215], v229 offset:34816
  v_mfma_f32_16x16x32_bf16 v[128:131], a[216:219], a[4:7], v[128:131]
  v_mfma_f32_16x16x32_bf16 v[128:131], a[220:223], a[20:23], v[128:131]
  v_mfma_f32_16x16x32_bf16 v[160:163], a[216:219], a[8:11], v[160:163]
  v_mfma_f32_16x16x32_bf16 v[160:163], a[220:223], a[24:27], v[160:163]
  buffer_load_dwordx4 a[92:95], v225, s[4:7], s40 offen offset:3072 sc1
  s_load_dwordx2 s[66:67], s[36:37], 0x60000
  v_mfma_f32_16x16x32_bf16 v[192:195], a[216:219], a[12:15], v[192:195]
  ds_read_b64_tr_b16 a[216:217], v229 offset:40960
  s_mov_b32 s41, 4587520
  v_mfma_f32_16x16x32_bf16 v[192:195], a[220:223], a[28:31], v[192:195]
  ds_read_b64_tr_b16 a[218:219], v229 offset:43008
  s_add_u32 m0, s42, 73728
  v_mfma_f32_16x16x32_bf16 v[196:199], a[224:227], a[12:15], v[196:199]
  ds_read_b64_tr_b16 a[220:221], v230 offset:32768
  s_waitcnt lgkmcnt(13)
  v_mfma_f32_16x16x32_bf16 v[196:199], a[228:231], a[28:31], v[196:199]
  ds_read_b64_tr_b16 a[222:223], v230 offset:34816
  v_mfma_f32_16x16x32_bf16 v[164:167], a[224:227], a[8:11], v[164:167]
  v_mfma_f32_16x16x32_bf16 v[164:167], a[228:231], a[24:27], v[164:167]
  buffer_load_dwordx4 v226, s[16:19], s41 offen offset:0 lds
  v_mfma_f32_16x16x32_bf16 v[132:135], a[224:227], a[4:7], v[132:135]
  s_mov_b32 s41, 4816896
  s_add_u32 m0, s42, 86016
  v_mfma_f32_16x16x32_bf16 v[132:135], a[228:231], a[20:23], v[132:135]
  v_mfma_f32_16x16x32_bf16 v[100:103], a[224:227], a[0:3], v[100:103]
  ds_read_b64_tr_b16 a[224:225], v230 offset:40960
  v_mfma_f32_16x16x32_bf16 v[100:103], a[228:231], a[16:19], v[100:103]
  ds_read_b64_tr_b16 a[226:227], v230 offset:43008
  v_mfma_f32_16x16x32_bf16 v[104:107], a[232:235], a[0:3], v[104:107]
  ds_read_b64_tr_b16 a[228:229], v231 offset:32768
  v_mfma_f32_16x16x32_bf16 v[104:107], a[192:195], a[16:19], v[104:107]
  buffer_load_dwordx4 v226, s[16:19], s41 offen offset:0 lds
  v_mfma_f32_16x16x32_bf16 v[136:139], a[232:235], a[4:7], v[136:139]
  ds_read_b64_tr_b16 a[230:231], v231 offset:34816
  s_mov_b32 s40, 12320768
  v_mfma_f32_16x16x32_bf16 v[136:139], a[192:195], a[20:23], v[136:139]
  v_mfma_f32_16x16x32_bf16 v[168:171], a[232:235], a[8:11], v[168:171]
  v_mfma_f32_16x16x32_bf16 v[168:171], a[192:195], a[24:27], v[168:171]
  v_mfma_f32_16x16x32_bf16 v[200:203], a[232:235], a[12:15], v[200:203]
  ds_read_b64_tr_b16 a[232:233], v231 offset:40960
  v_mfma_f32_16x16x32_bf16 v[200:203], a[192:195], a[28:31], v[200:203]
  buffer_load_dwordx4 a[96:99], v225, s[4:7], s40 offen offset:0 sc1
  s_waitcnt lgkmcnt(13)
  v_mfma_f32_16x16x32_bf16 v[204:207], a[196:199], a[12:15], v[204:207]
  ds_read_b64_tr_b16 a[234:235], v231 offset:43008
  v_mfma_f32_16x16x32_bf16 v[204:207], a[200:203], a[28:31], v[204:207]
  s_waitcnt vmcnt(24)
  s_barrier
  v_mfma_f32_16x16x32_bf16 v[172:175], a[196:199], a[8:11], v[172:175]
  ds_read_b64_tr_b16 a[192:193], v228 offset:53248
  ds_read_b64_tr_b16 a[194:195], v228 offset:55296
  v_mfma_f32_16x16x32_bf16 v[172:175], a[200:203], a[24:27], v[172:175]
  s_load_dwordx2 s[66:67], s[36:37], 0x80000
  v_mfma_f32_16x16x32_bf16 v[140:143], a[196:199], a[4:7], v[140:143]
  v_mfma_f32_16x16x32_bf16 v[140:143], a[200:203], a[20:23], v[140:143]
  buffer_load_dwordx4 a[100:103], v225, s[4:7], s40 offen offset:1024 sc1
  v_mfma_f32_16x16x32_bf16 v[108:111], a[196:199], a[0:3], v[108:111]
  ds_read_b64_tr_b16 a[196:197], v228 offset:57344
  v_mfma_f32_16x16x32_bf16 v[108:111], a[200:203], a[16:19], v[108:111]
  ds_read_b64_tr_b16 a[198:199], v228 offset:59392
  v_mfma_f32_16x16x32_bf16 v[112:115], a[204:207], a[0:3], v[112:115]
  ds_read_b64_tr_b16 a[200:201], v229 offset:53248
  s_waitcnt lgkmcnt(13)
  v_mfma_f32_16x16x32_bf16 v[112:115], a[208:211], a[16:19], v[112:115]
  ds_read_b64_tr_b16 a[202:203], v229 offset:55296
  v_mfma_f32_16x16x32_bf16 v[144:147], a[204:207], a[4:7], v[144:147]
  v_mfma_f32_16x16x32_bf16 v[144:147], a[208:211], a[20:23], v[144:147]
  buffer_load_dwordx4 a[104:107], v225, s[4:7], s40 offen offset:2048 sc1
  v_mfma_f32_16x16x32_bf16 v[176:179], a[204:207], a[8:11], v[176:179]
  v_mfma_f32_16x16x32_bf16 v[176:179], a[208:211], a[24:27], v[176:179]
  v_mfma_f32_16x16x32_bf16 v[208:211], a[204:207], a[12:15], v[208:211]
  ds_read_b64_tr_b16 a[204:205], v229 offset:57344
  v_mfma_f32_16x16x32_bf16 v[208:211], a[208:211], a[28:31], v[208:211]
  ds_read_b64_tr_b16 a[206:207], v229 offset:59392
  v_mfma_f32_16x16x32_bf16 v[212:215], a[212:215], a[12:15], v[212:215]
  ds_read_b64_tr_b16 a[208:209], v232 offset:0
  v_mfma_f32_16x16x32_bf16 v[212:215], a[216:219], a[28:31], v[212:215]
  buffer_load_dwordx4 a[108:111], v225, s[4:7], s40 offen offset:3072 sc1
L_wk1_4:
  s_cbranch_vccnz L_wk1_8
  v_mfma_f32_16x16x32_bf16 v[180:183], a[212:215], a[8:11], v[180:183]
  ds_read_b64_tr_b16 a[210:211], v232 offset:2048
  s_mov_b32 s41, 5046272
  v_mfma_f32_16x16x32_bf16 v[180:183], a[216:219], a[24:27], v[180:183]
  s_add_u32 m0, s42, 102400
  v_mfma_f32_16x16x32_bf16 v[148:151], a[212:215], a[4:7], v[148:151]
  v_mfma_f32_16x16x32_bf16 v[148:151], a[216:219], a[20:23], v[148:151]
  v_mfma_f32_16x16x32_bf16 v[116:119], a[212:215], a[0:3], v[116:119]
  ds_read_b64_tr_b16 a[212:213], v232 offset:28672
  v_mfma_f32_16x16x32_bf16 v[116:119], a[216:219], a[16:19], v[116:119]
  buffer_load_dwordx4 v227, s[12:15], s41 offen offset:0 lds
  s_waitcnt lgkmcnt(13)
  v_mfma_f32_16x16x32_bf16 v[120:123], a[220:223], a[0:3], v[120:123]
  ds_read_b64_tr_b16 a[214:215], v232 offset:30720
  s_mov_b32 s41, 5275648
  v_mfma_f32_16x16x32_bf16 v[120:123], a[224:227], a[16:19], v[120:123]
  ds_read_b64_tr_b16 a[216:217], v233 offset:0
  ds_read_b64_tr_b16 a[218:219], v233 offset:2048
  s_load_dwordx2 s[66:67], s[36:37], 0xa0000
  v_mfma_f32_16x16x32_bf16 v[152:155], a[220:223], a[4:7], v[152:155]
  s_add_u32 m0, s42, 98304
  v_mfma_f32_16x16x32_bf16 v[152:155], a[224:227], a[20:23], v[152:155]
  v_mfma_f32_16x16x32_bf16 v[184:187], a[220:223], a[8:11], v[184:187]
  v_mfma_f32_16x16x32_bf16 v[184:187], a[224:227], a[24:27], v[184:187]
  buffer_load_dwordx4 v227, s[12:15], s41 offen offset:0 lds
  v_mfma_f32_16x16x32_bf16 v[216:219], a[220:223], a[12:15], v[216:219]
  ds_read_b64_tr_b16 a[220:221], v233 offset:28672
  s_mov_b32 s41, 5046272
  v_mfma_f32_16x16x32_bf16 v[216:219], a[224:227], a[28:31], v[216:219]
  ds_read_b64_tr_b16 a[222:223], v233 offset:30720
  s_add_u32 m0, s42, 110592
  s_getpc_b64 s[30:31]
L_pc_30:
  s_lshr_b32 s32, s2, 4
  s_lshl_b32 s32, s32, 2
  s_add_u32 s32, s32, s3
  s_lshl_b32 s32, s32, 13
  v_lshlrev_b32 v244, 7, v224
  v_add_u32 v244, s32, v244
  v_min_u32 v244, L_code_end-L_pc_30-4, v244
  global_load_dword v241, v244, s[30:31]
  v_mfma_f32_16x16x32_bf16 v[220:223], a[228:231], a[12:15], v[220:223]
  ds_read_b64_tr_b16 a[224:225], v230 offset:53248
  s_waitcnt lgkmcnt(13)
  v_mfma_f32_16x16x32_bf16 v[220:223], a[232:235], a[28:31], v[220:223]
  ds_read_b64_tr_b16 a[226:227], v230 offset:55296
  buffer_store_dwordx4 a[252:255], v251, s[4:7], s96 offen offset:0 sc1
  v_mfma_f32_16x16x32_bf16 v[188:191], a[228:231], a[8:11], v[188:191]
  v_mfma_f32_16x16x32_bf16 v[188:191], a[232:235], a[24:27], v[188:191]
  buffer_load_dwordx4 v227, s[16:19], s41 offen offset:0 lds
  buffer_store_dwordx4 a[252:255], v251, s[4:7], s96 offen offset:1024 sc1
  v_mfma_f32_16x16x32_bf16 v[156:159], a[228:231], a[4:7], v[156:159]
  s_mov_b32 s41, 5275648
  s_add_u32 m0, s42, 126976
  v_mfma_f32_16x16x32_bf16 v[156:159], a[232:235], a[20:23], v[156:159]
  buffer_store_dwordx4 a[252:255], v251, s[4:7], s96 offen offset:2048 sc1
  v_mfma_f32_16x16x32_bf16 v[124:127], a[228:231], a[0:3], v[124:127]
  ds_read_b64_tr_b16 a[228:229], v230 offset:57344
  v_mfma_f32_16x16x32_bf16 v[124:127], a[232:235], a[16:19], v[124:127]
  ds_read_b64_tr_b16 a[230:231], v230 offset:59392
  buffer_store_dwordx4 a[252:255], v251, s[4:7], s96 offen offset:3072 sc1
  v_mfma_f32_16x16x32_bf16 v[0:3], a[192:195], a[32:35], v[0:3]
  ds_read_b64_tr_b16 a[232:233], v234 offset:0
  s_waitcnt vmcnt(31)
  v_mfma_f32_16x16x32_bf16 v[0:3], a[196:199], a[48:51], v[0:3]
  buffer_load_dwordx4 v227, s[16:19], s41 offen offset:0 lds
  v_mfma_f32_16x16x32_bf16 v[16:19], a[192:195], a[36:39], v[16:19]
  ds_read_b64_tr_b16 a[234:235], v234 offset:2048
  s_mov_b32 s41, 5505024
  v_mfma_f32_16x16x32_bf16 v[16:19], a[196:199], a[52:55], v[16:19]
  s_add_u32 m0, s42, 122880
  v_mfma_f32_16x16x32_bf16 v[32:35], a[192:195], a[40:43], v[32:35]
  v_mfma_f32_16x16x32_bf16 v[32:35], a[196:199], a[56:59], v[32:35]
  v_mfma_f32_16x16x32_bf16 v[48:51], a[192:195], a[44:47], v[48:51]
  ds_read_b64_tr_b16 a[192:193], v234 offset:28672
  v_mfma_f32_16x16x32_bf16 v[48:51], a[196:199], a[60:63], v[48:51]
  buffer_load_dwordx4 v227, s[12:15], s41 offen offset:0 lds
  s_load_dwordx2 s[66:67], s[36:37], 0xc0000
  s_waitcnt lgkmcnt(13)
  v_mfma_f32_16x16x32_bf16 v[52:55], a[200:203], a[44:47], v[52:55]
  ds_read_b64_tr_b16 a[194:195], v234 offset:30720
  s_mov_b32 s41, 5734400
  v_mfma_f32_16x16x32_bf16 v[52:55], a[204:207], a[60:63], v[52:55]
  ds_read_b64_tr_b16 a[196:197], v232 offset:40960
  ds_read_b64_tr_b16 a[198:199], v232 offset:43008
  v_mfma_f32_16x16x32_bf16 v[36:39], a[200:203], a[40:43], v[36:39]
  s_add_u32 m0, s42, 135168
  v_mfma_f32_16x16x32_bf16 v[36:39], a[204:207], a[56:59], v[36:39]
  v_mfma_f32_16x16x32_bf16 v[20:23], a[200:203], a[36:39], v[20:23]
  v_mfma_f32_16x16x32_bf16 v[20:23], a[204:207], a[52:55], v[20:23]
  buffer_load_dwordx4 v227, s[12:15], s41 offen offset:0 lds
  v_mfma_f32_16x16x32_bf16 v[4:7], a[200:203], a[32:35], v[4:7]
  ds_read_b64_tr_b16 a[200:201], v232 offset:49152
  s_mov_b32 s40, 12451840
  v_mfma_f32_16x16x32_bf16 v[4:7], a[204:207], a[48:51], v[4:7]
  ds_read_b64_tr_b16 a[202:203], v232 offset:51200
  v_mfma_f32_16x16x32_bf16 v[8:11], a[208:211], a[32:35], v[8:11]
  ds_read_b64_tr_b16 a[204:205], v233 offset:40960
  s_waitcnt lgkmcnt(13)
  v_mfma_f32_16x16x32_bf16 v[8:11], a[212:215], a[48:51], v[8:11]
  s_waitcnt vmcnt(31)
  s_barrier
  v_mfma_f32_16x16x32_bf16 v[24:27], a[208:211], a[36:39], v[24:27]
  ds_read_b64_tr_b16 a[206:207], v233 offset:43008
  v_mfma_f32_16x16x32_bf16 v[24:27], a[212:215], a[52:55], v[24:27]
  buffer_load_dwordx4 a[112:115], v225, s[4:7], s40 offen offset:0 sc1
  v_mfma_f32_16x16x32_bf16 v[40:43], a[208:211], a[40:43], v[40:43]
  v_mfma_f32_16x16x32_bf16 v[40:43], a[212:215], a[56:59], v[40:43]
  v_mfma_f32_16x16x32_bf16 v[56:59], a[208:211], a[44:47], v[56:59]
  ds_read_b64_tr_b16 a[208:209], v233 offset:49152
  v_mfma_f32_16x16x32_bf16 v[56:59], a[212:215], a[60:63], v[56:59]
  ds_read_b64_tr_b16 a[210:211], v233 offset:51200
  v_mfma_f32_16x16x32_bf16 v[60:63], a[216:219], a[44:47], v[60:63]
  ds_read_b64_tr_b16 a[212:213], v234 offset:40960
  v_mfma_f32_16x16x32_bf16 v[60:63], a[220:223], a[60:63], v[60:63]
  buffer_load_dwordx4 a[116:119], v225, s[4:7], s40 offen offset:1024 sc1
  v_mfma_f32_16x16x32_bf16 v[44:47], a[216:219], a[40:43], v[44:47]
  ds_read_b64_tr_b16 a[214:215], v234 offset:43008
  v_mfma_f32_16x16x32_bf16 v[44:47], a[220:223], a[56:59], v[44:47]
  v_mfma_f32_16x16x32_bf16 v[28:31], a[216:219], a[36:39], v[28:31]
  v_mfma_f32_16x16x32_bf16 v[28:31], a[220:223], a[52:55], v[28:31]
  s_load_dwordx2 s[66:67], s[36:37], 0xe0000
  s_add_u32 s36, s36, 0x100000
  s_addc_u32 s37, s37, 0
  v_mfma_f32_16x16x32_bf16 v[12:15], a[216:219], a[32:35], v[12:15]
  ds_read_b64_tr_b16 a[216:217], v234 offset:49152
  v_mfma_f32_16x16x32_bf16 v[12:15], a[220:223], a[48:51], v[12:15]
  buffer_load_dwordx4 a[120:123], v225, s[4:7], s40 offen offset:2048 sc1
  s_waitcnt lgkmcnt(13)
  v_mfma_f32_16x16x32_bf16 v[64:67], a[224:227], a[32:35], v[64:67]
  ds_read_b64_tr_b16 a[218:219], v234 offset:51200
  v_mfma_f32_16x16x32_bf16 v[64:67], a[228:231], a[48:51], v[64:67]
  ds_read_b64_tr_b16 a[220:221], v235 offset:40960
  ds_read_b64_tr_b16 a[222:223], v235 offset:43008
  v_mfma_f32_16x16x32_bf16 v[72:75], a[224:227], a[36:39], v[72:75]
  v_mfma_f32_16x16x32_bf16 v[72:75], a[228:231], a[52:55], v[72:75]
  v_mfma_f32_16x16x32_bf16 v[80:83], a[224:227], a[40:43], v[80:83]
  v_mfma_f32_16x16x32_bf16 v[80:83], a[228:231], a[56:59], v[80:83]
  buffer_load_dwordx4 a[124:127], v225, s[4:7], s40 offen offset:3072 sc1
  v_mfma_f32_16x16x32_bf16 v[88:91], a[224:227], a[44:47], v[88:91]
  ds_read_b64_tr_b16 a[224:225], v235 offset:49152
  s_mov_b32 s41, 5505024
  v_mfma_f32_16x16x32_bf16 v[88:91], a[228:231], a[60:63], v[88:91]
  ds_read_b64_tr_b16 a[226:227], v235 offset:51200
  s_add_u32 m0, s42, 151552
  v_mfma_f32_16x16x32_bf16 v[92:95], a[232:235], a[44:47], v[92:95]
  ds_read_b64_tr_b16 a[228:229], v236 offset:12288
  s_waitcnt lgkmcnt(13)
  v_mfma_f32_16x16x32_bf16 v[92:95], a[192:195], a[60:63], v[92:95]
  ds_read_b64_tr_b16 a[230:231], v236 offset:14336
  v_mfma_f32_16x16x32_bf16 v[84:87], a[232:235], a[40:43], v[84:87]
  v_mfma_f32_16x16x32_bf16 v[84:87], a[192:195], a[56:59], v[84:87]
  buffer_load_dwordx4 v227, s[16:19], s41 offen offset:0 lds
  v_mfma_f32_16x16x32_bf16 v[76:79], a[232:235], a[36:39], v[76:79]
  s_mov_b32 s41, 5734400
  s_add_u32 m0, s42, 147456
  v_mfma_f32_16x16x32_bf16 v[76:79], a[192:195], a[52:55], v[76:79]
  v_mfma_f32_16x16x32_bf16 v[68:71], a[232:235], a[32:35], v[68:71]
  ds_read_b64_tr_b16 a[232:233], v232 offset:4096
  v_mfma_f32_16x16x32_bf16 v[68:71], a[192:195], a[48:51], v[68:71]
  ds_read_b64_tr_b16 a[234:235], v232 offset:6144
  v_mfma_f32_16x16x32_bf16 v[96:99], a[196:199], a[32:35], v[96:99]
  ds_read_b64_tr_b16 a[192:193], v237 offset:12288
  v_mfma_f32_16x16x32_bf16 v[96:99], a[200:203], a[48:51], v[96:99]
  buffer_load_dwordx4 v227, s[16:19], s41 offen offset:0 lds
  v_mfma_f32_16x16x32_bf16 v[128:131], a[196:199], a[36:39], v[128:131]
  ds_read_b64_tr_b16 a[194:195], v237 offset:14336
  s_mov_b32 s41, 5963776
  v_mfma_f32_16x16x32_bf16 v[128:131], a[200:203], a[52:55], v[128:131]
  s_add_u32 m0, s42, 159744
  s_load_dwordx2 s[66:67], s[36:37], 0x0
  v_mfma_f32_16x16x32_bf16 v[160:163], a[196:199], a[40:43], v[160:163]
  v_mfma_f32_16x16x32_bf16 v[160:163], a[200:203], a[56:59], v[160:163]
  v_mfma_f32_16x16x32_bf16 v[192:195], a[196:199], a[44:47], v[192:195]
  ds_read_b64_tr_b16 a[196:197], v233 offset:4096
  v_mfma_f32_16x16x32_bf16 v[192:195], a[200:203], a[60:63], v[192:195]
  buffer_load_dwordx4 v227, s[12:15], s41 offen offset:0 lds
  s_waitcnt lgkmcnt(13)
  v_mfma_f32_16x16x32_bf16 v[196:199], a[204:207], a[44:47], v[196:199]
  ds_read_b64_tr_b16 a[198:199], v233 offset:6144
  s_mov_b32 s41, 6193152
  v_mfma_f32_16x16x32_bf16 v[196:199], a[208:211], a[60:63], v[196:199]
  ds_read_b64_tr_b16 a[200:201], v238 offset:12288
  ds_read_b64_tr_b16 a[202:203], v238 offset:14336
  v_mfma_f32_16x16x32_bf16 v[164:167], a[204:207], a[40:43], v[164:167]
  s_add_u32 m0, s42, 16384
  v_mfma_f32_16x16x32_bf16 v[164:167], a[208:211], a[56:59], v[164:167]
  v_mfma_f32_16x16x32_bf16 v[132:135], a[204:207], a[36:39], v[132:135]
  v_mfma_f32_16x16x32_bf16 v[132:135], a[208:211], a[52:55], v[132:135]
  buffer_load_dwordx4 v227, s[12:15], s41 offen offset:0 lds
  v_mfma_f32_16x16x32_bf16 v[100:103], a[204:207], a[32:35], v[100:103]
  ds_read_b64_tr_b16 a[204:205], v234 offset:4096
  s_mov_b32 s41, 5963776
  v_mfma_f32_16x16x32_bf16 v[100:103], a[208:211], a[48:51], v[100:103]
  ds_read_b64_tr_b16 a[206:207], v234 offset:6144
  s_add_u32 m0, s42, 28672
  v_mfma_f32_16x16x32_bf16 v[104:107], a[212:215], a[32:35], v[104:107]
  ds_read_b64_tr_b16 a[208:209], v239 offset:12288
  s_waitcnt lgkmcnt(13)
  v_mfma_f32_16x16x32_bf16 v[104:107], a[216:219], a[48:51], v[104:107]
  ds_read_b64_tr_b16 a[210:211], v239 offset:14336
  v_mfma_f32_16x16x32_bf16 v[136:139], a[212:215], a[36:39], v[136:139]
  v_mfma_f32_16x16x32_bf16 v[136:139], a[216:219], a[52:55], v[136:139]
  buffer_load_dwordx4 v227, s[16:19], s41 offen offset:0 lds
  v_mfma_f32_16x16x32_bf16 v[168:171], a[212:215], a[40:43], v[168:171]
  s_mov_b32 s40, 12582912
  v_mfma_f32_16x16x32_bf16 v[168:171], a[216:219], a[56:59], v[168:171]
  v_mfma_f32_16x16x32_bf16 v[200:203], a[212:215], a[44:47], v[200:203]
  ds_read_b64_tr_b16 a[212:213], v235 offset:4096
  v_mfma_f32_16x16x32_bf16 v[200:203], a[216:219], a[60:63], v[200:203]
  ds_read_b64_tr_b16 a[214:215], v235 offset:6144
  v_mfma_f32_16x16x32_bf16 v[204:207], a[220:223], a[44:47], v[204:207]
  ds_read_b64_tr_b16 a[216:217], v232 offset:16384
  v_mfma_f32_16x16x32_bf16 v[204:207], a[224:227], a[60:63], v[204:207]
  s_waitcnt vmcnt(30)
  s_barrier
  s_load_dwordx2 s[66:67], s[36:37], 0x20000
  v_mfma_f32_16x16x32_bf16 v[172:175], a[220:223], a[40:43], v[172:175]
  buffer_load_dwordx4 a[128:131], v225, s[4:7], s40 offen offset:0 sc1
  v_mfma_f32_16x16x32_bf16 v[172:175], a[224:227], a[56:59], v[172:175]
  ds_read_b64_tr_b16 a[218:219], v232 offset:18432
  v_mfma_f32_16x16x32_bf16 v[140:143], a[220:223], a[36:39], v[140:143]
  v_mfma_f32_16x16x32_bf16 v[140:143], a[224:227], a[52:55], v[140:143]
  v_mfma_f32_16x16x32_bf16 v[108:111], a[220:223], a[32:35], v[108:111]
  ds_read_b64_tr_b16 a[220:221], v228 offset:61440
  v_mfma_f32_16x16x32_bf16 v[108:111], a[224:227], a[48:51], v[108:111]
  buffer_load_dwordx4 a[132:135], v225, s[4:7], s40 offen offset:1024 sc1
  s_waitcnt lgkmcnt(13)
  v_mfma_f32_16x16x32_bf16 v[112:115], a[228:231], a[32:35], v[112:115]
  ds_read_b64_tr_b16 a[222:223], v228 offset:63488
  v_mfma_f32_16x16x32_bf16 v[112:115], a[232:235], a[48:51], v[112:115]
  ds_read_b64_tr_b16 a[224:225], v233 offset:16384
  ds_read_b64_tr_b16 a[226:227], v233 offset:18432
  v_mfma_f32_16x16x32_bf16 v[144:147], a[228:231], a[36:39], v[144:147]
  v_mfma_f32_16x16x32_bf16 v[144:147], a[232:235], a[52:55], v[144:147]
  v_mfma_f32_16x16x32_bf16 v[176:179], a[228:231], a[40:43], v[176:179]
  v_mfma_f32_16x16x32_bf16 v[176:179], a[232:235], a[56:59], v[176:179]
  buffer_load_dwordx4 a[136:139], v225, s[4:7], s40 offen offset:2048 sc1
  v_mfma_f32_16x16x32_bf16 v[208:211], a[228:231], a[44:47], v[208:211]
  ds_read_b64_tr_b16 a[228:229], v229 offset:61440
  v_mfma_f32_16x16x32_bf16 v[208:211], a[232:235], a[60:63], v[208:211]
  ds_read_b64_tr_b16 a[230:231], v229 offset:63488
  v_mfma_f32_16x16x32_bf16 v[212:215], a[192:195], a[44:47], v[212:215]
  ds_read_b64_tr_b16 a[232:233], v232 offset:24576
  s_waitcnt lgkmcnt(13)
  v_mfma_f32_16x16x32_bf16 v[212:215], a[196:199], a[60:63], v[212:215]
  ds_read_b64_tr_b16 a[234:235], v232 offset:26624
  v_mfma_f32_16x16x32_bf16 v[180:183], a[192:195], a[40:43], v[180:183]
  v_mfma_f32_16x16x32_bf16 v[180:183], a[196:199], a[56:59], v[180:183]
  buffer_load_dwordx4 a[140:143], v225, s[4:7], s40 offen offset:3072 sc1
  v_mfma_f32_16x16x32_bf16 v[148:151], a[192:195], a[36:39], v[148:151]
  s_mov_b32 s40, 12713984
  v_mfma_f32_16x16x32_bf16 v[148:151], a[196:199], a[52:55], v[148:151]
  v_mfma_f32_16x16x32_bf16 v[116:119], a[192:195], a[32:35], v[116:119]
  ds_read_b64_tr_b16 a[192:193], v232 offset:53248
  v_mfma_f32_16x16x32_bf16 v[116:119], a[196:199], a[48:51], v[116:119]
  ds_read_b64_tr_b16 a[194:195], v232 offset:55296
  s_load_dwordx2 s[66:67], s[36:37], 0x40000
  v_mfma_f32_16x16x32_bf16 v[120:123], a[200:203], a[32:35], v[120:123]
  ds_read_b64_tr_b16 a[196:197], v233 offset:24576
  v_mfma_f32_16x16x32_bf16 v[120:123], a[204:207], a[48:51], v[120:123]
  buffer_load_dwordx4 a[144:147], v225, s[4:7], s40 offen offset:0 sc1
  v_mfma_f32_16x16x32_bf16 v[152:155], a[200:203], a[36:39], v[152:155]
  ds_read_b64_tr_b16 a[198:199], v233 offset:26624
  v_mfma_f32_16x16x32_bf16 v[152:155], a[204:207], a[52:55], v[152:155]
  v_mfma_f32_16x16x32_bf16 v[184:187], a[200:203], a[40:43], v[184:187]
  v_mfma_f32_16x16x32_bf16 v[184:187], a[204:207], a[56:59], v[184:187]
  v_mfma_f32_16x16x32_bf16 v[216:219], a[200:203], a[44:47], v[216:219]
  ds_read_b64_tr_b16 a[200:201], v233 offset:53248
  v_mfma_f32_16x16x32_bf16 v[216:219], a[204:207], a[60:63], v[216:219]
  buffer_load_dwordx4 a[148:151], v225, s[4:7], s40 offen offset:1024 sc1
  s_waitcnt lgkmcnt(13)
  v_mfma_f32_16x16x32_bf16 v[220:223], a[208:211], a[44:47], v[220:223]
  ds_read_b64_tr_b16 a[202:203], v233 offset:55296
  v_mfma_f32_16x16x32_bf16 v[220:223], a[212:215], a[60:63], v[220:223]
  ds_read_b64_tr_b16 a[204:205], v234 offset:16384
  ds_read_b64_tr_b16 a[206:207], v234 offset:18432
  v_mfma_f32_16x16x32_bf16 v[188:191], a[208:211], a[40:43], v[188:191]
  v_mfma_f32_16x16x32_bf16 v[188:191], a[212:215], a[56:59], v[188:191]
  v_mfma_f32_16x16x32_bf16 v[156:159], a[208:211], a[36:39], v[156:159]
  v_mfma_f32_16x16x32_bf16 v[156:159], a[212:215], a[52:55], v[156:159]
  buffer_load_dwordx4 a[152:155], v225, s[4:7], s40 offen offset:2048 sc1
  v_mfma_f32_16x16x32_bf16 v[124:127], a[208:211], a[32:35], v[124:127]
  ds_read_b64_tr_b16 a[208:209], v230 offset:61440
  v_mfma_f32_16x16x32_bf16 v[124:127], a[212:215], a[48:51], v[124:127]
  ds_read_b64_tr_b16 a[210:211], v230 offset:63488
  v_mfma_f32_16x16x32_bf16 v[0:3], a[216:219], a[64:67], v[0:3]
  ds_read_b64_tr_b16 a[212:213], v234 offset:24576
  s_waitcnt vmcnt(33) lgkmcnt(13)
  v_mfma_f32_16x16x32_bf16 v[0:3], a[220:223], a[80:83], v[0:3]
  ds_read_b64_tr_b16 a[214:215], v234 offset:26624
  v_mfma_f32_16x16x32_bf16 v[16:19], a[216:219], a[68:71], v[16:19]
  v_mfma_f32_16x16x32_bf16 v[16:19], a[220:223], a[84:87], v[16:19]
  buffer_load_dwordx4 a[156:159], v225, s[4:7], s40 offen offset:3072 sc1
  v_mfma_f32_16x16x32_bf16 v[32:35], a[216:219], a[72:75], v[32:35]
  s_mov_b32 s41, 6193152
  s_add_u32 m0, s42, 139264
  v_mfma_f32_16x16x32_bf16 v[32:35], a[220:223], a[88:91], v[32:35]
  s_load_dwordx2 s[66:67], s[36:37], 0x60000
  v_mfma_f32_16x16x32_bf16 v[48:51], a[216:219], a[76:79], v[48:51]
  ds_read_b64_tr_b16 a[216:217], v234 offset:53248
  v_mfma_f32_16x16x32_bf16 v[48:51], a[220:223], a[92:95], v[48:51]
  ds_read_b64_tr_b16 a[218:219], v234 offset:55296
  v_mfma_f32_16x16x32_bf16 v[52:55], a[224:227], a[76:79], v[52:55]
  ds_read_b64_tr_b16 a[220:221], v236 offset:0
  v_mfma_f32_16x16x32_bf16 v[52:55], a[228:231], a[92:95], v[52:55]
  buffer_load_dwordx4 v227, s[16:19], s41 offen offset:0 lds
  v_mfma_f32_16x16x32_bf16 v[36:39], a[224:227], a[72:75], v[36:39]
  ds_read_b64_tr_b16 a[222:223], v236 offset:2048
  s_mov_b32 s41, 6422528
  v_mfma_f32_16x16x32_bf16 v[36:39], a[228:231], a[88:91], v[36:39]
  s_add_u32 m0, s42, 155648
  v_mfma_f32_16x16x32_bf16 v[20:23], a[224:227], a[68:71], v[20:23]
  v_mfma_f32_16x16x32_bf16 v[20:23], a[228:231], a[84:87], v[20:23]
  v_mfma_f32_16x16x32_bf16 v[4:7], a[224:227], a[64:67], v[4:7]
  ds_read_b64_tr_b16 a[224:225], v232 offset:12288
  v_mfma_f32_16x16x32_bf16 v[4:7], a[228:231], a[80:83], v[4:7]
  buffer_load_dwordx4 v227, s[12:15], s41 offen offset:0 lds
  s_waitcnt lgkmcnt(13)
  v_mfma_f32_16x16x32_bf16 v[8:11], a[232:235], a[64:67], v[8:11]
  ds_read_b64_tr_b16 a[226:227], v232 offset:14336
  s_mov_b32 s41, 6651904
  v_mfma_f32_16x16x32_bf16 v[8:11], a[192:195], a[80:83], v[8:11]
  s_waitcnt vmcnt(29)
  s_barrier
  v_mfma_f32_16x16x32_bf16 v[24:27], a[232:235], a[68:71], v[24:27]
  ds_read_b64_tr_b16 a[228:229], v237 offset:0
  ds_read_b64_tr_b16 a[230:231], v237 offset:2048
  v_mfma_f32_16x16x32_bf16 v[24:27], a[192:195], a[84:87], v[24:27]
  s_add_u32 m0, s42, 20480
  v_mfma_f32_16x16x32_bf16 v[40:43], a[232:235], a[72:75], v[40:43]
  v_mfma_f32_16x16x32_bf16 v[40:43], a[192:195], a[88:91], v[40:43]
  buffer_load_dwordx4 v227, s[12:15], s41 offen offset:0 lds
  v_mfma_f32_16x16x32_bf16 v[56:59], a[232:235], a[76:79], v[56:59]
  ds_read_b64_tr_b16 a[232:233], v233 offset:12288
  s_mov_b32 s41, 6422528
  v_mfma_f32_16x16x32_bf16 v[56:59], a[192:195], a[92:95], v[56:59]
  ds_read_b64_tr_b16 a[234:235], v233 offset:14336
  s_add_u32 m0, s42, 12288
  v_mfma_f32_16x16x32_bf16 v[60:63], a[196:199], a[76:79], v[60:63]
  ds_read_b64_tr_b16 a[192:193], v238 offset:0
  s_waitcnt lgkmcnt(13)
  v_mfma_f32_16x16x32_bf16 v[60:63], a[200:203], a[92:95], v[60:63]
  ds_read_b64_tr_b16 a[194:195], v238 offset:2048
  v_mfma_f32_16x16x32_bf16 v[44:47], a[196:199], a[72:75], v[44:47]
  v_mfma_f32_16x16x32_bf16 v[44:47], a[200:203], a[88:91], v[44:47]
  buffer_load_dwordx4 v227, s[16:19], s41 offen offset:0 lds
  s_load_dwordx2 s[66:67], s[36:37], 0x80000
  v_mfma_f32_16x16x32_bf16 v[28:31], a[196:199], a[68:71], v[28:31]
  s_mov_b32 s41, 6651904
  s_add_u32 m0, s42, 24576
  v_mfma_f32_16x16x32_bf16 v[28:31], a[200:203], a[84:87], v[28:31]
  v_mfma_f32_16x16x32_bf16 v[12:15], a[196:199], a[64:67], v[12:15]
  ds_read_b64_tr_b16 a[196:197], v234 offset:12288
  v_mfma_f32_16x16x32_bf16 v[12:15], a[200:203], a[80:83], v[12:15]
  ds_read_b64_tr_b16 a[198:199], v234 offset:14336
  v_mfma_f32_16x16x32_bf16 v[64:67], a[204:207], a[64:67], v[64:67]
  ds_read_b64_tr_b16 a[200:201], v239 offset:0
  v_mfma_f32_16x16x32_bf16 v[64:67], a[208:211], a[80:83], v[64:67]
  buffer_load_dwordx4 v227, s[16:19], s41 offen offset:0 lds
  v_mfma_f32_16x16x32_bf16 v[72:75], a[204:207], a[68:71], v[72:75]
  ds_read_b64_tr_b16 a[202:203], v239 offset:2048
  s_mov_b32 s40, 12845056
  v_mfma_f32_16x16x32_bf16 v[72:75], a[208:211], a[84:87], v[72:75]
  v_mfma_f32_16x16x32_bf16 v[80:83], a[204:207], a[72:75], v[80:83]
  v_mfma_f32_16x16x32_bf16 v[80:83], a[208:211], a[88:91], v[80:83]
  v_mfma_f32_16x16x32_bf16 v[88:91], a[204:207], a[76:79], v[88:91]
  ds_read_b64_tr_b16 a[204:205], v235 offset:12288
  v_mfma_f32_16x16x32_bf16 v[88:91], a[208:211], a[92:95], v[88:91]
  buffer_load_dwordx4 a[160:163], v225, s[4:7], s40 offen offset:0 sc1
  s_waitcnt lgkmcnt(13)
  v_mfma_f32_16x16x32_bf16 v[92:95], a[212:215], a[76:79], v[92:95]
  ds_read_b64_tr_b16 a[206:207], v235 offset:14336
  v_mfma_f32_16x16x32_bf16 v[92:95], a[216:219], a[92:95], v[92:95]
  ds_read_b64_tr_b16 a[208:209], v232 offset:8192
  ds_read_b64_tr_b16 a[210:211], v232 offset:10240
  v_mfma_f32_16x16x32_bf16 v[84:87], a[212:215], a[72:75], v[84:87]
  v_mfma_f32_16x16x32_bf16 v[84:87], a[216:219], a[88:91], v[84:87]
  v_mfma_f32_16x16x32_bf16 v[76:79], a[212:215], a[68:71], v[76:79]
  v_mfma_f32_16x16x32_bf16 v[76:79], a[216:219], a[84:87], v[76:79]
  buffer_load_dwordx4 a[164:167], v225, s[4:7], s40 offen offset:1024 sc1
  v_mfma_f32_16x16x32_bf16 v[68:71], a[212:215], a[64:67], v[68:71]
  ds_read_b64_tr_b16 a[212:213], v232 offset:20480
  v_mfma_f32_16x16x32_bf16 v[68:71], a[216:219], a[80:83], v[68:71]
  ds_read_b64_tr_b16 a[214:215], v232 offset:22528
  v_mfma_f32_16x16x32_bf16 v[96:99], a[220:223], a[64:67], v[96:99]
  ds_read_b64_tr_b16 a[216:217], v233 offset:8192
  s_waitcnt lgkmcnt(13)
  v_mfma_f32_16x16x32_bf16 v[96:99], a[224:227], a[80:83], v[96:99]
  ds_read_b64_tr_b16 a[218:219], v233 offset:10240
  s_load_dwordx2 s[66:67], s[36:37], 0xa0000
  v_mfma_f32_16x16x32_bf16 v[128:131], a[220:223], a[68:71], v[128:131]
  v_mfma_f32_16x16x32_bf16 v[128:131], a[224:227], a[84:87], v[128:131]
  buffer_load_dwordx4 a[168:171], v225, s[4:7], s40 offen offset:2048 sc1
  v_mfma_f32_16x16x32_bf16 v[160:163], a[220:223], a[72:75], v[160:163]
  v_mfma_f32_16x16x32_bf16 v[160:163], a[224:227], a[88:91], v[160:163]
  v_mfma_f32_16x16x32_bf16 v[192:195], a[220:223], a[76:79], v[192:195]
  ds_read_b64_tr_b16 a[220:221], v233 offset:20480
  v_mfma_f32_16x16x32_bf16 v[192:195], a[224:227], a[92:95], v[192:195]
  ds_read_b64_tr_b16 a[222:223], v233 offset:22528
  v_mfma_f32_16x16x32_bf16 v[196:199], a[228:231], a[76:79], v[196:199]
  ds_read_b64_tr_b16 a[224:225], v234 offset:8192
  v_mfma_f32_16x16x32_bf16 v[196:199], a[232:235], a[92:95], v[196:199]
  buffer_load_dwordx4 a[172:175], v225, s[4:7], s40 offen offset:3072 sc1
  v_mfma_f32_16x16x32_bf16 v[164:167], a[228:231], a[72:75], v[164:167]
  ds_read_b64_tr_b16 a[226:227], v234 offset:10240
  s_mov_b32 s40, 12976128
  v_mfma_f32_16x16x32_bf16 v[164:167], a[232:235], a[88:91], v[164:167]
  v_mfma_f32_16x16x32_bf16 v[132:135], a[228:231], a[68:71], v[132:135]
  v_mfma_f32_16x16x32_bf16 v[132:135], a[232:235], a[84:87], v[132:135]
  v_mfma_f32_16x16x32_bf16 v[100:103], a[228:231], a[64:67], v[100:103]
  ds_read_b64_tr_b16 a[228:229], v234 offset:20480
  v_mfma_f32_16x16x32_bf16 v[100:103], a[232:235], a[80:83], v[100:103]
  buffer_load_dwordx4 a[176:179], v225, s[4:7], s40 offen offset:0 sc1
  s_waitcnt lgkmcnt(13)
  v_mfma_f32_16x16x32_bf16 v[104:107], a[192:195], a[64:67], v[104:107]
  ds_read_b64_tr_b16 a[230:231], v234 offset:22528
  v_mfma_f32_16x16x32_bf16 v[104:107], a[196:199], a[80:83], v[104:107]
  ds_read_b64_tr_b16 a[232:233], v235 offset:8192
  ds_read_b64_tr_b16 a[234:235], v235 offset:10240
  v_mfma_f32_16x16x32_bf16 v[136:139], a[192:195], a[68:71], v[136:139]
  v_mfma_f32_16x16x32_bf16 v[136:139], a[196:199], a[84:87], v[136:139]
  v_mfma_f32_16x16x32_bf16 v[168:171], a[192:195], a[72:75], v[168:171]
  v_mfma_f32_16x16x32_bf16 v[168:171], a[196:199], a[88:91], v[168:171]
  buffer_load_dwordx4 a[180:183], v225, s[4:7], s40 offen offset:1024 sc1
  v_mfma_f32_16x16x32_bf16 v[200:203], a[192:195], a[76:79], v[200:203]
  ds_read_b64_tr_b16 a[192:193], v235 offset:20480
  v_mfma_f32_16x16x32_bf16 v[200:203], a[196:199], a[92:95], v[200:203]
  ds_read_b64_tr_b16 a[194:195], v235 offset:22528
  s_load_dwordx2 s[66:67], s[36:37], 0xc0000
  v_mfma_f32_16x16x32_bf16 v[204:207], a[200:203], a[76:79], v[204:207]
  ds_read_b64_tr_b16 a[196:197], v232 offset:36864
  s_waitcnt lgkmcnt(13)
  v_mfma_f32_16x16x32_bf16 v[204:207], a[204:207], a[92:95], v[204:207]
  s_waitcnt vmcnt(28)
  s_barrier
  v_mfma_f32_16x16x32_bf16 v[172:175], a[200:203], a[72:75], v[172:175]
  ds_read_b64_tr_b16 a[198:199], v232 offset:38912
  v_mfma_f32_16x16x32_bf16 v[172:175], a[204:207], a[88:91], v[172:175]
  buffer_load_dwordx4 a[184:187], v225, s[4:7], s40 offen offset:2048 sc1
  v_mfma_f32_16x16x32_bf16 v[140:143], a[200:203], a[68:71], v[140:143]
  v_mfma_f32_16x16x32_bf16 v[140:143], a[204:207], a[84:87], v[140:143]
  v_mfma_f32_16x16x32_bf16 v[108:111], a[200:203], a[64:67], v[108:111]
  ds_read_b64_tr_b16 a[200:201], v232 offset:32768
  v_mfma_f32_16x16x32_bf16 v[108:111], a[204:207], a[80:83], v[108:111]
  ds_read_b64_tr_b16 a[202:203], v232 offset:34816
  v_mfma_f32_16x16x32_bf16 v[112:115], a[208:211], a[64:67], v[112:115]
  ds_read_b64_tr_b16 a[204:205], v233 offset:36864
  v_mfma_f32_16x16x32_bf16 v[112:115], a[212:215], a[80:83], v[112:115]
  buffer_load_dwordx4 a[188:191], v225, s[4:7], s40 offen offset:3072 sc1
  v_mfma_f32_16x16x32_bf16 v[144:147], a[208:211], a[68:71], v[144:147]
  ds_read_b64_tr_b16 a[206:207], v233 offset:38912
  s_mov_b32 s41, 6881280
  v_mfma_f32_16x16x32_bf16 v[144:147], a[212:215], a[84:87], v[144:147]
  s_add_u32 m0, s42, 45056
  v_mfma_f32_16x16x32_bf16 v[176:179], a[208:211], a[72:75], v[176:179]
  v_mfma_f32_16x16x32_bf16 v[176:179], a[212:215], a[88:91], v[176:179]
  v_mfma_f32_16x16x32_bf16 v[208:211], a[208:211], a[76:79], v[208:211]
  ds_read_b64_tr_b16 a[208:209], v233 offset:32768
  v_mfma_f32_16x16x32_bf16 v[208:211], a[212:215], a[92:95], v[208:211]
  buffer_load_dwordx4 v227, s[12:15], s41 offen offset:0 lds
  s_waitcnt lgkmcnt(13)
  v_mfma_f32_16x16x32_bf16 v[212:215], a[216:219], a[76:79], v[212:215]
  ds_read_b64_tr_b16 a[210:211], v233 offset:34816
  s_mov_b32 s41, 7110656
  v_mfma_f32_16x16x32_bf16 v[212:215], a[220:223], a[92:95], v[212:215]
  ds_read_b64_tr_b16 a[212:213], v232 offset:45056
  ds_read_b64_tr_b16 a[214:215], v232 offset:47104
  v_mfma_f32_16x16x32_bf16 v[180:183], a[216:219], a[72:75], v[180:183]
  s_add_u32 m0, s42, 36864
  v_mfma_f32_16x16x32_bf16 v[180:183], a[220:223], a[88:91], v[180:183]
  v_mfma_f32_16x16x32_bf16 v[148:151], a[216:219], a[68:71], v[148:151]
  v_mfma_f32_16x16x32_bf16 v[148:151], a[220:223], a[84:87], v[148:151]
  buffer_load_dwordx4 v227, s[12:15], s41 offen offset:0 lds
  s_load_dwordx2 s[66:67], s[36:37], 0xe0000
  v_mfma_f32_16x16x32_bf16 v[116:119], a[216:219], a[64:67], v[116:119]
  ds_read_b64_tr_b16 a[216:217], v232 offset:61440
  s_mov_b32 s41, 6881280
  v_mfma_f32_16x16x32_bf16 v[116:119], a[220:223], a[80:83], v[116:119]
  ds_read_b64_tr_b16 a[218:219], v232 offset:63488
  s_add_u32 m0, s42, 49152
  v_mfma_f32_16x16x32_bf16 v[120:123], a[224:227], a[64:67], v[120:123]
  ds_read_b64_tr_b16 a[220:221], v233 offset:45056
  s_waitcnt lgkmcnt(13)
  v_mfma_f32_16x16x32_bf16 v[120:123], a[228:231], a[80:83], v[120:123]
  ds_read_b64_tr_b16 a[222:223], v233 offset:47104
  v_mfma_f32_16x16x32_bf16 v[152:155], a[224:227], a[68:71], v[152:155]
  v_mfma_f32_16x16x32_bf16 v[152:155], a[228:231], a[84:87], v[152:155]
  buffer_load_dwordx4 v227, s[16:19], s41 offen offset:0 lds
  v_mfma_f32_16x16x32_bf16 v[184:187], a[224:227], a[72:75], v[184:187]
  s_mov_b32 s41, 7110656
  s_add_u32 m0, s42, 32768
  v_mfma_f32_16x16x32_bf16 v[184:187], a[228:231], a[88:91], v[184:187]
  v_mfma_f32_16x16x32_bf16 v[216:219], a[224:227], a[76:79], v[216:219]
  ds_read_b64_tr_b16 a[224:225], v233 offset:61440
  v_mfma_f32_16x16x32_bf16 v[216:219], a[228:231], a[92:95], v[216:219]
  ds_read_b64_tr_b16 a[226:227], v233 offset:63488
  v_mfma_f32_16x16x32_bf16 v[220:223], a[232:235], a[76:79], v[220:223]
  ds_read_b64_tr_b16 a[228:229], v234 offset:36864
  v_mfma_f32_16x16x32_bf16 v[220:223], a[192:195], a[92:95], v[220:223]
  buffer_load_dwordx4 v227, s[16:19], s41 offen offset:0 lds
  v_mfma_f32_16x16x32_bf16 v[188:191], a[232:235], a[72:75], v[188:191]
  ds_read_b64_tr_b16 a[230:231], v234 offset:38912
  s_mov_b32 s40, 13107200
  v_mfma_f32_16x16x32_bf16 v[188:191], a[192:195], a[88:91], v[188:191]
  v_mfma_f32_16x16x32_bf16 v[156:159], a[232:235], a[68:71], v[156:159]
  v_mfma_f32_16x16x32_bf16 v[156:159], a[192:195], a[84:87], v[156:159]
  v_mfma_f32_16x16x32_bf16 v[124:127], a[232:235], a[64:67], v[124:127]
  ds_read_b64_tr_b16 a[232:233], v234 offset:32768
  v_mfma_f32_16x16x32_bf16 v[124:127], a[192:195], a[80:83], v[124:127]
  buffer_load_dwordx4 a[0:3], v225, s[4:7], s40 offen offset:0 sc1
  s_waitcnt lgkmcnt(13)
  v_mfma_f32_16x16x32_bf16 v[0:3], a[196:199], a[96:99], v[0:3]
  ds_read_b64_tr_b16 a[234:235], v234 offset:34816
  s_waitcnt vmcnt(31)
  v_mfma_f32_16x16x32_bf16 v[0:3], a[200:203], a[112:115], v[0:3]
  ds_read_b64_tr_b16 a[192:193], v234 offset:45056
  ds_read_b64_tr_b16 a[194:195], v234 offset:47104
  v_mfma_f32_16x16x32_bf16 v[16:19], a[196:199], a[100:103], v[16:19]
  v_mfma_f32_16x16x32_bf16 v[16:19], a[200:203], a[116:119], v[16:19]
  v_mfma_f32_16x16x32_bf16 v[32:35], a[196:199], a[104:107], v[32:35]
  v_mfma_f32_16x16x32_bf16 v[32:35], a[200:203], a[120:123], v[32:35]
  buffer_load_dwordx4 a[4:7], v225, s[4:7], s40 offen offset:1024 sc1
  v_mfma_f32_16x16x32_bf16 v[48:51], a[196:199], a[108:111], v[48:51]
  ds_read_b64_tr_b16 a[196:197], v234 offset:61440
  v_mfma_f32_16x16x32_bf16 v[48:51], a[200:203], a[124:127], v[48:51]
  ds_read_b64_tr_b16 a[198:199], v234 offset:63488
  v_mfma_f32_16x16x32_bf16 v[52:55], a[204:207], a[108:111], v[52:55]
  ds_read_b64_tr_b16 a[200:201], v232 offset:57344
  s_waitcnt lgkmcnt(13)
  v_mfma_f32_16x16x32_bf16 v[52:55], a[208:211], a[124:127], v[52:55]
  ds_read_b64_tr_b16 a[202:203], v232 offset:59392
L_wk1_5:
  s_cbranch_vccnz L_wk1_9
  v_mfma_f32_16x16x32_bf16 v[36:39], a[204:207], a[104:107], v[36:39]
  v_mfma_f32_16x16x32_bf16 v[36:39], a[208:211], a[120:123], v[36:39]
  buffer_load_dwordx4 a[8:11], v225, s[4:7], s40 offen offset:2048 sc1
  v_mfma_f32_16x16x32_bf16 v[20:23], a[204:207], a[100:103], v[20:23]
  v_mfma_f32_16x16x32_bf16 v[20:23], a[208:211], a[116:119], v[20:23]
  v_mfma_f32_16x16x32_bf16 v[4:7], a[204:207], a[96:99], v[4:7]
  ds_read_b64_tr_b16 a[204:205], v236 offset:4096
  v_mfma_f32_16x16x32_bf16 v[4:7], a[208:211], a[112:115], v[4:7]
  ds_read_b64_tr_b16 a[206:207], v236 offset:6144
  v_mfma_f32_16x16x32_bf16 v[8:11], a[212:215], a[96:99], v[8:11]
  ds_read_b64_tr_b16 a[208:209], v233 offset:57344
  v_mfma_f32_16x16x32_bf16 v[8:11], a[216:219], a[112:115], v[8:11]
  s_waitcnt vmcnt(28)
  s_barrier
  v_mfma_f32_16x16x32_bf16 v[24:27], a[212:215], a[100:103], v[24:27]
  buffer_load_dwordx4 a[12:15], v225, s[4:7], s40 offen offset:3072 sc1
  v_mfma_f32_16x16x32_bf16 v[24:27], a[216:219], a[116:119], v[24:27]
  ds_read_b64_tr_b16 a[210:211], v233 offset:59392
  s_mov_b32 s40, 13238272
  v_mfma_f32_16x16x32_bf16 v[40:43], a[212:215], a[104:107], v[40:43]
  v_mfma_f32_16x16x32_bf16 v[40:43], a[216:219], a[120:123], v[40:43]
  v_mfma_f32_16x16x32_bf16 v[56:59], a[212:215], a[108:111], v[56:59]
  ds_read_b64_tr_b16 a[212:213], v237 offset:4096
  v_mfma_f32_16x16x32_bf16 v[56:59], a[216:219], a[124:127], v[56:59]
  buffer_load_dwordx4 a[16:19], v225, s[4:7], s40 offen offset:0 sc1
  s_waitcnt lgkmcnt(13)
  v_mfma_f32_16x16x32_bf16 v[60:63], a[220:223], a[108:111], v[60:63]
  ds_read_b64_tr_b16 a[214:215], v237 offset:6144
  v_mfma_f32_16x16x32_bf16 v[60:63], a[224:227], a[124:127], v[60:63]
  ds_read_b64_tr_b16 a[216:217], v236 offset:20480
  ds_read_b64_tr_b16 a[218:219], v236 offset:22528
  v_mfma_f32_16x16x32_bf16 v[44:47], a[220:223], a[104:107], v[44:47]
  v_mfma_f32_16x16x32_bf16 v[44:47], a[224:227], a[120:123], v[44:47]
  v_mfma_f32_16x16x32_bf16 v[28:31], a[220:223], a[100:103], v[28:31]
  v_mfma_f32_16x16x32_bf16 v[28:31], a[224:227], a[116:119], v[28:31]
  buffer_load_dwordx4 a[20:23], v225, s[4:7], s40 offen offset:1024 sc1
  v_mfma_f32_16x16x32_bf16 v[12:15], a[220:223], a[96:99], v[12:15]
  ds_read_b64_tr_b16 a[220:221], v236 offset:16384
  v_mfma_f32_16x16x32_bf16 v[12:15], a[224:227], a[112:115], v[12:15]
  ds_read_b64_tr_b16 a[222:223], v236 offset:18432
  v_mfma_f32_16x16x32_bf16 v[64:67], a[228:231], a[96:99], v[64:67]
  ds_read_b64_tr_b16 a[224:225], v237 offset:20480
  s_waitcnt lgkmcnt(13)
  v_mfma_f32_16x16x32_bf16 v[64:67], a[232:235], a[112:115], v[64:67]
  ds_read_b64_tr_b16 a[226:227], v237 offset:22528
  v_mfma_f32_16x16x32_bf16 v[72:75], a[228:231], a[100:103], v[72:75]
  v_mfma_f32_16x16x32_bf16 v[72:75], a[232:235], a[116:119], v[72:75]
  buffer_load_dwordx4 a[24:27], v225, s[4:7], s40 offen offset:2048 sc1
  v_mfma_f32_16x16x32_bf16 v[80:83], a[228:231], a[104:107], v[80:83]
  v_mfma_f32_16x16x32_bf16 v[80:83], a[232:235], a[120:123], v[80:83]
  v_mfma_f32_16x16x32_bf16 v[88:91], a[228:231], a[108:111], v[88:91]
  ds_read_b64_tr_b16 a[228:229], v237 offset:16384
  v_mfma_f32_16x16x32_bf16 v[88:91], a[232:235], a[124:127], v[88:91]
  ds_read_b64_tr_b16 a[230:231], v237 offset:18432
  v_mfma_f32_16x16x32_bf16 v[92:95], a[192:195], a[108:111], v[92:95]
  ds_read_b64_tr_b16 a[232:233], v234 offset:57344
  v_mfma_f32_16x16x32_bf16 v[92:95], a[196:199], a[124:127], v[92:95]
  buffer_load_dwordx4 a[28:31], v225, s[4:7], s40 offen offset:3072 sc1
  v_mfma_f32_16x16x32_bf16 v[84:87], a[192:195], a[104:107], v[84:87]
  ds_read_b64_tr_b16 a[234:235], v234 offset:59392
  s_mov_b32 s41, 5046272
  v_mfma_f32_16x16x32_bf16 v[84:87], a[196:199], a[120:123], v[84:87]
  s_add_u32 m0, s42, 40960
  v_mfma_f32_16x16x32_bf16 v[76:79], a[192:195], a[100:103], v[76:79]
  v_mfma_f32_16x16x32_bf16 v[76:79], a[196:199], a[116:119], v[76:79]
  v_mfma_f32_16x16x32_bf16 v[68:71], a[192:195], a[96:99], v[68:71]
  ds_read_b64_tr_b16 a[192:193], v238 offset:4096
  v_mfma_f32_16x16x32_bf16 v[68:71], a[196:199], a[112:115], v[68:71]
  buffer_load_dwordx4 v226, s[12:15], s41 offen offset:0 lds
  s_waitcnt vmcnt(30) lgkmcnt(13)
  v_mfma_f32_16x16x32_bf16 v[0:3], a[200:203], a[128:131], v[0:3]
  ds_read_b64_tr_b16 a[194:195], v238 offset:6144
  s_mov_b32 s41, 5275648
  s_waitcnt vmcnt(26)
  v_mfma_f32_16x16x32_bf16 v[0:3], a[204:207], a[144:147], v[0:3]
  ds_read_b64_tr_b16 a[196:197], v238 offset:20480
  ds_read_b64_tr_b16 a[198:199], v238 offset:22528
  v_mfma_f32_16x16x32_bf16 v[16:19], a[200:203], a[132:135], v[16:19]
  s_add_u32 m0, s42, 53248
  v_mfma_f32_16x16x32_bf16 v[16:19], a[204:207], a[148:151], v[16:19]
  v_mfma_f32_16x16x32_bf16 v[32:35], a[200:203], a[136:139], v[32:35]
  v_mfma_f32_16x16x32_bf16 v[32:35], a[204:207], a[152:155], v[32:35]
  buffer_load_dwordx4 v226, s[12:15], s41 offen offset:0 lds
  v_mfma_f32_16x16x32_bf16 v[48:51], a[200:203], a[140:143], v[48:51]
  ds_read_b64_tr_b16 a[200:201], v238 offset:16384
  s_mov_b32 s41, 5046272
  v_mfma_f32_16x16x32_bf16 v[48:51], a[204:207], a[156:159], v[48:51]
  ds_read_b64_tr_b16 a[202:203], v238 offset:18432
  s_add_u32 m0, s42, 57344
  v_mfma_f32_16x16x32_bf16 v[52:55], a[208:211], a[140:143], v[52:55]
  ds_read_b64_tr_b16 a[204:205], v236 offset:28672
  s_waitcnt lgkmcnt(13)
  v_mfma_f32_16x16x32_bf16 v[52:55], a[212:215], a[156:159], v[52:55]
  ds_read_b64_tr_b16 a[206:207], v236 offset:30720
  v_mfma_f32_16x16x32_bf16 v[36:39], a[208:211], a[136:139], v[36:39]
  v_mfma_f32_16x16x32_bf16 v[36:39], a[212:215], a[152:155], v[36:39]
  buffer_load_dwordx4 v226, s[16:19], s41 offen offset:0 lds
  v_mfma_f32_16x16x32_bf16 v[20:23], a[208:211], a[132:135], v[20:23]
  s_mov_b32 s41, 5275648
  s_add_u32 m0, s42, 65536
  v_mfma_f32_16x16x32_bf16 v[20:23], a[212:215], a[148:151], v[20:23]
  v_mfma_f32_16x16x32_bf16 v[4:7], a[208:211], a[128:131], v[4:7]
  ds_read_b64_tr_b16 a[208:209], v228 offset:16384
  v_mfma_f32_16x16x32_bf16 v[4:7], a[212:215], a[144:147], v[4:7]
  ds_read_b64_tr_b16 a[210:211], v228 offset:18432
  v_mfma_f32_16x16x32_bf16 v[8:11], a[216:219], a[128:131], v[8:11]
  ds_read_b64_tr_b16 a[212:213], v237 offset:28672
  v_mfma_f32_16x16x32_bf16 v[8:11], a[220:223], a[144:147], v[8:11]
  buffer_load_dwordx4 v226, s[16:19], s41 offen offset:0 lds
  v_mfma_f32_16x16x32_bf16 v[24:27], a[216:219], a[132:135], v[24:27]
  ds_read_b64_tr_b16 a[214:215], v237 offset:30720
  s_mov_b32 s41, 5505024
  v_mfma_f32_16x16x32_bf16 v[24:27], a[220:223], a[148:151], v[24:27]
  s_add_u32 m0, s42, 94208
  v_mfma_f32_16x16x32_bf16 v[40:43], a[216:219], a[136:139], v[40:43]
  v_mfma_f32_16x16x32_bf16 v[40:43], a[220:223], a[152:155], v[40:43]
  v_mfma_f32_16x16x32_bf16 v[56:59], a[216:219], a[140:143], v[56:59]
  ds_read_b64_tr_b16 a[216:217], v229 offset:16384
  v_mfma_f32_16x16x32_bf16 v[56:59], a[220:223], a[156:159], v[56:59]
  buffer_load_dwordx4 v226, s[12:15], s41 offen offset:0 lds
  s_waitcnt lgkmcnt(13)
  v_mfma_f32_16x16x32_bf16 v[60:63], a[224:227], a[140:143], v[60:63]
  ds_read_b64_tr_b16 a[218:219], v229 offset:18432
  s_mov_b32 s41, 5734400
  v_mfma_f32_16x16x32_bf16 v[60:63], a[228:231], a[156:159], v[60:63]
  s_waitcnt vmcnt(25)
  s_barrier
  v_mfma_f32_16x16x32_bf16 v[44:47], a[224:227], a[136:139], v[44:47]
  ds_read_b64_tr_b16 a[220:221], v228 offset:28672
  ds_read_b64_tr_b16 a[222:223], v228 offset:30720
  v_mfma_f32_16x16x32_bf16 v[44:47], a[228:231], a[152:155], v[44:47]
  s_add_u32 m0, s42, 106496
  v_mfma_f32_16x16x32_bf16 v[28:31], a[224:227], a[132:135], v[28:31]
  v_mfma_f32_16x16x32_bf16 v[28:31], a[228:231], a[148:151], v[28:31]
  buffer_load_dwordx4 v226, s[12:15], s41 offen offset:0 lds
  v_mfma_f32_16x16x32_bf16 v[12:15], a[224:227], a[128:131], v[12:15]
  ds_read_b64_tr_b16 a[224:225], v236 offset:8192
  s_mov_b32 s40, 13369344
  v_mfma_f32_16x16x32_bf16 v[12:15], a[228:231], a[144:147], v[12:15]
  ds_read_b64_tr_b16 a[226:227], v236 offset:10240
  v_mfma_f32_16x16x32_bf16 v[64:67], a[232:235], a[128:131], v[64:67]
  ds_read_b64_tr_b16 a[228:229], v229 offset:28672
  s_waitcnt lgkmcnt(13)
  v_mfma_f32_16x16x32_bf16 v[64:67], a[192:195], a[144:147], v[64:67]
  ds_read_b64_tr_b16 a[230:231], v229 offset:30720
  v_mfma_f32_16x16x32_bf16 v[72:75], a[232:235], a[132:135], v[72:75]
  v_mfma_f32_16x16x32_bf16 v[72:75], a[192:195], a[148:151], v[72:75]
  buffer_load_dwordx4 a[32:35], v225, s[4:7], s40 offen offset:0 sc1
  v_mfma_f32_16x16x32_bf16 v[80:83], a[232:235], a[136:139], v[80:83]
  v_mfma_f32_16x16x32_bf16 v[80:83], a[192:195], a[152:155], v[80:83]
  v_mfma_f32_16x16x32_bf16 v[88:91], a[232:235], a[140:143], v[88:91]
  ds_read_b64_tr_b16 a[232:233], v237 offset:8192
  v_mfma_f32_16x16x32_bf16 v[88:91], a[192:195], a[156:159], v[88:91]
  ds_read_b64_tr_b16 a[234:235], v237 offset:10240
  v_mfma_f32_16x16x32_bf16 v[92:95], a[196:199], a[140:143], v[92:95]
  ds_read_b64_tr_b16 a[192:193], v238 offset:28672
  v_mfma_f32_16x16x32_bf16 v[92:95], a[200:203], a[156:159], v[92:95]
  buffer_load_dwordx4 a[36:39], v225, s[4:7], s40 offen offset:1024 sc1
  v_mfma_f32_16x16x32_bf16 v[84:87], a[196:199], a[136:139], v[84:87]
  ds_read_b64_tr_b16 a[194:195], v238 offset:30720
  v_mfma_f32_16x16x32_bf16 v[84:87], a[200:203], a[152:155], v[84:87]
  v_mfma_f32_16x16x32_bf16 v[76:79], a[196:199], a[132:135], v[76:79]
  v_mfma_f32_16x16x32_bf16 v[76:79], a[200:203], a[148:151], v[76:79]
  v_mfma_f32_16x16x32_bf16 v[68:71], a[196:199], a[128:131], v[68:71]
  ds_read_b64_tr_b16 a[196:197], v230 offset:16384
  v_mfma_f32_16x16x32_bf16 v[68:71], a[200:203], a[144:147], v[68:71]
  buffer_load_dwordx4 a[40:43], v225, s[4:7], s40 offen offset:2048 sc1
  s_waitcnt vmcnt(25) lgkmcnt(13)
  v_mfma_f32_16x16x32_bf16 v[0:3], a[204:207], a[160:163], v[0:3]
  ds_read_b64_tr_b16 a[198:199], v230 offset:18432
  s_waitcnt vmcnt(21)
  v_mfma_f32_16x16x32_bf16 v[0:3], a[208:211], a[176:179], v[0:3]
  ds_read_b64_tr_b16 a[200:201], v230 offset:28672
  ds_read_b64_tr_b16 a[202:203], v230 offset:30720
  v_mfma_f32_16x16x32_bf16 v[16:19], a[204:207], a[164:167], v[16:19]
  v_mfma_f32_16x16x32_bf16 v[16:19], a[208:211], a[180:183], v[16:19]
  v_mfma_f32_16x16x32_bf16 v[32:35], a[204:207], a[168:171], v[32:35]
  v_mfma_f32_16x16x32_bf16 v[32:35], a[208:211], a[184:187], v[32:35]
  buffer_load_dwordx4 a[44:47], v225, s[4:7], s40 offen offset:3072 sc1
  v_mfma_f32_16x16x32_bf16 v[48:51], a[204:207], a[172:175], v[48:51]
  ds_read_b64_tr_b16 a[204:205], v238 offset:8192
  s_mov_b32 s40, 13500416
  v_mfma_f32_16x16x32_bf16 v[48:51], a[208:211], a[188:191], v[48:51]
  ds_read_b64_tr_b16 a[206:207], v238 offset:10240
  v_mfma_f32_16x16x32_bf16 v[52:55], a[212:215], a[172:175], v[52:55]
  ds_read_b64_tr_b16 a[208:209], v236 offset:24576
  s_waitcnt lgkmcnt(13)
  v_mfma_f32_16x16x32_bf16 v[52:55], a[216:219], a[188:191], v[52:55]
  ds_read_b64_tr_b16 a[210:211], v236 offset:26624
  v_mfma_f32_16x16x32_bf16 v[36:39], a[212:215], a[168:171], v[36:39]
  v_mfma_f32_16x16x32_bf16 v[36:39], a[216:219], a[184:187], v[36:39]
  buffer_load_dwordx4 a[48:51], v225, s[4:7], s40 offen offset:0 sc1
  v_mfma_f32_16x16x32_bf16 v[20:23], a[212:215], a[164:167], v[20:23]
  v_mfma_f32_16x16x32_bf16 v[20:23], a[216:219], a[180:183], v[20:23]
  v_mfma_f32_16x16x32_bf16 v[4:7], a[212:215], a[160:163], v[4:7]
  ds_read_b64_tr_b16 a[212:213], v228 offset:20480
  v_mfma_f32_16x16x32_bf16 v[4:7], a[216:219], a[176:179], v[4:7]
  ds_read_b64_tr_b16 a[214:215], v228 offset:22528
  v_mfma_f32_16x16x32_bf16 v[8:11], a[220:223], a[160:163], v[8:11]
  ds_read_b64_tr_b16 a[216:217], v237 offset:24576
  v_mfma_f32_16x16x32_bf16 v[8:11], a[224:227], a[176:179], v[8:11]
  buffer_load_dwordx4 a[52:55], v225, s[4:7], s40 offen offset:1024 sc1
  v_mfma_f32_16x16x32_bf16 v[24:27], a[220:223], a[164:167], v[24:27]
  ds_read_b64_tr_b16 a[218:219], v237 offset:26624
  v_mfma_f32_16x16x32_bf16 v[24:27], a[224:227], a[180:183], v[24:27]
  v_mfma_f32_16x16x32_bf16 v[40:43], a[220:223], a[168:171], v[40:43]
  v_mfma_f32_16x16x32_bf16 v[40:43], a[224:227], a[184:187], v[40:43]
  v_mfma_f32_16x16x32_bf16 v[56:59], a[220:223], a[172:175], v[56:59]
  ds_read_b64_tr_b16 a[220:221], v229 offset:20480
  v_mfma_f32_16x16x32_bf16 v[56:59], a[224:227], a[188:191], v[56:59]
  buffer_load_dwordx4 a[56:59], v225, s[4:7], s40 offen offset:2048 sc1
  s_waitcnt lgkmcnt(13)
  v_mfma_f32_16x16x32_bf16 v[60:63], a[228:231], a[172:175], v[60:63]
  ds_read_b64_tr_b16 a[222:223], v229 offset:22528
  v_mfma_f32_16x16x32_bf16 v[60:63], a[232:235], a[188:191], v[60:63]
  ds_read_b64_tr_b16 a[224:225], v228 offset:12288
  ds_read_b64_tr_b16 a[226:227], v228 offset:14336
  v_mfma_f32_16x16x32_bf16 v[44:47], a[228:231], a[168:171], v[44:47]
  v_mfma_f32_16x16x32_bf16 v[44:47], a[232:235], a[184:187], v[44:47]
  v_mfma_f32_16x16x32_bf16 v[28:31], a[228:231], a[164:167], v[28:31]
  v_mfma_f32_16x16x32_bf16 v[28:31], a[232:235], a[180:183], v[28:31]
  buffer_load_dwordx4 a[60:63], v225, s[4:7], s40 offen offset:3072 sc1
  v_mfma_f32_16x16x32_bf16 v[12:15], a[228:231], a[160:163], v[12:15]
  ds_read_b64_tr_b16 a[228:229], v228 offset:24576
  s_mov_b32 s41, 5505024
  v_mfma_f32_16x16x32_bf16 v[12:15], a[232:235], a[176:179], v[12:15]
  ds_read_b64_tr_b16 a[230:231], v228 offset:26624
  s_add_u32 m0, s42, 114688
  v_mfma_f32_16x16x32_bf16 v[64:67], a[192:195], a[160:163], v[64:67]
  ds_read_b64_tr_b16 a[232:233], v229 offset:12288
  s_waitcnt lgkmcnt(13)
  v_mfma_f32_16x16x32_bf16 v[64:67], a[196:199], a[176:179], v[64:67]
  s_waitcnt vmcnt(22)
  s_barrier
  v_mfma_f32_16x16x32_bf16 v[72:75], a[192:195], a[164:167], v[72:75]
  ds_read_b64_tr_b16 a[234:235], v229 offset:14336
  v_mfma_f32_16x16x32_bf16 v[72:75], a[196:199], a[180:183], v[72:75]
  buffer_load_dwordx4 v226, s[16:19], s41 offen offset:0 lds
  v_mfma_f32_16x16x32_bf16 v[80:83], a[192:195], a[168:171], v[80:83]
  s_mov_b32 s41, 5734400
  s_add_u32 m0, s42, 143360
  v_mfma_f32_16x16x32_bf16 v[80:83], a[196:199], a[184:187], v[80:83]
  v_mfma_f32_16x16x32_bf16 v[88:91], a[192:195], a[172:175], v[88:91]
  ds_read_b64_tr_b16 a[192:193], v229 offset:24576
  v_mfma_f32_16x16x32_bf16 v[88:91], a[196:199], a[188:191], v[88:91]
  ds_read_b64_tr_b16 a[194:195], v229 offset:26624
  v_mfma_f32_16x16x32_bf16 v[92:95], a[200:203], a[172:175], v[92:95]
  ds_read_b64_tr_b16 a[196:197], v238 offset:24576
  v_mfma_f32_16x16x32_bf16 v[92:95], a[204:207], a[188:191], v[92:95]
  buffer_load_dwordx4 v226, s[16:19], s41 offen offset:0 lds
  v_mfma_f32_16x16x32_bf16 v[84:87], a[200:203], a[168:171], v[84:87]
  ds_read_b64_tr_b16 a[198:199], v238 offset:26624
  s_mov_b32 s41, 5963776
  v_mfma_f32_16x16x32_bf16 v[84:87], a[204:207], a[184:187], v[84:87]
  s_add_u32 m0, s42, 69632
  v_mfma_f32_16x16x32_bf16 v[76:79], a[200:203], a[164:167], v[76:79]
  v_mfma_f32_16x16x32_bf16 v[76:79], a[204:207], a[180:183], v[76:79]
  v_mfma_f32_16x16x32_bf16 v[68:71], a[200:203], a[160:163], v[68:71]
  ds_read_b64_tr_b16 a[200:201], v230 offset:20480
  v_mfma_f32_16x16x32_bf16 v[68:71], a[204:207], a[176:179], v[68:71]
  buffer_load_dwordx4 v226, s[12:15], s41 offen offset:0 lds
  s_waitcnt vmcnt(21) lgkmcnt(13)
  v_mfma_f32_16x16x32_bf16 v[0:3], a[208:211], a[0:3], v[0:3]
  ds_read_b64_tr_b16 a[202:203], v230 offset:22528
  s_mov_b32 s41, 6193152
  s_waitcnt vmcnt(17)
  v_mfma_f32_16x16x32_bf16 v[0:3], a[212:215], a[16:19], v[0:3]
  ds_read_b64_tr_b16 a[204:205], v230 offset:12288
  ds_read_b64_tr_b16 a[206:207], v230 offset:14336
  v_mfma_f32_16x16x32_bf16 v[16:19], a[208:211], a[4:7], v[16:19]
  s_add_u32 m0, s42, 81920
  v_mfma_f32_16x16x32_bf16 v[16:19], a[212:215], a[20:23], v[16:19]
  v_mfma_f32_16x16x32_bf16 v[32:35], a[208:211], a[8:11], v[32:35]
  v_mfma_f32_16x16x32_bf16 v[32:35], a[212:215], a[24:27], v[32:35]
  buffer_load_dwordx4 v226, s[12:15], s41 offen offset:0 lds
  v_mfma_f32_16x16x32_bf16 v[48:51], a[208:211], a[12:15], v[48:51]
  ds_read_b64_tr_b16 a[208:209], v230 offset:24576
  s_mov_b32 s41, 5963776
  v_mfma_f32_16x16x32_bf16 v[48:51], a[212:215], a[28:31], v[48:51]
  ds_read_b64_tr_b16 a[210:211], v230 offset:26624
  s_add_u32 m0, s42, 61440
  v_mfma_f32_16x16x32_bf16 v[52:55], a[216:219], a[12:15], v[52:55]
  ds_read_b64_tr_b16 a[212:213], v228 offset:45056
  s_waitcnt lgkmcnt(13)
  v_mfma_f32_16x16x32_bf16 v[52:55], a[220:223], a[28:31], v[52:55]
  ds_read_b64_tr_b16 a[214:215], v228 offset:47104
  v_mfma_f32_16x16x32_bf16 v[36:39], a[216:219], a[8:11], v[36:39]
  v_mfma_f32_16x16x32_bf16 v[36:39], a[220:223], a[24:27], v[36:39]
  buffer_load_dwordx4 v226, s[16:19], s41 offen offset:0 lds
  v_mfma_f32_16x16x32_bf16 v[20:23], a[216:219], a[4:7], v[20:23]
  s_mov_b32 s41, 6193152
  s_add_u32 m0, s42, 90112
  v_mfma_f32_16x16x32_bf16 v[20:23], a[220:223], a[20:23], v[20:23]
  v_mfma_f32_16x16x32_bf16 v[4:7], a[216:219], a[0:3], v[4:7]
  ds_read_b64_tr_b16 a[216:217], v228 offset:36864
  v_mfma_f32_16x16x32_bf16 v[4:7], a[220:223], a[16:19], v[4:7]
  ds_read_b64_tr_b16 a[218:219], v228 offset:38912
  v_mfma_f32_16x16x32_bf16 v[8:11], a[224:227], a[0:3], v[8:11]
  ds_read_b64_tr_b16 a[220:221], v229 offset:45056
  v_mfma_f32_16x16x32_bf16 v[8:11], a[228:231], a[16:19], v[8:11]
  buffer_load_dwordx4 v226, s[16:19], s41 offen offset:0 lds
  v_mfma_f32_16x16x32_bf16 v[24:27], a[224:227], a[4:7], v[24:27]
  ds_read_b64_tr_b16 a[222:223], v229 offset:47104
  s_mov_b32 s41, 6422528
  v_mfma_f32_16x16x32_bf16 v[24:27], a[228:231], a[20:23], v[24:27]
  s_add_u32 m0, s42, 118784
  v_mfma_f32_16x16x32_bf16 v[40:43], a[224:227], a[8:11], v[40:43]
  v_mfma_f32_16x16x32_bf16 v[40:43], a[228:231], a[24:27], v[40:43]
  v_mfma_f32_16x16x32_bf16 v[56:59], a[224:227], a[12:15], v[56:59]
  ds_read_b64_tr_b16 a[224:225], v229 offset:36864
  v_mfma_f32_16x16x32_bf16 v[56:59], a[228:231], a[28:31], v[56:59]
  buffer_load_dwordx4 v226, s[12:15], s41 offen offset:0 lds
  s_waitcnt lgkmcnt(13)
  v_mfma_f32_16x16x32_bf16 v[60:63], a[232:235], a[12:15], v[60:63]
  ds_read_b64_tr_b16 a[226:227], v229 offset:38912
  s_mov_b32 s41, 6651904
  v_mfma_f32_16x16x32_bf16 v[60:63], a[192:195], a[28:31], v[60:63]
  ds_read_b64_tr_b16 a[228:229], v228 offset:49152
  ds_read_b64_tr_b16 a[230:231], v228 offset:51200
  v_mfma_f32_16x16x32_bf16 v[44:47], a[232:235], a[8:11], v[44:47]
  s_add_u32 m0, s42, 131072
  v_mfma_f32_16x16x32_bf16 v[44:47], a[192:195], a[24:27], v[44:47]
  v_mfma_f32_16x16x32_bf16 v[28:31], a[232:235], a[4:7], v[28:31]
  v_mfma_f32_16x16x32_bf16 v[28:31], a[192:195], a[20:23], v[28:31]
  buffer_load_dwordx4 v226, s[12:15], s41 offen offset:0 lds
  v_mfma_f32_16x16x32_bf16 v[12:15], a[232:235], a[0:3], v[12:15]
  ds_read_b64_tr_b16 a[232:233], v228 offset:32768
  s_mov_b32 s41, 6422528
  v_mfma_f32_16x16x32_bf16 v[12:15], a[192:195], a[16:19], v[12:15]
  ds_read_b64_tr_b16 a[234:235], v228 offset:34816
  s_add_u32 m0, s42, 77824
  v_mfma_f32_16x16x32_bf16 v[64:67], a[196:199], a[0:3], v[64:67]
  ds_read_b64_tr_b16 a[192:193], v229 offset:49152
  s_waitcnt lgkmcnt(13)
  v_mfma_f32_16x16x32_bf16 v[64:67], a[200:203], a[16:19], v[64:67]
  ds_read_b64_tr_b16 a[194:195], v229 offset:51200
  v_mfma_f32_16x16x32_bf16 v[72:75], a[196:199], a[4:7], v[72:75]
  v_mfma_f32_16x16x32_bf16 v[72:75], a[200:203], a[20:23], v[72:75]
  buffer_load_dwordx4 v226, s[16:19], s41 offen offset:0 lds
  v_mfma_f32_16x16x32_bf16 v[80:83], a[196:199], a[8:11], v[80:83]
  s_mov_b32 s41, 6651904
  s_add_u32 m0, s42, 73728
  v_mfma_f32_16x16x32_bf16 v[80:83], a[200:203], a[24:27], v[80:83]
  v_mfma_f32_16x16x32_bf16 v[88:91], a[196:199], a[12:15], v[88:91]
  ds_read_b64_tr_b16 a[196:197], v229 offset:32768
  v_mfma_f32_16x16x32_bf16 v[88:91], a[200:203], a[28:31], v[88:91]
  ds_read_b64_tr_b16 a[198:199], v229 offset:34816
  v_mfma_f32_16x16x32_bf16 v[92:95], a[204:207], a[12:15], v[92:95]
  ds_read_b64_tr_b16 a[200:201], v230 offset:45056
  v_mfma_f32_16x16x32_bf16 v[92:95], a[208:211], a[28:31], v[92:95]
  s_waitcnt vmcnt(17)
  s_barrier
  v_mfma_f32_16x16x32_bf16 v[84:87], a[204:207], a[8:11], v[84:87]
  buffer_load_dwordx4 v226, s[16:19], s41 offen offset:0 lds
  v_mfma_f32_16x16x32_bf16 v[84:87], a[208:211], a[24:27], v[84:87]
  ds_read_b64_tr_b16 a[202:203], v230 offset:47104
  s_mov_b32 s41, 6881280
  v_mfma_f32_16x16x32_bf16 v[76:79], a[204:207], a[4:7], v[76:79]
  s_add_u32 m0, s42, 86016
  v_mfma_f32_16x16x32_bf16 v[76:79], a[208:211], a[20:23], v[76:79]
  v_mfma_f32_16x16x32_bf16 v[68:71], a[204:207], a[0:3], v[68:71]
  ds_read_b64_tr_b16 a[204:205], v230 offset:36864
  v_mfma_f32_16x16x32_bf16 v[68:71], a[208:211], a[16:19], v[68:71]
  buffer_load_dwordx4 v226, s[12:15], s41 offen offset:0 lds
  s_waitcnt vmcnt(15) lgkmcnt(13)
  v_mfma_f32_16x16x32_bf16 v[0:3], a[212:215], a[32:35], v[0:3]
  ds_read_b64_tr_b16 a[206:207], v230 offset:38912
  s_mov_b32 s41, 7110656
  s_waitcnt vmcnt(11)
  v_mfma_f32_16x16x32_bf16 v[0:3], a[216:219], a[48:51], v[0:3]
  ds_read_b64_tr_b16 a[208:209], v230 offset:49152
  ds_read_b64_tr_b16 a[210:211], v230 offset:51200
  v_mfma_f32_16x16x32_bf16 v[16:19], a[212:215], a[36:39], v[16:19]
  s_add_u32 m0, s42, 102400
  v_mfma_f32_16x16x32_bf16 v[16:19], a[216:219], a[52:55], v[16:19]
  v_mfma_f32_16x16x32_bf16 v[32:35], a[212:215], a[40:43], v[32:35]
  v_mfma_f32_16x16x32_bf16 v[32:35], a[216:219], a[56:59], v[32:35]
  buffer_load_dwordx4 v226, s[12:15], s41 offen offset:0 lds
  v_mfma_f32_16x16x32_bf16 v[48:51], a[212:215], a[44:47], v[48:51]
  ds_read_b64_tr_b16 a[212:213], v230 offset:32768
  s_mov_b32 s41, 6881280
  v_mfma_f32_16x16x32_bf16 v[48:51], a[216:219], a[60:63], v[48:51]
  ds_read_b64_tr_b16 a[214:215], v230 offset:34816
  s_add_u32 m0, s42, 98304
  v_mfma_f32_16x16x32_bf16 v[52:55], a[220:223], a[44:47], v[52:55]
  ds_read_b64_tr_b16 a[216:217], v228 offset:40960
  s_waitcnt lgkmcnt(13)
  v_mfma_f32_16x16x32_bf16 v[52:55], a[224:227], a[60:63], v[52:55]
  ds_read_b64_tr_b16 a[218:219], v228 offset:43008
  v_mfma_f32_16x16x32_bf16 v[36:39], a[220:223], a[40:43], v[36:39]
  v_mfma_f32_16x16x32_bf16 v[36:39], a[224:227], a[56:59], v[36:39]
  buffer_load_dwordx4 v226, s[16:19], s41 offen offset:0 lds
  v_mfma_f32_16x16x32_bf16 v[20:23], a[220:223], a[36:39], v[20:23]
  s_mov_b32 s41, 7110656
  s_add_u32 m0, s42, 110592
  v_mfma_f32_16x16x32_bf16 v[20:23], a[224:227], a[52:55], v[20:23]
  v_mfma_f32_16x16x32_bf16 v[4:7], a[220:223], a[32:35], v[4:7]
  ds_read_b64_tr_b16 a[220:221], v228 offset:53248
  v_mfma_f32_16x16x32_bf16 v[4:7], a[224:227], a[48:51], v[4:7]
  ds_read_b64_tr_b16 a[222:223], v228 offset:55296
  v_mfma_f32_16x16x32_bf16 v[8:11], a[228:231], a[32:35], v[8:11]
  ds_read_b64_tr_b16 a[224:225], v229 offset:40960
  v_mfma_f32_16x16x32_bf16 v[8:11], a[232:235], a[48:51], v[8:11]
  buffer_load_dwordx4 v226, s[16:19], s41 offen offset:0 lds
  v_mfma_f32_16x16x32_bf16 v[24:27], a[228:231], a[36:39], v[24:27]
  ds_read_b64_tr_b16 a[226:227], v229 offset:43008
  s_mov_b32 s41, 131072
  v_mfma_f32_16x16x32_bf16 v[24:27], a[232:235], a[52:55], v[24:27]
  s_add_u32 m0, s42, 126976
  v_mfma_f32_16x16x32_bf16 v[40:43], a[228:231], a[40:43], v[40:43]
  v_mfma_f32_16x16x32_bf16 v[40:43], a[232:235], a[56:59], v[40:43]
  v_mfma_f32_16x16x32_bf16 v[56:59], a[228:231], a[44:47], v[56:59]
  ds_read_b64_tr_b16 a[228:229], v229 offset:53248
  v_mfma_f32_16x16x32_bf16 v[56:59], a[232:235], a[60:63], v[56:59]
  buffer_load_dwordx4 v242, s[44:47], s41 offen offset:0 lds
  s_waitcnt lgkmcnt(13)
  v_mfma_f32_16x16x32_bf16 v[60:63], a[192:195], a[44:47], v[60:63]
  ds_read_b64_tr_b16 a[230:231], v229 offset:55296
  s_mov_b32 s41, 393216
  v_mfma_f32_16x16x32_bf16 v[60:63], a[196:199], a[60:63], v[60:63]
  ds_read_b64_tr_b16 a[232:233], v228 offset:57344
  ds_read_b64_tr_b16 a[234:235], v228 offset:59392
  v_mfma_f32_16x16x32_bf16 v[44:47], a[192:195], a[40:43], v[44:47]
  s_add_u32 m0, s42, 122880
  v_mfma_f32_16x16x32_bf16 v[44:47], a[196:199], a[56:59], v[44:47]
  v_mfma_f32_16x16x32_bf16 v[28:31], a[192:195], a[36:39], v[28:31]
  v_mfma_f32_16x16x32_bf16 v[28:31], a[196:199], a[52:55], v[28:31]
  buffer_load_dwordx4 v242, s[44:47], s41 offen offset:0 lds
  v_mfma_f32_16x16x32_bf16 v[12:15], a[192:195], a[32:35], v[12:15]
  ds_read_b64_tr_b16 a[192:193], v232 offset:0
  s_mov_b32 s41, 131072
  v_mfma_f32_16x16x32_bf16 v[12:15], a[196:199], a[48:51], v[12:15]
  ds_read_b64_tr_b16 a[194:195], v232 offset:2048
  ds_read_b64_tr_b16 a[196:197], v229 offset:57344
  v_mul_f32 v0, s43, v0
  v_mul_f32 v1, s43, v1
  v_mul_f32 v2, s43, v2
  v_mfma_f32_16x16x32_bf16 v[64:67], a[200:203], a[32:35], v[64:67]
  ds_read_b64_tr_b16 a[198:199], v229 offset:59392
  s_add_u32 m0, s42, 135168
  v_mul_f32 v3, s43, v3
  v_mul_f32 v4, s43, v4
  v_mul_f32 v5, s43, v5
  v_mul_f32 v6, s43, v6
  s_waitcnt lgkmcnt(13)
  v_mfma_f32_16x16x32_bf16 v[64:67], a[204:207], a[48:51], v[64:67]
  v_mul_f32 v7, s43, v7
  v_exp_f32 v0, v0
  v_mfma_f32_16x16x32_bf16 v[72:75], a[200:203], a[36:39], v[72:75]
  v_exp_f32 v1, v1
  v_exp_f32 v2, v2
  v_mfma_f32_16x16x32_bf16 v[72:75], a[204:207], a[52:55], v[72:75]
  buffer_load_dwordx4 v253, s[44:47], s41 offen offset:0 lds
  v_exp_f32 v3, v3
  v_exp_f32 v4, v4
  v_mfma_f32_16x16x32_bf16 v[80:83], a[200:203], a[40:43], v[80:83]
  s_mov_b32 s41, 393216
  s_add_u32 m0, s42, 151552
  v_exp_f32 v5, v5
  v_exp_f32 v6, v6
  v_mfma_f32_16x16x32_bf16 v[80:83], a[204:207], a[56:59], v[80:83]
  v_exp_f32 v7, v7
  v_add_f32 v0, 1.0, v0
  v_add_f32 v1, 1.0, v1
  v_add_f32 v2, 1.0, v2
  v_mfma_f32_16x16x32_bf16 v[88:91], a[200:203], a[44:47], v[88:91]
  ds_read_b64_tr_b16 a[200:201], v233 offset:0
  ds_read_b64_tr_b16 a[202:203], v233 offset:2048
  v_add_f32 v3, 1.0, v3
  v_add_f32 v4, 1.0, v4
  v_add_f32 v5, 1.0, v5
  v_add_f32 v6, 1.0, v6
  v_mfma_f32_16x16x32_bf16 v[88:91], a[204:207], a[60:63], v[88:91]
  ds_read_b64_tr_b16 a[204:205], v232 offset:28672
  ds_read_b64_tr_b16 a[206:207], v232 offset:30720
  v_add_f32 v7, 1.0, v7
  v_rcp_f32 v0, v0
  v_mfma_f32_16x16x32_bf16 v[92:95], a[208:211], a[44:47], v[92:95]
  v_rcp_f32 v1, v1
  v_rcp_f32 v2, v2
  v_mfma_f32_16x16x32_bf16 v[92:95], a[212:215], a[60:63], v[92:95]
  buffer_load_dwordx4 v253, s[44:47], s41 offen offset:0 lds
  v_rcp_f32 v3, v3
  v_rcp_f32 v4, v4
  v_mfma_f32_16x16x32_bf16 v[84:87], a[208:211], a[40:43], v[84:87]
  s_mov_b32 s41, 458752
  s_add_u32 m0, s42, 147456
  v_rcp_f32 v5, v5
  v_rcp_f32 v6, v6
  v_mfma_f32_16x16x32_bf16 v[84:87], a[212:215], a[56:59], v[84:87]
  v_rcp_f32 v7, v7
  v_mul_f32 v0, v0, v8
  v_mul_f32 v1, v1, v9
  v_mul_f32 v2, v2, v10
  v_mfma_f32_16x16x32_bf16 v[76:79], a[208:211], a[36:39], v[76:79]
  v_mul_f32 v3, v3, v11
  v_mul_f32 v4, v4, v12
  v_mul_f32 v5, v5, v13
  v_mul_f32 v6, v6, v14
  v_mfma_f32_16x16x32_bf16 v[76:79], a[212:215], a[52:55], v[76:79]
  v_mul_f32 v7, v7, v15
  v_cvt_pk_bf16_f32 v0, v0, v1
  v_cvt_pk_bf16_f32 v1, v2, v3
  v_cvt_pk_bf16_f32 v2, v4, v5
  v_mfma_f32_16x16x32_bf16 v[68:71], a[208:211], a[32:35], v[68:71]
  ds_read_b64_tr_b16 a[208:209], v232 offset:40960
  ds_read_b64_tr_b16 a[210:211], v232 offset:43008
  v_cvt_pk_bf16_f32 v3, v6, v7
  buffer_store_dwordx4 v[0:3], v225, s[4:7], s64 offen offset:0 sc1
  v_mul_f32 v16, s43, v16
  v_mfma_f32_16x16x32_bf16 v[68:71], a[212:215], a[48:51], v[68:71]
  ds_read_b64_tr_b16 a[212:213], v233 offset:28672
  ds_read_b64_tr_b16 a[214:215], v233 offset:30720
  v_mul_f32 v17, s43, v17
  v_mul_f32 v18, s43, v18
  v_mul_f32 v19, s43, v19
  v_mul_f32 v20, s43, v20
  s_waitcnt lgkmcnt(13)
  v_mfma_f32_16x16x32_bf16 v[96:99], a[216:219], a[96:99], v[96:99]
  buffer_load_dwordx4 v242, s[44:47], s41 offen offset:0 lds
  v_mul_f32 v21, s43, v21
  v_mul_f32 v22, s43, v22
  v_mul_f32 v23, s43, v23
  v_mfma_f32_16x16x32_bf16 v[96:99], a[220:223], a[112:115], v[96:99]
  s_waitcnt vmcnt(13)
  s_barrier
  v_exp_f32 v16, v16
  v_exp_f32 v17, v17
  v_mfma_f32_16x16x32_bf16 v[128:131], a[216:219], a[100:103], v[128:131]
  s_mov_b32 s41, 720896
  s_add_u32 m0, s42, 159744
  v_exp_f32 v18, v18
  v_exp_f32 v19, v19
  v_mfma_f32_16x16x32_bf16 v[128:131], a[220:223], a[116:119], v[128:131]
  v_exp_f32 v20, v20
  v_exp_f32 v21, v21
  v_mfma_f32_16x16x32_bf16 v[160:163], a[216:219], a[104:107], v[160:163]
  v_exp_f32 v22, v22
  v_exp_f32 v23, v23
  v_add_f32 v16, 1.0, v16
  v_mfma_f32_16x16x32_bf16 v[160:163], a[220:223], a[120:123], v[160:163]
  buffer_load_dwordx4 v242, s[44:47], s41 offen offset:0 lds
  v_add_f32 v17, 1.0, v17
  v_add_f32 v18, 1.0, v18
  v_add_f32 v19, 1.0, v19
  v_add_f32 v20, 1.0, v20
  v_mfma_f32_16x16x32_bf16 v[192:195], a[216:219], a[108:111], v[192:195]
  ds_read_b64_tr_b16 a[216:217], v233 offset:40960
  ds_read_b64_tr_b16 a[218:219], v233 offset:43008
  v_add_f32 v21, 1.0, v21
  v_add_f32 v22, 1.0, v22
  v_add_f32 v23, 1.0, v23
  v_mfma_f32_16x16x32_bf16 v[192:195], a[220:223], a[124:127], v[192:195]
  ds_read_b64_tr_b16 a[220:221], v232 offset:49152
  ds_read_b64_tr_b16 a[222:223], v232 offset:51200
  v_rcp_f32 v16, v16
  v_rcp_f32 v17, v17
  v_mfma_f32_16x16x32_bf16 v[196:199], a[224:227], a[108:111], v[196:199]
  s_mov_b32 s41, 458752
  s_add_u32 m0, s42, 16384
  v_rcp_f32 v18, v18
  v_rcp_f32 v19, v19
L_wk1_6:
  s_cbranch_vccnz L_wk1_10
  v_mfma_f32_16x16x32_bf16 v[196:199], a[228:231], a[124:127], v[196:199]
  v_rcp_f32 v20, v20
  v_rcp_f32 v21, v21
  v_mfma_f32_16x16x32_bf16 v[164:167], a[224:227], a[104:107], v[164:167]
  v_rcp_f32 v22, v22
  v_rcp_f32 v23, v23
  v_mul_f32 v16, v16, v24
  v_mfma_f32_16x16x32_bf16 v[164:167], a[228:231], a[120:123], v[164:167]
  buffer_load_dwordx4 v253, s[44:47], s41 offen offset:0 lds
  v_mul_f32 v17, v17, v25
  v_mul_f32 v18, v18, v26
  v_mul_f32 v19, v19, v27
  v_mul_f32 v20, v20, v28
  v_mfma_f32_16x16x32_bf16 v[132:135], a[224:227], a[100:103], v[132:135]
  s_mov_b32 s41, 720896
  s_add_u32 m0, s42, 28672
  v_mul_f32 v21, v21, v29
  v_mul_f32 v22, v22, v30
  v_mul_f32 v23, v23, v31
  v_cvt_pk_bf16_f32 v16, v16, v17
  v_mfma_f32_16x16x32_bf16 v[132:135], a[228:231], a[116:119], v[132:135]
  v_cvt_pk_bf16_f32 v17, v18, v19
  v_cvt_pk_bf16_f32 v18, v20, v21
  v_cvt_pk_bf16_f32 v19, v22, v23
  v_mfma_f32_16x16x32_bf16 v[100:103], a[224:227], a[96:99], v[100:103]
  ds_read_b64_tr_b16 a[224:225], v236 offset:12288
  ds_read_b64_tr_b16 a[226:227], v236 offset:14336
  buffer_store_dwordx4 v[16:19], v225, s[4:7], s64 offen offset:1024 sc1
  v_mul_f32 v32, s43, v32
  v_mul_f32 v33, s43, v33
  v_mul_f32 v34, s43, v34
  v_mfma_f32_16x16x32_bf16 v[100:103], a[228:231], a[112:115], v[100:103]
  ds_read_b64_tr_b16 a[228:229], v233 offset:49152
  ds_read_b64_tr_b16 a[230:231], v233 offset:51200
  v_mul_f32 v35, s43, v35
  v_mul_f32 v36, s43, v36
  v_mul_f32 v37, s43, v37
  v_mul_f32 v38, s43, v38
  s_waitcnt lgkmcnt(13)
  v_mfma_f32_16x16x32_bf16 v[112:115], a[232:235], a[96:99], v[112:115]
  v_mul_f32 v39, s43, v39
  v_exp_f32 v32, v32
  v_mfma_f32_16x16x32_bf16 v[112:115], a[192:195], a[112:115], v[112:115]
  buffer_load_dwordx4 v253, s[44:47], s41 offen offset:0 lds
  v_exp_f32 v33, v33
  v_exp_f32 v34, v34
  v_mfma_f32_16x16x32_bf16 v[144:147], a[232:235], a[100:103], v[144:147]
  s_mov_b32 s41, 1048576
  s_add_u32 m0, s42, 139264
  v_exp_f32 v35, v35
  v_exp_f32 v36, v36
  v_mfma_f32_16x16x32_bf16 v[144:147], a[192:195], a[116:119], v[144:147]
  v_exp_f32 v37, v37
  v_exp_f32 v38, v38
  v_mfma_f32_16x16x32_bf16 v[176:179], a[232:235], a[104:107], v[176:179]
  v_exp_f32 v39, v39
  v_add_f32 v32, 1.0, v32
  v_add_f32 v33, 1.0, v33
  v_add_f32 v34, 1.0, v34
  v_mfma_f32_16x16x32_bf16 v[176:179], a[192:195], a[120:123], v[176:179]
  v_add_f32 v35, 1.0, v35
  v_add_f32 v36, 1.0, v36
  v_add_f32 v37, 1.0, v37
  v_add_f32 v38, 1.0, v38
  v_mfma_f32_16x16x32_bf16 v[208:211], a[232:235], a[108:111], v[208:211]
  ds_read_b64_tr_b16 a[232:233], v237 offset:12288
  ds_read_b64_tr_b16 a[234:235], v237 offset:14336
  v_add_f32 v39, 1.0, v39
  v_rcp_f32 v32, v32
  v_mfma_f32_16x16x32_bf16 v[208:211], a[192:195], a[124:127], v[208:211]
  buffer_load_dwordx4 v242, s[44:47], s41 offen offset:0 lds
  v_rcp_f32 v33, v33
  v_rcp_f32 v34, v34
  v_mfma_f32_16x16x32_bf16 v[212:215], a[196:199], a[108:111], v[212:215]
  ds_read_b64_tr_b16 a[192:193], v232 offset:4096
  ds_read_b64_tr_b16 a[194:195], v232 offset:6144
  v_rcp_f32 v35, v35
  v_rcp_f32 v36, v36
  v_mfma_f32_16x16x32_bf16 v[212:215], a[200:203], a[124:127], v[212:215]
  s_mov_b32 s41, 1310720
  s_add_u32 m0, s42, 155648
  v_rcp_f32 v37, v37
  v_rcp_f32 v38, v38
  v_mfma_f32_16x16x32_bf16 v[180:183], a[196:199], a[104:107], v[180:183]
  v_rcp_f32 v39, v39
  v_mul_f32 v32, v32, v40
  v_mul_f32 v33, v33, v41
  v_mul_f32 v34, v34, v42
  v_mfma_f32_16x16x32_bf16 v[180:183], a[200:203], a[120:123], v[180:183]
  v_mul_f32 v35, v35, v43
  v_mul_f32 v36, v36, v44
  v_mul_f32 v37, v37, v45
  v_mul_f32 v38, v38, v46
  v_mfma_f32_16x16x32_bf16 v[148:151], a[196:199], a[100:103], v[148:151]
  v_mul_f32 v39, v39, v47
  v_cvt_pk_bf16_f32 v32, v32, v33
  v_cvt_pk_bf16_f32 v33, v34, v35
  v_cvt_pk_bf16_f32 v34, v36, v37
  v_mfma_f32_16x16x32_bf16 v[148:151], a[200:203], a[116:119], v[148:151]
  buffer_load_dwordx4 v242, s[44:47], s41 offen offset:0 lds
  v_cvt_pk_bf16_f32 v35, v38, v39
  buffer_store_dwordx4 v[32:35], v225, s[4:7], s64 offen offset:2048 sc1
  v_mul_f32 v48, s43, v48
  v_mfma_f32_16x16x32_bf16 v[116:119], a[196:199], a[96:99], v[116:119]
  ds_read_b64_tr_b16 a[196:197], v232 offset:16384
  ds_read_b64_tr_b16 a[198:199], v232 offset:18432
  v_mul_f32 v49, s43, v49
  v_mul_f32 v50, s43, v50
  v_mul_f32 v51, s43, v51
  v_mul_f32 v52, s43, v52
  v_mfma_f32_16x16x32_bf16 v[116:119], a[200:203], a[112:115], v[116:119]
  ds_read_b64_tr_b16 a[200:201], v233 offset:4096
  ds_read_b64_tr_b16 a[202:203], v233 offset:6144
  v_mul_f32 v53, s43, v53
  v_mul_f32 v54, s43, v54
  v_mul_f32 v55, s43, v55
  s_waitcnt lgkmcnt(13)
  v_mfma_f32_16x16x32_bf16 v[96:99], a[204:207], a[128:131], v[96:99]
  s_mov_b32 s41, 1048576
  s_add_u32 m0, s42, 20480
  v_exp_f32 v48, v48
  v_exp_f32 v49, v49
  v_mfma_f32_16x16x32_bf16 v[96:99], a[208:211], a[144:147], v[96:99]
  v_exp_f32 v50, v50
  v_exp_f32 v51, v51
  v_mfma_f32_16x16x32_bf16 v[128:131], a[204:207], a[132:135], v[128:131]
  v_exp_f32 v52, v52
  v_exp_f32 v53, v53
  v_mfma_f32_16x16x32_bf16 v[128:131], a[208:211], a[148:151], v[128:131]
  buffer_load_dwordx4 v253, s[44:47], s41 offen offset:0 lds
  v_exp_f32 v54, v54
  v_exp_f32 v55, v55
  v_add_f32 v48, 1.0, v48
  v_mfma_f32_16x16x32_bf16 v[160:163], a[204:207], a[136:139], v[160:163]
  s_mov_b32 s41, 1310720
  s_add_u32 m0, s42, 12288
  v_add_f32 v49, 1.0, v49
  v_add_f32 v50, 1.0, v50
  v_add_f32 v51, 1.0, v51
  v_add_f32 v52, 1.0, v52
  v_mfma_f32_16x16x32_bf16 v[160:163], a[208:211], a[152:155], v[160:163]
  v_add_f32 v53, 1.0, v53
  v_add_f32 v54, 1.0, v54
  v_add_f32 v55, 1.0, v55
  v_mfma_f32_16x16x32_bf16 v[192:195], a[204:207], a[140:143], v[192:195]
  ds_read_b64_tr_b16 a[204:205], v233 offset:16384
  ds_read_b64_tr_b16 a[206:207], v233 offset:18432
  v_rcp_f32 v48, v48
  v_rcp_f32 v49, v49
  v_mfma_f32_16x16x32_bf16 v[192:195], a[208:211], a[156:159], v[192:195]
  ds_read_b64_tr_b16 a[208:209], v228 offset:61440
  ds_read_b64_tr_b16 a[210:211], v228 offset:63488
  v_rcp_f32 v50, v50
  v_rcp_f32 v51, v51
  v_mfma_f32_16x16x32_bf16 v[196:199], a[212:215], a[140:143], v[196:199]
  v_rcp_f32 v52, v52
  v_rcp_f32 v53, v53
  v_mfma_f32_16x16x32_bf16 v[196:199], a[216:219], a[156:159], v[196:199]
  buffer_load_dwordx4 v253, s[44:47], s41 offen offset:0 lds
  v_rcp_f32 v54, v54
  v_rcp_f32 v55, v55
  v_mul_f32 v48, v48, v56
  v_mfma_f32_16x16x32_bf16 v[164:167], a[212:215], a[136:139], v[164:167]
  s_mov_b32 s41, 1376256
  s_add_u32 m0, s42, 24576
  v_mul_f32 v49, v49, v57
  v_mul_f32 v50, v50, v58
  v_mul_f32 v51, v51, v59
  v_mul_f32 v52, v52, v60
  v_mfma_f32_16x16x32_bf16 v[164:167], a[216:219], a[152:155], v[164:167]
  v_mul_f32 v53, v53, v61
  v_mul_f32 v54, v54, v62
  v_mul_f32 v55, v55, v63
  v_cvt_pk_bf16_f32 v48, v48, v49
  v_mfma_f32_16x16x32_bf16 v[132:135], a[212:215], a[132:135], v[132:135]
  v_cvt_pk_bf16_f32 v49, v50, v51
  v_cvt_pk_bf16_f32 v50, v52, v53
  v_cvt_pk_bf16_f32 v51, v54, v55
  v_mfma_f32_16x16x32_bf16 v[132:135], a[216:219], a[148:151], v[132:135]
  buffer_store_dwordx4 v[48:51], v225, s[4:7], s64 offen offset:3072 sc1
  v_mul_f32 v64, s43, v64
  v_mul_f32 v65, s43, v65
  v_mul_f32 v66, s43, v66
  v_mfma_f32_16x16x32_bf16 v[100:103], a[212:215], a[128:131], v[100:103]
  ds_read_b64_tr_b16 a[212:213], v232 offset:24576
  ds_read_b64_tr_b16 a[214:215], v232 offset:26624
  v_mul_f32 v67, s43, v67
  v_mfma_f32_16x16x32_bf16 v[100:103], a[216:219], a[144:147], v[100:103]
  buffer_load_dwordx4 v242, s[44:47], s41 offen offset:0 lds
  s_waitcnt lgkmcnt(13)
  v_mfma_f32_16x16x32_bf16 v[112:115], a[220:223], a[128:131], v[112:115]
  ds_read_b64_tr_b16 a[216:217], v229 offset:61440
  ds_read_b64_tr_b16 a[218:219], v229 offset:63488
  v_exp_f32 v64, v64
  v_mfma_f32_16x16x32_bf16 v[112:115], a[224:227], a[144:147], v[112:115]
  s_mov_b32 s41, 1638400
  s_add_u32 m0, s42, 45056
  v_exp_f32 v65, v65
  v_mfma_f32_16x16x32_bf16 v[144:147], a[220:223], a[132:135], v[144:147]
  v_exp_f32 v66, v66
  v_mfma_f32_16x16x32_bf16 v[144:147], a[224:227], a[148:151], v[144:147]
  v_exp_f32 v67, v67
  v_mfma_f32_16x16x32_bf16 v[176:179], a[220:223], a[136:139], v[176:179]
  v_add_f32 v64, 1.0, v64
  v_add_f32 v65, 1.0, v65
  v_mfma_f32_16x16x32_bf16 v[176:179], a[224:227], a[152:155], v[176:179]
  buffer_load_dwordx4 v242, s[44:47], s41 offen offset:0 lds
  v_add_f32 v66, 1.0, v66
  v_mfma_f32_16x16x32_bf16 v[208:211], a[220:223], a[140:143], v[208:211]
  ds_read_b64_tr_b16 a[220:221], v233 offset:24576
  ds_read_b64_tr_b16 a[222:223], v233 offset:26624
  v_add_f32 v67, 1.0, v67
  v_mfma_f32_16x16x32_bf16 v[208:211], a[224:227], a[156:159], v[208:211]
  ds_read_b64_tr_b16 a[224:225], v232 offset:53248
  ds_read_b64_tr_b16 a[226:227], v232 offset:55296
  v_mfma_f32_16x16x32_bf16 v[212:215], a[228:231], a[140:143], v[212:215]
  s_mov_b32 s41, 1376256
  s_add_u32 m0, s42, 36864
  v_rcp_f32 v64, v64
  s_waitcnt lgkmcnt(13)
  v_mfma_f32_16x16x32_bf16 v[212:215], a[232:235], a[156:159], v[212:215]
  s_waitcnt vmcnt(18)
  s_barrier
  v_rcp_f32 v65, v65
  v_mfma_f32_16x16x32_bf16 v[180:183], a[228:231], a[136:139], v[180:183]
  v_rcp_f32 v66, v66
  v_mfma_f32_16x16x32_bf16 v[180:183], a[232:235], a[152:155], v[180:183]
  buffer_load_dwordx4 v253, s[44:47], s41 offen offset:0 lds
  v_mfma_f32_16x16x32_bf16 v[148:151], a[228:231], a[132:135], v[148:151]
  s_mov_b32 s41, 1638400
  s_add_u32 m0, s42, 49152
  v_rcp_f32 v67, v67
  v_mul_f32 v64, v64, v68
  v_mfma_f32_16x16x32_bf16 v[148:151], a[232:235], a[148:151], v[148:151]
  v_mul_f32 v65, v65, v69
  v_mul_f32 v66, v66, v70
  v_mfma_f32_16x16x32_bf16 v[116:119], a[228:231], a[128:131], v[116:119]
  ds_read_b64_tr_b16 a[228:229], v236 offset:0
  ds_read_b64_tr_b16 a[230:231], v236 offset:2048
  v_mul_f32 v67, v67, v71
  v_mfma_f32_16x16x32_bf16 v[116:119], a[232:235], a[144:147], v[116:119]
  ds_read_b64_tr_b16 a[232:233], v233 offset:53248
  ds_read_b64_tr_b16 a[234:235], v233 offset:55296
  v_cvt_pk_bf16_f32 v64, v64, v65
  v_cvt_pk_bf16_f32 v65, v66, v67
  v_mfma_f32_16x16x32_bf16 v[96:99], a[192:195], a[160:163], v[96:99]
  v_mul_f32 v72, s43, v72
  v_mul_f32 v73, s43, v73
  v_mfma_f32_16x16x32_bf16 v[96:99], a[196:199], a[176:179], v[96:99]
  buffer_load_dwordx4 v253, s[44:47], s41 offen offset:0 lds
  v_mul_f32 v74, s43, v74
  v_mfma_f32_16x16x32_bf16 v[128:131], a[192:195], a[164:167], v[128:131]
  s_mov_b32 s41, 1966080
  s_add_u32 m0, s42, 32768
  v_mul_f32 v75, s43, v75
  v_mfma_f32_16x16x32_bf16 v[128:131], a[196:199], a[180:183], v[128:131]
  v_exp_f32 v72, v72
  v_mfma_f32_16x16x32_bf16 v[160:163], a[192:195], a[168:171], v[160:163]
  v_exp_f32 v73, v73
  v_mfma_f32_16x16x32_bf16 v[160:163], a[196:199], a[184:187], v[160:163]
  v_exp_f32 v74, v74
  v_mfma_f32_16x16x32_bf16 v[192:195], a[192:195], a[172:175], v[192:195]
  ds_read_b64_tr_b16 a[192:193], v237 offset:0
  ds_read_b64_tr_b16 a[194:195], v237 offset:2048
  v_mfma_f32_16x16x32_bf16 v[192:195], a[196:199], a[188:191], v[192:195]
  buffer_load_dwordx4 v242, s[44:47], s41 offen offset:0 lds
  s_waitcnt lgkmcnt(13)
  v_mfma_f32_16x16x32_bf16 v[196:199], a[200:203], a[172:175], v[196:199]
  ds_read_b64_tr_b16 a[196:197], v232 offset:12288
  ds_read_b64_tr_b16 a[198:199], v232 offset:14336
  v_exp_f32 v75, v75
  v_add_f32 v72, 1.0, v72
  v_mfma_f32_16x16x32_bf16 v[196:199], a[204:207], a[188:191], v[196:199]
  v_add_f32 v73, 1.0, v73
  v_add_f32 v74, 1.0, v74
  v_mfma_f32_16x16x32_bf16 v[164:167], a[200:203], a[168:171], v[164:167]
  v_add_f32 v75, 1.0, v75
  v_mfma_f32_16x16x32_bf16 v[164:167], a[204:207], a[184:187], v[164:167]
  v_rcp_f32 v72, v72
  v_mfma_f32_16x16x32_bf16 v[132:135], a[200:203], a[164:167], v[132:135]
  v_rcp_f32 v73, v73
  v_mfma_f32_16x16x32_bf16 v[132:135], a[204:207], a[180:183], v[132:135]
  v_rcp_f32 v74, v74
  v_mfma_f32_16x16x32_bf16 v[100:103], a[200:203], a[160:163], v[100:103]
  ds_read_b64_tr_b16 a[200:201], v232 offset:8192
  ds_read_b64_tr_b16 a[202:203], v232 offset:10240
  v_mfma_f32_16x16x32_bf16 v[100:103], a[204:207], a[176:179], v[100:103]
  ds_read_b64_tr_b16 a[204:205], v233 offset:12288
  ds_read_b64_tr_b16 a[206:207], v233 offset:14336
  v_mfma_f32_16x16x32_bf16 v[112:115], a[208:211], a[160:163], v[112:115]
  v_rcp_f32 v75, v75
  v_mul_f32 v72, v72, v76
  s_waitcnt lgkmcnt(13)
  v_mfma_f32_16x16x32_bf16 v[112:115], a[212:215], a[176:179], v[112:115]
  v_mul_f32 v73, v73, v77
  v_mul_f32 v74, v74, v78
  v_mfma_f32_16x16x32_bf16 v[144:147], a[208:211], a[164:167], v[144:147]
  v_mul_f32 v75, v75, v79
  v_cvt_pk_bf16_f32 v66, v72, v73
  v_mfma_f32_16x16x32_bf16 v[144:147], a[212:215], a[180:183], v[144:147]
  v_cvt_pk_bf16_f32 v67, v74, v75
  v_mfma_f32_16x16x32_bf16 v[176:179], a[208:211], a[168:171], v[176:179]
  buffer_store_dwordx4 v[64:67], v225, s[4:7], s65 offen offset:0 sc1
  v_mfma_f32_16x16x32_bf16 v[176:179], a[212:215], a[184:187], v[176:179]
  v_mul_f32 v80, s43, v80
  v_mul_f32 v81, s43, v81
  v_mfma_f32_16x16x32_bf16 v[208:211], a[208:211], a[172:175], v[208:211]
  ds_read_b64_tr_b16 a[208:209], v233 offset:8192
  ds_read_b64_tr_b16 a[210:211], v233 offset:10240
  v_mfma_f32_16x16x32_bf16 v[208:211], a[212:215], a[188:191], v[208:211]
  ds_read_b64_tr_b16 a[212:213], v232 offset:20480
  ds_read_b64_tr_b16 a[214:215], v232 offset:22528
  v_mul_f32 v82, s43, v82
  v_mul_f32 v83, s43, v83
  v_mfma_f32_16x16x32_bf16 v[212:215], a[216:219], a[172:175], v[212:215]
  v_exp_f32 v80, v80
  v_mfma_f32_16x16x32_bf16 v[212:215], a[220:223], a[188:191], v[212:215]
  v_exp_f32 v81, v81
  v_mfma_f32_16x16x32_bf16 v[180:183], a[216:219], a[168:171], v[180:183]
  v_exp_f32 v82, v82
  v_mfma_f32_16x16x32_bf16 v[180:183], a[220:223], a[184:187], v[180:183]
  v_exp_f32 v83, v83
  v_mfma_f32_16x16x32_bf16 v[148:151], a[216:219], a[164:167], v[148:151]
  v_add_f32 v80, 1.0, v80
  v_add_f32 v81, 1.0, v81
  v_mfma_f32_16x16x32_bf16 v[148:151], a[220:223], a[180:183], v[148:151]
  v_add_f32 v82, 1.0, v82
  v_add_f32 v83, 1.0, v83
  v_mfma_f32_16x16x32_bf16 v[116:119], a[216:219], a[160:163], v[116:119]
  ds_read_b64_tr_b16 a[216:217], v232 offset:36864
  ds_read_b64_tr_b16 a[218:219], v232 offset:38912
  s_waitcnt vmcnt(6)
  v_add_u32 v248, 0, v245
  buffer_store_dword v248, v246, s[4:7], s90 offen sc1
  v_mfma_f32_16x16x32_bf16 v[116:119], a[220:223], a[176:179], v[116:119]
  ds_read_b64_tr_b16 a[220:221], v233 offset:20480
  ds_read_b64_tr_b16 a[222:223], v233 offset:22528
  s_waitcnt lgkmcnt(13)
  v_mfma_f32_16x16x32_bf16 v[96:99], a[224:227], a[0:3], v[96:99]
  v_rcp_f32 v80, v80
  v_mfma_f32_16x16x32_bf16 v[96:99], a[228:231], a[16:19], v[96:99]
  v_rcp_f32 v81, v81
  v_mfma_f32_16x16x32_bf16 v[128:131], a[224:227], a[4:7], v[128:131]
  v_rcp_f32 v82, v82
  v_mfma_f32_16x16x32_bf16 v[128:131], a[228:231], a[20:23], v[128:131]
  v_rcp_f32 v83, v83
  v_mfma_f32_16x16x32_bf16 v[160:163], a[224:227], a[8:11], v[160:163]
  v_mul_f32 v80, v80, v84
  v_mul_f32 v81, v81, v85
  v_mfma_f32_16x16x32_bf16 v[160:163], a[228:231], a[24:27], v[160:163]
  v_mul_f32 v82, v82, v86
  v_mul_f32 v83, v83, v87
  v_mfma_f32_16x16x32_bf16 v[192:195], a[224:227], a[12:15], v[192:195]
  ds_read_b64_tr_b16 a[224:225], v233 offset:36864
  ds_read_b64_tr_b16 a[226:227], v233 offset:38912
  v_mfma_f32_16x16x32_bf16 v[192:195], a[228:231], a[28:31], v[192:195]
  ds_read_b64_tr_b16 a[228:229], v232 offset:32768
  ds_read_b64_tr_b16 a[230:231], v232 offset:34816
  v_mfma_f32_16x16x32_bf16 v[196:199], a[232:235], a[12:15], v[196:199]
  v_cvt_pk_bf16_f32 v80, v80, v81
  v_cvt_pk_bf16_f32 v81, v82, v83
  v_mfma_f32_16x16x32_bf16 v[196:199], a[192:195], a[28:31], v[196:199]
  v_mul_f32 v88, s43, v88
  v_mul_f32 v89, s43, v89
  v_mfma_f32_16x16x32_bf16 v[164:167], a[232:235], a[8:11], v[164:167]
  v_mul_f32 v90, s43, v90
  v_mul_f32 v91, s43, v91
  v_mfma_f32_16x16x32_bf16 v[164:167], a[192:195], a[24:27], v[164:167]
  v_exp_f32 v88, v88
  v_mfma_f32_16x16x32_bf16 v[132:135], a[232:235], a[4:7], v[132:135]
  v_exp_f32 v89, v89
  v_mfma_f32_16x16x32_bf16 v[132:135], a[192:195], a[20:23], v[132:135]
  v_exp_f32 v90, v90
  v_mfma_f32_16x16x32_bf16 v[100:103], a[232:235], a[0:3], v[100:103]
  ds_read_b64_tr_b16 a[232:233], v232 offset:45056
  ds_read_b64_tr_b16 a[234:235], v232 offset:47104
  v_mfma_f32_16x16x32_bf16 v[100:103], a[192:195], a[16:19], v[100:103]
  ds_read_b64_tr_b16 a[192:193], v233 offset:32768
  ds_read_b64_tr_b16 a[194:195], v233 offset:34816
  s_waitcnt lgkmcnt(13)
  v_mfma_f32_16x16x32_bf16 v[112:115], a[196:199], a[0:3], v[112:115]
  v_exp_f32 v91, v91
  v_mfma_f32_16x16x32_bf16 v[112:115], a[200:203], a[16:19], v[112:115]
  s_barrier
  v_add_f32 v88, 1.0, v88
  v_mfma_f32_16x16x32_bf16 v[144:147], a[196:199], a[4:7], v[144:147]
  v_add_f32 v89, 1.0, v89
  v_add_f32 v90, 1.0, v90
  v_mfma_f32_16x16x32_bf16 v[144:147], a[200:203], a[20:23], v[144:147]
  v_add_f32 v91, 1.0, v91
  v_mfma_f32_16x16x32_bf16 v[176:179], a[196:199], a[8:11], v[176:179]
  v_rcp_f32 v88, v88
  v_mfma_f32_16x16x32_bf16 v[176:179], a[200:203], a[24:27], v[176:179]
  v_rcp_f32 v89, v89
  v_mfma_f32_16x16x32_bf16 v[208:211], a[196:199], a[12:15], v[208:211]
  ds_read_b64_tr_b16 a[196:197], v233 offset:45056
  ds_read_b64_tr_b16 a[198:199], v233 offset:47104
  v_mfma_f32_16x16x32_bf16 v[208:211], a[200:203], a[28:31], v[208:211]
  ds_read_b64_tr_b16 a[200:201], v230 offset:40960
  ds_read_b64_tr_b16 a[202:203], v230 offset:43008
  v_mfma_f32_16x16x32_bf16 v[212:215], a[204:207], a[12:15], v[212:215]
  v_rcp_f32 v90, v90
  v_mfma_f32_16x16x32_bf16 v[212:215], a[208:211], a[28:31], v[212:215]
  v_rcp_f32 v91, v91
  v_mul_f32 v88, v88, v92
  v_mfma_f32_16x16x32_bf16 v[180:183], a[204:207], a[8:11], v[180:183]
  v_mul_f32 v89, v89, v93
  v_mul_f32 v90, v90, v94
  v_mfma_f32_16x16x32_bf16 v[180:183], a[208:211], a[24:27], v[180:183]
  v_mul_f32 v91, v91, v95
  v_cvt_pk_bf16_f32 v82, v88, v89
  v_mfma_f32_16x16x32_bf16 v[148:151], a[204:207], a[4:7], v[148:151]
  v_cvt_pk_bf16_f32 v83, v90, v91
  v_mfma_f32_16x16x32_bf16 v[148:151], a[208:211], a[20:23], v[148:151]
  buffer_store_dwordx4 v[80:83], v225, s[4:7], s65 offen offset:2048 sc1
  v_mfma_f32_16x16x32_bf16 v[116:119], a[204:207], a[0:3], v[116:119]
  ds_read_b64_tr_b16 a[204:205], v230 offset:53248
  ds_read_b64_tr_b16 a[206:207], v230 offset:55296
  v_mfma_f32_16x16x32_bf16 v[116:119], a[208:211], a[16:19], v[116:119]
  ds_read_b64_tr_b16 a[208:209], v231 offset:40960
  ds_read_b64_tr_b16 a[210:211], v231 offset:43008
  s_waitcnt lgkmcnt(13)
  v_mfma_f32_16x16x32_bf16 v[96:99], a[212:215], a[32:35], v[96:99]
  v_mfma_f32_16x16x32_bf16 v[96:99], a[216:219], a[48:51], v[96:99]
  v_mfma_f32_16x16x32_bf16 v[128:131], a[212:215], a[36:39], v[128:131]
  v_mfma_f32_16x16x32_bf16 v[128:131], a[216:219], a[52:55], v[128:131]
  v_mfma_f32_16x16x32_bf16 v[160:163], a[212:215], a[40:43], v[160:163]
  v_mfma_f32_16x16x32_bf16 v[160:163], a[216:219], a[56:59], v[160:163]
  v_mfma_f32_16x16x32_bf16 v[192:195], a[212:215], a[44:47], v[192:195]
  ds_read_b64_tr_b16 a[212:213], v231 offset:53248
  ds_read_b64_tr_b16 a[214:215], v231 offset:55296
  v_mfma_f32_16x16x32_bf16 v[192:195], a[216:219], a[60:63], v[192:195]
  ds_read_b64_tr_b16 a[216:217], v230 offset:57344
  ds_read_b64_tr_b16 a[218:219], v230 offset:59392
  v_mfma_f32_16x16x32_bf16 v[196:199], a[220:223], a[44:47], v[196:199]
  v_mfma_f32_16x16x32_bf16 v[196:199], a[224:227], a[60:63], v[196:199]
  v_mfma_f32_16x16x32_bf16 v[164:167], a[220:223], a[40:43], v[164:167]
  v_mfma_f32_16x16x32_bf16 v[164:167], a[224:227], a[56:59], v[164:167]
  v_mfma_f32_16x16x32_bf16 v[132:135], a[220:223], a[36:39], v[132:135]
  v_mfma_f32_16x16x32_bf16 v[132:135], a[224:227], a[52:55], v[132:135]
  v_mfma_f32_16x16x32_bf16 v[100:103], a[220:223], a[32:35], v[100:103]
  ds_read_b64_tr_b16 a[220:221], v234 offset:0
  ds_read_b64_tr_b16 a[222:223], v234 offset:2048
  v_mfma_f32_16x16x32_bf16 v[100:103], a[224:227], a[48:51], v[100:103]
  ds_read_b64_tr_b16 a[224:225], v231 offset:57344
  ds_read_b64_tr_b16 a[226:227], v231 offset:59392
  s_waitcnt lgkmcnt(13)
  v_mfma_f32_16x16x32_bf16 v[112:115], a[228:231], a[32:35], v[112:115]
  v_mfma_f32_16x16x32_bf16 v[112:115], a[232:235], a[48:51], v[112:115]
  v_mfma_f32_16x16x32_bf16 v[144:147], a[228:231], a[36:39], v[144:147]
  v_mfma_f32_16x16x32_bf16 v[144:147], a[232:235], a[52:55], v[144:147]
  v_mfma_f32_16x16x32_bf16 v[176:179], a[228:231], a[40:43], v[176:179]
  v_mfma_f32_16x16x32_bf16 v[176:179], a[232:235], a[56:59], v[176:179]
  v_mfma_f32_16x16x32_bf16 v[208:211], a[228:231], a[44:47], v[208:211]
  ds_read_b64_tr_b16 a[228:229], v235 offset:0
  ds_read_b64_tr_b16 a[230:231], v235 offset:2048
  v_mfma_f32_16x16x32_bf16 v[208:211], a[232:235], a[60:63], v[208:211]
  ds_read_b64_tr_b16 a[232:233], v234 offset:28672
  ds_read_b64_tr_b16 a[234:235], v234 offset:30720
  v_mfma_f32_16x16x32_bf16 v[212:215], a[192:195], a[44:47], v[212:215]
  v_mfma_f32_16x16x32_bf16 v[212:215], a[196:199], a[60:63], v[212:215]
  v_mfma_f32_16x16x32_bf16 v[180:183], a[192:195], a[40:43], v[180:183]
  v_mfma_f32_16x16x32_bf16 v[180:183], a[196:199], a[56:59], v[180:183]
  v_mfma_f32_16x16x32_bf16 v[148:151], a[192:195], a[36:39], v[148:151]
  v_mfma_f32_16x16x32_bf16 v[148:151], a[196:199], a[52:55], v[148:151]
  v_mfma_f32_16x16x32_bf16 v[116:119], a[192:195], a[32:35], v[116:119]
  ds_read_b64_tr_b16 a[192:193], v234 offset:40960
  ds_read_b64_tr_b16 a[194:195], v234 offset:43008
  v_mfma_f32_16x16x32_bf16 v[116:119], a[196:199], a[48:51], v[116:119]
  ds_read_b64_tr_b16 a[196:197], v235 offset:28672
  ds_read_b64_tr_b16 a[198:199], v235 offset:30720
  s_waitcnt lgkmcnt(13)
  v_mfma_f32_16x16x32_bf16 v[104:107], a[200:203], a[96:99], v[104:107]
  v_mul_f32 v96, s43, v96
  v_mul_f32 v97, s43, v97
  v_mfma_f32_16x16x32_bf16 v[104:107], a[204:207], a[112:115], v[104:107]
  v_mul_f32 v98, s43, v98
  v_mul_f32 v99, s43, v99
  v_mfma_f32_16x16x32_bf16 v[136:139], a[200:203], a[100:103], v[136:139]
  v_mul_f32 v100, s43, v100
  v_mul_f32 v101, s43, v101
  v_mfma_f32_16x16x32_bf16 v[136:139], a[204:207], a[116:119], v[136:139]
  v_mul_f32 v102, s43, v102
  v_mul_f32 v103, s43, v103
  v_mfma_f32_16x16x32_bf16 v[168:171], a[200:203], a[104:107], v[168:171]
  v_exp_f32 v96, v96
  v_mfma_f32_16x16x32_bf16 v[168:171], a[204:207], a[120:123], v[168:171]
  v_exp_f32 v97, v97
  v_mfma_f32_16x16x32_bf16 v[200:203], a[200:203], a[108:111], v[200:203]
  ds_read_b64_tr_b16 a[200:201], v235 offset:40960
  ds_read_b64_tr_b16 a[202:203], v235 offset:43008
  v_mfma_f32_16x16x32_bf16 v[200:203], a[204:207], a[124:127], v[200:203]
  ds_read_b64_tr_b16 a[204:205], v234 offset:49152
  ds_read_b64_tr_b16 a[206:207], v234 offset:51200
  v_mfma_f32_16x16x32_bf16 v[204:207], a[208:211], a[108:111], v[204:207]
  v_exp_f32 v98, v98
  v_mfma_f32_16x16x32_bf16 v[204:207], a[212:215], a[124:127], v[204:207]
  s_barrier
  v_exp_f32 v99, v99
  v_mfma_f32_16x16x32_bf16 v[172:175], a[208:211], a[104:107], v[172:175]
  s_mov_b32 s41, 2228224
  s_add_u32 m0, s42, 40960
  v_exp_f32 v100, v100
  v_mfma_f32_16x16x32_bf16 v[172:175], a[212:215], a[120:123], v[172:175]
  buffer_load_dwordx4 v242, s[44:47], s41 offen offset:0 lds
  v_exp_f32 v101, v101
  v_mfma_f32_16x16x32_bf16 v[140:143], a[208:211], a[100:103], v[140:143]
  s_mov_b32 s41, 1966080
  s_add_u32 m0, s42, 53248
  v_exp_f32 v102, v102
  v_mfma_f32_16x16x32_bf16 v[140:143], a[212:215], a[116:119], v[140:143]
  v_exp_f32 v103, v103
  v_add_f32 v96, 1.0, v96
  v_mfma_f32_16x16x32_bf16 v[108:111], a[208:211], a[96:99], v[108:111]
  ds_read_b64_tr_b16 a[208:209], v238 offset:12288
  ds_read_b64_tr_b16 a[210:211], v238 offset:14336
  v_add_f32 v97, 1.0, v97
  v_add_f32 v98, 1.0, v98
  v_mfma_f32_16x16x32_bf16 v[108:111], a[212:215], a[112:115], v[108:111]
  ds_read_b64_tr_b16 a[212:213], v235 offset:49152
  ds_read_b64_tr_b16 a[214:215], v235 offset:51200
  v_add_f32 v99, 1.0, v99
  s_waitcnt lgkmcnt(13)
  v_mfma_f32_16x16x32_bf16 v[120:123], a[216:219], a[96:99], v[120:123]
  buffer_load_dwordx4 v253, s[44:47], s41 offen offset:0 lds
  v_add_f32 v100, 1.0, v100
  v_add_f32 v101, 1.0, v101
  v_mfma_f32_16x16x32_bf16 v[120:123], a[220:223], a[112:115], v[120:123]
  v_add_f32 v102, 1.0, v102
  v_add_f32 v103, 1.0, v103
  v_mfma_f32_16x16x32_bf16 v[152:155], a[216:219], a[100:103], v[152:155]
  v_rcp_f32 v96, v96
  v_mfma_f32_16x16x32_bf16 v[152:155], a[220:223], a[116:119], v[152:155]
  v_rcp_f32 v97, v97
  v_mfma_f32_16x16x32_bf16 v[184:187], a[216:219], a[104:107], v[184:187]
  v_rcp_f32 v98, v98
  v_mfma_f32_16x16x32_bf16 v[184:187], a[220:223], a[120:123], v[184:187]
  v_rcp_f32 v99, v99
  v_mfma_f32_16x16x32_bf16 v[216:219], a[216:219], a[108:111], v[216:219]
  ds_read_b64_tr_b16 a[216:217], v239 offset:12288
  ds_read_b64_tr_b16 a[218:219], v239 offset:14336
  v_mfma_f32_16x16x32_bf16 v[216:219], a[220:223], a[124:127], v[216:219]
  ds_read_b64_tr_b16 a[220:221], v234 offset:4096
  ds_read_b64_tr_b16 a[222:223], v234 offset:6144
  v_mfma_f32_16x16x32_bf16 v[220:223], a[224:227], a[108:111], v[220:223]
  v_rcp_f32 v100, v100
  v_mfma_f32_16x16x32_bf16 v[220:223], a[228:231], a[124:127], v[220:223]
  v_rcp_f32 v101, v101
  v_mfma_f32_16x16x32_bf16 v[188:191], a[224:227], a[104:107], v[188:191]
  s_waitcnt vmcnt(2)
  v_add_u32 v248, 1, v245
  buffer_store_dword v248, v246, s[4:7], s90 offen sc1
  v_rcp_f32 v102, v102
  v_mfma_f32_16x16x32_bf16 v[188:191], a[228:231], a[120:123], v[188:191]
  v_rcp_f32 v103, v103
  v_mul_f32 v96, v96, v112
  v_mfma_f32_16x16x32_bf16 v[156:159], a[224:227], a[100:103], v[156:159]
  v_mul_f32 v97, v97, v113
  v_mul_f32 v98, v98, v114
  v_mfma_f32_16x16x32_bf16 v[156:159], a[228:231], a[116:119], v[156:159]
  v_mul_f32 v99, v99, v115
  v_mul_f32 v100, v100, v116
  v_mfma_f32_16x16x32_bf16 v[124:127], a[224:227], a[96:99], v[124:127]
  ds_read_b64_tr_b16 a[224:225], v234 offset:16384
  ds_read_b64_tr_b16 a[226:227], v234 offset:18432
  v_mul_f32 v101, v101, v117
  v_mul_f32 v102, v102, v118
  v_mfma_f32_16x16x32_bf16 v[124:127], a[228:231], a[112:115], v[124:127]
  ds_read_b64_tr_b16 a[228:229], v235 offset:4096
  ds_read_b64_tr_b16 a[230:231], v235 offset:6144
  v_mul_f32 v103, v103, v119
  s_waitcnt lgkmcnt(13)
  v_mfma_f32_16x16x32_bf16 v[104:107], a[232:235], a[128:131], v[104:107]
  v_cvt_pk_bf16_f32 v96, v96, v97
  v_cvt_pk_bf16_f32 v97, v98, v99
  v_mfma_f32_16x16x32_bf16 v[104:107], a[192:195], a[144:147], v[104:107]
  v_cvt_pk_bf16_f32 v98, v100, v101
  v_cvt_pk_bf16_f32 v99, v102, v103
  v_mfma_f32_16x16x32_bf16 v[136:139], a[232:235], a[132:135], v[136:139]
  buffer_store_dwordx4 v[96:99], v225, s[4:7], s20 offen offset:0 sc1
  v_mfma_f32_16x16x32_bf16 v[136:139], a[192:195], a[148:151], v[136:139]
  v_mul_f32 v128, s43, v128
  v_mul_f32 v129, s43, v129
  v_mfma_f32_16x16x32_bf16 v[168:171], a[232:235], a[136:139], v[168:171]
  v_mul_f32 v130, s43, v130
  v_mul_f32 v131, s43, v131
  v_mfma_f32_16x16x32_bf16 v[168:171], a[192:195], a[152:155], v[168:171]
  v_mul_f32 v132, s43, v132
  v_mul_f32 v133, s43, v133
  v_mfma_f32_16x16x32_bf16 v[200:203], a[232:235], a[140:143], v[200:203]
  ds_read_b64_tr_b16 a[232:233], v235 offset:16384
  ds_read_b64_tr_b16 a[234:235], v235 offset:18432
  v_mul_f32 v134, s43, v134
  v_mfma_f32_16x16x32_bf16 v[200:203], a[192:195], a[156:159], v[200:203]
  ds_read_b64_tr_b16 a[192:193], v230 offset:61440
  ds_read_b64_tr_b16 a[194:195], v230 offset:63488
  v_mul_f32 v135, s43, v135
  v_mfma_f32_16x16x32_bf16 v[204:207], a[196:199], a[140:143], v[204:207]
  v_exp_f32 v128, v128
  v_mfma_f32_16x16x32_bf16 v[204:207], a[200:203], a[156:159], v[204:207]
  v_exp_f32 v129, v129
  v_mfma_f32_16x16x32_bf16 v[172:175], a[196:199], a[136:139], v[172:175]
  v_exp_f32 v130, v130
  v_mfma_f32_16x16x32_bf16 v[172:175], a[200:203], a[152:155], v[172:175]
  v_exp_f32 v131, v131
  v_mfma_f32_16x16x32_bf16 v[140:143], a[196:199], a[132:135], v[140:143]
  v_exp_f32 v132, v132
  v_mfma_f32_16x16x32_bf16 v[140:143], a[200:203], a[148:151], v[140:143]
  v_exp_f32 v133, v133
  v_mfma_f32_16x16x32_bf16 v[108:111], a[196:199], a[128:131], v[108:111]
  ds_read_b64_tr_b16 a[196:197], v234 offset:24576
  ds_read_b64_tr_b16 a[198:199], v234 offset:26624
  v_mfma_f32_16x16x32_bf16 v[108:111], a[200:203], a[144:147], v[108:111]
  ds_read_b64_tr_b16 a[200:201], v231 offset:61440
  ds_read_b64_tr_b16 a[202:203], v231 offset:63488
  s_waitcnt lgkmcnt(13)
  v_mfma_f32_16x16x32_bf16 v[120:123], a[204:207], a[128:131], v[120:123]
  v_exp_f32 v134, v134
  v_mfma_f32_16x16x32_bf16 v[120:123], a[208:211], a[144:147], v[120:123]
  v_exp_f32 v135, v135
  v_add_f32 v128, 1.0, v128
  v_add_f32 v129, 1.0, v129
  v_mfma_f32_16x16x32_bf16 v[152:155], a[204:207], a[132:135], v[152:155]
  v_add_f32 v130, 1.0, v130
  v_add_f32 v131, 1.0, v131
  v_mfma_f32_16x16x32_bf16 v[152:155], a[208:211], a[148:151], v[152:155]
  v_add_f32 v132, 1.0, v132
  v_add_f32 v133, 1.0, v133
  v_mfma_f32_16x16x32_bf16 v[184:187], a[204:207], a[136:139], v[184:187]
  v_add_f32 v134, 1.0, v134
  v_add_f32 v135, 1.0, v135
  v_mfma_f32_16x16x32_bf16 v[184:187], a[208:211], a[152:155], v[184:187]
  v_rcp_f32 v128, v128
  v_mfma_f32_16x16x32_bf16 v[216:219], a[204:207], a[140:143], v[216:219]
  ds_read_b64_tr_b16 a[204:205], v235 offset:24576
  ds_read_b64_tr_b16 a[206:207], v235 offset:26624
  v_mfma_f32_16x16x32_bf16 v[216:219], a[208:211], a[156:159], v[216:219]
  ds_read_b64_tr_b16 a[208:209], v234 offset:53248
  ds_read_b64_tr_b16 a[210:211], v234 offset:55296
  v_mfma_f32_16x16x32_bf16 v[220:223], a[212:215], a[140:143], v[220:223]
  v_rcp_f32 v129, v129
  v_mfma_f32_16x16x32_bf16 v[220:223], a[216:219], a[156:159], v[220:223]
L_wk1_7:
  s_cbranch_vccnz L_wk1_11
  v_rcp_f32 v130, v130
  v_mfma_f32_16x16x32_bf16 v[188:191], a[212:215], a[136:139], v[188:191]
  v_rcp_f32 v131, v131
  v_mfma_f32_16x16x32_bf16 v[188:191], a[216:219], a[152:155], v[188:191]
  v_rcp_f32 v132, v132
  v_mfma_f32_16x16x32_bf16 v[156:159], a[212:215], a[132:135], v[156:159]
  v_rcp_f32 v133, v133
  v_mfma_f32_16x16x32_bf16 v[156:159], a[216:219], a[148:151], v[156:159]
  v_rcp_f32 v134, v134
  v_mfma_f32_16x16x32_bf16 v[124:127], a[212:215], a[128:131], v[124:127]
  ds_read_b64_tr_b16 a[212:213], v238 offset:0
  ds_read_b64_tr_b16 a[214:215], v238 offset:2048
  v_rcp_f32 v135, v135
  v_mul_f32 v128, v128, v144
  v_mfma_f32_16x16x32_bf16 v[124:127], a[216:219], a[144:147], v[124:127]
  ds_read_b64_tr_b16 a[216:217], v235 offset:53248
  ds_read_b64_tr_b16 a[218:219], v235 offset:55296
  v_mul_f32 v129, v129, v145
  s_waitcnt lgkmcnt(13)
  v_mfma_f32_16x16x32_bf16 v[104:107], a[220:223], a[160:163], v[104:107]
  v_mul_f32 v130, v130, v146
  v_mul_f32 v131, v131, v147
  v_mfma_f32_16x16x32_bf16 v[104:107], a[224:227], a[176:179], v[104:107]
  s_barrier
  v_mul_f32 v132, v132, v148
  v_mul_f32 v133, v133, v149
  v_mfma_f32_16x16x32_bf16 v[136:139], a[220:223], a[164:167], v[136:139]
  s_mov_b32 s41, 2228224
  s_add_u32 m0, s42, 57344
  v_mul_f32 v134, v134, v150
  v_mul_f32 v135, v135, v151
  v_mfma_f32_16x16x32_bf16 v[136:139], a[224:227], a[180:183], v[136:139]
  buffer_load_dwordx4 v253, s[44:47], s41 offen offset:0 lds
  v_cvt_pk_bf16_f32 v128, v128, v129
  v_mfma_f32_16x16x32_bf16 v[168:171], a[220:223], a[168:171], v[168:171]
  s_mov_b32 s41, 2293760
  s_add_u32 m0, s42, 65536
  v_cvt_pk_bf16_f32 v129, v130, v131
  v_cvt_pk_bf16_f32 v130, v132, v133
  v_mfma_f32_16x16x32_bf16 v[168:171], a[224:227], a[184:187], v[168:171]
  buffer_load_dword v244, v243, s[4:7], s91 offen sc1
  v_cvt_pk_bf16_f32 v131, v134, v135
  v_mfma_f32_16x16x32_bf16 v[200:203], a[220:223], a[172:175], v[200:203]
  ds_read_b64_tr_b16 a[220:221], v239 offset:0
  ds_read_b64_tr_b16 a[222:223], v239 offset:2048
  buffer_store_dwordx4 v[128:131], v225, s[4:7], s20 offen offset:1024 sc1
  v_mul_f32 v160, s43, v160
  v_mfma_f32_16x16x32_bf16 v[200:203], a[224:227], a[188:191], v[200:203]
  ds_read_b64_tr_b16 a[224:225], v234 offset:12288
  ds_read_b64_tr_b16 a[226:227], v234 offset:14336
  v_mul_f32 v161, s43, v161
  v_mfma_f32_16x16x32_bf16 v[204:207], a[228:231], a[172:175], v[204:207]
  buffer_load_dwordx4 v242, s[44:47], s41 offen offset:0 lds
  v_mul_f32 v162, s43, v162
  v_mul_f32 v163, s43, v163
  v_mfma_f32_16x16x32_bf16 v[204:207], a[232:235], a[188:191], v[204:207]
  s_mov_b32 s41, 2555904
  s_add_u32 m0, s42, 94208
  v_mul_f32 v164, s43, v164
  v_mul_f32 v165, s43, v165
  v_mfma_f32_16x16x32_bf16 v[172:175], a[228:231], a[168:171], v[172:175]
  v_mul_f32 v166, s43, v166
  v_mul_f32 v167, s43, v167
  v_mfma_f32_16x16x32_bf16 v[172:175], a[232:235], a[184:187], v[172:175]
  v_exp_f32 v160, v160
  v_mfma_f32_16x16x32_bf16 v[140:143], a[228:231], a[164:167], v[140:143]
  v_exp_f32 v161, v161
  v_mfma_f32_16x16x32_bf16 v[140:143], a[232:235], a[180:183], v[140:143]
  v_exp_f32 v162, v162
  v_mfma_f32_16x16x32_bf16 v[108:111], a[228:231], a[160:163], v[108:111]
  buffer_load_dwordx4 v242, s[44:47], s41 offen offset:0 lds
  v_mfma_f32_16x16x32_bf16 v[108:111], a[232:235], a[176:179], v[108:111]
  ds_read_b64_tr_b16 a[228:229], v234 offset:8192
  ds_read_b64_tr_b16 a[230:231], v234 offset:10240
  s_waitcnt lgkmcnt(13)
  v_mfma_f32_16x16x32_bf16 v[120:123], a[192:195], a[160:163], v[120:123]
  ds_read_b64_tr_b16 a[232:233], v235 offset:12288
  ds_read_b64_tr_b16 a[234:235], v235 offset:14336
  v_exp_f32 v163, v163
  v_mfma_f32_16x16x32_bf16 v[120:123], a[196:199], a[176:179], v[120:123]
  s_mov_b32 s41, 2293760
  s_add_u32 m0, s42, 106496
  v_exp_f32 v164, v164
  v_mfma_f32_16x16x32_bf16 v[152:155], a[192:195], a[164:167], v[152:155]
  v_exp_f32 v165, v165
  v_mfma_f32_16x16x32_bf16 v[152:155], a[196:199], a[180:183], v[152:155]
  v_exp_f32 v166, v166
  v_mfma_f32_16x16x32_bf16 v[184:187], a[192:195], a[168:171], v[184:187]
  buffer_load_dwordx4 v253, s[44:47], s41 offen offset:0 lds
  v_exp_f32 v167, v167
  v_add_f32 v160, 1.0, v160
  v_mfma_f32_16x16x32_bf16 v[184:187], a[196:199], a[184:187], v[184:187]
  s_mov_b32 s41, 2555904
  s_add_u32 m0, s42, 114688
  v_add_f32 v161, 1.0, v161
  v_add_f32 v162, 1.0, v162
  v_mfma_f32_16x16x32_bf16 v[216:219], a[192:195], a[172:175], v[216:219]
  ds_read_b64_tr_b16 a[192:193], v235 offset:8192
  ds_read_b64_tr_b16 a[194:195], v235 offset:10240
  v_add_f32 v163, 1.0, v163
  v_add_f32 v164, 1.0, v164
  v_mfma_f32_16x16x32_bf16 v[216:219], a[196:199], a[188:191], v[216:219]
  ds_read_b64_tr_b16 a[196:197], v234 offset:20480
  ds_read_b64_tr_b16 a[198:199], v234 offset:22528
  v_add_f32 v165, 1.0, v165
  v_mfma_f32_16x16x32_bf16 v[220:223], a[200:203], a[172:175], v[220:223]
  v_add_f32 v166, 1.0, v166
  v_add_f32 v167, 1.0, v167
  s_waitcnt lgkmcnt(13)
  v_mfma_f32_16x16x32_bf16 v[220:223], a[204:207], a[188:191], v[220:223]
  v_rcp_f32 v160, v160
  v_mfma_f32_16x16x32_bf16 v[188:191], a[200:203], a[168:171], v[188:191]
  buffer_load_dwordx4 v253, s[44:47], s41 offen offset:0 lds
  v_mfma_f32_16x16x32_bf16 v[188:191], a[204:207], a[184:187], v[188:191]
  s_mov_b32 s41, 2883584
  s_add_u32 m0, s42, 143360
  v_rcp_f32 v161, v161
  v_mfma_f32_16x16x32_bf16 v[156:159], a[200:203], a[164:167], v[156:159]
  v_rcp_f32 v162, v162
  v_mfma_f32_16x16x32_bf16 v[156:159], a[204:207], a[180:183], v[156:159]
  v_rcp_f32 v163, v163
  v_mfma_f32_16x16x32_bf16 v[124:127], a[200:203], a[160:163], v[124:127]
  ds_read_b64_tr_b16 a[200:201], v234 offset:36864
  ds_read_b64_tr_b16 a[202:203], v234 offset:38912
  v_rcp_f32 v164, v164
  v_mfma_f32_16x16x32_bf16 v[124:127], a[204:207], a[176:179], v[124:127]
  ds_read_b64_tr_b16 a[204:205], v235 offset:20480
  ds_read_b64_tr_b16 a[206:207], v235 offset:22528
  v_mfma_f32_16x16x32_bf16 v[104:107], a[208:211], a[0:3], v[104:107]
  buffer_load_dwordx4 v242, s[44:47], s41 offen offset:0 lds
  v_rcp_f32 v165, v165
  v_mfma_f32_16x16x32_bf16 v[104:107], a[212:215], a[16:19], v[104:107]
  s_mov_b32 s41, 3145728
  s_add_u32 m0, s42, 69632
  v_rcp_f32 v166, v166
  v_mfma_f32_16x16x32_bf16 v[136:139], a[208:211], a[4:7], v[136:139]
  v_rcp_f32 v167, v167
  v_mul_f32 v160, v160, v176
  v_mul_f32 v161, v161, v177
  v_mfma_f32_16x16x32_bf16 v[136:139], a[212:215], a[20:23], v[136:139]
  v_mul_f32 v162, v162, v178
  v_mul_f32 v163, v163, v179
  v_mfma_f32_16x16x32_bf16 v[168:171], a[208:211], a[8:11], v[168:171]
  v_mul_f32 v164, v164, v180
  v_mul_f32 v165, v165, v181
  v_mfma_f32_16x16x32_bf16 v[168:171], a[212:215], a[24:27], v[168:171]
  v_mul_f32 v166, v166, v182
  v_mul_f32 v167, v167, v183
  v_mfma_f32_16x16x32_bf16 v[200:203], a[208:211], a[12:15], v[200:203]
  buffer_load_dwordx4 v242, s[44:47], s41 offen offset:0 lds
  v_cvt_pk_bf16_f32 v160, v160, v161
  v_mfma_f32_16x16x32_bf16 v[200:203], a[212:215], a[28:31], v[200:203]
  ds_read_b64_tr_b16 a[208:209], v235 offset:36864
  ds_read_b64_tr_b16 a[210:211], v235 offset:38912
  v_cvt_pk_bf16_f32 v161, v162, v163
  s_waitcnt lgkmcnt(13)
  v_mfma_f32_16x16x32_bf16 v[204:207], a[216:219], a[12:15], v[204:207]
  ds_read_b64_tr_b16 a[212:213], v234 offset:32768
  ds_read_b64_tr_b16 a[214:215], v234 offset:34816
  v_cvt_pk_bf16_f32 v162, v164, v165
  v_cvt_pk_bf16_f32 v163, v166, v167
  v_mfma_f32_16x16x32_bf16 v[204:207], a[220:223], a[28:31], v[204:207]
  s_mov_b32 s41, 2883584
  s_add_u32 m0, s42, 81920
  v_mfma_f32_16x16x32_bf16 v[172:175], a[216:219], a[8:11], v[172:175]
  buffer_store_dwordx4 v[160:163], v225, s[4:7], s20 offen offset:2048 sc1
  v_mul_f32 v192, s43, v192
  v_mul_f32 v193, s43, v193
  v_mfma_f32_16x16x32_bf16 v[172:175], a[220:223], a[24:27], v[172:175]
  v_mul_f32 v194, s43, v194
  v_mul_f32 v195, s43, v195
  v_mfma_f32_16x16x32_bf16 v[140:143], a[216:219], a[4:7], v[140:143]
  buffer_load_dwordx4 v253, s[44:47], s41 offen offset:0 lds
  v_mul_f32 v196, s43, v196
  v_mfma_f32_16x16x32_bf16 v[140:143], a[220:223], a[20:23], v[140:143]
  s_waitcnt vmcnt(9)
  v_subrev_u32 v244, s100, v244
  v_cmp_lt_u32 s[68:69], 7, v244
  v_mul_f32 v197, s43, v197
  v_mul_f32 v198, s43, v198
  v_mfma_f32_16x16x32_bf16 v[108:111], a[216:219], a[0:3], v[108:111]
  ds_read_b64_tr_b16 a[216:217], v234 offset:45056
  ds_read_b64_tr_b16 a[218:219], v234 offset:47104
  s_cmp_lg_u64 s[68:69], 0
  s_cbranch_scc1 L_slow_31
L_back_32:
  v_mul_f32 v199, s43, v199
  v_mfma_f32_16x16x32_bf16 v[108:111], a[220:223], a[16:19], v[108:111]
  ds_read_b64_tr_b16 a[220:221], v235 offset:32768
  ds_read_b64_tr_b16 a[222:223], v235 offset:34816
  v_mfma_f32_16x16x32_bf16 v[120:123], a[224:227], a[0:3], v[120:123]
  s_mov_b32 s40, 17825792
  v_exp_f32 v192, v192
  s_waitcnt lgkmcnt(13)
  v_mfma_f32_16x16x32_bf16 v[120:123], a[228:231], a[16:19], v[120:123]
  buffer_load_dwordx4 a[64:67], v252, s[4:7], s40 offen offset:0 sc1
  v_exp_f32 v193, v193
  v_mfma_f32_16x16x32_bf16 v[152:155], a[224:227], a[4:7], v[152:155]
  v_exp_f32 v194, v194
  v_mfma_f32_16x16x32_bf16 v[152:155], a[228:231], a[20:23], v[152:155]
  buffer_load_dwordx4 a[68:71], v252, s[4:7], s40 offen offset:1024 sc1
  v_exp_f32 v195, v195
  v_mfma_f32_16x16x32_bf16 v[184:187], a[224:227], a[8:11], v[184:187]
  s_mov_b32 s40, 17956864
  v_exp_f32 v196, v196
  v_mfma_f32_16x16x32_bf16 v[184:187], a[228:231], a[24:27], v[184:187]
  buffer_load_dwordx4 a[72:75], v252, s[4:7], s40 offen offset:0 sc1
  v_exp_f32 v197, v197
  v_mfma_f32_16x16x32_bf16 v[216:219], a[224:227], a[12:15], v[216:219]
  ds_read_b64_tr_b16 a[224:225], v235 offset:45056
  ds_read_b64_tr_b16 a[226:227], v235 offset:47104
  v_exp_f32 v198, v198
  v_mfma_f32_16x16x32_bf16 v[216:219], a[228:231], a[28:31], v[216:219]
  buffer_load_dwordx4 a[76:79], v252, s[4:7], s40 offen offset:1024 sc1
  v_mfma_f32_16x16x32_bf16 v[220:223], a[232:235], a[12:15], v[220:223]
  ds_read_b64_tr_b16 a[228:229], v232 offset:61440
  ds_read_b64_tr_b16 a[230:231], v232 offset:63488
  v_exp_f32 v199, v199
  v_add_f32 v192, 1.0, v192
  v_add_f32 v193, 1.0, v193
  v_mfma_f32_16x16x32_bf16 v[220:223], a[192:195], a[28:31], v[220:223]
  s_barrier
  v_add_f32 v194, 1.0, v194
  v_add_f32 v195, 1.0, v195
  v_mfma_f32_16x16x32_bf16 v[188:191], a[232:235], a[8:11], v[188:191]
  s_mov_b32 s40, 18087936
  v_add_f32 v196, 1.0, v196
  v_add_f32 v197, 1.0, v197
  v_mfma_f32_16x16x32_bf16 v[188:191], a[192:195], a[24:27], v[188:191]
  v_add_f32 v198, 1.0, v198
  v_add_f32 v199, 1.0, v199
  v_mfma_f32_16x16x32_bf16 v[156:159], a[232:235], a[4:7], v[156:159]
  v_rcp_f32 v192, v192
  v_mfma_f32_16x16x32_bf16 v[156:159], a[192:195], a[20:23], v[156:159]
  v_rcp_f32 v193, v193
  v_mfma_f32_16x16x32_bf16 v[124:127], a[232:235], a[0:3], v[124:127]
  buffer_load_dwordx4 a[80:83], v252, s[4:7], s40 offen offset:0 sc1
  v_mfma_f32_16x16x32_bf16 v[124:127], a[192:195], a[16:19], v[124:127]
  ds_read_b64_tr_b16 a[232:233], v232 offset:57344
  ds_read_b64_tr_b16 a[234:235], v232 offset:59392
  s_waitcnt lgkmcnt(13)
  v_mfma_f32_16x16x32_bf16 v[104:107], a[196:199], a[32:35], v[104:107]
  ds_read_b64_tr_b16 a[192:193], v233 offset:61440
  ds_read_b64_tr_b16 a[194:195], v233 offset:63488
  v_rcp_f32 v194, v194
  v_mfma_f32_16x16x32_bf16 v[104:107], a[200:203], a[48:51], v[104:107]
  v_rcp_f32 v195, v195
  v_mfma_f32_16x16x32_bf16 v[136:139], a[196:199], a[36:39], v[136:139]
  v_rcp_f32 v196, v196
  v_mfma_f32_16x16x32_bf16 v[136:139], a[200:203], a[52:55], v[136:139]
  v_rcp_f32 v197, v197
  v_mfma_f32_16x16x32_bf16 v[168:171], a[196:199], a[40:43], v[168:171]
  buffer_load_dwordx4 a[84:87], v252, s[4:7], s40 offen offset:1024 sc1
  v_rcp_f32 v198, v198
  v_mfma_f32_16x16x32_bf16 v[168:171], a[200:203], a[56:59], v[168:171]
  s_mov_b32 s40, 18219008
  v_rcp_f32 v199, v199
  v_mul_f32 v192, v192, v208
  v_mfma_f32_16x16x32_bf16 v[200:203], a[196:199], a[44:47], v[200:203]
  buffer_load_dwordx4 a[88:91], v252, s[4:7], s40 offen offset:0 sc1
  v_mul_f32 v193, v193, v209
  v_mul_f32 v194, v194, v210
  v_mfma_f32_16x16x32_bf16 v[200:203], a[200:203], a[60:63], v[200:203]
  ds_read_b64_tr_b16 a[196:197], v233 offset:57344
  ds_read_b64_tr_b16 a[198:199], v233 offset:59392
  v_mul_f32 v195, v195, v211
  v_mfma_f32_16x16x32_bf16 v[204:207], a[204:207], a[44:47], v[204:207]
  buffer_load_dwordx4 a[92:95], v252, s[4:7], s40 offen offset:1024 sc1
  v_mul_f32 v196, v196, v212
  v_mul_f32 v197, v197, v213
  s_waitcnt lgkmcnt(13)
  v_mfma_f32_16x16x32_bf16 v[204:207], a[208:211], a[60:63], v[204:207]
  ds_read_b64_tr_b16 a[200:201], v234 offset:61440
  ds_read_b64_tr_b16 a[202:203], v234 offset:63488
  v_mul_f32 v198, v198, v214
  v_mul_f32 v199, v199, v215
  v_mfma_f32_16x16x32_bf16 v[172:175], a[204:207], a[40:43], v[172:175]
  s_mov_b32 s40, 18350080
  v_cvt_pk_bf16_f32 v192, v192, v193
  v_cvt_pk_bf16_f32 v193, v194, v195
  v_mfma_f32_16x16x32_bf16 v[172:175], a[208:211], a[56:59], v[172:175]
  v_cvt_pk_bf16_f32 v194, v196, v197
  v_cvt_pk_bf16_f32 v195, v198, v199
  v_mfma_f32_16x16x32_bf16 v[140:143], a[204:207], a[36:39], v[140:143]
  buffer_store_dwordx4 v[192:195], v225, s[4:7], s20 offen offset:3072 sc1
  v_mfma_f32_16x16x32_bf16 v[140:143], a[208:211], a[52:55], v[140:143]
  v_mfma_f32_16x16x32_bf16 v[108:111], a[204:207], a[32:35], v[108:111]
  ds_read_b64_tr_b16 a[204:205], v234 offset:57344
  ds_read_b64_tr_b16 a[206:207], v234 offset:59392
  v_mfma_f32_16x16x32_bf16 v[108:111], a[208:211], a[48:51], v[108:111]
  buffer_load_dwordx4 a[96:99], v252, s[4:7], s40 offen offset:0 sc1
  v_mfma_f32_16x16x32_bf16 v[120:123], a[212:215], a[32:35], v[120:123]
  ds_read_b64_tr_b16 a[208:209], v235 offset:61440
  ds_read_b64_tr_b16 a[210:211], v235 offset:63488
  s_waitcnt lgkmcnt(13)
  v_mfma_f32_16x16x32_bf16 v[120:123], a[216:219], a[48:51], v[120:123]
  v_mfma_f32_16x16x32_bf16 v[152:155], a[212:215], a[36:39], v[152:155]
  v_mfma_f32_16x16x32_bf16 v[152:155], a[216:219], a[52:55], v[152:155]
  v_mfma_f32_16x16x32_bf16 v[184:187], a[212:215], a[40:43], v[184:187]
  v_mfma_f32_16x16x32_bf16 v[184:187], a[216:219], a[56:59], v[184:187]
  buffer_load_dwordx4 a[100:103], v252, s[4:7], s40 offen offset:1024 sc1
  v_mfma_f32_16x16x32_bf16 v[216:219], a[212:215], a[44:47], v[216:219]
  ds_read_b64_tr_b16 a[212:213], v235 offset:57344
  ds_read_b64_tr_b16 a[214:215], v235 offset:59392
  v_mfma_f32_16x16x32_bf16 v[216:219], a[216:219], a[60:63], v[216:219]
  ds_read_b64_tr_b16 a[216:217], v236 offset:4096
  ds_read_b64_tr_b16 a[218:219], v236 offset:6144
  v_mfma_f32_16x16x32_bf16 v[220:223], a[220:223], a[44:47], v[220:223]
  s_mov_b32 s40, 18481152
  v_mfma_f32_16x16x32_bf16 v[220:223], a[224:227], a[60:63], v[220:223]
  v_mfma_f32_16x16x32_bf16 v[188:191], a[220:223], a[40:43], v[188:191]
  v_mfma_f32_16x16x32_bf16 v[188:191], a[224:227], a[56:59], v[188:191]
  buffer_load_dwordx4 a[104:107], v252, s[4:7], s40 offen offset:0 sc1
  v_mfma_f32_16x16x32_bf16 v[156:159], a[220:223], a[36:39], v[156:159]
  v_mfma_f32_16x16x32_bf16 v[156:159], a[224:227], a[52:55], v[156:159]
  v_mfma_f32_16x16x32_bf16 v[124:127], a[220:223], a[32:35], v[124:127]
  ds_read_b64_tr_b16 a[220:221], v236 offset:20480
  ds_read_b64_tr_b16 a[222:223], v236 offset:22528
  v_mfma_f32_16x16x32_bf16 v[124:127], a[224:227], a[48:51], v[124:127]
  ds_read_b64_tr_b16 a[224:225], v237 offset:4096
  ds_read_b64_tr_b16 a[226:227], v237 offset:6144
  s_waitcnt vmcnt(8) lgkmcnt(13)
  v_mfma_f32_16x16x32_bf16 v[32:35], a[228:231], a[64:67], 0
  v_mul_f32 v104, s43, v104
  v_mul_f32 v105, s43, v105
  v_mfma_f32_16x16x32_bf16 v[32:35], a[232:235], a[72:75], v[32:35]
  s_barrier
  v_mfma_f32_16x16x32_bf16 v[48:51], a[228:231], a[68:71], 0
  buffer_load_dwordx4 a[108:111], v252, s[4:7], s40 offen offset:1024 sc1
  v_mfma_f32_16x16x32_bf16 v[48:51], a[232:235], a[76:79], v[48:51]
  ds_read_b64_tr_b16 a[228:229], v237 offset:20480
  ds_read_b64_tr_b16 a[230:231], v237 offset:22528
  v_mul_f32 v106, s43, v106
  v_mfma_f32_16x16x32_bf16 v[52:55], a[192:195], a[68:71], 0
  ds_read_b64_tr_b16 a[232:233], v238 offset:4096
  ds_read_b64_tr_b16 a[234:235], v238 offset:6144
  v_mul_f32 v107, s43, v107
  v_mfma_f32_16x16x32_bf16 v[52:55], a[196:199], a[76:79], v[52:55]
  s_mov_b32 s40, 18612224
  v_mul_f32 v108, s43, v108
  v_mfma_f32_16x16x32_bf16 v[36:39], a[192:195], a[64:67], 0
  buffer_load_dwordx4 a[112:115], v252, s[4:7], s40 offen offset:0 sc1
  v_mfma_f32_16x16x32_bf16 v[36:39], a[196:199], a[72:75], v[36:39]
  ds_read_b64_tr_b16 a[192:193], v238 offset:20480
  ds_read_b64_tr_b16 a[194:195], v238 offset:22528
  v_mul_f32 v109, s43, v109
  s_waitcnt lgkmcnt(13)
  v_mfma_f32_16x16x32_bf16 v[40:43], a[200:203], a[64:67], 0
  ds_read_b64_tr_b16 a[196:197], v239 offset:4096
  ds_read_b64_tr_b16 a[198:199], v239 offset:6144
  v_mul_f32 v110, s43, v110
  v_mfma_f32_16x16x32_bf16 v[40:43], a[204:207], a[72:75], v[40:43]
  buffer_load_dwordx4 a[116:119], v252, s[4:7], s40 offen offset:1024 sc1
  v_mfma_f32_16x16x32_bf16 v[56:59], a[200:203], a[68:71], 0
  ds_read_b64_tr_b16 a[200:201], v239 offset:20480
  ds_read_b64_tr_b16 a[202:203], v239 offset:22528
  v_mul_f32 v111, s43, v111
  v_mfma_f32_16x16x32_bf16 v[56:59], a[204:207], a[76:79], v[56:59]
  ds_read_b64_tr_b16 a[204:205], v236 offset:16384
  ds_read_b64_tr_b16 a[206:207], v236 offset:18432
  v_mfma_f32_16x16x32_bf16 v[60:63], a[208:211], a[68:71], 0
  s_mov_b32 s40, 18743296
  v_exp_f32 v104, v104
  s_waitcnt lgkmcnt(13)
  v_mfma_f32_16x16x32_bf16 v[60:63], a[212:215], a[76:79], v[60:63]
  buffer_load_dwordx4 a[120:123], v252, s[4:7], s40 offen offset:0 sc1
  v_mfma_f32_16x16x32_bf16 v[44:47], a[208:211], a[64:67], 0
  ds_read_b64_tr_b16 a[208:209], v236 offset:28672
  ds_read_b64_tr_b16 a[210:211], v236 offset:30720
  v_mfma_f32_16x16x32_bf16 v[44:47], a[212:215], a[72:75], v[44:47]
  ds_read_b64_tr_b16 a[212:213], v237 offset:16384
  ds_read_b64_tr_b16 a[214:215], v237 offset:18432
  v_mfma_f32_16x16x32_bf16 v[0:3], a[216:219], a[64:67], 0
  v_exp_f32 v105, v105
  v_mfma_f32_16x16x32_bf16 v[0:3], a[220:223], a[72:75], v[0:3]
  buffer_load_dwordx4 a[124:127], v252, s[4:7], s40 offen offset:1024 sc1
  v_mfma_f32_16x16x32_bf16 v[16:19], a[216:219], a[68:71], 0
  ds_read_b64_tr_b16 a[216:217], v237 offset:28672
  ds_read_b64_tr_b16 a[218:219], v237 offset:30720
  v_mfma_f32_16x16x32_bf16 v[16:19], a[220:223], a[76:79], v[16:19]
  ds_read_b64_tr_b16 a[220:221], v238 offset:16384
  ds_read_b64_tr_b16 a[222:223], v238 offset:18432
  v_exp_f32 v106, v106
  s_waitcnt lgkmcnt(13)
  v_mfma_f32_16x16x32_bf16 v[20:23], a[224:227], a[68:71], 0
  s_mov_b32 s40, 18874368
  v_exp_f32 v107, v107
  v_mfma_f32_16x16x32_bf16 v[20:23], a[228:231], a[76:79], v[20:23]
  buffer_load_dwordx4 a[128:131], v252, s[4:7], s40 offen offset:0 sc1
  v_mfma_f32_16x16x32_bf16 v[4:7], a[224:227], a[64:67], 0
  ds_read_b64_tr_b16 a[224:225], v238 offset:28672
  ds_read_b64_tr_b16 a[226:227], v238 offset:30720
  v_mfma_f32_16x16x32_bf16 v[4:7], a[228:231], a[72:75], v[4:7]
  ds_read_b64_tr_b16 a[228:229], v239 offset:16384
  ds_read_b64_tr_b16 a[230:231], v239 offset:18432
  v_mfma_f32_16x16x32_bf16 v[8:11], a[232:235], a[64:67], 0
  v_exp_f32 v108, v108
  v_mfma_f32_16x16x32_bf16 v[8:11], a[192:195], a[72:75], v[8:11]
  buffer_load_dwordx4 a[132:135], v252, s[4:7], s40 offen offset:1024 sc1
  v_mfma_f32_16x16x32_bf16 v[24:27], a[232:235], a[68:71], 0
  ds_read_b64_tr_b16 a[232:233], v239 offset:28672
  ds_read_b64_tr_b16 a[234:235], v239 offset:30720
  v_mfma_f32_16x16x32_bf16 v[24:27], a[192:195], a[76:79], v[24:27]
  ds_read_b64_tr_b16 a[192:193], v228 offset:16384
  ds_read_b64_tr_b16 a[194:195], v228 offset:18432
  v_exp_f32 v109, v109
  s_waitcnt lgkmcnt(13)
  v_mfma_f32_16x16x32_bf16 v[28:31], a[196:199], a[68:71], 0
  s_mov_b32 s40, 19005440
  v_exp_f32 v110, v110
  v_mfma_f32_16x16x32_bf16 v[28:31], a[200:203], a[76:79], v[28:31]
  buffer_load_dwordx4 a[136:139], v252, s[4:7], s40 offen offset:0 sc1
  v_mfma_f32_16x16x32_bf16 v[12:15], a[196:199], a[64:67], 0
  ds_read_b64_tr_b16 a[196:197], v228 offset:28672
  ds_read_b64_tr_b16 a[198:199], v228 offset:30720
  v_mfma_f32_16x16x32_bf16 v[12:15], a[200:203], a[72:75], v[12:15]
  ds_read_b64_tr_b16 a[200:201], v229 offset:16384
  ds_read_b64_tr_b16 a[202:203], v229 offset:18432
  s_waitcnt vmcnt(12)
  v_mfma_f32_16x16x32_bf16 v[32:35], a[204:207], a[80:83], v[32:35]
  v_exp_f32 v111, v111
  v_add_f32 v104, 1.0, v104
  v_mfma_f32_16x16x32_bf16 v[32:35], a[208:211], a[88:91], v[32:35]
  s_barrier
  v_mfma_f32_16x16x32_bf16 v[48:51], a[204:207], a[84:87], v[48:51]
  buffer_load_dwordx4 a[140:143], v252, s[4:7], s40 offen offset:1024 sc1
  v_add_f32 v105, 1.0, v105
  v_mfma_f32_16x16x32_bf16 v[48:51], a[208:211], a[92:95], v[48:51]
  ds_read_b64_tr_b16 a[204:205], v229 offset:28672
  ds_read_b64_tr_b16 a[206:207], v229 offset:30720
  v_add_f32 v106, 1.0, v106
  s_waitcnt lgkmcnt(13)
  v_mfma_f32_16x16x32_bf16 v[52:55], a[212:215], a[84:87], v[52:55]
  ds_read_b64_tr_b16 a[208:209], v230 offset:16384
  ds_read_b64_tr_b16 a[210:211], v230 offset:18432
  v_add_f32 v107, 1.0, v107
  v_mfma_f32_16x16x32_bf16 v[52:55], a[216:219], a[92:95], v[52:55]
  s_mov_b32 s40, 19136512
  v_add_f32 v108, 1.0, v108
  v_mfma_f32_16x16x32_bf16 v[36:39], a[212:215], a[80:83], v[36:39]
  buffer_load_dwordx4 a[144:147], v252, s[4:7], s40 offen offset:0 sc1
  v_mfma_f32_16x16x32_bf16 v[36:39], a[216:219], a[88:91], v[36:39]
  ds_read_b64_tr_b16 a[212:213], v230 offset:28672
  ds_read_b64_tr_b16 a[214:215], v230 offset:30720
  v_add_f32 v109, 1.0, v109
  v_mfma_f32_16x16x32_bf16 v[40:43], a[220:223], a[80:83], v[40:43]
  ds_read_b64_tr_b16 a[216:217], v231 offset:16384
  ds_read_b64_tr_b16 a[218:219], v231 offset:18432
  v_add_f32 v110, 1.0, v110
  s_waitcnt lgkmcnt(13)
  v_mfma_f32_16x16x32_bf16 v[40:43], a[224:227], a[88:91], v[40:43]
  buffer_load_dwordx4 a[148:151], v252, s[4:7], s40 offen offset:1024 sc1
  s_waitcnt vmcnt(14)
  v_add_u32 v248, 2, v245
  buffer_store_dword v248, v246, s[4:7], s90 offen sc1
  v_mfma_f32_16x16x32_bf16 v[56:59], a[220:223], a[84:87], v[56:59]
  ds_read_b64_tr_b16 a[220:221], v231 offset:28672
  ds_read_b64_tr_b16 a[222:223], v231 offset:30720
  v_add_f32 v111, 1.0, v111
  v_mfma_f32_16x16x32_bf16 v[56:59], a[224:227], a[92:95], v[56:59]
  ds_read_b64_tr_b16 a[224:225], v236 offset:8192
  ds_read_b64_tr_b16 a[226:227], v236 offset:10240
  v_mfma_f32_16x16x32_bf16 v[60:63], a[228:231], a[84:87], v[60:63]
  s_mov_b32 s40, 19267584
  v_rcp_f32 v104, v104
  v_mfma_f32_16x16x32_bf16 v[60:63], a[232:235], a[92:95], v[60:63]
  buffer_load_dwordx4 a[152:155], v252, s[4:7], s40 offen offset:0 sc1
  v_mfma_f32_16x16x32_bf16 v[44:47], a[228:231], a[80:83], v[44:47]
  ds_read_b64_tr_b16 a[228:229], v236 offset:24576
  ds_read_b64_tr_b16 a[230:231], v236 offset:26624
  v_mfma_f32_16x16x32_bf16 v[44:47], a[232:235], a[88:91], v[44:47]
  ds_read_b64_tr_b16 a[232:233], v237 offset:8192
  ds_read_b64_tr_b16 a[234:235], v237 offset:10240
  s_waitcnt lgkmcnt(13)
  v_mfma_f32_16x16x32_bf16 v[0:3], a[192:195], a[80:83], v[0:3]
  v_rcp_f32 v105, v105
  v_mfma_f32_16x16x32_bf16 v[0:3], a[196:199], a[88:91], v[0:3]
  buffer_load_dwordx4 a[156:159], v252, s[4:7], s40 offen offset:1024 sc1
  v_mfma_f32_16x16x32_bf16 v[16:19], a[192:195], a[84:87], v[16:19]
  ds_read_b64_tr_b16 a[192:193], v237 offset:24576
  ds_read_b64_tr_b16 a[194:195], v237 offset:26624
  v_mfma_f32_16x16x32_bf16 v[16:19], a[196:199], a[92:95], v[16:19]
  ds_read_b64_tr_b16 a[196:197], v238 offset:8192
  ds_read_b64_tr_b16 a[198:199], v238 offset:10240
  v_rcp_f32 v106, v106
  v_mfma_f32_16x16x32_bf16 v[20:23], a[200:203], a[84:87], v[20:23]
  s_mov_b32 s41, 3145728
  s_add_u32 m0, s42, 61440
  v_mfma_f32_16x16x32_bf16 v[20:23], a[204:207], a[92:95], v[20:23]
  buffer_load_dwordx4 v253, s[44:47], s41 offen offset:0 lds
  v_mfma_f32_16x16x32_bf16 v[4:7], a[200:203], a[80:83], v[4:7]
  ds_read_b64_tr_b16 a[200:201], v238 offset:24576
  ds_read_b64_tr_b16 a[202:203], v238 offset:26624
  v_rcp_f32 v107, v107
  v_mfma_f32_16x16x32_bf16 v[4:7], a[204:207], a[88:91], v[4:7]
  ds_read_b64_tr_b16 a[204:205], v239 offset:8192
  ds_read_b64_tr_b16 a[206:207], v239 offset:10240
  s_waitcnt lgkmcnt(13)
  v_mfma_f32_16x16x32_bf16 v[8:11], a[208:211], a[80:83], v[8:11]
  s_mov_b32 s40, 19398656
  v_rcp_f32 v108, v108
  v_mfma_f32_16x16x32_bf16 v[8:11], a[212:215], a[88:91], v[8:11]
  buffer_load_dwordx4 a[160:163], v252, s[4:7], s40 offen offset:0 sc1
  v_mfma_f32_16x16x32_bf16 v[24:27], a[208:211], a[84:87], v[24:27]
  ds_read_b64_tr_b16 a[208:209], v239 offset:24576
  ds_read_b64_tr_b16 a[210:211], v239 offset:26624
  v_mfma_f32_16x16x32_bf16 v[24:27], a[212:215], a[92:95], v[24:27]
  ds_read_b64_tr_b16 a[212:213], v228 offset:20480
  ds_read_b64_tr_b16 a[214:215], v228 offset:22528
  v_rcp_f32 v109, v109
  v_mfma_f32_16x16x32_bf16 v[28:31], a[216:219], a[84:87], v[28:31]
  v_rcp_f32 v110, v110
  v_mfma_f32_16x16x32_bf16 v[28:31], a[220:223], a[92:95], v[28:31]
  buffer_load_dwordx4 a[164:167], v252, s[4:7], s40 offen offset:1024 sc1
  v_mfma_f32_16x16x32_bf16 v[12:15], a[216:219], a[80:83], v[12:15]
  ds_read_b64_tr_b16 a[216:217], v228 offset:12288
  ds_read_b64_tr_b16 a[218:219], v228 offset:14336
  v_mfma_f32_16x16x32_bf16 v[12:15], a[220:223], a[88:91], v[12:15]
  ds_read_b64_tr_b16 a[220:221], v229 offset:20480
  ds_read_b64_tr_b16 a[222:223], v229 offset:22528
  s_waitcnt vmcnt(16) lgkmcnt(13)
  v_mfma_f32_16x16x32_bf16 v[32:35], a[224:227], a[96:99], v[32:35]
  s_mov_b32 s40, 19529728
  v_rcp_f32 v111, v111
  v_mul_f32 v104, v104, v120
  v_mfma_f32_16x16x32_bf16 v[32:35], a[228:231], a[104:107], v[32:35]
  s_barrier
  v_mfma_f32_16x16x32_bf16 v[48:51], a[224:227], a[100:103], v[48:51]
  buffer_load_dwordx4 a[168:171], v252, s[4:7], s40 offen offset:0 sc1
  v_mul_f32 v105, v105, v121
  v_mfma_f32_16x16x32_bf16 v[48:51], a[228:231], a[108:111], v[48:51]
  ds_read_b64_tr_b16 a[224:225], v229 offset:12288
  ds_read_b64_tr_b16 a[226:227], v229 offset:14336
  v_mul_f32 v106, v106, v122
  v_mfma_f32_16x16x32_bf16 v[52:55], a[232:235], a[100:103], v[52:55]
  ds_read_b64_tr_b16 a[228:229], v230 offset:20480
  ds_read_b64_tr_b16 a[230:231], v230 offset:22528
  v_mul_f32 v107, v107, v123
  v_mfma_f32_16x16x32_bf16 v[52:55], a[192:195], a[108:111], v[52:55]
  buffer_load_dwordx4 a[172:175], v252, s[4:7], s40 offen offset:1024 sc1
  v_mfma_f32_16x16x32_bf16 v[36:39], a[232:235], a[96:99], v[36:39]
  ds_read_b64_tr_b16 a[232:233], v230 offset:12288
  ds_read_b64_tr_b16 a[234:235], v230 offset:14336
  v_mul_f32 v108, v108, v124
  v_mfma_f32_16x16x32_bf16 v[36:39], a[192:195], a[104:107], v[36:39]
  ds_read_b64_tr_b16 a[192:193], v231 offset:20480
  ds_read_b64_tr_b16 a[194:195], v231 offset:22528
  v_mul_f32 v109, v109, v125
  s_waitcnt lgkmcnt(13)
  v_mfma_f32_16x16x32_bf16 v[40:43], a[196:199], a[96:99], v[40:43]
  s_mov_b32 s41, 3211264
  s_add_u32 m0, s42, 90112
  v_mul_f32 v110, v110, v126
  v_mfma_f32_16x16x32_bf16 v[40:43], a[200:203], a[104:107], v[40:43]
  buffer_load_dwordx4 v242, s[44:47], s41 offen offset:0 lds
  v_mfma_f32_16x16x32_bf16 v[56:59], a[196:199], a[100:103], v[56:59]
  ds_read_b64_tr_b16 a[196:197], v231 offset:12288
  ds_read_b64_tr_b16 a[198:199], v231 offset:14336
  v_mul_f32 v111, v111, v127
  v_mfma_f32_16x16x32_bf16 v[56:59], a[200:203], a[108:111], v[56:59]
  ds_read_b64_tr_b16 a[200:201], v228 offset:24576
  ds_read_b64_tr_b16 a[202:203], v228 offset:26624
  v_cvt_pk_bf16_f32 v104, v104, v105
  v_mfma_f32_16x16x32_bf16 v[60:63], a[204:207], a[100:103], v[60:63]
  s_mov_b32 s41, 3473408
  s_add_u32 m0, s42, 118784
  v_cvt_pk_bf16_f32 v105, v106, v107
  v_mfma_f32_16x16x32_bf16 v[60:63], a[208:211], a[108:111], v[60:63]
  buffer_load_dwordx4 v242, s[44:47], s41 offen offset:0 lds
  v_mfma_f32_16x16x32_bf16 v[44:47], a[204:207], a[96:99], v[44:47]
  ds_read_b64_tr_b16 a[204:205], v228 offset:45056
  ds_read_b64_tr_b16 a[206:207], v228 offset:47104
  v_cvt_pk_bf16_f32 v106, v108, v109
  v_mfma_f32_16x16x32_bf16 v[44:47], a[208:211], a[104:107], v[44:47]
  ds_read_b64_tr_b16 a[208:209], v229 offset:24576
  ds_read_b64_tr_b16 a[210:211], v229 offset:26624
  v_cvt_pk_bf16_f32 v107, v110, v111
  s_waitcnt lgkmcnt(13)
  v_mfma_f32_16x16x32_bf16 v[0:3], a[212:215], a[96:99], v[0:3]
  s_mov_b32 s41, 3211264
  s_add_u32 m0, s42, 131072
  v_mfma_f32_16x16x32_bf16 v[0:3], a[216:219], a[104:107], v[0:3]
  buffer_load_dwordx4 v253, s[44:47], s41 offen offset:0 lds
  v_mfma_f32_16x16x32_bf16 v[16:19], a[212:215], a[100:103], v[16:19]
  ds_read_b64_tr_b16 a[212:213], v229 offset:45056
  ds_read_b64_tr_b16 a[214:215], v229 offset:47104
  v_mfma_f32_16x16x32_bf16 v[16:19], a[216:219], a[108:111], v[16:19]
  ds_read_b64_tr_b16 a[216:217], v230 offset:24576
  ds_read_b64_tr_b16 a[218:219], v230 offset:26624
  buffer_store_dwordx4 v[104:107], v225, s[4:7], s21 offen offset:0 sc1
  v_mul_f32 v136, s43, v136
  v_mfma_f32_16x16x32_bf16 v[20:23], a[220:223], a[100:103], v[20:23]
  s_mov_b32 s41, 3473408
  s_add_u32 m0, s42, 77824
  v_mul_f32 v137, s43, v137
  v_mfma_f32_16x16x32_bf16 v[20:23], a[224:227], a[108:111], v[20:23]
L_wk1_8:
  s_cbranch_vccnz L_wk1_12
  buffer_load_dwordx4 v253, s[44:47], s41 offen offset:0 lds
  v_mfma_f32_16x16x32_bf16 v[4:7], a[220:223], a[96:99], v[4:7]
  ds_read_b64_tr_b16 a[220:221], v230 offset:45056
  ds_read_b64_tr_b16 a[222:223], v230 offset:47104
  v_mul_f32 v138, s43, v138
  v_mfma_f32_16x16x32_bf16 v[4:7], a[224:227], a[104:107], v[4:7]
  ds_read_b64_tr_b16 a[224:225], v231 offset:24576
  ds_read_b64_tr_b16 a[226:227], v231 offset:26624
  v_mul_f32 v139, s43, v139
  s_waitcnt lgkmcnt(13)
  v_mfma_f32_16x16x32_bf16 v[8:11], a[228:231], a[96:99], v[8:11]
  s_mov_b32 s40, 19660800
  v_mul_f32 v140, s43, v140
  v_mfma_f32_16x16x32_bf16 v[8:11], a[232:235], a[104:107], v[8:11]
  buffer_load_dwordx4 a[176:179], v252, s[4:7], s40 offen offset:0 sc1
  v_mfma_f32_16x16x32_bf16 v[24:27], a[228:231], a[100:103], v[24:27]
  ds_read_b64_tr_b16 a[228:229], v231 offset:45056
  ds_read_b64_tr_b16 a[230:231], v231 offset:47104
  v_mul_f32 v141, s43, v141
  v_mfma_f32_16x16x32_bf16 v[24:27], a[232:235], a[108:111], v[24:27]
  ds_read_b64_tr_b16 a[232:233], v228 offset:36864
  ds_read_b64_tr_b16 a[234:235], v228 offset:38912
  v_mul_f32 v142, s43, v142
  v_mfma_f32_16x16x32_bf16 v[28:31], a[192:195], a[100:103], v[28:31]
  v_mul_f32 v143, s43, v143
  v_mfma_f32_16x16x32_bf16 v[28:31], a[196:199], a[108:111], v[28:31]
  buffer_load_dwordx4 a[180:183], v252, s[4:7], s40 offen offset:1024 sc1
  v_mfma_f32_16x16x32_bf16 v[12:15], a[192:195], a[96:99], v[12:15]
  ds_read_b64_tr_b16 a[192:193], v228 offset:49152
  ds_read_b64_tr_b16 a[194:195], v228 offset:51200
  v_mfma_f32_16x16x32_bf16 v[12:15], a[196:199], a[104:107], v[12:15]
  ds_read_b64_tr_b16 a[196:197], v229 offset:36864
  ds_read_b64_tr_b16 a[198:199], v229 offset:38912
  s_waitcnt vmcnt(21) lgkmcnt(13)
  v_mfma_f32_16x16x32_bf16 v[32:35], a[200:203], a[112:115], v[32:35]
  s_mov_b32 s40, 19791872
  v_exp_f32 v136, v136
  v_mfma_f32_16x16x32_bf16 v[32:35], a[204:207], a[120:123], v[32:35]
  s_barrier
  v_mfma_f32_16x16x32_bf16 v[48:51], a[200:203], a[116:119], v[48:51]
  buffer_load_dwordx4 a[184:187], v252, s[4:7], s40 offen offset:0 sc1
  v_mfma_f32_16x16x32_bf16 v[48:51], a[204:207], a[124:127], v[48:51]
  ds_read_b64_tr_b16 a[200:201], v229 offset:49152
  ds_read_b64_tr_b16 a[202:203], v229 offset:51200
  v_exp_f32 v137, v137
  v_mfma_f32_16x16x32_bf16 v[52:55], a[208:211], a[116:119], v[52:55]
  ds_read_b64_tr_b16 a[204:205], v230 offset:36864
  ds_read_b64_tr_b16 a[206:207], v230 offset:38912
  v_mfma_f32_16x16x32_bf16 v[52:55], a[212:215], a[124:127], v[52:55]
  buffer_load_dwordx4 a[188:191], v252, s[4:7], s40 offen offset:1024 sc1
  v_mfma_f32_16x16x32_bf16 v[36:39], a[208:211], a[112:115], v[36:39]
  ds_read_b64_tr_b16 a[208:209], v230 offset:49152
  ds_read_b64_tr_b16 a[210:211], v230 offset:51200
  v_exp_f32 v138, v138
  v_mfma_f32_16x16x32_bf16 v[36:39], a[212:215], a[120:123], v[36:39]
  ds_read_b64_tr_b16 a[212:213], v231 offset:36864
  ds_read_b64_tr_b16 a[214:215], v231 offset:38912
  s_waitcnt lgkmcnt(13)
  v_mfma_f32_16x16x32_bf16 v[40:43], a[216:219], a[112:115], v[40:43]
  s_mov_b32 s41, 196608
  s_add_u32 m0, s42, 73728
  v_exp_f32 v139, v139
  v_mfma_f32_16x16x32_bf16 v[40:43], a[220:223], a[120:123], v[40:43]
  buffer_load_dwordx4 v242, s[44:47], s41 offen offset:0 lds
  v_mfma_f32_16x16x32_bf16 v[56:59], a[216:219], a[116:119], v[56:59]
  ds_read_b64_tr_b16 a[216:217], v231 offset:49152
  ds_read_b64_tr_b16 a[218:219], v231 offset:51200
  v_mfma_f32_16x16x32_bf16 v[56:59], a[220:223], a[124:127], v[56:59]
  ds_read_b64_tr_b16 a[220:221], v228 offset:32768
  ds_read_b64_tr_b16 a[222:223], v228 offset:34816
  v_exp_f32 v140, v140
  v_mfma_f32_16x16x32_bf16 v[60:63], a[224:227], a[116:119], v[60:63]
  s_mov_b32 s41, 655360
  s_add_u32 m0, s42, 86016
  v_mfma_f32_16x16x32_bf16 v[60:63], a[228:231], a[124:127], v[60:63]
  buffer_load_dwordx4 v242, s[44:47], s41 offen offset:0 lds
  v_mfma_f32_16x16x32_bf16 v[44:47], a[224:227], a[112:115], v[44:47]
  ds_read_b64_tr_b16 a[224:225], v228 offset:40960
  ds_read_b64_tr_b16 a[226:227], v228 offset:43008
  v_exp_f32 v141, v141
  v_mfma_f32_16x16x32_bf16 v[44:47], a[228:231], a[120:123], v[44:47]
  ds_read_b64_tr_b16 a[228:229], v229 offset:32768
  ds_read_b64_tr_b16 a[230:231], v229 offset:34816
  s_waitcnt lgkmcnt(13)
  v_mfma_f32_16x16x32_bf16 v[0:3], a[232:235], a[112:115], v[0:3]
  s_mov_b32 s41, 196608
  s_add_u32 m0, s42, 102400
  v_exp_f32 v142, v142
  v_mfma_f32_16x16x32_bf16 v[0:3], a[192:195], a[120:123], v[0:3]
  buffer_load_dwordx4 v253, s[44:47], s41 offen offset:0 lds
  v_mfma_f32_16x16x32_bf16 v[16:19], a[232:235], a[116:119], v[16:19]
  ds_read_b64_tr_b16 a[232:233], v229 offset:40960
  ds_read_b64_tr_b16 a[234:235], v229 offset:43008
  v_mfma_f32_16x16x32_bf16 v[16:19], a[192:195], a[124:127], v[16:19]
  ds_read_b64_tr_b16 a[192:193], v230 offset:32768
  ds_read_b64_tr_b16 a[194:195], v230 offset:34816
  v_exp_f32 v143, v143
  v_add_f32 v136, 1.0, v136
  v_mfma_f32_16x16x32_bf16 v[20:23], a[196:199], a[116:119], v[20:23]
  s_mov_b32 s41, 655360
  s_add_u32 m0, s42, 98304
  v_add_f32 v137, 1.0, v137
  v_mfma_f32_16x16x32_bf16 v[20:23], a[200:203], a[124:127], v[20:23]
  buffer_load_dwordx4 v253, s[44:47], s41 offen offset:0 lds
  v_mfma_f32_16x16x32_bf16 v[4:7], a[196:199], a[112:115], v[4:7]
  ds_read_b64_tr_b16 a[196:197], v230 offset:40960
  ds_read_b64_tr_b16 a[198:199], v230 offset:43008
  v_add_f32 v138, 1.0, v138
  v_mfma_f32_16x16x32_bf16 v[4:7], a[200:203], a[120:123], v[4:7]
  ds_read_b64_tr_b16 a[200:201], v231 offset:32768
  ds_read_b64_tr_b16 a[202:203], v231 offset:34816
  v_add_f32 v139, 1.0, v139
  s_waitcnt lgkmcnt(13)
  v_mfma_f32_16x16x32_bf16 v[8:11], a[204:207], a[112:115], v[8:11]
  s_mov_b32 s41, 1114112
  s_add_u32 m0, s42, 110592
  v_add_f32 v140, 1.0, v140
  v_mfma_f32_16x16x32_bf16 v[8:11], a[208:211], a[120:123], v[8:11]
  buffer_load_dwordx4 v242, s[44:47], s41 offen offset:0 lds
  v_mfma_f32_16x16x32_bf16 v[24:27], a[204:207], a[116:119], v[24:27]
  ds_read_b64_tr_b16 a[204:205], v231 offset:40960
  ds_read_b64_tr_b16 a[206:207], v231 offset:43008
  v_add_f32 v141, 1.0, v141
  v_mfma_f32_16x16x32_bf16 v[24:27], a[208:211], a[124:127], v[24:27]
  ds_read_b64_tr_b16 a[208:209], v228 offset:53248
  ds_read_b64_tr_b16 a[210:211], v228 offset:55296
  v_add_f32 v142, 1.0, v142
  v_mfma_f32_16x16x32_bf16 v[28:31], a[212:215], a[116:119], v[28:31]
  s_mov_b32 s41, 1572864
  s_add_u32 m0, s42, 126976
  v_add_f32 v143, 1.0, v143
  v_mfma_f32_16x16x32_bf16 v[28:31], a[216:219], a[124:127], v[28:31]
  buffer_load_dwordx4 v242, s[44:47], s41 offen offset:0 lds
  v_mfma_f32_16x16x32_bf16 v[12:15], a[212:215], a[112:115], v[12:15]
  ds_read_b64_tr_b16 a[212:213], v228 offset:57344
  ds_read_b64_tr_b16 a[214:215], v228 offset:59392
  v_mfma_f32_16x16x32_bf16 v[12:15], a[216:219], a[120:123], v[12:15]
  ds_read_b64_tr_b16 a[216:217], v229 offset:53248
  ds_read_b64_tr_b16 a[218:219], v229 offset:55296
  s_waitcnt vmcnt(25) lgkmcnt(13)
  v_mfma_f32_16x16x32_bf16 v[32:35], a[220:223], a[128:131], v[32:35]
  s_mov_b32 s41, 1114112
  s_add_u32 m0, s42, 122880
  v_rcp_f32 v136, v136
  v_mfma_f32_16x16x32_bf16 v[32:35], a[224:227], a[136:139], v[32:35]
  s_barrier
  v_mfma_f32_16x16x32_bf16 v[48:51], a[220:223], a[132:135], v[48:51]
  buffer_load_dwordx4 v253, s[44:47], s41 offen offset:0 lds
  v_mfma_f32_16x16x32_bf16 v[48:51], a[224:227], a[140:143], v[48:51]
  ds_read_b64_tr_b16 a[220:221], v229 offset:57344
  ds_read_b64_tr_b16 a[222:223], v229 offset:59392
  v_rcp_f32 v137, v137
  v_mfma_f32_16x16x32_bf16 v[52:55], a[228:231], a[132:135], v[52:55]
  ds_read_b64_tr_b16 a[224:225], v230 offset:53248
  ds_read_b64_tr_b16 a[226:227], v230 offset:55296
  v_mfma_f32_16x16x32_bf16 v[52:55], a[232:235], a[140:143], v[52:55]
  s_mov_b32 s41, 1572864
  s_add_u32 m0, s42, 135168
  v_mfma_f32_16x16x32_bf16 v[36:39], a[228:231], a[128:131], v[36:39]
  buffer_load_dwordx4 v253, s[44:47], s41 offen offset:0 lds
  v_rcp_f32 v138, v138
  v_mfma_f32_16x16x32_bf16 v[36:39], a[232:235], a[136:139], v[36:39]
  ds_read_b64_tr_b16 a[228:229], v230 offset:57344
  ds_read_b64_tr_b16 a[230:231], v230 offset:59392
  s_waitcnt lgkmcnt(13)
  v_mfma_f32_16x16x32_bf16 v[40:43], a[192:195], a[128:131], v[40:43]
  ds_read_b64_tr_b16 a[232:233], v231 offset:53248
  ds_read_b64_tr_b16 a[234:235], v231 offset:55296
  v_rcp_f32 v139, v139
  v_mfma_f32_16x16x32_bf16 v[40:43], a[196:199], a[136:139], v[40:43]
  s_mov_b32 s41, 2031616
  s_add_u32 m0, s42, 151552
  v_mfma_f32_16x16x32_bf16 v[56:59], a[192:195], a[132:135], v[56:59]
  buffer_load_dwordx4 v242, s[44:47], s41 offen offset:0 lds
  v_mfma_f32_16x16x32_bf16 v[56:59], a[196:199], a[140:143], v[56:59]
  ds_read_b64_tr_b16 a[192:193], v231 offset:57344
  ds_read_b64_tr_b16 a[194:195], v231 offset:59392
  v_rcp_f32 v140, v140
  v_mfma_f32_16x16x32_bf16 v[60:63], a[200:203], a[132:135], v[60:63]
  ds_read_b64_tr_b16 a[196:197], v232 offset:0
  ds_read_b64_tr_b16 a[198:199], v232 offset:2048
  s_waitcnt lgkmcnt(13)
  v_mfma_f32_16x16x32_bf16 v[60:63], a[204:207], a[140:143], v[60:63]
  s_mov_b32 s41, 2490368
  s_add_u32 m0, s42, 147456
  v_mfma_f32_16x16x32_bf16 v[44:47], a[200:203], a[128:131], v[44:47]
  buffer_load_dwordx4 v242, s[44:47], s41 offen offset:0 lds
  v_rcp_f32 v141, v141
  v_mfma_f32_16x16x32_bf16 v[44:47], a[204:207], a[136:139], v[44:47]
  ds_read_b64_tr_b16 a[200:201], v232 offset:28672
  ds_read_b64_tr_b16 a[202:203], v232 offset:30720
  v_mfma_f32_16x16x32_bf16 v[0:3], a[208:211], a[128:131], v[0:3]
  ds_read_b64_tr_b16 a[204:205], v233 offset:0
  ds_read_b64_tr_b16 a[206:207], v233 offset:2048
  v_rcp_f32 v142, v142
  v_mfma_f32_16x16x32_bf16 v[0:3], a[212:215], a[136:139], v[0:3]
  s_mov_b32 s41, 2031616
  s_add_u32 m0, s42, 159744
  v_mfma_f32_16x16x32_bf16 v[16:19], a[208:211], a[132:135], v[16:19]
  buffer_load_dwordx4 v253, s[44:47], s41 offen offset:0 lds
  v_mfma_f32_16x16x32_bf16 v[16:19], a[212:215], a[140:143], v[16:19]
  ds_read_b64_tr_b16 a[208:209], v233 offset:28672
  ds_read_b64_tr_b16 a[210:211], v233 offset:30720
  v_rcp_f32 v143, v143
  v_mul_f32 v136, v136, v152
  s_waitcnt lgkmcnt(13)
  v_mfma_f32_16x16x32_bf16 v[20:23], a[216:219], a[132:135], v[20:23]
  ds_read_b64_tr_b16 a[212:213], v234 offset:0
  ds_read_b64_tr_b16 a[214:215], v234 offset:2048
  v_mul_f32 v137, v137, v153
  v_mfma_f32_16x16x32_bf16 v[20:23], a[220:223], a[140:143], v[20:23]
  s_mov_b32 s41, 2490368
  s_add_u32 m0, s42, 16384
  v_mfma_f32_16x16x32_bf16 v[4:7], a[216:219], a[128:131], v[4:7]
  buffer_load_dwordx4 v253, s[44:47], s41 offen offset:0 lds
  v_mul_f32 v138, v138, v154
  v_mfma_f32_16x16x32_bf16 v[4:7], a[220:223], a[136:139], v[4:7]
  ds_read_b64_tr_b16 a[216:217], v234 offset:28672
  ds_read_b64_tr_b16 a[218:219], v234 offset:30720
  buffer_load_dword v244, v243, s[4:7], s91 offen sc1
  v_mul_f32 v139, v139, v155
  v_mfma_f32_16x16x32_bf16 v[8:11], a[224:227], a[128:131], v[8:11]
  ds_read_b64_tr_b16 a[220:221], v235 offset:0
  ds_read_b64_tr_b16 a[222:223], v235 offset:2048
  v_mul_f32 v140, v140, v156
  s_waitcnt lgkmcnt(13)
  v_mfma_f32_16x16x32_bf16 v[8:11], a[228:231], a[136:139], v[8:11]
  s_mov_b32 s41, 2949120
  s_add_u32 m0, s42, 28672
  v_mfma_f32_16x16x32_bf16 v[24:27], a[224:227], a[132:135], v[24:27]
  buffer_load_dwordx4 v242, s[44:47], s41 offen offset:0 lds
  v_mul_f32 v141, v141, v157
  v_mfma_f32_16x16x32_bf16 v[24:27], a[228:231], a[140:143], v[24:27]
  ds_read_b64_tr_b16 a[224:225], v235 offset:28672
  ds_read_b64_tr_b16 a[226:227], v235 offset:30720
  v_mul_f32 v142, v142, v158
  v_mfma_f32_16x16x32_bf16 v[28:31], a[232:235], a[132:135], v[28:31]
  ds_read_b64_tr_b16 a[228:229], v232 offset:40960
  ds_read_b64_tr_b16 a[230:231], v232 offset:43008
  v_mul_f32 v143, v143, v159
  v_mfma_f32_16x16x32_bf16 v[28:31], a[192:195], a[140:143], v[28:31]
  s_mov_b32 s41, 3407872
  s_add_u32 m0, s42, 139264
  v_mfma_f32_16x16x32_bf16 v[12:15], a[232:235], a[128:131], v[12:15]
  buffer_load_dwordx4 v242, s[44:47], s41 offen offset:0 lds
  v_cvt_pk_bf16_f32 v136, v136, v137
  v_mfma_f32_16x16x32_bf16 v[12:15], a[192:195], a[136:139], v[12:15]
  ds_read_b64_tr_b16 a[232:233], v232 offset:49152
  ds_read_b64_tr_b16 a[234:235], v232 offset:51200
  v_cvt_pk_bf16_f32 v137, v138, v139
  s_waitcnt vmcnt(29) lgkmcnt(13)
  v_mfma_f32_16x16x32_bf16 v[32:35], a[196:199], a[144:147], v[32:35]
  ds_read_b64_tr_b16 a[192:193], v233 offset:40960
  ds_read_b64_tr_b16 a[194:195], v233 offset:43008
  v_cvt_pk_bf16_f32 v138, v140, v141
  v_mfma_f32_16x16x32_bf16 v[32:35], a[200:203], a[152:155], v[32:35]
  s_waitcnt vmcnt(28)
  s_barrier
  v_mfma_f32_16x16x32_bf16 v[48:51], a[196:199], a[148:151], v[48:51]
  ds_read_b64_tr_b16 a[196:197], v233 offset:49152
  ds_read_b64_tr_b16 a[198:199], v233 offset:51200
  v_cvt_pk_bf16_f32 v139, v142, v143
  v_mfma_f32_16x16x32_bf16 v[48:51], a[200:203], a[156:159], v[48:51]
  ds_read_b64_tr_b16 a[200:201], v234 offset:40960
  ds_read_b64_tr_b16 a[202:203], v234 offset:43008
  v_mfma_f32_16x16x32_bf16 v[52:55], a[204:207], a[148:151], v[52:55]
  s_mov_b32 s41, 2949120
  s_add_u32 m0, s42, 155648
  s_waitcnt lgkmcnt(13)
  v_mfma_f32_16x16x32_bf16 v[52:55], a[208:211], a[156:159], v[52:55]
  buffer_load_dwordx4 v253, s[44:47], s41 offen offset:0 lds
  v_mfma_f32_16x16x32_bf16 v[36:39], a[204:207], a[144:147], v[36:39]
  ds_read_b64_tr_b16 a[204:205], v234 offset:49152
  ds_read_b64_tr_b16 a[206:207], v234 offset:51200
  buffer_store_dwordx4 v[136:139], v225, s[4:7], s21 offen offset:1024 sc1
  v_mul_f32 v168, s43, v168
  v_mfma_f32_16x16x32_bf16 v[36:39], a[208:211], a[152:155], v[36:39]
  ds_read_b64_tr_b16 a[208:209], v235 offset:40960
  ds_read_b64_tr_b16 a[210:211], v235 offset:43008
  v_mul_f32 v169, s43, v169
  v_mfma_f32_16x16x32_bf16 v[40:43], a[212:215], a[144:147], v[40:43]
  s_mov_b32 s41, 3407872
  s_add_u32 m0, s42, 20480
  v_mul_f32 v170, s43, v170
  v_mfma_f32_16x16x32_bf16 v[40:43], a[216:219], a[152:155], v[40:43]
  buffer_load_dwordx4 v253, s[44:47], s41 offen offset:0 lds
  v_mfma_f32_16x16x32_bf16 v[56:59], a[212:215], a[148:151], v[56:59]
  ds_read_b64_tr_b16 a[212:213], v235 offset:49152
  ds_read_b64_tr_b16 a[214:215], v235 offset:51200
  v_mul_f32 v171, s43, v171
  v_mfma_f32_16x16x32_bf16 v[56:59], a[216:219], a[156:159], v[56:59]
  ds_read_b64_tr_b16 a[216:217], v236 offset:12288
  ds_read_b64_tr_b16 a[218:219], v236 offset:14336
  v_mul_f32 v172, s43, v172
  s_waitcnt lgkmcnt(13)
  v_mfma_f32_16x16x32_bf16 v[60:63], a[220:223], a[148:151], v[60:63]
  s_mov_b32 s41, 0
  s_add_u32 m0, s42, 12288
  v_mul_f32 v173, s43, v173
  v_mfma_f32_16x16x32_bf16 v[60:63], a[224:227], a[156:159], v[60:63]
  buffer_load_dwordx4 v242, s[44:47], s41 offen offset:0 lds
  v_mfma_f32_16x16x32_bf16 v[44:47], a[220:223], a[144:147], v[44:47]
  ds_read_b64_tr_b16 a[220:221], v232 offset:4096
  ds_read_b64_tr_b16 a[222:223], v232 offset:6144
  v_mul_f32 v174, s43, v174
  v_mfma_f32_16x16x32_bf16 v[44:47], a[224:227], a[152:155], v[44:47]
  ds_read_b64_tr_b16 a[224:225], v237 offset:12288
  ds_read_b64_tr_b16 a[226:227], v237 offset:14336
  v_mul_f32 v175, s43, v175
  v_mfma_f32_16x16x32_bf16 v[0:3], a[228:231], a[144:147], v[0:3]
  s_mov_b32 s41, 262144
  s_add_u32 m0, s42, 24576
  v_mfma_f32_16x16x32_bf16 v[0:3], a[232:235], a[152:155], v[0:3]
  buffer_load_dwordx4 v242, s[44:47], s41 offen offset:0 lds
  v_mfma_f32_16x16x32_bf16 v[16:19], a[228:231], a[148:151], v[16:19]
  ds_read_b64_tr_b16 a[228:229], v233 offset:4096
  ds_read_b64_tr_b16 a[230:231], v233 offset:6144
  v_mfma_f32_16x16x32_bf16 v[16:19], a[232:235], a[156:159], v[16:19]
  ds_read_b64_tr_b16 a[232:233], v238 offset:12288
  ds_read_b64_tr_b16 a[234:235], v238 offset:14336
  v_exp_f32 v168, v168
  s_waitcnt lgkmcnt(13)
  v_mfma_f32_16x16x32_bf16 v[20:23], a[192:195], a[148:151], v[20:23]
  s_mov_b32 s41, 0
  s_add_u32 m0, s42, 45056
  v_mfma_f32_16x16x32_bf16 v[20:23], a[196:199], a[156:159], v[20:23]
  buffer_load_dwordx4 v253, s[44:47], s41 offen offset:0 lds
  v_mfma_f32_16x16x32_bf16 v[4:7], a[192:195], a[144:147], v[4:7]
  ds_read_b64_tr_b16 a[192:193], v234 offset:4096
  ds_read_b64_tr_b16 a[194:195], v234 offset:6144
  v_exp_f32 v169, v169
  v_mfma_f32_16x16x32_bf16 v[4:7], a[196:199], a[152:155], v[4:7]
  ds_read_b64_tr_b16 a[196:197], v239 offset:12288
  ds_read_b64_tr_b16 a[198:199], v239 offset:14336
  v_mfma_f32_16x16x32_bf16 v[8:11], a[200:203], a[144:147], v[8:11]
  s_mov_b32 s41, 262144
  s_add_u32 m0, s42, 36864
  v_exp_f32 v170, v170
  v_mfma_f32_16x16x32_bf16 v[8:11], a[204:207], a[152:155], v[8:11]
  buffer_load_dwordx4 v253, s[44:47], s41 offen offset:0 lds
  v_mfma_f32_16x16x32_bf16 v[24:27], a[200:203], a[148:151], v[24:27]
  ds_read_b64_tr_b16 a[200:201], v235 offset:4096
  ds_read_b64_tr_b16 a[202:203], v235 offset:6144
  v_mfma_f32_16x16x32_bf16 v[24:27], a[204:207], a[156:159], v[24:27]
  ds_read_b64_tr_b16 a[204:205], v232 offset:16384
  ds_read_b64_tr_b16 a[206:207], v232 offset:18432
  v_exp_f32 v171, v171
  s_waitcnt lgkmcnt(13)
  v_mfma_f32_16x16x32_bf16 v[28:31], a[208:211], a[148:151], v[28:31]
  s_mov_b32 s41, 524288
  s_add_u32 m0, s42, 49152
  v_mfma_f32_16x16x32_bf16 v[28:31], a[212:215], a[156:159], v[28:31]
  buffer_load_dwordx4 v242, s[44:47], s41 offen offset:0 lds
  v_mfma_f32_16x16x32_bf16 v[12:15], a[208:211], a[144:147], v[12:15]
  ds_read_b64_tr_b16 a[208:209], v228 offset:61440
  ds_read_b64_tr_b16 a[210:211], v228 offset:63488
  v_exp_f32 v172, v172
  v_mfma_f32_16x16x32_bf16 v[12:15], a[212:215], a[152:155], v[12:15]
  ds_read_b64_tr_b16 a[212:213], v233 offset:16384
  ds_read_b64_tr_b16 a[214:215], v233 offset:18432
  s_waitcnt vmcnt(10)
  v_subrev_u32 v244, s100, v244
  v_mfma_f32_16x16x32_bf16 v[32:35], a[216:219], a[160:163], v[32:35]
  s_mov_b32 s41, 786432
  s_add_u32 m0, s42, 32768
  v_subrev_u32 v244, 1, v244
  v_cmp_lt_u32 s[68:69], 6, v244
  v_exp_f32 v173, v173
  v_mfma_f32_16x16x32_bf16 v[32:35], a[220:223], a[168:171], v[32:35]
  s_barrier
  s_cmp_lg_u64 s[68:69], 0
  s_cbranch_scc1 L_slow_33
L_back_34:
  v_mfma_f32_16x16x32_bf16 v[48:51], a[216:219], a[164:167], v[48:51]
  buffer_load_dwordx4 v242, s[44:47], s41 offen offset:0 lds
  v_mfma_f32_16x16x32_bf16 v[48:51], a[220:223], a[172:175], v[48:51]
  ds_read_b64_tr_b16 a[216:217], v229 offset:61440
  ds_read_b64_tr_b16 a[218:219], v229 offset:63488
  v_exp_f32 v174, v174
  s_waitcnt lgkmcnt(13)
  v_mfma_f32_16x16x32_bf16 v[52:55], a[224:227], a[164:167], v[52:55]
  ds_read_b64_tr_b16 a[220:221], v234 offset:16384
  ds_read_b64_tr_b16 a[222:223], v234 offset:18432
  v_mfma_f32_16x16x32_bf16 v[52:55], a[228:231], a[172:175], v[52:55]
  s_mov_b32 s40, 19922944
  v_exp_f32 v175, v175
  v_mfma_f32_16x16x32_bf16 v[36:39], a[224:227], a[160:163], v[36:39]
  buffer_load_dwordx4 v[96:99], v252, s[4:7], s40 offen offset:0 sc1
  v_add_f32 v168, 1.0, v168
  v_mfma_f32_16x16x32_bf16 v[36:39], a[228:231], a[168:171], v[36:39]
  ds_read_b64_tr_b16 a[224:225], v230 offset:61440
  ds_read_b64_tr_b16 a[226:227], v230 offset:63488
  v_add_f32 v169, 1.0, v169
  v_mfma_f32_16x16x32_bf16 v[40:43], a[232:235], a[160:163], v[40:43]
  ds_read_b64_tr_b16 a[228:229], v235 offset:16384
  ds_read_b64_tr_b16 a[230:231], v235 offset:18432
  v_add_f32 v170, 1.0, v170
  s_waitcnt lgkmcnt(13)
  v_mfma_f32_16x16x32_bf16 v[40:43], a[192:195], a[168:171], v[40:43]
  buffer_load_dwordx4 v[100:103], v252, s[4:7], s40 offen offset:1024 sc1
  v_mfma_f32_16x16x32_bf16 v[56:59], a[232:235], a[164:167], v[56:59]
  ds_read_b64_tr_b16 a[232:233], v231 offset:61440
  ds_read_b64_tr_b16 a[234:235], v231 offset:63488
  v_add_f32 v171, 1.0, v171
  v_mfma_f32_16x16x32_bf16 v[56:59], a[192:195], a[172:175], v[56:59]
  ds_read_b64_tr_b16 a[192:193], v232 offset:24576
  ds_read_b64_tr_b16 a[194:195], v232 offset:26624
  v_add_f32 v172, 1.0, v172
  v_mfma_f32_16x16x32_bf16 v[60:63], a[196:199], a[164:167], v[60:63]
  s_mov_b32 s40, 20054016
  v_add_f32 v173, 1.0, v173
  v_mfma_f32_16x16x32_bf16 v[60:63], a[200:203], a[172:175], v[60:63]
  buffer_load_dwordx4 v[112:115], v252, s[4:7], s40 offen offset:0 sc1
  v_mfma_f32_16x16x32_bf16 v[44:47], a[196:199], a[160:163], v[44:47]
  ds_read_b64_tr_b16 a[196:197], v232 offset:53248
  ds_read_b64_tr_b16 a[198:199], v232 offset:55296
  v_add_f32 v174, 1.0, v174
  v_mfma_f32_16x16x32_bf16 v[44:47], a[200:203], a[168:171], v[44:47]
  ds_read_b64_tr_b16 a[200:201], v233 offset:24576
  ds_read_b64_tr_b16 a[202:203], v233 offset:26624
  v_add_f32 v175, 1.0, v175
  s_waitcnt lgkmcnt(13)
  v_mfma_f32_16x16x32_bf16 v[0:3], a[204:207], a[160:163], v[0:3]
  v_rcp_f32 v168, v168
  v_mfma_f32_16x16x32_bf16 v[0:3], a[208:211], a[168:171], v[0:3]
  buffer_load_dwordx4 v[116:119], v252, s[4:7], s40 offen offset:1024 sc1
  v_mfma_f32_16x16x32_bf16 v[16:19], a[204:207], a[164:167], v[16:19]
  ds_read_b64_tr_b16 a[204:205], v233 offset:53248
  ds_read_b64_tr_b16 a[206:207], v233 offset:55296
  v_mfma_f32_16x16x32_bf16 v[16:19], a[208:211], a[172:175], v[16:19]
  ds_read_b64_tr_b16 a[208:209], v234 offset:24576
  ds_read_b64_tr_b16 a[210:211], v234 offset:26624
  v_mfma_f32_16x16x32_bf16 v[20:23], a[212:215], a[164:167], v[20:23]
  s_mov_b32 s40, 20185088
  v_rcp_f32 v169, v169
  v_mfma_f32_16x16x32_bf16 v[20:23], a[216:219], a[172:175], v[20:23]
  buffer_load_dwordx4 v[128:131], v252, s[4:7], s40 offen offset:0 sc1
  v_mfma_f32_16x16x32_bf16 v[4:7], a[212:215], a[160:163], v[4:7]
  ds_read_b64_tr_b16 a[212:213], v234 offset:53248
  ds_read_b64_tr_b16 a[214:215], v234 offset:55296
  v_mfma_f32_16x16x32_bf16 v[4:7], a[216:219], a[168:171], v[4:7]
  ds_read_b64_tr_b16 a[216:217], v235 offset:24576
  ds_read_b64_tr_b16 a[218:219], v235 offset:26624
  s_waitcnt lgkmcnt(13)
  v_mfma_f32_16x16x32_bf16 v[8:11], a[220:223], a[160:163], v[8:11]
  v_rcp_f32 v170, v170
  v_mfma_f32_16x16x32_bf16 v[8:11], a[224:227], a[168:171], v[8:11]
  buffer_load_dwordx4 v[132:135], v252, s[4:7], s40 offen offset:1024 sc1
  v_mfma_f32_16x16x32_bf16 v[24:27], a[220:223], a[164:167], v[24:27]
  ds_read_b64_tr_b16 a[220:221], v235 offset:53248
  ds_read_b64_tr_b16 a[222:223], v235 offset:55296
  v_mfma_f32_16x16x32_bf16 v[24:27], a[224:227], a[172:175], v[24:27]
  ds_read_b64_tr_b16 a[224:225], v236 offset:0
  ds_read_b64_tr_b16 a[226:227], v236 offset:2048
  v_rcp_f32 v171, v171
  v_mfma_f32_16x16x32_bf16 v[28:31], a[228:231], a[164:167], v[28:31]
  s_mov_b32 s40, 20316160
  v_rcp_f32 v172, v172
  v_mfma_f32_16x16x32_bf16 v[28:31], a[232:235], a[172:175], v[28:31]
  buffer_load_dwordx4 v[144:147], v252, s[4:7], s40 offen offset:0 sc1
  v_mfma_f32_16x16x32_bf16 v[12:15], a[228:231], a[160:163], v[12:15]
  ds_read_b64_tr_b16 a[228:229], v232 offset:12288
  ds_read_b64_tr_b16 a[230:231], v232 offset:14336
  v_mfma_f32_16x16x32_bf16 v[12:15], a[232:235], a[168:171], v[12:15]
  ds_read_b64_tr_b16 a[232:233], v237 offset:0
  ds_read_b64_tr_b16 a[234:235], v237 offset:2048
  s_waitcnt lgkmcnt(13)
  v_mfma_f32_16x16x32_bf16 v[32:35], a[192:195], a[176:179], v[32:35]
  v_rcp_f32 v173, v173
  v_mfma_f32_16x16x32_bf16 v[32:35], a[196:199], a[184:187], v[32:35]
  s_barrier
  v_mfma_f32_16x16x32_bf16 v[48:51], a[192:195], a[180:183], v[48:51]
  buffer_load_dwordx4 v[148:151], v252, s[4:7], s40 offen offset:1024 sc1
  v_mfma_f32_16x16x32_bf16 v[48:51], a[196:199], a[188:191], v[48:51]
  ds_read_b64_tr_b16 a[192:193], v233 offset:12288
  ds_read_b64_tr_b16 a[194:195], v233 offset:14336
  v_rcp_f32 v174, v174
  v_mfma_f32_16x16x32_bf16 v[52:55], a[200:203], a[180:183], v[52:55]
  ds_read_b64_tr_b16 a[196:197], v238 offset:0
  ds_read_b64_tr_b16 a[198:199], v238 offset:2048
  v_mfma_f32_16x16x32_bf16 v[52:55], a[204:207], a[188:191], v[52:55]
  s_mov_b32 s40, 20447232
  v_rcp_f32 v175, v175
  v_mfma_f32_16x16x32_bf16 v[36:39], a[200:203], a[176:179], v[36:39]
  buffer_load_dwordx4 v[160:163], v252, s[4:7], s40 offen offset:0 sc1
  v_mul_f32 v168, v168, v184
  v_mfma_f32_16x16x32_bf16 v[36:39], a[204:207], a[184:187], v[36:39]
  ds_read_b64_tr_b16 a[200:201], v234 offset:12288
  ds_read_b64_tr_b16 a[202:203], v234 offset:14336
  v_mul_f32 v169, v169, v185
  s_waitcnt lgkmcnt(13)
  v_mfma_f32_16x16x32_bf16 v[40:43], a[208:211], a[176:179], v[40:43]
  ds_read_b64_tr_b16 a[204:205], v239 offset:0
  ds_read_b64_tr_b16 a[206:207], v239 offset:2048
  v_mul_f32 v170, v170, v186
  v_mfma_f32_16x16x32_bf16 v[40:43], a[212:215], a[184:187], v[40:43]
  buffer_load_dwordx4 v[164:167], v252, s[4:7], s40 offen offset:1024 sc1
  v_mfma_f32_16x16x32_bf16 v[56:59], a[208:211], a[180:183], v[56:59]
  ds_read_b64_tr_b16 a[208:209], v235 offset:12288
  ds_read_b64_tr_b16 a[210:211], v235 offset:14336
  v_mul_f32 v171, v171, v187
  v_mfma_f32_16x16x32_bf16 v[56:59], a[212:215], a[188:191], v[56:59]
  ds_read_b64_tr_b16 a[212:213], v232 offset:8192
  ds_read_b64_tr_b16 a[214:215], v232 offset:10240
  v_mul_f32 v172, v172, v188
  v_mfma_f32_16x16x32_bf16 v[60:63], a[216:219], a[180:183], v[60:63]
  s_mov_b32 s40, 20578304
  v_mul_f32 v173, v173, v189
  s_waitcnt lgkmcnt(13)
  v_mfma_f32_16x16x32_bf16 v[60:63], a[220:223], a[188:191], v[60:63]
  buffer_load_dwordx4 v[176:179], v252, s[4:7], s40 offen offset:0 sc1
  v_mfma_f32_16x16x32_bf16 v[44:47], a[216:219], a[176:179], v[44:47]
  ds_read_b64_tr_b16 a[216:217], v232 offset:20480
  ds_read_b64_tr_b16 a[218:219], v232 offset:22528
  v_mul_f32 v174, v174, v190
  v_mfma_f32_16x16x32_bf16 v[44:47], a[220:223], a[184:187], v[44:47]
  ds_read_b64_tr_b16 a[220:221], v233 offset:8192
  ds_read_b64_tr_b16 a[222:223], v233 offset:10240
  v_mul_f32 v175, v175, v191
  v_mfma_f32_16x16x32_bf16 v[0:3], a[224:227], a[176:179], v[0:3]
  v_cvt_pk_bf16_f32 v168, v168, v169
  v_cvt_pk_bf16_f32 v169, v170, v171
  v_mfma_f32_16x16x32_bf16 v[0:3], a[228:231], a[184:187], v[0:3]
  buffer_load_dwordx4 v[180:183], v252, s[4:7], s40 offen offset:1024 sc1
  v_mfma_f32_16x16x32_bf16 v[16:19], a[224:227], a[180:183], v[16:19]
  ds_read_b64_tr_b16 a[224:225], v233 offset:20480
  ds_read_b64_tr_b16 a[226:227], v233 offset:22528
  v_mfma_f32_16x16x32_bf16 v[16:19], a[228:231], a[188:191], v[16:19]
  ds_read_b64_tr_b16 a[228:229], v234 offset:8192
  ds_read_b64_tr_b16 a[230:231], v234 offset:10240
  v_cvt_pk_bf16_f32 v170, v172, v173
  s_waitcnt lgkmcnt(13)
  v_mfma_f32_16x16x32_bf16 v[20:23], a[232:235], a[180:183], v[20:23]
  s_mov_b32 s40, 20709376
  v_cvt_pk_bf16_f32 v171, v174, v175
  v_mfma_f32_16x16x32_bf16 v[20:23], a[192:195], a[188:191], v[20:23]
  buffer_load_dwordx4 v[192:195], v252, s[4:7], s40 offen offset:0 sc1
  v_mfma_f32_16x16x32_bf16 v[4:7], a[232:235], a[176:179], v[4:7]
  ds_read_b64_tr_b16 a[232:233], v234 offset:20480
  ds_read_b64_tr_b16 a[234:235], v234 offset:22528
  v_mfma_f32_16x16x32_bf16 v[4:7], a[192:195], a[184:187], v[4:7]
  ds_read_b64_tr_b16 a[192:193], v235 offset:8192
  ds_read_b64_tr_b16 a[194:195], v235 offset:10240
  v_mfma_f32_16x16x32_bf16 v[8:11], a[196:199], a[176:179], v[8:11]
  buffer_store_dwordx4 v[168:171], v225, s[4:7], s21 offen offset:2048 sc1
  v_mul_f32 v200, s43, v200
  v_mfma_f32_16x16x32_bf16 v[8:11], a[200:203], a[184:187], v[8:11]
  v_mul_f32 v201, s43, v201
  v_mul_f32 v202, s43, v202
  v_mfma_f32_16x16x32_bf16 v[24:27], a[196:199], a[180:183], v[24:27]
  buffer_load_dwordx4 v[196:199], v252, s[4:7], s40 offen offset:1024 sc1
  v_mfma_f32_16x16x32_bf16 v[24:27], a[200:203], a[188:191], v[24:27]
  ds_read_b64_tr_b16 a[196:197], v235 offset:20480
  ds_read_b64_tr_b16 a[198:199], v235 offset:22528
  s_waitcnt lgkmcnt(13)
  v_mfma_f32_16x16x32_bf16 v[28:31], a[204:207], a[180:183], v[28:31]
  s_waitcnt vmcnt(11)
  v_swap_b32 v98, v100
  v_swap_b32 v99, v101
  v_swap_b32 v114, v116
  v_swap_b32 v115, v117
  ds_read_b64_tr_b16 a[200:201], v232 offset:36864
  ds_read_b64_tr_b16 a[202:203], v232 offset:38912
  v_mul_f32 v203, s43, v203
  v_mfma_f32_16x16x32_bf16 v[28:31], a[208:211], a[188:191], v[28:31]
  s_mov_b32 s40, 20840448
  v_mul_f32 v204, s43, v204
  v_mfma_f32_16x16x32_bf16 v[12:15], a[204:207], a[176:179], v[12:15]
  buffer_load_dwordx4 v[208:211], v252, s[4:7], s40 offen offset:0 sc1
  v_mfma_f32_16x16x32_bf16 v[12:15], a[208:211], a[184:187], v[12:15]
  ds_read_b64_tr_b16 a[204:205], v232 offset:32768
  ds_read_b64_tr_b16 a[206:207], v232 offset:34816
  v_mul_f32 v205, s43, v205
  v_mfma_f32_16x16x32_bf16 v[32:35], a[212:215], v[96:99], v[32:35]
  ds_read_b64_tr_b16 a[208:209], v233 offset:36864
  ds_read_b64_tr_b16 a[210:211], v233 offset:38912
L_wk1_9:
  s_cbranch_vccnz L_wk1_end
  v_mul_f32 v206, s43, v206
  s_waitcnt lgkmcnt(13)
  v_mfma_f32_16x16x32_bf16 v[32:35], a[216:219], v[112:115], v[32:35]
  s_barrier
  v_mfma_f32_16x16x32_bf16 v[48:51], a[212:215], v[100:103], v[48:51]
  buffer_load_dwordx4 v[212:215], v252, s[4:7], s40 offen offset:1024 sc1
  v_mul_f32 v207, s43, v207
  v_mfma_f32_16x16x32_bf16 v[48:51], a[216:219], v[116:119], v[48:51]
  ds_read_b64_tr_b16 a[212:213], v233 offset:32768
  ds_read_b64_tr_b16 a[214:215], v233 offset:34816
  v_mfma_f32_16x16x32_bf16 v[52:55], a[220:223], v[100:103], v[52:55]
  ds_read_b64_tr_b16 a[216:217], v234 offset:36864
  ds_read_b64_tr_b16 a[218:219], v234 offset:38912
  v_mfma_f32_16x16x32_bf16 v[52:55], a[224:227], v[116:119], v[52:55]
  s_mov_b32 s41, 524288
  s_add_u32 m0, s42, 40960
  v_mfma_f32_16x16x32_bf16 v[36:39], a[220:223], v[96:99], v[36:39]
  buffer_load_dwordx4 v253, s[44:47], s41 offen offset:0 lds
  v_exp_f32 v200, v200
  v_mfma_f32_16x16x32_bf16 v[36:39], a[224:227], v[112:115], v[36:39]
  ds_read_b64_tr_b16 a[220:221], v234 offset:32768
  ds_read_b64_tr_b16 a[222:223], v234 offset:34816
  s_waitcnt lgkmcnt(13)
  v_mfma_f32_16x16x32_bf16 v[40:43], a[228:231], v[96:99], v[40:43]
  ds_read_b64_tr_b16 a[224:225], v235 offset:36864
  ds_read_b64_tr_b16 a[226:227], v235 offset:38912
  v_exp_f32 v201, v201
  v_mfma_f32_16x16x32_bf16 v[40:43], a[232:235], v[112:115], v[40:43]
  s_mov_b32 s41, 786432
  s_add_u32 m0, s42, 53248
  v_mfma_f32_16x16x32_bf16 v[56:59], a[228:231], v[100:103], v[56:59]
  buffer_load_dwordx4 v253, s[44:47], s41 offen offset:0 lds
  v_mfma_f32_16x16x32_bf16 v[56:59], a[232:235], v[116:119], v[56:59]
  ds_read_b64_tr_b16 a[228:229], v235 offset:32768
  ds_read_b64_tr_b16 a[230:231], v235 offset:34816
  v_exp_f32 v202, v202
  v_mfma_f32_16x16x32_bf16 v[60:63], a[192:195], v[100:103], v[60:63]
  ds_read_b64_tr_b16 a[232:233], v232 offset:45056
  ds_read_b64_tr_b16 a[234:235], v232 offset:47104
  s_waitcnt lgkmcnt(13)
  v_mfma_f32_16x16x32_bf16 v[60:63], a[196:199], v[116:119], v[60:63]
  s_mov_b32 s41, 917504
  s_add_u32 m0, s42, 57344
  v_mfma_f32_16x16x32_bf16 v[44:47], a[192:195], v[96:99], v[44:47]
  buffer_load_dwordx4 v242, s[44:47], s41 offen offset:0 lds
  v_exp_f32 v203, v203
  v_mfma_f32_16x16x32_bf16 v[44:47], a[196:199], v[112:115], v[44:47]
  ds_read_b64_tr_b16 a[192:193], v232 offset:61440
  ds_read_b64_tr_b16 a[194:195], v232 offset:63488
  v_mfma_f32_16x16x32_bf16 v[0:3], a[200:203], v[96:99], v[0:3]
  ds_read_b64_tr_b16 a[196:197], v233 offset:45056
  ds_read_b64_tr_b16 a[198:199], v233 offset:47104
  v_exp_f32 v204, v204
  v_mfma_f32_16x16x32_bf16 v[0:3], a[204:207], v[112:115], v[0:3]
  s_mov_b32 s41, 1179648
  s_add_u32 m0, s42, 65536
  v_mfma_f32_16x16x32_bf16 v[16:19], a[200:203], v[100:103], v[16:19]
  buffer_load_dwordx4 v242, s[44:47], s41 offen offset:0 lds
  v_mfma_f32_16x16x32_bf16 v[16:19], a[204:207], v[116:119], v[16:19]
  ds_read_b64_tr_b16 a[200:201], v233 offset:61440
  ds_read_b64_tr_b16 a[202:203], v233 offset:63488
  v_exp_f32 v205, v205
  s_waitcnt lgkmcnt(13)
  v_mfma_f32_16x16x32_bf16 v[20:23], a[208:211], v[100:103], v[20:23]
  ds_read_b64_tr_b16 a[204:205], v234 offset:45056
  ds_read_b64_tr_b16 a[206:207], v234 offset:47104
  v_mfma_f32_16x16x32_bf16 v[20:23], a[212:215], v[116:119], v[20:23]
  s_mov_b32 s41, 917504
  s_add_u32 m0, s42, 94208
  v_mfma_f32_16x16x32_bf16 v[4:7], a[208:211], v[96:99], v[4:7]
  buffer_load_dwordx4 v253, s[44:47], s41 offen offset:0 lds
  v_exp_f32 v206, v206
  v_mfma_f32_16x16x32_bf16 v[4:7], a[212:215], v[112:115], v[4:7]
  ds_read_b64_tr_b16 a[208:209], v234 offset:61440
  ds_read_b64_tr_b16 a[210:211], v234 offset:63488
  buffer_load_dword v244, v243, s[4:7], s91 offen sc1
  v_mfma_f32_16x16x32_bf16 v[8:11], a[216:219], v[96:99], v[8:11]
  ds_read_b64_tr_b16 a[212:213], v235 offset:45056
  ds_read_b64_tr_b16 a[214:215], v235 offset:47104
  v_exp_f32 v207, v207
  v_add_f32 v200, 1.0, v200
  s_waitcnt lgkmcnt(13)
  v_mfma_f32_16x16x32_bf16 v[8:11], a[220:223], v[112:115], v[8:11]
  s_mov_b32 s41, 1179648
  s_add_u32 m0, s42, 106496
  v_mfma_f32_16x16x32_bf16 v[24:27], a[216:219], v[100:103], v[24:27]
  buffer_load_dwordx4 v253, s[44:47], s41 offen offset:0 lds
  v_add_f32 v201, 1.0, v201
  v_mfma_f32_16x16x32_bf16 v[24:27], a[220:223], v[116:119], v[24:27]
  ds_read_b64_tr_b16 a[216:217], v235 offset:61440
  ds_read_b64_tr_b16 a[218:219], v235 offset:63488
  v_add_f32 v202, 1.0, v202
  v_mfma_f32_16x16x32_bf16 v[28:31], a[224:227], v[100:103], v[28:31]
  s_waitcnt vmcnt(16)
  v_swap_b32 v130, v132
  v_swap_b32 v131, v133
  v_swap_b32 v146, v148
  v_swap_b32 v147, v149
  ds_read_b64_tr_b16 a[220:221], v232 offset:57344
  ds_read_b64_tr_b16 a[222:223], v232 offset:59392
  v_add_f32 v203, 1.0, v203
  v_mfma_f32_16x16x32_bf16 v[28:31], a[228:231], v[116:119], v[28:31]
  s_mov_b32 s41, 1441792
  s_add_u32 m0, s42, 114688
  v_mfma_f32_16x16x32_bf16 v[12:15], a[224:227], v[96:99], v[12:15]
  buffer_load_dwordx4 v242, s[44:47], s41 offen offset:0 lds
  v_add_f32 v204, 1.0, v204
  v_mfma_f32_16x16x32_bf16 v[12:15], a[228:231], v[112:115], v[12:15]
  ds_read_b64_tr_b16 a[224:225], v236 offset:4096
  ds_read_b64_tr_b16 a[226:227], v236 offset:6144
  v_add_f32 v205, 1.0, v205
  s_waitcnt lgkmcnt(13)
  v_mfma_f32_16x16x32_bf16 v[32:35], a[232:235], v[128:131], v[32:35]
  ds_read_b64_tr_b16 a[228:229], v233 offset:57344
  ds_read_b64_tr_b16 a[230:231], v233 offset:59392
  v_add_f32 v206, 1.0, v206
  v_mfma_f32_16x16x32_bf16 v[32:35], a[192:195], v[144:147], v[32:35]
  s_barrier
  v_mfma_f32_16x16x32_bf16 v[48:51], a[232:235], v[132:135], v[48:51]
  ds_read_b64_tr_b16 a[232:233], v237 offset:4096
  ds_read_b64_tr_b16 a[234:235], v237 offset:6144
  v_add_f32 v207, 1.0, v207
  v_mfma_f32_16x16x32_bf16 v[48:51], a[192:195], v[148:151], v[48:51]
  ds_read_b64_tr_b16 a[192:193], v234 offset:57344
  ds_read_b64_tr_b16 a[194:195], v234 offset:59392
  v_mfma_f32_16x16x32_bf16 v[52:55], a[196:199], v[132:135], v[52:55]
  s_mov_b32 s41, 1703936
  s_add_u32 m0, s42, 143360
  s_waitcnt lgkmcnt(13)
  v_mfma_f32_16x16x32_bf16 v[52:55], a[200:203], v[148:151], v[52:55]
  buffer_load_dwordx4 v242, s[44:47], s41 offen offset:0 lds
  v_mfma_f32_16x16x32_bf16 v[36:39], a[196:199], v[128:131], v[36:39]
  ds_read_b64_tr_b16 a[196:197], v238 offset:4096
  ds_read_b64_tr_b16 a[198:199], v238 offset:6144
  v_rcp_f32 v200, v200
  v_mfma_f32_16x16x32_bf16 v[36:39], a[200:203], v[144:147], v[36:39]
  ds_read_b64_tr_b16 a[200:201], v235 offset:57344
  ds_read_b64_tr_b16 a[202:203], v235 offset:59392
  v_mfma_f32_16x16x32_bf16 v[40:43], a[204:207], v[128:131], v[40:43]
  s_mov_b32 s41, 1441792
  s_add_u32 m0, s42, 69632
  v_rcp_f32 v201, v201
  v_mfma_f32_16x16x32_bf16 v[40:43], a[208:211], v[144:147], v[40:43]
  buffer_load_dwordx4 v253, s[44:47], s41 offen offset:0 lds
  v_mfma_f32_16x16x32_bf16 v[56:59], a[204:207], v[132:135], v[56:59]
  ds_read_b64_tr_b16 a[204:205], v239 offset:4096
  ds_read_b64_tr_b16 a[206:207], v239 offset:6144
  v_mfma_f32_16x16x32_bf16 v[56:59], a[208:211], v[148:151], v[56:59]
  ds_read_b64_tr_b16 a[208:209], v236 offset:20480
  ds_read_b64_tr_b16 a[210:211], v236 offset:22528
  v_rcp_f32 v202, v202
  s_waitcnt lgkmcnt(13)
  v_mfma_f32_16x16x32_bf16 v[60:63], a[212:215], v[132:135], v[60:63]
  s_mov_b32 s41, 1703936
  s_add_u32 m0, s42, 81920
  v_mfma_f32_16x16x32_bf16 v[60:63], a[216:219], v[148:151], v[60:63]
  buffer_load_dwordx4 v253, s[44:47], s41 offen offset:0 lds
  v_mfma_f32_16x16x32_bf16 v[44:47], a[212:215], v[128:131], v[44:47]
  ds_read_b64_tr_b16 a[212:213], v236 offset:16384
  ds_read_b64_tr_b16 a[214:215], v236 offset:18432
  v_rcp_f32 v203, v203
  v_mfma_f32_16x16x32_bf16 v[44:47], a[216:219], v[144:147], v[44:47]
  ds_read_b64_tr_b16 a[216:217], v237 offset:20480
  ds_read_b64_tr_b16 a[218:219], v237 offset:22528
  v_mfma_f32_16x16x32_bf16 v[0:3], a[220:223], v[128:131], v[0:3]
  s_mov_b32 s41, 1835008
  s_add_u32 m0, s42, 61440
  v_rcp_f32 v204, v204
  v_mfma_f32_16x16x32_bf16 v[0:3], a[224:227], v[144:147], v[0:3]
  buffer_load_dwordx4 v242, s[44:47], s41 offen offset:0 lds
  v_mfma_f32_16x16x32_bf16 v[16:19], a[220:223], v[132:135], v[16:19]
  ds_read_b64_tr_b16 a[220:221], v237 offset:16384
  ds_read_b64_tr_b16 a[222:223], v237 offset:18432
  v_mfma_f32_16x16x32_bf16 v[16:19], a[224:227], v[148:151], v[16:19]
  ds_read_b64_tr_b16 a[224:225], v238 offset:20480
  ds_read_b64_tr_b16 a[226:227], v238 offset:22528
  v_rcp_f32 v205, v205
  s_waitcnt lgkmcnt(13)
  v_mfma_f32_16x16x32_bf16 v[20:23], a[228:231], v[132:135], v[20:23]
  s_mov_b32 s41, 2097152
  s_add_u32 m0, s42, 90112
  v_mfma_f32_16x16x32_bf16 v[20:23], a[232:235], v[148:151], v[20:23]
  buffer_load_dwordx4 v242, s[44:47], s41 offen offset:0 lds
  v_mfma_f32_16x16x32_bf16 v[4:7], a[228:231], v[128:131], v[4:7]
  ds_read_b64_tr_b16 a[228:229], v238 offset:16384
  ds_read_b64_tr_b16 a[230:231], v238 offset:18432
  v_rcp_f32 v206, v206
  v_mfma_f32_16x16x32_bf16 v[4:7], a[232:235], v[144:147], v[4:7]
  ds_read_b64_tr_b16 a[232:233], v239 offset:20480
  ds_read_b64_tr_b16 a[234:235], v239 offset:22528
  v_mfma_f32_16x16x32_bf16 v[8:11], a[192:195], v[128:131], v[8:11]
  s_mov_b32 s41, 1835008
  s_add_u32 m0, s42, 118784
  v_rcp_f32 v207, v207
  v_mul_f32 v200, v200, v216
  v_mfma_f32_16x16x32_bf16 v[8:11], a[196:199], v[144:147], v[8:11]
  buffer_load_dwordx4 v253, s[44:47], s41 offen offset:0 lds
  v_mfma_f32_16x16x32_bf16 v[24:27], a[192:195], v[132:135], v[24:27]
  ds_read_b64_tr_b16 a[192:193], v239 offset:16384
  ds_read_b64_tr_b16 a[194:195], v239 offset:18432
  v_mul_f32 v201, v201, v217
  v_mfma_f32_16x16x32_bf16 v[24:27], a[196:199], v[148:151], v[24:27]
  ds_read_b64_tr_b16 a[196:197], v236 offset:28672
  ds_read_b64_tr_b16 a[198:199], v236 offset:30720
  v_mul_f32 v202, v202, v218
  s_waitcnt lgkmcnt(13)
  v_mfma_f32_16x16x32_bf16 v[28:31], a[200:203], v[132:135], v[28:31]
  s_waitcnt vmcnt(19)
  v_swap_b32 v162, v164
  v_swap_b32 v163, v165
  v_swap_b32 v178, v180
  v_swap_b32 v179, v181
  s_mov_b32 s41, 2097152
  s_add_u32 m0, s42, 131072
  v_mul_f32 v203, v203, v219
  v_mfma_f32_16x16x32_bf16 v[28:31], a[204:207], v[148:151], v[28:31]
  buffer_load_dwordx4 v253, s[44:47], s41 offen offset:0 lds
  v_mfma_f32_16x16x32_bf16 v[12:15], a[200:203], v[128:131], v[12:15]
  ds_read_b64_tr_b16 a[200:201], v228 offset:16384
  ds_read_b64_tr_b16 a[202:203], v228 offset:18432
  v_mul_f32 v204, v204, v220
  v_mfma_f32_16x16x32_bf16 v[12:15], a[204:207], v[144:147], v[12:15]
  ds_read_b64_tr_b16 a[204:205], v237 offset:28672
  ds_read_b64_tr_b16 a[206:207], v237 offset:30720
  s_waitcnt vmcnt(9)
  v_subrev_u32 v244, s100, v244
  v_mul_f32 v205, v205, v221
  v_mfma_f32_16x16x32_bf16 v[32:35], a[208:211], v[160:163], v[32:35]
  s_mov_b32 s41, 2359296
  s_add_u32 m0, s42, 77824
  v_subrev_u32 v244, 2, v244
  v_cmp_lt_u32 s[68:69], 5, v244
  v_mul_f32 v206, v206, v222
  v_mfma_f32_16x16x32_bf16 v[32:35], a[212:215], v[176:179], v[32:35]
  s_barrier
  s_cmp_lg_u64 s[68:69], 0
  s_cbranch_scc1 L_slow_35
L_back_36:
  v_mfma_f32_16x16x32_bf16 v[48:51], a[208:211], v[164:167], v[48:51]
  buffer_load_dwordx4 v242, s[44:47], s41 offen offset:0 lds
  s_xor_b32 s32, s90, 0x8000
  v_mov_b32 v254, s32
  v_mul_f32 v207, v207, v223
  v_mfma_f32_16x16x32_bf16 v[48:51], a[212:215], v[180:183], v[48:51]
  ds_read_b64_tr_b16 a[208:209], v229 offset:16384
  ds_read_b64_tr_b16 a[210:211], v229 offset:18432
  v_cndmask_b32_e64 v243, v254, v243, s[34:35]
  v_cvt_pk_bf16_f32 v200, v200, v201
  s_waitcnt lgkmcnt(13)
  v_mfma_f32_16x16x32_bf16 v[52:55], a[216:219], v[164:167], v[52:55]
  ds_read_b64_tr_b16 a[212:213], v238 offset:28672
  ds_read_b64_tr_b16 a[214:215], v238 offset:30720
  v_cvt_pk_bf16_f32 v201, v202, v203
  v_mfma_f32_16x16x32_bf16 v[52:55], a[220:223], v[180:183], v[52:55]
  s_mov_b32 s40, 20971520
  v_cvt_pk_bf16_f32 v202, v204, v205
  v_mfma_f32_16x16x32_bf16 v[36:39], a[216:219], v[160:163], v[36:39]
  buffer_load_dwordx4 a[64:67], v252, s[4:7], s40 offen offset:0 sc1
  v_mfma_f32_16x16x32_bf16 v[36:39], a[220:223], v[176:179], v[36:39]
  ds_read_b64_tr_b16 a[216:217], v230 offset:16384
  ds_read_b64_tr_b16 a[218:219], v230 offset:18432
  v_cvt_pk_bf16_f32 v203, v206, v207
  v_mfma_f32_16x16x32_bf16 v[40:43], a[224:227], v[160:163], v[40:43]
  ds_read_b64_tr_b16 a[220:221], v239 offset:28672
  ds_read_b64_tr_b16 a[222:223], v239 offset:30720
  s_waitcnt lgkmcnt(13)
  v_mfma_f32_16x16x32_bf16 v[40:43], a[228:231], v[176:179], v[40:43]
  buffer_load_dwordx4 a[68:71], v252, s[4:7], s40 offen offset:1024 sc1
  v_mfma_f32_16x16x32_bf16 v[56:59], a[224:227], v[164:167], v[56:59]
  ds_read_b64_tr_b16 a[224:225], v231 offset:16384
  ds_read_b64_tr_b16 a[226:227], v231 offset:18432
  v_mfma_f32_16x16x32_bf16 v[56:59], a[228:231], v[180:183], v[56:59]
  ds_read_b64_tr_b16 a[228:229], v228 offset:28672
  ds_read_b64_tr_b16 a[230:231], v228 offset:30720
  buffer_store_dwordx4 v[200:203], v225, s[4:7], s21 offen offset:3072 sc1
  v_mfma_f32_16x16x32_bf16 v[60:63], a[232:235], v[164:167], v[60:63]
  s_mov_b32 s40, 21102592
  v_mfma_f32_16x16x32_bf16 v[60:63], a[192:195], v[180:183], v[60:63]
  buffer_load_dwordx4 a[72:75], v252, s[4:7], s40 offen offset:0 sc1
  v_mfma_f32_16x16x32_bf16 v[44:47], a[232:235], v[160:163], v[44:47]
  ds_read_b64_tr_b16 a[232:233], v236 offset:8192
  ds_read_b64_tr_b16 a[234:235], v236 offset:10240
  v_mfma_f32_16x16x32_bf16 v[44:47], a[192:195], v[176:179], v[44:47]
  ds_read_b64_tr_b16 a[192:193], v229 offset:28672
  ds_read_b64_tr_b16 a[194:195], v229 offset:30720
  s_waitcnt lgkmcnt(13)
  v_mfma_f32_16x16x32_bf16 v[0:3], a[196:199], v[160:163], v[0:3]
  v_mfma_f32_16x16x32_bf16 v[0:3], a[200:203], v[176:179], v[0:3]
  buffer_load_dwordx4 a[76:79], v252, s[4:7], s40 offen offset:1024 sc1
  v_mfma_f32_16x16x32_bf16 v[16:19], a[196:199], v[164:167], v[16:19]
  ds_read_b64_tr_b16 a[196:197], v237 offset:8192
  ds_read_b64_tr_b16 a[198:199], v237 offset:10240
  v_mfma_f32_16x16x32_bf16 v[16:19], a[200:203], v[180:183], v[16:19]
  ds_read_b64_tr_b16 a[200:201], v230 offset:28672
  ds_read_b64_tr_b16 a[202:203], v230 offset:30720
  v_mfma_f32_16x16x32_bf16 v[20:23], a[204:207], v[164:167], v[20:23]
  s_mov_b32 s40, 21233664
  v_mfma_f32_16x16x32_bf16 v[20:23], a[208:211], v[180:183], v[20:23]
  buffer_load_dwordx4 a[80:83], v252, s[4:7], s40 offen offset:0 sc1
  v_mfma_f32_16x16x32_bf16 v[4:7], a[204:207], v[160:163], v[4:7]
  ds_read_b64_tr_b16 a[204:205], v238 offset:8192
  ds_read_b64_tr_b16 a[206:207], v238 offset:10240
  v_mfma_f32_16x16x32_bf16 v[4:7], a[208:211], v[176:179], v[4:7]
  ds_read_b64_tr_b16 a[208:209], v231 offset:28672
  ds_read_b64_tr_b16 a[210:211], v231 offset:30720
  s_waitcnt lgkmcnt(13)
  v_mfma_f32_16x16x32_bf16 v[8:11], a[212:215], v[160:163], v[8:11]
  v_mfma_f32_16x16x32_bf16 v[8:11], a[216:219], v[176:179], v[8:11]
  buffer_load_dwordx4 a[84:87], v252, s[4:7], s40 offen offset:1024 sc1
  v_mfma_f32_16x16x32_bf16 v[24:27], a[212:215], v[164:167], v[24:27]
  ds_read_b64_tr_b16 a[212:213], v239 offset:8192
  ds_read_b64_tr_b16 a[214:215], v239 offset:10240
  v_mfma_f32_16x16x32_bf16 v[24:27], a[216:219], v[180:183], v[24:27]
  ds_read_b64_tr_b16 a[216:217], v236 offset:24576
  ds_read_b64_tr_b16 a[218:219], v236 offset:26624
  v_mfma_f32_16x16x32_bf16 v[28:31], a[220:223], v[164:167], v[28:31]
  v_swap_b32 v194, v196
  v_swap_b32 v195, v197
  v_swap_b32 v210, v212
  v_swap_b32 v211, v213
  s_mov_b32 s40, 21364736
  v_mfma_f32_16x16x32_bf16 v[28:31], a[224:227], v[180:183], v[28:31]
  buffer_load_dwordx4 a[88:91], v252, s[4:7], s40 offen offset:0 sc1
  v_mfma_f32_16x16x32_bf16 v[12:15], a[220:223], v[160:163], v[12:15]
  ds_read_b64_tr_b16 a[220:221], v228 offset:20480
  ds_read_b64_tr_b16 a[222:223], v228 offset:22528
  v_mfma_f32_16x16x32_bf16 v[12:15], a[224:227], v[176:179], v[12:15]
  ds_read_b64_tr_b16 a[224:225], v237 offset:24576
  ds_read_b64_tr_b16 a[226:227], v237 offset:26624
  s_waitcnt lgkmcnt(13)
  v_mfma_f32_16x16x32_bf16 v[32:35], a[228:231], v[192:195], v[32:35]
  v_mfma_f32_16x16x32_bf16 v[32:35], a[232:235], v[208:211], v[32:35]
  s_barrier
  v_mfma_f32_16x16x32_bf16 v[48:51], a[228:231], v[196:199], v[48:51]
  buffer_load_dwordx4 a[92:95], v252, s[4:7], s40 offen offset:1024 sc1
  v_mfma_f32_16x16x32_bf16 v[48:51], a[232:235], v[212:215], v[48:51]
  ds_read_b64_tr_b16 a[228:229], v229 offset:20480
  ds_read_b64_tr_b16 a[230:231], v229 offset:22528
  v_mfma_f32_16x16x32_bf16 v[52:55], a[192:195], v[196:199], v[52:55]
  ds_read_b64_tr_b16 a[232:233], v238 offset:24576
  ds_read_b64_tr_b16 a[234:235], v238 offset:26624
  v_mfma_f32_16x16x32_bf16 v[52:55], a[196:199], v[212:215], v[52:55]
  s_mov_b32 s40, 21495808
  v_mfma_f32_16x16x32_bf16 v[36:39], a[192:195], v[192:195], v[36:39]
  buffer_load_dwordx4 a[96:99], v252, s[4:7], s40 offen offset:0 sc1
  v_mfma_f32_16x16x32_bf16 v[36:39], a[196:199], v[208:211], v[36:39]
  ds_read_b64_tr_b16 a[192:193], v230 offset:20480
  ds_read_b64_tr_b16 a[194:195], v230 offset:22528
  s_waitcnt lgkmcnt(13)
  v_mfma_f32_16x16x32_bf16 v[40:43], a[200:203], v[192:195], v[40:43]
  ds_read_b64_tr_b16 a[196:197], v239 offset:24576
  ds_read_b64_tr_b16 a[198:199], v239 offset:26624
  v_mfma_f32_16x16x32_bf16 v[40:43], a[204:207], v[208:211], v[40:43]
  buffer_load_dwordx4 a[100:103], v252, s[4:7], s40 offen offset:1024 sc1
  v_mfma_f32_16x16x32_bf16 v[56:59], a[200:203], v[196:199], v[56:59]
  ds_read_b64_tr_b16 a[200:201], v231 offset:20480
  ds_read_b64_tr_b16 a[202:203], v231 offset:22528
  v_mfma_f32_16x16x32_bf16 v[56:59], a[204:207], v[212:215], v[56:59]
  ds_read_b64_tr_b16 a[204:205], v228 offset:12288
  ds_read_b64_tr_b16 a[206:207], v228 offset:14336
  v_mfma_f32_16x16x32_bf16 v[60:63], a[208:211], v[196:199], v[60:63]
  s_mov_b32 s40, 21626880
  s_waitcnt lgkmcnt(13)
  v_mfma_f32_16x16x32_bf16 v[60:63], a[212:215], v[212:215], v[60:63]
  buffer_load_dwordx4 a[104:107], v252, s[4:7], s40 offen offset:0 sc1
  v_mfma_f32_16x16x32_bf16 v[44:47], a[208:211], v[192:195], v[44:47]
  ds_read_b64_tr_b16 a[208:209], v228 offset:24576
  ds_read_b64_tr_b16 a[210:211], v228 offset:26624
  v_mfma_f32_16x16x32_bf16 v[44:47], a[212:215], v[208:211], v[44:47]
  ds_read_b64_tr_b16 a[212:213], v229 offset:12288
  ds_read_b64_tr_b16 a[214:215], v229 offset:14336
  v_mfma_f32_16x16x32_bf16 v[0:3], a[216:219], v[192:195], v[0:3]
  v_mfma_f32_16x16x32_bf16 v[0:3], a[220:223], v[208:211], v[0:3]
  buffer_load_dwordx4 a[108:111], v252, s[4:7], s40 offen offset:1024 sc1
  v_mfma_f32_16x16x32_bf16 v[16:19], a[216:219], v[196:199], v[16:19]
  ds_read_b64_tr_b16 a[216:217], v229 offset:24576
  ds_read_b64_tr_b16 a[218:219], v229 offset:26624
  v_mfma_f32_16x16x32_bf16 v[16:19], a[220:223], v[212:215], v[16:19]
  ds_read_b64_tr_b16 a[220:221], v230 offset:12288
  ds_read_b64_tr_b16 a[222:223], v230 offset:14336
  s_waitcnt lgkmcnt(13)
  v_mfma_f32_16x16x32_bf16 v[20:23], a[224:227], v[196:199], v[20:23]
  s_mov_b32 s40, 21757952
  v_mfma_f32_16x16x32_bf16 v[20:23], a[228:231], v[212:215], v[20:23]
  buffer_load_dwordx4 a[112:115], v252, s[4:7], s40 offen offset:0 sc1
  v_mfma_f32_16x16x32_bf16 v[4:7], a[224:227], v[192:195], v[4:7]
  ds_read_b64_tr_b16 a[224:225], v230 offset:24576
  ds_read_b64_tr_b16 a[226:227], v230 offset:26624
  v_mfma_f32_16x16x32_bf16 v[4:7], a[228:231], v[208:211], v[4:7]
  ds_read_b64_tr_b16 a[228:229], v231 offset:12288
  ds_read_b64_tr_b16 a[230:231], v231 offset:14336
  v_mfma_f32_16x16x32_bf16 v[8:11], a[232:235], v[192:195], v[8:11]
  v_mfma_f32_16x16x32_bf16 v[8:11], a[192:195], v[208:211], v[8:11]
  buffer_load_dwordx4 a[116:119], v252, s[4:7], s40 offen offset:1024 sc1
  v_mfma_f32_16x16x32_bf16 v[24:27], a[232:235], v[196:199], v[24:27]
  ds_read_b64_tr_b16 a[232:233], v231 offset:24576
  ds_read_b64_tr_b16 a[234:235], v231 offset:26624
  v_mfma_f32_16x16x32_bf16 v[24:27], a[192:195], v[212:215], v[24:27]
  ds_read_b64_tr_b16 a[192:193], v228 offset:45056
  ds_read_b64_tr_b16 a[194:195], v228 offset:47104
  s_waitcnt lgkmcnt(13)
  v_mfma_f32_16x16x32_bf16 v[28:31], a[196:199], v[196:199], v[28:31]
  s_mov_b32 s40, 21889024
  v_mfma_f32_16x16x32_bf16 v[28:31], a[200:203], v[212:215], v[28:31]
  buffer_load_dwordx4 a[120:123], v252, s[4:7], s40 offen offset:0 sc1
  v_mfma_f32_16x16x32_bf16 v[12:15], a[196:199], v[192:195], v[12:15]
  ds_read_b64_tr_b16 a[196:197], v228 offset:36864
  ds_read_b64_tr_b16 a[198:199], v228 offset:38912
  v_mfma_f32_16x16x32_bf16 v[12:15], a[200:203], v[208:211], v[12:15]
  ds_read_b64_tr_b16 a[200:201], v229 offset:45056
  ds_read_b64_tr_b16 a[202:203], v229 offset:47104
  s_waitcnt vmcnt(11)
  v_mfma_f32_16x16x32_bf16 v[32:35], a[204:207], a[64:67], v[32:35]
  v_mfma_f32_16x16x32_bf16 v[32:35], a[208:211], a[72:75], v[32:35]
  s_barrier
  v_mfma_f32_16x16x32_bf16 v[48:51], a[204:207], a[68:71], v[48:51]
  buffer_load_dwordx4 a[124:127], v252, s[4:7], s40 offen offset:1024 sc1
  v_mfma_f32_16x16x32_bf16 v[48:51], a[208:211], a[76:79], v[48:51]
  ds_read_b64_tr_b16 a[204:205], v229 offset:36864
  ds_read_b64_tr_b16 a[206:207], v229 offset:38912
  s_waitcnt lgkmcnt(13)
  v_mfma_f32_16x16x32_bf16 v[52:55], a[212:215], a[68:71], v[52:55]
  ds_read_b64_tr_b16 a[208:209], v230 offset:45056
  ds_read_b64_tr_b16 a[210:211], v230 offset:47104
  v_mfma_f32_16x16x32_bf16 v[52:55], a[216:219], a[76:79], v[52:55]
  s_mov_b32 s40, 22020096
  v_mfma_f32_16x16x32_bf16 v[36:39], a[212:215], a[64:67], v[36:39]
  buffer_load_dwordx4 a[128:131], v252, s[4:7], s40 offen offset:0 sc1
  v_mfma_f32_16x16x32_bf16 v[36:39], a[216:219], a[72:75], v[36:39]
  ds_read_b64_tr_b16 a[212:213], v230 offset:36864
  ds_read_b64_tr_b16 a[214:215], v230 offset:38912
  v_mfma_f32_16x16x32_bf16 v[40:43], a[220:223], a[64:67], v[40:43]
  ds_read_b64_tr_b16 a[216:217], v231 offset:45056
  ds_read_b64_tr_b16 a[218:219], v231 offset:47104
  v_add_u32 v248, 3, v245
  buffer_store_dword v248, v246, s[4:7], s90 offen sc1
  s_waitcnt lgkmcnt(13)
  v_mfma_f32_16x16x32_bf16 v[40:43], a[224:227], a[72:75], v[40:43]
  v_mfma_f32_16x16x32_bf16 v[56:59], a[220:223], a[68:71], v[56:59]
  buffer_load_dwordx4 a[132:135], v252, s[4:7], s40 offen offset:1024 sc1
  v_mfma_f32_16x16x32_bf16 v[56:59], a[224:227], a[76:79], v[56:59]
  ds_read_b64_tr_b16 a[220:221], v231 offset:36864
  ds_read_b64_tr_b16 a[222:223], v231 offset:38912
  v_mfma_f32_16x16x32_bf16 v[60:63], a[228:231], a[68:71], v[60:63]
  ds_read_b64_tr_b16 a[224:225], v228 offset:49152
  ds_read_b64_tr_b16 a[226:227], v228 offset:51200
  v_mfma_f32_16x16x32_bf16 v[60:63], a[232:235], a[76:79], v[60:63]
  s_mov_b32 s40, 22151168
  v_mfma_f32_16x16x32_bf16 v[44:47], a[228:231], a[64:67], v[44:47]
  buffer_load_dwordx4 a[136:139], v252, s[4:7], s40 offen offset:0 sc1
  v_mfma_f32_16x16x32_bf16 v[44:47], a[232:235], a[72:75], v[44:47]
  ds_read_b64_tr_b16 a[228:229], v228 offset:32768
  ds_read_b64_tr_b16 a[230:231], v228 offset:34816
  s_waitcnt lgkmcnt(13)
  v_mfma_f32_16x16x32_bf16 v[0:3], a[192:195], a[64:67], v[0:3]
  ds_read_b64_tr_b16 a[232:233], v229 offset:49152
  ds_read_b64_tr_b16 a[234:235], v229 offset:51200
  v_mfma_f32_16x16x32_bf16 v[0:3], a[196:199], a[72:75], v[0:3]
  buffer_load_dwordx4 a[140:143], v252, s[4:7], s40 offen offset:1024 sc1
  v_mfma_f32_16x16x32_bf16 v[16:19], a[192:195], a[68:71], v[16:19]
  ds_read_b64_tr_b16 a[192:193], v229 offset:32768
  ds_read_b64_tr_b16 a[194:195], v229 offset:34816
  v_mfma_f32_16x16x32_bf16 v[16:19], a[196:199], a[76:79], v[16:19]
  ds_read_b64_tr_b16 a[196:197], v230 offset:49152
  ds_read_b64_tr_b16 a[198:199], v230 offset:51200
  v_mfma_f32_16x16x32_bf16 v[20:23], a[200:203], a[68:71], v[20:23]
  s_mov_b32 s41, 2621440
  s_add_u32 m0, s42, 73728
  s_waitcnt lgkmcnt(13)
  v_mfma_f32_16x16x32_bf16 v[20:23], a[204:207], a[76:79], v[20:23]
  buffer_load_dwordx4 v242, s[44:47], s41 offen offset:0 lds
  v_mfma_f32_16x16x32_bf16 v[4:7], a[200:203], a[64:67], v[4:7]
  ds_read_b64_tr_b16 a[200:201], v230 offset:32768
  ds_read_b64_tr_b16 a[202:203], v230 offset:34816
  v_mfma_f32_16x16x32_bf16 v[4:7], a[204:207], a[72:75], v[4:7]
  ds_read_b64_tr_b16 a[204:205], v231 offset:49152
  ds_read_b64_tr_b16 a[206:207], v231 offset:51200
  v_mfma_f32_16x16x32_bf16 v[8:11], a[208:211], a[64:67], v[8:11]
  s_mov_b32 s41, 2359296
  s_add_u32 m0, s42, 86016
  v_mfma_f32_16x16x32_bf16 v[8:11], a[212:215], a[72:75], v[8:11]
  buffer_load_dwordx4 v253, s[44:47], s41 offen offset:0 lds
  v_mfma_f32_16x16x32_bf16 v[24:27], a[208:211], a[68:71], v[24:27]
  ds_read_b64_tr_b16 a[208:209], v231 offset:32768
  ds_read_b64_tr_b16 a[210:211], v231 offset:34816
  v_mfma_f32_16x16x32_bf16 v[24:27], a[212:215], a[76:79], v[24:27]
  ds_read_b64_tr_b16 a[212:213], v228 offset:40960
  ds_read_b64_tr_b16 a[214:215], v228 offset:43008
  s_waitcnt lgkmcnt(13)
  v_mfma_f32_16x16x32_bf16 v[28:31], a[216:219], a[68:71], v[28:31]
  s_mov_b32 s41, 2621440
  s_add_u32 m0, s42, 102400
  v_mfma_f32_16x16x32_bf16 v[28:31], a[220:223], a[76:79], v[28:31]
  buffer_load_dwordx4 v253, s[44:47], s41 offen offset:0 lds
  v_mfma_f32_16x16x32_bf16 v[12:15], a[216:219], a[64:67], v[12:15]
  ds_read_b64_tr_b16 a[216:217], v228 offset:53248
  ds_read_b64_tr_b16 a[218:219], v228 offset:55296
  v_mfma_f32_16x16x32_bf16 v[12:15], a[220:223], a[72:75], v[12:15]
  ds_read_b64_tr_b16 a[220:221], v229 offset:40960
  ds_read_b64_tr_b16 a[222:223], v229 offset:43008
  s_waitcnt vmcnt(16)
  v_mfma_f32_16x16x32_bf16 v[32:35], a[224:227], a[80:83], v[32:35]
  s_mov_b32 s40, 22282240
  v_mfma_f32_16x16x32_bf16 v[32:35], a[228:231], a[88:91], v[32:35]
  s_barrier
  v_mfma_f32_16x16x32_bf16 v[48:51], a[224:227], a[84:87], v[48:51]
  buffer_load_dwordx4 a[144:147], v252, s[4:7], s40 offen offset:0 sc1
  v_mfma_f32_16x16x32_bf16 v[48:51], a[228:231], a[92:95], v[48:51]
  ds_read_b64_tr_b16 a[224:225], v229 offset:53248
  ds_read_b64_tr_b16 a[226:227], v229 offset:55296
  s_waitcnt lgkmcnt(13)
  v_mfma_f32_16x16x32_bf16 v[52:55], a[232:235], a[84:87], v[52:55]
  ds_read_b64_tr_b16 a[228:229], v230 offset:40960
  ds_read_b64_tr_b16 a[230:231], v230 offset:43008
  v_mfma_f32_16x16x32_bf16 v[52:55], a[192:195], a[92:95], v[52:55]
  buffer_load_dwordx4 a[148:151], v252, s[4:7], s40 offen offset:1024 sc1
  v_mfma_f32_16x16x32_bf16 v[36:39], a[232:235], a[80:83], v[36:39]
  ds_read_b64_tr_b16 a[232:233], v230 offset:53248
  ds_read_b64_tr_b16 a[234:235], v230 offset:55296
  v_mfma_f32_16x16x32_bf16 v[36:39], a[192:195], a[88:91], v[36:39]
  ds_read_b64_tr_b16 a[192:193], v231 offset:40960
  ds_read_b64_tr_b16 a[194:195], v231 offset:43008
  v_mfma_f32_16x16x32_bf16 v[40:43], a[196:199], a[80:83], v[40:43]
  s_mov_b32 s40, 22413312
  s_waitcnt lgkmcnt(13)
  v_mfma_f32_16x16x32_bf16 v[40:43], a[200:203], a[88:91], v[40:43]
  buffer_load_dwordx4 a[152:155], v252, s[4:7], s40 offen offset:0 sc1
  v_mfma_f32_16x16x32_bf16 v[56:59], a[196:199], a[84:87], v[56:59]
  ds_read_b64_tr_b16 a[196:197], v231 offset:53248
  ds_read_b64_tr_b16 a[198:199], v231 offset:55296
  v_mfma_f32_16x16x32_bf16 v[56:59], a[200:203], a[92:95], v[56:59]
  ds_read_b64_tr_b16 a[200:201], v228 offset:57344
  ds_read_b64_tr_b16 a[202:203], v228 offset:59392
  v_mfma_f32_16x16x32_bf16 v[60:63], a[204:207], a[84:87], v[60:63]
  v_mfma_f32_16x16x32_bf16 v[60:63], a[208:211], a[92:95], v[60:63]
  buffer_load_dwordx4 a[156:159], v252, s[4:7], s40 offen offset:1024 sc1
  v_mfma_f32_16x16x32_bf16 v[44:47], a[204:207], a[80:83], v[44:47]
  ds_read_b64_tr_b16 a[204:205], v232 offset:0
  ds_read_b64_tr_b16 a[206:207], v232 offset:2048
  v_mfma_f32_16x16x32_bf16 v[44:47], a[208:211], a[88:91], v[44:47]
  ds_read_b64_tr_b16 a[208:209], v229 offset:57344
  ds_read_b64_tr_b16 a[210:211], v229 offset:59392
  s_waitcnt lgkmcnt(13)
  v_mfma_f32_16x16x32_bf16 v[0:3], a[212:215], a[80:83], v[0:3]
  s_mov_b32 s41, 2752512
  s_add_u32 m0, s42, 98304
  v_mfma_f32_16x16x32_bf16 v[0:3], a[216:219], a[88:91], v[0:3]
  buffer_load_dwordx4 v242, s[44:47], s41 offen offset:0 lds
  v_mfma_f32_16x16x32_bf16 v[16:19], a[212:215], a[84:87], v[16:19]
  ds_read_b64_tr_b16 a[212:213], v233 offset:0
  ds_read_b64_tr_b16 a[214:215], v233 offset:2048
  v_mfma_f32_16x16x32_bf16 v[16:19], a[216:219], a[92:95], v[16:19]
  ds_read_b64_tr_b16 a[216:217], v230 offset:57344
  ds_read_b64_tr_b16 a[218:219], v230 offset:59392
  v_mfma_f32_16x16x32_bf16 v[20:23], a[220:223], a[84:87], v[20:23]
  s_mov_b32 s41, 3014656
  s_add_u32 m0, s42, 110592
L_wk1_10:
  s_cbranch_vccnz L_wk1_end
  v_mfma_f32_16x16x32_bf16 v[20:23], a[224:227], a[92:95], v[20:23]
  buffer_load_dwordx4 v242, s[44:47], s41 offen offset:0 lds
  v_mfma_f32_16x16x32_bf16 v[4:7], a[220:223], a[80:83], v[4:7]
  ds_read_b64_tr_b16 a[220:221], v234 offset:0
  ds_read_b64_tr_b16 a[222:223], v234 offset:2048
  v_mfma_f32_16x16x32_bf16 v[4:7], a[224:227], a[88:91], v[4:7]
  ds_read_b64_tr_b16 a[224:225], v231 offset:57344
  ds_read_b64_tr_b16 a[226:227], v231 offset:59392
  s_waitcnt lgkmcnt(13)
  v_mfma_f32_16x16x32_bf16 v[8:11], a[228:231], a[80:83], v[8:11]
  s_mov_b32 s41, 2752512
  s_add_u32 m0, s42, 126976
  v_mfma_f32_16x16x32_bf16 v[8:11], a[232:235], a[88:91], v[8:11]
  buffer_load_dwordx4 v253, s[44:47], s41 offen offset:0 lds
  v_mfma_f32_16x16x32_bf16 v[24:27], a[228:231], a[84:87], v[24:27]
  ds_read_b64_tr_b16 a[228:229], v235 offset:0
  ds_read_b64_tr_b16 a[230:231], v235 offset:2048
  v_mfma_f32_16x16x32_bf16 v[24:27], a[232:235], a[92:95], v[24:27]
  ds_read_b64_tr_b16 a[232:233], v232 offset:28672
  ds_read_b64_tr_b16 a[234:235], v232 offset:30720
  v_mfma_f32_16x16x32_bf16 v[28:31], a[192:195], a[84:87], v[28:31]
  s_mov_b32 s41, 3014656
  s_add_u32 m0, s42, 122880
  v_mfma_f32_16x16x32_bf16 v[28:31], a[196:199], a[92:95], v[28:31]
  buffer_load_dwordx4 v253, s[44:47], s41 offen offset:0 lds
  v_mfma_f32_16x16x32_bf16 v[12:15], a[192:195], a[80:83], v[12:15]
  ds_read_b64_tr_b16 a[192:193], v232 offset:40960
  ds_read_b64_tr_b16 a[194:195], v232 offset:43008
  v_mfma_f32_16x16x32_bf16 v[12:15], a[196:199], a[88:91], v[12:15]
  ds_read_b64_tr_b16 a[196:197], v233 offset:28672
  ds_read_b64_tr_b16 a[198:199], v233 offset:30720
  s_waitcnt vmcnt(20) lgkmcnt(13)
  v_mfma_f32_16x16x32_bf16 v[32:35], a[200:203], a[96:99], v[32:35]
  s_mov_b32 s40, 22544384
  v_mfma_f32_16x16x32_bf16 v[32:35], a[204:207], a[104:107], v[32:35]
  s_barrier
  v_mfma_f32_16x16x32_bf16 v[48:51], a[200:203], a[100:103], v[48:51]
  buffer_load_dwordx4 a[160:163], v252, s[4:7], s40 offen offset:0 sc1
  v_mfma_f32_16x16x32_bf16 v[48:51], a[204:207], a[108:111], v[48:51]
  ds_read_b64_tr_b16 a[200:201], v233 offset:40960
  ds_read_b64_tr_b16 a[202:203], v233 offset:43008
  v_mfma_f32_16x16x32_bf16 v[52:55], a[208:211], a[100:103], v[52:55]
  ds_read_b64_tr_b16 a[204:205], v234 offset:28672
  ds_read_b64_tr_b16 a[206:207], v234 offset:30720
  v_mfma_f32_16x16x32_bf16 v[52:55], a[212:215], a[108:111], v[52:55]
  buffer_load_dwordx4 a[164:167], v252, s[4:7], s40 offen offset:1024 sc1
  v_mfma_f32_16x16x32_bf16 v[36:39], a[208:211], a[96:99], v[36:39]
  ds_read_b64_tr_b16 a[208:209], v234 offset:40960
  ds_read_b64_tr_b16 a[210:211], v234 offset:43008
  v_mfma_f32_16x16x32_bf16 v[36:39], a[212:215], a[104:107], v[36:39]
  ds_read_b64_tr_b16 a[212:213], v235 offset:28672
  ds_read_b64_tr_b16 a[214:215], v235 offset:30720
  s_waitcnt lgkmcnt(13)
  v_mfma_f32_16x16x32_bf16 v[40:43], a[216:219], a[96:99], v[40:43]
  s_mov_b32 s40, 22675456
  v_mfma_f32_16x16x32_bf16 v[40:43], a[220:223], a[104:107], v[40:43]
  buffer_load_dwordx4 a[168:171], v252, s[4:7], s40 offen offset:0 sc1
  v_mfma_f32_16x16x32_bf16 v[56:59], a[216:219], a[100:103], v[56:59]
  ds_read_b64_tr_b16 a[216:217], v235 offset:40960
  ds_read_b64_tr_b16 a[218:219], v235 offset:43008
  v_mfma_f32_16x16x32_bf16 v[56:59], a[220:223], a[108:111], v[56:59]
  ds_read_b64_tr_b16 a[220:221], v232 offset:49152
  ds_read_b64_tr_b16 a[222:223], v232 offset:51200
  v_mfma_f32_16x16x32_bf16 v[60:63], a[224:227], a[100:103], v[60:63]
  v_mfma_f32_16x16x32_bf16 v[60:63], a[228:231], a[108:111], v[60:63]
  buffer_load_dwordx4 a[172:175], v252, s[4:7], s40 offen offset:1024 sc1
  v_mfma_f32_16x16x32_bf16 v[44:47], a[224:227], a[96:99], v[44:47]
  ds_read_b64_tr_b16 a[224:225], v236 offset:12288
  ds_read_b64_tr_b16 a[226:227], v236 offset:14336
  v_mfma_f32_16x16x32_bf16 v[44:47], a[228:231], a[104:107], v[44:47]
  ds_read_b64_tr_b16 a[228:229], v233 offset:49152
  ds_read_b64_tr_b16 a[230:231], v233 offset:51200
  s_waitcnt lgkmcnt(13)
  v_mfma_f32_16x16x32_bf16 v[0:3], a[232:235], a[96:99], v[0:3]
  s_mov_b32 s41, 3276800
  s_add_u32 m0, s42, 135168
  v_mfma_f32_16x16x32_bf16 v[0:3], a[192:195], a[104:107], v[0:3]
  buffer_load_dwordx4 v242, s[44:47], s41 offen offset:0 lds
  v_mfma_f32_16x16x32_bf16 v[16:19], a[232:235], a[100:103], v[16:19]
  ds_read_b64_tr_b16 a[232:233], v237 offset:12288
  ds_read_b64_tr_b16 a[234:235], v237 offset:14336
  v_mfma_f32_16x16x32_bf16 v[16:19], a[192:195], a[108:111], v[16:19]
  ds_read_b64_tr_b16 a[192:193], v234 offset:49152
  ds_read_b64_tr_b16 a[194:195], v234 offset:51200
  v_mfma_f32_16x16x32_bf16 v[20:23], a[196:199], a[100:103], v[20:23]
  s_mov_b32 s41, 3538944
  s_add_u32 m0, s42, 151552
  v_mfma_f32_16x16x32_bf16 v[20:23], a[200:203], a[108:111], v[20:23]
  buffer_load_dwordx4 v242, s[44:47], s41 offen offset:0 lds
  v_mfma_f32_16x16x32_bf16 v[4:7], a[196:199], a[96:99], v[4:7]
  ds_read_b64_tr_b16 a[196:197], v238 offset:12288
  ds_read_b64_tr_b16 a[198:199], v238 offset:14336
  v_mfma_f32_16x16x32_bf16 v[4:7], a[200:203], a[104:107], v[4:7]
  ds_read_b64_tr_b16 a[200:201], v235 offset:49152
  ds_read_b64_tr_b16 a[202:203], v235 offset:51200
  s_waitcnt lgkmcnt(13)
  v_mfma_f32_16x16x32_bf16 v[8:11], a[204:207], a[96:99], v[8:11]
  s_mov_b32 s41, 3276800
  s_add_u32 m0, s42, 147456
  v_mfma_f32_16x16x32_bf16 v[8:11], a[208:211], a[104:107], v[8:11]
  buffer_load_dwordx4 v253, s[44:47], s41 offen offset:0 lds
  v_mfma_f32_16x16x32_bf16 v[24:27], a[204:207], a[100:103], v[24:27]
  ds_read_b64_tr_b16 a[204:205], v239 offset:12288
  ds_read_b64_tr_b16 a[206:207], v239 offset:14336
  v_mfma_f32_16x16x32_bf16 v[24:27], a[208:211], a[108:111], v[24:27]
  ds_read_b64_tr_b16 a[208:209], v232 offset:4096
  ds_read_b64_tr_b16 a[210:211], v232 offset:6144
  v_mfma_f32_16x16x32_bf16 v[28:31], a[212:215], a[100:103], v[28:31]
  s_mov_b32 s41, 3538944
  s_add_u32 m0, s42, 159744
  v_mfma_f32_16x16x32_bf16 v[28:31], a[216:219], a[108:111], v[28:31]
  buffer_load_dwordx4 v253, s[44:47], s41 offen offset:0 lds
  v_mfma_f32_16x16x32_bf16 v[12:15], a[212:215], a[96:99], v[12:15]
  ds_read_b64_tr_b16 a[212:213], v232 offset:16384
  ds_read_b64_tr_b16 a[214:215], v232 offset:18432
  v_mfma_f32_16x16x32_bf16 v[12:15], a[216:219], a[104:107], v[12:15]
  ds_read_b64_tr_b16 a[216:217], v233 offset:4096
  ds_read_b64_tr_b16 a[218:219], v233 offset:6144
  s_waitcnt vmcnt(24) lgkmcnt(13)
  v_mfma_f32_16x16x32_bf16 v[32:35], a[220:223], a[112:115], v[32:35]
  s_mov_b32 s40, 22806528
  v_mfma_f32_16x16x32_bf16 v[32:35], a[224:227], a[120:123], v[32:35]
  s_barrier
  v_mfma_f32_16x16x32_bf16 v[48:51], a[220:223], a[116:119], v[48:51]
  buffer_load_dwordx4 a[176:179], v252, s[4:7], s40 offen offset:0 sc1
  v_mfma_f32_16x16x32_bf16 v[48:51], a[224:227], a[124:127], v[48:51]
  ds_read_b64_tr_b16 a[220:221], v233 offset:16384
  ds_read_b64_tr_b16 a[222:223], v233 offset:18432
  v_mfma_f32_16x16x32_bf16 v[52:55], a[228:231], a[116:119], v[52:55]
  ds_read_b64_tr_b16 a[224:225], v234 offset:4096
  ds_read_b64_tr_b16 a[226:227], v234 offset:6144
  v_mfma_f32_16x16x32_bf16 v[52:55], a[232:235], a[124:127], v[52:55]
  buffer_load_dwordx4 a[180:183], v252, s[4:7], s40 offen offset:1024 sc1
  v_mfma_f32_16x16x32_bf16 v[36:39], a[228:231], a[112:115], v[36:39]
  ds_read_b64_tr_b16 a[228:229], v234 offset:16384
  ds_read_b64_tr_b16 a[230:231], v234 offset:18432
  v_mfma_f32_16x16x32_bf16 v[36:39], a[232:235], a[120:123], v[36:39]
  ds_read_b64_tr_b16 a[232:233], v235 offset:4096
  ds_read_b64_tr_b16 a[234:235], v235 offset:6144
  s_waitcnt lgkmcnt(13)
  v_mfma_f32_16x16x32_bf16 v[40:43], a[192:195], a[112:115], v[40:43]
  s_mov_b32 s40, 22937600
  v_mfma_f32_16x16x32_bf16 v[40:43], a[196:199], a[120:123], v[40:43]
  buffer_load_dwordx4 a[184:187], v252, s[4:7], s40 offen offset:0 sc1
  v_mfma_f32_16x16x32_bf16 v[56:59], a[192:195], a[116:119], v[56:59]
  ds_read_b64_tr_b16 a[192:193], v235 offset:16384
  ds_read_b64_tr_b16 a[194:195], v235 offset:18432
  v_mfma_f32_16x16x32_bf16 v[56:59], a[196:199], a[124:127], v[56:59]
  ds_read_b64_tr_b16 a[196:197], v228 offset:61440
  ds_read_b64_tr_b16 a[198:199], v228 offset:63488
  v_mfma_f32_16x16x32_bf16 v[60:63], a[200:203], a[116:119], v[60:63]
  v_mfma_f32_16x16x32_bf16 v[60:63], a[204:207], a[124:127], v[60:63]
  buffer_load_dwordx4 a[188:191], v252, s[4:7], s40 offen offset:1024 sc1
  v_mfma_f32_16x16x32_bf16 v[44:47], a[200:203], a[112:115], v[44:47]
  ds_read_b64_tr_b16 a[200:201], v232 offset:24576
  ds_read_b64_tr_b16 a[202:203], v232 offset:26624
  v_mfma_f32_16x16x32_bf16 v[44:47], a[204:207], a[120:123], v[44:47]
  ds_read_b64_tr_b16 a[204:205], v229 offset:61440
  ds_read_b64_tr_b16 a[206:207], v229 offset:63488
  s_waitcnt lgkmcnt(13)
  v_mfma_f32_16x16x32_bf16 v[0:3], a[208:211], a[112:115], v[0:3]
  s_mov_b32 s41, 65536
  s_add_u32 m0, s42, 16384
  v_mfma_f32_16x16x32_bf16 v[0:3], a[212:215], a[120:123], v[0:3]
  buffer_load_dwordx4 v242, s[44:47], s41 offen offset:0 lds
  v_mfma_f32_16x16x32_bf16 v[16:19], a[208:211], a[116:119], v[16:19]
  ds_read_b64_tr_b16 a[208:209], v233 offset:24576
  ds_read_b64_tr_b16 a[210:211], v233 offset:26624
  v_mfma_f32_16x16x32_bf16 v[16:19], a[212:215], a[124:127], v[16:19]
  ds_read_b64_tr_b16 a[212:213], v230 offset:61440
  ds_read_b64_tr_b16 a[214:215], v230 offset:63488
  v_mfma_f32_16x16x32_bf16 v[20:23], a[216:219], a[116:119], v[20:23]
  s_mov_b32 s41, 327680
  s_add_u32 m0, s42, 28672
  v_mfma_f32_16x16x32_bf16 v[20:23], a[220:223], a[124:127], v[20:23]
  buffer_load_dwordx4 v242, s[44:47], s41 offen offset:0 lds
  v_mfma_f32_16x16x32_bf16 v[4:7], a[216:219], a[112:115], v[4:7]
  ds_read_b64_tr_b16 a[216:217], v234 offset:24576
  ds_read_b64_tr_b16 a[218:219], v234 offset:26624
  v_mfma_f32_16x16x32_bf16 v[4:7], a[220:223], a[120:123], v[4:7]
  ds_read_b64_tr_b16 a[220:221], v231 offset:61440
  ds_read_b64_tr_b16 a[222:223], v231 offset:63488
  s_waitcnt lgkmcnt(13)
  v_mfma_f32_16x16x32_bf16 v[8:11], a[224:227], a[112:115], v[8:11]
  s_mov_b32 s41, 65536
  s_add_u32 m0, s42, 139264
  v_mfma_f32_16x16x32_bf16 v[8:11], a[228:231], a[120:123], v[8:11]
  buffer_load_dwordx4 v253, s[44:47], s41 offen offset:0 lds
  v_mfma_f32_16x16x32_bf16 v[24:27], a[224:227], a[116:119], v[24:27]
  ds_read_b64_tr_b16 a[224:225], v235 offset:24576
  ds_read_b64_tr_b16 a[226:227], v235 offset:26624
  v_mfma_f32_16x16x32_bf16 v[24:27], a[228:231], a[124:127], v[24:27]
  ds_read_b64_tr_b16 a[228:229], v232 offset:53248
  ds_read_b64_tr_b16 a[230:231], v232 offset:55296
  v_mfma_f32_16x16x32_bf16 v[28:31], a[232:235], a[116:119], v[28:31]
  s_mov_b32 s41, 327680
  s_add_u32 m0, s42, 155648
  v_mfma_f32_16x16x32_bf16 v[28:31], a[192:195], a[124:127], v[28:31]
  buffer_load_dwordx4 v253, s[44:47], s41 offen offset:0 lds
  v_mfma_f32_16x16x32_bf16 v[12:15], a[232:235], a[112:115], v[12:15]
  ds_read_b64_tr_b16 a[232:233], v236 offset:0
  ds_read_b64_tr_b16 a[234:235], v236 offset:2048
  v_mfma_f32_16x16x32_bf16 v[12:15], a[192:195], a[120:123], v[12:15]
  ds_read_b64_tr_b16 a[192:193], v233 offset:53248
  ds_read_b64_tr_b16 a[194:195], v233 offset:55296
  s_waitcnt vmcnt(27) lgkmcnt(13)
  v_mfma_f32_16x16x32_bf16 v[32:35], a[196:199], a[128:131], v[32:35]
  s_mov_b32 s41, 589824
  s_add_u32 m0, s42, 20480
  v_mfma_f32_16x16x32_bf16 v[32:35], a[200:203], a[136:139], v[32:35]
  s_waitcnt vmcnt(24)
  s_barrier
  v_mfma_f32_16x16x32_bf16 v[48:51], a[196:199], a[132:135], v[48:51]
  buffer_load_dwordx4 v242, s[44:47], s41 offen offset:0 lds
  v_mfma_f32_16x16x32_bf16 v[48:51], a[200:203], a[140:143], v[48:51]
  ds_read_b64_tr_b16 a[196:197], v237 offset:0
  ds_read_b64_tr_b16 a[198:199], v237 offset:2048
  v_mfma_f32_16x16x32_bf16 v[52:55], a[204:207], a[132:135], v[52:55]
  ds_read_b64_tr_b16 a[200:201], v234 offset:53248
  ds_read_b64_tr_b16 a[202:203], v234 offset:55296
  v_mfma_f32_16x16x32_bf16 v[52:55], a[208:211], a[140:143], v[52:55]
  s_mov_b32 s41, 851968
  s_add_u32 m0, s42, 12288
  v_mfma_f32_16x16x32_bf16 v[36:39], a[204:207], a[128:131], v[36:39]
  buffer_load_dwordx4 v242, s[44:47], s41 offen offset:0 lds
  v_mfma_f32_16x16x32_bf16 v[36:39], a[208:211], a[136:139], v[36:39]
  ds_read_b64_tr_b16 a[204:205], v238 offset:0
  ds_read_b64_tr_b16 a[206:207], v238 offset:2048
  s_waitcnt lgkmcnt(13)
  v_mfma_f32_16x16x32_bf16 v[40:43], a[212:215], a[128:131], v[40:43]
  ds_read_b64_tr_b16 a[208:209], v235 offset:53248
  ds_read_b64_tr_b16 a[210:211], v235 offset:55296
  v_mfma_f32_16x16x32_bf16 v[40:43], a[216:219], a[136:139], v[40:43]
  s_mov_b32 s41, 589824
  s_add_u32 m0, s42, 24576
  v_mfma_f32_16x16x32_bf16 v[56:59], a[212:215], a[132:135], v[56:59]
  buffer_load_dwordx4 v253, s[44:47], s41 offen offset:0 lds
  v_mfma_f32_16x16x32_bf16 v[56:59], a[216:219], a[140:143], v[56:59]
  ds_read_b64_tr_b16 a[212:213], v239 offset:0
  ds_read_b64_tr_b16 a[214:215], v239 offset:2048
  v_mfma_f32_16x16x32_bf16 v[60:63], a[220:223], a[132:135], v[60:63]
  ds_read_b64_tr_b16 a[216:217], v232 offset:12288
  ds_read_b64_tr_b16 a[218:219], v232 offset:14336
  s_waitcnt lgkmcnt(13)
  v_mfma_f32_16x16x32_bf16 v[60:63], a[224:227], a[140:143], v[60:63]
  s_mov_b32 s41, 851968
  s_add_u32 m0, s42, 45056
  v_mfma_f32_16x16x32_bf16 v[44:47], a[220:223], a[128:131], v[44:47]
  buffer_load_dwordx4 v253, s[44:47], s41 offen offset:0 lds
  v_mfma_f32_16x16x32_bf16 v[44:47], a[224:227], a[136:139], v[44:47]
  ds_read_b64_tr_b16 a[220:221], v232 offset:8192
  ds_read_b64_tr_b16 a[222:223], v232 offset:10240
  v_mfma_f32_16x16x32_bf16 v[0:3], a[228:231], a[128:131], v[0:3]
  ds_read_b64_tr_b16 a[224:225], v233 offset:12288
  ds_read_b64_tr_b16 a[226:227], v233 offset:14336
  v_mfma_f32_16x16x32_bf16 v[0:3], a[232:235], a[136:139], v[0:3]
  s_mov_b32 s41, 983040
  s_add_u32 m0, s42, 36864
  v_mfma_f32_16x16x32_bf16 v[16:19], a[228:231], a[132:135], v[16:19]
  buffer_load_dwordx4 v242, s[44:47], s41 offen offset:0 lds
  v_mfma_f32_16x16x32_bf16 v[16:19], a[232:235], a[140:143], v[16:19]
  ds_read_b64_tr_b16 a[228:229], v233 offset:8192
  ds_read_b64_tr_b16 a[230:231], v233 offset:10240
  s_waitcnt lgkmcnt(13)
  v_mfma_f32_16x16x32_bf16 v[20:23], a[192:195], a[132:135], v[20:23]
  ds_read_b64_tr_b16 a[232:233], v234 offset:12288
  ds_read_b64_tr_b16 a[234:235], v234 offset:14336
  v_mfma_f32_16x16x32_bf16 v[20:23], a[196:199], a[140:143], v[20:23]
  s_mov_b32 s41, 1245184
  s_add_u32 m0, s42, 49152
  v_mfma_f32_16x16x32_bf16 v[4:7], a[192:195], a[128:131], v[4:7]
  buffer_load_dwordx4 v242, s[44:47], s41 offen offset:0 lds
  v_mfma_f32_16x16x32_bf16 v[4:7], a[196:199], a[136:139], v[4:7]
  ds_read_b64_tr_b16 a[192:193], v234 offset:8192
  ds_read_b64_tr_b16 a[194:195], v234 offset:10240
  buffer_load_dword v244, v243, s[4:7], s91 offen sc1
  v_mfma_f32_16x16x32_bf16 v[8:11], a[200:203], a[128:131], v[8:11]
  ds_read_b64_tr_b16 a[196:197], v235 offset:12288
  ds_read_b64_tr_b16 a[198:199], v235 offset:14336
  s_waitcnt lgkmcnt(13)
  v_mfma_f32_16x16x32_bf16 v[8:11], a[204:207], a[136:139], v[8:11]
  s_mov_b32 s41, 983040
  s_add_u32 m0, s42, 32768
  v_mfma_f32_16x16x32_bf16 v[24:27], a[200:203], a[132:135], v[24:27]
  buffer_load_dwordx4 v253, s[44:47], s41 offen offset:0 lds
  v_mfma_f32_16x16x32_bf16 v[24:27], a[204:207], a[140:143], v[24:27]
  ds_read_b64_tr_b16 a[200:201], v235 offset:8192
  ds_read_b64_tr_b16 a[202:203], v235 offset:10240
  v_mfma_f32_16x16x32_bf16 v[28:31], a[208:211], a[132:135], v[28:31]
  ds_read_b64_tr_b16 a[204:205], v232 offset:20480
  ds_read_b64_tr_b16 a[206:207], v232 offset:22528
  v_mfma_f32_16x16x32_bf16 v[28:31], a[212:215], a[140:143], v[28:31]
  s_mov_b32 s41, 1245184
  s_add_u32 m0, s42, 40960
  v_mfma_f32_16x16x32_bf16 v[12:15], a[208:211], a[128:131], v[12:15]
  buffer_load_dwordx4 v253, s[44:47], s41 offen offset:0 lds
  v_mfma_f32_16x16x32_bf16 v[12:15], a[212:215], a[136:139], v[12:15]
  ds_read_b64_tr_b16 a[208:209], v232 offset:36864
  ds_read_b64_tr_b16 a[210:211], v232 offset:38912
  s_waitcnt vmcnt(29) lgkmcnt(13)
  v_mfma_f32_16x16x32_bf16 v[32:35], a[216:219], a[144:147], v[32:35]
  ds_read_b64_tr_b16 a[212:213], v233 offset:20480
  ds_read_b64_tr_b16 a[214:215], v233 offset:22528
  v_mfma_f32_16x16x32_bf16 v[32:35], a[220:223], a[152:155], v[32:35]
  s_waitcnt vmcnt(25)
  s_barrier
  v_mfma_f32_16x16x32_bf16 v[48:51], a[216:219], a[148:151], v[48:51]
  ds_read_b64_tr_b16 a[216:217], v233 offset:36864
  ds_read_b64_tr_b16 a[218:219], v233 offset:38912
  v_mfma_f32_16x16x32_bf16 v[48:51], a[220:223], a[156:159], v[48:51]
  ds_read_b64_tr_b16 a[220:221], v234 offset:20480
  ds_read_b64_tr_b16 a[222:223], v234 offset:22528
  v_mfma_f32_16x16x32_bf16 v[52:55], a[224:227], a[148:151], v[52:55]
  s_mov_b32 s41, 1507328
  s_add_u32 m0, s42, 53248
  s_waitcnt lgkmcnt(13)
  v_mfma_f32_16x16x32_bf16 v[52:55], a[228:231], a[156:159], v[52:55]
  buffer_load_dwordx4 v242, s[44:47], s41 offen offset:0 lds
  v_mfma_f32_16x16x32_bf16 v[36:39], a[224:227], a[144:147], v[36:39]
  ds_read_b64_tr_b16 a[224:225], v234 offset:36864
  ds_read_b64_tr_b16 a[226:227], v234 offset:38912
  v_mfma_f32_16x16x32_bf16 v[36:39], a[228:231], a[152:155], v[36:39]
  ds_read_b64_tr_b16 a[228:229], v235 offset:20480
  ds_read_b64_tr_b16 a[230:231], v235 offset:22528
  v_mfma_f32_16x16x32_bf16 v[40:43], a[232:235], a[144:147], v[40:43]
  s_mov_b32 s41, 1769472
  s_add_u32 m0, s42, 57344
  v_mfma_f32_16x16x32_bf16 v[40:43], a[192:195], a[152:155], v[40:43]
  buffer_load_dwordx4 v242, s[44:47], s41 offen offset:0 lds
  v_mfma_f32_16x16x32_bf16 v[56:59], a[232:235], a[148:151], v[56:59]
  ds_read_b64_tr_b16 a[232:233], v235 offset:36864
  ds_read_b64_tr_b16 a[234:235], v235 offset:38912
  v_mfma_f32_16x16x32_bf16 v[56:59], a[192:195], a[156:159], v[56:59]
  ds_read_b64_tr_b16 a[192:193], v232 offset:32768
  ds_read_b64_tr_b16 a[194:195], v232 offset:34816
  s_waitcnt lgkmcnt(13)
  v_mfma_f32_16x16x32_bf16 v[60:63], a[196:199], a[148:151], v[60:63]
  s_mov_b32 s41, 1507328
  s_add_u32 m0, s42, 65536
  v_mfma_f32_16x16x32_bf16 v[60:63], a[200:203], a[156:159], v[60:63]
  buffer_load_dwordx4 v253, s[44:47], s41 offen offset:0 lds
  v_mfma_f32_16x16x32_bf16 v[44:47], a[196:199], a[144:147], v[44:47]
  ds_read_b64_tr_b16 a[196:197], v232 offset:45056
  ds_read_b64_tr_b16 a[198:199], v232 offset:47104
  v_mfma_f32_16x16x32_bf16 v[44:47], a[200:203], a[152:155], v[44:47]
  ds_read_b64_tr_b16 a[200:201], v233 offset:32768
  ds_read_b64_tr_b16 a[202:203], v233 offset:34816
  v_mfma_f32_16x16x32_bf16 v[0:3], a[204:207], a[144:147], v[0:3]
  s_mov_b32 s41, 1769472
  s_add_u32 m0, s42, 94208
  v_mfma_f32_16x16x32_bf16 v[0:3], a[208:211], a[152:155], v[0:3]
  buffer_load_dwordx4 v253, s[44:47], s41 offen offset:0 lds
  v_mfma_f32_16x16x32_bf16 v[16:19], a[204:207], a[148:151], v[16:19]
  ds_read_b64_tr_b16 a[204:205], v233 offset:45056
  ds_read_b64_tr_b16 a[206:207], v233 offset:47104
  v_mfma_f32_16x16x32_bf16 v[16:19], a[208:211], a[156:159], v[16:19]
  ds_read_b64_tr_b16 a[208:209], v234 offset:32768
  ds_read_b64_tr_b16 a[210:211], v234 offset:34816
  s_waitcnt lgkmcnt(13)
  v_mfma_f32_16x16x32_bf16 v[20:23], a[212:215], a[148:151], v[20:23]
  s_mov_b32 s41, 1900544
  s_add_u32 m0, s42, 106496
  v_mfma_f32_16x16x32_bf16 v[20:23], a[216:219], a[156:159], v[20:23]
  buffer_load_dwordx4 v242, s[44:47], s41 offen offset:0 lds
  v_mfma_f32_16x16x32_bf16 v[4:7], a[212:215], a[144:147], v[4:7]
  ds_read_b64_tr_b16 a[212:213], v234 offset:45056
  ds_read_b64_tr_b16 a[214:215], v234 offset:47104
  v_mfma_f32_16x16x32_bf16 v[4:7], a[216:219], a[152:155], v[4:7]
  ds_read_b64_tr_b16 a[216:217], v235 offset:32768
  ds_read_b64_tr_b16 a[218:219], v235 offset:34816
  v_mfma_f32_16x16x32_bf16 v[8:11], a[220:223], a[144:147], v[8:11]
  s_mov_b32 s41, 2162688
  s_add_u32 m0, s42, 114688
  v_mfma_f32_16x16x32_bf16 v[8:11], a[224:227], a[152:155], v[8:11]
  buffer_load_dwordx4 v242, s[44:47], s41 offen offset:0 lds
  v_mfma_f32_16x16x32_bf16 v[24:27], a[220:223], a[148:151], v[24:27]
  ds_read_b64_tr_b16 a[220:221], v235 offset:45056
  ds_read_b64_tr_b16 a[222:223], v235 offset:47104
  v_mfma_f32_16x16x32_bf16 v[24:27], a[224:227], a[156:159], v[24:27]
  ds_read_b64_tr_b16 a[224:225], v232 offset:61440
  ds_read_b64_tr_b16 a[226:227], v232 offset:63488
  s_waitcnt lgkmcnt(13)
  v_mfma_f32_16x16x32_bf16 v[28:31], a[228:231], a[148:151], v[28:31]
  s_mov_b32 s41, 2424832
  s_add_u32 m0, s42, 143360
  v_mfma_f32_16x16x32_bf16 v[28:31], a[232:235], a[156:159], v[28:31]
  buffer_load_dwordx4 v242, s[44:47], s41 offen offset:0 lds
  v_mfma_f32_16x16x32_bf16 v[12:15], a[228:231], a[144:147], v[12:15]
  ds_read_b64_tr_b16 a[228:229], v232 offset:57344
  ds_read_b64_tr_b16 a[230:231], v232 offset:59392
  v_mfma_f32_16x16x32_bf16 v[12:15], a[232:235], a[152:155], v[12:15]
  ds_read_b64_tr_b16 a[232:233], v233 offset:61440
  ds_read_b64_tr_b16 a[234:235], v233 offset:63488
  s_waitcnt vmcnt(9)
  v_subrev_u32 v244, s100, v244
  v_mfma_f32_16x16x32_bf16 v[32:35], a[192:195], a[160:163], v[32:35]
  s_mov_b32 s41, 2686976
  s_add_u32 m0, s42, 69632
  v_subrev_u32 v244, 3, v244
  v_cmp_lt_u32 s[68:69], 4, v244
  v_mfma_f32_16x16x32_bf16 v[32:35], a[196:199], a[168:171], v[32:35]
  s_barrier
  s_cmp_lg_u64 s[68:69], 0
  s_cbranch_scc1 L_slow_37
L_back_38:
  v_mfma_f32_16x16x32_bf16 v[48:51], a[192:195], a[164:167], v[48:51]
  buffer_load_dwordx4 v242, s[44:47], s41 offen offset:0 lds
  v_mfma_f32_16x16x32_bf16 v[48:51], a[196:199], a[172:175], v[48:51]
  ds_read_b64_tr_b16 a[192:193], v233 offset:57344
  ds_read_b64_tr_b16 a[194:195], v233 offset:59392
  s_waitcnt lgkmcnt(13)
  v_mfma_f32_16x16x32_bf16 v[52:55], a[200:203], a[164:167], v[52:55]
  ds_read_b64_tr_b16 a[196:197], v234 offset:61440
  ds_read_b64_tr_b16 a[198:199], v234 offset:63488
  v_mfma_f32_16x16x32_bf16 v[52:55], a[204:207], a[172:175], v[52:55]
  s_mov_b32 s40, 23068672
  v_mfma_f32_16x16x32_bf16 v[36:39], a[200:203], a[160:163], v[36:39]
  buffer_load_dwordx4 a[0:3], v252, s[4:7], s40 offen offset:0 sc1
  v_mfma_f32_16x16x32_bf16 v[36:39], a[204:207], a[168:171], v[36:39]
  ds_read_b64_tr_b16 a[200:201], v234 offset:57344
  ds_read_b64_tr_b16 a[202:203], v234 offset:59392
  v_mfma_f32_16x16x32_bf16 v[40:43], a[208:211], a[160:163], v[40:43]
  ds_read_b64_tr_b16 a[204:205], v235 offset:61440
  ds_read_b64_tr_b16 a[206:207], v235 offset:63488
  s_waitcnt lgkmcnt(13)
  v_mfma_f32_16x16x32_bf16 v[40:43], a[212:215], a[168:171], v[40:43]
  buffer_load_dwordx4 a[4:7], v252, s[4:7], s40 offen offset:1024 sc1
  v_mfma_f32_16x16x32_bf16 v[56:59], a[208:211], a[164:167], v[56:59]
  ds_read_b64_tr_b16 a[208:209], v235 offset:57344
  ds_read_b64_tr_b16 a[210:211], v235 offset:59392
  v_mfma_f32_16x16x32_bf16 v[56:59], a[212:215], a[172:175], v[56:59]
  ds_read_b64_tr_b16 a[212:213], v236 offset:4096
  ds_read_b64_tr_b16 a[214:215], v236 offset:6144
  v_mfma_f32_16x16x32_bf16 v[60:63], a[216:219], a[164:167], v[60:63]
  s_mov_b32 s40, 23199744
  v_mfma_f32_16x16x32_bf16 v[60:63], a[220:223], a[172:175], v[60:63]
  buffer_load_dwordx4 a[8:11], v252, s[4:7], s40 offen offset:0 sc1
  v_mfma_f32_16x16x32_bf16 v[44:47], a[216:219], a[160:163], v[44:47]
  ds_read_b64_tr_b16 a[216:217], v236 offset:20480
  ds_read_b64_tr_b16 a[218:219], v236 offset:22528
  v_mfma_f32_16x16x32_bf16 v[44:47], a[220:223], a[168:171], v[44:47]
  ds_read_b64_tr_b16 a[220:221], v237 offset:4096
  ds_read_b64_tr_b16 a[222:223], v237 offset:6144
  s_waitcnt lgkmcnt(13)
  v_mfma_f32_16x16x32_bf16 v[0:3], a[224:227], a[160:163], v[0:3]
  v_mfma_f32_16x16x32_bf16 v[0:3], a[228:231], a[168:171], v[0:3]
  buffer_load_dwordx4 a[12:15], v252, s[4:7], s40 offen offset:1024 sc1
  v_mfma_f32_16x16x32_bf16 v[16:19], a[224:227], a[164:167], v[16:19]
  ds_read_b64_tr_b16 a[224:225], v237 offset:20480
  ds_read_b64_tr_b16 a[226:227], v237 offset:22528
  v_mfma_f32_16x16x32_bf16 v[16:19], a[228:231], a[172:175], v[16:19]
  ds_read_b64_tr_b16 a[228:229], v238 offset:4096
  ds_read_b64_tr_b16 a[230:231], v238 offset:6144
  v_mfma_f32_16x16x32_bf16 v[20:23], a[232:235], a[164:167], v[20:23]
  s_mov_b32 s40, 23330816
  v_mfma_f32_16x16x32_bf16 v[20:23], a[192:195], a[172:175], v[20:23]
  buffer_load_dwordx4 a[16:19], v252, s[4:7], s40 offen offset:0 sc1
  v_mfma_f32_16x16x32_bf16 v[4:7], a[232:235], a[160:163], v[4:7]
  ds_read_b64_tr_b16 a[232:233], v238 offset:20480
  ds_read_b64_tr_b16 a[234:235], v238 offset:22528
  v_mfma_f32_16x16x32_bf16 v[4:7], a[192:195], a[168:171], v[4:7]
  ds_read_b64_tr_b16 a[192:193], v239 offset:4096
  ds_read_b64_tr_b16 a[194:195], v239 offset:6144
  s_waitcnt lgkmcnt(13)
  v_mfma_f32_16x16x32_bf16 v[8:11], a[196:199], a[160:163], v[8:11]
  v_mfma_f32_16x16x32_bf16 v[8:11], a[200:203], a[168:171], v[8:11]
  buffer_load_dwordx4 a[20:23], v252, s[4:7], s40 offen offset:1024 sc1
  v_mfma_f32_16x16x32_bf16 v[24:27], a[196:199], a[164:167], v[24:27]
  ds_read_b64_tr_b16 a[196:197], v239 offset:20480
  ds_read_b64_tr_b16 a[198:199], v239 offset:22528
  v_mfma_f32_16x16x32_bf16 v[24:27], a[200:203], a[172:175], v[24:27]
  ds_read_b64_tr_b16 a[200:201], v236 offset:16384
  ds_read_b64_tr_b16 a[202:203], v236 offset:18432
  v_mfma_f32_16x16x32_bf16 v[28:31], a[204:207], a[164:167], v[28:31]
  s_mov_b32 s40, 23461888
  v_mfma_f32_16x16x32_bf16 v[28:31], a[208:211], a[172:175], v[28:31]
  buffer_load_dwordx4 a[24:27], v252, s[4:7], s40 offen offset:0 sc1
  v_mfma_f32_16x16x32_bf16 v[12:15], a[204:207], a[160:163], v[12:15]
  ds_read_b64_tr_b16 a[204:205], v236 offset:28672
  ds_read_b64_tr_b16 a[206:207], v236 offset:30720
  v_mfma_f32_16x16x32_bf16 v[12:15], a[208:211], a[168:171], v[12:15]
  ds_read_b64_tr_b16 a[208:209], v237 offset:16384
  ds_read_b64_tr_b16 a[210:211], v237 offset:18432
  s_waitcnt lgkmcnt(13)
  v_mfma_f32_16x16x32_bf16 v[32:35], a[212:215], a[176:179], v[32:35]
  v_mfma_f32_16x16x32_bf16 v[32:35], a[216:219], a[184:187], v[32:35]
  s_barrier
  v_mfma_f32_16x16x32_bf16 v[48:51], a[212:215], a[180:183], v[48:51]
  buffer_load_dwordx4 a[28:31], v252, s[4:7], s40 offen offset:1024 sc1
  v_mfma_f32_16x16x32_bf16 v[48:51], a[216:219], a[188:191], v[48:51]
  ds_read_b64_tr_b16 a[212:213], v237 offset:28672
  ds_read_b64_tr_b16 a[214:215], v237 offset:30720
  v_mfma_f32_16x16x32_bf16 v[52:55], a[220:223], a[180:183], v[52:55]
  ds_read_b64_tr_b16 a[216:217], v238 offset:16384
  ds_read_b64_tr_b16 a[218:219], v238 offset:18432
  v_mfma_f32_16x16x32_bf16 v[52:55], a[224:227], a[188:191], v[52:55]
  s_mov_b32 s40, 23592960
  v_mfma_f32_16x16x32_bf16 v[36:39], a[220:223], a[176:179], v[36:39]
  buffer_load_dwordx4 a[32:35], v252, s[4:7], s40 offen offset:0 sc1
  v_mfma_f32_16x16x32_bf16 v[36:39], a[224:227], a[184:187], v[36:39]
  ds_read_b64_tr_b16 a[220:221], v238 offset:28672
  ds_read_b64_tr_b16 a[222:223], v238 offset:30720
  s_waitcnt lgkmcnt(13)
  v_mfma_f32_16x16x32_bf16 v[40:43], a[228:231], a[176:179], v[40:43]
  ds_read_b64_tr_b16 a[224:225], v239 offset:16384
  ds_read_b64_tr_b16 a[226:227], v239 offset:18432
  v_mfma_f32_16x16x32_bf16 v[40:43], a[232:235], a[184:187], v[40:43]
  buffer_load_dwordx4 a[36:39], v252, s[4:7], s40 offen offset:1024 sc1
  v_mfma_f32_16x16x32_bf16 v[56:59], a[228:231], a[180:183], v[56:59]
  ds_read_b64_tr_b16 a[228:229], v239 offset:28672
  ds_read_b64_tr_b16 a[230:231], v239 offset:30720
  v_mfma_f32_16x16x32_bf16 v[56:59], a[232:235], a[188:191], v[56:59]
  ds_read_b64_tr_b16 a[232:233], v228 offset:16384
  ds_read_b64_tr_b16 a[234:235], v228 offset:18432
  v_mfma_f32_16x16x32_bf16 v[60:63], a[192:195], a[180:183], v[60:63]
  s_mov_b32 s40, 23724032
  s_waitcnt lgkmcnt(13)
  v_mfma_f32_16x16x32_bf16 v[60:63], a[196:199], a[188:191], v[60:63]
  buffer_load_dwordx4 a[40:43], v252, s[4:7], s40 offen offset:0 sc1
  v_mfma_f32_16x16x32_bf16 v[44:47], a[192:195], a[176:179], v[44:47]
  ds_read_b64_tr_b16 a[192:193], v228 offset:28672
  ds_read_b64_tr_b16 a[194:195], v228 offset:30720
  v_mfma_f32_16x16x32_bf16 v[44:47], a[196:199], a[184:187], v[44:47]
  ds_read_b64_tr_b16 a[196:197], v229 offset:16384
  ds_read_b64_tr_b16 a[198:199], v229 offset:18432
  v_mfma_f32_16x16x32_bf16 v[0:3], a[200:203], a[176:179], v[0:3]
  v_mfma_f32_16x16x32_bf16 v[0:3], a[204:207], a[184:187], v[0:3]
  buffer_load_dwordx4 a[44:47], v252, s[4:7], s40 offen offset:1024 sc1
  v_mfma_f32_16x16x32_bf16 v[16:19], a[200:203], a[180:183], v[16:19]
  ds_read_b64_tr_b16 a[200:201], v229 offset:28672
  ds_read_b64_tr_b16 a[202:203], v229 offset:30720
  v_mfma_f32_16x16x32_bf16 v[16:19], a[204:207], a[188:191], v[16:19]
L_wk1_11:
  s_cbranch_vccnz L_wk1_end
  ds_read_b64_tr_b16 a[204:205], v230 offset:16384
  ds_read_b64_tr_b16 a[206:207], v230 offset:18432
  s_waitcnt lgkmcnt(13)
  v_mfma_f32_16x16x32_bf16 v[20:23], a[208:211], a[180:183], v[20:23]
  s_mov_b32 s40, 23855104
  v_mfma_f32_16x16x32_bf16 v[20:23], a[212:215], a[188:191], v[20:23]
  buffer_load_dwordx4 a[48:51], v252, s[4:7], s40 offen offset:0 sc1
  v_mfma_f32_16x16x32_bf16 v[4:7], a[208:211], a[176:179], v[4:7]
  ds_read_b64_tr_b16 a[208:209], v230 offset:28672
  ds_read_b64_tr_b16 a[210:211], v230 offset:30720
  v_mfma_f32_16x16x32_bf16 v[4:7], a[212:215], a[184:187], v[4:7]
  ds_read_b64_tr_b16 a[212:213], v231 offset:16384
  ds_read_b64_tr_b16 a[214:215], v231 offset:18432
  v_mfma_f32_16x16x32_bf16 v[8:11], a[216:219], a[176:179], v[8:11]
  v_mfma_f32_16x16x32_bf16 v[8:11], a[220:223], a[184:187], v[8:11]
  buffer_load_dwordx4 a[52:55], v252, s[4:7], s40 offen offset:1024 sc1
  v_mfma_f32_16x16x32_bf16 v[24:27], a[216:219], a[180:183], v[24:27]
  ds_read_b64_tr_b16 a[216:217], v231 offset:28672
  ds_read_b64_tr_b16 a[218:219], v231 offset:30720
  v_mfma_f32_16x16x32_bf16 v[24:27], a[220:223], a[188:191], v[24:27]
  ds_read_b64_tr_b16 a[220:221], v236 offset:8192
  ds_read_b64_tr_b16 a[222:223], v236 offset:10240
  s_waitcnt lgkmcnt(13)
  v_mfma_f32_16x16x32_bf16 v[28:31], a[224:227], a[180:183], v[28:31]
  s_mov_b32 s40, 23986176
  v_mfma_f32_16x16x32_bf16 v[28:31], a[228:231], a[188:191], v[28:31]
  buffer_load_dwordx4 a[56:59], v252, s[4:7], s40 offen offset:0 sc1
  v_mfma_f32_16x16x32_bf16 v[12:15], a[224:227], a[176:179], v[12:15]
  ds_read_b64_tr_b16 a[224:225], v236 offset:24576
  ds_read_b64_tr_b16 a[226:227], v236 offset:26624
  v_mfma_f32_16x16x32_bf16 v[12:15], a[228:231], a[184:187], v[12:15]
  ds_read_b64_tr_b16 a[228:229], v237 offset:8192
  ds_read_b64_tr_b16 a[230:231], v237 offset:10240
  s_waitcnt vmcnt(11)
  v_mfma_f32_16x16x32_bf16 v[32:35], a[232:235], a[0:3], v[32:35]
  v_mfma_f32_16x16x32_bf16 v[32:35], a[192:195], a[8:11], v[32:35]
  s_barrier
  v_mfma_f32_16x16x32_bf16 v[48:51], a[232:235], a[4:7], v[48:51]
  buffer_load_dwordx4 a[60:63], v252, s[4:7], s40 offen offset:1024 sc1
  v_mfma_f32_16x16x32_bf16 v[48:51], a[192:195], a[12:15], v[48:51]
  ds_read_b64_tr_b16 a[232:233], v237 offset:24576
  ds_read_b64_tr_b16 a[234:235], v237 offset:26624
  s_waitcnt lgkmcnt(13)
  v_mfma_f32_16x16x32_bf16 v[52:55], a[196:199], a[4:7], v[52:55]
  ds_read_b64_tr_b16 a[192:193], v238 offset:8192
  ds_read_b64_tr_b16 a[194:195], v238 offset:10240
  v_mfma_f32_16x16x32_bf16 v[52:55], a[200:203], a[12:15], v[52:55]
  s_mov_b32 s40, 24117248
  v_mfma_f32_16x16x32_bf16 v[36:39], a[196:199], a[0:3], v[36:39]
  buffer_load_dwordx4 a[64:67], v252, s[4:7], s40 offen offset:0 sc1
  v_mfma_f32_16x16x32_bf16 v[36:39], a[200:203], a[8:11], v[36:39]
  ds_read_b64_tr_b16 a[196:197], v238 offset:24576
  ds_read_b64_tr_b16 a[198:199], v238 offset:26624
  v_mfma_f32_16x16x32_bf16 v[40:43], a[204:207], a[0:3], v[40:43]
  ds_read_b64_tr_b16 a[200:201], v239 offset:8192
  ds_read_b64_tr_b16 a[202:203], v239 offset:10240
  s_waitcnt lgkmcnt(13)
  v_mfma_f32_16x16x32_bf16 v[40:43], a[208:211], a[8:11], v[40:43]
  buffer_load_dwordx4 a[68:71], v252, s[4:7], s40 offen offset:1024 sc1
  v_mfma_f32_16x16x32_bf16 v[56:59], a[204:207], a[4:7], v[56:59]
  ds_read_b64_tr_b16 a[204:205], v239 offset:24576
  ds_read_b64_tr_b16 a[206:207], v239 offset:26624
  v_mfma_f32_16x16x32_bf16 v[56:59], a[208:211], a[12:15], v[56:59]
  ds_read_b64_tr_b16 a[208:209], v228 offset:20480
  ds_read_b64_tr_b16 a[210:211], v228 offset:22528
  v_mfma_f32_16x16x32_bf16 v[60:63], a[212:215], a[4:7], v[60:63]
  s_mov_b32 s40, 24248320
  v_mfma_f32_16x16x32_bf16 v[60:63], a[216:219], a[12:15], v[60:63]
  buffer_load_dwordx4 a[72:75], v252, s[4:7], s40 offen offset:0 sc1
  v_mfma_f32_16x16x32_bf16 v[44:47], a[212:215], a[0:3], v[44:47]
  ds_read_b64_tr_b16 a[212:213], v228 offset:12288
  ds_read_b64_tr_b16 a[214:215], v228 offset:14336
  v_mfma_f32_16x16x32_bf16 v[44:47], a[216:219], a[8:11], v[44:47]
  ds_read_b64_tr_b16 a[216:217], v229 offset:20480
  ds_read_b64_tr_b16 a[218:219], v229 offset:22528
  s_waitcnt lgkmcnt(13)
  v_mfma_f32_16x16x32_bf16 v[0:3], a[220:223], a[0:3], v[0:3]
  v_mfma_f32_16x16x32_bf16 v[0:3], a[224:227], a[8:11], v[0:3]
  buffer_load_dwordx4 a[76:79], v252, s[4:7], s40 offen offset:1024 sc1
  v_mfma_f32_16x16x32_bf16 v[16:19], a[220:223], a[4:7], v[16:19]
  ds_read_b64_tr_b16 a[220:221], v229 offset:12288
  ds_read_b64_tr_b16 a[222:223], v229 offset:14336
  v_mfma_f32_16x16x32_bf16 v[16:19], a[224:227], a[12:15], v[16:19]
  ds_read_b64_tr_b16 a[224:225], v230 offset:20480
  ds_read_b64_tr_b16 a[226:227], v230 offset:22528
  v_mfma_f32_16x16x32_bf16 v[20:23], a[228:231], a[4:7], v[20:23]
  s_mov_b32 s41, 2818048
  s_add_u32 m0, s42, 81920
  v_mfma_f32_16x16x32_bf16 v[20:23], a[232:235], a[12:15], v[20:23]
  buffer_load_dwordx4 v242, s[44:47], s41 offen offset:0 lds
  v_mfma_f32_16x16x32_bf16 v[4:7], a[228:231], a[0:3], v[4:7]
  ds_read_b64_tr_b16 a[228:229], v230 offset:12288
  ds_read_b64_tr_b16 a[230:231], v230 offset:14336
  v_mfma_f32_16x16x32_bf16 v[4:7], a[232:235], a[8:11], v[4:7]
  ds_read_b64_tr_b16 a[232:233], v231 offset:20480
  ds_read_b64_tr_b16 a[234:235], v231 offset:22528
  s_waitcnt lgkmcnt(13)
  v_mfma_f32_16x16x32_bf16 v[8:11], a[192:195], a[0:3], v[8:11]
  s_mov_b32 s41, 3080192
  s_add_u32 m0, s42, 61440
  v_mfma_f32_16x16x32_bf16 v[8:11], a[196:199], a[8:11], v[8:11]
  buffer_load_dwordx4 v242, s[44:47], s41 offen offset:0 lds
  v_mfma_f32_16x16x32_bf16 v[24:27], a[192:195], a[4:7], v[24:27]
  ds_read_b64_tr_b16 a[192:193], v231 offset:12288
  ds_read_b64_tr_b16 a[194:195], v231 offset:14336
  v_mfma_f32_16x16x32_bf16 v[24:27], a[196:199], a[12:15], v[24:27]
  ds_read_b64_tr_b16 a[196:197], v228 offset:24576
  ds_read_b64_tr_b16 a[198:199], v228 offset:26624
  v_mfma_f32_16x16x32_bf16 v[28:31], a[200:203], a[4:7], v[28:31]
  s_mov_b32 s41, 3342336
  s_add_u32 m0, s42, 90112
  v_mfma_f32_16x16x32_bf16 v[28:31], a[204:207], a[12:15], v[28:31]
  buffer_load_dwordx4 v242, s[44:47], s41 offen offset:0 lds
  v_mfma_f32_16x16x32_bf16 v[12:15], a[200:203], a[0:3], v[12:15]
  ds_read_b64_tr_b16 a[200:201], v228 offset:45056
  ds_read_b64_tr_b16 a[202:203], v228 offset:47104
  v_mfma_f32_16x16x32_bf16 v[12:15], a[204:207], a[8:11], v[12:15]
  ds_read_b64_tr_b16 a[204:205], v229 offset:24576
  ds_read_b64_tr_b16 a[206:207], v229 offset:26624
  s_waitcnt vmcnt(15) lgkmcnt(13)
  v_mfma_f32_16x16x32_bf16 v[32:35], a[208:211], a[16:19], v[32:35]
  s_mov_b32 s41, 3604480
  s_add_u32 m0, s42, 118784
  v_mfma_f32_16x16x32_bf16 v[32:35], a[212:215], a[24:27], v[32:35]
  s_barrier
  v_mfma_f32_16x16x32_bf16 v[48:51], a[208:211], a[20:23], v[48:51]
  buffer_load_dwordx4 v242, s[44:47], s41 offen offset:0 lds
  v_mfma_f32_16x16x32_bf16 v[48:51], a[212:215], a[28:31], v[48:51]
  ds_read_b64_tr_b16 a[208:209], v229 offset:45056
  ds_read_b64_tr_b16 a[210:211], v229 offset:47104
  v_mfma_f32_16x16x32_bf16 v[52:55], a[216:219], a[20:23], v[52:55]
  ds_read_b64_tr_b16 a[212:213], v230 offset:24576
  ds_read_b64_tr_b16 a[214:215], v230 offset:26624
  v_mfma_f32_16x16x32_bf16 v[52:55], a[220:223], a[28:31], v[52:55]
  s_mov_b32 s40, 24379392
  v_mfma_f32_16x16x32_bf16 v[36:39], a[216:219], a[16:19], v[36:39]
  buffer_load_dwordx4 a[80:83], v252, s[4:7], s40 offen offset:0 sc1
  v_mfma_f32_16x16x32_bf16 v[36:39], a[220:223], a[24:27], v[36:39]
  ds_read_b64_tr_b16 a[216:217], v230 offset:45056
  ds_read_b64_tr_b16 a[218:219], v230 offset:47104
  s_waitcnt lgkmcnt(13)
  v_mfma_f32_16x16x32_bf16 v[40:43], a[224:227], a[16:19], v[40:43]
  ds_read_b64_tr_b16 a[220:221], v231 offset:24576
  ds_read_b64_tr_b16 a[222:223], v231 offset:26624
  v_mfma_f32_16x16x32_bf16 v[40:43], a[228:231], a[24:27], v[40:43]
  buffer_load_dwordx4 a[84:87], v252, s[4:7], s40 offen offset:1024 sc1
  v_mfma_f32_16x16x32_bf16 v[56:59], a[224:227], a[20:23], v[56:59]
  ds_read_b64_tr_b16 a[224:225], v231 offset:45056
  ds_read_b64_tr_b16 a[226:227], v231 offset:47104
  v_mfma_f32_16x16x32_bf16 v[56:59], a[228:231], a[28:31], v[56:59]
  ds_read_b64_tr_b16 a[228:229], v228 offset:36864
  ds_read_b64_tr_b16 a[230:231], v228 offset:38912
  v_mfma_f32_16x16x32_bf16 v[60:63], a[232:235], a[20:23], v[60:63]
  s_mov_b32 s40, 24510464
  s_waitcnt lgkmcnt(13)
  v_mfma_f32_16x16x32_bf16 v[60:63], a[192:195], a[28:31], v[60:63]
  buffer_load_dwordx4 a[88:91], v252, s[4:7], s40 offen offset:0 sc1
  v_mfma_f32_16x16x32_bf16 v[44:47], a[232:235], a[16:19], v[44:47]
  ds_read_b64_tr_b16 a[232:233], v228 offset:49152
  ds_read_b64_tr_b16 a[234:235], v228 offset:51200
  v_mfma_f32_16x16x32_bf16 v[44:47], a[192:195], a[24:27], v[44:47]
  ds_read_b64_tr_b16 a[192:193], v229 offset:36864
  ds_read_b64_tr_b16 a[194:195], v229 offset:38912
  v_mfma_f32_16x16x32_bf16 v[0:3], a[196:199], a[16:19], v[0:3]
  v_mfma_f32_16x16x32_bf16 v[0:3], a[200:203], a[24:27], v[0:3]
  buffer_load_dwordx4 a[92:95], v252, s[4:7], s40 offen offset:1024 sc1
  v_mfma_f32_16x16x32_bf16 v[16:19], a[196:199], a[20:23], v[16:19]
  ds_read_b64_tr_b16 a[196:197], v229 offset:49152
  ds_read_b64_tr_b16 a[198:199], v229 offset:51200
  v_mfma_f32_16x16x32_bf16 v[16:19], a[200:203], a[28:31], v[16:19]
  ds_read_b64_tr_b16 a[200:201], v230 offset:36864
  ds_read_b64_tr_b16 a[202:203], v230 offset:38912
  s_waitcnt lgkmcnt(13)
  v_mfma_f32_16x16x32_bf16 v[20:23], a[204:207], a[20:23], v[20:23]
  s_mov_b32 s40, 24641536
  v_mfma_f32_16x16x32_bf16 v[20:23], a[208:211], a[28:31], v[20:23]
  buffer_load_dwordx4 a[96:99], v252, s[4:7], s40 offen offset:0 sc1
  v_mfma_f32_16x16x32_bf16 v[4:7], a[204:207], a[16:19], v[4:7]
  ds_read_b64_tr_b16 a[204:205], v230 offset:49152
  ds_read_b64_tr_b16 a[206:207], v230 offset:51200
  v_mfma_f32_16x16x32_bf16 v[4:7], a[208:211], a[24:27], v[4:7]
  ds_read_b64_tr_b16 a[208:209], v231 offset:36864
  ds_read_b64_tr_b16 a[210:211], v231 offset:38912
  v_mfma_f32_16x16x32_bf16 v[8:11], a[212:215], a[16:19], v[8:11]
  v_mfma_f32_16x16x32_bf16 v[8:11], a[216:219], a[24:27], v[8:11]
  buffer_load_dwordx4 a[100:103], v252, s[4:7], s40 offen offset:1024 sc1
  v_mfma_f32_16x16x32_bf16 v[24:27], a[212:215], a[20:23], v[24:27]
  ds_read_b64_tr_b16 a[212:213], v231 offset:49152
  ds_read_b64_tr_b16 a[214:215], v231 offset:51200
  v_mfma_f32_16x16x32_bf16 v[24:27], a[216:219], a[28:31], v[24:27]
  ds_read_b64_tr_b16 a[216:217], v228 offset:32768
  ds_read_b64_tr_b16 a[218:219], v228 offset:34816
  s_waitcnt lgkmcnt(13)
  v_mfma_f32_16x16x32_bf16 v[28:31], a[220:223], a[20:23], v[28:31]
  s_mov_b32 s40, 24772608
  v_mfma_f32_16x16x32_bf16 v[28:31], a[224:227], a[28:31], v[28:31]
  buffer_load_dwordx4 a[104:107], v252, s[4:7], s40 offen offset:0 sc1
  v_mfma_f32_16x16x32_bf16 v[12:15], a[220:223], a[16:19], v[12:15]
  ds_read_b64_tr_b16 a[220:221], v228 offset:40960
  ds_read_b64_tr_b16 a[222:223], v228 offset:43008
  v_mfma_f32_16x16x32_bf16 v[12:15], a[224:227], a[24:27], v[12:15]
  ds_read_b64_tr_b16 a[224:225], v229 offset:32768
  ds_read_b64_tr_b16 a[226:227], v229 offset:34816
  s_waitcnt vmcnt(19)
  v_mfma_f32_16x16x32_bf16 v[32:35], a[228:231], a[32:35], v[32:35]
  v_mfma_f32_16x16x32_bf16 v[32:35], a[232:235], a[40:43], v[32:35]
  s_barrier
  v_mfma_f32_16x16x32_bf16 v[48:51], a[228:231], a[36:39], v[48:51]
  buffer_load_dwordx4 a[108:111], v252, s[4:7], s40 offen offset:1024 sc1
  v_mfma_f32_16x16x32_bf16 v[48:51], a[232:235], a[44:47], v[48:51]
  ds_read_b64_tr_b16 a[228:229], v229 offset:40960
  ds_read_b64_tr_b16 a[230:231], v229 offset:43008
  s_waitcnt lgkmcnt(13)
  v_mfma_f32_16x16x32_bf16 v[52:55], a[192:195], a[36:39], v[52:55]
  ds_read_b64_tr_b16 a[232:233], v230 offset:32768
  ds_read_b64_tr_b16 a[234:235], v230 offset:34816
  v_mfma_f32_16x16x32_bf16 v[52:55], a[196:199], a[44:47], v[52:55]
  s_mov_b32 s41, 1900544
  s_add_u32 m0, s42, 131072
  v_mfma_f32_16x16x32_bf16 v[36:39], a[192:195], a[32:35], v[36:39]
  buffer_load_dwordx4 v253, s[44:47], s41 offen offset:0 lds
  v_mfma_f32_16x16x32_bf16 v[36:39], a[196:199], a[40:43], v[36:39]
  ds_read_b64_tr_b16 a[192:193], v230 offset:40960
  ds_read_b64_tr_b16 a[194:195], v230 offset:43008
  v_mfma_f32_16x16x32_bf16 v[40:43], a[200:203], a[32:35], v[40:43]
  ds_read_b64_tr_b16 a[196:197], v231 offset:32768
  ds_read_b64_tr_b16 a[198:199], v231 offset:34816
  s_waitcnt lgkmcnt(13)
  v_mfma_f32_16x16x32_bf16 v[40:43], a[204:207], a[40:43], v[40:43]
  s_mov_b32 s41, 2162688
  s_add_u32 m0, s42, 77824
  v_mfma_f32_16x16x32_bf16 v[56:59], a[200:203], a[36:39], v[56:59]
  buffer_load_dwordx4 v253, s[44:47], s41 offen offset:0 lds
  v_mfma_f32_16x16x32_bf16 v[56:59], a[204:207], a[44:47], v[56:59]
  ds_read_b64_tr_b16 a[200:201], v231 offset:40960
  ds_read_b64_tr_b16 a[202:203], v231 offset:43008
  v_mfma_f32_16x16x32_bf16 v[60:63], a[208:211], a[36:39], v[60:63]
  ds_read_b64_tr_b16 a[204:205], v228 offset:53248
  ds_read_b64_tr_b16 a[206:207], v228 offset:55296
  v_mfma_f32_16x16x32_bf16 v[60:63], a[212:215], a[44:47], v[60:63]
  s_mov_b32 s41, 2424832
  s_add_u32 m0, s42, 73728
  v_mfma_f32_16x16x32_bf16 v[44:47], a[208:211], a[32:35], v[44:47]
  buffer_load_dwordx4 v253, s[44:47], s41 offen offset:0 lds
  v_mfma_f32_16x16x32_bf16 v[44:47], a[212:215], a[40:43], v[44:47]
  ds_read_b64_tr_b16 a[208:209], v228 offset:57344
  ds_read_b64_tr_b16 a[210:211], v228 offset:59392
  s_waitcnt lgkmcnt(13)
  v_mfma_f32_16x16x32_bf16 v[0:3], a[216:219], a[32:35], v[0:3]
  ds_read_b64_tr_b16 a[212:213], v229 offset:53248
  ds_read_b64_tr_b16 a[214:215], v229 offset:55296
  v_mfma_f32_16x16x32_bf16 v[0:3], a[220:223], a[40:43], v[0:3]
  s_mov_b32 s41, 2686976
  s_add_u32 m0, s42, 86016
  v_mfma_f32_16x16x32_bf16 v[16:19], a[216:219], a[36:39], v[16:19]
  buffer_load_dwordx4 v253, s[44:47], s41 offen offset:0 lds
  v_mfma_f32_16x16x32_bf16 v[16:19], a[220:223], a[44:47], v[16:19]
  ds_read_b64_tr_b16 a[216:217], v229 offset:57344
  ds_read_b64_tr_b16 a[218:219], v229 offset:59392
  v_mfma_f32_16x16x32_bf16 v[20:23], a[224:227], a[36:39], v[20:23]
  ds_read_b64_tr_b16 a[220:221], v230 offset:53248
  ds_read_b64_tr_b16 a[222:223], v230 offset:55296
  s_waitcnt lgkmcnt(13)
  v_mfma_f32_16x16x32_bf16 v[20:23], a[228:231], a[44:47], v[20:23]
  s_mov_b32 s41, 2818048
  s_add_u32 m0, s42, 102400
  v_mfma_f32_16x16x32_bf16 v[4:7], a[224:227], a[32:35], v[4:7]
  buffer_load_dwordx4 v253, s[44:47], s41 offen offset:0 lds
  v_mfma_f32_16x16x32_bf16 v[4:7], a[228:231], a[40:43], v[4:7]
  ds_read_b64_tr_b16 a[224:225], v230 offset:57344
  ds_read_b64_tr_b16 a[226:227], v230 offset:59392
  v_mfma_f32_16x16x32_bf16 v[8:11], a[232:235], a[32:35], v[8:11]
  ds_read_b64_tr_b16 a[228:229], v231 offset:53248
  ds_read_b64_tr_b16 a[230:231], v231 offset:55296
  v_mfma_f32_16x16x32_bf16 v[8:11], a[192:195], a[40:43], v[8:11]
  s_mov_b32 s41, 3080192
  s_add_u32 m0, s42, 98304
  v_mfma_f32_16x16x32_bf16 v[24:27], a[232:235], a[36:39], v[24:27]
  buffer_load_dwordx4 v253, s[44:47], s41 offen offset:0 lds
  v_mfma_f32_16x16x32_bf16 v[24:27], a[192:195], a[44:47], v[24:27]
  ds_read_b64_tr_b16 a[232:233], v231 offset:57344
  ds_read_b64_tr_b16 a[234:235], v231 offset:59392
  s_waitcnt lgkmcnt(13)
  v_mfma_f32_16x16x32_bf16 v[28:31], a[196:199], a[36:39], v[28:31]
  ds_read_b64_tr_b16 a[192:193], v232 offset:0
  ds_read_b64_tr_b16 a[194:195], v232 offset:2048
  v_mfma_f32_16x16x32_bf16 v[28:31], a[200:203], a[44:47], v[28:31]
  s_mov_b32 s40, 24903680
  v_mfma_f32_16x16x32_bf16 v[12:15], a[196:199], a[32:35], v[12:15]
  buffer_load_dwordx4 a[112:115], v252, s[4:7], s40 offen offset:0 sc1
  v_mfma_f32_16x16x32_bf16 v[12:15], a[200:203], a[40:43], v[12:15]
  ds_read_b64_tr_b16 a[196:197], v232 offset:28672
  ds_read_b64_tr_b16 a[198:199], v232 offset:30720
  s_waitcnt vmcnt(23)
  v_mfma_f32_16x16x32_bf16 v[32:35], a[204:207], a[48:51], v[32:35]
  ds_read_b64_tr_b16 a[200:201], v233 offset:0
  ds_read_b64_tr_b16 a[202:203], v233 offset:2048
  s_waitcnt lgkmcnt(13)
  v_mfma_f32_16x16x32_bf16 v[32:35], a[208:211], a[56:59], v[32:35]
  s_barrier
  v_mfma_f32_16x16x32_bf16 v[48:51], a[204:207], a[52:55], v[48:51]
  buffer_load_dwordx4 a[116:119], v252, s[4:7], s40 offen offset:1024 sc1
  v_mfma_f32_16x16x32_bf16 v[48:51], a[208:211], a[60:63], v[48:51]
  ds_read_b64_tr_b16 a[204:205], v233 offset:28672
  ds_read_b64_tr_b16 a[206:207], v233 offset:30720
  v_mfma_f32_16x16x32_bf16 v[52:55], a[212:215], a[52:55], v[52:55]
  ds_read_b64_tr_b16 a[208:209], v234 offset:0
  ds_read_b64_tr_b16 a[210:211], v234 offset:2048
  v_mfma_f32_16x16x32_bf16 v[52:55], a[216:219], a[60:63], v[52:55]
  s_mov_b32 s40, 25034752
  v_mfma_f32_16x16x32_bf16 v[36:39], a[212:215], a[48:51], v[36:39]
  buffer_load_dwordx4 a[120:123], v252, s[4:7], s40 offen offset:0 sc1
  v_mfma_f32_16x16x32_bf16 v[36:39], a[216:219], a[56:59], v[36:39]
  ds_read_b64_tr_b16 a[212:213], v234 offset:28672
  ds_read_b64_tr_b16 a[214:215], v234 offset:30720
  s_waitcnt lgkmcnt(13)
  v_mfma_f32_16x16x32_bf16 v[40:43], a[220:223], a[48:51], v[40:43]
  ds_read_b64_tr_b16 a[216:217], v235 offset:0
  ds_read_b64_tr_b16 a[218:219], v235 offset:2048
  v_mfma_f32_16x16x32_bf16 v[40:43], a[224:227], a[56:59], v[40:43]
  buffer_load_dwordx4 a[124:127], v252, s[4:7], s40 offen offset:1024 sc1
  v_mfma_f32_16x16x32_bf16 v[56:59], a[220:223], a[52:55], v[56:59]
  ds_read_b64_tr_b16 a[220:221], v235 offset:28672
  ds_read_b64_tr_b16 a[222:223], v235 offset:30720
  v_mfma_f32_16x16x32_bf16 v[56:59], a[224:227], a[60:63], v[56:59]
  ds_read_b64_tr_b16 a[224:225], v232 offset:40960
  ds_read_b64_tr_b16 a[226:227], v232 offset:43008
  v_mfma_f32_16x16x32_bf16 v[60:63], a[228:231], a[52:55], v[60:63]
  s_mov_b32 s41, 3342336
  s_add_u32 m0, s42, 110592
  s_waitcnt lgkmcnt(13)
  v_mfma_f32_16x16x32_bf16 v[60:63], a[232:235], a[60:63], v[60:63]
  buffer_load_dwordx4 v253, s[44:47], s41 offen offset:0 lds
  v_mfma_f32_16x16x32_bf16 v[44:47], a[228:231], a[48:51], v[44:47]
  ds_read_b64_tr_b16 a[228:229], v232 offset:49152
  ds_read_b64_tr_b16 a[230:231], v232 offset:51200
  v_mfma_f32_16x16x32_bf16 v[44:47], a[232:235], a[56:59], v[44:47]
  ds_read_b64_tr_b16 a[232:233], v233 offset:40960
  ds_read_b64_tr_b16 a[234:235], v233 offset:43008
  v_mfma_f32_16x16x32_bf16 v[0:3], a[192:195], a[48:51], v[0:3]
  s_mov_b32 s41, 3604480
  s_add_u32 m0, s42, 126976
  v_mfma_f32_16x16x32_bf16 v[0:3], a[196:199], a[56:59], v[0:3]
  buffer_load_dwordx4 v253, s[44:47], s41 offen offset:0 lds
  v_mfma_f32_16x16x32_bf16 v[16:19], a[192:195], a[52:55], v[16:19]
  ds_read_b64_tr_b16 a[192:193], v233 offset:49152
  ds_read_b64_tr_b16 a[194:195], v233 offset:51200
  v_mfma_f32_16x16x32_bf16 v[16:19], a[196:199], a[60:63], v[16:19]
  ds_read_b64_tr_b16 a[196:197], v234 offset:40960
  ds_read_b64_tr_b16 a[198:199], v234 offset:43008
  s_waitcnt lgkmcnt(13)
  v_mfma_f32_16x16x32_bf16 v[20:23], a[200:203], a[52:55], v[20:23]
  v_mfma_f32_16x16x32_bf16 v[20:23], a[204:207], a[60:63], v[20:23]
  v_mfma_f32_16x16x32_bf16 v[4:7], a[200:203], a[48:51], v[4:7]
  ds_read_b64_tr_b16 a[200:201], v234 offset:49152
  ds_read_b64_tr_b16 a[202:203], v234 offset:51200
  v_mfma_f32_16x16x32_bf16 v[4:7], a[204:207], a[56:59], v[4:7]
  ds_read_b64_tr_b16 a[204:205], v235 offset:40960
  ds_read_b64_tr_b16 a[206:207], v235 offset:43008
  v_mfma_f32_16x16x32_bf16 v[8:11], a[208:211], a[48:51], v[8:11]
  v_mfma_f32_16x16x32_bf16 v[8:11], a[212:215], a[56:59], v[8:11]
  v_mfma_f32_16x16x32_bf16 v[24:27], a[208:211], a[52:55], v[24:27]
  ds_read_b64_tr_b16 a[208:209], v235 offset:49152
  ds_read_b64_tr_b16 a[210:211], v235 offset:51200
  v_mfma_f32_16x16x32_bf16 v[24:27], a[212:215], a[60:63], v[24:27]
  ds_read_b64_tr_b16 a[212:213], v236 offset:12288
  ds_read_b64_tr_b16 a[214:215], v236 offset:14336
  s_waitcnt lgkmcnt(13)
  v_mfma_f32_16x16x32_bf16 v[28:31], a[216:219], a[52:55], v[28:31]
  v_mfma_f32_16x16x32_bf16 v[28:31], a[220:223], a[60:63], v[28:31]
  v_mfma_f32_16x16x32_bf16 v[12:15], a[216:219], a[48:51], v[12:15]
  ds_read_b64_tr_b16 a[216:217], v232 offset:4096
  ds_read_b64_tr_b16 a[218:219], v232 offset:6144
  v_mfma_f32_16x16x32_bf16 v[12:15], a[220:223], a[56:59], v[12:15]
  ds_read_b64_tr_b16 a[220:221], v237 offset:12288
  ds_read_b64_tr_b16 a[222:223], v237 offset:14336
  s_waitcnt vmcnt(24)
  v_mfma_f32_16x16x32_bf16 v[32:35], a[224:227], a[64:67], v[32:35]
  v_mfma_f32_16x16x32_bf16 v[32:35], a[228:231], a[72:75], v[32:35]
  s_waitcnt vmcnt(20)
  s_barrier
  v_mfma_f32_16x16x32_bf16 v[48:51], a[224:227], a[68:71], v[48:51]
  ds_read_b64_tr_b16 a[224:225], v233 offset:4096
  ds_read_b64_tr_b16 a[226:227], v233 offset:6144
  v_mfma_f32_16x16x32_bf16 v[48:51], a[228:231], a[76:79], v[48:51]
  ds_read_b64_tr_b16 a[228:229], v238 offset:12288
  ds_read_b64_tr_b16 a[230:231], v238 offset:14336
  s_waitcnt lgkmcnt(13)
  v_mfma_f32_16x16x32_bf16 v[52:55], a[232:235], a[68:71], v[52:55]
  v_mfma_f32_16x16x32_bf16 v[52:55], a[192:195], a[76:79], v[52:55]
  v_mfma_f32_16x16x32_bf16 v[36:39], a[232:235], a[64:67], v[36:39]
  ds_read_b64_tr_b16 a[232:233], v234 offset:4096
  ds_read_b64_tr_b16 a[234:235], v234 offset:6144
  v_mfma_f32_16x16x32_bf16 v[36:39], a[192:195], a[72:75], v[36:39]
  ds_read_b64_tr_b16 a[192:193], v239 offset:12288
  ds_read_b64_tr_b16 a[194:195], v239 offset:14336
  v_mfma_f32_16x16x32_bf16 v[40:43], a[196:199], a[64:67], v[40:43]
  v_mfma_f32_16x16x32_bf16 v[40:43], a[200:203], a[72:75], v[40:43]
  v_mfma_f32_16x16x32_bf16 v[56:59], a[196:199], a[68:71], v[56:59]
  ds_read_b64_tr_b16 a[196:197], v235 offset:4096
  ds_read_b64_tr_b16 a[198:199], v235 offset:6144
  v_mfma_f32_16x16x32_bf16 v[56:59], a[200:203], a[76:79], v[56:59]
  ds_read_b64_tr_b16 a[200:201], v232 offset:16384
  ds_read_b64_tr_b16 a[202:203], v232 offset:18432
  s_waitcnt lgkmcnt(13)
  v_mfma_f32_16x16x32_bf16 v[60:63], a[204:207], a[68:71], v[60:63]
  v_mfma_f32_16x16x32_bf16 v[60:63], a[208:211], a[76:79], v[60:63]
  v_mfma_f32_16x16x32_bf16 v[44:47], a[204:207], a[64:67], v[44:47]
  ds_read_b64_tr_b16 a[204:205], v228 offset:61440
  ds_read_b64_tr_b16 a[206:207], v228 offset:63488
  v_mfma_f32_16x16x32_bf16 v[44:47], a[208:211], a[72:75], v[44:47]
  ds_read_b64_tr_b16 a[208:209], v233 offset:16384
  ds_read_b64_tr_b16 a[210:211], v233 offset:18432
  s_waitcnt vmcnt(16)
  v_mfma_f32_16x16x32_bf16 v[32:35], a[212:215], a[80:83], v[32:35]
  v_mfma_f32_16x16x32_bf16 v[32:35], a[216:219], a[88:91], v[32:35]
  v_mfma_f32_16x16x32_bf16 v[48:51], a[212:215], a[84:87], v[48:51]
  ds_read_b64_tr_b16 a[212:213], v229 offset:61440
  ds_read_b64_tr_b16 a[214:215], v229 offset:63488
  v_mfma_f32_16x16x32_bf16 v[48:51], a[216:219], a[92:95], v[48:51]
  ds_read_b64_tr_b16 a[216:217], v234 offset:16384
  ds_read_b64_tr_b16 a[218:219], v234 offset:18432
  s_waitcnt lgkmcnt(13)
  v_mfma_f32_16x16x32_bf16 v[52:55], a[220:223], a[84:87], v[52:55]
  v_mfma_f32_16x16x32_bf16 v[52:55], a[224:227], a[92:95], v[52:55]
  v_mfma_f32_16x16x32_bf16 v[36:39], a[220:223], a[80:83], v[36:39]
  ds_read_b64_tr_b16 a[220:221], v230 offset:61440
  ds_read_b64_tr_b16 a[222:223], v230 offset:63488
  v_mfma_f32_16x16x32_bf16 v[36:39], a[224:227], a[88:91], v[36:39]
  ds_read_b64_tr_b16 a[224:225], v235 offset:16384
  ds_read_b64_tr_b16 a[226:227], v235 offset:18432
  v_mfma_f32_16x16x32_bf16 v[40:43], a[228:231], a[80:83], v[40:43]
  v_mfma_f32_16x16x32_bf16 v[40:43], a[232:235], a[88:91], v[40:43]
  v_mfma_f32_16x16x32_bf16 v[56:59], a[228:231], a[84:87], v[56:59]
  ds_read_b64_tr_b16 a[228:229], v231 offset:61440
  ds_read_b64_tr_b16 a[230:231], v231 offset:63488
  v_mfma_f32_16x16x32_bf16 v[56:59], a[232:235], a[92:95], v[56:59]
  ds_read_b64_tr_b16 a[232:233], v232 offset:24576
  ds_read_b64_tr_b16 a[234:235], v232 offset:26624
  s_waitcnt lgkmcnt(13)
  v_mfma_f32_16x16x32_bf16 v[60:63], a[192:195], a[84:87], v[60:63]
  v_mfma_f32_16x16x32_bf16 v[60:63], a[196:199], a[92:95], v[60:63]
  v_mfma_f32_16x16x32_bf16 v[44:47], a[192:195], a[80:83], v[44:47]
  ds_read_b64_tr_b16 a[192:193], v232 offset:53248
  ds_read_b64_tr_b16 a[194:195], v232 offset:55296
  v_mfma_f32_16x16x32_bf16 v[44:47], a[196:199], a[88:91], v[44:47]
  ds_read_b64_tr_b16 a[196:197], v233 offset:24576
  ds_read_b64_tr_b16 a[198:199], v233 offset:26624
  s_waitcnt vmcnt(12)
  v_mfma_f32_16x16x32_bf16 v[32:35], a[200:203], a[96:99], v[32:35]
  v_mfma_f32_16x16x32_bf16 v[32:35], a[204:207], a[104:107], v[32:35]
  s_waitcnt vmcnt(6)
  s_barrier
  v_mfma_f32_16x16x32_bf16 v[48:51], a[200:203], a[100:103], v[48:51]
  ds_read_b64_tr_b16 a[200:201], v233 offset:53248
  ds_read_b64_tr_b16 a[202:203], v233 offset:55296
  v_mfma_f32_16x16x32_bf16 v[48:51], a[204:207], a[108:111], v[48:51]
  ds_read_b64_tr_b16 a[204:205], v234 offset:24576
  ds_read_b64_tr_b16 a[206:207], v234 offset:26624
  s_waitcnt lgkmcnt(13)
  v_mfma_f32_16x16x32_bf16 v[52:55], a[208:211], a[100:103], v[52:55]
  v_mfma_f32_16x16x32_bf16 v[52:55], a[212:215], a[108:111], v[52:55]
  v_mfma_f32_16x16x32_bf16 v[36:39], a[208:211], a[96:99], v[36:39]
  ds_read_b64_tr_b16 a[208:209], v234 offset:53248
  ds_read_b64_tr_b16 a[210:211], v234 offset:55296
  v_mfma_f32_16x16x32_bf16 v[36:39], a[212:215], a[104:107], v[36:39]
  ds_read_b64_tr_b16 a[212:213], v235 offset:24576
  ds_read_b64_tr_b16 a[214:215], v235 offset:26624
  v_mfma_f32_16x16x32_bf16 v[40:43], a[216:219], a[96:99], v[40:43]
  v_mfma_f32_16x16x32_bf16 v[40:43], a[220:223], a[104:107], v[40:43]
  v_mfma_f32_16x16x32_bf16 v[56:59], a[216:219], a[100:103], v[56:59]
  ds_read_b64_tr_b16 a[216:217], v235 offset:53248
  ds_read_b64_tr_b16 a[218:219], v235 offset:55296
  v_mfma_f32_16x16x32_bf16 v[56:59], a[220:223], a[108:111], v[56:59]
  ds_read_b64_tr_b16 a[220:221], v236 offset:0
  ds_read_b64_tr_b16 a[222:223], v236 offset:2048
  s_waitcnt lgkmcnt(13)
  v_mfma_f32_16x16x32_bf16 v[60:63], a[224:227], a[100:103], v[60:63]
  v_mfma_f32_16x16x32_bf16 v[60:63], a[228:231], a[108:111], v[60:63]
  v_mfma_f32_16x16x32_bf16 v[44:47], a[224:227], a[96:99], v[44:47]
  ds_read_b64_tr_b16 a[224:225], v232 offset:12288
  ds_read_b64_tr_b16 a[226:227], v232 offset:14336
  v_mfma_f32_16x16x32_bf16 v[44:47], a[228:231], a[104:107], v[44:47]
  ds_read_b64_tr_b16 a[228:229], v237 offset:0
  ds_read_b64_tr_b16 a[230:231], v237 offset:2048
  s_waitcnt vmcnt(2)
  v_mfma_f32_16x16x32_bf16 v[32:35], a[232:235], a[112:115], v[32:35]
  v_mfma_f32_16x16x32_bf16 v[32:35], a[192:195], a[120:123], v[32:35]
  v_mfma_f32_16x16x32_bf16 v[48:51], a[232:235], a[116:119], v[48:51]
  ds_read_b64_tr_b16 a[232:233], v233 offset:12288
  ds_read_b64_tr_b16 a[234:235], v233 offset:14336
  v_mfma_f32_16x16x32_bf16 v[48:51], a[192:195], a[124:127], v[48:51]
  ds_read_b64_tr_b16 a[192:193], v232 offset:8192
  ds_read_b64_tr_b16 a[194:195], v232 offset:10240
  s_waitcnt lgkmcnt(13)
  v_mfma_f32_16x16x32_bf16 v[52:55], a[196:199], a[116:119], v[52:55]
  v_mfma_f32_16x16x32_bf16 v[52:55], a[200:203], a[124:127], v[52:55]
  v_mfma_f32_16x16x32_bf16 v[36:39], a[196:199], a[112:115], v[36:39]
  ds_read_b64_tr_b16 a[196:197], v232 offset:20480
  ds_read_b64_tr_b16 a[198:199], v232 offset:22528
  v_mfma_f32_16x16x32_bf16 v[36:39], a[200:203], a[120:123], v[36:39]
  ds_read_b64_tr_b16 a[200:201], v233 offset:8192
  ds_read_b64_tr_b16 a[202:203], v233 offset:10240
  v_cvt_pk_bf16_f32 v64, v32, v33
  v_cvt_pk_bf16_f32 v65, v34, v35
  v_mfma_f32_16x16x32_bf16 v[40:43], a[204:207], a[112:115], v[40:43]
  v_mfma_f32_16x16x32_bf16 v[40:43], a[208:211], a[120:123], v[40:43]
  v_mfma_f32_16x16x32_bf16 v[56:59], a[204:207], a[116:119], v[56:59]
  ds_read_b64_tr_b16 a[204:205], v233 offset:20480
  ds_read_b64_tr_b16 a[206:207], v233 offset:22528
  v_cvt_pk_bf16_f32 v66, v36, v37
  v_cvt_pk_bf16_f32 v67, v38, v39
  buffer_store_dwordx4 v[64:67], v251, s[4:7], s97 offen offset:0 sc1
  v_cvt_pk_bf16_f32 v72, v48, v49
  v_mfma_f32_16x16x32_bf16 v[56:59], a[208:211], a[124:127], v[56:59]
  ds_read_b64_tr_b16 a[208:209], v232 offset:36864
  ds_read_b64_tr_b16 a[210:211], v232 offset:38912
  v_cvt_pk_bf16_f32 v73, v50, v51
  v_cvt_pk_bf16_f32 v74, v52, v53
  v_cvt_pk_bf16_f32 v75, v54, v55
  s_waitcnt lgkmcnt(13)
  v_mfma_f32_16x16x32_bf16 v[60:63], a[212:215], a[116:119], v[60:63]
  buffer_store_dwordx4 v[72:75], v251, s[4:7], s97 offen offset:2048 sc1
  v_mfma_f32_16x16x32_bf16 v[60:63], a[216:219], a[124:127], v[60:63]
  v_mfma_f32_16x16x32_bf16 v[44:47], a[212:215], a[112:115], v[44:47]
  ds_read_b64_tr_b16 a[212:213], v232 offset:32768
  ds_read_b64_tr_b16 a[214:215], v232 offset:34816
  v_mfma_f32_16x16x32_bf16 v[44:47], a[216:219], a[120:123], v[44:47]
  ds_read_b64_tr_b16 a[216:217], v233 offset:36864
  ds_read_b64_tr_b16 a[218:219], v233 offset:38912
  v_cvt_pk_bf16_f32 v68, v40, v41
  v_cvt_pk_bf16_f32 v69, v42, v43
  v_mfma_f32_16x16x32_bf16 v[0:3], a[220:223], a[64:67], v[0:3]
  v_mfma_f32_16x16x32_bf16 v[0:3], a[224:227], a[72:75], v[0:3]
L_wk1_12:
  s_cbranch_vccnz L_wk1_end
  s_waitcnt vmcnt(2)
  s_barrier
  v_cvt_pk_bf16_f32 v70, v44, v45
  v_cvt_pk_bf16_f32 v71, v46, v47
  buffer_store_dwordx4 v[68:71], v251, s[4:7], s97 offen offset:1024 sc1
  v_cvt_pk_bf16_f32 v76, v56, v57
  v_mfma_f32_16x16x32_bf16 v[16:19], a[220:223], a[68:71], v[16:19]
  ds_read_b64_tr_b16 a[220:221], v233 offset:32768
  ds_read_b64_tr_b16 a[222:223], v233 offset:34816
  v_cvt_pk_bf16_f32 v77, v58, v59
  v_cvt_pk_bf16_f32 v78, v60, v61
  v_cvt_pk_bf16_f32 v79, v62, v63
  v_mfma_f32_16x16x32_bf16 v[16:19], a[224:227], a[76:79], v[16:19]
  ds_read_b64_tr_b16 a[224:225], v232 offset:45056
  ds_read_b64_tr_b16 a[226:227], v232 offset:47104
  buffer_store_dwordx4 v[76:79], v251, s[4:7], s97 offen offset:3072 sc1
  v_accvgpr_read_b32 v80, a236
  s_waitcnt lgkmcnt(13)
  v_mfma_f32_16x16x32_bf16 v[20:23], a[228:231], a[68:71], v[20:23]
  v_accvgpr_read_b32 v81, a237
  v_accvgpr_read_b32 v82, a238
  v_accvgpr_read_b32 v83, a239
  v_mfma_f32_16x16x32_bf16 v[20:23], a[232:235], a[76:79], v[20:23]
  v_accvgpr_read_b32 v84, a240
  v_accvgpr_read_b32 v85, a241
  v_accvgpr_read_b32 v86, a242
  v_mfma_f32_16x16x32_bf16 v[4:7], a[228:231], a[64:67], v[4:7]
  ds_read_b64_tr_b16 a[228:229], v232 offset:61440
  ds_read_b64_tr_b16 a[230:231], v232 offset:63488
  v_accvgpr_read_b32 v87, a243
  v_accvgpr_read_b32 v88, a244
  v_accvgpr_read_b32 v89, a245
  v_mfma_f32_16x16x32_bf16 v[4:7], a[232:235], a[72:75], v[4:7]
  ds_read_b64_tr_b16 a[232:233], v233 offset:45056
  ds_read_b64_tr_b16 a[234:235], v233 offset:47104
  v_accvgpr_read_b32 v90, a246
  v_accvgpr_read_b32 v91, a247
  v_accvgpr_read_b32 v92, a248
  v_mfma_f32_16x16x32_bf16 v[0:3], a[192:195], a[80:83], v[0:3]
  v_accvgpr_read_b32 v93, a249
  v_accvgpr_read_b32 v94, a250
  v_accvgpr_read_b32 v95, a251
  v_mfma_f32_16x16x32_bf16 v[0:3], a[196:199], a[88:91], v[0:3]
  v_lshlrev_b32 v96, 16, v80
  v_and_b32 v97, 0xffff0000, v80
  v_lshlrev_b32 v98, 16, v81
  v_mfma_f32_16x16x32_bf16 v[16:19], a[192:195], a[84:87], v[16:19]
  ds_read_b64_tr_b16 a[192:193], v233 offset:61440
  ds_read_b64_tr_b16 a[194:195], v233 offset:63488
  v_and_b32 v99, 0xffff0000, v81
  v_lshlrev_b32 v100, 16, v82
  v_and_b32 v101, 0xffff0000, v82
  v_mfma_f32_16x16x32_bf16 v[16:19], a[196:199], a[92:95], v[16:19]
  ds_read_b64_tr_b16 a[196:197], v238 offset:0
  ds_read_b64_tr_b16 a[198:199], v238 offset:2048
  v_lshlrev_b32 v102, 16, v83
  v_and_b32 v103, 0xffff0000, v83
  v_lshlrev_b32 v104, 16, v84
  s_waitcnt lgkmcnt(13)
  v_mfma_f32_16x16x32_bf16 v[20:23], a[200:203], a[84:87], v[20:23]
  v_and_b32 v105, 0xffff0000, v84
  v_lshlrev_b32 v106, 16, v85
  v_and_b32 v107, 0xffff0000, v85
  v_mfma_f32_16x16x32_bf16 v[20:23], a[204:207], a[92:95], v[20:23]
  v_lshlrev_b32 v108, 16, v86
  v_and_b32 v109, 0xffff0000, v86
  v_lshlrev_b32 v110, 16, v87
  v_mfma_f32_16x16x32_bf16 v[4:7], a[200:203], a[80:83], v[4:7]
  ds_read_b64_tr_b16 a[200:201], v234 offset:12288
  ds_read_b64_tr_b16 a[202:203], v234 offset:14336
  v_and_b32 v111, 0xffff0000, v87
  v_lshlrev_b32 v112, 16, v88
  v_and_b32 v113, 0xffff0000, v88
  v_mfma_f32_16x16x32_bf16 v[4:7], a[204:207], a[88:91], v[4:7]
  ds_read_b64_tr_b16 a[204:205], v239 offset:0
  ds_read_b64_tr_b16 a[206:207], v239 offset:2048
  v_lshlrev_b32 v114, 16, v89
  v_and_b32 v115, 0xffff0000, v89
  v_lshlrev_b32 v116, 16, v90
  v_mfma_f32_16x16x32_bf16 v[0:3], a[208:211], a[96:99], v[0:3]
  v_and_b32 v117, 0xffff0000, v90
  v_lshlrev_b32 v118, 16, v91
  v_and_b32 v119, 0xffff0000, v91
  v_mfma_f32_16x16x32_bf16 v[0:3], a[212:215], a[104:107], v[0:3]
  v_lshlrev_b32 v120, 16, v92
  v_and_b32 v121, 0xffff0000, v92
  v_lshlrev_b32 v122, 16, v93
  v_mfma_f32_16x16x32_bf16 v[16:19], a[208:211], a[100:103], v[16:19]
  ds_read_b64_tr_b16 a[208:209], v235 offset:12288
  ds_read_b64_tr_b16 a[210:211], v235 offset:14336
  v_and_b32 v123, 0xffff0000, v93
  v_lshlrev_b32 v124, 16, v94
  v_and_b32 v125, 0xffff0000, v94
  v_mfma_f32_16x16x32_bf16 v[16:19], a[212:215], a[108:111], v[16:19]
  ds_read_b64_tr_b16 a[212:213], v234 offset:8192
  ds_read_b64_tr_b16 a[214:215], v234 offset:10240
  v_lshlrev_b32 v126, 16, v95
  v_and_b32 v127, 0xffff0000, v95
  ds_read_b128 v[128:131], v250 offset:11008
  s_waitcnt lgkmcnt(13)
  v_mfma_f32_16x16x32_bf16 v[20:23], a[216:219], a[100:103], v[20:23]
  ds_read_b128 v[132:135], v250 offset:11072
  ds_read_b128 v[136:139], v250 offset:11136
  ds_read_b128 v[140:143], v250 offset:11200
  v_mfma_f32_16x16x32_bf16 v[20:23], a[220:223], a[108:111], v[20:23]
  v_mfma_f32_16x16x32_bf16 v[4:7], a[216:219], a[96:99], v[4:7]
  ds_read_b64_tr_b16 a[216:217], v234 offset:20480
  ds_read_b64_tr_b16 a[218:219], v234 offset:22528
  v_mfma_f32_16x16x32_bf16 v[4:7], a[220:223], a[104:107], v[4:7]
  ds_read_b64_tr_b16 a[220:221], v235 offset:8192
  ds_read_b64_tr_b16 a[222:223], v235 offset:10240
  v_mfma_f32_16x16x32_bf16 v[0:3], a[224:227], a[112:115], v[0:3]
  v_mfma_f32_16x16x32_bf16 v[0:3], a[228:231], a[120:123], v[0:3]
  v_mfma_f32_16x16x32_bf16 v[16:19], a[224:227], a[116:119], v[16:19]
  ds_read_b64_tr_b16 a[224:225], v235 offset:20480
  ds_read_b64_tr_b16 a[226:227], v235 offset:22528
  v_mfma_f32_16x16x32_bf16 v[16:19], a[228:231], a[124:127], v[16:19]
  ds_read_b64_tr_b16 a[228:229], v234 offset:36864
  ds_read_b64_tr_b16 a[230:231], v234 offset:38912
  buffer_load_dwordx4 v[64:67], v251, s[4:7], s96 offen offset:0 sc1
  v_mfma_f32_16x16x32_bf16 v[20:23], a[232:235], a[116:119], v[20:23]
  buffer_load_dwordx4 v[68:71], v251, s[4:7], s96 offen offset:1024 sc1
  s_waitcnt lgkmcnt(13)
  v_mfma_f32_16x16x32_bf16 v[20:23], a[192:195], a[124:127], v[20:23]
  buffer_load_dwordx4 v[72:75], v251, s[4:7], s96 offen offset:2048 sc1
  buffer_load_dwordx4 v[76:79], v251, s[4:7], s96 offen offset:3072 sc1
  v_mfma_f32_16x16x32_bf16 v[4:7], a[232:235], a[112:115], v[4:7]
  ds_read_b64_tr_b16 a[232:233], v234 offset:32768
  ds_read_b64_tr_b16 a[234:235], v234 offset:34816
  v_mfma_f32_16x16x32_bf16 v[4:7], a[192:195], a[120:123], v[4:7]
  ds_read_b64_tr_b16 a[192:193], v235 offset:36864
  ds_read_b64_tr_b16 a[194:195], v235 offset:38912
  v_mfma_f32_16x16x32_bf16 v[8:11], a[196:199], a[64:67], v[8:11]
  v_mfma_f32_16x16x32_bf16 v[8:11], a[200:203], a[72:75], v[8:11]
  s_barrier
  v_mfma_f32_16x16x32_bf16 v[24:27], a[196:199], a[68:71], v[24:27]
  ds_read_b64_tr_b16 a[196:197], v235 offset:32768
  ds_read_b64_tr_b16 a[198:199], v235 offset:34816
  v_mfma_f32_16x16x32_bf16 v[24:27], a[200:203], a[76:79], v[24:27]
  ds_read_b64_tr_b16 a[200:201], v234 offset:45056
  ds_read_b64_tr_b16 a[202:203], v234 offset:47104
  v_mfma_f32_16x16x32_bf16 v[28:31], a[204:207], a[68:71], v[28:31]
  v_mfma_f32_16x16x32_bf16 v[28:31], a[208:211], a[76:79], v[28:31]
  v_mfma_f32_16x16x32_bf16 v[12:15], a[204:207], a[64:67], v[12:15]
  ds_read_b64_tr_b16 a[204:205], v234 offset:61440
  ds_read_b64_tr_b16 a[206:207], v234 offset:63488
  v_mfma_f32_16x16x32_bf16 v[12:15], a[208:211], a[72:75], v[12:15]
  ds_read_b64_tr_b16 a[208:209], v235 offset:45056
  ds_read_b64_tr_b16 a[210:211], v235 offset:47104
  s_waitcnt lgkmcnt(13)
  v_mfma_f32_16x16x32_bf16 v[8:11], a[212:215], a[80:83], v[8:11]
  v_mfma_f32_16x16x32_bf16 v[8:11], a[216:219], a[88:91], v[8:11]
  v_mfma_f32_16x16x32_bf16 v[24:27], a[212:215], a[84:87], v[24:27]
  ds_read_b64_tr_b16 a[212:213], v235 offset:61440
  ds_read_b64_tr_b16 a[214:215], v235 offset:63488
  v_mfma_f32_16x16x32_bf16 v[24:27], a[216:219], a[92:95], v[24:27]
  v_mfma_f32_16x16x32_bf16 v[28:31], a[220:223], a[84:87], v[28:31]
  v_mfma_f32_16x16x32_bf16 v[28:31], a[224:227], a[92:95], v[28:31]
  v_mfma_f32_16x16x32_bf16 v[12:15], a[220:223], a[80:83], v[12:15]
  v_mfma_f32_16x16x32_bf16 v[12:15], a[224:227], a[88:91], v[12:15]
  s_waitcnt lgkmcnt(13)
  v_mfma_f32_16x16x32_bf16 v[8:11], a[228:231], a[96:99], v[8:11]
  s_waitcnt lgkmcnt(12)
  v_mfma_f32_16x16x32_bf16 v[8:11], a[232:235], a[104:107], v[8:11]
  v_mfma_f32_16x16x32_bf16 v[24:27], a[228:231], a[100:103], v[24:27]
  v_mfma_f32_16x16x32_bf16 v[24:27], a[232:235], a[108:111], v[24:27]
  s_waitcnt lgkmcnt(10)
  v_mfma_f32_16x16x32_bf16 v[28:31], a[192:195], a[100:103], v[28:31]
  s_waitcnt lgkmcnt(8)
  v_mfma_f32_16x16x32_bf16 v[28:31], a[196:199], a[108:111], v[28:31]
  v_mfma_f32_16x16x32_bf16 v[12:15], a[192:195], a[96:99], v[12:15]
  v_mfma_f32_16x16x32_bf16 v[12:15], a[196:199], a[104:107], v[12:15]
  s_waitcnt lgkmcnt(6)
  v_mfma_f32_16x16x32_bf16 v[8:11], a[200:203], a[112:115], v[8:11]
  s_waitcnt lgkmcnt(4)
  v_mfma_f32_16x16x32_bf16 v[8:11], a[204:207], a[120:123], v[8:11]
  v_mfma_f32_16x16x32_bf16 v[24:27], a[200:203], a[116:119], v[24:27]
  v_mfma_f32_16x16x32_bf16 v[24:27], a[204:207], a[124:127], v[24:27]
  s_waitcnt vmcnt(0)
  v_max3_u32 v244, v64, v65, v66
  v_max3_u32 v244, v244, v67, v68
  v_max3_u32 v244, v244, v69, v70
  v_max3_u32 v244, v244, v71, v72
  s_waitcnt lgkmcnt(2)
  v_mfma_f32_16x16x32_bf16 v[28:31], a[208:211], a[116:119], v[28:31]
  v_max3_u32 v244, v244, v73, v74
  v_max3_u32 v244, v244, v75, v76
  v_max3_u32 v244, v244, v77, v78
  s_waitcnt lgkmcnt(0)
  v_mfma_f32_16x16x32_bf16 v[28:31], a[212:215], a[124:127], v[28:31]
  v_max_u32 v244, v244, v79
  v_cmp_eq_u32 s[68:69], -1, v244
  v_mfma_f32_16x16x32_bf16 v[12:15], a[208:211], a[112:115], v[12:15]
  v_mfma_f32_16x16x32_bf16 v[12:15], a[212:215], a[120:123], v[12:15]
  s_cmp_lg_u64 s[68:69], 0
  s_cbranch_scc1 L_slow_39
L_back_40:
  v_lshlrev_b32 v144, 16, v64
  v_and_b32 v64, 0xffff0000, v64
  v_fmac_f32 v96, v144, v128
  v_fmac_f32 v97, v64, v129
  v_lshlrev_b32 v145, 16, v65
  v_and_b32 v65, 0xffff0000, v65
  v_fmac_f32 v98, v145, v130
  v_fmac_f32 v99, v65, v131
  v_lshlrev_b32 v146, 16, v66
  v_and_b32 v66, 0xffff0000, v66
  v_fmac_f32 v100, v146, v132
  v_fmac_f32 v101, v66, v133
  v_lshlrev_b32 v147, 16, v67
  v_and_b32 v67, 0xffff0000, v67
  v_fmac_f32 v102, v147, v134
  v_fmac_f32 v103, v67, v135
  v_lshlrev_b32 v144, 16, v68
  v_and_b32 v68, 0xffff0000, v68
  v_fmac_f32 v104, v144, v136
  v_fmac_f32 v105, v68, v137
  v_lshlrev_b32 v145, 16, v69
  v_and_b32 v69, 0xffff0000, v69
  v_fmac_f32 v106, v145, v138
  v_fmac_f32 v107, v69, v139
  v_lshlrev_b32 v146, 16, v70
  v_and_b32 v70, 0xffff0000, v70
  v_fmac_f32 v108, v146, v140
  v_fmac_f32 v109, v70, v141
  v_lshlrev_b32 v147, 16, v71
  v_and_b32 v71, 0xffff0000, v71
  v_fmac_f32 v110, v147, v142
  v_fmac_f32 v111, v71, v143
  v_lshlrev_b32 v144, 16, v72
  v_and_b32 v72, 0xffff0000, v72
  v_fmac_f32 v112, v144, v128
  v_fmac_f32 v113, v72, v129
  v_lshlrev_b32 v145, 16, v73
  v_and_b32 v73, 0xffff0000, v73
  v_fmac_f32 v114, v145, v130
  v_fmac_f32 v115, v73, v131
  v_lshlrev_b32 v146, 16, v74
  v_and_b32 v74, 0xffff0000, v74
  v_fmac_f32 v116, v146, v132
  v_fmac_f32 v117, v74, v133
  v_lshlrev_b32 v147, 16, v75
  v_and_b32 v75, 0xffff0000, v75
  v_fmac_f32 v118, v147, v134
  v_fmac_f32 v119, v75, v135
  v_lshlrev_b32 v144, 16, v76
  v_and_b32 v76, 0xffff0000, v76
  v_fmac_f32 v120, v144, v136
  v_fmac_f32 v121, v76, v137
  v_lshlrev_b32 v145, 16, v77
  v_and_b32 v77, 0xffff0000, v77
  v_fmac_f32 v122, v145, v138
  v_fmac_f32 v123, v77, v139
  v_lshlrev_b32 v146, 16, v78
  v_and_b32 v78, 0xffff0000, v78
  v_fmac_f32 v124, v146, v140
  v_fmac_f32 v125, v78, v141
  v_lshlrev_b32 v147, 16, v79
  v_and_b32 v79, 0xffff0000, v79
  v_fmac_f32 v126, v147, v142
  v_fmac_f32 v127, v79, v143
  v_fmac_f32 v96, v0, v128
  v_fmac_f32 v97, v1, v129
  v_fmac_f32 v98, v2, v130
  v_fmac_f32 v99, v3, v131
  v_fmac_f32 v100, v4, v132
  v_fmac_f32 v101, v5, v133
  v_fmac_f32 v102, v6, v134
  v_fmac_f32 v103, v7, v135
  v_cvt_pk_bf16_f32 v80, v96, v97
  v_cvt_pk_bf16_f32 v81, v98, v99
  v_cvt_pk_bf16_f32 v82, v100, v101
  v_cvt_pk_bf16_f32 v83, v102, v103
  s_nop 0
  v_permlane16_swap_b32 v80, v82
  v_permlane16_swap_b32 v81, v83
  s_nop 1
  buffer_store_dwordx4 v[80:83], v249, s[52:55], 0 offen offset:0 sc1
  v_fmac_f32 v112, v16, v128
  v_fmac_f32 v113, v17, v129
  v_fmac_f32 v114, v18, v130
  v_fmac_f32 v115, v19, v131
  v_fmac_f32 v116, v20, v132
  v_fmac_f32 v117, v21, v133
  v_fmac_f32 v118, v22, v134
  v_fmac_f32 v119, v23, v135
  v_cvt_pk_bf16_f32 v88, v112, v113
  v_cvt_pk_bf16_f32 v89, v114, v115
  v_cvt_pk_bf16_f32 v90, v116, v117
  v_cvt_pk_bf16_f32 v91, v118, v119
  s_nop 0
  v_permlane16_swap_b32 v88, v90
  v_permlane16_swap_b32 v89, v91
  s_nop 1
  buffer_store_dwordx4 v[88:91], v249, s[52:55], s38 offen offset:0 sc1
  v_pk_fma_f32 v[104:105], v[8:9], v[136:137], v[104:105]
  v_pk_fma_f32 v[106:107], v[10:11], v[138:139], v[106:107]
  v_pk_fma_f32 v[108:109], v[12:13], v[140:141], v[108:109]
  v_pk_fma_f32 v[110:111], v[14:15], v[142:143], v[110:111]
  v_cvt_pk_bf16_f32 v84, v104, v105
  v_cvt_pk_bf16_f32 v85, v106, v107
  v_cvt_pk_bf16_f32 v86, v108, v109
  v_cvt_pk_bf16_f32 v87, v110, v111
  s_nop 0
  v_permlane16_swap_b32 v84, v86
  v_permlane16_swap_b32 v85, v87
  s_nop 1
  buffer_store_dwordx4 v[84:87], v249, s[52:55], 0 offen offset:64 sc1
  v_pk_fma_f32 v[120:121], v[24:25], v[136:137], v[120:121]
  v_pk_fma_f32 v[122:123], v[26:27], v[138:139], v[122:123]
  v_pk_fma_f32 v[124:125], v[28:29], v[140:141], v[124:125]
  v_pk_fma_f32 v[126:127], v[30:31], v[142:143], v[126:127]
  v_cvt_pk_bf16_f32 v92, v120, v121
  v_cvt_pk_bf16_f32 v93, v122, v123
  v_cvt_pk_bf16_f32 v94, v124, v125
  v_cvt_pk_bf16_f32 v95, v126, v127
  s_nop 0
  v_permlane16_swap_b32 v92, v94
  v_permlane16_swap_b32 v93, v95
  s_nop 1
  buffer_store_dwordx4 v[92:95], v249, s[52:55], s38 offen offset:64 sc1
L_hot_end:
  s_endpgm
L_slow_12:
  s_mov_b32 s33, 262144
L_spin_41:
  buffer_load_dword v244, v189, s[4:7], 0 offen sc1
  s_waitcnt vmcnt(0)
  v_subrev_u32 v244, s100, v244
  v_subrev_u32 v244, 1, v244
  v_cmp_lt_u32 s[68:69], 6, v244
  s_nop 1
  s_cmp_eq_u64 s[68:69], 0
  s_cbranch_scc1 L_back_13
  s_sub_u32 s33, s33, 1
  s_cmp_lg_u32 s33, 0
  s_cbranch_scc1 L_spin_41
  s_branch L_back_13
L_slow_14:
  s_mov_b32 s33, 262144
L_spin_42:
  buffer_load_dword v244, v243, s[4:7], s88 offen sc1
  s_waitcnt vmcnt(0)
  v_subrev_u32 v244, s100, v244
  v_cmp_lt_u32 s[68:69], 7, v244
  s_nop 1
  s_cmp_eq_u64 s[68:69], 0
  s_cbranch_scc1 L_back_15
  s_sub_u32 s33, s33, 1
  s_cmp_lg_u32 s33, 0
  s_cbranch_scc1 L_spin_42
  s_branch L_back_15
L_slow_16:
  s_mov_b32 s33, 262144
L_spin_43:
  buffer_load_dword v244, v243, s[4:7], s88 offen sc1
  s_waitcnt vmcnt(0)
  v_subrev_u32 v244, s100, v244
  v_subrev_u32 v244, 1, v244
  v_cmp_lt_u32 s[68:69], 6, v244
  s_nop 1
  s_cmp_eq_u64 s[68:69], 0
  s_cbranch_scc1 L_back_17
  s_sub_u32 s33, s33, 1
  s_cmp_lg_u32 s33, 0
  s_cbranch_scc1 L_spin_43
  s_branch L_back_17
L_slow_18:
  s_mov_b32 s33, 262144
L_spin_44:
  buffer_load_dword v244, v192, s[4:7], s89 offen sc1
  s_waitcnt vmcnt(0)
  v_subrev_u32 v244, s100, v244
  v_cmp_lt_u32 s[68:69], 7, v244
  s_nop 1
  s_cmp_eq_u64 s[68:69], 0
  s_cbranch_scc1 L_back_19
  s_sub_u32 s33, s33, 1
  s_cmp_lg_u32 s33, 0
  s_cbranch_scc1 L_spin_44
  s_branch L_back_19
L_slow_20:
  s_mov_b32 s33, 262144
L_spin_45:
  buffer_load_dwordx4 v[96:99], v210, s[4:7], s101 offen sc1
  s_waitcnt vmcnt(0)
  v_xor_b32 v96, s84, v96
  v_xor_b32 v97, s85, v97
  v_or_b32 v100, v96, v97
  v_xor_b32 v98, s86, v98
  v_xor_b32 v99, s87, v99
  v_or3_b32 v100, v100, v98, v99
  v_and_b32 v100, 0xff, v100
  v_cmp_ne_u32 s[68:69], 0, v100
  s_nop 1
  s_cmp_eq_u64 s[68:69], 0
  s_cbranch_scc1 L_back_21
  s_sub_u32 s33, s33, 1
  s_cmp_lg_u32 s33, 0
  s_cbranch_scc1 L_spin_45
  s_branch L_back_21
L_slow_26:
  s_mov_b32 s33, 262144
L_spin_46:
  buffer_load_dword v244, v254, s[4:7], s93 offen sc1
  s_waitcnt vmcnt(0)
  v_subrev_u32 v244, s100, v244
  v_cmp_lt_u32 s[68:69], 7, v244
  s_nop 1
  s_cmp_eq_u64 s[68:69], 0
  s_cbranch_scc1 L_back_27
  s_sub_u32 s33, s33, 1
  s_cmp_lg_u32 s33, 0
  s_cbranch_scc1 L_spin_46
  s_branch L_back_27
L_slow_28:
  s_mov_b32 s33, 262144
L_spin_47:
  buffer_load_dword v244, v254, s[4:7], s32 offen sc1
  s_waitcnt vmcnt(0)
  v_subrev_u32 v244, s100, v244
  v_cmp_lt_u32 s[68:69], 7, v244
  s_nop 1
  s_cmp_eq_u64 s[68:69], 0
  s_cbranch_scc1 L_back_29
  s_sub_u32 s33, s33, 1
  s_cmp_lg_u32 s33, 0
  s_cbranch_scc1 L_spin_47
  s_branch L_back_29
L_slow_31:
  s_mov_b32 s33, 262144
L_spin_48:
  buffer_load_dword v244, v243, s[4:7], s91 offen sc1
  s_waitcnt vmcnt(0)
  v_subrev_u32 v244, s100, v244
  v_cmp_lt_u32 s[68:69], 7, v244
  s_nop 1
  s_cmp_eq_u64 s[68:69], 0
  s_cbranch_scc1 L_back_32
  s_sub_u32 s33, s33, 1
  s_cmp_lg_u32 s33, 0
  s_cbranch_scc1 L_spin_48
  s_branch L_back_32
L_slow_33:
  s_mov_b32 s33, 262144
L_spin_49:
  buffer_load_dword v244, v243, s[4:7], s91 offen sc1
  s_waitcnt vmcnt(0)
  v_subrev_u32 v244, s100, v244
  v_subrev_u32 v244, 1, v244
  v_cmp_lt_u32 s[68:69], 6, v244
  s_nop 1
  s_cmp_eq_u64 s[68:69], 0
  s_cbranch_scc1 L_back_34
  s_sub_u32 s33, s33, 1
  s_cmp_lg_u32 s33, 0
  s_cbranch_scc1 L_spin_49
  s_branch L_back_34
L_slow_35:
  s_mov_b32 s33, 262144
L_spin_50:
  buffer_load_dword v244, v243, s[4:7], s91 offen sc1
  s_waitcnt vmcnt(0)
  v_subrev_u32 v244, s100, v244
  v_subrev_u32 v244, 2, v244
  v_cmp_lt_u32 s[68:69], 5, v244
  s_nop 1
  s_cmp_eq_u64 s[68:69], 0
  s_cbranch_scc1 L_back_36
  s_sub_u32 s33, s33, 1
  s_cmp_lg_u32 s33, 0
  s_cbranch_scc1 L_spin_50
  s_branch L_back_36
L_slow_37:
  s_mov_b32 s33, 262144
L_spin_51:
  buffer_load_dword v244, v243, s[4:7], s91 offen sc1
  s_waitcnt vmcnt(0)
  v_subrev_u32 v244, s100, v244
  v_subrev_u32 v244, 3, v244
  v_cmp_lt_u32 s[68:69], 4, v244
  s_nop 1
  s_cmp_eq_u64 s[68:69], 0
  s_cbranch_scc1 L_back_38
  s_sub_u32 s33, s33, 1
  s_cmp_lg_u32 s33, 0
  s_cbranch_scc1 L_spin_51
  s_branch L_back_38
L_slow_39:
  s_mov_b32 s33, 262144
L_spin_52:
  buffer_load_dwordx4 v[64:67], v251, s[4:7], s96 offen offset:0 sc1
  buffer_load_dwordx4 v[68:71], v251, s[4:7], s96 offen offset:1024 sc1
  buffer_load_dwordx4 v[72:75], v251, s[4:7], s96 offen offset:2048 sc1
  buffer_load_dwordx4 v[76:79], v251, s[4:7], s96 offen offset:3072 sc1
  s_waitcnt vmcnt(0)
  v_max3_u32 v244, v64, v65, v66
  v_max3_u32 v244, v244, v67, v68
  v_max3_u32 v244, v244, v69, v70
  v_max3_u32 v244, v244, v71, v72
  v_max3_u32 v244, v244, v73, v74
  v_max3_u32 v244, v244, v75, v76
  v_max3_u32 v244, v244, v77, v78
  v_max_u32 v244, v244, v79
  v_cmp_eq_u32 s[68:69], -1, v244
  s_nop 1
  s_cmp_eq_u64 s[68:69], 0
  s_cbranch_scc1 L_back_40
  s_sub_u32 s33, s33, 1
  s_cmp_lg_u32 s33, 0
  s_cbranch_scc1 L_spin_52
  s_branch L_back_40
L_end_1:
  s_endpgm
L_code_end:
  s_endpgm
.section .rodata,"a"
.p2align 6
.amdhsa_kernel adaLN_cond__sliding_local_dilated__glu_gated_glu__prompt_kernel
  .amdhsa_next_free_vgpr 512
  .amdhsa_next_free_sgpr 102
  .amdhsa_accum_offset 256
  .amdhsa_group_segment_fixed_size 0
  .amdhsa_kernarg_size 96
  .amdhsa_user_sgpr_count 2
  .amdhsa_user_sgpr_kernarg_segment_ptr 1
  .amdhsa_system_sgpr_workgroup_id_x 1
  .amdhsa_float_denorm_mode_32 3
.end_amdhsa_kernel
```

```asm
; @launch grid=(256,1,1) block=(256,1,1) lds=163840
.amdgcn_target "amdgcn-amd-amdhsa--gfx950"
.text
.globl adaLN_cond__sliding_local_dilated__glu_gated_glu__prompt_kernel
.p2align 8
.type adaLN_cond__sliding_local_dilated__glu_gated_glu__prompt_kernel,@function
adaLN_cond__sliding_local_dilated__glu_gated_glu__prompt_kernel:
  s_cmp_ge_u32 s2, 256
  s_cbranch_scc1 L_end_1
  s_load_dwordx2 s[4:5], s[0:1], 88
  s_load_dwordx2 s[48:49], s[0:1], 0
  s_load_dwordx2 s[64:65], s[0:1], 56
  s_load_dwordx2 s[60:61], s[0:1], 64
  v_lshrrev_b32 v200, 6, v0
  v_and_b32 v224, 63, v0
  v_readfirstlane_b32 s3, v200
  s_getpc_b64 s[30:31]
L_pc_6:
  s_lshr_b32 s32, s2, 4
  s_lshl_b32 s32, s32, 2
  s_add_u32 s32, s32, s3
  s_lshl_b32 s32, s32, 13
  s_bitcmp1_b32 s2, 3
  s_cselect_b32 s32, s32, 0x100000
  v_lshlrev_b32 v200, 7, v224
  v_add_u32 v200, s32, v200
  v_min_u32 v200, L_code_end-L_pc_6-4, v200
  global_load_dword v223, v200, s[30:31]
  v_lshlrev_b32 v251, 4, v224
  s_lshr_b32 s36, s2, 4
  s_lshl_b32 s36, s36, 3
  s_and_b32 s30, s2, 7
  s_add_u32 s36, s36, s30
  s_lshl_b32 s42, s3, 10
  v_lshrrev_b32 v206, 3, v0
  v_and_b32 v207, 6, v206
  v_and_b32 v202, 7, v224
  v_xor_b32 v207, v207, v202
  s_and_b32 s35, s2, 3
  s_movk_i32 s30, 12288
  v_mul_u32_u24 v217, s30, v206
  v_lshl_add_u32 v217, v207, 4, v217
  s_mul_i32 s30, s35, 3145728
  v_add_u32 v217, s30, v217
  s_lshr_b32 s34, s36, 2
  s_lshl_b32 s31, s34, 7
  v_lshlrev_b32 v220, 1, v0
  s_lshl_b32 s30, s35, 9
  v_bfe_u32 v114, v224, 4, 1
  v_lshlrev_b32 v222, 5, v114
  v_lshrrev_b32 v114, 5, v224
  v_lshl_add_u32 v222, v114, 4, v222
  v_and_b32 v114, 15, v224
  v_lshl_add_u32 v1, v114, 11, v222
  s_lshl_b32 s33, s36, 15
  s_lshl_b32 s32, s3, 7
  s_add_u32 s33, s33, s32
  s_mov_b32 s66, 0x800
  s_mov_b32 s67, 0x20000
  s_mov_b32 s62, 0xc00000
  s_mov_b32 s63, 0x20000
  s_mov_b32 s50, 0x400000
  s_mov_b32 s51, 0x20000
  s_mov_b32 s6, 0x2800000
  s_mov_b32 s7, 0x20000
  s_bitcmp1_b32 s2, 3
  s_waitcnt lgkmcnt(0)
  buffer_load_ushort v196, v220, s[64:67], s30 offen
  s_cbranch_scc1 L_l1_2
  s_add_u32 m0, s42, 131072
  s_nop 0
  buffer_load_dwordx4 v217, s[60:63], s31 offen nt lds
  s_add_u32 m0, s42, 135168
  s_add_u32 s31, s31, 393216
  buffer_load_dwordx4 v217, s[60:63], s31 offen nt lds
  s_add_u32 m0, s42, 139264
  s_add_u32 s31, s31, 393216
  buffer_load_dwordx4 v217, s[60:63], s31 offen nt lds
  s_add_u32 m0, s42, 143360
  s_add_u32 s31, s31, 393216
  buffer_load_dwordx4 v217, s[60:63], s31 offen nt lds
  s_add_u32 m0, s42, 147456
  s_add_u32 s31, s31, 393216
  buffer_load_dwordx4 v217, s[60:63], s31 offen nt lds
  s_add_u32 m0, s42, 151552
  s_add_u32 s31, s31, 393216
  buffer_load_dwordx4 v217, s[60:63], s31 offen nt lds
  s_add_u32 m0, s42, 155648
  s_add_u32 s31, s31, 393216
  buffer_load_dwordx4 v217, s[60:63], s31 offen nt lds
  s_add_u32 m0, s42, 159744
  s_add_u32 s31, s31, 393216
  buffer_load_dwordx4 v217, s[60:63], s31 offen nt lds
  s_branch L_j1_3
L_l1_2:
L_j1_3:
  s_mov_b32 s40, s33
  s_load_dword s100, s[4:5], 0xd2d00
  s_load_dwordx2 s[80:81], s[0:1], 8
  s_load_dwordx2 s[8:9], s[0:1], 16
  s_load_dwordx2 s[12:13], s[0:1], 32
  s_load_dwordx2 s[16:17], s[0:1], 40
  s_load_dwordx2 s[44:45], s[0:1], 48
  s_load_dwordx2 s[52:53], s[0:1], 72
  v_lshrrev_b32 v199, 4, v224
  s_movk_i32 s30, 6144
  v_mul_u32_u24 v199, s30, v199
  v_and_b32 v200, 15, v224
  v_min_u32 v200, 11, v200
  v_and_b32 v201, 3, v200
  v_lshl_add_u32 v199, v201, 7, v199
  v_lshrrev_b32 v200, 2, v200
  v_lshl_add_u32 v199, v200, 11, v199
  s_lshr_b32 s32, s2, 4
  s_mul_i32 s30, s3, 16
  s_add_u32 s32, s32, s30
  s_mul_i32 s32, s32, 24576
  s_bfe_u32 s30, s2, 0x20001
  s_lshl_b32 s30, s30, 9
  s_add_u32 s32, s32, s30
  v_add_u32 v199, s32, v199
  s_and_b32 s22, s2, 1
  s_lshl_b32 s22, s22, 3
  s_bfe_u32 s30, s2, 0x30003
  s_add_u32 s22, s22, s30
  s_bfe_u32 s23, s2, 0x20001
  s_lshl_b32 s23, s23, 2
  s_lshr_b32 s30, s2, 6
  s_add_u32 s23, s23, s30
  v_lshrrev_b32 v200, 2, v0
  s_movk_i32 s30, 6144
  v_mul_u32_u24 v200, s30, v200
  v_bfe_u32 v201, v224, 4, 1
  v_lshlrev_b32 v202, 1, v201
  v_and_b32 v203, 3, v224
  v_xor_b32 v202, v202, v203
  v_lshl_add_u32 v200, v202, 4, v200
  s_lshl_b32 s30, s23, 7
  v_add_u32 v185, s30, v200
  v_add_u32 v186, 4096, v185
  v_lshrrev_b32 v200, 2, v224
  v_lshlrev_b32 v200, 6, v200
  v_lshl_add_u32 v200, v201, 5, v200
  v_lshl_add_u32 v176, v203, 3, v200
  v_xor_b32 v177, 32, v176
  v_add_u32 v178, 0x10000, v176
  v_add_u32 v179, 0x10000, v177
  v_add_u32 v180, 0x20000, v176
  v_add_u32 v181, 0x20000, v177
  s_lshl_b32 s30, s22, 13
  s_lshl_b32 s32, s3, 11
  s_add_u32 s30, s30, s32
  v_add_u32 v187, s30, v251
  s_lshl_b32 s30, s22, 3
  s_lshl_b32 s31, s3, 1
  s_add_u32 s30, s30, s31
  s_lshl_b32 s30, s30, 2
  v_and_b32 v189, 7, v224
  v_add_u32 v189, s30, v189
  v_lshlrev_b32 v189, 6, v189
  v_add_u32 v189, 0xc0000, v189
  v_cmp_ne_u32 vcc, 0, v224
  v_mov_b32 v200, 0x40000000
  s_nop 0
  v_cndmask_b32 v246, 0, v200, vcc
  v_lshrrev_b32 v200, 2, v224
  v_lshlrev_b32 v200, 7, v200
  v_bfe_u32 v201, v224, 3, 2
  v_lshl_add_u32 v200, v201, 5, v200
  v_lshl_add_u32 v228, v203, 3, v200
  s_waitcnt lgkmcnt(0)
  s_add_u32 s100, s100, 0x9e3779b8
  s_and_b32 s100, s100, -8
  v_mov_b32 v245, s100
  s_mov_b32 s82, 0x600000
  s_mov_b32 s83, 0x20000
  s_bfe_u32 s84, s100, 0x80000
  s_bfe_u32 s85, s100, 0x80008
  s_bfe_u32 s86, s100, 0x80010
  s_bfe_u32 s87, s100, 0x80018
  s_bitcmp0_b32 s2, 3
  s_cbranch_scc1 L_sk_7
  buffer_load_dwordx4 v[8:11], v1, s[48:51], s40 offen offset:0
  buffer_load_dwordx4 v[12:15], v1, s[48:51], s40 offen offset:64
  buffer_load_dwordx4 v[16:19], v1, s[48:51], s40 offen offset:512
  buffer_load_dwordx4 v[20:23], v1, s[48:51], s40 offen offset:576
  buffer_load_dwordx4 v[24:27], v1, s[48:51], s40 offen offset:1024
  buffer_load_dwordx4 v[28:31], v1, s[48:51], s40 offen offset:1088
  buffer_load_dwordx4 v[32:35], v1, s[48:51], s40 offen offset:1536
  buffer_load_dwordx4 v[36:39], v1, s[48:51], s40 offen offset:1600
L_sk_7:
  s_bitcmp1_b32 s2, 3
  s_cselect_b32 s30, 0, 0x40000000
  buffer_load_dword v223, v199, s[80:83], s30 offen
  s_mul_i32 s35, s35, 24576
  s_lshl_b32 s30, s3, 6
  s_add_u32 s35, s35, s30
  s_lshl_b32 s30, s34, 8
  s_add_u32 s66, s35, s30
  s_lshr_b32 s30, s2, 2
  s_lshl_b32 s31, s30, 8
  s_add_u32 s35, s35, s31
  s_add_u32 s35, s35, 8192
  s_lshl_b32 s30, s30, 7
  s_add_u32 s30, s30, 0x1000
  v_add_u32 v217, s30, v217
  v_lshrrev_b32 v201, 4, v224
  v_lshlrev_b32 v250, 4, v201
  v_and_b32 v202, 15, v224
  v_cmp_ne_u32 vcc, 0, v202
  v_mov_b32 v6, 0x40000000
  s_nop 0
  v_cndmask_b32 v6, v250, v6, vcc
  v_add_u32 v218, s35, v6
  s_lshl_b32 s30, s3, 5
  v_xor_b32 v214, s30, v228
  v_add_u32 v215, 0x10000, v214
  v_add_u32 v216, 0x20000, v214
  s_lshl_b32 s0, s36, 2
  s_add_u32 s0, s0, s3
  s_lshl_b32 s0, s0, 6
  s_add_u32 s0, s0, 0xc0000
  s_lshl_b32 s1, s3, 18
  s_lshl_b32 s30, s36, 10
  s_add_u32 s1, s1, s30
  s_add_u32 s1, s1, 0x100000
  v_lshrrev_b32 v200, 5, v0
  v_lshlrev_b32 v200, 6, v200
  v_bfe_u32 v201, v0, 2, 2
  v_lshl_add_u32 v200, v201, 4, v200
  v_bfe_u32 v201, v0, 4, 1
  v_lshl_add_u32 v200, v201, 3, v200
  v_lshl_add_u32 v200, v203, 1, v200
  s_waitcnt vmcnt(9)
  v_lshlrev_b32 v196, 16, v196
  v_mul_f32 v197, 0xbfb8aa3b, v196
  v_exp_f32 v197, v197
  s_nop 0
  v_add_f32 v197, 1.0, v197
  v_rcp_f32 v197, v197
  s_nop 0
  v_mul_f32 v196, v196, v197
  v_cvt_pk_bf16_f32 v196, v196, v196
  ds_write_b16 v200, v196 offset:11264
  s_mov_b32 s10, 0x200000
  s_mov_b32 s11, 0x20000
  s_mov_b32 s14, 0x700000
  s_mov_b32 s15, 0x20000
  s_mov_b32 s18, 0x700000
  s_mov_b32 s19, 0x20000
  s_mov_b32 s46, 0x700000
  s_mov_b32 s47, 0x20000
  s_mov_b32 s54, 0x400000
  s_mov_b32 s55, 0x20000
  s_lshl_b32 s30, s23, 17
  s_add_u32 s78, s30, 0x500000
  s_lshl_b32 s30, s22, 2
  s_add_u32 s30, s30, s3
  s_lshl_b32 s30, s30, 4
  s_add_u32 s30, s30, s23
  s_lshl_b32 s30, s30, 6
  s_add_u32 s79, s30, 0x90000
  s_lshl_b32 s30, s22, 14
  s_lshl_b32 s31, s23, 10
  s_add_u32 s30, s30, s31
  s_lshl_b32 s31, s3, 8
  s_add_u32 s30, s30, s31
  s_add_u32 s89, s30, 0x40000
  s_xor_b32 s30, s3, 2
  s_lshl_b32 s30, s30, 11
  v_add_u32 v191, s30, v251
  s_lshl_b32 s30, s22, 4
  s_add_u32 s30, s30, s23
  s_lshl_b32 s30, s30, 13
  s_add_u32 s30, s30, 0x2400000
  s_add_u32 s31, s30, 0x20000
  s_cmp_eq_u32 s3, 3
  s_cselect_b32 s31, s31, 0x40000000
  s_cmp_lt_u32 s22, 15
  s_cselect_b32 s31, s31, 0x40000000
  v_add_u32 v188, s31, v251
  s_cmp_eq_u32 s3, 0
  s_cselect_b32 s31, s22, 0
  s_cmp_lg_u32 s31, 0
  s_cselect_b32 s30, s30, 0x40000000
  s_cselect_b32 s31, s100, 0
  v_add_u32 v182, s30, v251
  v_mov_b32 v183, s31
  s_sub_u32 s30, s3, 1
  s_xor_b32 s30, s30, 2
  s_lshl_b32 s30, s30, 11
  s_cmp_eq_u32 s3, 0
  s_cselect_b32 s30, 8192, s30
  v_add_u32 v209, s30, v251
  s_or_b32 s33, s22, s3
  s_and_b32 s24, s2, 1
  s_lshr_b32 s29, s2, 3
  s_bfe_u32 s25, s2, 0x20001
  s_lshl_b32 s25, s25, 2
  s_and_b32 s30, s29, 3
  s_add_u32 s25, s25, s30
  s_lshr_b32 s26, s29, 2
  s_xor_b32 s26, s26, 2
  s_lshl_b32 s26, s26, 1
  s_add_u32 s26, s26, s24
  s_lshl_b32 s30, s25, 13
  s_lshl_b32 s31, s3, 11
  s_add_u32 s30, s30, s31
  v_add_u32 v240, s30, v251
  v_lshlrev_b32 v202, 11, v206
  v_lshl_add_u32 v202, v207, 4, v202
  s_lshl_b32 s30, s26, 7
  v_add_u32 v241, s30, v202
  s_mul_i32 s30, s24, 3670016
  v_add_u32 v253, s30, v241
  v_xor_b32 v242, 128, v253
  s_mul_i32 s30, s24, 7340032
  v_add_u32 v252, s30, v240
  s_lshl_b32 s27, s24, 2
  s_and_b32 s30, s29, 3
  s_add_u32 s27, s27, s30
  s_bfe_u32 s28, s2, 0x20001
  s_lshl_b32 s28, s28, 3
  s_lshr_b32 s30, s29, 2
  s_add_u32 s28, s28, s30
  s_lshl_b32 s30, s27, 14
  s_lshl_b32 s31, s3, 12
  s_add_u32 s30, s30, s31
  v_add_u32 v225, s30, v251
  s_movk_i32 s30, 7168
  v_mul_u32_u24 v202, s30, v206
  v_lshl_add_u32 v202, v207, 4, v202
  s_lshr_b32 s30, s28, 2
  s_mul_i32 s30, s30, 896
  s_and_b32 s31, s28, 3
  s_lshl_b32 s32, s31, 8
  s_add_u32 s32, s32, s30
  v_add_u32 v226, s32, v202
  s_lshl_b32 s31, s31, 3
  s_lshr_b32 s32, 0x160e0c04, s31
  s_and_b32 s32, s32, 255
  s_lshl_b32 s32, s32, 5
  s_add_u32 s32, s32, s30
  v_mov_b32 v203, s32
  s_lshr_b32 s32, 0x15140706, s31
  s_and_b32 s32, s32, 255
  s_lshl_b32 s32, s32, 5
  s_add_u32 s32, s32, s30
  s_sub_u32 s32, s32, 64
  v_mov_b32 v204, s32
  v_cmp_lt_u32 vcc, 3, v207
  s_nop 1
  v_cndmask_b32 v203, v203, v204, vcc
  v_mov_b32 v204, 0x40000000
  v_cmp_lt_u32 vcc, 5, v207
  s_nop 1
  v_cndmask_b32 v203, v203, v204, vcc
  v_add_u32 v227, v203, v202
  v_xor_b32 v229, 32, v228
  v_xor_b32 v230, 64, v228
  v_xor_b32 v231, 96, v228
  v_add_u32 v232, 0x10000, v228
  v_add_u32 v233, 0x10000, v229
  v_add_u32 v234, 0x10000, v230
  v_add_u32 v235, 0x10000, v231
  v_add_u32 v236, 0x20000, v228
  v_add_u32 v237, 0x20000, v229
  v_add_u32 v238, 0x20000, v230
  v_add_u32 v239, 0x20000, v231
  s_lshr_b32 s30, s28, 4
  s_mul_i32 s30, s30, 56
  s_and_b32 s31, s28, 15
  s_add_u32 s32, s30, s31
  s_lshl_b32 s32, s32, 17
  s_add_u32 s64, s32, 17825792
  s_lshr_b32 s32, s31, 1
  s_add_u32 s32, s32, s30
  s_lshl_b32 s32, s32, 17
  s_and_b32 s31, s31, 1
  s_lshl_b32 s31, s31, 10
  s_add_u32 s32, s32, s31
  s_add_u32 s65, s32, 19922944
  s_add_u32 s20, s64, 3145728
  s_add_u32 s21, s64, 5242880
  s_lshl_b32 s30, s27, 2
  s_add_u32 s30, s30, s3
  s_lshl_b32 s30, s30, 5
  s_lshl_b32 s31, s30, 6
  s_add_u32 s93, s31, 720896
  s_add_u32 s30, s30, s28
  s_lshl_b32 s30, s30, 6
  s_add_u32 s90, s30, 524288
  s_lshl_b32 s30, s25, 1
  s_lshr_b32 s31, s3, 1
  s_add_u32 s30, s30, s31
  s_lshl_b32 s30, s30, 1
  s_add_u32 s30, s30, s24
  s_lshl_b32 s30, s30, 10
  s_add_u32 s91, s30, 524288
  s_lshl_b32 s30, s25, 2
  s_add_u32 s30, s30, s3
  s_lshl_b32 s30, s30, 10
  s_add_u32 s88, s30, 589824
  s_lshl_b32 s31, s26, 6
  s_add_u32 s30, s30, s31
  s_add_u32 s92, s30, 720896
  v_and_b32 v254, 31, v224
  v_lshlrev_b32 v254, 6, v254
  v_and_b32 v243, 960, v254
  s_lshl_b32 s30, s25, 14
  s_lshl_b32 s31, s3, 8
  s_add_u32 s30, s30, s31
  s_add_u32 s94, s30, 262144
  s_lshl_b32 s31, s26, 10
  s_add_u32 s95, s94, s31
  s_lshl_b32 s30, s2, 2
  s_add_u32 s30, s30, s3
  s_lshl_b32 s22, s30, 7
  s_xor_b32 s31, s30, 4
  s_lshl_b32 s30, s30, 12
  s_lshl_b32 s31, s31, 12
  s_add_u32 s96, s30, 13631488
  s_add_u32 s97, s31, 13631488
  s_lshl_b32 s30, s26, 18
  s_add_u32 s98, s30, 9437184
  s_add_u32 s99, s30, 9568256
  s_mov_b32 s38, 0x8000
  s_mov_b32 s43, 0xbfb8aa3b
  v_and_b32 v200, 15, v224
  v_lshlrev_b32 v249, 11, v200
  v_bfe_u32 v202, v224, 4, 1
  v_lshl_add_u32 v249, v202, 5, v249
  v_lshrrev_b32 v202, 5, v224
  v_lshl_add_u32 v249, v202, 4, v249
  s_lshl_b32 s30, s25, 18
  s_lshl_b32 s31, s3, 16
  s_add_u32 s30, s30, s31
  s_lshl_b32 s31, s26, 7
  s_add_u32 s30, s30, s31
  v_add_u32 v249, s30, v249
  v_lshrrev_b32 v201, 4, v224
  v_lshlrev_b32 v250, 4, v201
  s_bitcmp1_b32 s3, 0
  s_cselect_b32 s56, s16, s12
  s_cselect_b32 s57, s17, s13
  s_mov_b32 s58, 0x700000
  s_mov_b32 s59, 0x20000
  s_lshr_b32 s30, s2, 6
  s_lshl_b32 s30, s30, 5
  s_and_b32 s31, s2, 31
  s_add_u32 s30, s30, s31
  s_lshl_b32 s30, s30, 1
  s_lshr_b32 s31, s3, 1
  s_add_u32 s30, s30, s31
  s_lshl_b32 s30, s30, 11
  s_add_u32 s31, s28, 1
  s_bitcmp1_b32 s31, 1
  s_cselect_b32 s30, 0x40000000, s30
  v_lshrrev_b32 v247, 2, v224
  v_lshlrev_b32 v247, 7, v247
  v_add_u32 v247, s30, v247
  s_movk_i32 s30, 24576
  v_mul_u32_u24 v210, s30, v201
  v_lshl_add_u32 v210, v200, 4, v210
  s_lshl_b32 s30, s26, 8
  s_lshl_b32 s31, s3, 12
  s_add_u32 s30, s30, s31
  s_add_u32 s101, s30, 8192
  v_lshlrev_b32 v213, 4, v200
  s_lshl_b32 s30, s3, 8
  v_add_u32 v213, s30, v213
  v_lshlrev_b32 v212, 12, v201
  v_lshl_add_u32 v212, v200, 3, v212
  v_cmp_gt_u32 s[34:35], 16, v224
  v_lshlrev_b32 v211, 3, v224
  v_mov_b32 v202, 0x40000000
  v_cndmask_b32_e64 v211, v202, v211, s[34:35]
  s_cmp_eq_u32 s3, 2
  s_cselect_b32 s39, 1.0, 0
  v_and_b32 v202, 14, v224
  v_lshlrev_b32 v201, 2, v201
  v_cmp_le_u32 s[24:25], v201, v202
  v_add_u32 v201, 2, v201
  v_cmp_le_u32 s[26:27], v201, v202
  v_and_b32 v202, 1, v224
  v_cmp_eq_u32 s[28:29], 1, v202
  v_lshlrev_b32 v195, 4, v202
  s_cmp_eq_u32 s33, 0
  s_cselect_b32 s33, 0xf149f2ca, 0
  v_mov_b32 v200, s33
  v_cndmask_b32_e64 v193, v200, 0, s[24:25]
  v_cndmask_b32_e64 v194, v200, 0, s[26:27]
  s_add_u32 s23, s22, 60
  s_add_u32 s36, s23, s8
  s_addc_u32 s37, s9, 0
  s_bitcmp1_b32 s2, 3
  s_cbranch_scc1 L_l2_4
  v_add_u32 v5, 0x20000, v214
  v_mov_b32 v7, 0xff
  s_waitcnt lgkmcnt(0)
  s_barrier
  ds_read_b128 v[16:19], v250 offset:11264
  ds_read_b128 v[20:23], v250 offset:11328
  ds_read_b128 v[24:27], v250 offset:11392
  ds_read_b128 v[28:31], v250 offset:11456
  ds_read_b128 v[32:35], v250 offset:11520
  ds_read_b128 v[36:39], v250 offset:11584
  ds_read_b128 v[40:43], v250 offset:11648
  ds_read_b128 v[44:47], v250 offset:11712
  s_waitcnt vmcnt(1)
  s_barrier
  ds_read_b64_tr_b16 v[48:49], v5 offset:0
  ds_read_b64_tr_b16 v[50:51], v5 offset:2048
  ds_read_b64_tr_b16 v[52:53], v5 offset:4096
  ds_read_b64_tr_b16 v[54:55], v5 offset:6144
  ds_read_b64_tr_b16 v[56:57], v5 offset:8192
  ds_read_b64_tr_b16 v[58:59], v5 offset:10240
  ds_read_b64_tr_b16 v[60:61], v5 offset:12288
  ds_read_b64_tr_b16 v[62:63], v5 offset:14336
  ds_read_b64_tr_b16 v[64:65], v5 offset:16384
  ds_read_b64_tr_b16 v[66:67], v5 offset:18432
  ds_read_b64_tr_b16 v[68:69], v5 offset:20480
  ds_read_b64_tr_b16 v[70:71], v5 offset:22528
  ds_read_b64_tr_b16 v[72:73], v5 offset:24576
  ds_read_b64_tr_b16 v[74:75], v5 offset:26624
  ds_read_b64_tr_b16 v[76:77], v5 offset:28672
  ds_read_b64_tr_b16 v[78:79], v5 offset:30720
  s_waitcnt lgkmcnt(14)
  v_mfma_f32_16x16x32_bf16 v[80:83], v[48:51], v[16:19], 0
  s_waitcnt lgkmcnt(12)
  v_mfma_f32_16x16x32_bf16 v[80:83], v[52:55], v[20:23], v[80:83]
  s_waitcnt lgkmcnt(10)
  v_mfma_f32_16x16x32_bf16 v[80:83], v[56:59], v[24:27], v[80:83]
  s_waitcnt lgkmcnt(8)
  v_mfma_f32_16x16x32_bf16 v[80:83], v[60:63], v[28:31], v[80:83]
  s_waitcnt lgkmcnt(6)
  v_mfma_f32_16x16x32_bf16 v[80:83], v[64:67], v[32:35], v[80:83]
  s_waitcnt lgkmcnt(4)
  v_mfma_f32_16x16x32_bf16 v[80:83], v[68:71], v[36:39], v[80:83]
  s_waitcnt lgkmcnt(2)
  v_mfma_f32_16x16x32_bf16 v[80:83], v[72:75], v[40:43], v[80:83]
  s_waitcnt lgkmcnt(0)
  v_mfma_f32_16x16x32_bf16 v[80:83], v[76:79], v[44:47], v[80:83]
  s_nop 7
  v_bfi_b32 v80, v7, s84, v80
  v_bfi_b32 v81, v7, s85, v81
  v_bfi_b32 v82, v7, s86, v82
  v_bfi_b32 v83, v7, s87, v83
  buffer_store_dwordx4 v[80:83], v6, s[4:7], s66 offen sc1
  s_mov_b32 s30, 1572864
  buffer_load_dword v223, v199, s[80:83], s30 offen
  s_mov_b32 s30, 3145728
  buffer_load_dword v223, v199, s[80:83], s30 offen
  s_mov_b32 s30, 4718592
  buffer_load_dword v223, v199, s[80:83], s30 offen
  s_mov_b32 s41, 0
  s_add_u32 m0, s42, 10240
  s_nop 0
  buffer_load_dwordx4 v185, s[80:83], s41 offen offset:2048 lds
  s_mov_b32 s41, 0
  s_add_u32 m0, s42, 14272
  s_nop 0
  buffer_load_dwordx4 v185, s[80:83], s41 offen offset:2112 lds
  s_mov_b32 s41, 0
  s_add_u32 m0, s42, 20480
  s_nop 0
  buffer_load_dwordx4 v186, s[80:83], s41 offen offset:0 lds
  s_mov_b32 s41, 0
  s_add_u32 m0, s42, 24512
  s_nop 0
  buffer_load_dwordx4 v186, s[80:83], s41 offen offset:64 lds
  s_mov_b32 s41, 0
  s_add_u32 m0, s42, 28672
  s_nop 0
  buffer_load_dwordx4 v185, s[80:83], s41 offen offset:0 lds
  s_mov_b32 s41, 0
  s_add_u32 m0, s42, 32704
  s_nop 0
  buffer_load_dwordx4 v185, s[80:83], s41 offen offset:64 lds
  s_mov_b32 s41, 393216
  s_add_u32 m0, s42, 34816
  s_nop 0
  buffer_load_dwordx4 v185, s[80:83], s41 offen offset:2048 lds
  s_mov_b32 s41, 393216
  s_add_u32 m0, s42, 38848
  s_nop 0
  buffer_load_dwordx4 v185, s[80:83], s41 offen offset:2112 lds
  s_mov_b32 s41, 393216
  s_add_u32 m0, s42, 45056
  s_nop 0
  buffer_load_dwordx4 v186, s[80:83], s41 offen offset:0 lds
  s_mov_b32 s41, 393216
  s_add_u32 m0, s42, 49088
  s_nop 0
  buffer_load_dwordx4 v186, s[80:83], s41 offen offset:64 lds
  s_mov_b32 s41, 393216
  s_add_u32 m0, s42, 53248
  s_nop 0
  buffer_load_dwordx4 v185, s[80:83], s41 offen offset:0 lds
  s_mov_b32 s41, 393216
  s_add_u32 m0, s42, 57280
  s_nop 0
  buffer_load_dwordx4 v185, s[80:83], s41 offen offset:64 lds
  s_mov_b32 s41, 786432
  s_add_u32 m0, s42, 59392
  s_nop 0
  buffer_load_dwordx4 v185, s[80:83], s41 offen offset:2048 lds
  s_mov_b32 s41, 786432
  s_add_u32 m0, s42, 63424
  s_nop 0
  buffer_load_dwordx4 v185, s[80:83], s41 offen offset:2112 lds
  s_mov_b32 s41, 786432
  s_add_u32 m0, s42, 69632
  s_nop 0
  buffer_load_dwordx4 v186, s[80:83], s41 offen offset:0 lds
  s_mov_b32 s41, 786432
  s_add_u32 m0, s42, 73664
  s_nop 0
  buffer_load_dwordx4 v186, s[80:83], s41 offen offset:64 lds
  s_mov_b32 s41, 786432
  s_add_u32 m0, s42, 77824
  s_nop 0
  buffer_load_dwordx4 v185, s[80:83], s41 offen offset:0 lds
  s_mov_b32 s41, 786432
  s_add_u32 m0, s42, 81856
  s_nop 0
  buffer_load_dwordx4 v185, s[80:83], s41 offen offset:64 lds
  s_mov_b32 s41, 1179648
  s_add_u32 m0, s42, 83968
  s_nop 0
  buffer_load_dwordx4 v185, s[80:83], s41 offen offset:2048 lds
  s_mov_b32 s41, 1179648
  s_add_u32 m0, s42, 88000
  s_nop 0
  buffer_load_dwordx4 v185, s[80:83], s41 offen offset:2112 lds
  s_mov_b32 s41, 1179648
  s_add_u32 m0, s42, 94208
  s_nop 0
  buffer_load_dwordx4 v186, s[80:83], s41 offen offset:0 lds
  s_mov_b32 s41, 1179648
  s_add_u32 m0, s42, 98240
  s_nop 0
  buffer_load_dwordx4 v186, s[80:83], s41 offen offset:64 lds
  s_mov_b32 s41, 1179648
  s_add_u32 m0, s42, 102400
  s_nop 0
  buffer_load_dwordx4 v185, s[80:83], s41 offen offset:0 lds
  s_mov_b32 s41, 1179648
  s_add_u32 m0, s42, 106432
  s_nop 0
  buffer_load_dwordx4 v185, s[80:83], s41 offen offset:64 lds
  s_mov_b32 s41, 1572864
  s_add_u32 m0, s42, 108544
  s_nop 0
  buffer_load_dwordx4 v185, s[80:83], s41 offen offset:2048 lds
  s_mov_b32 s41, 1572864
  s_add_u32 m0, s42, 112576
  s_nop 0
  buffer_load_dwordx4 v185, s[80:83], s41 offen offset:2112 lds
  s_mov_b32 s41, 1572864
  s_add_u32 m0, s42, 118784
  s_nop 0
  buffer_load_dwordx4 v186, s[80:83], s41 offen offset:0 lds
  s_mov_b32 s41, 1572864
  s_add_u32 m0, s42, 122816
  s_nop 0
  buffer_load_dwordx4 v186, s[80:83], s41 offen offset:64 lds
  s_mov_b32 s41, 1572864
  s_add_u32 m0, s42, 126976
  s_nop 0
  buffer_load_dwordx4 v185, s[80:83], s41 offen offset:0 lds
  s_barrier
  s_mov_b32 s41, 1572864
  s_add_u32 m0, s42, 131008
  s_nop 0
  buffer_load_dwordx4 v185, s[80:83], s41 offen offset:64 lds
  s_mov_b32 s41, 1966080
  s_add_u32 m0, s42, 133120
  s_nop 0
  buffer_load_dwordx4 v185, s[80:83], s41 offen offset:2048 lds
  s_mov_b32 s41, 1966080
  s_add_u32 m0, s42, 137152
  s_nop 0
  buffer_load_dwordx4 v185, s[80:83], s41 offen offset:2112 lds
  s_mov_b32 s41, 1966080
  s_add_u32 m0, s42, 143360
  s_nop 0
  buffer_load_dwordx4 v186, s[80:83], s41 offen offset:0 lds
  s_mov_b32 s41, 1966080
  s_add_u32 m0, s42, 147392
  s_nop 0
  buffer_load_dwordx4 v186, s[80:83], s41 offen offset:64 lds
  s_mov_b32 s41, 1966080
  s_add_u32 m0, s42, 151552
  s_nop 0
  buffer_load_dwordx4 v185, s[80:83], s41 offen offset:0 lds
  s_mov_b32 s41, 1966080
  s_add_u32 m0, s42, 155584
  s_nop 0
  buffer_load_dwordx4 v185, s[80:83], s41 offen offset:64 lds
  s_branch L_j2_5
L_l2_4:
  s_lshl_b32 s33, s3, 11
  v_lshlrev_b32 v222, 1, v222
  v_add_u32 v222, s33, v222
  v_add_u32 v3, s33, v251
  v_lshrrev_b32 v4, 4, v224
  v_lshlrev_b32 v4, 10, v4
  v_and_b32 v114, 15, v224
  v_lshl_add_u32 v4, v114, 4, v4
  s_lshl_b32 s33, s3, 8
  v_add_u32 v4, s33, v4
  v_add_u32 v5, 4096, v4
  v_mul_u32_u24 v6, 48, v114
  s_lshl_b32 s33, s3, 3
  v_add_u32 v7, s33, v6
  s_waitcnt vmcnt(8)
  v_lshlrev_b32 v40, 16, v8
  v_and_b32 v41, 0xffff0000, v8
  v_lshlrev_b32 v42, 16, v9
  v_and_b32 v43, 0xffff0000, v9
  v_lshlrev_b32 v44, 16, v10
  v_and_b32 v45, 0xffff0000, v10
  v_lshlrev_b32 v46, 16, v11
  v_and_b32 v47, 0xffff0000, v11
  v_pk_add_f32 v[114:115], v[40:41], v[42:43]
  v_pk_add_f32 v[116:117], v[44:45], v[46:47]
  s_waitcnt vmcnt(7)
  v_lshlrev_b32 v48, 16, v12
  v_and_b32 v49, 0xffff0000, v12
  v_lshlrev_b32 v50, 16, v13
  v_and_b32 v51, 0xffff0000, v13
  v_lshlrev_b32 v52, 16, v14
  v_and_b32 v53, 0xffff0000, v14
  v_lshlrev_b32 v54, 16, v15
  v_and_b32 v55, 0xffff0000, v15
  v_pk_add_f32 v[114:115], v[114:115], v[48:49]
  v_pk_add_f32 v[116:117], v[116:117], v[50:51]
  v_pk_add_f32 v[114:115], v[114:115], v[52:53]
  v_pk_add_f32 v[116:117], v[116:117], v[54:55]
  s_waitcnt vmcnt(6)
  v_lshlrev_b32 v56, 16, v16
  v_and_b32 v57, 0xffff0000, v16
  v_lshlrev_b32 v58, 16, v17
  v_and_b32 v59, 0xffff0000, v17
  v_lshlrev_b32 v60, 16, v18
  v_and_b32 v61, 0xffff0000, v18
  v_lshlrev_b32 v62, 16, v19
  v_and_b32 v63, 0xffff0000, v19
  v_pk_add_f32 v[114:115], v[114:115], v[56:57]
  v_pk_add_f32 v[116:117], v[116:117], v[58:59]
  v_pk_add_f32 v[114:115], v[114:115], v[60:61]
  v_pk_add_f32 v[116:117], v[116:117], v[62:63]
  s_waitcnt vmcnt(5)
  v_lshlrev_b32 v64, 16, v20
  v_and_b32 v65, 0xffff0000, v20
  v_lshlrev_b32 v66, 16, v21
  v_and_b32 v67, 0xffff0000, v21
  v_lshlrev_b32 v68, 16, v22
  v_and_b32 v69, 0xffff0000, v22
  v_lshlrev_b32 v70, 16, v23
  v_and_b32 v71, 0xffff0000, v23
  v_pk_add_f32 v[114:115], v[114:115], v[64:65]
  v_pk_add_f32 v[116:117], v[116:117], v[66:67]
  v_pk_add_f32 v[114:115], v[114:115], v[68:69]
  v_pk_add_f32 v[116:117], v[116:117], v[70:71]
  s_waitcnt vmcnt(4)
  v_lshlrev_b32 v72, 16, v24
  v_and_b32 v73, 0xffff0000, v24
  v_lshlrev_b32 v74, 16, v25
  v_and_b32 v75, 0xffff0000, v25
  v_lshlrev_b32 v76, 16, v26
  v_and_b32 v77, 0xffff0000, v26
  v_lshlrev_b32 v78, 16, v27
  v_and_b32 v79, 0xffff0000, v27
  v_pk_add_f32 v[114:115], v[114:115], v[72:73]
  v_pk_add_f32 v[116:117], v[116:117], v[74:75]
  v_pk_add_f32 v[114:115], v[114:115], v[76:77]
  v_pk_add_f32 v[116:117], v[116:117], v[78:79]
  s_waitcnt vmcnt(3)
  v_lshlrev_b32 v80, 16, v28
  v_and_b32 v81, 0xffff0000, v28
  v_lshlrev_b32 v82, 16, v29
  v_and_b32 v83, 0xffff0000, v29
  v_lshlrev_b32 v84, 16, v30
  v_and_b32 v85, 0xffff0000, v30
  v_lshlrev_b32 v86, 16, v31
  v_and_b32 v87, 0xffff0000, v31
  v_pk_add_f32 v[114:115], v[114:115], v[80:81]
  v_pk_add_f32 v[116:117], v[116:117], v[82:83]
  v_pk_add_f32 v[114:115], v[114:115], v[84:85]
  v_pk_add_f32 v[116:117], v[116:117], v[86:87]
  s_waitcnt vmcnt(2)
  v_lshlrev_b32 v88, 16, v32
  v_and_b32 v89, 0xffff0000, v32
  v_lshlrev_b32 v90, 16, v33
  v_and_b32 v91, 0xffff0000, v33
  v_lshlrev_b32 v92, 16, v34
  v_and_b32 v93, 0xffff0000, v34
  v_lshlrev_b32 v94, 16, v35
  v_and_b32 v95, 0xffff0000, v35
  v_pk_add_f32 v[114:115], v[114:115], v[88:89]
  v_pk_add_f32 v[116:117], v[116:117], v[90:91]
  v_pk_add_f32 v[114:115], v[114:115], v[92:93]
  v_pk_add_f32 v[116:117], v[116:117], v[94:95]
  s_waitcnt vmcnt(1)
  v_lshlrev_b32 v96, 16, v36
  v_and_b32 v97, 0xffff0000, v36
  v_lshlrev_b32 v98, 16, v37
  v_and_b32 v99, 0xffff0000, v37
  v_lshlrev_b32 v100, 16, v38
  v_and_b32 v101, 0xffff0000, v38
  v_lshlrev_b32 v102, 16, v39
  v_and_b32 v103, 0xffff0000, v39
  v_pk_add_f32 v[114:115], v[114:115], v[96:97]
  v_pk_add_f32 v[116:117], v[116:117], v[98:99]
  v_pk_add_f32 v[114:115], v[114:115], v[100:101]
  v_pk_add_f32 v[116:117], v[116:117], v[102:103]
  v_pk_add_f32 v[114:115], v[114:115], v[116:117]
  v_add_f32 v114, v114, v115
  v_mov_b32 v115, v114
  s_nop 1
  v_permlane16_swap_b32 v115, v114
  s_nop 1
  v_add_f32 v114, v114, v115
  v_mov_b32 v115, v114
  s_nop 1
  v_permlane32_swap_b32 v115, v114
  s_nop 1
  v_add_f32 v114, v114, v115
  v_mul_f32 v104, 0x3b800000, v114
  s_mov_b32 s41, 0
  s_add_u32 m0, s42, 10240
  s_nop 0
  buffer_load_dwordx4 v185, s[80:83], s41 offen offset:2048 lds
  v_mov_b32 v105, v104
  v_pk_add_f32 v[108:109], v[40:41], v[104:105] neg_lo:[0,1] neg_hi:[0,1]
  v_pk_mul_f32 v[114:115], v[108:109], v[108:109]
  v_pk_add_f32 v[110:111], v[42:43], v[104:105] neg_lo:[0,1] neg_hi:[0,1]
  v_pk_mul_f32 v[116:117], v[110:111], v[110:111]
  v_pk_add_f32 v[108:109], v[44:45], v[104:105] neg_lo:[0,1] neg_hi:[0,1]
  v_pk_fma_f32 v[114:115], v[108:109], v[108:109], v[114:115]
  v_pk_add_f32 v[110:111], v[46:47], v[104:105] neg_lo:[0,1] neg_hi:[0,1]
  v_pk_fma_f32 v[116:117], v[110:111], v[110:111], v[116:117]
  s_mov_b32 s41, 0
  s_add_u32 m0, s42, 14272
  s_nop 0
  buffer_load_dwordx4 v185, s[80:83], s41 offen offset:2112 lds
  v_pk_add_f32 v[108:109], v[48:49], v[104:105] neg_lo:[0,1] neg_hi:[0,1]
  v_pk_fma_f32 v[114:115], v[108:109], v[108:109], v[114:115]
  v_pk_add_f32 v[110:111], v[50:51], v[104:105] neg_lo:[0,1] neg_hi:[0,1]
  v_pk_fma_f32 v[116:117], v[110:111], v[110:111], v[116:117]
  v_pk_add_f32 v[108:109], v[52:53], v[104:105] neg_lo:[0,1] neg_hi:[0,1]
  v_pk_fma_f32 v[114:115], v[108:109], v[108:109], v[114:115]
  v_pk_add_f32 v[110:111], v[54:55], v[104:105] neg_lo:[0,1] neg_hi:[0,1]
  v_pk_fma_f32 v[116:117], v[110:111], v[110:111], v[116:117]
  v_pk_add_f32 v[108:109], v[56:57], v[104:105] neg_lo:[0,1] neg_hi:[0,1]
  s_mov_b32 s41, 0
  s_add_u32 m0, s42, 20480
  s_nop 0
  buffer_load_dwordx4 v186, s[80:83], s41 offen offset:0 lds
  v_pk_fma_f32 v[114:115], v[108:109], v[108:109], v[114:115]
  v_pk_add_f32 v[110:111], v[58:59], v[104:105] neg_lo:[0,1] neg_hi:[0,1]
  v_pk_fma_f32 v[116:117], v[110:111], v[110:111], v[116:117]
  v_pk_add_f32 v[108:109], v[60:61], v[104:105] neg_lo:[0,1] neg_hi:[0,1]
  v_pk_fma_f32 v[114:115], v[108:109], v[108:109], v[114:115]
  v_pk_add_f32 v[110:111], v[62:63], v[104:105] neg_lo:[0,1] neg_hi:[0,1]
  v_pk_fma_f32 v[116:117], v[110:111], v[110:111], v[116:117]
  v_pk_add_f32 v[108:109], v[64:65], v[104:105] neg_lo:[0,1] neg_hi:[0,1]
  v_pk_fma_f32 v[114:115], v[108:109], v[108:109], v[114:115]
  s_mov_b32 s41, 0
  s_add_u32 m0, s42, 24512
  s_nop 0
  buffer_load_dwordx4 v186, s[80:83], s41 offen offset:64 lds
  v_pk_add_f32 v[110:111], v[66:67], v[104:105] neg_lo:[0,1] neg_hi:[0,1]
  v_pk_fma_f32 v[116:117], v[110:111], v[110:111], v[116:117]
  v_pk_add_f32 v[108:109], v[68:69], v[104:105] neg_lo:[0,1] neg_hi:[0,1]
  v_pk_fma_f32 v[114:115], v[108:109], v[108:109], v[114:115]
  v_pk_add_f32 v[110:111], v[70:71], v[104:105] neg_lo:[0,1] neg_hi:[0,1]
  v_pk_fma_f32 v[116:117], v[110:111], v[110:111], v[116:117]
  v_pk_add_f32 v[108:109], v[72:73], v[104:105] neg_lo:[0,1] neg_hi:[0,1]
  v_pk_fma_f32 v[114:115], v[108:109], v[108:109], v[114:115]
  v_pk_add_f32 v[110:111], v[74:75], v[104:105] neg_lo:[0,1] neg_hi:[0,1]
  s_mov_b32 s41, 0
  s_add_u32 m0, s42, 28672
  s_nop 0
  buffer_load_dwordx4 v185, s[80:83], s41 offen offset:0 lds
  v_pk_fma_f32 v[116:117], v[110:111], v[110:111], v[116:117]
  v_pk_add_f32 v[108:109], v[76:77], v[104:105] neg_lo:[0,1] neg_hi:[0,1]
  v_pk_fma_f32 v[114:115], v[108:109], v[108:109], v[114:115]
  v_pk_add_f32 v[110:111], v[78:79], v[104:105] neg_lo:[0,1] neg_hi:[0,1]
  v_pk_fma_f32 v[116:117], v[110:111], v[110:111], v[116:117]
  v_pk_add_f32 v[108:109], v[80:81], v[104:105] neg_lo:[0,1] neg_hi:[0,1]
  v_pk_fma_f32 v[114:115], v[108:109], v[108:109], v[114:115]
  v_pk_add_f32 v[110:111], v[82:83], v[104:105] neg_lo:[0,1] neg_hi:[0,1]
  v_pk_fma_f32 v[116:117], v[110:111], v[110:111], v[116:117]
  s_mov_b32 s41, 0
  s_add_u32 m0, s42, 32704
  s_nop 0
  buffer_load_dwordx4 v185, s[80:83], s41 offen offset:64 lds
  v_pk_add_f32 v[108:109], v[84:85], v[104:105] neg_lo:[0,1] neg_hi:[0,1]
  v_pk_fma_f32 v[114:115], v[108:109], v[108:109], v[114:115]
  v_pk_add_f32 v[110:111], v[86:87], v[104:105] neg_lo:[0,1] neg_hi:[0,1]
  v_pk_fma_f32 v[116:117], v[110:111], v[110:111], v[116:117]
  v_pk_add_f32 v[108:109], v[88:89], v[104:105] neg_lo:[0,1] neg_hi:[0,1]
  v_pk_fma_f32 v[114:115], v[108:109], v[108:109], v[114:115]
  v_pk_add_f32 v[110:111], v[90:91], v[104:105] neg_lo:[0,1] neg_hi:[0,1]
  v_pk_fma_f32 v[116:117], v[110:111], v[110:111], v[116:117]
  v_pk_add_f32 v[108:109], v[92:93], v[104:105] neg_lo:[0,1] neg_hi:[0,1]
  s_mov_b32 s41, 393216
  s_add_u32 m0, s42, 34816
  s_nop 0
  buffer_load_dwordx4 v185, s[80:83], s41 offen offset:2048 lds
  v_pk_fma_f32 v[114:115], v[108:109], v[108:109], v[114:115]
  v_pk_add_f32 v[110:111], v[94:95], v[104:105] neg_lo:[0,1] neg_hi:[0,1]
  v_pk_fma_f32 v[116:117], v[110:111], v[110:111], v[116:117]
  v_pk_add_f32 v[108:109], v[96:97], v[104:105] neg_lo:[0,1] neg_hi:[0,1]
  v_pk_fma_f32 v[114:115], v[108:109], v[108:109], v[114:115]
  v_pk_add_f32 v[110:111], v[98:99], v[104:105] neg_lo:[0,1] neg_hi:[0,1]
  v_pk_fma_f32 v[116:117], v[110:111], v[110:111], v[116:117]
  v_pk_add_f32 v[108:109], v[100:101], v[104:105] neg_lo:[0,1] neg_hi:[0,1]
  v_pk_fma_f32 v[114:115], v[108:109], v[108:109], v[114:115]
  s_mov_b32 s41, 393216
  s_add_u32 m0, s42, 38848
  s_nop 0
  buffer_load_dwordx4 v185, s[80:83], s41 offen offset:2112 lds
  v_pk_add_f32 v[110:111], v[102:103], v[104:105] neg_lo:[0,1] neg_hi:[0,1]
  v_pk_fma_f32 v[116:117], v[110:111], v[110:111], v[116:117]
  v_pk_add_f32 v[114:115], v[114:115], v[116:117]
  v_add_f32 v105, v114, v115
  v_mov_b32 v115, v105
  s_nop 1
  v_permlane16_swap_b32 v115, v105
  s_nop 1
  v_add_f32 v105, v105, v115
  v_mov_b32 v115, v105
  s_nop 1
  v_permlane32_swap_b32 v115, v105
  s_mov_b32 s41, 393216
  s_add_u32 m0, s42, 45056
  s_nop 0
  buffer_load_dwordx4 v186, s[80:83], s41 offen offset:0 lds
  v_add_f32 v105, v105, v115
  ds_write_b64 v7, v[104:105] offset:8192
  s_waitcnt lgkmcnt(0)
  s_barrier
  ds_read_b128 v[120:123], v6 offset:8192
  ds_read_b128 v[124:127], v6 offset:8208
  s_waitcnt lgkmcnt(0)
  v_pk_add_f32 v[114:115], v[120:121], v[122:123]
  v_pk_add_f32 v[116:117], v[124:125], v[126:127]
  v_pk_add_f32 v[114:115], v[114:115], v[116:117]
  v_mul_f32 v104, 0x3e800000, v114
  v_sub_f32 v120, v120, v104
  v_sub_f32 v122, v122, v104
  v_sub_f32 v124, v124, v104
  v_sub_f32 v126, v126, v104
  s_mov_b32 s41, 393216
  s_add_u32 m0, s42, 49088
  s_nop 0
  buffer_load_dwordx4 v186, s[80:83], s41 offen offset:64 lds
  v_mul_f32 v116, v120, v120
  v_fmac_f32 v116, v122, v122
  v_fmac_f32 v116, v124, v124
  v_fmac_f32 v116, v126, v126
  v_mul_f32 v108, 0x3a800000, v115
  v_fmac_f32 v108, 0x3e800000, v116
  s_mov_b32 s30, 0
  buffer_load_dwordx4 v[120:123], v4, s[4:7], s30 offen sc1
  buffer_load_dwordx4 v[136:139], v5, s[4:7], s30 offen sc1
  s_mov_b32 s30, 24576
  buffer_load_dwordx4 v[124:127], v4, s[4:7], s30 offen sc1
  buffer_load_dwordx4 v[140:143], v5, s[4:7], s30 offen sc1
  s_mov_b32 s30, 49152
  buffer_load_dwordx4 v[128:131], v4, s[4:7], s30 offen sc1
  buffer_load_dwordx4 v[144:147], v5, s[4:7], s30 offen sc1
  s_mov_b32 s30, 73728
  buffer_load_dwordx4 v[132:135], v4, s[4:7], s30 offen sc1
  buffer_load_dwordx4 v[148:151], v5, s[4:7], s30 offen sc1
  v_cvt_pk_bf16_f32 v112, v104, v108
  v_lshlrev_b32 v104, 16, v112
  v_and_b32 v108, 0xffff0000, v112
  s_mov_b32 s41, 393216
  s_add_u32 m0, s42, 53248
  s_nop 0
  buffer_load_dwordx4 v185, s[80:83], s41 offen offset:0 lds
  v_add_f32 v108, 0x3727c5ac, v108
  v_cvt_pk_bf16_f32 v112, v108, v109
  v_lshlrev_b32 v108, 16, v112
  v_and_b32 v109, 0xffff0000, v112
  v_sqrt_f32 v108, v108
  s_nop 0
  v_cvt_pk_bf16_f32 v112, v108, v109
  v_lshlrev_b32 v108, 16, v112
  v_and_b32 v109, 0xffff0000, v112
  v_rcp_f32 v108, v108
  s_mov_b32 s41, 393216
  s_add_u32 m0, s42, 57280
  s_nop 0
  buffer_load_dwordx4 v185, s[80:83], s41 offen offset:64 lds
  v_mov_b32 v105, v104
  v_mov_b32 v109, v108
  v_pk_add_f32 v[40:41], v[40:41], v[104:105] neg_lo:[0,1] neg_hi:[0,1]
  v_pk_add_f32 v[42:43], v[42:43], v[104:105] neg_lo:[0,1] neg_hi:[0,1]
  v_pk_add_f32 v[44:45], v[44:45], v[104:105] neg_lo:[0,1] neg_hi:[0,1]
  v_pk_add_f32 v[46:47], v[46:47], v[104:105] neg_lo:[0,1] neg_hi:[0,1]
  v_pk_add_f32 v[48:49], v[48:49], v[104:105] neg_lo:[0,1] neg_hi:[0,1]
  v_pk_add_f32 v[50:51], v[50:51], v[104:105] neg_lo:[0,1] neg_hi:[0,1]
  v_pk_add_f32 v[52:53], v[52:53], v[104:105] neg_lo:[0,1] neg_hi:[0,1]
  s_mov_b32 s41, 786432
  s_add_u32 m0, s42, 59392
  s_nop 0
  buffer_load_dwordx4 v185, s[80:83], s41 offen offset:2048 lds
  v_pk_add_f32 v[54:55], v[54:55], v[104:105] neg_lo:[0,1] neg_hi:[0,1]
  v_pk_add_f32 v[56:57], v[56:57], v[104:105] neg_lo:[0,1] neg_hi:[0,1]
  v_pk_add_f32 v[58:59], v[58:59], v[104:105] neg_lo:[0,1] neg_hi:[0,1]
  v_pk_add_f32 v[60:61], v[60:61], v[104:105] neg_lo:[0,1] neg_hi:[0,1]
  v_pk_add_f32 v[62:63], v[62:63], v[104:105] neg_lo:[0,1] neg_hi:[0,1]
  v_pk_add_f32 v[64:65], v[64:65], v[104:105] neg_lo:[0,1] neg_hi:[0,1]
  v_pk_add_f32 v[66:67], v[66:67], v[104:105] neg_lo:[0,1] neg_hi:[0,1]
  v_pk_add_f32 v[68:69], v[68:69], v[104:105] neg_lo:[0,1] neg_hi:[0,1]
  v_pk_add_f32 v[70:71], v[70:71], v[104:105] neg_lo:[0,1] neg_hi:[0,1]
  s_mov_b32 s41, 786432
  s_add_u32 m0, s42, 63424
  s_nop 0
  buffer_load_dwordx4 v185, s[80:83], s41 offen offset:2112 lds
  v_pk_add_f32 v[72:73], v[72:73], v[104:105] neg_lo:[0,1] neg_hi:[0,1]
  v_pk_add_f32 v[74:75], v[74:75], v[104:105] neg_lo:[0,1] neg_hi:[0,1]
  v_pk_add_f32 v[76:77], v[76:77], v[104:105] neg_lo:[0,1] neg_hi:[0,1]
  v_pk_add_f32 v[78:79], v[78:79], v[104:105] neg_lo:[0,1] neg_hi:[0,1]
  v_pk_add_f32 v[80:81], v[80:81], v[104:105] neg_lo:[0,1] neg_hi:[0,1]
  v_pk_add_f32 v[82:83], v[82:83], v[104:105] neg_lo:[0,1] neg_hi:[0,1]
  v_pk_add_f32 v[84:85], v[84:85], v[104:105] neg_lo:[0,1] neg_hi:[0,1]
  v_pk_add_f32 v[86:87], v[86:87], v[104:105] neg_lo:[0,1] neg_hi:[0,1]
  v_pk_add_f32 v[88:89], v[88:89], v[104:105] neg_lo:[0,1] neg_hi:[0,1]
  s_mov_b32 s41, 786432
  s_add_u32 m0, s42, 69632
  s_nop 0
  buffer_load_dwordx4 v186, s[80:83], s41 offen offset:0 lds
  v_pk_add_f32 v[90:91], v[90:91], v[104:105] neg_lo:[0,1] neg_hi:[0,1]
  v_pk_add_f32 v[92:93], v[92:93], v[104:105] neg_lo:[0,1] neg_hi:[0,1]
  v_pk_add_f32 v[94:95], v[94:95], v[104:105] neg_lo:[0,1] neg_hi:[0,1]
  v_pk_add_f32 v[96:97], v[96:97], v[104:105] neg_lo:[0,1] neg_hi:[0,1]
  v_pk_add_f32 v[98:99], v[98:99], v[104:105] neg_lo:[0,1] neg_hi:[0,1]
  v_pk_add_f32 v[100:101], v[100:101], v[104:105] neg_lo:[0,1] neg_hi:[0,1]
  v_pk_add_f32 v[102:103], v[102:103], v[104:105] neg_lo:[0,1] neg_hi:[0,1]
  v_pk_mul_f32 v[40:41], v[40:41], v[108:109]
  v_pk_mul_f32 v[42:43], v[42:43], v[108:109]
  s_mov_b32 s41, 786432
  s_add_u32 m0, s42, 73664
  s_nop 0
  buffer_load_dwordx4 v186, s[80:83], s41 offen offset:64 lds
  v_pk_mul_f32 v[44:45], v[44:45], v[108:109]
  v_pk_mul_f32 v[46:47], v[46:47], v[108:109]
  v_pk_mul_f32 v[48:49], v[48:49], v[108:109]
  v_pk_mul_f32 v[50:51], v[50:51], v[108:109]
  v_pk_mul_f32 v[52:53], v[52:53], v[108:109]
  v_pk_mul_f32 v[54:55], v[54:55], v[108:109]
  v_pk_mul_f32 v[56:57], v[56:57], v[108:109]
  v_pk_mul_f32 v[58:59], v[58:59], v[108:109]
  v_pk_mul_f32 v[60:61], v[60:61], v[108:109]
  s_mov_b32 s41, 786432
  s_add_u32 m0, s42, 77824
  s_nop 0
  buffer_load_dwordx4 v185, s[80:83], s41 offen offset:0 lds
  v_pk_mul_f32 v[62:63], v[62:63], v[108:109]
  v_pk_mul_f32 v[64:65], v[64:65], v[108:109]
  v_pk_mul_f32 v[66:67], v[66:67], v[108:109]
  v_pk_mul_f32 v[68:69], v[68:69], v[108:109]
  v_pk_mul_f32 v[70:71], v[70:71], v[108:109]
  v_pk_mul_f32 v[72:73], v[72:73], v[108:109]
  v_pk_mul_f32 v[74:75], v[74:75], v[108:109]
  v_pk_mul_f32 v[76:77], v[76:77], v[108:109]
  v_pk_mul_f32 v[78:79], v[78:79], v[108:109]
  s_mov_b32 s41, 786432
  s_add_u32 m0, s42, 81856
  s_nop 0
  buffer_load_dwordx4 v185, s[80:83], s41 offen offset:64 lds
  v_pk_mul_f32 v[80:81], v[80:81], v[108:109]
  v_pk_mul_f32 v[82:83], v[82:83], v[108:109]
  v_pk_mul_f32 v[84:85], v[84:85], v[108:109]
  v_pk_mul_f32 v[86:87], v[86:87], v[108:109]
  v_pk_mul_f32 v[88:89], v[88:89], v[108:109]
  v_pk_mul_f32 v[90:91], v[90:91], v[108:109]
  v_pk_mul_f32 v[92:93], v[92:93], v[108:109]
  v_pk_mul_f32 v[94:95], v[94:95], v[108:109]
  v_pk_mul_f32 v[96:97], v[96:97], v[108:109]
  v_pk_mul_f32 v[98:99], v[98:99], v[108:109]
  v_pk_mul_f32 v[100:101], v[100:101], v[108:109]
  v_pk_mul_f32 v[102:103], v[102:103], v[108:109]
  s_mov_b32 s33, 262144
  s_waitcnt vmcnt(8)
  s_branch L_mchk_10
L_mod_8:
  s_mov_b32 s30, 0
  buffer_load_dwordx4 v[120:123], v4, s[4:7], s30 offen sc1
  buffer_load_dwordx4 v[136:139], v5, s[4:7], s30 offen sc1
  s_mov_b32 s30, 24576
  buffer_load_dwordx4 v[124:127], v4, s[4:7], s30 offen sc1
  buffer_load_dwordx4 v[140:143], v5, s[4:7], s30 offen sc1
  s_mov_b32 s30, 49152
  buffer_load_dwordx4 v[128:131], v4, s[4:7], s30 offen sc1
  buffer_load_dwordx4 v[144:147], v5, s[4:7], s30 offen sc1
  s_mov_b32 s30, 73728
  buffer_load_dwordx4 v[132:135], v4, s[4:7], s30 offen sc1
  buffer_load_dwordx4 v[148:151], v5, s[4:7], s30 offen sc1
  s_waitcnt vmcnt(0)
L_mchk_10:
  v_xor_b32 v120, s84, v120
  v_xor_b32 v121, s85, v121
  v_or_b32 v114, v120, v121
  v_xor_b32 v122, s86, v122
  v_xor_b32 v123, s87, v123
  v_or3_b32 v114, v114, v122, v123
  v_xor_b32 v124, s84, v124
  v_xor_b32 v125, s85, v125
  v_or3_b32 v114, v114, v124, v125
  v_xor_b32 v126, s86, v126
  v_xor_b32 v127, s87, v127
  v_or3_b32 v114, v114, v126, v127
  v_xor_b32 v128, s84, v128
  v_xor_b32 v129, s85, v129
  v_or3_b32 v114, v114, v128, v129
  v_xor_b32 v130, s86, v130
  v_xor_b32 v131, s87, v131
  v_or3_b32 v114, v114, v130, v131
  v_xor_b32 v132, s84, v132
  v_xor_b32 v133, s85, v133
  v_or3_b32 v114, v114, v132, v133
  v_xor_b32 v134, s86, v134
  v_xor_b32 v135, s87, v135
  v_or3_b32 v114, v114, v134, v135
  v_xor_b32 v136, s84, v136
  v_xor_b32 v137, s85, v137
  v_or3_b32 v114, v114, v136, v137
  v_xor_b32 v138, s86, v138
  v_xor_b32 v139, s87, v139
  v_or3_b32 v114, v114, v138, v139
  v_xor_b32 v140, s84, v140
  v_xor_b32 v141, s85, v141
  v_or3_b32 v114, v114, v140, v141
  v_xor_b32 v142, s86, v142
  v_xor_b32 v143, s87, v143
  v_or3_b32 v114, v114, v142, v143
  v_xor_b32 v144, s84, v144
  v_xor_b32 v145, s85, v145
  v_or3_b32 v114, v114, v144, v145
  v_xor_b32 v146, s86, v146
  v_xor_b32 v147, s87, v147
  v_or3_b32 v114, v114, v146, v147
  v_xor_b32 v148, s84, v148
  v_xor_b32 v149, s85, v149
  v_or3_b32 v114, v114, v148, v149
  v_xor_b32 v150, s86, v150
  v_xor_b32 v151, s87, v151
  v_or3_b32 v114, v114, v150, v151
  v_and_b32 v114, 0xff, v114
  v_cmp_ne_u32 s[68:69], 0, v114
  s_nop 1
  s_cmp_eq_u64 s[68:69], 0
  s_cbranch_scc1 L_mok_9
  s_sub_u32 s33, s33, 1
  s_cmp_lg_u32 s33, 0
  s_cbranch_scc1 L_mod_8
L_mok_9:
  v_pk_add_f32 v[120:121], v[120:121], v[124:125]
  v_pk_add_f32 v[128:129], v[128:129], v[132:133]
  v_pk_add_f32 v[122:123], v[122:123], v[126:127]
  v_pk_add_f32 v[130:131], v[130:131], v[134:135]
  v_pk_add_f32 v[136:137], v[136:137], v[140:141]
  v_pk_add_f32 v[144:145], v[144:145], v[148:149]
  v_pk_add_f32 v[138:139], v[138:139], v[142:143]
  v_pk_add_f32 v[146:147], v[146:147], v[150:151]
  v_pk_add_f32 v[120:121], v[120:121], v[128:129]
  v_pk_add_f32 v[122:123], v[122:123], v[130:131]
  v_pk_add_f32 v[136:137], v[136:137], v[144:145]
  v_pk_add_f32 v[138:139], v[138:139], v[146:147]
  v_cvt_pk_bf16_f32 v124, v120, v121
  v_lshlrev_b32 v120, 16, v124
  v_and_b32 v121, 0xffff0000, v124
  v_cvt_pk_bf16_f32 v126, v122, v123
  v_lshlrev_b32 v122, 16, v126
  v_and_b32 v123, 0xffff0000, v126
  v_cvt_pk_bf16_f32 v140, v136, v137
  v_lshlrev_b32 v136, 16, v140
  v_and_b32 v137, 0xffff0000, v140
  v_cvt_pk_bf16_f32 v142, v138, v139
  v_lshlrev_b32 v138, 16, v142
  v_and_b32 v139, 0xffff0000, v142
  ds_write_b128 v3, v[120:123]
  v_add_f32 v136, 1.0, v136
  v_add_f32 v137, 1.0, v137
  v_add_f32 v138, 1.0, v138
  v_add_f32 v139, 1.0, v139
  v_cvt_pk_bf16_f32 v140, v136, v137
  v_lshlrev_b32 v136, 16, v140
  v_and_b32 v137, 0xffff0000, v140
  v_cvt_pk_bf16_f32 v142, v138, v139
  v_lshlrev_b32 v138, 16, v142
  v_and_b32 v139, 0xffff0000, v142
  ds_write_b128 v3, v[136:139] offset:1024
  ds_read_b128 v[144:147], v222 offset:0
  ds_read_b128 v[148:151], v222 offset:16
  ds_read_b128 v[152:155], v222 offset:1024
  ds_read_b128 v[156:159], v222 offset:1040
  ds_read_b128 v[160:163], v222 offset:128
  ds_read_b128 v[164:167], v222 offset:144
  ds_read_b128 v[168:171], v222 offset:1152
  ds_read_b128 v[172:175], v222 offset:1168
  ds_read_b128 v[128:131], v222 offset:256
  ds_read_b128 v[132:135], v222 offset:272
  ds_read_b128 v[136:139], v222 offset:1280
  ds_read_b128 v[140:143], v222 offset:1296
  s_waitcnt lgkmcnt(8)
  v_pk_fma_f32 v[40:41], v[40:41], v[152:153], v[144:145]
  v_pk_fma_f32 v[42:43], v[42:43], v[154:155], v[146:147]
  v_pk_fma_f32 v[44:45], v[44:45], v[156:157], v[148:149]
  v_pk_fma_f32 v[46:47], v[46:47], v[158:159], v[150:151]
  v_cvt_pk_bf16_f32 v8, v40, v41
  v_cvt_pk_bf16_f32 v9, v42, v43
  v_cvt_pk_bf16_f32 v10, v44, v45
  v_cvt_pk_bf16_f32 v11, v46, v47
  s_add_u32 s33, s1, 0
  v_permlane16_swap_b32 v8, v10
  v_permlane16_swap_b32 v9, v11
  s_nop 1
  buffer_store_dwordx4 v[8:11], v251, s[4:7], s33 offen sc1
  ds_read_b128 v[144:147], v222 offset:384
  ds_read_b128 v[148:151], v222 offset:400
  ds_read_b128 v[152:155], v222 offset:1408
  ds_read_b128 v[156:159], v222 offset:1424
  s_waitcnt lgkmcnt(8)
  v_pk_fma_f32 v[48:49], v[48:49], v[168:169], v[160:161]
  v_pk_fma_f32 v[50:51], v[50:51], v[170:171], v[162:163]
  v_pk_fma_f32 v[52:53], v[52:53], v[172:173], v[164:165]
  v_pk_fma_f32 v[54:55], v[54:55], v[174:175], v[166:167]
  v_cvt_pk_bf16_f32 v12, v48, v49
  v_cvt_pk_bf16_f32 v13, v50, v51
  v_cvt_pk_bf16_f32 v14, v52, v53
  v_cvt_pk_bf16_f32 v15, v54, v55
  s_add_u32 s33, s1, 131072
  v_permlane16_swap_b32 v12, v14
  v_permlane16_swap_b32 v13, v15
  s_nop 1
  buffer_store_dwordx4 v[12:15], v251, s[4:7], s33 offen sc1
  ds_read_b128 v[160:163], v222 offset:512
  ds_read_b128 v[164:167], v222 offset:528
  ds_read_b128 v[168:171], v222 offset:1536
  ds_read_b128 v[172:175], v222 offset:1552
  s_waitcnt lgkmcnt(8)
  v_pk_fma_f32 v[56:57], v[56:57], v[136:137], v[128:129]
  v_pk_fma_f32 v[58:59], v[58:59], v[138:139], v[130:131]
  v_pk_fma_f32 v[60:61], v[60:61], v[140:141], v[132:133]
  v_pk_fma_f32 v[62:63], v[62:63], v[142:143], v[134:135]
  v_cvt_pk_bf16_f32 v16, v56, v57
  v_cvt_pk_bf16_f32 v17, v58, v59
  v_cvt_pk_bf16_f32 v18, v60, v61
  v_cvt_pk_bf16_f32 v19, v62, v63
  s_add_u32 s33, s1, 1048576
  v_permlane16_swap_b32 v16, v18
  v_permlane16_swap_b32 v17, v19
  s_nop 1
  buffer_store_dwordx4 v[16:19], v251, s[4:7], s33 offen sc1
  ds_read_b128 v[128:131], v222 offset:640
  ds_read_b128 v[132:135], v222 offset:656
  ds_read_b128 v[136:139], v222 offset:1664
  ds_read_b128 v[140:143], v222 offset:1680
  s_waitcnt lgkmcnt(8)
  v_pk_fma_f32 v[64:65], v[64:65], v[152:153], v[144:145]
  v_pk_fma_f32 v[66:67], v[66:67], v[154:155], v[146:147]
  v_pk_fma_f32 v[68:69], v[68:69], v[156:157], v[148:149]
  v_pk_fma_f32 v[70:71], v[70:71], v[158:159], v[150:151]
  v_cvt_pk_bf16_f32 v20, v64, v65
  v_cvt_pk_bf16_f32 v21, v66, v67
  v_cvt_pk_bf16_f32 v22, v68, v69
  v_cvt_pk_bf16_f32 v23, v70, v71
  s_add_u32 s33, s1, 1179648
  v_permlane16_swap_b32 v20, v22
  v_permlane16_swap_b32 v21, v23
  s_nop 1
  buffer_store_dwordx4 v[20:23], v251, s[4:7], s33 offen sc1
  ds_read_b128 v[144:147], v222 offset:768
  ds_read_b128 v[148:151], v222 offset:784
  ds_read_b128 v[152:155], v222 offset:1792
  ds_read_b128 v[156:159], v222 offset:1808
  s_waitcnt lgkmcnt(8)
  v_pk_fma_f32 v[72:73], v[72:73], v[168:169], v[160:161]
  v_pk_fma_f32 v[74:75], v[74:75], v[170:171], v[162:163]
  v_pk_fma_f32 v[76:77], v[76:77], v[172:173], v[164:165]
  v_pk_fma_f32 v[78:79], v[78:79], v[174:175], v[166:167]
  v_cvt_pk_bf16_f32 v24, v72, v73
  v_cvt_pk_bf16_f32 v25, v74, v75
  v_cvt_pk_bf16_f32 v26, v76, v77
  v_cvt_pk_bf16_f32 v27, v78, v79
  s_add_u32 s33, s1, 2097152
  v_permlane16_swap_b32 v24, v26
  v_permlane16_swap_b32 v25, v27
  s_nop 1
  buffer_store_dwordx4 v[24:27], v251, s[4:7], s33 offen sc1
  ds_read_b128 v[160:163], v222 offset:896
  ds_read_b128 v[164:167], v222 offset:912
  ds_read_b128 v[168:171], v222 offset:1920
  ds_read_b128 v[172:175], v222 offset:1936
  s_waitcnt lgkmcnt(8)
  v_pk_fma_f32 v[80:81], v[80:81], v[136:137], v[128:129]
  v_pk_fma_f32 v[82:83], v[82:83], v[138:139], v[130:131]
  v_pk_fma_f32 v[84:85], v[84:85], v[140:141], v[132:133]
  v_pk_fma_f32 v[86:87], v[86:87], v[142:143], v[134:135]
  v_cvt_pk_bf16_f32 v28, v80, v81
  v_cvt_pk_bf16_f32 v29, v82, v83
  v_cvt_pk_bf16_f32 v30, v84, v85
  v_cvt_pk_bf16_f32 v31, v86, v87
  s_add_u32 s33, s1, 2228224
  v_permlane16_swap_b32 v28, v30
  v_permlane16_swap_b32 v29, v31
  s_nop 1
  buffer_store_dwordx4 v[28:31], v251, s[4:7], s33 offen sc1
  s_waitcnt lgkmcnt(4)
  v_pk_fma_f32 v[88:89], v[88:89], v[152:153], v[144:145]
  v_pk_fma_f32 v[90:91], v[90:91], v[154:155], v[146:147]
  v_pk_fma_f32 v[92:93], v[92:93], v[156:157], v[148:149]
  v_pk_fma_f32 v[94:95], v[94:95], v[158:159], v[150:151]
  v_cvt_pk_bf16_f32 v32, v88, v89
  v_cvt_pk_bf16_f32 v33, v90, v91
  v_cvt_pk_bf16_f32 v34, v92, v93
  v_cvt_pk_bf16_f32 v35, v94, v95
  s_add_u32 s33, s1, 3145728
  v_permlane16_swap_b32 v32, v34
  v_permlane16_swap_b32 v33, v35
  s_nop 1
  buffer_store_dwordx4 v[32:35], v251, s[4:7], s33 offen sc1
  s_waitcnt lgkmcnt(0)
  v_pk_fma_f32 v[96:97], v[96:97], v[168:169], v[160:161]
  v_pk_fma_f32 v[98:99], v[98:99], v[170:171], v[162:163]
  v_pk_fma_f32 v[100:101], v[100:101], v[172:173], v[164:165]
  v_pk_fma_f32 v[102:103], v[102:103], v[174:175], v[166:167]
  v_cvt_pk_bf16_f32 v36, v96, v97
  v_cvt_pk_bf16_f32 v37, v98, v99
  v_cvt_pk_bf16_f32 v38, v100, v101
  v_cvt_pk_bf16_f32 v39, v102, v103
  s_add_u32 s33, s1, 3276800
  v_permlane16_swap_b32 v36, v38
  v_permlane16_swap_b32 v37, v39
  s_nop 1
  buffer_store_dwordx4 v[36:39], v251, s[4:7], s33 offen sc1
  s_waitcnt vmcnt(6)
  v_add_u32 v248, 0, v245
  buffer_store_dword v248, v246, s[4:7], s0 offen sc1
  s_waitcnt vmcnt(1)
  v_add_u32 v248, 1, v245
  buffer_store_dword v248, v246, s[4:7], s0 offen sc1
  s_mov_b32 s41, 1179648
  s_add_u32 m0, s42, 83968
  s_nop 0
  buffer_load_dwordx4 v185, s[80:83], s41 offen offset:2048 lds
  s_mov_b32 s41, 1179648
  s_add_u32 m0, s42, 88000
  s_nop 0
  buffer_load_dwordx4 v185, s[80:83], s41 offen offset:2112 lds
  s_mov_b32 s41, 1179648
  s_add_u32 m0, s42, 94208
  s_nop 0
  buffer_load_dwordx4 v186, s[80:83], s41 offen offset:0 lds
  s_mov_b32 s41, 1179648
  s_add_u32 m0, s42, 98240
  s_nop 0
  buffer_load_dwordx4 v186, s[80:83], s41 offen offset:64 lds
  s_mov_b32 s41, 1179648
  s_add_u32 m0, s42, 102400
  s_nop 0
  buffer_load_dwordx4 v185, s[80:83], s41 offen offset:0 lds
  s_mov_b32 s41, 1179648
  s_add_u32 m0, s42, 106432
  s_nop 0
  buffer_load_dwordx4 v185, s[80:83], s41 offen offset:64 lds
  s_mov_b32 s41, 1572864
  s_add_u32 m0, s42, 108544
  s_nop 0
  buffer_load_dwordx4 v185, s[80:83], s41 offen offset:2048 lds
  s_mov_b32 s41, 1572864
  s_add_u32 m0, s42, 112576
  s_nop 0
  buffer_load_dwordx4 v185, s[80:83], s41 offen offset:2112 lds
  s_mov_b32 s41, 1572864
  s_add_u32 m0, s42, 118784
  s_nop 0
  buffer_load_dwordx4 v186, s[80:83], s41 offen offset:0 lds
  s_mov_b32 s41, 1572864
  s_add_u32 m0, s42, 122816
  s_nop 0
  buffer_load_dwordx4 v186, s[80:83], s41 offen offset:64 lds
  s_mov_b32 s41, 1572864
  s_add_u32 m0, s42, 126976
  s_nop 0
  buffer_load_dwordx4 v185, s[80:83], s41 offen offset:0 lds
  s_mov_b32 s41, 1572864
  s_add_u32 m0, s42, 131008
  s_nop 0
  buffer_load_dwordx4 v185, s[80:83], s41 offen offset:64 lds
  s_mov_b32 s41, 1966080
  s_add_u32 m0, s42, 133120
  s_nop 0
  buffer_load_dwordx4 v185, s[80:83], s41 offen offset:2048 lds
  s_mov_b32 s41, 1966080
  s_add_u32 m0, s42, 137152
  s_nop 0
  buffer_load_dwordx4 v185, s[80:83], s41 offen offset:2112 lds
  s_mov_b32 s41, 1966080
  s_add_u32 m0, s42, 143360
  s_nop 0
  buffer_load_dwordx4 v186, s[80:83], s41 offen offset:0 lds
  s_mov_b32 s41, 1966080
  s_add_u32 m0, s42, 147392
  s_nop 0
  buffer_load_dwordx4 v186, s[80:83], s41 offen offset:64 lds
  s_mov_b32 s41, 1966080
  s_add_u32 m0, s42, 151552
  s_nop 0
  buffer_load_dwordx4 v185, s[80:83], s41 offen offset:0 lds
  s_mov_b32 s41, 1966080
  s_add_u32 m0, s42, 155584
  s_nop 0
  buffer_load_dwordx4 v185, s[80:83], s41 offen offset:64 lds
L_j2_5:
  s_mov_b64 vcc, 0
  s_mov_b64 vcc, -1
  s_cmp_eq_u32 s3, 0
  s_cbranch_scc1 L_wk0_0
  s_cmp_eq_u32 s3, 1
  s_cbranch_scc1 L_wk0_1
  s_cmp_eq_u32 s3, 2
  s_cbranch_scc1 L_wk0_2
  s_branch L_wk0_3
L_wk0_end:
  s_mov_b64 vcc, 0
  s_branch L_hot
  .p2align 12
L_hot:
  s_mov_b32 s33, 262144
L_spin_11:
  buffer_load_dword v244, v189, s[4:7], 0 offen sc1
  s_waitcnt vmcnt(0)
  v_subrev_u32 v244, s100, v244
  v_cmp_lt_u32 s[68:69], 7, v244
  s_nop 1
  s_cmp_eq_u64 s[68:69], 0
  s_cbranch_scc1 L_ok_12
  s_sub_u32 s33, s33, 1
  s_cmp_lg_u32 s33, 0
  s_cbranch_scc1 L_spin_11
L_ok_12:
  s_mov_b32 s40, 1048576
  buffer_load_dwordx4 a[0:3], v187, s[4:7], s40 offen offset:0 sc1
  buffer_load_dwordx4 a[4:7], v187, s[4:7], s40 offen offset:1024 sc1
  s_mov_b32 s40, 1179648
  buffer_load_dwordx4 a[8:11], v187, s[4:7], s40 offen offset:0 sc1
  buffer_load_dwordx4 a[12:15], v187, s[4:7], s40 offen offset:1024 sc1
  s_mov_b32 s40, 1310720
  buffer_load_dwordx4 a[16:19], v187, s[4:7], s40 offen offset:0 sc1
  buffer_load_dwordx4 a[20:23], v187, s[4:7], s40 offen offset:1024 sc1
  s_mov_b32 s40, 1441792
  buffer_load_dwordx4 a[24:27], v187, s[4:7], s40 offen offset:0 sc1
  buffer_load_dwordx4 a[28:31], v187, s[4:7], s40 offen offset:1024 sc1
  s_barrier
  ds_read_b64_tr_b16 a[192:193], v176 offset:12288
  ds_read_b64_tr_b16 a[194:195], v176 offset:13312
  ds_read_b64_tr_b16 a[196:197], v176 offset:14336
  ds_read_b64_tr_b16 a[198:199], v176 offset:15360
  ds_read_b64_tr_b16 a[200:201], v177 offset:12288
  ds_read_b64_tr_b16 a[202:203], v177 offset:13312
  ds_read_b64_tr_b16 a[204:205], v177 offset:14336
  ds_read_b64_tr_b16 a[206:207], v177 offset:15360
  ds_read_b64_tr_b16 a[208:209], v176 offset:20480
  ds_read_b64_tr_b16 a[210:211], v176 offset:21504
  ds_read_b64_tr_b16 a[212:213], v176 offset:22528
  ds_read_b64_tr_b16 a[214:215], v176 offset:23552
  ds_read_b64_tr_b16 a[216:217], v177 offset:20480
  ds_read_b64_tr_b16 a[218:219], v177 offset:21504
  ds_read_b64_tr_b16 a[220:221], v177 offset:22528
  ds_read_b64_tr_b16 a[222:223], v177 offset:23552
  ds_read_b64_tr_b16 a[224:225], v176 offset:28672
  ds_read_b64_tr_b16 a[226:227], v176 offset:29696
  ds_read_b64_tr_b16 a[228:229], v176 offset:30720
  ds_read_b64_tr_b16 a[230:231], v176 offset:31744
  ds_read_b64_tr_b16 a[232:233], v177 offset:28672
  ds_read_b64_tr_b16 a[234:235], v177 offset:29696
  s_mov_b32 s40, 1572864
  buffer_load_dword v244, v189, s[4:7], 0 offen sc1
  s_waitcnt vmcnt(5) lgkmcnt(13)
  v_mfma_f32_16x16x32_bf16 v[8:11], a[192:195], a[0:3], 0
  v_mfma_f32_16x16x32_bf16 v[8:11], a[196:199], a[8:11], v[8:11]
  buffer_load_dwordx4 a[32:35], v187, s[4:7], s40 offen offset:0 sc1
  v_mfma_f32_16x16x32_bf16 v[32:35], a[192:195], a[4:7], 0
  ds_read_b64_tr_b16 a[192:193], v177 offset:30720
  ds_read_b64_tr_b16 a[194:195], v177 offset:31744
  v_mfma_f32_16x16x32_bf16 v[32:35], a[196:199], a[12:15], v[32:35]
  ds_read_b64_tr_b16 a[196:197], v176 offset:16384
  ds_read_b64_tr_b16 a[198:199], v176 offset:17408
  v_mfma_f32_16x16x32_bf16 v[36:39], a[200:203], a[4:7], 0
  buffer_load_dwordx4 a[36:39], v187, s[4:7], s40 offen offset:1024 sc1
  s_mov_b32 s40, 1703936
  v_mfma_f32_16x16x32_bf16 v[36:39], a[204:207], a[12:15], v[36:39]
  v_mfma_f32_16x16x32_bf16 v[12:15], a[200:203], a[0:3], 0
  ds_read_b64_tr_b16 a[200:201], v176 offset:18432
  ds_read_b64_tr_b16 a[202:203], v176 offset:19456
  v_mfma_f32_16x16x32_bf16 v[12:15], a[204:207], a[8:11], v[12:15]
  ds_read_b64_tr_b16 a[204:205], v177 offset:16384
  ds_read_b64_tr_b16 a[206:207], v177 offset:17408
  s_waitcnt lgkmcnt(13)
  v_mfma_f32_16x16x32_bf16 v[16:19], a[0:3], a[208:211], 0
  buffer_load_dwordx4 a[40:43], v187, s[4:7], s40 offen offset:0 sc1
  v_mfma_f32_16x16x32_bf16 v[16:19], a[8:11], a[212:215], v[16:19]
  v_mfma_f32_16x16x32_bf16 v[40:43], a[4:7], a[208:211], 0
  ds_read_b64_tr_b16 a[208:209], v177 offset:18432
  ds_read_b64_tr_b16 a[210:211], v177 offset:19456
  v_mfma_f32_16x16x32_bf16 v[40:43], a[12:15], a[212:215], v[40:43]
  ds_read_b64_tr_b16 a[212:213], v176 offset:24576
  ds_read_b64_tr_b16 a[214:215], v176 offset:25600
  v_mfma_f32_16x16x32_bf16 v[44:47], a[4:7], a[216:219], 0
  buffer_load_dwordx4 a[44:47], v187, s[4:7], s40 offen offset:1024 sc1
  v_mfma_f32_16x16x32_bf16 v[44:47], a[12:15], a[220:223], v[44:47]
  s_mov_b32 s40, 1835008
  v_mfma_f32_16x16x32_bf16 v[20:23], a[0:3], a[216:219], 0
  ds_read_b64_tr_b16 a[216:217], v176 offset:26624
  ds_read_b64_tr_b16 a[218:219], v176 offset:27648
  v_mfma_f32_16x16x32_bf16 v[20:23], a[8:11], a[220:223], v[20:23]
  ds_read_b64_tr_b16 a[220:221], v177 offset:24576
  ds_read_b64_tr_b16 a[222:223], v177 offset:25600
  s_waitcnt lgkmcnt(13)
  v_mfma_f32_16x16x32_bf16 v[0:3], a[224:227], a[0:3], 0
  buffer_load_dwordx4 a[48:51], v187, s[4:7], s40 offen offset:0 sc1
  v_mfma_f32_16x16x32_bf16 v[0:3], a[228:231], a[8:11], v[0:3]
  v_mfma_f32_16x16x32_bf16 v[24:27], a[224:227], a[4:7], 0
  ds_read_b64_tr_b16 a[224:225], v177 offset:26624
  ds_read_b64_tr_b16 a[226:227], v177 offset:27648
  v_mfma_f32_16x16x32_bf16 v[24:27], a[228:231], a[12:15], v[24:27]
  ds_read_b64_tr_b16 a[228:229], v176 offset:32768
  ds_read_b64_tr_b16 a[230:231], v176 offset:33792
  v_mfma_f32_16x16x32_bf16 v[28:31], a[232:235], a[4:7], 0
  buffer_load_dwordx4 a[52:55], v187, s[4:7], s40 offen offset:1024 sc1
  s_mov_b32 s40, 1966080
  v_mfma_f32_16x16x32_bf16 v[28:31], a[192:195], a[12:15], v[28:31]
  v_mfma_f32_16x16x32_bf16 v[4:7], a[232:235], a[0:3], 0
  ds_read_b64_tr_b16 a[232:233], v176 offset:34816
  ds_read_b64_tr_b16 a[234:235], v176 offset:35840
  v_mfma_f32_16x16x32_bf16 v[4:7], a[192:195], a[8:11], v[4:7]
  s_barrier
  ds_read_b64_tr_b16 a[192:193], v177 offset:32768
  s_waitcnt lgkmcnt(13)
  v_mfma_f32_16x16x32_bf16 v[56:59], a[196:199], a[0:3], 0
  buffer_load_dwordx4 a[56:59], v187, s[4:7], s40 offen offset:0 sc1
  v_mfma_f32_16x16x32_bf16 v[56:59], a[200:203], a[8:11], v[56:59]
  ds_read_b64_tr_b16 a[194:195], v177 offset:33792
  v_mfma_f32_16x16x32_bf16 v[80:83], a[196:199], a[4:7], 0
  ds_read_b64_tr_b16 a[196:197], v177 offset:34816
  ds_read_b64_tr_b16 a[198:199], v177 offset:35840
  v_mfma_f32_16x16x32_bf16 v[80:83], a[200:203], a[12:15], v[80:83]
  ds_read_b64_tr_b16 a[200:201], v176 offset:36864
  ds_read_b64_tr_b16 a[202:203], v176 offset:37888
  s_waitcnt vmcnt(7)
  v_subrev_u32 v244, s100, v244
  v_subrev_u32 v244, 1, v244
  v_mfma_f32_16x16x32_bf16 v[84:87], a[204:207], a[4:7], 0
  buffer_load_dwordx4 a[60:63], v187, s[4:7], s40 offen offset:1024 sc1
  v_cmp_lt_u32 s[68:69], 6, v244
  v_mfma_f32_16x16x32_bf16 v[84:87], a[208:211], a[12:15], v[84:87]
  s_mov_b32 s41, 2359296
  s_add_u32 m0, s42, 157696
  s_cmp_lg_u64 s[68:69], 0
  s_cbranch_scc1 L_slow_13
L_back_14:
  v_mfma_f32_16x16x32_bf16 v[60:63], a[204:207], a[0:3], 0
  ds_read_b64_tr_b16 a[204:205], v176 offset:38912
  ds_read_b64_tr_b16 a[206:207], v176 offset:39936
  s_load_dwordx2 s[66:67], s[36:37], 0x0
  v_mfma_f32_16x16x32_bf16 v[60:63], a[208:211], a[8:11], v[60:63]
  ds_read_b64_tr_b16 a[208:209], v177 offset:36864
  ds_read_b64_tr_b16 a[210:211], v177 offset:37888
  s_waitcnt lgkmcnt(13)
  v_mfma_f32_16x16x32_bf16 v[64:67], a[0:3], a[212:215], 0
  buffer_load_dwordx4 v185, s[80:83], s41 offen offset:2048 lds
  s_add_u32 m0, s42, 10176
  v_mfma_f32_16x16x32_bf16 v[64:67], a[8:11], a[216:219], v[64:67]
  v_mfma_f32_16x16x32_bf16 v[88:91], a[4:7], a[212:215], 0
  ds_read_b64_tr_b16 a[212:213], v177 offset:38912
  ds_read_b64_tr_b16 a[214:215], v177 offset:39936
  v_mfma_f32_16x16x32_bf16 v[88:91], a[12:15], a[216:219], v[88:91]
  ds_read_b64_tr_b16 a[216:217], v176 offset:45056
  ds_read_b64_tr_b16 a[218:219], v176 offset:46080
  v_mfma_f32_16x16x32_bf16 v[92:95], a[4:7], a[220:223], 0
  buffer_load_dwordx4 v185, s[80:83], s41 offen offset:2112 lds
  v_mfma_f32_16x16x32_bf16 v[92:95], a[12:15], a[224:227], v[92:95]
  s_mov_b32 s40, 2097152
  v_mfma_f32_16x16x32_bf16 v[68:71], a[0:3], a[220:223], 0
  ds_read_b64_tr_b16 a[220:221], v176 offset:47104
  ds_read_b64_tr_b16 a[222:223], v176 offset:48128
  v_mfma_f32_16x16x32_bf16 v[68:71], a[8:11], a[224:227], v[68:71]
  ds_read_b64_tr_b16 a[224:225], v177 offset:45056
  ds_read_b64_tr_b16 a[226:227], v177 offset:46080
  s_waitcnt lgkmcnt(13)
  v_mfma_f32_16x16x32_bf16 v[48:51], a[228:231], a[0:3], 0
  buffer_load_dwordx4 a[64:67], v187, s[4:7], s40 offen offset:0 sc1
  v_mfma_f32_16x16x32_bf16 v[48:51], a[232:235], a[8:11], v[48:51]
  v_mfma_f32_16x16x32_bf16 v[72:75], a[228:231], a[4:7], 0
  ds_read_b64_tr_b16 a[228:229], v177 offset:47104
  ds_read_b64_tr_b16 a[230:231], v177 offset:48128
  v_mfma_f32_16x16x32_bf16 v[72:75], a[232:235], a[12:15], v[72:75]
  ds_read_b64_tr_b16 a[232:233], v176 offset:53248
  ds_read_b64_tr_b16 a[234:235], v176 offset:54272
  v_mfma_f32_16x16x32_bf16 v[76:79], a[192:195], a[4:7], 0
  buffer_load_dwordx4 a[68:71], v187, s[4:7], s40 offen offset:1024 sc1
  s_mov_b32 s40, 2228224
  v_mfma_f32_16x16x32_bf16 v[76:79], a[196:199], a[12:15], v[76:79]
  v_mfma_f32_16x16x32_bf16 v[52:55], a[192:195], a[0:3], 0
  ds_read_b64_tr_b16 a[192:193], v176 offset:55296
  ds_read_b64_tr_b16 a[194:195], v176 offset:56320
  v_mfma_f32_16x16x32_bf16 v[52:55], a[196:199], a[8:11], v[52:55]
  s_barrier
  ds_read_b64_tr_b16 a[196:197], v177 offset:53248
  s_load_dwordx2 s[66:67], s[36:37], 0x1ff80
  s_waitcnt lgkmcnt(13)
  v_mfma_f32_16x16x32_bf16 v[8:11], a[200:203], a[16:19], v[8:11]
  buffer_load_dwordx4 a[72:75], v187, s[4:7], s40 offen offset:0 sc1
  v_mfma_f32_16x16x32_bf16 v[8:11], a[204:207], a[24:27], v[8:11]
  ds_read_b64_tr_b16 a[198:199], v177 offset:54272
  v_mfma_f32_16x16x32_bf16 v[32:35], a[200:203], a[20:23], v[32:35]
  ds_read_b64_tr_b16 a[200:201], v177 offset:55296
  ds_read_b64_tr_b16 a[202:203], v177 offset:56320
  v_mfma_f32_16x16x32_bf16 v[32:35], a[204:207], a[28:31], v[32:35]
  ds_read_b64_tr_b16 a[204:205], v176 offset:40960
  ds_read_b64_tr_b16 a[206:207], v176 offset:41984
  v_mfma_f32_16x16x32_bf16 v[36:39], a[208:211], a[20:23], v[36:39]
  buffer_load_dwordx4 a[76:79], v187, s[4:7], s40 offen offset:1024 sc1
  v_mfma_f32_16x16x32_bf16 v[36:39], a[212:215], a[28:31], v[36:39]
  s_mov_b32 s40, 2359296
  v_mfma_f32_16x16x32_bf16 v[12:15], a[208:211], a[16:19], v[12:15]
  ds_read_b64_tr_b16 a[208:209], v176 offset:43008
  ds_read_b64_tr_b16 a[210:211], v176 offset:44032
  v_mfma_f32_16x16x32_bf16 v[12:15], a[212:215], a[24:27], v[12:15]
  ds_read_b64_tr_b16 a[212:213], v177 offset:40960
  ds_read_b64_tr_b16 a[214:215], v177 offset:41984
  s_waitcnt lgkmcnt(13)
  v_mfma_f32_16x16x32_bf16 v[16:19], a[16:19], a[216:219], v[16:19]
  buffer_load_dwordx4 a[80:83], v187, s[4:7], s40 offen offset:0 sc1
  v_mfma_f32_16x16x32_bf16 v[16:19], a[24:27], a[220:223], v[16:19]
  v_mfma_f32_16x16x32_bf16 v[40:43], a[20:23], a[216:219], v[40:43]
  ds_read_b64_tr_b16 a[216:217], v177 offset:43008
  ds_read_b64_tr_b16 a[218:219], v177 offset:44032
  v_mfma_f32_16x16x32_bf16 v[40:43], a[28:31], a[220:223], v[40:43]
  ds_read_b64_tr_b16 a[220:221], v176 offset:49152
  ds_read_b64_tr_b16 a[222:223], v176 offset:50176
  v_mov_b32 v196, 0
  v_mfma_f32_16x16x32_bf16 v[44:47], a[20:23], a[224:227], v[44:47]
  buffer_load_dwordx4 a[84:87], v187, s[4:7], s40 offen offset:1024 sc1
  s_mov_b32 s40, 2490368
  v_mfma_f32_16x16x32_bf16 v[44:47], a[28:31], a[228:231], v[44:47]
  v_mov_b32 v197, 0
  v_mov_b32 v198, 0
  v_mov_b32 v199, 0
  v_mfma_f32_16x16x32_bf16 v[20:23], a[16:19], a[224:227], v[20:23]
  ds_read_b64_tr_b16 a[224:225], v176 offset:51200
  ds_read_b64_tr_b16 a[226:227], v176 offset:52224
  ds_write_b128 v251, v[196:199] offset:8192
  v_mfma_f32_16x16x32_bf16 v[20:23], a[24:27], a[228:231], v[20:23]
  ds_read_b64_tr_b16 a[228:229], v177 offset:49152
  ds_read_b64_tr_b16 a[230:231], v177 offset:50176
  ds_write_b128 v251, v[196:199] offset:9216
  s_waitcnt lgkmcnt(13)
  v_mfma_f32_16x16x32_bf16 v[0:3], a[232:235], a[16:19], v[0:3]
  buffer_load_dwordx4 a[88:91], v187, s[4:7], s40 offen offset:0 sc1
  v_mov_b32 v145, v245
  s_load_dwordx2 s[66:67], s[36:37], 0x3ff00
  v_mfma_f32_16x16x32_bf16 v[0:3], a[192:195], a[24:27], v[0:3]
  v_mov_b32 v147, v245
  v_mov_b32 v149, v245
  v_mov_b32 v151, v245
  v_mfma_f32_16x16x32_bf16 v[24:27], a[232:235], a[20:23], v[24:27]
  ds_read_b64_tr_b16 a[232:233], v177 offset:51200
  ds_read_b64_tr_b16 a[234:235], v177 offset:52224
  v_mov_b32 v153, v245
  v_mfma_f32_16x16x32_bf16 v[24:27], a[192:195], a[28:31], v[24:27]
  ds_read_b64_tr_b16 a[192:193], v176 offset:57344
  ds_read_b64_tr_b16 a[194:195], v176 offset:58368
  v_mov_b32 v155, v245
  v_mfma_f32_16x16x32_bf16 v[28:31], a[196:199], a[20:23], v[28:31]
  buffer_load_dwordx4 a[92:95], v187, s[4:7], s40 offen offset:1024 sc1
  v_mov_b32 v157, v245
  v_mfma_f32_16x16x32_bf16 v[28:31], a[200:203], a[28:31], v[28:31]
  s_add_u32 m0, s42, 20480
  v_mov_b32 v159, v245
  v_mfma_f32_16x16x32_bf16 v[4:7], a[196:199], a[16:19], v[4:7]
  ds_read_b64_tr_b16 a[196:197], v176 offset:59392
  ds_read_b64_tr_b16 a[198:199], v176 offset:60416
  v_mfma_f32_16x16x32_bf16 v[4:7], a[200:203], a[24:27], v[4:7]
  s_barrier
  ds_read_b64_tr_b16 a[200:201], v177 offset:57344
  v_mfma_f32_16x16x32_bf16 v[56:59], a[204:207], a[16:19], v[56:59]
  buffer_load_dwordx4 v186, s[80:83], s41 offen offset:0 lds
  s_add_u32 m0, s42, 28608
  s_waitcnt lgkmcnt(13)
  v_mfma_f32_16x16x32_bf16 v[56:59], a[208:211], a[24:27], v[56:59]
  ds_read_b64_tr_b16 a[202:203], v177 offset:58368
  v_mfma_f32_16x16x32_bf16 v[80:83], a[204:207], a[20:23], v[80:83]
  ds_read_b64_tr_b16 a[204:205], v177 offset:59392
  ds_read_b64_tr_b16 a[206:207], v177 offset:60416
  v_mfma_f32_16x16x32_bf16 v[80:83], a[208:211], a[28:31], v[80:83]
  ds_read_b64_tr_b16 a[208:209], v176 offset:61440
  ds_read_b64_tr_b16 a[210:211], v176 offset:62464
  v_mfma_f32_16x16x32_bf16 v[84:87], a[212:215], a[20:23], v[84:87]
  buffer_load_dwordx4 v186, s[80:83], s41 offen offset:64 lds
  v_mfma_f32_16x16x32_bf16 v[84:87], a[216:219], a[28:31], v[84:87]
  s_add_u32 m0, s42, 16384
  v_mfma_f32_16x16x32_bf16 v[60:63], a[212:215], a[16:19], v[60:63]
  ds_read_b64_tr_b16 a[212:213], v176 offset:63488
  ds_read_b64_tr_b16 a[214:215], v176 offset:64512
  v_mfma_f32_16x16x32_bf16 v[60:63], a[216:219], a[24:27], v[60:63]
  ds_read_b64_tr_b16 a[216:217], v177 offset:61440
  ds_read_b64_tr_b16 a[218:219], v177 offset:62464
  v_mfma_f32_16x16x32_bf16 v[64:67], a[16:19], a[220:223], v[64:67]
  buffer_load_dwordx4 v185, s[80:83], s41 offen offset:0 lds
  s_add_u32 m0, s42, 24512
  s_waitcnt lgkmcnt(13)
  v_mfma_f32_16x16x32_bf16 v[64:67], a[24:27], a[224:227], v[64:67]
  s_load_dwordx2 s[66:67], s[36:37], 0x5fe80
  v_mfma_f32_16x16x32_bf16 v[88:91], a[20:23], a[220:223], v[88:91]
  ds_read_b64_tr_b16 a[220:221], v177 offset:63488
  ds_read_b64_tr_b16 a[222:223], v177 offset:64512
  v_mfma_f32_16x16x32_bf16 v[88:91], a[28:31], a[224:227], v[88:91]
  ds_read_b64_tr_b16 a[224:225], v178 offset:4096
  ds_read_b64_tr_b16 a[226:227], v178 offset:5120
  v_mfma_f32_16x16x32_bf16 v[92:95], a[20:23], a[228:231], v[92:95]
  buffer_load_dwordx4 v185, s[80:83], s41 offen offset:64 lds
  v_mfma_f32_16x16x32_bf16 v[92:95], a[28:31], a[232:235], v[92:95]
  s_mov_b32 s40, 2621440
  v_mfma_f32_16x16x32_bf16 v[68:71], a[16:19], a[228:231], v[68:71]
  ds_read_b64_tr_b16 a[228:229], v178 offset:6144
  ds_read_b64_tr_b16 a[230:231], v178 offset:7168
  v_mfma_f32_16x16x32_bf16 v[68:71], a[24:27], a[232:235], v[68:71]
  ds_read_b64_tr_b16 a[232:233], v179 offset:4096
  ds_read_b64_tr_b16 a[234:235], v179 offset:5120
  s_waitcnt lgkmcnt(13)
  v_mfma_f32_16x16x32_bf16 v[48:51], a[192:195], a[16:19], v[48:51]
  buffer_load_dwordx4 a[96:99], v187, s[4:7], s40 offen offset:0 sc1
  v_mfma_f32_16x16x32_bf16 v[48:51], a[196:199], a[24:27], v[48:51]
  v_mfma_f32_16x16x32_bf16 v[72:75], a[192:195], a[20:23], v[72:75]
  ds_read_b64_tr_b16 a[192:193], v179 offset:6144
  ds_read_b64_tr_b16 a[194:195], v179 offset:7168
  v_mfma_f32_16x16x32_bf16 v[72:75], a[196:199], a[28:31], v[72:75]
  ds_read_b64_tr_b16 a[196:197], v178 offset:12288
  ds_read_b64_tr_b16 a[198:199], v178 offset:13312
  v_mfma_f32_16x16x32_bf16 v[76:79], a[200:203], a[20:23], v[76:79]
  buffer_load_dwordx4 a[100:103], v187, s[4:7], s40 offen offset:1024 sc1
  s_mov_b32 s40, 2752512
  v_mfma_f32_16x16x32_bf16 v[76:79], a[204:207], a[28:31], v[76:79]
  v_mfma_f32_16x16x32_bf16 v[52:55], a[200:203], a[16:19], v[52:55]
  ds_read_b64_tr_b16 a[200:201], v178 offset:14336
  ds_read_b64_tr_b16 a[202:203], v178 offset:15360
  v_mfma_f32_16x16x32_bf16 v[52:55], a[204:207], a[24:27], v[52:55]
  s_barrier
  ds_read_b64_tr_b16 a[204:205], v179 offset:12288
  s_waitcnt vmcnt(20) lgkmcnt(13)
  v_mfma_f32_16x16x32_bf16 v[8:11], a[208:211], a[32:35], v[8:11]
  buffer_load_dwordx4 a[104:107], v187, s[4:7], s40 offen offset:0 sc1
  v_mfma_f32_16x16x32_bf16 v[8:11], a[212:215], a[40:43], v[8:11]
  ds_read_b64_tr_b16 a[206:207], v179 offset:13312
  v_mfma_f32_16x16x32_bf16 v[32:35], a[208:211], a[36:39], v[32:35]
  ds_read_b64_tr_b16 a[208:209], v179 offset:14336
  ds_read_b64_tr_b16 a[210:211], v179 offset:15360
  s_load_dwordx2 s[66:67], s[36:37], 0x7fe00
  v_mfma_f32_16x16x32_bf16 v[32:35], a[212:215], a[44:47], v[32:35]
  ds_read_b64_tr_b16 a[212:213], v178 offset:0
  ds_read_b64_tr_b16 a[214:215], v178 offset:1024
  v_mfma_f32_16x16x32_bf16 v[36:39], a[216:219], a[36:39], v[36:39]
  buffer_load_dwordx4 a[108:111], v187, s[4:7], s40 offen offset:1024 sc1
  v_mfma_f32_16x16x32_bf16 v[36:39], a[220:223], a[44:47], v[36:39]
  s_mov_b32 s41, 2752512
  s_add_u32 m0, s42, 30720
  v_mfma_f32_16x16x32_bf16 v[12:15], a[216:219], a[32:35], v[12:15]
  ds_read_b64_tr_b16 a[216:217], v178 offset:2048
  ds_read_b64_tr_b16 a[218:219], v178 offset:3072
  v_mfma_f32_16x16x32_bf16 v[12:15], a[220:223], a[40:43], v[12:15]
  ds_read_b64_tr_b16 a[220:221], v179 offset:0
  ds_read_b64_tr_b16 a[222:223], v179 offset:1024
  s_waitcnt lgkmcnt(13)
  v_mfma_f32_16x16x32_bf16 v[16:19], a[32:35], a[224:227], v[16:19]
  buffer_load_dwordx4 v185, s[80:83], s41 offen offset:2048 lds
  s_add_u32 m0, s42, 34752
  v_mfma_f32_16x16x32_bf16 v[16:19], a[40:43], a[228:231], v[16:19]
  v_mfma_f32_16x16x32_bf16 v[40:43], a[36:39], a[224:227], v[40:43]
  ds_read_b64_tr_b16 a[224:225], v179 offset:2048
  ds_read_b64_tr_b16 a[226:227], v179 offset:3072
  v_mfma_f32_16x16x32_bf16 v[40:43], a[44:47], a[228:231], v[40:43]
  ds_read_b64_tr_b16 a[228:229], v178 offset:8192
  ds_read_b64_tr_b16 a[230:231], v178 offset:9216
  v_mfma_f32_16x16x32_bf16 v[44:47], a[36:39], a[232:235], v[44:47]
  buffer_load_dwordx4 v185, s[80:83], s41 offen offset:2112 lds
  v_mfma_f32_16x16x32_bf16 v[44:47], a[44:47], a[192:195], v[44:47]
  s_add_u32 m0, s42, 45056
  v_mfma_f32_16x16x32_bf16 v[20:23], a[32:35], a[232:235], v[20:23]
  ds_read_b64_tr_b16 a[232:233], v178 offset:10240
  ds_read_b64_tr_b16 a[234:235], v178 offset:11264
  v_mfma_f32_16x16x32_bf16 v[20:23], a[40:43], a[192:195], v[20:23]
  ds_read_b64_tr_b16 a[192:193], v179 offset:8192
  ds_read_b64_tr_b16 a[194:195], v179 offset:9216
  s_waitcnt lgkmcnt(13)
  v_mfma_f32_16x16x32_bf16 v[0:3], a[196:199], a[32:35], v[0:3]
  buffer_load_dwordx4 v186, s[80:83], s41 offen offset:0 lds
  s_add_u32 m0, s42, 53184
  v_mfma_f32_16x16x32_bf16 v[0:3], a[200:203], a[40:43], v[0:3]
  v_mfma_f32_16x16x32_bf16 v[24:27], a[196:199], a[36:39], v[24:27]
  ds_read_b64_tr_b16 a[196:197], v179 offset:10240
  ds_read_b64_tr_b16 a[198:199], v179 offset:11264
  v_mfma_f32_16x16x32_bf16 v[24:27], a[200:203], a[44:47], v[24:27]
  ds_read_b64_tr_b16 a[200:201], v178 offset:16384
  ds_read_b64_tr_b16 a[202:203], v178 offset:17408
  s_load_dwordx2 s[66:67], s[36:37], 0x9fd80
  v_mfma_f32_16x16x32_bf16 v[28:31], a[204:207], a[36:39], v[28:31]
  buffer_load_dwordx4 v186, s[80:83], s41 offen offset:64 lds
  v_mfma_f32_16x16x32_bf16 v[28:31], a[208:211], a[44:47], v[28:31]
  s_mov_b32 s41, 3145728
  s_add_u32 m0, s42, 38912
  v_mfma_f32_16x16x32_bf16 v[4:7], a[204:207], a[32:35], v[4:7]
  ds_read_b64_tr_b16 a[204:205], v178 offset:18432
  ds_read_b64_tr_b16 a[206:207], v178 offset:19456
  v_mfma_f32_16x16x32_bf16 v[4:7], a[208:211], a[40:43], v[4:7]
  s_barrier
  ds_read_b64_tr_b16 a[208:209], v179 offset:16384
  s_waitcnt lgkmcnt(13)
  v_mfma_f32_16x16x32_bf16 v[56:59], a[212:215], a[32:35], v[56:59]
  buffer_load_dwordx4 v185, s[80:83], s41 offen offset:2048 lds
  s_add_u32 m0, s42, 47040
  v_mfma_f32_16x16x32_bf16 v[56:59], a[216:219], a[40:43], v[56:59]
  ds_read_b64_tr_b16 a[210:211], v179 offset:17408
  v_mfma_f32_16x16x32_bf16 v[80:83], a[212:215], a[36:39], v[80:83]
  ds_read_b64_tr_b16 a[212:213], v179 offset:18432
  ds_read_b64_tr_b16 a[214:215], v179 offset:19456
  v_mfma_f32_16x16x32_bf16 v[80:83], a[216:219], a[44:47], v[80:83]
  ds_read_b64_tr_b16 a[216:217], v178 offset:20480
  ds_read_b64_tr_b16 a[218:219], v178 offset:21504
  v_mfma_f32_16x16x32_bf16 v[84:87], a[220:223], a[36:39], v[84:87]
  buffer_load_dwordx4 v185, s[80:83], s41 offen offset:2112 lds
  v_mfma_f32_16x16x32_bf16 v[84:87], a[224:227], a[44:47], v[84:87]
  s_add_u32 m0, s42, 57344
  v_mfma_f32_16x16x32_bf16 v[60:63], a[220:223], a[32:35], v[60:63]
  ds_read_b64_tr_b16 a[220:221], v178 offset:22528
  ds_read_b64_tr_b16 a[222:223], v178 offset:23552
  v_mfma_f32_16x16x32_bf16 v[60:63], a[224:227], a[40:43], v[60:63]
  ds_read_b64_tr_b16 a[224:225], v179 offset:20480
  ds_read_b64_tr_b16 a[226:227], v179 offset:21504
  s_waitcnt lgkmcnt(13)
  v_mfma_f32_16x16x32_bf16 v[64:67], a[32:35], a[228:231], v[64:67]
  buffer_load_dwordx4 v186, s[80:83], s41 offen offset:0 lds
  s_add_u32 m0, s42, 61376
  v_mfma_f32_16x16x32_bf16 v[64:67], a[40:43], a[232:235], v[64:67]
  v_mfma_f32_16x16x32_bf16 v[88:91], a[36:39], a[228:231], v[88:91]
  ds_read_b64_tr_b16 a[228:229], v179 offset:22528
  ds_read_b64_tr_b16 a[230:231], v179 offset:23552
  v_mfma_f32_16x16x32_bf16 v[88:91], a[44:47], a[232:235], v[88:91]
  ds_read_b64_tr_b16 a[232:233], v178 offset:28672
  ds_read_b64_tr_b16 a[234:235], v178 offset:29696
  v_mfma_f32_16x16x32_bf16 v[92:95], a[36:39], a[192:195], v[92:95]
  buffer_load_dwordx4 v186, s[80:83], s41 offen offset:64 lds
  s_load_dwordx2 s[66:67], s[36:37], 0xbfd00
  v_mfma_f32_16x16x32_bf16 v[92:95], a[44:47], a[196:199], v[92:95]
  s_mov_b32 s41, 3538944
  s_add_u32 m0, s42, 67584
  v_mfma_f32_16x16x32_bf16 v[68:71], a[32:35], a[192:195], v[68:71]
  ds_read_b64_tr_b16 a[192:193], v178 offset:30720
  ds_read_b64_tr_b16 a[194:195], v178 offset:31744
  v_mfma_f32_16x16x32_bf16 v[68:71], a[40:43], a[196:199], v[68:71]
  ds_read_b64_tr_b16 a[196:197], v179 offset:28672
  ds_read_b64_tr_b16 a[198:199], v179 offset:29696
  s_waitcnt lgkmcnt(13)
  v_mfma_f32_16x16x32_bf16 v[48:51], a[200:203], a[32:35], v[48:51]
  buffer_load_dwordx4 v185, s[80:83], s41 offen offset:2048 lds
  s_add_u32 m0, s42, 75712
  v_mfma_f32_16x16x32_bf16 v[48:51], a[204:207], a[40:43], v[48:51]
  v_mfma_f32_16x16x32_bf16 v[72:75], a[200:203], a[36:39], v[72:75]
  ds_read_b64_tr_b16 a[200:201], v179 offset:30720
  ds_read_b64_tr_b16 a[202:203], v179 offset:31744
  v_mfma_f32_16x16x32_bf16 v[72:75], a[204:207], a[44:47], v[72:75]
  ds_read_b64_tr_b16 a[204:205], v178 offset:36864
  ds_read_b64_tr_b16 a[206:207], v178 offset:37888
  v_mfma_f32_16x16x32_bf16 v[76:79], a[208:211], a[36:39], v[76:79]
  buffer_load_dwordx4 v185, s[80:83], s41 offen offset:2112 lds
  v_mfma_f32_16x16x32_bf16 v[76:79], a[212:215], a[44:47], v[76:79]
  s_mov_b32 s40, 2883584
  v_mfma_f32_16x16x32_bf16 v[52:55], a[208:211], a[32:35], v[52:55]
  ds_read_b64_tr_b16 a[208:209], v178 offset:38912
  ds_read_b64_tr_b16 a[210:211], v178 offset:39936
  v_mfma_f32_16x16x32_bf16 v[52:55], a[212:215], a[40:43], v[52:55]
  s_barrier
  ds_read_b64_tr_b16 a[212:213], v179 offset:36864
  s_waitcnt vmcnt(28) lgkmcnt(13)
  v_mfma_f32_16x16x32_bf16 v[8:11], a[216:219], a[48:51], v[8:11]
  buffer_load_dwordx4 a[112:115], v187, s[4:7], s40 offen offset:0 sc1
  v_mfma_f32_16x16x32_bf16 v[8:11], a[220:223], a[56:59], v[8:11]
  ds_read_b64_tr_b16 a[214:215], v179 offset:37888
  v_mfma_f32_16x16x32_bf16 v[32:35], a[216:219], a[52:55], v[32:35]
  ds_read_b64_tr_b16 a[216:217], v179 offset:38912
  ds_read_b64_tr_b16 a[218:219], v179 offset:39936
  v_mfma_f32_16x16x32_bf16 v[32:35], a[220:223], a[60:63], v[32:35]
  ds_read_b64_tr_b16 a[220:221], v178 offset:24576
  ds_read_b64_tr_b16 a[222:223], v178 offset:25600
  v_mfma_f32_16x16x32_bf16 v[36:39], a[224:227], a[52:55], v[36:39]
  buffer_load_dwordx4 a[116:119], v187, s[4:7], s40 offen offset:1024 sc1
  s_mov_b32 s40, 3014656
  v_mfma_f32_16x16x32_bf16 v[36:39], a[228:231], a[60:63], v[36:39]
  s_load_dwordx2 s[66:67], s[36:37], 0xdfc80
  s_add_u32 s36, s36, 0xffc00
  s_addc_u32 s37, s37, 0
  v_mfma_f32_16x16x32_bf16 v[12:15], a[224:227], a[48:51], v[12:15]
  ds_read_b64_tr_b16 a[224:225], v178 offset:26624
  ds_read_b64_tr_b16 a[226:227], v178 offset:27648
  v_mfma_f32_16x16x32_bf16 v[12:15], a[228:231], a[56:59], v[12:15]
  ds_read_b64_tr_b16 a[228:229], v179 offset:24576
  ds_read_b64_tr_b16 a[230:231], v179 offset:25600
  s_waitcnt lgkmcnt(13)
  v_mfma_f32_16x16x32_bf16 v[16:19], a[48:51], a[232:235], v[16:19]
  buffer_load_dwordx4 a[120:123], v187, s[4:7], s40 offen offset:0 sc1
  v_mfma_f32_16x16x32_bf16 v[16:19], a[56:59], a[192:195], v[16:19]
  v_mfma_f32_16x16x32_bf16 v[40:43], a[52:55], a[232:235], v[40:43]
  ds_read_b64_tr_b16 a[232:233], v179 offset:26624
  ds_read_b64_tr_b16 a[234:235], v179 offset:27648
  v_mfma_f32_16x16x32_bf16 v[40:43], a[60:63], a[192:195], v[40:43]
  ds_read_b64_tr_b16 a[192:193], v178 offset:32768
  ds_read_b64_tr_b16 a[194:195], v178 offset:33792
  v_mfma_f32_16x16x32_bf16 v[44:47], a[52:55], a[196:199], v[44:47]
  buffer_load_dwordx4 a[124:127], v187, s[4:7], s40 offen offset:1024 sc1
  v_mfma_f32_16x16x32_bf16 v[44:47], a[60:63], a[200:203], v[44:47]
  s_add_u32 m0, s42, 65536
  v_mfma_f32_16x16x32_bf16 v[20:23], a[48:51], a[196:199], v[20:23]
  ds_read_b64_tr_b16 a[196:197], v178 offset:34816
  ds_read_b64_tr_b16 a[198:199], v178 offset:35840
  v_mfma_f32_16x16x32_bf16 v[20:23], a[56:59], a[200:203], v[20:23]
  ds_read_b64_tr_b16 a[200:201], v179 offset:32768
  ds_read_b64_tr_b16 a[202:203], v179 offset:33792
  s_waitcnt lgkmcnt(13)
  v_mfma_f32_16x16x32_bf16 v[0:3], a[204:207], a[48:51], v[0:3]
  buffer_load_dwordx4 v186, s[80:83], s41 offen offset:0 lds
  s_add_u32 m0, s42, 73664
  v_mfma_f32_16x16x32_bf16 v[0:3], a[208:211], a[56:59], v[0:3]
  v_mfma_f32_16x16x32_bf16 v[24:27], a[204:207], a[52:55], v[24:27]
  ds_read_b64_tr_b16 a[204:205], v179 offset:34816
  ds_read_b64_tr_b16 a[206:207], v179 offset:35840
  v_mfma_f32_16x16x32_bf16 v[24:27], a[208:211], a[60:63], v[24:27]
  ds_read_b64_tr_b16 a[208:209], v178 offset:40960
  ds_read_b64_tr_b16 a[210:211], v178 offset:41984
  v_mfma_f32_16x16x32_bf16 v[28:31], a[212:215], a[52:55], v[28:31]
  buffer_load_dwordx4 v186, s[80:83], s41 offen offset:64 lds
  v_mfma_f32_16x16x32_bf16 v[28:31], a[216:219], a[60:63], v[28:31]
  s_mov_b32 s40, 3145728
  v_mfma_f32_16x16x32_bf16 v[4:7], a[212:215], a[48:51], v[4:7]
  ds_read_b64_tr_b16 a[212:213], v178 offset:43008
  ds_read_b64_tr_b16 a[214:215], v178 offset:44032
  s_load_dwordx2 s[66:67], s[36:37], 0x0
  v_mfma_f32_16x16x32_bf16 v[4:7], a[216:219], a[56:59], v[4:7]
  s_barrier
  ds_read_b64_tr_b16 a[216:217], v179 offset:40960
  s_waitcnt lgkmcnt(13)
  v_mfma_f32_16x16x32_bf16 v[56:59], a[220:223], a[48:51], v[56:59]
  buffer_load_dwordx4 a[128:131], v187, s[4:7], s40 offen offset:0 sc1
  v_mfma_f32_16x16x32_bf16 v[56:59], a[224:227], a[56:59], v[56:59]
  ds_read_b64_tr_b16 a[218:219], v179 offset:41984
  v_mfma_f32_16x16x32_bf16 v[80:83], a[220:223], a[52:55], v[80:83]
  ds_read_b64_tr_b16 a[220:221], v179 offset:43008
  ds_read_b64_tr_b16 a[222:223], v179 offset:44032
  v_mfma_f32_16x16x32_bf16 v[80:83], a[224:227], a[60:63], v[80:83]
  ds_read_b64_tr_b16 a[224:225], v178 offset:45056
  ds_read_b64_tr_b16 a[226:227], v178 offset:46080
  v_mfma_f32_16x16x32_bf16 v[84:87], a[228:231], a[52:55], v[84:87]
  buffer_load_dwordx4 a[132:135], v187, s[4:7], s40 offen offset:1024 sc1
  s_mov_b32 s40, 3276800
  v_mfma_f32_16x16x32_bf16 v[84:87], a[232:235], a[60:63], v[84:87]
  v_mfma_f32_16x16x32_bf16 v[60:63], a[228:231], a[48:51], v[60:63]
  ds_read_b64_tr_b16 a[228:229], v178 offset:47104
  ds_read_b64_tr_b16 a[230:231], v178 offset:48128
  v_mfma_f32_16x16x32_bf16 v[60:63], a[232:235], a[56:59], v[60:63]
  ds_read_b64_tr_b16 a[232:233], v179 offset:45056
  ds_read_b64_tr_b16 a[234:235], v179 offset:46080
  s_waitcnt lgkmcnt(13)
  v_mfma_f32_16x16x32_bf16 v[64:67], a[48:51], a[192:195], v[64:67]
L_wk0_0:
  s_cbranch_vccnz L_wk0_4
  buffer_load_dwordx4 a[136:139], v187, s[4:7], s40 offen offset:0 sc1
  v_mfma_f32_16x16x32_bf16 v[64:67], a[56:59], a[196:199], v[64:67]
  v_mfma_f32_16x16x32_bf16 v[88:91], a[52:55], a[192:195], v[88:91]
  ds_read_b64_tr_b16 a[192:193], v179 offset:47104
  ds_read_b64_tr_b16 a[194:195], v179 offset:48128
  v_mfma_f32_16x16x32_bf16 v[88:91], a[60:63], a[196:199], v[88:91]
  ds_read_b64_tr_b16 a[196:197], v178 offset:53248
  ds_read_b64_tr_b16 a[198:199], v178 offset:54272
  v_mfma_f32_16x16x32_bf16 v[92:95], a[52:55], a[200:203], v[92:95]
  buffer_load_dwordx4 a[140:143], v187, s[4:7], s40 offen offset:1024 sc1
  v_mfma_f32_16x16x32_bf16 v[92:95], a[60:63], a[204:207], v[92:95]
  s_mov_b32 s41, 3932160
  s_add_u32 m0, s42, 79872
  v_mfma_f32_16x16x32_bf16 v[68:71], a[48:51], a[200:203], v[68:71]
  ds_read_b64_tr_b16 a[200:201], v178 offset:55296
  ds_read_b64_tr_b16 a[202:203], v178 offset:56320
  v_mfma_f32_16x16x32_bf16 v[68:71], a[56:59], a[204:207], v[68:71]
  ds_read_b64_tr_b16 a[204:205], v179 offset:53248
  ds_read_b64_tr_b16 a[206:207], v179 offset:54272
  s_load_dwordx2 s[66:67], s[36:37], 0x1ff80
  s_waitcnt lgkmcnt(13)
  v_mfma_f32_16x16x32_bf16 v[48:51], a[208:211], a[48:51], v[48:51]
  buffer_load_dwordx4 v185, s[80:83], s41 offen offset:2048 lds
  s_add_u32 m0, s42, 83904
  v_mfma_f32_16x16x32_bf16 v[48:51], a[212:215], a[56:59], v[48:51]
  v_mfma_f32_16x16x32_bf16 v[72:75], a[208:211], a[52:55], v[72:75]
  ds_read_b64_tr_b16 a[208:209], v179 offset:55296
  ds_read_b64_tr_b16 a[210:211], v179 offset:56320
  v_mfma_f32_16x16x32_bf16 v[72:75], a[212:215], a[60:63], v[72:75]
  ds_read_b64_tr_b16 a[212:213], v178 offset:61440
  ds_read_b64_tr_b16 a[214:215], v178 offset:62464
  v_mfma_f32_16x16x32_bf16 v[76:79], a[216:219], a[52:55], v[76:79]
  buffer_load_dwordx4 v185, s[80:83], s41 offen offset:2112 lds
  v_mfma_f32_16x16x32_bf16 v[76:79], a[220:223], a[60:63], v[76:79]
  s_add_u32 m0, s42, 94208
  v_mfma_f32_16x16x32_bf16 v[52:55], a[216:219], a[48:51], v[52:55]
  ds_read_b64_tr_b16 a[216:217], v178 offset:63488
  ds_read_b64_tr_b16 a[218:219], v178 offset:64512
  v_mfma_f32_16x16x32_bf16 v[52:55], a[220:223], a[56:59], v[52:55]
  s_barrier
  ds_read_b64_tr_b16 a[220:221], v179 offset:61440
  s_waitcnt vmcnt(34) lgkmcnt(13)
  v_mfma_f32_16x16x32_bf16 v[8:11], a[224:227], a[64:67], v[8:11]
  buffer_load_dwordx4 v186, s[80:83], s41 offen offset:0 lds
  s_add_u32 m0, s42, 102336
  v_mfma_f32_16x16x32_bf16 v[8:11], a[228:231], a[72:75], v[8:11]
  ds_read_b64_tr_b16 a[222:223], v179 offset:62464
  v_mfma_f32_16x16x32_bf16 v[32:35], a[224:227], a[68:71], v[32:35]
  ds_read_b64_tr_b16 a[224:225], v179 offset:63488
  ds_read_b64_tr_b16 a[226:227], v179 offset:64512
  v_mfma_f32_16x16x32_bf16 v[32:35], a[228:231], a[76:79], v[32:35]
  ds_read_b64_tr_b16 a[228:229], v178 offset:49152
  ds_read_b64_tr_b16 a[230:231], v178 offset:50176
  v_mfma_f32_16x16x32_bf16 v[36:39], a[232:235], a[68:71], v[36:39]
  buffer_load_dwordx4 v186, s[80:83], s41 offen offset:64 lds
  v_mfma_f32_16x16x32_bf16 v[36:39], a[192:195], a[76:79], v[36:39]
  s_mov_b32 s41, 4325376
  s_add_u32 m0, s42, 88064
  v_mfma_f32_16x16x32_bf16 v[12:15], a[232:235], a[64:67], v[12:15]
  ds_read_b64_tr_b16 a[232:233], v178 offset:51200
  ds_read_b64_tr_b16 a[234:235], v178 offset:52224
  v_mfma_f32_16x16x32_bf16 v[12:15], a[192:195], a[72:75], v[12:15]
  ds_read_b64_tr_b16 a[192:193], v179 offset:49152
  ds_read_b64_tr_b16 a[194:195], v179 offset:50176
  s_waitcnt lgkmcnt(13)
  v_mfma_f32_16x16x32_bf16 v[16:19], a[64:67], a[196:199], v[16:19]
  buffer_load_dwordx4 v185, s[80:83], s41 offen offset:2048 lds
  s_add_u32 m0, s42, 96192
  s_load_dwordx2 s[66:67], s[36:37], 0x3ff00
  v_mfma_f32_16x16x32_bf16 v[16:19], a[72:75], a[200:203], v[16:19]
  v_mfma_f32_16x16x32_bf16 v[40:43], a[68:71], a[196:199], v[40:43]
  ds_read_b64_tr_b16 a[196:197], v179 offset:51200
  ds_read_b64_tr_b16 a[198:199], v179 offset:52224
  v_mfma_f32_16x16x32_bf16 v[40:43], a[76:79], a[200:203], v[40:43]
  ds_read_b64_tr_b16 a[200:201], v178 offset:57344
  ds_read_b64_tr_b16 a[202:203], v178 offset:58368
  v_mfma_f32_16x16x32_bf16 v[44:47], a[68:71], a[204:207], v[44:47]
  buffer_load_dwordx4 v185, s[80:83], s41 offen offset:2112 lds
  v_mfma_f32_16x16x32_bf16 v[44:47], a[76:79], a[208:211], v[44:47]
  s_mov_b32 s40, 3407872
  v_mfma_f32_16x16x32_bf16 v[20:23], a[64:67], a[204:207], v[20:23]
  ds_read_b64_tr_b16 a[204:205], v178 offset:59392
  ds_read_b64_tr_b16 a[206:207], v178 offset:60416
  v_mfma_f32_16x16x32_bf16 v[20:23], a[72:75], a[208:211], v[20:23]
  ds_read_b64_tr_b16 a[208:209], v179 offset:57344
  ds_read_b64_tr_b16 a[210:211], v179 offset:58368
  s_waitcnt lgkmcnt(13)
  v_mfma_f32_16x16x32_bf16 v[0:3], a[212:215], a[64:67], v[0:3]
  buffer_load_dwordx4 a[144:147], v187, s[4:7], s40 offen offset:0 sc1
  v_mfma_f32_16x16x32_bf16 v[0:3], a[216:219], a[72:75], v[0:3]
  v_mfma_f32_16x16x32_bf16 v[24:27], a[212:215], a[68:71], v[24:27]
  ds_read_b64_tr_b16 a[212:213], v179 offset:59392
  ds_read_b64_tr_b16 a[214:215], v179 offset:60416
  v_mfma_f32_16x16x32_bf16 v[24:27], a[216:219], a[76:79], v[24:27]
  ds_read_b64_tr_b16 a[216:217], v180 offset:0
  ds_read_b64_tr_b16 a[218:219], v180 offset:1024
  v_mfma_f32_16x16x32_bf16 v[28:31], a[220:223], a[68:71], v[28:31]
  buffer_load_dwordx4 a[148:151], v187, s[4:7], s40 offen offset:1024 sc1
  s_mov_b32 s40, 3538944
  v_mfma_f32_16x16x32_bf16 v[28:31], a[224:227], a[76:79], v[28:31]
  v_mfma_f32_16x16x32_bf16 v[4:7], a[220:223], a[64:67], v[4:7]
  ds_read_b64_tr_b16 a[220:221], v180 offset:2048
  ds_read_b64_tr_b16 a[222:223], v180 offset:3072
  v_mfma_f32_16x16x32_bf16 v[4:7], a[224:227], a[72:75], v[4:7]
  s_barrier
  ds_read_b64_tr_b16 a[224:225], v181 offset:0
  s_waitcnt lgkmcnt(13)
  v_mfma_f32_16x16x32_bf16 v[56:59], a[228:231], a[64:67], v[56:59]
  buffer_load_dwordx4 a[152:155], v187, s[4:7], s40 offen offset:0 sc1
  v_mfma_f32_16x16x32_bf16 v[56:59], a[232:235], a[72:75], v[56:59]
  ds_read_b64_tr_b16 a[226:227], v181 offset:1024
  s_load_dwordx2 s[66:67], s[36:37], 0x5fe80
  v_mfma_f32_16x16x32_bf16 v[80:83], a[228:231], a[68:71], v[80:83]
  ds_read_b64_tr_b16 a[228:229], v181 offset:2048
  ds_read_b64_tr_b16 a[230:231], v181 offset:3072
  v_mfma_f32_16x16x32_bf16 v[80:83], a[232:235], a[76:79], v[80:83]
  ds_read_b64_tr_b16 a[232:233], v180 offset:4096
  ds_read_b64_tr_b16 a[234:235], v180 offset:5120
  v_mfma_f32_16x16x32_bf16 v[84:87], a[192:195], a[68:71], v[84:87]
  buffer_load_dwordx4 a[156:159], v187, s[4:7], s40 offen offset:1024 sc1
  v_mfma_f32_16x16x32_bf16 v[84:87], a[196:199], a[76:79], v[84:87]
  s_add_u32 m0, s42, 106496
  v_mfma_f32_16x16x32_bf16 v[60:63], a[192:195], a[64:67], v[60:63]
  ds_read_b64_tr_b16 a[192:193], v180 offset:6144
  ds_read_b64_tr_b16 a[194:195], v180 offset:7168
  v_mfma_f32_16x16x32_bf16 v[60:63], a[196:199], a[72:75], v[60:63]
  ds_read_b64_tr_b16 a[196:197], v181 offset:4096
  ds_read_b64_tr_b16 a[198:199], v181 offset:5120
  s_waitcnt lgkmcnt(13)
  v_mfma_f32_16x16x32_bf16 v[64:67], a[64:67], a[200:203], v[64:67]
  buffer_load_dwordx4 v186, s[80:83], s41 offen offset:0 lds
  s_add_u32 m0, s42, 110528
  v_mfma_f32_16x16x32_bf16 v[64:67], a[72:75], a[204:207], v[64:67]
  v_mfma_f32_16x16x32_bf16 v[88:91], a[68:71], a[200:203], v[88:91]
  ds_read_b64_tr_b16 a[200:201], v181 offset:6144
  ds_read_b64_tr_b16 a[202:203], v181 offset:7168
  v_mfma_f32_16x16x32_bf16 v[88:91], a[76:79], a[204:207], v[88:91]
  ds_read_b64_tr_b16 a[204:205], v180 offset:12288
  ds_read_b64_tr_b16 a[206:207], v180 offset:13312
  v_mfma_f32_16x16x32_bf16 v[92:95], a[68:71], a[208:211], v[92:95]
  buffer_load_dwordx4 v186, s[80:83], s41 offen offset:64 lds
  v_mfma_f32_16x16x32_bf16 v[92:95], a[76:79], a[212:215], v[92:95]
  s_mov_b32 s41, 4718592
  s_add_u32 m0, s42, 116736
  v_mfma_f32_16x16x32_bf16 v[68:71], a[64:67], a[208:211], v[68:71]
  ds_read_b64_tr_b16 a[208:209], v180 offset:14336
  ds_read_b64_tr_b16 a[210:211], v180 offset:15360
  v_mfma_f32_16x16x32_bf16 v[68:71], a[72:75], a[212:215], v[68:71]
  ds_read_b64_tr_b16 a[212:213], v181 offset:12288
  ds_read_b64_tr_b16 a[214:215], v181 offset:13312
  s_waitcnt lgkmcnt(13)
  v_mfma_f32_16x16x32_bf16 v[48:51], a[216:219], a[64:67], v[48:51]
  buffer_load_dwordx4 v185, s[80:83], s41 offen offset:2048 lds
  s_add_u32 m0, s42, 124864
  v_mfma_f32_16x16x32_bf16 v[48:51], a[220:223], a[72:75], v[48:51]
  v_mfma_f32_16x16x32_bf16 v[72:75], a[216:219], a[68:71], v[72:75]
  ds_read_b64_tr_b16 a[216:217], v181 offset:14336
  ds_read_b64_tr_b16 a[218:219], v181 offset:15360
  s_load_dwordx2 s[66:67], s[36:37], 0x7fe00
  v_mfma_f32_16x16x32_bf16 v[72:75], a[220:223], a[76:79], v[72:75]
  ds_read_b64_tr_b16 a[220:221], v180 offset:20480
  ds_read_b64_tr_b16 a[222:223], v180 offset:21504
  v_mfma_f32_16x16x32_bf16 v[76:79], a[224:227], a[68:71], v[76:79]
  buffer_load_dwordx4 v185, s[80:83], s41 offen offset:2112 lds
  v_mfma_f32_16x16x32_bf16 v[76:79], a[228:231], a[76:79], v[76:79]
  s_mov_b32 s40, 3670016
  v_mfma_f32_16x16x32_bf16 v[52:55], a[224:227], a[64:67], v[52:55]
  ds_read_b64_tr_b16 a[224:225], v180 offset:22528
  ds_read_b64_tr_b16 a[226:227], v180 offset:23552
  v_mfma_f32_16x16x32_bf16 v[52:55], a[228:231], a[72:75], v[52:55]
  s_barrier
  ds_read_b64_tr_b16 a[228:229], v181 offset:20480
  s_waitcnt vmcnt(42) lgkmcnt(13)
  v_mfma_f32_16x16x32_bf16 v[8:11], a[232:235], a[80:83], v[8:11]
  buffer_load_dwordx4 a[160:163], v187, s[4:7], s40 offen offset:0 sc1
  v_mfma_f32_16x16x32_bf16 v[8:11], a[192:195], a[88:91], v[8:11]
  ds_read_b64_tr_b16 a[230:231], v181 offset:21504
  v_mfma_f32_16x16x32_bf16 v[32:35], a[232:235], a[84:87], v[32:35]
  ds_read_b64_tr_b16 a[232:233], v181 offset:22528
  ds_read_b64_tr_b16 a[234:235], v181 offset:23552
  v_mfma_f32_16x16x32_bf16 v[32:35], a[192:195], a[92:95], v[32:35]
  ds_read_b64_tr_b16 a[192:193], v180 offset:8192
  ds_read_b64_tr_b16 a[194:195], v180 offset:9216
  v_mfma_f32_16x16x32_bf16 v[36:39], a[196:199], a[84:87], v[36:39]
  buffer_load_dwordx4 a[164:167], v187, s[4:7], s40 offen offset:1024 sc1
  s_mov_b32 s40, 3801088
  v_mfma_f32_16x16x32_bf16 v[36:39], a[200:203], a[92:95], v[36:39]
  v_mfma_f32_16x16x32_bf16 v[12:15], a[196:199], a[80:83], v[12:15]
  ds_read_b64_tr_b16 a[196:197], v180 offset:10240
  ds_read_b64_tr_b16 a[198:199], v180 offset:11264
  v_mfma_f32_16x16x32_bf16 v[12:15], a[200:203], a[88:91], v[12:15]
  ds_read_b64_tr_b16 a[200:201], v181 offset:8192
  ds_read_b64_tr_b16 a[202:203], v181 offset:9216
  s_waitcnt lgkmcnt(13)
  v_mfma_f32_16x16x32_bf16 v[16:19], a[80:83], a[204:207], v[16:19]
  buffer_load_dwordx4 a[168:171], v187, s[4:7], s40 offen offset:0 sc1
  v_mfma_f32_16x16x32_bf16 v[16:19], a[88:91], a[208:211], v[16:19]
  v_mfma_f32_16x16x32_bf16 v[40:43], a[84:87], a[204:207], v[40:43]
  ds_read_b64_tr_b16 a[204:205], v181 offset:10240
  ds_read_b64_tr_b16 a[206:207], v181 offset:11264
  v_mfma_f32_16x16x32_bf16 v[40:43], a[92:95], a[208:211], v[40:43]
  ds_read_b64_tr_b16 a[208:209], v180 offset:16384
  ds_read_b64_tr_b16 a[210:211], v180 offset:17408
  s_load_dwordx2 s[66:67], s[36:37], 0x9fd80
  v_mfma_f32_16x16x32_bf16 v[44:47], a[84:87], a[212:215], v[44:47]
  buffer_load_dwordx4 a[172:175], v187, s[4:7], s40 offen offset:1024 sc1
  v_mfma_f32_16x16x32_bf16 v[44:47], a[92:95], a[216:219], v[44:47]
  s_add_u32 m0, s42, 114688
  v_mfma_f32_16x16x32_bf16 v[20:23], a[80:83], a[212:215], v[20:23]
  ds_read_b64_tr_b16 a[212:213], v180 offset:18432
  ds_read_b64_tr_b16 a[214:215], v180 offset:19456
  v_mfma_f32_16x16x32_bf16 v[20:23], a[88:91], a[216:219], v[20:23]
  ds_read_b64_tr_b16 a[216:217], v181 offset:16384
  ds_read_b64_tr_b16 a[218:219], v181 offset:17408
  s_waitcnt lgkmcnt(13)
  v_mfma_f32_16x16x32_bf16 v[0:3], a[220:223], a[80:83], v[0:3]
  buffer_load_dwordx4 v186, s[80:83], s41 offen offset:0 lds
  s_add_u32 m0, s42, 122816
  v_mfma_f32_16x16x32_bf16 v[0:3], a[224:227], a[88:91], v[0:3]
  v_mfma_f32_16x16x32_bf16 v[24:27], a[220:223], a[84:87], v[24:27]
  ds_read_b64_tr_b16 a[220:221], v181 offset:18432
  ds_read_b64_tr_b16 a[222:223], v181 offset:19456
  v_mfma_f32_16x16x32_bf16 v[24:27], a[224:227], a[92:95], v[24:27]
  ds_read_b64_tr_b16 a[224:225], v180 offset:24576
  ds_read_b64_tr_b16 a[226:227], v180 offset:25600
  v_mfma_f32_16x16x32_bf16 v[28:31], a[228:231], a[84:87], v[28:31]
  buffer_load_dwordx4 v186, s[80:83], s41 offen offset:64 lds
  v_mfma_f32_16x16x32_bf16 v[28:31], a[232:235], a[92:95], v[28:31]
  s_mov_b32 s40, 3932160
  v_mfma_f32_16x16x32_bf16 v[4:7], a[228:231], a[80:83], v[4:7]
  ds_read_b64_tr_b16 a[228:229], v180 offset:26624
  ds_read_b64_tr_b16 a[230:231], v180 offset:27648
  v_mfma_f32_16x16x32_bf16 v[4:7], a[232:235], a[88:91], v[4:7]
  s_waitcnt vmcnt(45)
  s_barrier
  ds_read_b64_tr_b16 a[232:233], v181 offset:24576
  s_waitcnt lgkmcnt(13)
  v_mfma_f32_16x16x32_bf16 v[56:59], a[192:195], a[80:83], v[56:59]
  buffer_load_dwordx4 a[176:179], v187, s[4:7], s40 offen offset:0 sc1
  v_mfma_f32_16x16x32_bf16 v[56:59], a[196:199], a[88:91], v[56:59]
  ds_read_b64_tr_b16 a[234:235], v181 offset:25600
  v_mfma_f32_16x16x32_bf16 v[80:83], a[192:195], a[84:87], v[80:83]
  ds_read_b64_tr_b16 a[192:193], v181 offset:26624
  ds_read_b64_tr_b16 a[194:195], v181 offset:27648
  v_mfma_f32_16x16x32_bf16 v[80:83], a[196:199], a[92:95], v[80:83]
  ds_read_b64_tr_b16 a[196:197], v180 offset:28672
  ds_read_b64_tr_b16 a[198:199], v180 offset:29696
  v_mfma_f32_16x16x32_bf16 v[84:87], a[200:203], a[84:87], v[84:87]
  buffer_load_dwordx4 a[180:183], v187, s[4:7], s40 offen offset:1024 sc1
  s_mov_b32 s40, 4063232
  s_load_dwordx2 s[66:67], s[36:37], 0xbfd00
  v_mfma_f32_16x16x32_bf16 v[84:87], a[204:207], a[92:95], v[84:87]
  v_mfma_f32_16x16x32_bf16 v[60:63], a[200:203], a[80:83], v[60:63]
  ds_read_b64_tr_b16 a[200:201], v180 offset:30720
  ds_read_b64_tr_b16 a[202:203], v180 offset:31744
  v_mfma_f32_16x16x32_bf16 v[60:63], a[204:207], a[88:91], v[60:63]
  ds_read_b64_tr_b16 a[204:205], v181 offset:28672
  ds_read_b64_tr_b16 a[206:207], v181 offset:29696
  s_waitcnt lgkmcnt(13)
  v_mfma_f32_16x16x32_bf16 v[64:67], a[80:83], a[208:211], v[64:67]
  buffer_load_dwordx4 a[184:187], v187, s[4:7], s40 offen offset:0 sc1
  v_mfma_f32_16x16x32_bf16 v[64:67], a[88:91], a[212:215], v[64:67]
  v_mfma_f32_16x16x32_bf16 v[88:91], a[84:87], a[208:211], v[88:91]
  ds_read_b64_tr_b16 a[208:209], v181 offset:30720
  ds_read_b64_tr_b16 a[210:211], v181 offset:31744
  v_mfma_f32_16x16x32_bf16 v[88:91], a[92:95], a[212:215], v[88:91]
  ds_read_b64_tr_b16 a[212:213], v176 offset:20480
  ds_read_b64_tr_b16 a[214:215], v176 offset:21504
  v_mfma_f32_16x16x32_bf16 v[92:95], a[84:87], a[216:219], v[92:95]
  buffer_load_dwordx4 a[188:191], v187, s[4:7], s40 offen offset:1024 sc1
  v_mfma_f32_16x16x32_bf16 v[92:95], a[92:95], a[220:223], v[92:95]
  s_mov_b32 s41, 5111808
  s_add_u32 m0, s42, 129024
  v_mfma_f32_16x16x32_bf16 v[68:71], a[80:83], a[216:219], v[68:71]
  ds_read_b64_tr_b16 a[216:217], v176 offset:22528
  ds_read_b64_tr_b16 a[218:219], v176 offset:23552
  v_mfma_f32_16x16x32_bf16 v[68:71], a[88:91], a[220:223], v[68:71]
  ds_read_b64_tr_b16 a[220:221], v177 offset:20480
  ds_read_b64_tr_b16 a[222:223], v177 offset:21504
  s_waitcnt lgkmcnt(13)
  v_mfma_f32_16x16x32_bf16 v[48:51], a[224:227], a[80:83], v[48:51]
  buffer_load_dwordx4 v185, s[80:83], s41 offen offset:2048 lds
  s_add_u32 m0, s42, 133056
  v_mfma_f32_16x16x32_bf16 v[48:51], a[228:231], a[88:91], v[48:51]
  v_mfma_f32_16x16x32_bf16 v[72:75], a[224:227], a[84:87], v[72:75]
  ds_read_b64_tr_b16 a[224:225], v177 offset:22528
  ds_read_b64_tr_b16 a[226:227], v177 offset:23552
  v_mfma_f32_16x16x32_bf16 v[72:75], a[228:231], a[92:95], v[72:75]
  ds_read_b64_tr_b16 a[228:229], v176 offset:16384
  ds_read_b64_tr_b16 a[230:231], v176 offset:17408
  v_mfma_f32_16x16x32_bf16 v[76:79], a[232:235], a[84:87], v[76:79]
  buffer_load_dwordx4 v185, s[80:83], s41 offen offset:2112 lds
  v_mfma_f32_16x16x32_bf16 v[76:79], a[192:195], a[92:95], v[76:79]
  s_add_u32 m0, s42, 143360
  s_load_dwordx2 s[66:67], s[36:37], 0xdfc80
  v_mfma_f32_16x16x32_bf16 v[52:55], a[232:235], a[80:83], v[52:55]
  ds_read_b64_tr_b16 a[232:233], v176 offset:18432
  ds_read_b64_tr_b16 a[234:235], v176 offset:19456
  v_mfma_f32_16x16x32_bf16 v[52:55], a[192:195], a[88:91], v[52:55]
  s_waitcnt vmcnt(50)
  s_barrier
  ds_read_b64_tr_b16 a[192:193], v177 offset:16384
  s_waitcnt vmcnt(46) lgkmcnt(13)
  v_mfma_f32_16x16x32_bf16 v[8:11], a[196:199], a[96:99], v[8:11]
  buffer_load_dwordx4 v186, s[80:83], s41 offen offset:0 lds
  s_add_u32 m0, s42, 151488
  v_mfma_f32_16x16x32_bf16 v[8:11], a[200:203], a[104:107], v[8:11]
  ds_read_b64_tr_b16 a[194:195], v177 offset:17408
  s_lshr_b32 s36, s22, 8
  s_lshl_b32 s36, s36, 7
  s_add_u32 s36, s36, 60
  s_add_u32 s36, s36, s56
  s_addc_u32 s37, s57, 0
  v_mfma_f32_16x16x32_bf16 v[32:35], a[196:199], a[100:103], v[32:35]
  ds_read_b64_tr_b16 a[196:197], v177 offset:18432
  ds_read_b64_tr_b16 a[198:199], v177 offset:19456
  v_mfma_f32_16x16x32_bf16 v[32:35], a[200:203], a[108:111], v[32:35]
  ds_read_b64_tr_b16 a[200:201], v176 offset:12288
  ds_read_b64_tr_b16 a[202:203], v176 offset:13312
  v_mfma_f32_16x16x32_bf16 v[36:39], a[204:207], a[100:103], v[36:39]
  buffer_load_dwordx4 v186, s[80:83], s41 offen offset:64 lds
  v_mfma_f32_16x16x32_bf16 v[36:39], a[208:211], a[108:111], v[36:39]
  s_mov_b32 s41, 5505024
  s_add_u32 m0, s42, 137216
  v_mfma_f32_16x16x32_bf16 v[12:15], a[204:207], a[96:99], v[12:15]
  ds_read_b64_tr_b16 a[204:205], v176 offset:14336
  ds_read_b64_tr_b16 a[206:207], v176 offset:15360
  v_mfma_f32_16x16x32_bf16 v[12:15], a[208:211], a[104:107], v[12:15]
  ds_read_b64_tr_b16 a[208:209], v177 offset:12288
  ds_read_b64_tr_b16 a[210:211], v177 offset:13312
  s_waitcnt lgkmcnt(13)
  v_mfma_f32_16x16x32_bf16 v[16:19], a[96:99], a[212:215], v[16:19]
  buffer_load_dwordx4 v185, s[80:83], s41 offen offset:2048 lds
  s_add_u32 m0, s42, 145344
  v_mfma_f32_16x16x32_bf16 v[16:19], a[104:107], a[216:219], v[16:19]
  v_mfma_f32_16x16x32_bf16 v[40:43], a[100:103], a[212:215], v[40:43]
  ds_read_b64_tr_b16 a[212:213], v177 offset:14336
  ds_read_b64_tr_b16 a[214:215], v177 offset:15360
  v_mfma_f32_16x16x32_bf16 v[40:43], a[108:111], a[216:219], v[40:43]
  ds_read_b64_tr_b16 a[216:217], v176 offset:28672
  ds_read_b64_tr_b16 a[218:219], v176 offset:29696
  v_mfma_f32_16x16x32_bf16 v[44:47], a[100:103], a[220:223], v[44:47]
  buffer_load_dwordx4 v185, s[80:83], s41 offen offset:2112 lds
  v_mfma_f32_16x16x32_bf16 v[44:47], a[108:111], a[224:227], v[44:47]
  s_mov_b32 s40, 4194304
  v_mfma_f32_16x16x32_bf16 v[20:23], a[96:99], a[220:223], v[20:23]
  ds_read_b64_tr_b16 a[220:221], v176 offset:30720
  ds_read_b64_tr_b16 a[222:223], v176 offset:31744
  v_mfma_f32_16x16x32_bf16 v[20:23], a[104:107], a[224:227], v[20:23]
  ds_read_b64_tr_b16 a[224:225], v177 offset:28672
  ds_read_b64_tr_b16 a[226:227], v177 offset:29696
  s_waitcnt lgkmcnt(13)
  v_mfma_f32_16x16x32_bf16 v[0:3], a[228:231], a[96:99], v[0:3]
  buffer_load_dwordx4 a[0:3], v187, s[4:7], s40 offen offset:0 sc1
  v_mfma_f32_16x16x32_bf16 v[0:3], a[232:235], a[104:107], v[0:3]
  v_mfma_f32_16x16x32_bf16 v[24:27], a[228:231], a[100:103], v[24:27]
  ds_read_b64_tr_b16 a[228:229], v177 offset:30720
  ds_read_b64_tr_b16 a[230:231], v177 offset:31744
  s_load_dwordx2 s[66:67], s[36:37], 0x0
  v_mfma_f32_16x16x32_bf16 v[24:27], a[232:235], a[108:111], v[24:27]
  ds_read_b64_tr_b16 a[232:233], v176 offset:24576
  ds_read_b64_tr_b16 a[234:235], v176 offset:25600
  v_mfma_f32_16x16x32_bf16 v[28:31], a[192:195], a[100:103], v[28:31]
  buffer_load_dwordx4 a[4:7], v187, s[4:7], s40 offen offset:1024 sc1
  s_mov_b32 s40, 4325376
  v_mfma_f32_16x16x32_bf16 v[28:31], a[196:199], a[108:111], v[28:31]
  v_mfma_f32_16x16x32_bf16 v[4:7], a[192:195], a[96:99], v[4:7]
  ds_read_b64_tr_b16 a[192:193], v176 offset:26624
  ds_read_b64_tr_b16 a[194:195], v176 offset:27648
  v_mfma_f32_16x16x32_bf16 v[4:7], a[196:199], a[104:107], v[4:7]
  s_waitcnt vmcnt(47)
  s_barrier
  ds_read_b64_tr_b16 a[196:197], v177 offset:24576
  s_waitcnt lgkmcnt(13)
  v_mfma_f32_16x16x32_bf16 v[56:59], a[200:203], a[96:99], v[56:59]
  buffer_load_dwordx4 a[8:11], v187, s[4:7], s40 offen offset:0 sc1
  v_mfma_f32_16x16x32_bf16 v[56:59], a[204:207], a[104:107], v[56:59]
  ds_read_b64_tr_b16 a[198:199], v177 offset:25600
  v_mfma_f32_16x16x32_bf16 v[80:83], a[200:203], a[100:103], v[80:83]
  ds_read_b64_tr_b16 a[200:201], v177 offset:26624
  ds_read_b64_tr_b16 a[202:203], v177 offset:27648
  v_mfma_f32_16x16x32_bf16 v[80:83], a[204:207], a[108:111], v[80:83]
  ds_read_b64_tr_b16 a[204:205], v176 offset:32768
  ds_read_b64_tr_b16 a[206:207], v176 offset:33792
  v_mfma_f32_16x16x32_bf16 v[84:87], a[208:211], a[100:103], v[84:87]
  buffer_load_dwordx4 a[12:15], v187, s[4:7], s40 offen offset:1024 sc1
  v_mfma_f32_16x16x32_bf16 v[84:87], a[212:215], a[108:111], v[84:87]
  s_add_u32 m0, s42, 155648
  v_mfma_f32_16x16x32_bf16 v[60:63], a[208:211], a[96:99], v[60:63]
  ds_read_b64_tr_b16 a[208:209], v176 offset:34816
  ds_read_b64_tr_b16 a[210:211], v176 offset:35840
  v_mfma_f32_16x16x32_bf16 v[60:63], a[212:215], a[104:107], v[60:63]
  ds_read_b64_tr_b16 a[212:213], v177 offset:32768
  ds_read_b64_tr_b16 a[214:215], v177 offset:33792
  s_waitcnt lgkmcnt(13)
  v_mfma_f32_16x16x32_bf16 v[64:67], a[96:99], a[216:219], v[64:67]
  buffer_load_dwordx4 v186, s[80:83], s41 offen offset:0 lds
  s_add_u32 m0, s42, 159680
  v_mfma_f32_16x16x32_bf16 v[64:67], a[104:107], a[220:223], v[64:67]
  v_mfma_f32_16x16x32_bf16 v[88:91], a[100:103], a[216:219], v[88:91]
  ds_read_b64_tr_b16 a[216:217], v177 offset:34816
  ds_read_b64_tr_b16 a[218:219], v177 offset:35840
  v_mfma_f32_16x16x32_bf16 v[88:91], a[108:111], a[220:223], v[88:91]
  ds_read_b64_tr_b16 a[220:221], v176 offset:45056
  ds_read_b64_tr_b16 a[222:223], v176 offset:46080
  s_load_dwordx2 s[66:67], s[36:37], 0xff80
  v_mfma_f32_16x16x32_bf16 v[92:95], a[100:103], a[224:227], v[92:95]
  buffer_load_dwordx4 v186, s[80:83], s41 offen offset:64 lds
  v_mfma_f32_16x16x32_bf16 v[92:95], a[108:111], a[228:231], v[92:95]
  s_mov_b32 s41, 5898240
  s_add_u32 m0, s42, 18432
  v_mfma_f32_16x16x32_bf16 v[68:71], a[96:99], a[224:227], v[68:71]
  ds_read_b64_tr_b16 a[224:225], v176 offset:47104
  ds_read_b64_tr_b16 a[226:227], v176 offset:48128
  v_mfma_f32_16x16x32_bf16 v[68:71], a[104:107], a[228:231], v[68:71]
  ds_read_b64_tr_b16 a[228:229], v177 offset:45056
  ds_read_b64_tr_b16 a[230:231], v177 offset:46080
  s_waitcnt lgkmcnt(13)
  v_mfma_f32_16x16x32_bf16 v[48:51], a[232:235], a[96:99], v[48:51]
  buffer_load_dwordx4 v185, s[80:83], s41 offen offset:2048 lds
  s_add_u32 m0, s42, 14272
  v_mfma_f32_16x16x32_bf16 v[48:51], a[192:195], a[104:107], v[48:51]
  v_mfma_f32_16x16x32_bf16 v[72:75], a[232:235], a[100:103], v[72:75]
  ds_read_b64_tr_b16 a[232:233], v177 offset:47104
  ds_read_b64_tr_b16 a[234:235], v177 offset:48128
  v_mfma_f32_16x16x32_bf16 v[72:75], a[192:195], a[108:111], v[72:75]
  ds_read_b64_tr_b16 a[192:193], v176 offset:40960
  ds_read_b64_tr_b16 a[194:195], v176 offset:41984
  v_mfma_f32_16x16x32_bf16 v[76:79], a[196:199], a[100:103], v[76:79]
  buffer_load_dwordx4 v185, s[80:83], s41 offen offset:2112 lds
  v_mfma_f32_16x16x32_bf16 v[76:79], a[200:203], a[108:111], v[76:79]
  s_mov_b32 s40, 4456448
  v_mfma_f32_16x16x32_bf16 v[52:55], a[196:199], a[96:99], v[52:55]
  ds_read_b64_tr_b16 a[196:197], v176 offset:43008
  ds_read_b64_tr_b16 a[198:199], v176 offset:44032
  v_mfma_f32_16x16x32_bf16 v[52:55], a[200:203], a[104:107], v[52:55]
  s_waitcnt vmcnt(43)
  s_barrier
  ds_read_b64_tr_b16 a[200:201], v177 offset:40960
  s_waitcnt lgkmcnt(13)
  v_mfma_f32_16x16x32_bf16 v[8:11], a[204:207], a[112:115], v[8:11]
  buffer_load_dwordx4 a[16:19], v187, s[4:7], s40 offen offset:0 sc1
  v_mfma_f32_16x16x32_bf16 v[8:11], a[208:211], a[120:123], v[8:11]
  ds_read_b64_tr_b16 a[202:203], v177 offset:41984
  v_mfma_f32_16x16x32_bf16 v[32:35], a[204:207], a[116:119], v[32:35]
  ds_read_b64_tr_b16 a[204:205], v177 offset:43008
  ds_read_b64_tr_b16 a[206:207], v177 offset:44032
  v_mfma_f32_16x16x32_bf16 v[32:35], a[208:211], a[124:127], v[32:35]
  ds_read_b64_tr_b16 a[208:209], v176 offset:57344
  ds_read_b64_tr_b16 a[210:211], v176 offset:58368
  v_mfma_f32_16x16x32_bf16 v[36:39], a[212:215], a[116:119], v[36:39]
  buffer_load_dwordx4 a[20:23], v187, s[4:7], s40 offen offset:1024 sc1
  s_mov_b32 s40, 4587520
  s_load_dwordx2 s[66:67], s[36:37], 0x1ff00
  v_mfma_f32_16x16x32_bf16 v[36:39], a[216:219], a[124:127], v[36:39]
  v_mfma_f32_16x16x32_bf16 v[12:15], a[212:215], a[112:115], v[12:15]
  ds_read_b64_tr_b16 a[212:213], v176 offset:59392
  ds_read_b64_tr_b16 a[214:215], v176 offset:60416
  v_mfma_f32_16x16x32_bf16 v[12:15], a[216:219], a[120:123], v[12:15]
  ds_read_b64_tr_b16 a[216:217], v177 offset:57344
  ds_read_b64_tr_b16 a[218:219], v177 offset:58368
  s_waitcnt lgkmcnt(13)
  v_mfma_f32_16x16x32_bf16 v[16:19], a[112:115], a[220:223], v[16:19]
  buffer_load_dwordx4 a[24:27], v187, s[4:7], s40 offen offset:0 sc1
  v_mfma_f32_16x16x32_bf16 v[16:19], a[120:123], a[224:227], v[16:19]
  v_mfma_f32_16x16x32_bf16 v[40:43], a[116:119], a[220:223], v[40:43]
  ds_read_b64_tr_b16 a[220:221], v177 offset:59392
  ds_read_b64_tr_b16 a[222:223], v177 offset:60416
  v_mfma_f32_16x16x32_bf16 v[40:43], a[124:127], a[224:227], v[40:43]
  ds_read_b64_tr_b16 a[224:225], v178 offset:4096
  ds_read_b64_tr_b16 a[226:227], v178 offset:5120
  v_mfma_f32_16x16x32_bf16 v[44:47], a[116:119], a[228:231], v[44:47]
  buffer_load_dwordx4 a[28:31], v187, s[4:7], s40 offen offset:1024 sc1
  v_mfma_f32_16x16x32_bf16 v[44:47], a[124:127], a[232:235], v[44:47]
  s_add_u32 m0, s42, 12288
  v_mfma_f32_16x16x32_bf16 v[20:23], a[112:115], a[228:231], v[20:23]
  ds_read_b64_tr_b16 a[228:229], v178 offset:6144
  ds_read_b64_tr_b16 a[230:231], v178 offset:7168
  v_mfma_f32_16x16x32_bf16 v[20:23], a[120:123], a[232:235], v[20:23]
  ds_read_b64_tr_b16 a[232:233], v179 offset:4096
  ds_read_b64_tr_b16 a[234:235], v179 offset:5120
  s_waitcnt vmcnt(42) lgkmcnt(13)
  v_mfma_f32_16x16x32_bf16 v[8:11], a[192:195], a[128:131], v[8:11]
  buffer_load_dwordx4 v186, s[80:83], s41 offen offset:0 lds
  s_add_u32 m0, s42, 28608
  v_mfma_f32_16x16x32_bf16 v[8:11], a[196:199], a[136:139], v[8:11]
  v_mfma_f32_16x16x32_bf16 v[32:35], a[192:195], a[132:135], v[32:35]
  ds_read_b64_tr_b16 a[192:193], v179 offset:6144
  ds_read_b64_tr_b16 a[194:195], v179 offset:7168
  v_mfma_f32_16x16x32_bf16 v[32:35], a[196:199], a[140:143], v[32:35]
  ds_read_b64_tr_b16 a[196:197], v178 offset:0
  ds_read_b64_tr_b16 a[198:199], v178 offset:1024
  v_mfma_f32_16x16x32_bf16 v[36:39], a[200:203], a[132:135], v[36:39]
  buffer_load_dwordx4 v186, s[80:83], s41 offen offset:64 lds
  v_mfma_f32_16x16x32_bf16 v[36:39], a[204:207], a[140:143], v[36:39]
  s_mov_b32 s40, 4718592
  s_load_dwordx2 s[66:67], s[36:37], 0x2fe80
  v_mfma_f32_16x16x32_bf16 v[12:15], a[200:203], a[128:131], v[12:15]
  ds_read_b64_tr_b16 a[200:201], v178 offset:2048
  ds_read_b64_tr_b16 a[202:203], v178 offset:3072
  v_mfma_f32_16x16x32_bf16 v[12:15], a[204:207], a[136:139], v[12:15]
  s_waitcnt vmcnt(39)
  s_barrier
  ds_read_b64_tr_b16 a[204:205], v179 offset:0
  s_waitcnt lgkmcnt(13)
  v_mfma_f32_16x16x32_bf16 v[16:19], a[128:131], a[208:211], v[16:19]
  buffer_load_dwordx4 a[32:35], v187, s[4:7], s40 offen offset:0 sc1
  v_mfma_f32_16x16x32_bf16 v[16:19], a[136:139], a[212:215], v[16:19]
  ds_read_b64_tr_b16 a[206:207], v179 offset:1024
  v_mfma_f32_16x16x32_bf16 v[40:43], a[132:135], a[208:211], v[40:43]
  ds_read_b64_tr_b16 a[208:209], v179 offset:2048
  ds_read_b64_tr_b16 a[210:211], v179 offset:3072
  v_mfma_f32_16x16x32_bf16 v[40:43], a[140:143], a[212:215], v[40:43]
  ds_read_b64_tr_b16 a[212:213], v178 offset:16384
  ds_read_b64_tr_b16 a[214:215], v178 offset:17408
  v_mfma_f32_16x16x32_bf16 v[44:47], a[132:135], a[216:219], v[44:47]
  buffer_load_dwordx4 a[36:39], v187, s[4:7], s40 offen offset:1024 sc1
  s_mov_b32 s40, 4849664
  v_mfma_f32_16x16x32_bf16 v[44:47], a[140:143], a[220:223], v[44:47]
  v_mfma_f32_16x16x32_bf16 v[20:23], a[128:131], a[216:219], v[20:23]
  ds_read_b64_tr_b16 a[216:217], v178 offset:18432
  ds_read_b64_tr_b16 a[218:219], v178 offset:19456
  v_mfma_f32_16x16x32_bf16 v[20:23], a[136:139], a[220:223], v[20:23]
  ds_read_b64_tr_b16 a[220:221], v179 offset:16384
  ds_read_b64_tr_b16 a[222:223], v179 offset:17408
  s_waitcnt vmcnt(36) lgkmcnt(13)
  v_mfma_f32_16x16x32_bf16 v[8:11], a[224:227], a[144:147], v[8:11]
  buffer_load_dwordx4 a[40:43], v187, s[4:7], s40 offen offset:0 sc1
  v_mfma_f32_16x16x32_bf16 v[8:11], a[228:231], a[152:155], v[8:11]
  v_mfma_f32_16x16x32_bf16 v[32:35], a[224:227], a[148:151], v[32:35]
  ds_read_b64_tr_b16 a[224:225], v179 offset:18432
  ds_read_b64_tr_b16 a[226:227], v179 offset:19456
L_wk0_1:
  s_cbranch_vccnz L_wk0_5
  v_mfma_f32_16x16x32_bf16 v[32:35], a[228:231], a[156:159], v[32:35]
  ds_read_b64_tr_b16 a[228:229], v178 offset:28672
  ds_read_b64_tr_b16 a[230:231], v178 offset:29696
  v_mfma_f32_16x16x32_bf16 v[36:39], a[232:235], a[148:151], v[36:39]
  buffer_load_dwordx4 a[44:47], v187, s[4:7], s40 offen offset:1024 sc1
  v_mfma_f32_16x16x32_bf16 v[36:39], a[192:195], a[156:159], v[36:39]
  s_mov_b32 s41, 2752512
  s_add_u32 m0, s42, 24576
  v_mfma_f32_16x16x32_bf16 v[12:15], a[232:235], a[144:147], v[12:15]
  ds_read_b64_tr_b16 a[232:233], v178 offset:30720
  ds_read_b64_tr_b16 a[234:235], v178 offset:31744
  s_load_dwordx2 s[66:67], s[36:37], 0x3fe00
  v_mfma_f32_16x16x32_bf16 v[12:15], a[192:195], a[152:155], v[12:15]
  ds_read_b64_tr_b16 a[192:193], v179 offset:28672
  ds_read_b64_tr_b16 a[194:195], v179 offset:29696
  s_waitcnt lgkmcnt(13)
  v_mfma_f32_16x16x32_bf16 v[16:19], a[144:147], a[196:199], v[16:19]
  buffer_load_dwordx4 v185, s[80:83], s41 offen offset:0 lds
  s_add_u32 m0, s42, 32704
  v_mfma_f32_16x16x32_bf16 v[16:19], a[152:155], a[200:203], v[16:19]
  v_mfma_f32_16x16x32_bf16 v[40:43], a[148:151], a[196:199], v[40:43]
  ds_read_b64_tr_b16 a[196:197], v179 offset:30720
  ds_read_b64_tr_b16 a[198:199], v179 offset:31744
  v_mfma_f32_16x16x32_bf16 v[40:43], a[156:159], a[200:203], v[40:43]
  ds_read_b64_tr_b16 a[200:201], v178 offset:24576
  ds_read_b64_tr_b16 a[202:203], v178 offset:25600
  v_mfma_f32_16x16x32_bf16 v[44:47], a[148:151], a[204:207], v[44:47]
  buffer_load_dwordx4 v185, s[80:83], s41 offen offset:64 lds
  v_mfma_f32_16x16x32_bf16 v[44:47], a[156:159], a[208:211], v[44:47]
  s_mov_b32 s41, 3145728
  s_add_u32 m0, s42, 45056
  v_mfma_f32_16x16x32_bf16 v[20:23], a[144:147], a[204:207], v[20:23]
  ds_read_b64_tr_b16 a[204:205], v178 offset:26624
  ds_read_b64_tr_b16 a[206:207], v178 offset:27648
  v_mfma_f32_16x16x32_bf16 v[20:23], a[152:155], a[208:211], v[20:23]
  s_waitcnt vmcnt(31)
  s_barrier
  ds_read_b64_tr_b16 a[208:209], v179 offset:24576
  s_waitcnt lgkmcnt(13)
  v_mfma_f32_16x16x32_bf16 v[8:11], a[212:215], a[160:163], v[8:11]
  buffer_load_dwordx4 v185, s[80:83], s41 offen offset:0 lds
  s_add_u32 m0, s42, 40896
  v_mfma_f32_16x16x32_bf16 v[8:11], a[216:219], a[168:171], v[8:11]
  ds_read_b64_tr_b16 a[210:211], v179 offset:25600
  v_mfma_f32_16x16x32_bf16 v[32:35], a[212:215], a[164:167], v[32:35]
  ds_read_b64_tr_b16 a[212:213], v179 offset:26624
  ds_read_b64_tr_b16 a[214:215], v179 offset:27648
  v_mfma_f32_16x16x32_bf16 v[32:35], a[216:219], a[172:175], v[32:35]
  ds_read_b64_tr_b16 a[216:217], v178 offset:40960
  ds_read_b64_tr_b16 a[218:219], v178 offset:41984
  v_mfma_f32_16x16x32_bf16 v[36:39], a[220:223], a[164:167], v[36:39]
  buffer_load_dwordx4 v185, s[80:83], s41 offen offset:64 lds
  v_mfma_f32_16x16x32_bf16 v[36:39], a[224:227], a[172:175], v[36:39]
  s_mov_b32 s41, 3538944
  s_add_u32 m0, s42, 57344
  v_mfma_f32_16x16x32_bf16 v[12:15], a[220:223], a[160:163], v[12:15]
  ds_read_b64_tr_b16 a[220:221], v178 offset:43008
  ds_read_b64_tr_b16 a[222:223], v178 offset:44032
  v_mfma_f32_16x16x32_bf16 v[12:15], a[224:227], a[168:171], v[12:15]
  ds_read_b64_tr_b16 a[224:225], v179 offset:40960
  ds_read_b64_tr_b16 a[226:227], v179 offset:41984
  s_load_dwordx2 s[66:67], s[36:37], 0x4fd80
  s_waitcnt lgkmcnt(13)
  v_mfma_f32_16x16x32_bf16 v[16:19], a[160:163], a[228:231], v[16:19]
  buffer_load_dwordx4 v185, s[80:83], s41 offen offset:0 lds
  s_add_u32 m0, s42, 69568
  v_mfma_f32_16x16x32_bf16 v[16:19], a[168:171], a[232:235], v[16:19]
  v_mfma_f32_16x16x32_bf16 v[40:43], a[164:167], a[228:231], v[40:43]
  ds_read_b64_tr_b16 a[228:229], v179 offset:43008
  ds_read_b64_tr_b16 a[230:231], v179 offset:44032
  v_mfma_f32_16x16x32_bf16 v[40:43], a[172:175], a[232:235], v[40:43]
  ds_read_b64_tr_b16 a[232:233], v178 offset:53248
  ds_read_b64_tr_b16 a[234:235], v178 offset:54272
  v_mfma_f32_16x16x32_bf16 v[44:47], a[164:167], a[192:195], v[44:47]
  buffer_load_dwordx4 v185, s[80:83], s41 offen offset:64 lds
  v_mfma_f32_16x16x32_bf16 v[44:47], a[172:175], a[196:199], v[44:47]
  s_mov_b32 s40, 4980736
  v_mfma_f32_16x16x32_bf16 v[20:23], a[160:163], a[192:195], v[20:23]
  ds_read_b64_tr_b16 a[192:193], v178 offset:55296
  ds_read_b64_tr_b16 a[194:195], v178 offset:56320
  v_mfma_f32_16x16x32_bf16 v[20:23], a[168:171], a[196:199], v[20:23]
  ds_read_b64_tr_b16 a[196:197], v179 offset:53248
  ds_read_b64_tr_b16 a[198:199], v179 offset:54272
  v_mov_b32 v200, -1
  s_waitcnt vmcnt(30) lgkmcnt(13)
  v_mfma_f32_16x16x32_bf16 v[8:11], a[200:203], a[176:179], v[8:11]
  buffer_load_dwordx4 a[48:51], v187, s[4:7], s40 offen offset:0 sc1
  v_mov_b32 v201, -1
  v_mfma_f32_16x16x32_bf16 v[8:11], a[204:207], a[184:187], v[8:11]
  v_mov_b32 v202, -1
  v_mov_b32 v203, -1
  v_lshlrev_b32 v204, 2, v224
  v_mfma_f32_16x16x32_bf16 v[32:35], a[200:203], a[180:183], v[32:35]
  ds_read_b64_tr_b16 a[200:201], v179 offset:55296
  ds_read_b64_tr_b16 a[202:203], v179 offset:56320
  v_mfma_f32_16x16x32_bf16 v[32:35], a[204:207], a[188:191], v[32:35]
  ds_read_b64_tr_b16 a[204:205], v178 offset:49152
  ds_read_b64_tr_b16 a[206:207], v178 offset:50176
  v_mfma_f32_16x16x32_bf16 v[36:39], a[208:211], a[180:183], v[36:39]
  buffer_load_dwordx4 a[52:55], v187, s[4:7], s40 offen offset:1024 sc1
  s_mov_b32 s40, 5111808
  v_mfma_f32_16x16x32_bf16 v[36:39], a[212:215], a[188:191], v[36:39]
  s_sub_u32 s30, s78, 0x500000
  s_lshr_b32 s31, s30, 18
  s_lshl_b32 s31, s31, 17
  s_bfe_u32 s32, s30, 0x10011
  s_lshl_b32 s32, s32, 10
  s_add_u32 s31, s31, s32
  s_add_u32 s31, s31, 0x900000
  s_cmp_lt_u32 s30, 0x100000
  s_cselect_b32 s31, s31, 0x40000000
  buffer_store_dwordx4 v[200:203], v187, s[4:7], s31 offen sc1
  v_mfma_f32_16x16x32_bf16 v[12:15], a[208:211], a[176:179], v[12:15]
  ds_read_b64_tr_b16 a[208:209], v178 offset:51200
  ds_read_b64_tr_b16 a[210:211], v178 offset:52224
  v_mfma_f32_16x16x32_bf16 v[12:15], a[212:215], a[184:187], v[12:15]
  s_waitcnt vmcnt(28)
  s_barrier
  ds_read_b64_tr_b16 a[212:213], v179 offset:49152
  s_waitcnt lgkmcnt(13)
  v_mfma_f32_16x16x32_bf16 v[16:19], a[176:179], a[216:219], v[16:19]
  buffer_load_dwordx4 a[56:59], v187, s[4:7], s40 offen offset:0 sc1
  s_load_dwordx2 s[66:67], s[36:37], 0x5fd00
  v_mfma_f32_16x16x32_bf16 v[16:19], a[184:187], a[220:223], v[16:19]
  ds_read_b64_tr_b16 a[214:215], v179 offset:50176
  buffer_store_dword v200, v204, s[4:7], s89 offen sc1
  v_mfma_f32_16x16x32_bf16 v[40:43], a[180:183], a[216:219], v[40:43]
  ds_read_b64_tr_b16 a[216:217], v179 offset:51200
  ds_read_b64_tr_b16 a[218:219], v179 offset:52224
  v_mfma_f32_16x16x32_bf16 v[40:43], a[188:191], a[220:223], v[40:43]
  ds_read_b64_tr_b16 a[220:221], v180 offset:0
  ds_read_b64_tr_b16 a[222:223], v180 offset:1024
  v_mfma_f32_16x16x32_bf16 v[44:47], a[180:183], a[224:227], v[44:47]
  buffer_load_dwordx4 a[60:63], v187, s[4:7], s40 offen offset:1024 sc1
  v_mfma_f32_16x16x32_bf16 v[44:47], a[188:191], a[228:231], v[44:47]
  s_mov_b32 s41, 3932160
  s_add_u32 m0, s42, 65536
  v_mfma_f32_16x16x32_bf16 v[20:23], a[176:179], a[224:227], v[20:23]
  ds_read_b64_tr_b16 a[224:225], v180 offset:2048
  ds_read_b64_tr_b16 a[226:227], v180 offset:3072
  v_mfma_f32_16x16x32_bf16 v[20:23], a[184:187], a[228:231], v[20:23]
  ds_read_b64_tr_b16 a[228:229], v181 offset:0
  ds_read_b64_tr_b16 a[230:231], v181 offset:1024
  s_waitcnt vmcnt(26) lgkmcnt(13)
  v_mfma_f32_16x16x32_bf16 v[8:11], a[232:235], a[0:3], v[8:11]
  buffer_load_dwordx4 v185, s[80:83], s41 offen offset:0 lds
  s_add_u32 m0, s42, 81856
  v_mfma_f32_16x16x32_bf16 v[8:11], a[192:195], a[8:11], v[8:11]
  v_mfma_f32_16x16x32_bf16 v[32:35], a[232:235], a[4:7], v[32:35]
  ds_read_b64_tr_b16 a[232:233], v181 offset:2048
  ds_read_b64_tr_b16 a[234:235], v181 offset:3072
  v_mfma_f32_16x16x32_bf16 v[32:35], a[192:195], a[12:15], v[32:35]
  ds_read_b64_tr_b16 a[192:193], v180 offset:12288
  ds_read_b64_tr_b16 a[194:195], v180 offset:13312
  v_mfma_f32_16x16x32_bf16 v[36:39], a[196:199], a[4:7], v[36:39]
  buffer_load_dwordx4 v185, s[80:83], s41 offen offset:64 lds
  v_mfma_f32_16x16x32_bf16 v[36:39], a[200:203], a[12:15], v[36:39]
  s_mov_b32 s41, 4325376
  s_add_u32 m0, s42, 94208
  v_mfma_f32_16x16x32_bf16 v[12:15], a[196:199], a[0:3], v[12:15]
  ds_read_b64_tr_b16 a[196:197], v180 offset:14336
  ds_read_b64_tr_b16 a[198:199], v180 offset:15360
  v_mfma_f32_16x16x32_bf16 v[12:15], a[200:203], a[8:11], v[12:15]
  ds_read_b64_tr_b16 a[200:201], v181 offset:12288
  ds_read_b64_tr_b16 a[202:203], v181 offset:13312
  s_waitcnt lgkmcnt(13)
  v_mfma_f32_16x16x32_bf16 v[16:19], a[0:3], a[204:207], v[16:19]
  buffer_load_dwordx4 v185, s[80:83], s41 offen offset:0 lds
  s_add_u32 m0, s42, 90048
  v_mfma_f32_16x16x32_bf16 v[16:19], a[8:11], a[208:211], v[16:19]
  s_load_dwordx2 s[66:67], s[36:37], 0x6fc80
  v_mfma_f32_16x16x32_bf16 v[40:43], a[4:7], a[204:207], v[40:43]
  ds_read_b64_tr_b16 a[204:205], v181 offset:14336
  ds_read_b64_tr_b16 a[206:207], v181 offset:15360
  v_mfma_f32_16x16x32_bf16 v[40:43], a[12:15], a[208:211], v[40:43]
  ds_read_b64_tr_b16 a[208:209], v180 offset:8192
  ds_read_b64_tr_b16 a[210:211], v180 offset:9216
  v_mfma_f32_16x16x32_bf16 v[44:47], a[4:7], a[212:215], v[44:47]
  buffer_load_dwordx4 v185, s[80:83], s41 offen offset:64 lds
  v_mfma_f32_16x16x32_bf16 v[44:47], a[12:15], a[216:219], v[44:47]
  v_mfma_f32_16x16x32_bf16 v[20:23], a[0:3], a[212:215], v[20:23]
  ds_read_b64_tr_b16 a[212:213], v180 offset:10240
  ds_read_b64_tr_b16 a[214:215], v180 offset:11264
  v_mfma_f32_16x16x32_bf16 v[20:23], a[8:11], a[216:219], v[20:23]
  s_waitcnt vmcnt(21)
  s_barrier
  ds_read_b64_tr_b16 a[216:217], v181 offset:8192
  s_waitcnt lgkmcnt(13)
  v_mfma_f32_16x16x32_bf16 v[8:11], a[220:223], a[16:19], v[8:11]
  ds_read_b64_tr_b16 a[218:219], v181 offset:9216
  s_mov_b32 s41, 4718592
  s_add_u32 m0, s42, 106496
  v_mfma_f32_16x16x32_bf16 v[8:11], a[224:227], a[24:27], v[8:11]
  buffer_load_dwordx4 v185, s[80:83], s41 offen offset:0 lds
  s_add_u32 m0, s42, 118720
  v_mfma_f32_16x16x32_bf16 v[32:35], a[220:223], a[20:23], v[32:35]
  ds_read_b64_tr_b16 a[220:221], v181 offset:10240
  ds_read_b64_tr_b16 a[222:223], v181 offset:11264
  v_mfma_f32_16x16x32_bf16 v[32:35], a[224:227], a[28:31], v[32:35]
  ds_read_b64_tr_b16 a[224:225], v180 offset:24576
  ds_read_b64_tr_b16 a[226:227], v180 offset:25600
  v_mfma_f32_16x16x32_bf16 v[36:39], a[228:231], a[20:23], v[36:39]
  buffer_load_dwordx4 v185, s[80:83], s41 offen offset:64 lds
  v_mfma_f32_16x16x32_bf16 v[36:39], a[232:235], a[28:31], v[36:39]
  v_mfma_f32_16x16x32_bf16 v[12:15], a[228:231], a[16:19], v[12:15]
  ds_read_b64_tr_b16 a[228:229], v180 offset:26624
  ds_read_b64_tr_b16 a[230:231], v180 offset:27648
  v_mfma_f32_16x16x32_bf16 v[12:15], a[232:235], a[24:27], v[12:15]
  ds_read_b64_tr_b16 a[232:233], v181 offset:24576
  ds_read_b64_tr_b16 a[234:235], v181 offset:25600
  s_waitcnt lgkmcnt(13)
  v_mfma_f32_16x16x32_bf16 v[16:19], a[16:19], a[192:195], v[16:19]
  v_mfma_f32_16x16x32_bf16 v[16:19], a[24:27], a[196:199], v[16:19]
  v_mfma_f32_16x16x32_bf16 v[40:43], a[20:23], a[192:195], v[40:43]
  ds_read_b64_tr_b16 a[192:193], v181 offset:26624
  ds_read_b64_tr_b16 a[194:195], v181 offset:27648
  s_load_dwordx2 s[66:67], s[36:37], 0x7fc00
  v_mfma_f32_16x16x32_bf16 v[40:43], a[28:31], a[196:199], v[40:43]
  ds_read_b64_tr_b16 a[196:197], v176 offset:20480
  ds_read_b64_tr_b16 a[198:199], v176 offset:21504
  v_mfma_f32_16x16x32_bf16 v[44:47], a[20:23], a[200:203], v[44:47]
  v_mfma_f32_16x16x32_bf16 v[44:47], a[28:31], a[204:207], v[44:47]
  v_mfma_f32_16x16x32_bf16 v[20:23], a[16:19], a[200:203], v[20:23]
  ds_read_b64_tr_b16 a[200:201], v176 offset:22528
  ds_read_b64_tr_b16 a[202:203], v176 offset:23552
  v_mfma_f32_16x16x32_bf16 v[20:23], a[24:27], a[204:207], v[20:23]
  ds_read_b64_tr_b16 a[204:205], v177 offset:20480
  ds_read_b64_tr_b16 a[206:207], v177 offset:21504
  s_waitcnt vmcnt(18) lgkmcnt(13)
  v_mfma_f32_16x16x32_bf16 v[8:11], a[208:211], a[32:35], v[8:11]
  v_mfma_f32_16x16x32_bf16 v[8:11], a[212:215], a[40:43], v[8:11]
  v_mfma_f32_16x16x32_bf16 v[32:35], a[208:211], a[36:39], v[32:35]
  ds_read_b64_tr_b16 a[208:209], v177 offset:22528
  ds_read_b64_tr_b16 a[210:211], v177 offset:23552
  v_mfma_f32_16x16x32_bf16 v[32:35], a[212:215], a[44:47], v[32:35]
  ds_read_b64_tr_b16 a[212:213], v176 offset:12288
  ds_read_b64_tr_b16 a[214:215], v176 offset:13312
  v_mfma_f32_16x16x32_bf16 v[36:39], a[216:219], a[36:39], v[36:39]
  v_mfma_f32_16x16x32_bf16 v[36:39], a[220:223], a[44:47], v[36:39]
  v_mfma_f32_16x16x32_bf16 v[12:15], a[216:219], a[32:35], v[12:15]
  ds_read_b64_tr_b16 a[216:217], v176 offset:14336
  ds_read_b64_tr_b16 a[218:219], v176 offset:15360
  v_mfma_f32_16x16x32_bf16 v[12:15], a[220:223], a[40:43], v[12:15]
  s_waitcnt vmcnt(13)
  s_barrier
  ds_read_b64_tr_b16 a[220:221], v177 offset:12288
  s_waitcnt lgkmcnt(13)
  v_mfma_f32_16x16x32_bf16 v[16:19], a[32:35], a[224:227], v[16:19]
  ds_read_b64_tr_b16 a[222:223], v177 offset:13312
  s_mov_b32 s41, 5111808
  s_add_u32 m0, s42, 114688
  v_mfma_f32_16x16x32_bf16 v[16:19], a[40:43], a[228:231], v[16:19]
  buffer_load_dwordx4 v185, s[80:83], s41 offen offset:0 lds
  s_add_u32 m0, s42, 131008
  v_mfma_f32_16x16x32_bf16 v[40:43], a[36:39], a[224:227], v[40:43]
  ds_read_b64_tr_b16 a[224:225], v177 offset:14336
  ds_read_b64_tr_b16 a[226:227], v177 offset:15360
  v_mfma_f32_16x16x32_bf16 v[40:43], a[44:47], a[228:231], v[40:43]
  ds_read_b64_tr_b16 a[228:229], v176 offset:24576
  ds_read_b64_tr_b16 a[230:231], v176 offset:25600
  s_load_dwordx2 s[66:67], s[36:37], 0x8fb80
  v_mfma_f32_16x16x32_bf16 v[44:47], a[36:39], a[232:235], v[44:47]
  buffer_load_dwordx4 v185, s[80:83], s41 offen offset:64 lds
  v_mfma_f32_16x16x32_bf16 v[44:47], a[44:47], a[192:195], v[44:47]
  s_mov_b32 s41, 5505024
  s_add_u32 m0, s42, 143360
  v_mfma_f32_16x16x32_bf16 v[20:23], a[32:35], a[232:235], v[20:23]
  ds_read_b64_tr_b16 a[232:233], v176 offset:26624
  ds_read_b64_tr_b16 a[234:235], v176 offset:27648
  v_mfma_f32_16x16x32_bf16 v[20:23], a[40:43], a[192:195], v[20:23]
  ds_read_b64_tr_b16 a[192:193], v177 offset:24576
  ds_read_b64_tr_b16 a[194:195], v177 offset:25600
  s_waitcnt vmcnt(8) lgkmcnt(13)
  v_mfma_f32_16x16x32_bf16 v[8:11], a[196:199], a[48:51], v[8:11]
  buffer_load_dwordx4 v185, s[80:83], s41 offen offset:0 lds
  s_add_u32 m0, s42, 139200
  v_mfma_f32_16x16x32_bf16 v[8:11], a[200:203], a[56:59], v[8:11]
  v_mfma_f32_16x16x32_bf16 v[32:35], a[196:199], a[52:55], v[32:35]
  ds_read_b64_tr_b16 a[196:197], v177 offset:26624
  ds_read_b64_tr_b16 a[198:199], v177 offset:27648
  v_mfma_f32_16x16x32_bf16 v[32:35], a[200:203], a[60:63], v[32:35]
  ds_read_b64_tr_b16 a[200:201], v176 offset:45056
  ds_read_b64_tr_b16 a[202:203], v176 offset:46080
  v_mfma_f32_16x16x32_bf16 v[36:39], a[204:207], a[52:55], v[36:39]
  buffer_load_dwordx4 v185, s[80:83], s41 offen offset:64 lds
  v_mfma_f32_16x16x32_bf16 v[36:39], a[208:211], a[60:63], v[36:39]
  v_mfma_f32_16x16x32_bf16 v[12:15], a[204:207], a[48:51], v[12:15]
  ds_read_b64_tr_b16 a[204:205], v176 offset:47104
  ds_read_b64_tr_b16 a[206:207], v176 offset:48128
  v_mfma_f32_16x16x32_bf16 v[12:15], a[208:211], a[56:59], v[12:15]
  ds_read_b64_tr_b16 a[208:209], v177 offset:45056
  ds_read_b64_tr_b16 a[210:211], v177 offset:46080
  v_cvt_pk_bf16_f32 v128, v32, v33
  v_cvt_pk_bf16_f32 v129, v34, v35
  v_cvt_pk_bf16_f32 v130, v36, v37
  v_cvt_pk_bf16_f32 v131, v38, v39
  ds_write_b128 v191, v[128:131]
  v_mov_b32 v144, v128
  v_mov_b32 v146, v129
  s_waitcnt lgkmcnt(13)
  v_mfma_f32_16x16x32_bf16 v[16:19], a[48:51], a[212:215], v[16:19]
  v_mov_b32 v148, v130
  v_mov_b32 v150, v131
  buffer_store_dwordx4 v[144:147], v188, s[4:7], 0 offen offset:0 sc1
  buffer_store_dwordx4 v[148:151], v188, s[4:7], 0 offen offset:1024 sc1
  v_mfma_f32_16x16x32_bf16 v[16:19], a[56:59], a[216:219], v[16:19]
  v_mfma_f32_16x16x32_bf16 v[40:43], a[52:55], a[212:215], v[40:43]
  ds_read_b64_tr_b16 a[212:213], v177 offset:47104
  ds_read_b64_tr_b16 a[214:215], v177 offset:48128
  v_mfma_f32_16x16x32_bf16 v[40:43], a[60:63], a[216:219], v[40:43]
  ds_read_b64_tr_b16 a[216:217], v176 offset:57344
  ds_read_b64_tr_b16 a[218:219], v176 offset:58368
  v_mfma_f32_16x16x32_bf16 v[44:47], a[52:55], a[220:223], v[44:47]
  s_load_dwordx2 s[66:67], s[36:37], 0x9fb00
  v_mfma_f32_16x16x32_bf16 v[44:47], a[60:63], a[224:227], v[44:47]
  v_mfma_f32_16x16x32_bf16 v[20:23], a[48:51], a[220:223], v[20:23]
  ds_read_b64_tr_b16 a[220:221], v176 offset:59392
  ds_read_b64_tr_b16 a[222:223], v176 offset:60416
  v_mfma_f32_16x16x32_bf16 v[20:23], a[56:59], a[224:227], v[20:23]
  s_waitcnt vmcnt(11)
  s_barrier
  ds_read_b64_tr_b16 a[224:225], v177 offset:57344
  v_cvt_pk_bf16_f32 v136, v40, v41
  v_cvt_pk_bf16_f32 v137, v42, v43
  v_cvt_pk_bf16_f32 v142, v44, v45
  v_cvt_pk_bf16_f32 v143, v46, v47
  v_mov_b32 v152, v136
  v_mov_b32 v154, v137
  v_mov_b32 v156, v142
  v_mov_b32 v158, v143
  v_mfma_f32_16x16x32_bf16 v[0:3], a[228:231], a[112:115], v[0:3]
  ds_read_b64_tr_b16 a[226:227], v177 offset:58368
  s_mov_b32 s41, 5898240
  s_add_u32 m0, s42, 155648
  buffer_store_dwordx4 v[152:155], v188, s[4:7], 0 offen offset:2048 sc1
  buffer_store_dwordx4 v[156:159], v188, s[4:7], 0 offen offset:3072 sc1
  ds_write_b64 v191, v[136:137] offset:1024
  ds_write_b64 v191, v[142:143] offset:1032
  v_cvt_pk_bf16_f32 v124, v8, v9
  v_cvt_pk_bf16_f32 v125, v10, v11
  v_cvt_pk_bf16_f32 v126, v12, v13
  v_cvt_pk_bf16_f32 v127, v14, v15
  s_waitcnt lgkmcnt(13)
  v_mfma_f32_16x16x32_bf16 v[0:3], a[232:235], a[120:123], v[0:3]
  v_cvt_pk_bf16_f32 v134, v16, v17
  v_cvt_pk_bf16_f32 v135, v18, v19
  v_cvt_pk_bf16_f32 v140, v20, v21
  v_cvt_pk_bf16_f32 v141, v22, v23
  v_mfma_f32_16x16x32_bf16 v[24:27], a[228:231], a[116:119], v[24:27]
  buffer_load_dwordx4 v185, s[80:83], s41 offen offset:0 lds
  s_add_u32 m0, s42, 20416
  v_mfma_f32_16x16x32_bf16 v[24:27], a[232:235], a[124:127], v[24:27]
  ds_read_b64_tr_b16 a[228:229], v177 offset:59392
  ds_read_b64_tr_b16 a[230:231], v177 offset:60416
  v_mfma_f32_16x16x32_bf16 v[28:31], a[192:195], a[116:119], v[28:31]
  buffer_load_dwordx4 v185, s[80:83], s41 offen offset:64 lds
  v_mfma_f32_16x16x32_bf16 v[28:31], a[196:199], a[124:127], v[28:31]
  ds_read_b64_tr_b16 a[232:233], v178 offset:0
  ds_read_b64_tr_b16 a[234:235], v178 offset:1024
  s_mov_b32 s41, 0
  v_mfma_f32_16x16x32_bf16 v[4:7], a[192:195], a[112:115], v[4:7]
  ds_read_b64_tr_b16 a[192:193], v178 offset:2048
  ds_read_b64_tr_b16 a[194:195], v178 offset:3072
  s_add_u32 m0, s42, 12288
  v_mfma_f32_16x16x32_bf16 v[4:7], a[196:199], a[120:123], v[4:7]
  ds_read_b64_tr_b16 a[196:197], v179 offset:0
  ds_read_b64_tr_b16 a[198:199], v179 offset:1024
  s_waitcnt lgkmcnt(8)
  v_add_u32 v188, 4096, v188
  v_mfma_f32_16x16x32_bf16 v[0:3], a[200:203], a[128:131], v[0:3]
  v_mfma_f32_16x16x32_bf16 v[0:3], a[204:207], a[136:139], v[0:3]
  buffer_load_dwordx4 v217, s[60:63], s41 offen offset:0 nt lds
  v_mfma_f32_16x16x32_bf16 v[24:27], a[200:203], a[132:135], v[24:27]
  ds_read_b64_tr_b16 a[200:201], v179 offset:2048
  ds_read_b64_tr_b16 a[202:203], v179 offset:3072
  v_mfma_f32_16x16x32_bf16 v[24:27], a[204:207], a[140:143], v[24:27]
  v_mfma_f32_16x16x32_bf16 v[28:31], a[208:211], a[132:135], v[28:31]
  v_mfma_f32_16x16x32_bf16 v[28:31], a[212:215], a[140:143], v[28:31]
  s_load_dwordx2 s[66:67], s[36:37], 0xafa80
  v_mfma_f32_16x16x32_bf16 v[4:7], a[208:211], a[128:131], v[4:7]
  v_mfma_f32_16x16x32_bf16 v[4:7], a[212:215], a[136:139], v[4:7]
  v_mfma_f32_16x16x32_bf16 v[0:3], a[216:219], a[144:147], v[0:3]
  v_mfma_f32_16x16x32_bf16 v[0:3], a[220:223], a[152:155], v[0:3]
  v_mfma_f32_16x16x32_bf16 v[24:27], a[216:219], a[148:151], v[24:27]
  v_mfma_f32_16x16x32_bf16 v[24:27], a[220:223], a[156:159], v[24:27]
  v_mfma_f32_16x16x32_bf16 v[28:31], a[224:227], a[148:151], v[28:31]
  s_waitcnt lgkmcnt(8)
  v_mfma_f32_16x16x32_bf16 v[28:31], a[228:231], a[156:159], v[28:31]
  v_mfma_f32_16x16x32_bf16 v[4:7], a[224:227], a[144:147], v[4:7]
  v_mfma_f32_16x16x32_bf16 v[4:7], a[228:231], a[152:155], v[4:7]
  s_waitcnt vmcnt(10)
  s_barrier
  ds_read_b64_tr_b16 a[204:205], v178 offset:28672
  ds_read_b128 v[120:123], v209
  ds_read_b64 v[132:133], v209 offset:1024
  ds_read_b64 v[138:139], v209 offset:1032
  s_waitcnt lgkmcnt(10)
  v_mfma_f32_16x16x32_bf16 v[0:3], a[232:235], a[160:163], v[0:3]
  ds_read_b64_tr_b16 a[206:207], v178 offset:29696
  ds_read_b64_tr_b16 a[208:209], v178 offset:30720
  s_mov_b32 s41, 393216
  s_waitcnt lgkmcnt(10)
  v_mfma_f32_16x16x32_bf16 v[0:3], a[192:195], a[168:171], v[0:3]
  ds_read_b64_tr_b16 a[210:211], v178 offset:31744
  ds_read_b64_tr_b16 a[212:213], v179 offset:28672
  s_add_u32 m0, s42, 24576
  v_mfma_f32_16x16x32_bf16 v[24:27], a[232:235], a[164:167], v[24:27]
  buffer_load_dwordx4 v217, s[60:63], s41 offen offset:0 nt lds
  v_mfma_f32_16x16x32_bf16 v[24:27], a[192:195], a[172:175], v[24:27]
  ds_read_b64_tr_b16 a[214:215], v179 offset:29696
  ds_read_b64_tr_b16 a[216:217], v179 offset:30720
  s_mov_b32 s41, 786432
  s_waitcnt lgkmcnt(12)
  v_mfma_f32_16x16x32_bf16 v[28:31], a[196:199], a[164:167], v[28:31]
  ds_read_b64_tr_b16 a[218:219], v179 offset:31744
  ds_read_b64_tr_b16 a[220:221], v178 offset:40960
  s_add_u32 m0, s42, 45056
  s_waitcnt lgkmcnt(12)
  v_mfma_f32_16x16x32_bf16 v[28:31], a[200:203], a[172:175], v[28:31]
  buffer_load_dwordx4 v217, s[60:63], s41 offen offset:0 nt lds
  v_mfma_f32_16x16x32_bf16 v[4:7], a[196:199], a[160:163], v[4:7]
  ds_read_b64_tr_b16 a[222:223], v178 offset:41984
  ds_read_b64_tr_b16 a[224:225], v178 offset:43008
  s_mov_b32 s41, 1179648
  s_load_dwordx2 s[66:67], s[36:37], 0xbfa00
  v_mfma_f32_16x16x32_bf16 v[4:7], a[200:203], a[168:171], v[4:7]
  ds_read_b64_tr_b16 a[226:227], v178 offset:44032
  ds_read_b64_tr_b16 a[228:229], v179 offset:40960
  s_add_u32 m0, s42, 57344
  s_waitcnt lgkmcnt(11)
  v_mfma_f32_16x16x32_bf16 v[0:3], a[204:207], a[176:179], v[0:3]
  ds_read_b64_tr_b16 a[230:231], v179 offset:41984
  ds_read_b64_tr_b16 a[232:233], v179 offset:43008
  s_waitcnt lgkmcnt(11)
  v_mfma_f32_16x16x32_bf16 v[0:3], a[208:211], a[184:187], v[0:3]
  buffer_load_dwordx4 v217, s[60:63], s41 offen offset:0 nt lds
  v_mfma_f32_16x16x32_bf16 v[24:27], a[204:207], a[180:183], v[24:27]
  ds_read_b64_tr_b16 a[234:235], v179 offset:44032
  ds_read_b64_tr_b16 a[192:193], v178 offset:49152
  v_mfma_f32_16x16x32_bf16 v[24:27], a[208:211], a[188:191], v[24:27]
  ds_read_b64_tr_b16 a[194:195], v178 offset:50176
  ds_read_b64_tr_b16 a[196:197], v178 offset:51200
  s_waitcnt lgkmcnt(13)
  v_mfma_f32_16x16x32_bf16 v[28:31], a[212:215], a[180:183], v[28:31]
  ds_read_b64_tr_b16 a[198:199], v178 offset:52224
  ds_read_b64_tr_b16 a[200:201], v179 offset:49152
  s_waitcnt lgkmcnt(13)
  v_mfma_f32_16x16x32_bf16 v[28:31], a[216:219], a[188:191], v[28:31]
  ds_read_b64_tr_b16 a[202:203], v179 offset:50176
  ds_read_b64_tr_b16 a[204:205], v179 offset:51200
  v_mfma_f32_16x16x32_bf16 v[4:7], a[212:215], a[176:179], v[4:7]
  ds_read_b64_tr_b16 a[206:207], v179 offset:52224
  v_mfma_f32_16x16x32_bf16 v[4:7], a[216:219], a[184:187], v[4:7]
  s_waitcnt lgkmcnt(13)
  v_mfma_f32_16x16x32_bf16 v[0:3], a[220:223], a[0:3], v[0:3]
  s_waitcnt lgkmcnt(12)
  v_mfma_f32_16x16x32_bf16 v[0:3], a[224:227], a[8:11], v[0:3]
  v_mfma_f32_16x16x32_bf16 v[24:27], a[220:223], a[4:7], v[24:27]
  v_mfma_f32_16x16x32_bf16 v[24:27], a[224:227], a[12:15], v[24:27]
  s_waitcnt lgkmcnt(10)
  v_mfma_f32_16x16x32_bf16 v[28:31], a[228:231], a[4:7], v[28:31]
  s_waitcnt lgkmcnt(8)
  v_mfma_f32_16x16x32_bf16 v[28:31], a[232:235], a[12:15], v[28:31]
  v_mfma_f32_16x16x32_bf16 v[4:7], a[228:231], a[0:3], v[4:7]
  v_mfma_f32_16x16x32_bf16 v[4:7], a[232:235], a[8:11], v[4:7]
  s_waitcnt vmcnt(5)
  s_barrier
  ds_read_b64_tr_b16 a[208:209], v180 offset:12288
  buffer_load_dwordx4 v[160:163], v182, s[4:7], 0 offen offset:0 sc1
  buffer_load_dwordx4 v[164:167], v182, s[4:7], 0 offen offset:1024 sc1
  buffer_load_dwordx4 v[168:171], v182, s[4:7], 0 offen offset:2048 sc1
  buffer_load_dwordx4 v[172:175], v182, s[4:7], 0 offen offset:3072 sc1
  s_load_dwordx2 s[66:67], s[36:37], 0xcf980
  s_waitcnt lgkmcnt(7)
  v_mfma_f32_16x16x32_bf16 v[0:3], a[192:195], a[16:19], v[0:3]
  ds_read_b64_tr_b16 a[210:211], v180 offset:13312
  ds_read_b64_tr_b16 a[212:213], v180 offset:14336
  s_mov_b32 s41, 1572864
  s_waitcnt lgkmcnt(7)
  v_mfma_f32_16x16x32_bf16 v[0:3], a[196:199], a[24:27], v[0:3]
  ds_read_b64_tr_b16 a[214:215], v180 offset:15360
  ds_read_b64_tr_b16 a[216:217], v181 offset:12288
  s_add_u32 m0, s42, 65536
  v_mfma_f32_16x16x32_bf16 v[24:27], a[192:195], a[20:23], v[24:27]
  buffer_load_dwordx4 v217, s[60:63], s41 offen offset:0 nt lds
  v_mfma_f32_16x16x32_bf16 v[24:27], a[196:199], a[28:31], v[24:27]
  ds_read_b64_tr_b16 a[218:219], v181 offset:13312
  ds_read_b64_tr_b16 a[220:221], v181 offset:14336
  s_mov_b32 s41, 1966080
  s_waitcnt lgkmcnt(9)
  v_mfma_f32_16x16x32_bf16 v[28:31], a[200:203], a[20:23], v[28:31]
  ds_read_b64_tr_b16 a[222:223], v181 offset:15360
  ds_read_b64_tr_b16 a[224:225], v180 offset:24576
  s_add_u32 m0, s42, 94208
  s_waitcnt lgkmcnt(9)
  v_mfma_f32_16x16x32_bf16 v[28:31], a[204:207], a[28:31], v[28:31]
  buffer_load_dwordx4 v217, s[60:63], s41 offen offset:0 nt lds
  v_mfma_f32_16x16x32_bf16 v[4:7], a[200:203], a[16:19], v[4:7]
  ds_read_b64_tr_b16 a[226:227], v180 offset:25600
  ds_read_b64_tr_b16 a[228:229], v180 offset:26624
  s_mov_b32 s41, 2359296
  v_mfma_f32_16x16x32_bf16 v[4:7], a[204:207], a[24:27], v[4:7]
  ds_read_b64_tr_b16 a[230:231], v180 offset:27648
  ds_read_b64_tr_b16 a[232:233], v181 offset:24576
  s_add_u32 m0, s42, 106496
  s_waitcnt lgkmcnt(11)
  v_mfma_f32_16x16x32_bf16 v[0:3], a[208:211], a[32:35], v[0:3]
  ds_read_b64_tr_b16 a[234:235], v181 offset:25600
  ds_read_b64_tr_b16 a[192:193], v181 offset:26624
  s_waitcnt lgkmcnt(11)
  v_mfma_f32_16x16x32_bf16 v[0:3], a[212:215], a[40:43], v[0:3]
  buffer_load_dwordx4 v217, s[60:63], s41 offen offset:0 nt lds
  v_mfma_f32_16x16x32_bf16 v[24:27], a[208:211], a[36:39], v[24:27]
  ds_read_b64_tr_b16 a[194:195], v181 offset:27648
  ds_read_b64_tr_b16 a[196:197], v176 offset:36864
  v_mfma_f32_16x16x32_bf16 v[24:27], a[212:215], a[44:47], v[24:27]
  ds_read_b64_tr_b16 a[198:199], v176 offset:37888
  ds_read_b64_tr_b16 a[200:201], v176 offset:38912
  s_waitcnt lgkmcnt(13)
  v_mfma_f32_16x16x32_bf16 v[28:31], a[216:219], a[36:39], v[28:31]
  ds_read_b64_tr_b16 a[202:203], v176 offset:39936
  ds_read_b64_tr_b16 a[204:205], v177 offset:36864
  s_waitcnt lgkmcnt(13)
  v_mfma_f32_16x16x32_bf16 v[28:31], a[220:223], a[44:47], v[28:31]
  ds_read_b64_tr_b16 a[206:207], v177 offset:37888
  ds_read_b64_tr_b16 a[208:209], v177 offset:38912
  v_mfma_f32_16x16x32_bf16 v[4:7], a[216:219], a[32:35], v[4:7]
  ds_read_b64_tr_b16 a[210:211], v177 offset:39936
  ds_read_b64_tr_b16 a[212:213], v176 offset:53248
  v_mfma_f32_16x16x32_bf16 v[4:7], a[220:223], a[40:43], v[4:7]
  ds_read_b64_tr_b16 a[214:215], v176 offset:54272
  ds_read_b64_tr_b16 a[216:217], v176 offset:55296
  s_waitcnt lgkmcnt(13)
  v_mfma_f32_16x16x32_bf16 v[0:3], a[224:227], a[48:51], v[0:3]
  ds_read_b64_tr_b16 a[218:219], v176 offset:56320
  ds_read_b64_tr_b16 a[220:221], v177 offset:53248
  s_load_dwordx2 s[66:67], s[36:37], 0xdf900
  v_mfma_f32_16x16x32_bf16 v[0:3], a[228:231], a[56:59], v[0:3]
  ds_read_b64_tr_b16 a[222:223], v177 offset:54272
  v_mfma_f32_16x16x32_bf16 v[24:27], a[224:227], a[52:55], v[24:27]
  ds_read_b64_tr_b16 a[224:225], v177 offset:55296
  ds_read_b64_tr_b16 a[226:227], v177 offset:56320
  v_mfma_f32_16x16x32_bf16 v[24:27], a[228:231], a[60:63], v[24:27]
  ds_read_b64_tr_b16 a[228:229], v176 offset:49152
  ds_read_b64_tr_b16 a[230:231], v176 offset:50176
  v_mfma_f32_16x16x32_bf16 v[28:31], a[232:235], a[52:55], v[28:31]
  s_waitcnt lgkmcnt(13)
L_wk0_2:
  s_cbranch_vccnz L_wk0_end
  v_mfma_f32_16x16x32_bf16 v[28:31], a[192:195], a[60:63], v[28:31]
  v_mfma_f32_16x16x32_bf16 v[4:7], a[232:235], a[48:51], v[4:7]
  ds_read_b64_tr_b16 a[232:233], v176 offset:51200
  ds_read_b64_tr_b16 a[234:235], v176 offset:52224
  v_mfma_f32_16x16x32_bf16 v[4:7], a[192:195], a[56:59], v[4:7]
  s_barrier
  ds_read_b64_tr_b16 a[192:193], v177 offset:49152
  v_cvt_pk_bf16_f32 v116, v24, v25
  v_cvt_pk_bf16_f32 v117, v26, v27
  v_cvt_pk_bf16_f32 v118, v28, v29
  v_cvt_pk_bf16_f32 v119, v30, v31
  v_cvt_pk_bf16_f32 v112, v0, v1
  v_cvt_pk_bf16_f32 v113, v2, v3
  v_cvt_pk_bf16_f32 v114, v4, v5
  v_cvt_pk_bf16_f32 v115, v6, v7
  v_mfma_f32_16x16x32_bf16 v[56:59], a[196:199], a[112:115], v[56:59]
  ds_read_b64_tr_b16 a[194:195], v177 offset:50176
  s_mov_b32 s41, 2752512
  s_add_u32 m0, s42, 114688
  v_mfma_f32_16x16x32_bf16 v[4:7], v[128:131], v[116:119], 0
  v_mfma_f32_16x16x32_bf16 v[0:3], v[124:127], v[116:119], 0
  v_mfma_f32_16x16x32_bf16 v[12:15], v[124:127], v[112:115], 0
  s_waitcnt vmcnt(3)
  v_xor_b32 v196, v183, v161
  v_bitop3_b32 v196, v163, v183, v196 bitop3:0xbe
  v_mfma_f32_16x16x32_bf16 v[56:59], a[200:203], a[120:123], v[56:59]
  buffer_load_dwordx4 v217, s[60:63], s41 offen offset:0 nt lds
  v_bitop3_b32 v196, v165, v183, v196 bitop3:0xbe
  v_bitop3_b32 v196, v167, v183, v196 bitop3:0xbe
  v_bitop3_b32 v196, v169, v183, v196 bitop3:0xbe
  v_bitop3_b32 v196, v171, v183, v196 bitop3:0xbe
  v_bitop3_b32 v196, v173, v183, v196 bitop3:0xbe
  v_bitop3_b32 v196, v175, v183, v196 bitop3:0xbe
  v_cmp_ne_u32 s[0:1], 0, v196
  v_mfma_f32_16x16x32_bf16 v[80:83], a[196:199], a[116:119], v[80:83]
  ds_read_b64_tr_b16 a[196:197], v177 offset:51200
  ds_read_b64_tr_b16 a[198:199], v177 offset:52224
  s_mov_b32 s41, 0
  s_cmp_lg_u64 s[0:1], 0
  s_cbranch_scc1 L_slow_21
L_back_22:
  v_or_b32 v120, v120, v160
  v_or_b32 v121, v121, v162
  v_or_b32 v122, v122, v164
  v_or_b32 v123, v123, v166
  v_or_b32 v132, v132, v168
  v_or_b32 v133, v133, v170
  v_or_b32 v138, v138, v172
  v_mfma_f32_16x16x32_bf16 v[80:83], a[200:203], a[124:127], v[80:83]
  ds_read_b64_tr_b16 a[200:201], v176 offset:61440
  ds_read_b64_tr_b16 a[202:203], v176 offset:62464
  s_add_u32 m0, s42, 143360
  v_or_b32 v139, v139, v174
  v_add_u32 v182, 4096, v182
  s_waitcnt lgkmcnt(13)
  v_mfma_f32_16x16x32_bf16 v[84:87], a[204:207], a[116:119], v[84:87]
  buffer_load_dwordx4 v241, s[8:11], s41 offen offset:0 lds
  v_mfma_f32_16x16x32_bf16 v[8:11], v[120:123], v[112:115], 0
  v_cndmask_b32_e64 v0, v0, v1, s[28:29]
  v_cndmask_b32_e64 v2, v2, v3, s[28:29]
  v_cndmask_b32_e64 v4, v4, v5, s[28:29]
  v_cndmask_b32_e64 v6, v6, v7, s[28:29]
  v_mfma_f32_16x16x32_bf16 v[84:87], a[208:211], a[124:127], v[84:87]
  s_mov_b32 s41, 131072
  s_add_u32 m0, s42, 155648
  v_mfma_f32_16x16x32_bf16 v[60:63], a[204:207], a[112:115], v[60:63]
  ds_read_b64_tr_b16 a[204:205], v176 offset:63488
  ds_read_b64_tr_b16 a[206:207], v176 offset:64512
  v_cndmask_b32_e64 v8, v8, v9, s[28:29]
  v_cndmask_b32_e64 v10, v10, v11, s[28:29]
  v_cndmask_b32_e64 v12, v12, v13, s[28:29]
  v_cndmask_b32_e64 v14, v14, v15, s[28:29]
  v_cndmask_b32_e64 v0, v0, v4, s[24:25]
  v_cndmask_b32_e64 v1, v2, v6, s[26:27]
  v_cndmask_b32_e64 v8, v8, v12, s[24:25]
  v_cndmask_b32_e64 v9, v10, v14, s[26:27]
  v_mfma_f32_16x16x32_bf16 v[60:63], a[208:211], a[120:123], v[60:63]
  ds_read_b64_tr_b16 a[208:209], v177 offset:61440
  ds_read_b64_tr_b16 a[210:211], v177 offset:62464
  s_mov_b32 s33, 0x3e8293ee
  v_mul_f32 v0, s33, v0
  v_mul_f32 v1, s33, v1
  v_fma_f32 v8, v8, s33, v193
  v_fma_f32 v9, v9, s33, v194
  v_max_f32 v16, v0, v1
  v_max_f32 v17, v8, v9
  v_mov_b32 v20, v16
  v_mov_b32 v21, v17
  v_mfma_f32_16x16x32_bf16 v[64:67], a[112:115], a[212:215], v[64:67]
  buffer_load_dwordx4 v241, s[8:11], s41 offen offset:0 lds
  v_permlane16_swap_b32 v20, v16
  v_permlane16_swap_b32 v21, v17
  v_mfma_f32_16x16x32_bf16 v[64:67], a[120:123], a[216:219], v[64:67]
  v_max_f32 v16, v16, v20
  v_max_f32 v17, v17, v21
  v_mov_b32 v20, v16
  v_mov_b32 v21, v17
  s_load_dwordx2 s[66:67], s[36:37], 0xef880
  s_add_u32 s36, s36, 0xff800
  s_addc_u32 s37, s37, 0
  v_mfma_f32_16x16x32_bf16 v[88:91], a[116:119], a[212:215], v[88:91]
  ds_read_b64_tr_b16 a[212:213], v177 offset:63488
  ds_read_b64_tr_b16 a[214:215], v177 offset:64512
  v_permlane32_swap_b32 v20, v16
  v_permlane32_swap_b32 v21, v17
  v_mfma_f32_16x16x32_bf16 v[88:91], a[124:127], a[216:219], v[88:91]
  ds_read_b64_tr_b16 a[216:217], v178 offset:12288
  ds_read_b64_tr_b16 a[218:219], v178 offset:13312
  v_max_f32 v16, v16, v20
  v_max_f32 v17, v17, v21
  v_sub_f32 v0, v0, v16
  v_sub_f32 v1, v1, v16
  v_sub_f32 v8, v8, v17
  v_sub_f32 v9, v9, v17
  v_exp_f32 v0, v0
  v_exp_f32 v1, v1
  v_exp_f32 v8, v8
  v_exp_f32 v9, v9
  v_add_f32 v16, v0, v1
  s_waitcnt lgkmcnt(13)
  v_mfma_f32_16x16x32_bf16 v[92:95], a[116:119], a[220:223], v[92:95]
  v_add_f32 v17, v8, v9
  v_mov_b32 v20, v16
  v_mov_b32 v21, v17
  v_mfma_f32_16x16x32_bf16 v[92:95], a[124:127], a[224:227], v[92:95]
  v_permlane16_swap_b32 v20, v16
  v_permlane16_swap_b32 v21, v17
  v_mfma_f32_16x16x32_bf16 v[68:71], a[112:115], a[220:223], v[68:71]
  ds_read_b64_tr_b16 a[220:221], v178 offset:14336
  ds_read_b64_tr_b16 a[222:223], v178 offset:15360
  v_add_f32 v16, v16, v20
  v_add_f32 v17, v17, v21
  v_mov_b32 v20, v16
  v_mov_b32 v21, v17
  v_mfma_f32_16x16x32_bf16 v[68:71], a[120:123], a[224:227], v[68:71]
  ds_read_b64_tr_b16 a[224:225], v179 offset:12288
  ds_read_b64_tr_b16 a[226:227], v179 offset:13312
  v_permlane32_swap_b32 v20, v16
  v_permlane32_swap_b32 v21, v17
  v_mfma_f32_16x16x32_bf16 v[56:59], a[228:231], a[128:131], v[56:59]
  v_add_f32 v16, v16, v20
  v_add_f32 v17, v17, v21
  v_rcp_f32 v16, v16
  v_rcp_f32 v17, v17
  v_mul_f32 v0, v0, v16
  v_mul_f32 v1, v1, v16
  v_mul_f32 v8, v8, v17
  v_mul_f32 v9, v9, v17
  v_cvt_pk_bf16_f32 v0, v0, 0
  v_cvt_pk_bf16_f32 v1, v1, 0
  v_cvt_pk_bf16_f32 v8, v8, 0
  v_cvt_pk_bf16_f32 v9, v9, 0
  v_lshlrev_b32 v0, v195, v0
  v_mfma_f32_16x16x32_bf16 v[56:59], a[232:235], a[136:139], v[56:59]
  v_lshlrev_b32 v1, v195, v1
  v_lshlrev_b32 v8, v195, v8
  v_lshlrev_b32 v9, v195, v9
  v_cndmask_b32_e64 v112, v0, 0, s[24:25]
  v_cndmask_b32_e64 v114, 0, v0, s[24:25]
  v_cndmask_b32_e64 v113, v1, 0, s[26:27]
  v_cndmask_b32_e64 v115, 0, v1, s[26:27]
  v_cndmask_b32_e64 v116, v8, 0, s[24:25]
  v_mfma_f32_16x16x32_bf16 v[80:83], a[228:231], a[132:135], v[80:83]
  ds_read_b64_tr_b16 a[228:229], v179 offset:14336
  ds_read_b64_tr_b16 a[230:231], v179 offset:15360
  v_cndmask_b32_e64 v118, 0, v8, s[24:25]
  v_cndmask_b32_e64 v117, v9, 0, s[26:27]
  v_cndmask_b32_e64 v119, 0, v9, s[26:27]
  v_mfma_f32_16x16x32_bf16 v[80:83], a[232:235], a[140:143], v[80:83]
  ds_read_b64_tr_b16 a[232:233], v178 offset:8192
  ds_read_b64_tr_b16 a[234:235], v178 offset:9216
  v_mfma_f32_16x16x32_bf16 v[0:3], v[134:137], v[112:115], 0
  v_mfma_f32_16x16x32_bf16 v[4:7], v[140:143], v[112:115], 0
  s_waitcnt lgkmcnt(13)
  v_mfma_f32_16x16x32_bf16 v[84:87], a[192:195], a[132:135], v[84:87]
  v_mfma_f32_16x16x32_bf16 v[8:11], v[132:135], v[116:119], 0
  v_mfma_f32_16x16x32_bf16 v[12:15], v[138:141], v[116:119], 0
  v_mfma_f32_16x16x32_bf16 v[84:87], a[196:199], a[140:143], v[84:87]
  v_mfma_f32_16x16x32_bf16 v[60:63], a[192:195], a[128:131], v[60:63]
  ds_read_b64_tr_b16 a[192:193], v178 offset:10240
  ds_read_b64_tr_b16 a[194:195], v178 offset:11264
  v_cvt_pk_bf16_f32 v120, v0, v1
  v_cvt_pk_bf16_f32 v121, v2, v3
  v_cvt_pk_bf16_f32 v122, v4, v5
  v_cvt_pk_bf16_f32 v123, v6, v7
  buffer_store_dwordx4 v[120:123], v187, s[4:7], s78 offen offset:1024 sc1
  v_cvt_pk_bf16_f32 v124, v8, v9
  v_cvt_pk_bf16_f32 v125, v10, v11
  v_cvt_pk_bf16_f32 v126, v12, v13
  v_cvt_pk_bf16_f32 v127, v14, v15
  buffer_store_dwordx4 v[124:127], v187, s[4:7], s78 offen offset:0 sc1
  s_add_u32 s78, s78, 2097152
  v_mfma_f32_16x16x32_bf16 v[60:63], a[196:199], a[136:139], v[60:63]
  s_barrier
  ds_read_b64_tr_b16 a[196:197], v179 offset:8192
  v_mfma_f32_16x16x32_bf16 v[64:67], a[128:131], a[200:203], v[64:67]
  ds_read_b64_tr_b16 a[198:199], v179 offset:9216
  s_mov_b32 s41, 262144
  s_add_u32 m0, s42, 36864
  v_mfma_f32_16x16x32_bf16 v[64:67], a[136:139], a[204:207], v[64:67]
  buffer_load_dwordx4 v241, s[8:11], s41 offen offset:0 lds
  v_mfma_f32_16x16x32_bf16 v[88:91], a[132:135], a[200:203], v[88:91]
  ds_read_b64_tr_b16 a[200:201], v179 offset:10240
  ds_read_b64_tr_b16 a[202:203], v179 offset:11264
  s_mov_b32 s41, 393216
  s_load_dwordx2 s[66:67], s[36:37], 0x0
  v_mfma_f32_16x16x32_bf16 v[88:91], a[140:143], a[204:207], v[88:91]
  ds_read_b64_tr_b16 a[204:205], v178 offset:20480
  ds_read_b64_tr_b16 a[206:207], v178 offset:21504
  s_add_u32 m0, s42, 53248
  s_waitcnt lgkmcnt(13)
  v_mfma_f32_16x16x32_bf16 v[92:95], a[132:135], a[208:211], v[92:95]
  buffer_load_dwordx4 v241, s[8:11], s41 offen offset:0 lds
  v_mfma_f32_16x16x32_bf16 v[92:95], a[140:143], a[212:215], v[92:95]
  s_mov_b32 s41, 524288
  s_add_u32 m0, s42, 49152
  v_mfma_f32_16x16x32_bf16 v[68:71], a[128:131], a[208:211], v[68:71]
  ds_read_b64_tr_b16 a[208:209], v178 offset:22528
  ds_read_b64_tr_b16 a[210:211], v178 offset:23552
  v_mfma_f32_16x16x32_bf16 v[68:71], a[136:139], a[212:215], v[68:71]
  ds_read_b64_tr_b16 a[212:213], v179 offset:20480
  ds_read_b64_tr_b16 a[214:215], v179 offset:21504
  v_mfma_f32_16x16x32_bf16 v[56:59], a[216:219], a[144:147], v[56:59]
  buffer_load_dwordx4 v241, s[8:11], s41 offen offset:0 lds
  v_mfma_f32_16x16x32_bf16 v[56:59], a[220:223], a[152:155], v[56:59]
  v_mfma_f32_16x16x32_bf16 v[80:83], a[216:219], a[148:151], v[80:83]
  ds_read_b64_tr_b16 a[216:217], v179 offset:22528
  ds_read_b64_tr_b16 a[218:219], v179 offset:23552
  v_mfma_f32_16x16x32_bf16 v[80:83], a[220:223], a[156:159], v[80:83]
  ds_read_b64_tr_b16 a[220:221], v178 offset:36864
  ds_read_b64_tr_b16 a[222:223], v178 offset:37888
  s_waitcnt lgkmcnt(13)
  v_mfma_f32_16x16x32_bf16 v[84:87], a[224:227], a[148:151], v[84:87]
  v_mfma_f32_16x16x32_bf16 v[84:87], a[228:231], a[156:159], v[84:87]
  v_mfma_f32_16x16x32_bf16 v[60:63], a[224:227], a[144:147], v[60:63]
  ds_read_b64_tr_b16 a[224:225], v178 offset:38912
  ds_read_b64_tr_b16 a[226:227], v178 offset:39936
  v_mfma_f32_16x16x32_bf16 v[60:63], a[228:231], a[152:155], v[60:63]
  ds_read_b64_tr_b16 a[228:229], v179 offset:36864
  ds_read_b64_tr_b16 a[230:231], v179 offset:37888
  v_mfma_f32_16x16x32_bf16 v[64:67], a[144:147], a[232:235], v[64:67]
  v_mfma_f32_16x16x32_bf16 v[64:67], a[152:155], a[192:195], v[64:67]
  v_mfma_f32_16x16x32_bf16 v[88:91], a[148:151], a[232:235], v[88:91]
  ds_read_b64_tr_b16 a[232:233], v179 offset:38912
  ds_read_b64_tr_b16 a[234:235], v179 offset:39936
  v_mfma_f32_16x16x32_bf16 v[88:91], a[156:159], a[192:195], v[88:91]
  ds_read_b64_tr_b16 a[192:193], v178 offset:32768
  ds_read_b64_tr_b16 a[194:195], v178 offset:33792
  s_load_dwordx2 s[66:67], s[36:37], 0xff80
  s_waitcnt lgkmcnt(13)
  v_mfma_f32_16x16x32_bf16 v[92:95], a[148:151], a[196:199], v[92:95]
  v_mfma_f32_16x16x32_bf16 v[92:95], a[156:159], a[200:203], v[92:95]
  v_mfma_f32_16x16x32_bf16 v[68:71], a[144:147], a[196:199], v[68:71]
  ds_read_b64_tr_b16 a[196:197], v178 offset:34816
  ds_read_b64_tr_b16 a[198:199], v178 offset:35840
  v_mfma_f32_16x16x32_bf16 v[68:71], a[152:155], a[200:203], v[68:71]
  s_barrier
  ds_read_b64_tr_b16 a[200:201], v179 offset:32768
  v_mfma_f32_16x16x32_bf16 v[56:59], a[204:207], a[160:163], v[56:59]
  ds_read_b64_tr_b16 a[202:203], v179 offset:33792
  s_mov_b32 s41, 655360
  s_add_u32 m0, s42, 61440
  v_mfma_f32_16x16x32_bf16 v[56:59], a[208:211], a[168:171], v[56:59]
  buffer_load_dwordx4 v241, s[8:11], s41 offen offset:0 lds
  v_mfma_f32_16x16x32_bf16 v[80:83], a[204:207], a[164:167], v[80:83]
  ds_read_b64_tr_b16 a[204:205], v179 offset:34816
  ds_read_b64_tr_b16 a[206:207], v179 offset:35840
  s_mov_b32 s41, 786432
  v_mfma_f32_16x16x32_bf16 v[80:83], a[208:211], a[172:175], v[80:83]
  ds_read_b64_tr_b16 a[208:209], v178 offset:45056
  ds_read_b64_tr_b16 a[210:211], v178 offset:46080
  s_add_u32 m0, s42, 77824
  s_waitcnt lgkmcnt(13)
  v_mfma_f32_16x16x32_bf16 v[84:87], a[212:215], a[164:167], v[84:87]
  buffer_load_dwordx4 v241, s[8:11], s41 offen offset:0 lds
  v_mfma_f32_16x16x32_bf16 v[84:87], a[216:219], a[172:175], v[84:87]
  s_mov_b32 s41, 917504
  s_add_u32 m0, s42, 73728
  v_mfma_f32_16x16x32_bf16 v[60:63], a[212:215], a[160:163], v[60:63]
  ds_read_b64_tr_b16 a[212:213], v178 offset:47104
  ds_read_b64_tr_b16 a[214:215], v178 offset:48128
  v_mfma_f32_16x16x32_bf16 v[60:63], a[216:219], a[168:171], v[60:63]
  ds_read_b64_tr_b16 a[216:217], v179 offset:45056
  ds_read_b64_tr_b16 a[218:219], v179 offset:46080
  v_mfma_f32_16x16x32_bf16 v[64:67], a[160:163], a[220:223], v[64:67]
  buffer_load_dwordx4 v241, s[8:11], s41 offen offset:0 lds
  v_mfma_f32_16x16x32_bf16 v[64:67], a[168:171], a[224:227], v[64:67]
  v_mfma_f32_16x16x32_bf16 v[88:91], a[164:167], a[220:223], v[88:91]
  ds_read_b64_tr_b16 a[220:221], v179 offset:47104
  ds_read_b64_tr_b16 a[222:223], v179 offset:48128
  v_mfma_f32_16x16x32_bf16 v[88:91], a[172:175], a[224:227], v[88:91]
  ds_read_b64_tr_b16 a[224:225], v178 offset:61440
  ds_read_b64_tr_b16 a[226:227], v178 offset:62464
  s_waitcnt lgkmcnt(13)
  v_mfma_f32_16x16x32_bf16 v[92:95], a[164:167], a[228:231], v[92:95]
  s_load_dwordx2 s[66:67], s[36:37], 0x1ff00
  v_mfma_f32_16x16x32_bf16 v[92:95], a[172:175], a[232:235], v[92:95]
  v_mfma_f32_16x16x32_bf16 v[68:71], a[160:163], a[228:231], v[68:71]
  ds_read_b64_tr_b16 a[228:229], v178 offset:63488
  ds_read_b64_tr_b16 a[230:231], v178 offset:64512
  v_mfma_f32_16x16x32_bf16 v[68:71], a[168:171], a[232:235], v[68:71]
  ds_read_b64_tr_b16 a[232:233], v179 offset:61440
  ds_read_b64_tr_b16 a[234:235], v179 offset:62464
  v_mfma_f32_16x16x32_bf16 v[56:59], a[192:195], a[176:179], v[56:59]
  v_mfma_f32_16x16x32_bf16 v[56:59], a[196:199], a[184:187], v[56:59]
  v_mfma_f32_16x16x32_bf16 v[80:83], a[192:195], a[180:183], v[80:83]
  ds_read_b64_tr_b16 a[192:193], v179 offset:63488
  ds_read_b64_tr_b16 a[194:195], v179 offset:64512
  v_mfma_f32_16x16x32_bf16 v[80:83], a[196:199], a[188:191], v[80:83]
  ds_read_b64_tr_b16 a[196:197], v178 offset:57344
  ds_read_b64_tr_b16 a[198:199], v178 offset:58368
  s_waitcnt lgkmcnt(13)
  v_mfma_f32_16x16x32_bf16 v[84:87], a[200:203], a[180:183], v[84:87]
  v_mfma_f32_16x16x32_bf16 v[84:87], a[204:207], a[188:191], v[84:87]
  v_mfma_f32_16x16x32_bf16 v[60:63], a[200:203], a[176:179], v[60:63]
  ds_read_b64_tr_b16 a[200:201], v178 offset:59392
  ds_read_b64_tr_b16 a[202:203], v178 offset:60416
  v_mfma_f32_16x16x32_bf16 v[60:63], a[204:207], a[184:187], v[60:63]
  s_barrier
  ds_read_b64_tr_b16 a[204:205], v179 offset:57344
  v_mfma_f32_16x16x32_bf16 v[64:67], a[176:179], a[208:211], v[64:67]
  ds_read_b64_tr_b16 a[206:207], v179 offset:58368
  s_mov_b32 s41, 1048576
  s_add_u32 m0, s42, 86016
  v_mfma_f32_16x16x32_bf16 v[64:67], a[184:187], a[212:215], v[64:67]
  buffer_load_dwordx4 v241, s[8:11], s41 offen offset:0 lds
  v_mfma_f32_16x16x32_bf16 v[88:91], a[180:183], a[208:211], v[88:91]
  ds_read_b64_tr_b16 a[208:209], v179 offset:59392
  ds_read_b64_tr_b16 a[210:211], v179 offset:60416
  s_mov_b32 s41, 1179648
  v_mfma_f32_16x16x32_bf16 v[88:91], a[188:191], a[212:215], v[88:91]
  ds_read_b64_tr_b16 a[212:213], v180 offset:4096
  ds_read_b64_tr_b16 a[214:215], v180 offset:5120
  s_add_u32 m0, s42, 102400
  s_waitcnt lgkmcnt(13)
  v_mfma_f32_16x16x32_bf16 v[92:95], a[180:183], a[216:219], v[92:95]
  buffer_load_dwordx4 v241, s[8:11], s41 offen offset:0 lds
  v_mfma_f32_16x16x32_bf16 v[92:95], a[188:191], a[220:223], v[92:95]
  s_mov_b32 s41, 1310720
  s_add_u32 m0, s42, 98304
  s_waitcnt vmcnt(8)
  v_add_u32 v248, 0, v245
  buffer_store_dword v248, v246, s[4:7], s79 offen sc1
  s_load_dwordx2 s[66:67], s[36:37], 0x2fe80
  v_mfma_f32_16x16x32_bf16 v[68:71], a[176:179], a[216:219], v[68:71]
  ds_read_b64_tr_b16 a[216:217], v180 offset:6144
  ds_read_b64_tr_b16 a[218:219], v180 offset:7168
  v_mfma_f32_16x16x32_bf16 v[68:71], a[184:187], a[220:223], v[68:71]
  ds_read_b64_tr_b16 a[220:221], v181 offset:4096
  ds_read_b64_tr_b16 a[222:223], v181 offset:5120
  v_mfma_f32_16x16x32_bf16 v[56:59], a[224:227], a[0:3], v[56:59]
  buffer_load_dwordx4 v241, s[8:11], s41 offen offset:0 lds
  v_mfma_f32_16x16x32_bf16 v[56:59], a[228:231], a[8:11], v[56:59]
  v_mfma_f32_16x16x32_bf16 v[80:83], a[224:227], a[4:7], v[80:83]
  ds_read_b64_tr_b16 a[224:225], v181 offset:6144
  ds_read_b64_tr_b16 a[226:227], v181 offset:7168
  v_mfma_f32_16x16x32_bf16 v[80:83], a[228:231], a[12:15], v[80:83]
  ds_read_b64_tr_b16 a[228:229], v180 offset:20480
  ds_read_b64_tr_b16 a[230:231], v180 offset:21504
  s_waitcnt lgkmcnt(13)
  v_mfma_f32_16x16x32_bf16 v[84:87], a[232:235], a[4:7], v[84:87]
  v_mfma_f32_16x16x32_bf16 v[84:87], a[192:195], a[12:15], v[84:87]
  v_mfma_f32_16x16x32_bf16 v[60:63], a[232:235], a[0:3], v[60:63]
  ds_read_b64_tr_b16 a[232:233], v180 offset:22528
  ds_read_b64_tr_b16 a[234:235], v180 offset:23552
  v_mfma_f32_16x16x32_bf16 v[60:63], a[192:195], a[8:11], v[60:63]
  ds_read_b64_tr_b16 a[192:193], v181 offset:20480
  ds_read_b64_tr_b16 a[194:195], v181 offset:21504
  ds_read_b128 v[160:163], v250 offset:11264
  v_mfma_f32_16x16x32_bf16 v[64:67], a[0:3], a[196:199], v[64:67]
  ds_read_b128 v[164:167], v250 offset:11328
  ds_read_b128 v[168:171], v250 offset:11392
  ds_read_b128 v[172:175], v250 offset:11456
  v_mfma_f32_16x16x32_bf16 v[64:67], a[8:11], a[200:203], v[64:67]
  ds_read_b128 v[96:99], v250 offset:11520
  ds_read_b128 v[100:103], v250 offset:11584
  ds_read_b128 v[104:107], v250 offset:11648
  v_mfma_f32_16x16x32_bf16 v[88:91], a[4:7], a[196:199], v[88:91]
  ds_read_b64_tr_b16 a[196:197], v181 offset:22528
  ds_read_b64_tr_b16 a[198:199], v181 offset:23552
  ds_read_b128 v[108:111], v250 offset:11712
  v_mfma_f32_16x16x32_bf16 v[88:91], a[12:15], a[200:203], v[88:91]
  ds_read_b64_tr_b16 a[200:201], v180 offset:16384
  ds_read_b64_tr_b16 a[202:203], v180 offset:17408
  s_waitcnt lgkmcnt(13)
  v_mfma_f32_16x16x32_bf16 v[92:95], a[4:7], a[204:207], v[92:95]
  v_mfma_f32_16x16x32_bf16 v[92:95], a[12:15], a[208:211], v[92:95]
  v_mfma_f32_16x16x32_bf16 v[68:71], a[0:3], a[204:207], v[68:71]
  ds_read_b64_tr_b16 a[204:205], v180 offset:18432
  ds_read_b64_tr_b16 a[206:207], v180 offset:19456
  s_load_dwordx2 s[66:67], s[36:37], 0x3fe00
  v_mfma_f32_16x16x32_bf16 v[68:71], a[8:11], a[208:211], v[68:71]
  s_barrier
  ds_read_b64_tr_b16 a[208:209], v181 offset:16384
  v_mfma_f32_16x16x32_bf16 v[56:59], a[212:215], a[16:19], v[56:59]
  ds_read_b64_tr_b16 a[210:211], v181 offset:17408
  s_mov_b32 s41, 1441792
  s_add_u32 m0, s42, 110592
  v_mfma_f32_16x16x32_bf16 v[56:59], a[216:219], a[24:27], v[56:59]
  buffer_load_dwordx4 v241, s[8:11], s41 offen offset:0 lds
  v_mfma_f32_16x16x32_bf16 v[80:83], a[212:215], a[20:23], v[80:83]
  ds_read_b64_tr_b16 a[212:213], v181 offset:18432
  ds_read_b64_tr_b16 a[214:215], v181 offset:19456
  s_mov_b32 s41, 1572864
  v_mfma_f32_16x16x32_bf16 v[80:83], a[216:219], a[28:31], v[80:83]
  ds_read_b64_tr_b16 a[216:217], v180 offset:28672
  ds_read_b64_tr_b16 a[218:219], v180 offset:29696
  s_add_u32 m0, s42, 126976
  v_mfma_f32_16x16x32_bf16 v[84:87], a[220:223], a[20:23], v[84:87]
  buffer_load_dwordx4 v241, s[8:11], s41 offen offset:0 lds
  v_mfma_f32_16x16x32_bf16 v[84:87], a[224:227], a[28:31], v[84:87]
  s_mov_b32 s41, 1703936
  s_add_u32 m0, s42, 122880
  v_mfma_f32_16x16x32_bf16 v[60:63], a[220:223], a[16:19], v[60:63]
  ds_read_b64_tr_b16 a[220:221], v180 offset:30720
  ds_read_b64_tr_b16 a[222:223], v180 offset:31744
  v_mfma_f32_16x16x32_bf16 v[60:63], a[224:227], a[24:27], v[60:63]
  ds_read_b64_tr_b16 a[224:225], v181 offset:28672
  ds_read_b64_tr_b16 a[226:227], v181 offset:29696
  v_mfma_f32_16x16x32_bf16 v[64:67], a[16:19], a[228:231], v[64:67]
  buffer_load_dwordx4 v241, s[8:11], s41 offen offset:0 lds
  v_mfma_f32_16x16x32_bf16 v[64:67], a[24:27], a[232:235], v[64:67]
  s_mov_b32 s41, 1835008
  s_add_u32 m0, s42, 135168
  v_mfma_f32_16x16x32_bf16 v[88:91], a[20:23], a[228:231], v[88:91]
  ds_read_b64_tr_b16 a[228:229], v181 offset:30720
  ds_read_b64_tr_b16 a[230:231], v181 offset:31744
  v_mfma_f32_16x16x32_bf16 v[88:91], a[28:31], a[232:235], v[88:91]
  s_getpc_b64 s[30:31]
L_pc_25:
  s_lshr_b32 s32, s2, 4
  s_lshl_b32 s32, s32, 2
  s_add_u32 s32, s32, s3
  s_lshl_b32 s32, s32, 13
  v_lshlrev_b32 v190, 7, v224
  v_add_u32 v190, s32, v190
  v_min_u32 v190, L_code_end-L_pc_25-4, v190
  global_load_dword v219, v190, s[30:31]
  ds_read_b64_tr_b16 a[232:233], v214 offset:12288
  ds_read_b64_tr_b16 a[234:235], v214 offset:14336
  s_waitcnt lgkmcnt(13)
  v_mfma_f32_16x16x32_bf16 v[92:95], a[20:23], a[192:195], v[92:95]
  v_mfma_f32_16x16x32_bf16 v[92:95], a[28:31], a[196:199], v[92:95]
  buffer_load_dwordx4 v241, s[8:11], s41 offen offset:0 lds
  v_mfma_f32_16x16x32_bf16 v[68:71], a[16:19], a[192:195], v[68:71]
  ds_read_b64_tr_b16 a[192:193], v214 offset:24576
  ds_read_b64_tr_b16 a[194:195], v214 offset:26624
  v_mfma_f32_16x16x32_bf16 v[68:71], a[24:27], a[196:199], v[68:71]
  ds_read_b64_tr_b16 a[196:197], v214 offset:45056
  ds_read_b64_tr_b16 a[198:199], v214 offset:47104
  s_load_dwordx2 s[66:67], s[36:37], 0x4fd80
  v_mfma_f32_16x16x32_bf16 v[56:59], a[200:203], a[32:35], v[56:59]
  v_mfma_f32_16x16x32_bf16 v[56:59], a[204:207], a[40:43], v[56:59]
  v_mfma_f32_16x16x32_bf16 v[80:83], a[200:203], a[36:39], v[80:83]
  ds_read_b64_tr_b16 a[200:201], v214 offset:57344
  ds_read_b64_tr_b16 a[202:203], v214 offset:59392
  v_mfma_f32_16x16x32_bf16 v[80:83], a[204:207], a[44:47], v[80:83]
  ds_read_b64_tr_b16 a[204:205], v215 offset:0
  ds_read_b64_tr_b16 a[206:207], v215 offset:2048
  s_waitcnt lgkmcnt(13)
  v_mfma_f32_16x16x32_bf16 v[84:87], a[208:211], a[36:39], v[84:87]
  v_mfma_f32_16x16x32_bf16 v[84:87], a[212:215], a[44:47], v[84:87]
  v_mfma_f32_16x16x32_bf16 v[60:63], a[208:211], a[32:35], v[60:63]
  ds_read_b64_tr_b16 a[208:209], v215 offset:28672
  ds_read_b64_tr_b16 a[210:211], v215 offset:30720
  v_mfma_f32_16x16x32_bf16 v[60:63], a[212:215], a[40:43], v[60:63]
  s_barrier
  ds_read_b64_tr_b16 a[212:213], v215 offset:40960
  v_mfma_f32_16x16x32_bf16 v[64:67], a[32:35], a[216:219], v[64:67]
  ds_read_b64_tr_b16 a[214:215], v215 offset:43008
  s_mov_b32 s41, 1966080
  s_add_u32 m0, s42, 151552
  v_mfma_f32_16x16x32_bf16 v[64:67], a[40:43], a[220:223], v[64:67]
  buffer_load_dwordx4 v241, s[8:11], s41 offen offset:0 lds
  v_mfma_f32_16x16x32_bf16 v[88:91], a[36:39], a[216:219], v[88:91]
  ds_read_b64_tr_b16 a[216:217], v215 offset:49152
  ds_read_b64_tr_b16 a[218:219], v215 offset:51200
  s_mov_b32 s41, 65536
  v_mfma_f32_16x16x32_bf16 v[88:91], a[44:47], a[220:223], v[88:91]
  ds_read_b64_tr_b16 a[220:221], v176 offset:16384
  ds_read_b64_tr_b16 a[222:223], v176 offset:17408
  s_add_u32 m0, s42, 147456
  s_waitcnt lgkmcnt(13)
  v_mfma_f32_16x16x32_bf16 v[92:95], a[36:39], a[224:227], v[92:95]
  buffer_load_dwordx4 v241, s[8:11], s41 offen offset:0 lds
  v_mfma_f32_16x16x32_bf16 v[92:95], a[44:47], a[228:231], v[92:95]
  v_mfma_f32_16x16x32_bf16 v[68:71], a[32:35], a[224:227], v[68:71]
  ds_read_b64_tr_b16 a[224:225], v176 offset:18432
  ds_read_b64_tr_b16 a[226:227], v176 offset:19456
  v_mfma_f32_16x16x32_bf16 v[68:71], a[40:43], a[228:231], v[68:71]
  ds_read_b64_tr_b16 a[228:229], v177 offset:16384
  ds_read_b64_tr_b16 a[230:231], v177 offset:17408
  v_mfma_f32_16x16x32_bf16 v[220:223], a[232:235], v[160:163], 0
  ds_read_b64_tr_b16 a[232:233], v177 offset:18432
  ds_read_b64_tr_b16 a[234:235], v177 offset:19456
  s_load_dwordx2 s[66:67], s[36:37], 0x5fd00
  v_mfma_f32_16x16x32_bf16 v[220:223], a[192:195], v[164:167], v[220:223]
  ds_read_b64_tr_b16 a[192:193], v176 offset:28672
  ds_read_b64_tr_b16 a[194:195], v176 offset:29696
  s_waitcnt lgkmcnt(13)
  v_mfma_f32_16x16x32_bf16 v[220:223], a[196:199], v[168:171], v[220:223]
  ds_read_b64_tr_b16 a[196:197], v176 offset:30720
  ds_read_b64_tr_b16 a[198:199], v176 offset:31744
  v_mfma_f32_16x16x32_bf16 v[220:223], a[200:203], v[172:175], v[220:223]
  ds_read_b64_tr_b16 a[200:201], v177 offset:28672
  ds_read_b64_tr_b16 a[202:203], v177 offset:29696
  v_mfma_f32_16x16x32_bf16 v[220:223], a[204:207], v[96:99], v[220:223]
  ds_read_b64_tr_b16 a[204:205], v177 offset:30720
  ds_read_b64_tr_b16 a[206:207], v177 offset:31744
  v_mfma_f32_16x16x32_bf16 v[220:223], a[208:211], v[100:103], v[220:223]
  ds_read_b64_tr_b16 a[208:209], v176 offset:32768
  ds_read_b64_tr_b16 a[210:211], v176 offset:33792
  s_waitcnt lgkmcnt(13)
  v_mfma_f32_16x16x32_bf16 v[220:223], a[212:215], v[104:107], v[220:223]
  ds_read_b64_tr_b16 a[212:213], v176 offset:34816
  ds_read_b64_tr_b16 a[214:215], v176 offset:35840
  v_mfma_f32_16x16x32_bf16 v[220:223], a[216:219], v[108:111], v[220:223]
  ds_read_b64_tr_b16 a[216:217], v177 offset:32768
  ds_read_b64_tr_b16 a[218:219], v177 offset:33792
  v_mov_b32 v217, 0xff
  v_mfma_f32_16x16x32_bf16 v[56:59], a[220:223], a[48:51], v[56:59]
  v_mfma_f32_16x16x32_bf16 v[56:59], a[224:227], a[56:59], v[56:59]
  v_mfma_f32_16x16x32_bf16 v[80:83], a[220:223], a[52:55], v[80:83]
  ds_read_b64_tr_b16 a[220:221], v177 offset:34816
  ds_read_b64_tr_b16 a[222:223], v177 offset:35840
  v_bfi_b32 v220, v217, s84, v220
  v_mfma_f32_16x16x32_bf16 v[80:83], a[224:227], a[60:63], v[80:83]
  ds_read_b64_tr_b16 a[224:225], v176 offset:40960
  ds_read_b64_tr_b16 a[226:227], v176 offset:41984
  v_bfi_b32 v221, v217, s85, v221
  s_waitcnt lgkmcnt(13)
  v_mfma_f32_16x16x32_bf16 v[84:87], a[228:231], a[52:55], v[84:87]
  v_bfi_b32 v222, v217, s86, v222
  v_bfi_b32 v223, v217, s87, v223
  v_mfma_f32_16x16x32_bf16 v[84:87], a[232:235], a[60:63], v[84:87]
  buffer_store_dwordx4 v[220:223], v218, s[4:7], 0 offen sc1
  v_mfma_f32_16x16x32_bf16 v[60:63], a[228:231], a[48:51], v[60:63]
  ds_read_b64_tr_b16 a[228:229], v176 offset:43008
  ds_read_b64_tr_b16 a[230:231], v176 offset:44032
  v_mfma_f32_16x16x32_bf16 v[60:63], a[232:235], a[56:59], v[60:63]
  s_barrier
  ds_read_b64_tr_b16 a[232:233], v177 offset:40960
  buffer_load_dword v244, v243, s[4:7], s88 offen sc1
  v_cvt_pk_bf16_f32 v128, v80, v81
  v_cvt_pk_bf16_f32 v129, v82, v83
  v_cvt_pk_bf16_f32 v130, v84, v85
  v_cvt_pk_bf16_f32 v131, v86, v87
  ds_write_b128 v191, v[128:131]
  v_mov_b32 v144, v128
  v_mov_b32 v146, v129
  v_mov_b32 v148, v130
  v_mov_b32 v150, v131
  v_mfma_f32_16x16x32_bf16 v[64:67], a[48:51], a[192:195], v[64:67]
  ds_read_b64_tr_b16 a[234:235], v177 offset:41984
  s_mov_b32 s41, 196608
  s_add_u32 m0, s42, 159744
  buffer_store_dwordx4 v[144:147], v188, s[4:7], 0 offen offset:0 sc1
  buffer_store_dwordx4 v[148:151], v188, s[4:7], 0 offen offset:1024 sc1
  v_mfma_f32_16x16x32_bf16 v[64:67], a[56:59], a[196:199], v[64:67]
  buffer_load_dwordx4 v[32:35], v249, s[48:51], 0 offen offset:0
  s_load_dwordx2 s[66:67], s[36:37], 0x6fc80
  s_add_u32 s36, s23, s44
  s_addc_u32 s37, s45, 0
  v_mfma_f32_16x16x32_bf16 v[88:91], a[52:55], a[192:195], v[88:91]
  ds_read_b64_tr_b16 a[192:193], v177 offset:43008
L_wk0_3:
  s_cbranch_vccnz L_wk0_end
  ds_read_b64_tr_b16 a[194:195], v177 offset:44032
  v_mfma_f32_16x16x32_bf16 v[88:91], a[60:63], a[196:199], v[88:91]
  buffer_load_dwordx4 v241, s[8:11], s41 offen offset:0 lds
  s_waitcnt lgkmcnt(13)
  v_mfma_f32_16x16x32_bf16 v[92:95], a[52:55], a[200:203], v[92:95]
  ds_read_b64_tr_b16 a[196:197], v178 offset:4096
  ds_read_b64_tr_b16 a[198:199], v178 offset:5120
  s_mov_b32 s41, 327680
  v_mfma_f32_16x16x32_bf16 v[92:95], a[60:63], a[204:207], v[92:95]
  s_add_u32 m0, s42, 16384
  buffer_load_dwordx4 v[36:39], v249, s[48:51], 0 offen offset:64
  v_mfma_f32_16x16x32_bf16 v[68:71], a[48:51], a[200:203], v[68:71]
  ds_read_b64_tr_b16 a[200:201], v178 offset:6144
  ds_read_b64_tr_b16 a[202:203], v178 offset:7168
  v_mfma_f32_16x16x32_bf16 v[68:71], a[56:59], a[204:207], v[68:71]
  buffer_load_dwordx4 v241, s[8:11], s41 offen offset:0 lds
  v_cvt_pk_bf16_f32 v136, v88, v89
  v_cvt_pk_bf16_f32 v137, v90, v91
  v_cvt_pk_bf16_f32 v142, v92, v93
  v_cvt_pk_bf16_f32 v143, v94, v95
  v_mov_b32 v152, v136
  v_mov_b32 v154, v137
  v_mov_b32 v156, v142
  v_mov_b32 v158, v143
  buffer_store_dwordx4 v[152:155], v188, s[4:7], 0 offen offset:2048 sc1
  buffer_store_dwordx4 v[156:159], v188, s[4:7], 0 offen offset:3072 sc1
  ds_write_b64 v191, v[136:137] offset:1024
  v_mfma_f32_16x16x32_bf16 v[48:51], a[208:211], a[112:115], v[48:51]
  ds_read_b64_tr_b16 a[204:205], v179 offset:4096
  ds_read_b64_tr_b16 a[206:207], v179 offset:5120
  s_mov_b32 s41, 458752
  ds_write_b64 v191, v[142:143] offset:1032
  v_cvt_pk_bf16_f32 v124, v56, v57
  v_cvt_pk_bf16_f32 v125, v58, v59
  v_cvt_pk_bf16_f32 v126, v60, v61
  v_cvt_pk_bf16_f32 v127, v62, v63
  v_cvt_pk_bf16_f32 v134, v64, v65
  v_cvt_pk_bf16_f32 v135, v66, v67
  v_cvt_pk_bf16_f32 v140, v68, v69
  v_mfma_f32_16x16x32_bf16 v[48:51], a[212:215], a[120:123], v[48:51]
  s_add_u32 m0, s42, 12288
  v_cvt_pk_bf16_f32 v141, v70, v71
  buffer_load_dwordx4 v[40:43], v249, s[48:51], s38 offen offset:0
  v_mfma_f32_16x16x32_bf16 v[72:75], a[208:211], a[116:119], v[72:75]
  ds_read_b64_tr_b16 a[208:209], v179 offset:6144
  ds_read_b64_tr_b16 a[210:211], v179 offset:7168
  v_mfma_f32_16x16x32_bf16 v[72:75], a[212:215], a[124:127], v[72:75]
  buffer_load_dwordx4 v241, s[8:11], s41 offen offset:0 lds
  s_waitcnt lgkmcnt(13)
  v_mfma_f32_16x16x32_bf16 v[76:79], a[216:219], a[116:119], v[76:79]
  ds_read_b64_tr_b16 a[212:213], v178 offset:16384
  ds_read_b64_tr_b16 a[214:215], v178 offset:17408
  s_mov_b32 s41, 589824
  v_mfma_f32_16x16x32_bf16 v[76:79], a[220:223], a[124:127], v[76:79]
  s_add_u32 m0, s42, 24576
  buffer_load_dwordx4 v[44:47], v249, s[48:51], s38 offen offset:64
  v_mfma_f32_16x16x32_bf16 v[52:55], a[216:219], a[112:115], v[52:55]
  ds_read_b64_tr_b16 a[216:217], v178 offset:18432
  ds_read_b64_tr_b16 a[218:219], v178 offset:19456
  v_mfma_f32_16x16x32_bf16 v[52:55], a[220:223], a[120:123], v[52:55]
  buffer_load_dwordx4 v241, s[8:11], s41 offen offset:0 lds
  v_mfma_f32_16x16x32_bf16 v[48:51], a[224:227], a[128:131], v[48:51]
  ds_read_b64_tr_b16 a[220:221], v179 offset:16384
  ds_read_b64_tr_b16 a[222:223], v179 offset:17408
  s_mov_b32 s41, 720896
  s_waitcnt lgkmcnt(8)
  v_add_u32 v188, 4096, v188
  v_mfma_f32_16x16x32_bf16 v[48:51], a[228:231], a[136:139], v[48:51]
  s_add_u32 m0, s42, 45056
  v_mfma_f32_16x16x32_bf16 v[72:75], a[224:227], a[132:135], v[72:75]
  buffer_load_dwordx4 v241, s[8:11], s41 offen offset:0 lds
  v_mfma_f32_16x16x32_bf16 v[72:75], a[228:231], a[140:143], v[72:75]
  ds_read_b64_tr_b16 a[224:225], v179 offset:18432
  ds_read_b64_tr_b16 a[226:227], v179 offset:19456
  s_mov_b32 s41, 851968
  v_mfma_f32_16x16x32_bf16 v[76:79], a[232:235], a[132:135], v[76:79]
  ds_read_b64_tr_b16 a[228:229], v178 offset:24576
  ds_read_b64_tr_b16 a[230:231], v178 offset:25600
  s_add_u32 m0, s42, 57344
  v_mfma_f32_16x16x32_bf16 v[76:79], a[192:195], a[140:143], v[76:79]
  v_mfma_f32_16x16x32_bf16 v[52:55], a[232:235], a[128:131], v[52:55]
  buffer_load_dwordx4 v241, s[8:11], s41 offen offset:0 lds
  v_mfma_f32_16x16x32_bf16 v[52:55], a[192:195], a[136:139], v[52:55]
  s_barrier
  ds_read_b64_tr_b16 a[232:233], v178 offset:26624
  ds_read_b128 v[120:123], v209
  ds_read_b64 v[132:133], v209 offset:1024
  ds_read_b64 v[138:139], v209 offset:1032
  v_mfma_f32_16x16x32_bf16 v[48:51], a[196:199], a[144:147], v[48:51]
  ds_read_b64_tr_b16 a[234:235], v178 offset:27648
  ds_read_b64_tr_b16 a[192:193], v179 offset:24576
  s_mov_b32 s41, 983040
  v_mfma_f32_16x16x32_bf16 v[48:51], a[200:203], a[152:155], v[48:51]
  ds_read_b64_tr_b16 a[194:195], v179 offset:25600
  s_add_u32 m0, s42, 65536
  v_mfma_f32_16x16x32_bf16 v[72:75], a[196:199], a[148:151], v[72:75]
  buffer_load_dwordx4 v241, s[8:11], s41 offen offset:0 lds
  v_mfma_f32_16x16x32_bf16 v[72:75], a[200:203], a[156:159], v[72:75]
  ds_read_b64_tr_b16 a[196:197], v179 offset:26624
  ds_read_b64_tr_b16 a[198:199], v179 offset:27648
  s_mov_b32 s41, 1114112
  v_mfma_f32_16x16x32_bf16 v[76:79], a[204:207], a[148:151], v[76:79]
  ds_read_b64_tr_b16 a[200:201], v178 offset:53248
  ds_read_b64_tr_b16 a[202:203], v178 offset:54272
  s_add_u32 m0, s42, 94208
  s_waitcnt lgkmcnt(13)
  v_mfma_f32_16x16x32_bf16 v[76:79], a[208:211], a[156:159], v[76:79]
  v_mfma_f32_16x16x32_bf16 v[52:55], a[204:207], a[144:147], v[52:55]
  buffer_load_dwordx4 v241, s[8:11], s41 offen offset:0 lds
  v_mfma_f32_16x16x32_bf16 v[52:55], a[208:211], a[152:155], v[52:55]
  ds_read_b64_tr_b16 a[204:205], v178 offset:55296
  ds_read_b64_tr_b16 a[206:207], v178 offset:56320
  s_mov_b32 s41, 1245184
  v_mfma_f32_16x16x32_bf16 v[48:51], a[212:215], a[160:163], v[48:51]
  ds_read_b64_tr_b16 a[208:209], v179 offset:53248
  ds_read_b64_tr_b16 a[210:211], v179 offset:54272
  s_add_u32 m0, s42, 106496
  v_mfma_f32_16x16x32_bf16 v[48:51], a[216:219], a[168:171], v[48:51]
  v_mfma_f32_16x16x32_bf16 v[72:75], a[212:215], a[164:167], v[72:75]
  buffer_load_dwordx4 v241, s[8:11], s41 offen offset:0 lds
  v_mfma_f32_16x16x32_bf16 v[72:75], a[216:219], a[172:175], v[72:75]
  ds_read_b64_tr_b16 a[212:213], v179 offset:55296
  ds_read_b64_tr_b16 a[214:215], v179 offset:56320
  s_mov_b32 s41, 1376256
  v_mfma_f32_16x16x32_bf16 v[76:79], a[220:223], a[164:167], v[76:79]
  ds_read_b64_tr_b16 a[216:217], v180 offset:0
  ds_read_b64_tr_b16 a[218:219], v180 offset:1024
  s_add_u32 m0, s42, 114688
  v_mfma_f32_16x16x32_bf16 v[76:79], a[224:227], a[172:175], v[76:79]
  v_mfma_f32_16x16x32_bf16 v[52:55], a[220:223], a[160:163], v[52:55]
  buffer_load_dwordx4 v241, s[8:11], s41 offen offset:0 lds
  v_mfma_f32_16x16x32_bf16 v[52:55], a[224:227], a[168:171], v[52:55]
  ds_read_b64_tr_b16 a[220:221], v180 offset:2048
  ds_read_b64_tr_b16 a[222:223], v180 offset:3072
  s_mov_b32 s41, 1507328
  s_waitcnt vmcnt(18)
  v_subrev_u32 v244, s100, v244
  s_waitcnt lgkmcnt(13)
  v_mfma_f32_16x16x32_bf16 v[48:51], a[228:231], a[176:179], v[48:51]
  ds_read_b64_tr_b16 a[224:225], v181 offset:0
  ds_read_b64_tr_b16 a[226:227], v181 offset:1024
  s_add_u32 m0, s42, 28672
  v_cmp_lt_u32 s[68:69], 7, v244
  v_mfma_f32_16x16x32_bf16 v[48:51], a[232:235], a[184:187], v[48:51]
  v_mfma_f32_16x16x32_bf16 v[72:75], a[228:231], a[180:183], v[72:75]
  buffer_load_dwordx4 v241, s[8:11], s41 offen offset:0 lds
  s_cmp_lg_u64 s[68:69], 0
  s_cbranch_scc1 L_slow_15
L_back_16:
  v_mfma_f32_16x16x32_bf16 v[72:75], a[232:235], a[188:191], v[72:75]
  ds_read_b64_tr_b16 a[228:229], v181 offset:2048
  ds_read_b64_tr_b16 a[230:231], v181 offset:3072
  s_mov_b32 s40, 5242880
  v_mfma_f32_16x16x32_bf16 v[76:79], a[192:195], a[180:183], v[76:79]
  ds_read_b64_tr_b16 a[232:233], v180 offset:8192
  ds_read_b64_tr_b16 a[234:235], v180 offset:9216
  s_waitcnt lgkmcnt(13)
  v_mfma_f32_16x16x32_bf16 v[76:79], a[196:199], a[188:191], v[76:79]
  v_mfma_f32_16x16x32_bf16 v[52:55], a[192:195], a[176:179], v[52:55]
  buffer_load_dwordx4 a[64:67], v240, s[4:7], s40 offen offset:0 sc1
  v_mfma_f32_16x16x32_bf16 v[52:55], a[196:199], a[184:187], v[52:55]
  s_barrier
  ds_read_b64_tr_b16 a[192:193], v180 offset:10240
  v_mfma_f32_16x16x32_bf16 v[48:51], a[200:203], a[0:3], v[48:51]
  ds_read_b64_tr_b16 a[194:195], v180 offset:11264
  ds_read_b64_tr_b16 a[196:197], v181 offset:8192
  v_mfma_f32_16x16x32_bf16 v[48:51], a[204:207], a[8:11], v[48:51]
  ds_read_b64_tr_b16 a[198:199], v181 offset:9216
  v_mfma_f32_16x16x32_bf16 v[72:75], a[200:203], a[4:7], v[72:75]
  buffer_load_dwordx4 a[68:71], v240, s[4:7], s40 offen offset:1024 sc1
  s_mov_b32 s40, 5373952
  v_mfma_f32_16x16x32_bf16 v[72:75], a[204:207], a[12:15], v[72:75]
  ds_read_b64_tr_b16 a[200:201], v181 offset:10240
  ds_read_b64_tr_b16 a[202:203], v181 offset:11264
  s_waitcnt lgkmcnt(13)
  v_mfma_f32_16x16x32_bf16 v[76:79], a[208:211], a[4:7], v[76:79]
  ds_read_b64_tr_b16 a[204:205], v176 offset:20480
  ds_read_b64_tr_b16 a[206:207], v176 offset:21504
  v_mfma_f32_16x16x32_bf16 v[76:79], a[212:215], a[12:15], v[76:79]
  v_mfma_f32_16x16x32_bf16 v[52:55], a[208:211], a[0:3], v[52:55]
  buffer_load_dwordx4 a[72:75], v240, s[4:7], s40 offen offset:0 sc1
  v_mfma_f32_16x16x32_bf16 v[52:55], a[212:215], a[8:11], v[52:55]
  ds_read_b64_tr_b16 a[208:209], v176 offset:22528
  ds_read_b64_tr_b16 a[210:211], v176 offset:23552
  buffer_load_dwordx4 v[160:163], v182, s[4:7], 0 offen offset:0 sc1
  buffer_load_dwordx4 v[164:167], v182, s[4:7], 0 offen offset:1024 sc1
  buffer_load_dwordx4 v[168:171], v182, s[4:7], 0 offen offset:2048 sc1
  buffer_load_dwordx4 v[172:175], v182, s[4:7], 0 offen offset:3072 sc1
  v_mfma_f32_16x16x32_bf16 v[48:51], a[216:219], a[16:19], v[48:51]
  ds_read_b64_tr_b16 a[212:213], v177 offset:20480
  ds_read_b64_tr_b16 a[214:215], v177 offset:21504
  s_waitcnt lgkmcnt(13)
  v_mfma_f32_16x16x32_bf16 v[48:51], a[220:223], a[24:27], v[48:51]
  buffer_load_dwordx4 a[76:79], v240, s[4:7], s40 offen offset:1024 sc1
  v_mfma_f32_16x16x32_bf16 v[72:75], a[216:219], a[20:23], v[72:75]
  ds_read_b64_tr_b16 a[216:217], v177 offset:22528
  ds_read_b64_tr_b16 a[218:219], v177 offset:23552
  s_mov_b32 s40, 5505024
  v_mfma_f32_16x16x32_bf16 v[72:75], a[220:223], a[28:31], v[72:75]
  ds_read_b64_tr_b16 a[220:221], v236 offset:12288
  ds_read_b64_tr_b16 a[222:223], v236 offset:14336
  v_mfma_f32_16x16x32_bf16 v[76:79], a[224:227], a[20:23], v[76:79]
  v_mfma_f32_16x16x32_bf16 v[76:79], a[228:231], a[28:31], v[76:79]
  v_mfma_f32_16x16x32_bf16 v[52:55], a[224:227], a[16:19], v[52:55]
  buffer_load_dwordx4 a[80:83], v240, s[4:7], s40 offen offset:0 sc1
  v_mfma_f32_16x16x32_bf16 v[52:55], a[228:231], a[24:27], v[52:55]
  ds_read_b64_tr_b16 a[224:225], v236 offset:24576
  ds_read_b64_tr_b16 a[226:227], v236 offset:26624
  s_waitcnt lgkmcnt(13)
  v_mfma_f32_16x16x32_bf16 v[48:51], a[232:235], a[32:35], v[48:51]
  ds_read_b64_tr_b16 a[228:229], v237 offset:12288
  ds_read_b64_tr_b16 a[230:231], v237 offset:14336
  v_mfma_f32_16x16x32_bf16 v[48:51], a[192:195], a[40:43], v[48:51]
  v_mfma_f32_16x16x32_bf16 v[72:75], a[232:235], a[36:39], v[72:75]
  buffer_load_dwordx4 a[84:87], v240, s[4:7], s40 offen offset:1024 sc1
  s_mov_b32 s40, 5636096
  v_mfma_f32_16x16x32_bf16 v[72:75], a[192:195], a[44:47], v[72:75]
  ds_read_b64_tr_b16 a[232:233], v237 offset:24576
  ds_read_b64_tr_b16 a[234:235], v237 offset:26624
  v_mfma_f32_16x16x32_bf16 v[76:79], a[196:199], a[36:39], v[76:79]
  ds_read_b64_tr_b16 a[192:193], v238 offset:12288
  ds_read_b64_tr_b16 a[194:195], v238 offset:14336
  s_waitcnt lgkmcnt(13)
  v_mfma_f32_16x16x32_bf16 v[76:79], a[200:203], a[44:47], v[76:79]
  v_mfma_f32_16x16x32_bf16 v[52:55], a[196:199], a[32:35], v[52:55]
  buffer_load_dwordx4 a[88:91], v240, s[4:7], s40 offen offset:0 sc1
  v_mfma_f32_16x16x32_bf16 v[52:55], a[200:203], a[40:43], v[52:55]
  ds_read_b64_tr_b16 a[196:197], v238 offset:24576
  ds_read_b64_tr_b16 a[198:199], v238 offset:26624
  v_mfma_f32_16x16x32_bf16 v[48:51], a[204:207], a[48:51], v[48:51]
  buffer_load_dwordx4 a[92:95], v240, s[4:7], s40 offen offset:1024 sc1
  v_mfma_f32_16x16x32_bf16 v[48:51], a[208:211], a[56:59], v[48:51]
  ds_read_b64_tr_b16 a[200:201], v239 offset:12288
  ds_read_b64_tr_b16 a[202:203], v239 offset:14336
  s_mov_b32 s40, 5767168
  v_mfma_f32_16x16x32_bf16 v[72:75], a[204:207], a[52:55], v[72:75]
  ds_read_b64_tr_b16 a[204:205], v239 offset:24576
  ds_read_b64_tr_b16 a[206:207], v239 offset:26624
  v_mfma_f32_16x16x32_bf16 v[72:75], a[208:211], a[60:63], v[72:75]
  ds_read_b64_tr_b16 a[208:209], v228 offset:36864
  ds_read_b64_tr_b16 a[210:211], v228 offset:38912
  s_waitcnt lgkmcnt(13)
  v_mfma_f32_16x16x32_bf16 v[76:79], a[212:215], a[52:55], v[76:79]
  v_mfma_f32_16x16x32_bf16 v[76:79], a[216:219], a[60:63], v[76:79]
  buffer_load_dwordx4 a[96:99], v240, s[4:7], s40 offen offset:0 sc1
  v_mfma_f32_16x16x32_bf16 v[52:55], a[212:215], a[48:51], v[52:55]
  ds_read_b64_tr_b16 a[212:213], v228 offset:53248
  ds_read_b64_tr_b16 a[214:215], v228 offset:55296
  v_mfma_f32_16x16x32_bf16 v[52:55], a[216:219], a[56:59], v[52:55]
  v_cvt_pk_bf16_f32 v116, v72, v73
  v_cvt_pk_bf16_f32 v117, v74, v75
  s_nop 0
  v_cvt_pk_bf16_f32 v118, v76, v77
  v_cvt_pk_bf16_f32 v119, v78, v79
  v_cvt_pk_bf16_f32 v112, v48, v49
  buffer_load_dwordx4 a[100:103], v240, s[4:7], s40 offen offset:1024 sc1
  v_cvt_pk_bf16_f32 v113, v50, v51
  v_cvt_pk_bf16_f32 v114, v52, v53
  v_cvt_pk_bf16_f32 v115, v54, v55
  v_mfma_f32_16x16x32_bf16 v[52:55], v[128:131], v[116:119], 0
  s_mov_b32 s40, 5898240
  buffer_load_dwordx4 a[104:107], v240, s[4:7], s40 offen offset:0 sc1
  v_mfma_f32_16x16x32_bf16 v[48:51], v[124:127], v[116:119], 0
  v_mfma_f32_16x16x32_bf16 v[60:63], v[124:127], v[112:115], 0
  s_waitcnt vmcnt(8)
  v_xor_b32 v196, v183, v161
  v_bitop3_b32 v196, v163, v183, v196 bitop3:0xbe
  v_bitop3_b32 v196, v165, v183, v196 bitop3:0xbe
  buffer_load_dwordx4 a[108:111], v240, s[4:7], s40 offen offset:1024 sc1
  v_bitop3_b32 v196, v167, v183, v196 bitop3:0xbe
  v_bitop3_b32 v196, v169, v183, v196 bitop3:0xbe
  v_bitop3_b32 v196, v171, v183, v196 bitop3:0xbe
  v_bitop3_b32 v196, v173, v183, v196 bitop3:0xbe
  v_bitop3_b32 v196, v175, v183, v196 bitop3:0xbe
  s_mov_b32 s40, 6029312
  buffer_load_dwordx4 a[112:115], v240, s[4:7], s40 offen offset:0 sc1
  v_cmp_ne_u32 s[0:1], 0, v196
  s_nop 1
  s_cmp_lg_u64 s[0:1], 0
  s_cbranch_scc1 L_slow_23
L_back_24:
  v_or_b32 v120, v120, v160
  v_or_b32 v121, v121, v162
  v_or_b32 v122, v122, v164
  buffer_load_dwordx4 a[116:119], v240, s[4:7], s40 offen offset:1024 sc1
  v_or_b32 v123, v123, v166
  v_or_b32 v132, v132, v168
  v_or_b32 v133, v133, v170
  v_or_b32 v138, v138, v172
  v_or_b32 v139, v139, v174
  s_mov_b32 s40, 6160384
  buffer_load_dwordx4 a[120:123], v240, s[4:7], s40 offen offset:0 sc1
  v_add_u32 v182, 4096, v182
  v_mfma_f32_16x16x32_bf16 v[56:59], v[120:123], v[112:115], 0
  v_cndmask_b32_e64 v48, v48, v49, s[28:29]
  v_cndmask_b32_e64 v50, v50, v51, s[28:29]
  v_cndmask_b32_e64 v52, v52, v53, s[28:29]
  buffer_load_dwordx4 a[124:127], v240, s[4:7], s40 offen offset:1024 sc1
  v_cndmask_b32_e64 v54, v54, v55, s[28:29]
  s_nop 2
  v_cndmask_b32_e64 v56, v56, v57, s[28:29]
  v_cndmask_b32_e64 v58, v58, v59, s[28:29]
  v_cndmask_b32_e64 v60, v60, v61, s[28:29]
  v_cndmask_b32_e64 v62, v62, v63, s[28:29]
  s_mov_b32 s40, 6291456
  buffer_load_dwordx4 a[128:131], v240, s[4:7], s40 offen offset:0 sc1
  v_cndmask_b32_e64 v48, v48, v52, s[24:25]
  v_cndmask_b32_e64 v49, v50, v54, s[26:27]
  v_cndmask_b32_e64 v56, v56, v60, s[24:25]
  v_cndmask_b32_e64 v57, v58, v62, s[26:27]
  s_mov_b32 s33, 0x3e8293ee
  v_mul_f32 v48, s33, v48
  v_mul_f32 v49, s33, v49
  v_fma_f32 v56, v56, s33, v193
  v_fma_f32 v57, v57, s33, v194
  buffer_load_dwordx4 a[132:135], v240, s[4:7], s40 offen offset:1024 sc1
  v_max_f32 v64, v48, v49
  v_max_f32 v65, v56, v57
  v_mov_b32 v68, v64
  v_mov_b32 v69, v65
  s_nop 0
  v_permlane16_swap_b32 v68, v64
  s_mov_b32 s40, 6422528
  buffer_load_dwordx4 a[136:139], v240, s[4:7], s40 offen offset:0 sc1
  v_permlane16_swap_b32 v69, v65
  v_max_f32 v64, v64, v68
  s_nop 0
  v_max_f32 v65, v65, v69
  v_mov_b32 v68, v64
  v_mov_b32 v69, v65
  buffer_load_dwordx4 a[140:143], v240, s[4:7], s40 offen offset:1024 sc1
  v_permlane32_swap_b32 v68, v64
  v_permlane32_swap_b32 v69, v65
  s_nop 0
  v_max_f32 v64, v64, v68
  v_max_f32 v65, v65, v69
  v_sub_f32 v48, v48, v64
  s_mov_b32 s40, 6553600
  buffer_load_dwordx4 a[144:147], v240, s[4:7], s40 offen offset:0 sc1
  v_sub_f32 v49, v49, v64
  v_sub_f32 v56, v56, v65
  v_sub_f32 v57, v57, v65
  v_exp_f32 v48, v48
  v_exp_f32 v49, v49
  buffer_load_dwordx4 a[148:151], v240, s[4:7], s40 offen offset:1024 sc1
  v_exp_f32 v56, v56
  v_exp_f32 v57, v57
  v_add_f32 v64, v48, v49
  v_add_f32 v65, v56, v57
  v_mov_b32 v68, v64
  s_mov_b32 s40, 6684672
  buffer_load_dwordx4 a[152:155], v240, s[4:7], s40 offen offset:0 sc1
  v_mov_b32 v69, v65
  v_permlane16_swap_b32 v68, v64
  s_nop 0
  v_permlane16_swap_b32 v69, v65
  v_add_f32 v64, v64, v68
  s_nop 0
  v_add_f32 v65, v65, v69
  buffer_load_dwordx4 a[156:159], v240, s[4:7], s40 offen offset:1024 sc1
  v_mov_b32 v68, v64
  v_mov_b32 v69, v65
  s_nop 0
  v_permlane32_swap_b32 v68, v64
  v_permlane32_swap_b32 v69, v65
  s_nop 0
  v_add_f32 v64, v64, v68
  s_mov_b32 s40, 6815744
  buffer_load_dwordx4 a[160:163], v240, s[4:7], s40 offen offset:0 sc1
  v_add_f32 v65, v65, v69
  v_rcp_f32 v64, v64
  v_rcp_f32 v65, v65
  v_mul_f32 v48, v48, v64
  v_mul_f32 v49, v49, v64
  buffer_load_dwordx4 a[164:167], v240, s[4:7], s40 offen offset:1024 sc1
  v_mul_f32 v56, v56, v65
  v_mul_f32 v57, v57, v65
  v_cvt_pk_bf16_f32 v48, v48, 0
  v_cvt_pk_bf16_f32 v49, v49, 0
  v_cvt_pk_bf16_f32 v56, v56, 0
  s_mov_b32 s40, 6946816
  buffer_load_dwordx4 a[168:171], v240, s[4:7], s40 offen offset:0 sc1
  v_cvt_pk_bf16_f32 v57, v57, 0
  v_lshlrev_b32 v48, v195, v48
  v_lshlrev_b32 v49, v195, v49
  v_lshlrev_b32 v56, v195, v56
  v_lshlrev_b32 v57, v195, v57
  buffer_load_dwordx4 a[172:175], v240, s[4:7], s40 offen offset:1024 sc1
  v_cndmask_b32_e64 v112, v48, 0, s[24:25]
  v_cndmask_b32_e64 v114, 0, v48, s[24:25]
  v_cndmask_b32_e64 v113, v49, 0, s[26:27]
  v_cndmask_b32_e64 v115, 0, v49, s[26:27]
  v_cndmask_b32_e64 v116, v56, 0, s[24:25]
  s_mov_b32 s40, 7077888
  buffer_load_dwordx4 a[176:179], v240, s[4:7], s40 offen offset:0 sc1
  v_cndmask_b32_e64 v118, 0, v56, s[24:25]
  v_cndmask_b32_e64 v117, v57, 0, s[26:27]
  v_cndmask_b32_e64 v119, 0, v57, s[26:27]
  v_mfma_f32_16x16x32_bf16 v[48:51], v[134:137], v[112:115], 0
  v_mfma_f32_16x16x32_bf16 v[52:55], v[140:143], v[112:115], 0
  v_mfma_f32_16x16x32_bf16 v[56:59], v[132:135], v[116:119], 0
  v_mfma_f32_16x16x32_bf16 v[60:63], v[138:141], v[116:119], 0
  s_nop 4
  v_cvt_pk_bf16_f32 v120, v48, v49
  v_cvt_pk_bf16_f32 v121, v50, v51
  v_cvt_pk_bf16_f32 v122, v52, v53
  v_cvt_pk_bf16_f32 v123, v54, v55
  buffer_store_dwordx4 v[120:123], v187, s[4:7], s78 offen offset:1024 sc1
  v_cvt_pk_bf16_f32 v124, v56, v57
  v_cvt_pk_bf16_f32 v125, v58, v59
  v_cvt_pk_bf16_f32 v126, v60, v61
  v_cvt_pk_bf16_f32 v127, v62, v63
  buffer_store_dwordx4 v[124:127], v187, s[4:7], s78 offen offset:0 sc1
  s_add_u32 s78, s78, 2097152
  ds_read_b64_tr_b16 a[216:217], v229 offset:36864
  ds_read_b64_tr_b16 a[218:219], v229 offset:38912
  s_waitcnt vmcnt(27)
  v_mfma_f32_16x16x32_bf16 v[0:3], a[220:223], a[64:67], 0
  v_mfma_f32_16x16x32_bf16 v[0:3], a[224:227], a[72:75], v[0:3]
  v_mfma_f32_16x16x32_bf16 v[16:19], a[220:223], a[68:71], 0
  ds_read_b64_tr_b16 a[220:221], v229 offset:53248
  ds_read_b64_tr_b16 a[222:223], v229 offset:55296
  v_mfma_f32_16x16x32_bf16 v[16:19], a[224:227], a[76:79], v[16:19]
  ds_read_b64_tr_b16 a[224:225], v230 offset:36864
  ds_read_b64_tr_b16 a[226:227], v230 offset:38912
  s_waitcnt lgkmcnt(13)
  v_mfma_f32_16x16x32_bf16 v[20:23], a[228:231], a[68:71], 0
  v_mfma_f32_16x16x32_bf16 v[20:23], a[232:235], a[76:79], v[20:23]
  v_mfma_f32_16x16x32_bf16 v[4:7], a[228:231], a[64:67], 0
  ds_read_b64_tr_b16 a[228:229], v230 offset:53248
  ds_read_b64_tr_b16 a[230:231], v230 offset:55296
  v_mfma_f32_16x16x32_bf16 v[4:7], a[232:235], a[72:75], v[4:7]
  ds_read_b64_tr_b16 a[232:233], v231 offset:36864
  ds_read_b64_tr_b16 a[234:235], v231 offset:38912
  v_mfma_f32_16x16x32_bf16 v[8:11], a[192:195], a[64:67], 0
  v_mfma_f32_16x16x32_bf16 v[8:11], a[196:199], a[72:75], v[8:11]
  v_mfma_f32_16x16x32_bf16 v[24:27], a[192:195], a[68:71], 0
  ds_read_b64_tr_b16 a[192:193], v231 offset:53248
  ds_read_b64_tr_b16 a[194:195], v231 offset:55296
  v_mfma_f32_16x16x32_bf16 v[24:27], a[196:199], a[76:79], v[24:27]
  ds_read_b64_tr_b16 a[196:197], v228 offset:49152
  ds_read_b64_tr_b16 a[198:199], v228 offset:51200
  s_waitcnt lgkmcnt(13)
  v_mfma_f32_16x16x32_bf16 v[28:31], a[200:203], a[68:71], 0
  v_mfma_f32_16x16x32_bf16 v[28:31], a[204:207], a[76:79], v[28:31]
  v_mfma_f32_16x16x32_bf16 v[12:15], a[200:203], a[64:67], 0
  ds_read_b64_tr_b16 a[200:201], v228 offset:61440
  ds_read_b64_tr_b16 a[202:203], v228 offset:63488
  v_mfma_f32_16x16x32_bf16 v[12:15], a[204:207], a[72:75], v[12:15]
  s_barrier
  ds_read_b64_tr_b16 a[204:205], v229 offset:49152
  s_waitcnt vmcnt(23)
  v_mfma_f32_16x16x32_bf16 v[0:3], a[208:211], a[80:83], v[0:3]
  ds_read_b64_tr_b16 a[206:207], v229 offset:51200
  v_mfma_f32_16x16x32_bf16 v[0:3], a[212:215], a[88:91], v[0:3]
  v_mfma_f32_16x16x32_bf16 v[16:19], a[208:211], a[84:87], v[16:19]
  ds_read_b64_tr_b16 a[208:209], v229 offset:61440
  ds_read_b64_tr_b16 a[210:211], v229 offset:63488
  v_mfma_f32_16x16x32_bf16 v[16:19], a[212:215], a[92:95], v[16:19]
  ds_read_b64_tr_b16 a[212:213], v230 offset:49152
  ds_read_b64_tr_b16 a[214:215], v230 offset:51200
  s_waitcnt lgkmcnt(13)
  v_mfma_f32_16x16x32_bf16 v[20:23], a[216:219], a[84:87], v[20:23]
  v_mfma_f32_16x16x32_bf16 v[20:23], a[220:223], a[92:95], v[20:23]
  v_mfma_f32_16x16x32_bf16 v[4:7], a[216:219], a[80:83], v[4:7]
  ds_read_b64_tr_b16 a[216:217], v230 offset:61440
  ds_read_b64_tr_b16 a[218:219], v230 offset:63488
  v_mfma_f32_16x16x32_bf16 v[4:7], a[220:223], a[88:91], v[4:7]
  ds_read_b64_tr_b16 a[220:221], v231 offset:49152
  ds_read_b64_tr_b16 a[222:223], v231 offset:51200
  v_mfma_f32_16x16x32_bf16 v[8:11], a[224:227], a[80:83], v[8:11]
  v_mfma_f32_16x16x32_bf16 v[8:11], a[228:231], a[88:91], v[8:11]
  v_mfma_f32_16x16x32_bf16 v[24:27], a[224:227], a[84:87], v[24:27]
  ds_read_b64_tr_b16 a[224:225], v231 offset:61440
  ds_read_b64_tr_b16 a[226:227], v231 offset:63488
  v_mfma_f32_16x16x32_bf16 v[24:27], a[228:231], a[92:95], v[24:27]
  ds_read_b64_tr_b16 a[228:229], v232 offset:12288
  ds_read_b64_tr_b16 a[230:231], v232 offset:14336
  s_waitcnt lgkmcnt(13)
  v_mfma_f32_16x16x32_bf16 v[28:31], a[232:235], a[84:87], v[28:31]
  v_mfma_f32_16x16x32_bf16 v[28:31], a[192:195], a[92:95], v[28:31]
  v_mfma_f32_16x16x32_bf16 v[12:15], a[232:235], a[80:83], v[12:15]
  ds_read_b64_tr_b16 a[232:233], v232 offset:8192
  ds_read_b64_tr_b16 a[234:235], v232 offset:10240
  v_mfma_f32_16x16x32_bf16 v[12:15], a[192:195], a[88:91], v[12:15]
  s_barrier
  ds_read_b64_tr_b16 a[192:193], v233 offset:12288
  s_waitcnt vmcnt(19)
  v_mfma_f32_16x16x32_bf16 v[0:3], a[196:199], a[96:99], v[0:3]
  ds_read_b64_tr_b16 a[194:195], v233 offset:14336
  v_mfma_f32_16x16x32_bf16 v[0:3], a[200:203], a[104:107], v[0:3]
  v_mfma_f32_16x16x32_bf16 v[16:19], a[196:199], a[100:103], v[16:19]
  ds_read_b64_tr_b16 a[196:197], v233 offset:8192
  ds_read_b64_tr_b16 a[198:199], v233 offset:10240
  v_mfma_f32_16x16x32_bf16 v[16:19], a[200:203], a[108:111], v[16:19]
  ds_read_b64_tr_b16 a[200:201], v234 offset:12288
  ds_read_b64_tr_b16 a[202:203], v234 offset:14336
  s_waitcnt lgkmcnt(13)
  v_mfma_f32_16x16x32_bf16 v[20:23], a[204:207], a[100:103], v[20:23]
  v_mfma_f32_16x16x32_bf16 v[20:23], a[208:211], a[108:111], v[20:23]
  v_mfma_f32_16x16x32_bf16 v[4:7], a[204:207], a[96:99], v[4:7]
  ds_read_b64_tr_b16 a[204:205], v234 offset:8192
  ds_read_b64_tr_b16 a[206:207], v234 offset:10240
  v_mfma_f32_16x16x32_bf16 v[4:7], a[208:211], a[104:107], v[4:7]
  buffer_load_dwordx4 a[180:183], v240, s[4:7], s40 offen offset:1024 sc1
  s_mov_b32 s40, 7208960
  s_waitcnt vmcnt(1)
  v_add_u32 v248, 1, v245
  buffer_store_dword v248, v246, s[4:7], s79 offen sc1
  v_mfma_f32_16x16x32_bf16 v[8:11], a[212:215], a[96:99], v[8:11]
  ds_read_b64_tr_b16 a[208:209], v235 offset:12288
  ds_read_b64_tr_b16 a[210:211], v235 offset:14336
  v_mfma_f32_16x16x32_bf16 v[8:11], a[216:219], a[104:107], v[8:11]
  v_mfma_f32_16x16x32_bf16 v[24:27], a[212:215], a[100:103], v[24:27]
  buffer_load_dwordx4 a[184:187], v240, s[4:7], s40 offen offset:0 sc1
  v_mfma_f32_16x16x32_bf16 v[24:27], a[216:219], a[108:111], v[24:27]
  ds_read_b64_tr_b16 a[212:213], v235 offset:8192
  ds_read_b64_tr_b16 a[214:215], v235 offset:10240
  s_waitcnt lgkmcnt(13)
  v_mfma_f32_16x16x32_bf16 v[28:31], a[220:223], a[100:103], v[28:31]
  ds_read_b64_tr_b16 a[216:217], v232 offset:20480
  ds_read_b64_tr_b16 a[218:219], v232 offset:22528
  buffer_load_dwordx4 v[96:99], v210, s[4:7], s101 offen sc1
  v_mfma_f32_16x16x32_bf16 v[28:31], a[224:227], a[108:111], v[28:31]
  v_mfma_f32_16x16x32_bf16 v[12:15], a[220:223], a[96:99], v[12:15]
  buffer_load_dwordx4 a[188:191], v240, s[4:7], s40 offen offset:1024 sc1
  v_mfma_f32_16x16x32_bf16 v[12:15], a[224:227], a[104:107], v[12:15]
  s_barrier
  ds_read_b64_tr_b16 a[220:221], v232 offset:36864
  v_mfma_f32_16x16x32_bf16 v[0:3], a[228:231], a[112:115], v[0:3]
  ds_read_b64_tr_b16 a[222:223], v232 offset:38912
  ds_read_b64_tr_b16 a[224:225], v233 offset:20480
  s_mov_b32 s41, 1638400
  s_waitcnt lgkmcnt(13)
  v_mfma_f32_16x16x32_bf16 v[0:3], a[232:235], a[120:123], v[0:3]
  ds_read_b64_tr_b16 a[226:227], v233 offset:22528
  s_add_u32 m0, s42, 32768
  v_permlane16_swap_b32 v32, v34
  v_mfma_f32_16x16x32_bf16 v[16:19], a[228:231], a[116:119], v[16:19]
  buffer_load_dwordx4 v241, s[8:11], s41 offen offset:0 lds
  v_permlane16_swap_b32 v33, v35
  v_mfma_f32_16x16x32_bf16 v[16:19], a[232:235], a[124:127], v[16:19]
  ds_read_b64_tr_b16 a[228:229], v233 offset:36864
  ds_read_b64_tr_b16 a[230:231], v233 offset:38912
  s_mov_b32 s41, 1769472
  v_mfma_f32_16x16x32_bf16 v[20:23], a[192:195], a[116:119], v[20:23]
  ds_read_b64_tr_b16 a[232:233], v234 offset:20480
  ds_read_b64_tr_b16 a[234:235], v234 offset:22528
  s_add_u32 m0, s42, 40960
  v_permlane16_swap_b32 v36, v38
  v_mfma_f32_16x16x32_bf16 v[20:23], a[196:199], a[124:127], v[20:23]
  buffer_load_dwordx4 v241, s[8:11], s41 offen offset:0 lds
  v_permlane16_swap_b32 v37, v39
  v_mfma_f32_16x16x32_bf16 v[4:7], a[192:195], a[112:115], v[4:7]
  ds_read_b64_tr_b16 a[192:193], v234 offset:36864
  ds_read_b64_tr_b16 a[194:195], v234 offset:38912
  s_mov_b32 s41, 1900544
  v_permlane16_swap_b32 v40, v42
  v_mfma_f32_16x16x32_bf16 v[4:7], a[196:199], a[120:123], v[4:7]
  ds_read_b64_tr_b16 a[196:197], v235 offset:20480
  ds_read_b64_tr_b16 a[198:199], v235 offset:22528
  s_add_u32 m0, s42, 69632
  v_permlane16_swap_b32 v41, v43
  s_waitcnt lgkmcnt(13)
  v_mfma_f32_16x16x32_bf16 v[8:11], a[200:203], a[112:115], v[8:11]
  buffer_load_dwordx4 v241, s[8:11], s41 offen offset:0 lds
  v_permlane16_swap_b32 v44, v46
  v_mfma_f32_16x16x32_bf16 v[8:11], a[204:207], a[120:123], v[8:11]
  s_mov_b32 s41, 2031616
  s_add_u32 m0, s42, 81920
  v_permlane16_swap_b32 v45, v47
L_wk0_4:
  s_cbranch_vccnz L_wk0_end
  v_mfma_f32_16x16x32_bf16 v[24:27], a[200:203], a[116:119], v[24:27]
  buffer_load_dwordx4 v241, s[8:11], s41 offen offset:0 lds
  v_lshlrev_b32 v160, 16, v32
  v_mfma_f32_16x16x32_bf16 v[24:27], a[204:207], a[124:127], v[24:27]
  ds_read_b64_tr_b16 a[200:201], v235 offset:36864
  ds_read_b64_tr_b16 a[202:203], v235 offset:38912
  buffer_load_dword v244, v243, s[4:7], s88 offen sc1
  v_and_b32 v161, 0xffff0000, v32
  v_mfma_f32_16x16x32_bf16 v[28:31], a[208:211], a[116:119], v[28:31]
  ds_read_b64_tr_b16 a[204:205], v232 offset:32768
  ds_read_b64_tr_b16 a[206:207], v232 offset:34816
  v_lshlrev_b32 v162, 16, v33
  v_mfma_f32_16x16x32_bf16 v[28:31], a[212:215], a[124:127], v[28:31]
  v_and_b32 v163, 0xffff0000, v33
  v_lshlrev_b32 v164, 16, v34
  v_and_b32 v165, 0xffff0000, v34
  v_mfma_f32_16x16x32_bf16 v[12:15], a[208:211], a[112:115], v[12:15]
  ds_read_b64_tr_b16 a[208:209], v232 offset:45056
  ds_read_b64_tr_b16 a[210:211], v232 offset:47104
  v_lshlrev_b32 v166, 16, v35
  v_mfma_f32_16x16x32_bf16 v[12:15], a[212:215], a[120:123], v[12:15]
  s_barrier
  ds_read_b64_tr_b16 a[212:213], v233 offset:32768
  s_waitcnt lgkmcnt(13)
  v_mfma_f32_16x16x32_bf16 v[0:3], a[216:219], a[128:131], v[0:3]
  ds_read_b64_tr_b16 a[214:215], v233 offset:34816
  v_and_b32 v167, 0xffff0000, v35
  v_lshlrev_b32 v168, 16, v36
  v_mfma_f32_16x16x32_bf16 v[0:3], a[220:223], a[136:139], v[0:3]
  v_and_b32 v169, 0xffff0000, v36
  v_lshlrev_b32 v170, 16, v37
  v_and_b32 v171, 0xffff0000, v37
  v_mfma_f32_16x16x32_bf16 v[16:19], a[216:219], a[132:135], v[16:19]
  ds_read_b64_tr_b16 a[216:217], v233 offset:45056
  ds_read_b64_tr_b16 a[218:219], v233 offset:47104
  v_lshlrev_b32 v172, 16, v38
  v_mfma_f32_16x16x32_bf16 v[16:19], a[220:223], a[140:143], v[16:19]
  ds_read_b64_tr_b16 a[220:221], v234 offset:32768
  ds_read_b64_tr_b16 a[222:223], v234 offset:34816
  v_and_b32 v173, 0xffff0000, v38
  v_mfma_f32_16x16x32_bf16 v[20:23], a[224:227], a[132:135], v[20:23]
  v_lshlrev_b32 v174, 16, v39
  v_and_b32 v175, 0xffff0000, v39
  v_lshlrev_b32 v176, 16, v40
  v_mfma_f32_16x16x32_bf16 v[20:23], a[228:231], a[140:143], v[20:23]
  v_and_b32 v177, 0xffff0000, v40
  v_lshlrev_b32 v178, 16, v41
  v_and_b32 v179, 0xffff0000, v41
  v_mfma_f32_16x16x32_bf16 v[4:7], a[224:227], a[128:131], v[4:7]
  ds_read_b64_tr_b16 a[224:225], v234 offset:45056
  ds_read_b64_tr_b16 a[226:227], v234 offset:47104
  v_lshlrev_b32 v180, 16, v42
  v_mfma_f32_16x16x32_bf16 v[4:7], a[228:231], a[136:139], v[4:7]
  ds_read_b64_tr_b16 a[228:229], v235 offset:32768
  ds_read_b64_tr_b16 a[230:231], v235 offset:34816
  v_and_b32 v181, 0xffff0000, v42
  s_waitcnt lgkmcnt(13)
  v_mfma_f32_16x16x32_bf16 v[8:11], a[232:235], a[128:131], v[8:11]
  v_lshlrev_b32 v182, 16, v43
  v_and_b32 v183, 0xffff0000, v43
  v_lshlrev_b32 v184, 16, v44
  v_mfma_f32_16x16x32_bf16 v[8:11], a[192:195], a[136:139], v[8:11]
  v_and_b32 v185, 0xffff0000, v44
  v_lshlrev_b32 v186, 16, v45
  v_and_b32 v187, 0xffff0000, v45
  v_mfma_f32_16x16x32_bf16 v[24:27], a[232:235], a[132:135], v[24:27]
  ds_read_b64_tr_b16 a[232:233], v235 offset:45056
  ds_read_b64_tr_b16 a[234:235], v235 offset:47104
  v_lshlrev_b32 v188, 16, v46
  v_mfma_f32_16x16x32_bf16 v[24:27], a[192:195], a[140:143], v[24:27]
  ds_read_b64_tr_b16 a[192:193], v232 offset:61440
  ds_read_b64_tr_b16 a[194:195], v232 offset:63488
  v_and_b32 v189, 0xffff0000, v46
  v_mfma_f32_16x16x32_bf16 v[28:31], a[196:199], a[132:135], v[28:31]
  v_lshlrev_b32 v190, 16, v47
  v_and_b32 v191, 0xffff0000, v47
  v_mfma_f32_16x16x32_bf16 v[28:31], a[200:203], a[140:143], v[28:31]
  v_mfma_f32_16x16x32_bf16 v[12:15], a[196:199], a[128:131], v[12:15]
  ds_read_b64_tr_b16 a[196:197], v232 offset:57344
  ds_read_b64_tr_b16 a[198:199], v232 offset:59392
  v_mfma_f32_16x16x32_bf16 v[12:15], a[200:203], a[136:139], v[12:15]
  s_barrier
  ds_read_b64_tr_b16 a[200:201], v233 offset:61440
  s_waitcnt lgkmcnt(13)
  v_mfma_f32_16x16x32_bf16 v[0:3], a[204:207], a[144:147], v[0:3]
  ds_read_b64_tr_b16 a[202:203], v233 offset:63488
  v_mfma_f32_16x16x32_bf16 v[0:3], a[208:211], a[152:155], v[0:3]
  v_mfma_f32_16x16x32_bf16 v[16:19], a[204:207], a[148:151], v[16:19]
  ds_read_b64_tr_b16 a[204:205], v233 offset:57344
  ds_read_b64_tr_b16 a[206:207], v233 offset:59392
  v_mfma_f32_16x16x32_bf16 v[16:19], a[208:211], a[156:159], v[16:19]
  ds_read_b64_tr_b16 a[208:209], v234 offset:61440
  ds_read_b64_tr_b16 a[210:211], v234 offset:63488
  v_mfma_f32_16x16x32_bf16 v[20:23], a[212:215], a[148:151], v[20:23]
  s_mov_b64 vcc, -1
  s_cmp_eq_u32 s3, 0
  s_cbranch_scc1 L_wk2_0
  s_cmp_eq_u32 s3, 1
  s_cbranch_scc1 L_wk2_1
  s_cmp_eq_u32 s3, 2
  s_cbranch_scc1 L_wk2_2
  s_branch L_wk2_3
L_wk2_end:
  s_mov_b64 vcc, 0
  s_waitcnt vmcnt(6)
  v_xor_b32 v96, s84, v96
  v_xor_b32 v97, s85, v97
  v_or_b32 v100, v96, v97
  v_xor_b32 v98, s86, v98
  v_mfma_f32_16x16x32_bf16 v[20:23], a[216:219], a[156:159], v[20:23]
  v_xor_b32 v99, s87, v99
  v_or3_b32 v100, v100, v98, v99
  v_and_b32 v100, 0xff, v100
  v_mfma_f32_16x16x32_bf16 v[4:7], a[212:215], a[144:147], v[4:7]
  ds_read_b64_tr_b16 a[212:213], v234 offset:57344
  ds_read_b64_tr_b16 a[214:215], v234 offset:59392
  v_cmp_ne_u32 s[24:25], 0, v100
  v_mfma_f32_16x16x32_bf16 v[4:7], a[216:219], a[152:155], v[4:7]
  ds_read_b64_tr_b16 a[216:217], v235 offset:61440
  ds_read_b64_tr_b16 a[218:219], v235 offset:63488
  s_waitcnt lgkmcnt(13)
  v_mfma_f32_16x16x32_bf16 v[8:11], a[220:223], a[144:147], v[8:11]
  s_cmp_lg_u64 s[24:25], 0
  s_cbranch_scc1 L_slow_26
L_back_27:
  v_mov_b32 v100, v96
  v_mfma_f32_16x16x32_bf16 v[8:11], a[224:227], a[152:155], v[8:11]
  s_waitcnt vmcnt(0)
  v_subrev_u32 v244, s100, v244
  v_subrev_u32 v244, 1, v244
  v_cmp_lt_u32 s[68:69], 6, v244
  v_mfma_f32_16x16x32_bf16 v[24:27], a[220:223], a[148:151], v[24:27]
  ds_read_b64_tr_b16 a[220:221], v235 offset:57344
  ds_read_b64_tr_b16 a[222:223], v235 offset:59392
  s_cmp_lg_u64 s[68:69], 0
  s_cbranch_scc1 L_slow_17
L_back_18:
  v_and_b32 v192, 1472, v254
  v_mov_b32 v101, v97
  v_mov_b32 v102, v98
  v_mfma_f32_16x16x32_bf16 v[24:27], a[224:227], a[156:159], v[24:27]
  ds_read_b64_tr_b16 a[224:225], v236 offset:4096
  ds_read_b64_tr_b16 a[226:227], v236 offset:6144
  s_mov_b32 s40, 7340032
  s_sub_u32 s89, s93, 0x20000
  v_mov_b32 v103, v99
  v_mfma_f32_16x16x32_bf16 v[28:31], a[228:231], a[148:151], v[28:31]
  buffer_load_dwordx4 a[0:3], v240, s[4:7], s40 offen offset:0 sc1
  s_mov_b32 s40, 7471104
  v_permlane16_swap_b32 v100, v96
  v_permlane16_swap_b32 v101, v97
  v_mfma_f32_16x16x32_bf16 v[28:31], a[232:235], a[156:159], v[28:31]
  v_permlane16_swap_b32 v102, v98
  v_permlane16_swap_b32 v103, v99
  v_add_f32 v96, v96, v100
  v_mfma_f32_16x16x32_bf16 v[12:15], a[228:231], a[144:147], v[12:15]
  buffer_load_dwordx4 a[8:11], v240, s[4:7], s40 offen offset:0 sc1
  v_add_f32 v97, v97, v101
  v_mfma_f32_16x16x32_bf16 v[12:15], a[232:235], a[152:155], v[12:15]
  s_barrier
  ds_read_b64_tr_b16 a[228:229], v236 offset:20480
  buffer_load_dword v244, v192, s[4:7], s89 offen sc1
  s_waitcnt lgkmcnt(13)
  v_mfma_f32_16x16x32_bf16 v[0:3], a[192:195], a[160:163], v[0:3]
  ds_read_b64_tr_b16 a[230:231], v236 offset:22528
  ds_read_b64_tr_b16 a[232:233], v237 offset:4096
  s_mov_b32 s40, 7602176
  v_add_f32 v98, v98, v102
  v_add_f32 v99, v99, v103
  v_mfma_f32_16x16x32_bf16 v[0:3], a[196:199], a[168:171], v[0:3]
  buffer_load_dwordx4 a[16:19], v240, s[4:7], s40 offen offset:0 sc1
  s_mov_b32 s40, 7733248
  v_mov_b32 v100, v96
  v_mfma_f32_16x16x32_bf16 v[16:19], a[192:195], a[164:167], v[16:19]
  ds_read_b64_tr_b16 a[234:235], v237 offset:6144
  ds_read_b64_tr_b16 a[192:193], v237 offset:20480
  v_mov_b32 v101, v97
  v_mov_b32 v102, v98
  v_mfma_f32_16x16x32_bf16 v[16:19], a[196:199], a[172:175], v[16:19]
  ds_read_b64_tr_b16 a[194:195], v237 offset:22528
  ds_read_b64_tr_b16 a[196:197], v238 offset:4096
  v_mov_b32 v103, v99
  v_mfma_f32_16x16x32_bf16 v[20:23], a[200:203], a[164:167], v[20:23]
  buffer_load_dwordx4 a[24:27], v240, s[4:7], s40 offen offset:0 sc1
  v_permlane32_swap_b32 v100, v96
  v_permlane32_swap_b32 v101, v97
  s_waitcnt lgkmcnt(13)
  v_mfma_f32_16x16x32_bf16 v[20:23], a[204:207], a[172:175], v[20:23]
  ds_read_b64_tr_b16 a[198:199], v238 offset:6144
  s_mov_b32 s40, 7864320
  v_permlane32_swap_b32 v102, v98
  v_mfma_f32_16x16x32_bf16 v[4:7], a[200:203], a[160:163], v[4:7]
  ds_read_b64_tr_b16 a[200:201], v238 offset:20480
  ds_read_b64_tr_b16 a[202:203], v238 offset:22528
  v_permlane32_swap_b32 v103, v99
  v_add_f32 v96, v96, v100
  v_mfma_f32_16x16x32_bf16 v[4:7], a[204:207], a[168:171], v[4:7]
  buffer_load_dwordx4 a[32:35], v240, s[4:7], s40 offen offset:0 sc1
  s_mov_b32 s40, 7995392
  v_add_f32 v97, v97, v101
  v_mfma_f32_16x16x32_bf16 v[8:11], a[208:211], a[160:163], v[8:11]
  ds_read_b64_tr_b16 a[204:205], v239 offset:4096
  ds_read_b64_tr_b16 a[206:207], v239 offset:6144
  v_add_f32 v98, v98, v102
  v_add_f32 v99, v99, v103
  v_mfma_f32_16x16x32_bf16 v[8:11], a[212:215], a[168:171], v[8:11]
  v_cvt_pk_bf16_f32 v100, v96, v97
  v_lshlrev_b32 v96, 16, v100
  v_and_b32 v97, 0xffff0000, v100
  v_mfma_f32_16x16x32_bf16 v[24:27], a[208:211], a[164:167], v[24:27]
  buffer_load_dwordx4 a[40:43], v240, s[4:7], s40 offen offset:0 sc1
  v_cvt_pk_bf16_f32 v101, v98, v99
  v_mfma_f32_16x16x32_bf16 v[24:27], a[212:215], a[172:175], v[24:27]
  ds_read_b64_tr_b16 a[208:209], v239 offset:20480
  ds_read_b64_tr_b16 a[210:211], v239 offset:22528
  s_mov_b32 s40, 8126464
  s_waitcnt lgkmcnt(13)
  v_mfma_f32_16x16x32_bf16 v[28:31], a[216:219], a[164:167], v[28:31]
  ds_read_b64_tr_b16 a[212:213], v236 offset:16384
  ds_read_b64_tr_b16 a[214:215], v236 offset:18432
  v_lshlrev_b32 v98, 16, v101
  v_and_b32 v99, 0xffff0000, v101
  v_mfma_f32_16x16x32_bf16 v[28:31], a[220:223], a[172:175], v[28:31]
  buffer_load_dwordx4 a[48:51], v240, s[4:7], s40 offen offset:0 sc1
  s_mov_b32 s40, 8257536
  v_add_f32 v96, s39, v96
  v_mfma_f32_16x16x32_bf16 v[12:15], a[216:219], a[160:163], v[12:15]
  ds_read_b64_tr_b16 a[216:217], v236 offset:28672
  ds_read_b64_tr_b16 a[218:219], v236 offset:30720
  v_add_f32 v97, s39, v97
  v_add_f32 v98, s39, v98
  v_mfma_f32_16x16x32_bf16 v[12:15], a[220:223], a[168:171], v[12:15]
  s_barrier
  ds_read_b64_tr_b16 a[220:221], v237 offset:16384
  v_add_f32 v99, s39, v99
  v_mfma_f32_16x16x32_bf16 v[0:3], a[224:227], a[176:179], v[0:3]
  buffer_load_dwordx4 a[56:59], v240, s[4:7], s40 offen offset:0 sc1
  v_cvt_pk_bf16_f32 v100, v96, v97
  v_lshlrev_b32 v96, 16, v100
  s_waitcnt lgkmcnt(13)
  v_mfma_f32_16x16x32_bf16 v[0:3], a[228:231], a[184:187], v[0:3]
  ds_read_b64_tr_b16 a[222:223], v237 offset:18432
  s_mov_b32 s40, 8388608
  v_and_b32 v97, 0xffff0000, v100
  v_mfma_f32_16x16x32_bf16 v[16:19], a[224:227], a[180:183], v[16:19]
  ds_read_b64_tr_b16 a[224:225], v237 offset:28672
  ds_read_b64_tr_b16 a[226:227], v237 offset:30720
  v_cvt_pk_bf16_f32 v101, v98, v99
  v_lshlrev_b32 v98, 16, v101
  v_mfma_f32_16x16x32_bf16 v[16:19], a[228:231], a[188:191], v[16:19]
  buffer_load_dwordx4 a[64:67], v240, s[4:7], s40 offen offset:0 sc1
  s_mov_b32 s40, 8519680
  v_and_b32 v99, 0xffff0000, v101
  v_mfma_f32_16x16x32_bf16 v[20:23], a[232:235], a[180:183], v[20:23]
  ds_read_b64_tr_b16 a[228:229], v238 offset:16384
  ds_read_b64_tr_b16 a[230:231], v238 offset:18432
  ds_write_b128 v213, v[96:99] offset:10240
  v_mfma_f32_16x16x32_bf16 v[20:23], a[192:195], a[188:191], v[20:23]
  v_mfma_f32_16x16x32_bf16 v[4:7], a[232:235], a[176:179], v[4:7]
  buffer_load_dwordx4 a[72:75], v240, s[4:7], s40 offen offset:0 sc1
  v_mfma_f32_16x16x32_bf16 v[4:7], a[192:195], a[184:187], v[4:7]
  ds_read_b64_tr_b16 a[232:233], v238 offset:28672
  ds_read_b64_tr_b16 a[234:235], v238 offset:30720
  s_mov_b32 s40, 8650752
  s_waitcnt lgkmcnt(13)
  v_mfma_f32_16x16x32_bf16 v[8:11], a[196:199], a[176:179], v[8:11]
  ds_read_b64_tr_b16 a[192:193], v239 offset:16384
  ds_read_b64_tr_b16 a[194:195], v239 offset:18432
  v_mfma_f32_16x16x32_bf16 v[8:11], a[200:203], a[184:187], v[8:11]
  buffer_load_dwordx4 a[80:83], v240, s[4:7], s40 offen offset:0 sc1
  s_mov_b32 s40, 8781824
  v_mfma_f32_16x16x32_bf16 v[24:27], a[196:199], a[180:183], v[24:27]
  ds_read_b64_tr_b16 a[196:197], v239 offset:28672
  ds_read_b64_tr_b16 a[198:199], v239 offset:30720
  s_waitcnt lgkmcnt(6)
  v_mfma_f32_16x16x32_bf16 v[24:27], a[200:203], a[188:191], v[24:27]
  ds_read_b64_tr_b16 a[200:201], v228 offset:16384
  ds_read_b64_tr_b16 a[202:203], v228 offset:18432
  v_mfma_f32_16x16x32_bf16 v[28:31], a[204:207], a[180:183], v[28:31]
  buffer_load_dwordx4 a[88:91], v240, s[4:7], s40 offen offset:0 sc1
  v_mfma_f32_16x16x32_bf16 v[28:31], a[208:211], a[188:191], v[28:31]
  s_mov_b32 s40, 8912896
  v_mfma_f32_16x16x32_bf16 v[12:15], a[204:207], a[176:179], v[12:15]
  ds_read_b64_tr_b16 a[204:205], v228 offset:12288
  ds_read_b64_tr_b16 a[206:207], v228 offset:14336
  v_mfma_f32_16x16x32_bf16 v[12:15], a[208:211], a[184:187], v[12:15]
  s_barrier
  ds_read_b64_tr_b16 a[208:209], v229 offset:16384
  ds_read_b128 v[64:67], v250 offset:10240
  s_waitcnt vmcnt(11)
  v_mfma_f32_16x16x32_bf16 v[0:3], a[212:215], a[0:3], v[0:3]
  buffer_load_dwordx4 a[96:99], v240, s[4:7], s40 offen offset:0 sc1
  s_mov_b32 s40, 9043968
  ds_read_b128 v[68:71], v250 offset:10304
  v_mfma_f32_16x16x32_bf16 v[0:3], a[216:219], a[8:11], v[0:3]
  ds_read_b64_tr_b16 a[210:211], v229 offset:18432
  ds_read_b64_tr_b16 a[212:213], v229 offset:12288
  ds_read_b128 v[72:75], v250 offset:10368
  v_mfma_f32_16x16x32_bf16 v[4:7], a[220:223], a[0:3], v[4:7]
  buffer_load_dwordx4 a[104:107], v240, s[4:7], s40 offen offset:0 sc1
  ds_read_b128 v[76:79], v250 offset:10432
  v_mfma_f32_16x16x32_bf16 v[4:7], a[224:227], a[8:11], v[4:7]
  ds_read_b64_tr_b16 a[214:215], v229 offset:14336
  ds_read_b64_tr_b16 a[216:217], v230 offset:16384
  s_mov_b32 s40, 9175040
  ds_read_b128 v[96:99], v250 offset:10496
  v_mfma_f32_16x16x32_bf16 v[8:11], a[228:231], a[0:3], v[8:11]
  ds_read_b64_tr_b16 a[218:219], v230 offset:18432
  ds_read_b64_tr_b16 a[220:221], v230 offset:12288
  ds_read_b128 v[100:103], v250 offset:10560
  s_waitcnt lgkmcnt(13)
  v_mfma_f32_16x16x32_bf16 v[8:11], a[232:235], a[8:11], v[8:11]
  buffer_load_dwordx4 a[112:115], v240, s[4:7], s40 offen offset:0 sc1
  s_mov_b32 s40, 9306112
  ds_read_b128 v[104:107], v250 offset:10624
  v_mfma_f32_16x16x32_bf16 v[12:15], a[192:195], a[0:3], v[12:15]
  ds_read_b64_tr_b16 a[222:223], v230 offset:14336
  ds_read_b64_tr_b16 a[224:225], v231 offset:16384
  ds_read_b128 v[108:111], v250 offset:10688
  v_mfma_f32_16x16x32_bf16 v[12:15], a[196:199], a[8:11], v[12:15]
  ds_read_b64_tr_b16 a[226:227], v231 offset:18432
  ds_read_b64_tr_b16 a[228:229], v231 offset:12288
  ds_read_b128 v[144:147], v250 offset:10752
  s_waitcnt vmcnt(11)
  v_mfma_f32_16x16x32_bf16 v[0:3], a[200:203], a[16:19], v[0:3]
  buffer_load_dwordx4 a[120:123], v240, s[4:7], s40 offen offset:0 sc1
  ds_read_b64_tr_b16 a[230:231], v231 offset:14336
  ds_read_b64_tr_b16 a[232:233], v228 offset:24576
  ds_read_b128 v[148:151], v250 offset:10816
  v_mfma_f32_16x16x32_bf16 v[0:3], a[204:207], a[24:27], v[0:3]
  ds_read_b64_tr_b16 a[234:235], v228 offset:26624
  ds_read_b64_tr_b16 a[192:193], v228 offset:45056
  s_mov_b32 s40, 7340032
  ds_read_b128 v[152:155], v250 offset:10880
  s_waitcnt lgkmcnt(13)
  v_mfma_f32_16x16x32_bf16 v[4:7], a[208:211], a[16:19], v[4:7]
  ds_read_b64_tr_b16 a[194:195], v228 offset:47104
  ds_read_b64_tr_b16 a[196:197], v229 offset:24576
  ds_read_b128 v[156:159], v250 offset:10944
  v_mfma_f32_16x16x32_bf16 v[4:7], a[212:215], a[24:27], v[4:7]
  buffer_load_dwordx4 a[4:7], v240, s[4:7], s40 offen offset:1024 sc1
  ds_read_b64_tr_b16 a[198:199], v229 offset:26624
  ds_read_b64_tr_b16 a[200:201], v229 offset:45056
  v_subrev_u32 v244, s100, v244
  v_mfma_f32_16x16x32_bf16 v[8:11], a[216:219], a[16:19], v[8:11]
  ds_read_b64_tr_b16 a[202:203], v229 offset:47104
  ds_read_b64_tr_b16 a[204:205], v230 offset:24576
  s_mov_b32 s40, 7471104
  v_cmp_lt_u32 s[68:69], 7, v244
  s_waitcnt lgkmcnt(13)
  v_mfma_f32_16x16x32_bf16 v[8:11], a[220:223], a[24:27], v[8:11]
  ds_read_b64_tr_b16 a[206:207], v230 offset:26624
  ds_read_b64_tr_b16 a[208:209], v230 offset:45056
  s_cmp_lg_u64 s[68:69], 0
  s_cbranch_scc1 L_slow_19
L_back_20:
  v_mfma_f32_16x16x32_bf16 v[12:15], a[224:227], a[16:19], v[12:15]
  buffer_load_dwordx4 a[12:15], v240, s[4:7], s40 offen offset:1024 sc1
  ds_read_b64_tr_b16 a[210:211], v230 offset:47104
  ds_read_b64_tr_b16 a[212:213], v231 offset:24576
  s_waitcnt lgkmcnt(13)
  v_mfma_f32_16x16x32_bf16 v[12:15], a[228:231], a[24:27], v[12:15]
  s_barrier
  ds_read_b64_tr_b16 a[214:215], v231 offset:26624
  s_waitcnt vmcnt(12)
  v_mfma_f32_16x16x32_bf16 v[0:3], a[232:235], a[32:35], v[0:3]
  ds_read_b64_tr_b16 a[216:217], v231 offset:45056
  ds_read_b64_tr_b16 a[218:219], v231 offset:47104
  s_mov_b32 s40, 7602176
  s_waitcnt lgkmcnt(13)
  v_mfma_f32_16x16x32_bf16 v[0:3], a[192:195], a[40:43], v[0:3]
  buffer_load_dwordx4 a[20:23], v240, s[4:7], s40 offen offset:1024 sc1
  ds_read_b64_tr_b16 a[220:221], v228 offset:57344
  ds_read_b64_tr_b16 a[222:223], v228 offset:59392
  s_waitcnt lgkmcnt(12)
  v_mfma_f32_16x16x32_bf16 v[4:7], a[196:199], a[32:35], v[4:7]
  ds_read_b64_tr_b16 a[224:225], v232 offset:0
  ds_read_b64_tr_b16 a[226:227], v232 offset:2048
  s_mov_b32 s40, 7733248
  s_waitcnt lgkmcnt(12)
  v_mfma_f32_16x16x32_bf16 v[4:7], a[200:203], a[40:43], v[4:7]
  ds_read_b64_tr_b16 a[228:229], v229 offset:57344
  ds_read_b64_tr_b16 a[230:231], v229 offset:59392
  s_waitcnt lgkmcnt(12)
  v_mfma_f32_16x16x32_bf16 v[8:11], a[204:207], a[32:35], v[8:11]
  buffer_load_dwordx4 a[28:31], v240, s[4:7], s40 offen offset:1024 sc1
  ds_read_b64_tr_b16 a[232:233], v233 offset:0
  ds_read_b64_tr_b16 a[234:235], v233 offset:2048
  s_waitcnt lgkmcnt(12)
  v_mfma_f32_16x16x32_bf16 v[8:11], a[208:211], a[40:43], v[8:11]
  ds_read_b64_tr_b16 a[192:193], v230 offset:57344
  ds_read_b64_tr_b16 a[194:195], v230 offset:59392
  s_mov_b32 s40, 7864320
  s_waitcnt lgkmcnt(12)
  v_mfma_f32_16x16x32_bf16 v[12:15], a[212:215], a[32:35], v[12:15]
  ds_read_b64_tr_b16 a[196:197], v234 offset:0
  ds_read_b64_tr_b16 a[198:199], v234 offset:2048
  s_waitcnt lgkmcnt(12)
  v_mfma_f32_16x16x32_bf16 v[12:15], a[216:219], a[40:43], v[12:15]
  buffer_load_dwordx4 a[36:39], v240, s[4:7], s40 offen offset:1024 sc1
  ds_read_b64_tr_b16 a[200:201], v231 offset:57344
  ds_read_b64_tr_b16 a[202:203], v231 offset:59392
  s_waitcnt vmcnt(13) lgkmcnt(12)
  v_mfma_f32_16x16x32_bf16 v[0:3], a[220:223], a[48:51], v[0:3]
  ds_read_b64_tr_b16 a[204:205], v235 offset:0
  ds_read_b64_tr_b16 a[206:207], v235 offset:2048
  s_mov_b32 s40, 7995392
  s_waitcnt lgkmcnt(12)
  v_mfma_f32_16x16x32_bf16 v[0:3], a[224:227], a[56:59], v[0:3]
  ds_read_b64_tr_b16 a[208:209], v232 offset:28672
  ds_read_b64_tr_b16 a[210:211], v232 offset:30720
  s_waitcnt lgkmcnt(12)
  v_mfma_f32_16x16x32_bf16 v[4:7], a[228:231], a[48:51], v[4:7]
  buffer_load_dwordx4 a[44:47], v240, s[4:7], s40 offen offset:1024 sc1
  ds_read_b64_tr_b16 a[212:213], v232 offset:40960
  ds_read_b64_tr_b16 a[214:215], v232 offset:43008
  s_waitcnt lgkmcnt(12)
  v_mfma_f32_16x16x32_bf16 v[4:7], a[232:235], a[56:59], v[4:7]
  ds_read_b64_tr_b16 a[216:217], v233 offset:28672
  ds_read_b64_tr_b16 a[218:219], v233 offset:30720
  s_mov_b32 s40, 8126464
  s_waitcnt lgkmcnt(12)
  v_mfma_f32_16x16x32_bf16 v[8:11], a[192:195], a[48:51], v[8:11]
  ds_read_b64_tr_b16 a[220:221], v233 offset:40960
  ds_read_b64_tr_b16 a[222:223], v233 offset:43008
  s_waitcnt lgkmcnt(12)
  v_mfma_f32_16x16x32_bf16 v[8:11], a[196:199], a[56:59], v[8:11]
  buffer_load_dwordx4 a[52:55], v240, s[4:7], s40 offen offset:1024 sc1
  ds_read_b64_tr_b16 a[224:225], v234 offset:28672
  ds_read_b64_tr_b16 a[226:227], v234 offset:30720
  s_waitcnt lgkmcnt(12)
  v_mfma_f32_16x16x32_bf16 v[12:15], a[200:203], a[48:51], v[12:15]
  ds_read_b64_tr_b16 a[228:229], v234 offset:40960
  ds_read_b64_tr_b16 a[230:231], v234 offset:43008
  s_mov_b32 s40, 8257536
  s_waitcnt lgkmcnt(12)
  v_mfma_f32_16x16x32_bf16 v[12:15], a[204:207], a[56:59], v[12:15]
  s_barrier
  ds_read_b64_tr_b16 a[232:233], v235 offset:28672
  s_waitcnt vmcnt(13) lgkmcnt(11)
  v_mfma_f32_16x16x32_bf16 v[0:3], a[208:211], a[64:67], v[0:3]
  buffer_load_dwordx4 a[60:63], v240, s[4:7], s40 offen offset:1024 sc1
  ds_read_b64_tr_b16 a[234:235], v235 offset:30720
  ds_read_b64_tr_b16 a[192:193], v235 offset:40960
  s_waitcnt lgkmcnt(11)
  v_mfma_f32_16x16x32_bf16 v[0:3], a[212:215], a[72:75], v[0:3]
  ds_read_b64_tr_b16 a[194:195], v235 offset:43008
  ds_read_b64_tr_b16 a[196:197], v232 offset:49152
  s_mov_b32 s40, 8388608
  s_waitcnt lgkmcnt(11)
  v_mfma_f32_16x16x32_bf16 v[4:7], a[216:219], a[64:67], v[4:7]
  ds_read_b64_tr_b16 a[198:199], v232 offset:51200
  ds_read_b64_tr_b16 a[200:201], v228 offset:28672
  s_waitcnt lgkmcnt(11)
  v_mfma_f32_16x16x32_bf16 v[4:7], a[220:223], a[72:75], v[4:7]
  buffer_load_dwordx4 a[68:71], v240, s[4:7], s40 offen offset:1024 sc1
  ds_read_b64_tr_b16 a[202:203], v228 offset:30720
  ds_read_b64_tr_b16 a[204:205], v233 offset:49152
  s_waitcnt lgkmcnt(11)
  v_mfma_f32_16x16x32_bf16 v[8:11], a[224:227], a[64:67], v[8:11]
  ds_read_b64_tr_b16 a[206:207], v233 offset:51200
  ds_read_b64_tr_b16 a[208:209], v229 offset:28672
  s_mov_b32 s40, 8519680
  s_waitcnt lgkmcnt(11)
  v_mfma_f32_16x16x32_bf16 v[8:11], a[228:231], a[72:75], v[8:11]
  ds_read_b64_tr_b16 a[210:211], v229 offset:30720
  ds_read_b64_tr_b16 a[212:213], v234 offset:49152
  s_waitcnt lgkmcnt(11)
  v_mfma_f32_16x16x32_bf16 v[12:15], a[232:235], a[64:67], v[12:15]
  buffer_load_dwordx4 a[76:79], v240, s[4:7], s40 offen offset:1024 sc1
  ds_read_b64_tr_b16 a[214:215], v234 offset:51200
  ds_read_b64_tr_b16 a[216:217], v230 offset:28672
  s_waitcnt lgkmcnt(11)
  v_mfma_f32_16x16x32_bf16 v[12:15], a[192:195], a[72:75], v[12:15]
  ds_read_b64_tr_b16 a[218:219], v230 offset:30720
  ds_read_b64_tr_b16 a[220:221], v235 offset:49152
  s_mov_b32 s40, 8650752
  s_waitcnt vmcnt(14) lgkmcnt(11)
  v_mfma_f32_16x16x32_bf16 v[0:3], a[196:199], a[80:83], v[0:3]
  ds_read_b64_tr_b16 a[222:223], v235 offset:51200
  ds_read_b64_tr_b16 a[224:225], v231 offset:28672
  s_waitcnt lgkmcnt(11)
  v_mfma_f32_16x16x32_bf16 v[0:3], a[200:203], a[88:91], v[0:3]
  buffer_load_dwordx4 a[84:87], v240, s[4:7], s40 offen offset:1024 sc1
  ds_read_b64_tr_b16 a[226:227], v231 offset:30720
  ds_read_b64_tr_b16 a[228:229], v228 offset:32768
  s_waitcnt lgkmcnt(11)
  v_mfma_f32_16x16x32_bf16 v[4:7], a[204:207], a[80:83], v[4:7]
  ds_read_b64_tr_b16 a[230:231], v228 offset:34816
  ds_read_b64_tr_b16 a[232:233], v228 offset:40960
  s_mov_b32 s40, 8781824
  s_waitcnt lgkmcnt(11)
  v_mfma_f32_16x16x32_bf16 v[4:7], a[208:211], a[88:91], v[4:7]
  ds_read_b64_tr_b16 a[234:235], v228 offset:43008
  ds_read_b64_tr_b16 a[192:193], v229 offset:32768
  s_waitcnt lgkmcnt(11)
  v_mfma_f32_16x16x32_bf16 v[8:11], a[212:215], a[80:83], v[8:11]
  buffer_load_dwordx4 a[92:95], v240, s[4:7], s40 offen offset:1024 sc1
  ds_read_b64_tr_b16 a[194:195], v229 offset:34816
  ds_read_b64_tr_b16 a[196:197], v229 offset:40960
  s_waitcnt lgkmcnt(11)
  v_mfma_f32_16x16x32_bf16 v[8:11], a[216:219], a[88:91], v[8:11]
  ds_read_b64_tr_b16 a[198:199], v229 offset:43008
  ds_read_b64_tr_b16 a[200:201], v230 offset:32768
  s_mov_b32 s41, 0
  s_waitcnt lgkmcnt(11)
  v_mfma_f32_16x16x32_bf16 v[12:15], a[220:223], a[80:83], v[12:15]
  ds_read_b64_tr_b16 a[202:203], v230 offset:34816
  ds_read_b64_tr_b16 a[204:205], v230 offset:40960
  s_add_u32 m0, s42, 90112
  s_waitcnt lgkmcnt(11)
  v_mfma_f32_16x16x32_bf16 v[12:15], a[224:227], a[88:91], v[12:15]
  s_barrier
  ds_read_b64_tr_b16 a[206:207], v230 offset:43008
  s_waitcnt vmcnt(14) lgkmcnt(10)
  v_mfma_f32_16x16x32_bf16 v[0:3], a[228:231], a[96:99], v[0:3]
  buffer_load_dwordx4 v227, s[12:15], s41 offen offset:0 lds
  ds_read_b64_tr_b16 a[208:209], v231 offset:32768
  ds_read_b64_tr_b16 a[210:211], v231 offset:34816
  s_waitcnt lgkmcnt(10)
  v_mfma_f32_16x16x32_bf16 v[0:3], a[232:235], a[104:107], v[0:3]
  ds_read_b64_tr_b16 a[212:213], v231 offset:40960
  ds_read_b64_tr_b16 a[214:215], v231 offset:43008
  s_mov_b32 s41, 229376
  s_waitcnt lgkmcnt(10)
  v_mfma_f32_16x16x32_bf16 v[4:7], a[192:195], a[96:99], v[4:7]
  ds_read_b64_tr_b16 a[216:217], v232 offset:4096
  ds_read_b64_tr_b16 a[218:219], v232 offset:6144
  s_add_u32 m0, s42, 118784
  s_waitcnt lgkmcnt(10)
  v_mfma_f32_16x16x32_bf16 v[4:7], a[196:199], a[104:107], v[4:7]
  buffer_load_dwordx4 v227, s[12:15], s41 offen offset:0 lds
  ds_read_b64_tr_b16 a[220:221], v232 offset:16384
  ds_read_b64_tr_b16 a[222:223], v232 offset:18432
  s_waitcnt lgkmcnt(10)
  v_mfma_f32_16x16x32_bf16 v[8:11], a[200:203], a[96:99], v[8:11]
  ds_read_b64_tr_b16 a[224:225], v233 offset:4096
  ds_read_b64_tr_b16 a[226:227], v233 offset:6144
  s_mov_b32 s41, 0
  s_waitcnt lgkmcnt(10)
  v_mfma_f32_16x16x32_bf16 v[8:11], a[204:207], a[104:107], v[8:11]
  ds_read_b64_tr_b16 a[228:229], v233 offset:16384
  ds_read_b64_tr_b16 a[230:231], v233 offset:18432
  s_add_u32 m0, s42, 131072
  s_waitcnt lgkmcnt(10)
  v_mfma_f32_16x16x32_bf16 v[12:15], a[208:211], a[96:99], v[12:15]
  buffer_load_dwordx4 v227, s[16:19], s41 offen offset:0 lds
  ds_read_b64_tr_b16 a[232:233], v234 offset:4096
  ds_read_b64_tr_b16 a[234:235], v234 offset:6144
  s_waitcnt lgkmcnt(10)
  v_mfma_f32_16x16x32_bf16 v[12:15], a[212:215], a[104:107], v[12:15]
  ds_read_b64_tr_b16 a[192:193], v234 offset:16384
  ds_read_b64_tr_b16 a[194:195], v234 offset:18432
  s_mov_b32 s41, 229376
  s_waitcnt vmcnt(15) lgkmcnt(10)
  v_mfma_f32_16x16x32_bf16 v[0:3], a[216:219], a[112:115], v[0:3]
  ds_read_b64_tr_b16 a[196:197], v235 offset:4096
  ds_read_b64_tr_b16 a[198:199], v235 offset:6144
  s_add_u32 m0, s42, 139264
  s_waitcnt lgkmcnt(10)
  v_mfma_f32_16x16x32_bf16 v[0:3], a[220:223], a[120:123], v[0:3]
  buffer_load_dwordx4 v227, s[16:19], s41 offen offset:0 lds
  ds_read_b64_tr_b16 a[200:201], v235 offset:16384
  ds_read_b64_tr_b16 a[202:203], v235 offset:18432
  s_waitcnt lgkmcnt(10)
  v_mfma_f32_16x16x32_bf16 v[4:7], a[224:227], a[112:115], v[4:7]
  ds_read_b64_tr_b16 a[204:205], v236 offset:16384
  ds_read_b64_tr_b16 a[206:207], v236 offset:18432
  s_mov_b32 s40, 8912896
  s_waitcnt lgkmcnt(10)
  v_mfma_f32_16x16x32_bf16 v[4:7], a[228:231], a[120:123], v[4:7]
  buffer_load_dwordx4 a[100:103], v240, s[4:7], s40 offen offset:1024 sc1
  ds_read_b64_tr_b16 a[208:209], v236 offset:28672
  ds_read_b64_tr_b16 a[210:211], v236 offset:30720
  s_waitcnt lgkmcnt(10)
  v_mfma_f32_16x16x32_bf16 v[8:11], a[232:235], a[112:115], v[8:11]
  ds_read_b64_tr_b16 a[212:213], v237 offset:16384
  ds_read_b64_tr_b16 a[214:215], v237 offset:18432
  s_mov_b32 s40, 9043968
  s_waitcnt lgkmcnt(10)
  v_mfma_f32_16x16x32_bf16 v[8:11], a[192:195], a[120:123], v[8:11]
  ds_read_b64_tr_b16 a[216:217], v237 offset:28672
  ds_read_b64_tr_b16 a[218:219], v237 offset:30720
  s_waitcnt lgkmcnt(10)
  v_mfma_f32_16x16x32_bf16 v[12:15], a[196:199], a[112:115], v[12:15]
  buffer_load_dwordx4 a[108:111], v240, s[4:7], s40 offen offset:1024 sc1
  ds_read_b64_tr_b16 a[220:221], v238 offset:16384
  ds_read_b64_tr_b16 a[222:223], v238 offset:18432
  s_waitcnt lgkmcnt(10)
L_wk0_5:
  s_cbranch_vccnz L_wk0_end
  v_mfma_f32_16x16x32_bf16 v[12:15], a[200:203], a[120:123], v[12:15]
  s_barrier
  ds_read_b64_tr_b16 a[224:225], v238 offset:28672
  v_fmac_f32 v160, v0, v64
  v_fmac_f32 v161, v1, v65
  v_fmac_f32 v162, v2, v66
  s_waitcnt vmcnt(16) lgkmcnt(9)
  v_mfma_f32_16x16x32_bf16 v[16:19], a[204:207], a[4:7], v[16:19]
  ds_read_b64_tr_b16 a[226:227], v238 offset:30720
  ds_read_b64_tr_b16 a[228:229], v239 offset:16384
  s_mov_b32 s40, 9175040
  v_fmac_f32 v163, v3, v67
  v_fmac_f32 v164, v4, v68
  v_fmac_f32 v165, v5, v69
  v_fmac_f32 v166, v6, v70
  s_waitcnt lgkmcnt(9)
  v_mfma_f32_16x16x32_bf16 v[16:19], a[208:211], a[12:15], v[16:19]
  buffer_load_dwordx4 a[116:119], v240, s[4:7], s40 offen offset:1024 sc1
  ds_read_b64_tr_b16 a[230:231], v239 offset:18432
  ds_read_b64_tr_b16 a[232:233], v239 offset:28672
  v_fmac_f32 v167, v7, v71
  v_fmac_f32 v168, v8, v72
  v_fmac_f32 v169, v9, v73
  v_fmac_f32 v170, v10, v74
  s_waitcnt lgkmcnt(9)
  v_mfma_f32_16x16x32_bf16 v[20:23], a[212:215], a[4:7], v[20:23]
  ds_read_b64_tr_b16 a[234:235], v239 offset:30720
  ds_read_b64_tr_b16 a[192:193], v228 offset:16384
  s_mov_b32 s40, 9306112
  v_fmac_f32 v171, v11, v75
  v_fmac_f32 v172, v12, v76
  v_fmac_f32 v173, v13, v77
  v_fmac_f32 v174, v14, v78
  s_waitcnt lgkmcnt(9)
  v_mfma_f32_16x16x32_bf16 v[20:23], a[216:219], a[12:15], v[20:23]
  ds_read_b64_tr_b16 a[194:195], v228 offset:18432
  ds_read_b64_tr_b16 a[196:197], v228 offset:12288
  v_fmac_f32 v175, v15, v79
  v_mul_f32 v82, v160, v160
  v_mul_f32 v83, v161, v161
  v_fmac_f32 v82, v162, v162
  s_waitcnt lgkmcnt(9)
  v_mfma_f32_16x16x32_bf16 v[24:27], a[220:223], a[4:7], v[24:27]
  buffer_load_dwordx4 a[124:127], v240, s[4:7], s40 offen offset:1024 sc1
  ds_read_b64_tr_b16 a[198:199], v228 offset:14336
  ds_read_b64_tr_b16 a[200:201], v229 offset:16384
  v_add_f32 v80, v160, v162
  v_fmac_f32 v83, v163, v163
  v_add_f32 v81, v161, v163
  v_fmac_f32 v82, v164, v164
  s_waitcnt lgkmcnt(9)
  v_mfma_f32_16x16x32_bf16 v[24:27], a[224:227], a[12:15], v[24:27]
  ds_read_b64_tr_b16 a[202:203], v229 offset:18432
  ds_read_b64_tr_b16 a[204:205], v229 offset:12288
  s_mov_b32 s41, 0
  v_add_f32 v80, v80, v164
  v_fmac_f32 v83, v165, v165
  v_add_f32 v81, v81, v165
  v_fmac_f32 v82, v166, v166
  s_waitcnt lgkmcnt(9)
  v_mfma_f32_16x16x32_bf16 v[28:31], a[228:231], a[4:7], v[28:31]
  ds_read_b64_tr_b16 a[206:207], v229 offset:14336
  ds_read_b64_tr_b16 a[208:209], v230 offset:16384
  s_add_u32 m0, s42, 20480
  v_add_f32 v80, v80, v166
  v_fmac_f32 v83, v167, v167
  v_add_f32 v81, v81, v167
  v_fmac_f32 v82, v168, v168
  s_waitcnt lgkmcnt(9)
  v_mfma_f32_16x16x32_bf16 v[28:31], a[232:235], a[12:15], v[28:31]
  buffer_load_dwordx4 v226, s[12:15], s41 offen offset:0 lds
  ds_read_b64_tr_b16 a[210:211], v230 offset:18432
  ds_read_b64_tr_b16 a[212:213], v230 offset:12288
  v_add_f32 v80, v80, v168
  v_fmac_f32 v83, v169, v169
  v_add_f32 v81, v81, v169
  v_fmac_f32 v82, v170, v170
  s_waitcnt vmcnt(17) lgkmcnt(9)
  v_mfma_f32_16x16x32_bf16 v[16:19], a[192:195], a[20:23], v[16:19]
  ds_read_b64_tr_b16 a[214:215], v230 offset:14336
  ds_read_b64_tr_b16 a[216:217], v231 offset:16384
  s_mov_b32 s41, 229376
  v_add_f32 v80, v80, v170
  v_fmac_f32 v83, v171, v171
  v_add_f32 v81, v81, v171
  v_fmac_f32 v82, v172, v172
  s_waitcnt lgkmcnt(9)
  v_mfma_f32_16x16x32_bf16 v[16:19], a[196:199], a[28:31], v[16:19]
  ds_read_b64_tr_b16 a[218:219], v231 offset:18432
  ds_read_b64_tr_b16 a[220:221], v231 offset:12288
  s_add_u32 m0, s42, 143360
  v_add_f32 v80, v80, v172
  v_fmac_f32 v83, v173, v173
  v_add_f32 v81, v81, v173
  v_fmac_f32 v82, v174, v174
  s_waitcnt lgkmcnt(9)
  v_mfma_f32_16x16x32_bf16 v[20:23], a[200:203], a[20:23], v[20:23]
  buffer_load_dwordx4 v226, s[12:15], s41 offen offset:0 lds
  ds_read_b64_tr_b16 a[222:223], v231 offset:14336
  ds_read_b64_tr_b16 a[224:225], v228 offset:24576
  v_add_f32 v80, v80, v174
  v_fmac_f32 v83, v175, v175
  v_add_f32 v81, v81, v175
  v_add_f32 v80, v80, v81
  s_waitcnt lgkmcnt(9)
  v_mfma_f32_16x16x32_bf16 v[20:23], a[204:207], a[28:31], v[20:23]
  ds_read_b64_tr_b16 a[226:227], v228 offset:26624
  ds_read_b64_tr_b16 a[228:229], v228 offset:45056
  s_mov_b32 s41, 0
  v_add_f32 v81, v82, v83
  v_mov_b32 v82, v80
  v_mov_b32 v83, v81
  s_waitcnt lgkmcnt(9)
  v_mfma_f32_16x16x32_bf16 v[24:27], a[208:211], a[20:23], v[24:27]
  ds_read_b64_tr_b16 a[230:231], v228 offset:47104
  ds_read_b64_tr_b16 a[232:233], v229 offset:24576
  s_add_u32 m0, s42, 155648
  v_permlane16_swap_b32 v82, v80
  v_permlane16_swap_b32 v83, v81
  s_waitcnt lgkmcnt(9)
  v_mfma_f32_16x16x32_bf16 v[24:27], a[212:215], a[28:31], v[24:27]
  buffer_load_dwordx4 v226, s[16:19], s41 offen offset:0 lds
  ds_read_b64_tr_b16 a[234:235], v229 offset:26624
  ds_read_b64_tr_b16 a[192:193], v229 offset:45056
  v_add_f32 v80, v80, v82
  v_add_f32 v81, v81, v83
  v_mov_b32 v82, v80
  v_mov_b32 v83, v81
  s_waitcnt lgkmcnt(9)
  v_mfma_f32_16x16x32_bf16 v[28:31], a[216:219], a[20:23], v[28:31]
  ds_read_b64_tr_b16 a[194:195], v229 offset:47104
  ds_read_b64_tr_b16 a[196:197], v230 offset:24576
  s_mov_b32 s41, 229376
  v_permlane32_swap_b32 v82, v80
  v_permlane32_swap_b32 v83, v81
  s_waitcnt lgkmcnt(9)
  v_mfma_f32_16x16x32_bf16 v[28:31], a[220:223], a[28:31], v[28:31]
  s_barrier
  ds_read_b64_tr_b16 a[198:199], v230 offset:26624
  v_add_f32 v80, v80, v82
  v_add_f32 v81, v81, v83
  v_and_b32 v80, -2, v80
  v_and_b32 v81, 0x7fffffff, v81
  buffer_store_dwordx2 v[80:81], v211, s[4:7], s95 offen offset:0 sc1
  v_cvt_pk_bf16_f32 v32, v160, v161
  s_waitcnt vmcnt(18) lgkmcnt(8)
  v_mfma_f32_16x16x32_bf16 v[16:19], a[224:227], a[36:39], v[16:19]
  ds_read_b64_tr_b16 a[200:201], v230 offset:45056
  ds_read_b64_tr_b16 a[202:203], v230 offset:47104
  s_add_u32 m0, s42, 36864
  v_cvt_pk_bf16_f32 v33, v162, v163
  v_cvt_pk_bf16_f32 v34, v164, v165
  v_cvt_pk_bf16_f32 v35, v166, v167
  v_cvt_pk_bf16_f32 v36, v168, v169
  s_waitcnt lgkmcnt(8)
  v_mfma_f32_16x16x32_bf16 v[16:19], a[228:231], a[44:47], v[16:19]
  buffer_load_dwordx4 v226, s[16:19], s41 offen offset:0 lds
  ds_read_b64_tr_b16 a[204:205], v231 offset:24576
  ds_read_b64_tr_b16 a[206:207], v231 offset:26624
  v_cvt_pk_bf16_f32 v37, v170, v171
  v_cvt_pk_bf16_f32 v38, v172, v173
  v_cvt_pk_bf16_f32 v39, v174, v175
  v_accvgpr_write_b32 a236, v32
  s_waitcnt lgkmcnt(8)
  v_mfma_f32_16x16x32_bf16 v[20:23], a[232:235], a[36:39], v[20:23]
  ds_read_b64_tr_b16 a[208:209], v231 offset:45056
  ds_read_b64_tr_b16 a[210:211], v231 offset:47104
  s_mov_b32 s41, 458752
  v_lshlrev_b32 v0, 16, v32
  v_and_b32 v1, 0xffff0000, v32
  v_accvgpr_write_b32 a237, v33
  v_lshlrev_b32 v2, 16, v33
  s_waitcnt lgkmcnt(8)
  v_mfma_f32_16x16x32_bf16 v[20:23], a[192:195], a[44:47], v[20:23]
  ds_read_b64_tr_b16 a[212:213], v228 offset:57344
  ds_read_b64_tr_b16 a[214:215], v228 offset:59392
  s_add_u32 m0, s42, 53248
  v_and_b32 v3, 0xffff0000, v33
  v_accvgpr_write_b32 a238, v34
  v_lshlrev_b32 v4, 16, v34
  v_and_b32 v5, 0xffff0000, v34
  s_waitcnt lgkmcnt(8)
  v_mfma_f32_16x16x32_bf16 v[24:27], a[196:199], a[36:39], v[24:27]
  buffer_load_dwordx4 v227, s[12:15], s41 offen offset:0 lds
  ds_read_b64_tr_b16 a[216:217], v232 offset:0
  ds_read_b64_tr_b16 a[218:219], v232 offset:2048
  v_accvgpr_write_b32 a239, v35
  v_lshlrev_b32 v6, 16, v35
  v_and_b32 v7, 0xffff0000, v35
  v_accvgpr_write_b32 a240, v36
  s_waitcnt lgkmcnt(8)
  v_mfma_f32_16x16x32_bf16 v[24:27], a[200:203], a[44:47], v[24:27]
  ds_read_b64_tr_b16 a[220:221], v229 offset:57344
  ds_read_b64_tr_b16 a[222:223], v229 offset:59392
  s_mov_b32 s41, 688128
  v_lshlrev_b32 v8, 16, v36
  v_and_b32 v9, 0xffff0000, v36
  v_accvgpr_write_b32 a241, v37
  v_lshlrev_b32 v10, 16, v37
  s_waitcnt lgkmcnt(8)
  v_mfma_f32_16x16x32_bf16 v[28:31], a[204:207], a[36:39], v[28:31]
  ds_read_b64_tr_b16 a[224:225], v233 offset:0
  ds_read_b64_tr_b16 a[226:227], v233 offset:2048
  s_add_u32 m0, s42, 49152
  v_and_b32 v11, 0xffff0000, v37
  v_accvgpr_write_b32 a242, v38
  v_lshlrev_b32 v12, 16, v38
  v_and_b32 v13, 0xffff0000, v38
  s_waitcnt lgkmcnt(8)
  v_mfma_f32_16x16x32_bf16 v[28:31], a[208:211], a[44:47], v[28:31]
  buffer_load_dwordx4 v227, s[12:15], s41 offen offset:0 lds
  ds_read_b64_tr_b16 a[228:229], v230 offset:57344
  ds_read_b64_tr_b16 a[230:231], v230 offset:59392
  v_accvgpr_write_b32 a243, v39
  v_lshlrev_b32 v14, 16, v39
  v_and_b32 v15, 0xffff0000, v39
  s_waitcnt vmcnt(19) lgkmcnt(8)
  v_mfma_f32_16x16x32_bf16 v[16:19], a[212:215], a[52:55], v[16:19]
  ds_read_b64_tr_b16 a[232:233], v234 offset:0
  ds_read_b64_tr_b16 a[234:235], v234 offset:2048
  s_mov_b32 s41, 458752
  s_waitcnt lgkmcnt(8)
  v_mfma_f32_16x16x32_bf16 v[16:19], a[216:219], a[60:63], v[16:19]
  ds_read_b64_tr_b16 a[192:193], v231 offset:57344
  ds_read_b64_tr_b16 a[194:195], v231 offset:59392
  s_add_u32 m0, s42, 61440
  s_waitcnt lgkmcnt(8)
  v_mfma_f32_16x16x32_bf16 v[20:23], a[220:223], a[52:55], v[20:23]
  buffer_load_dwordx4 v227, s[16:19], s41 offen offset:0 lds
  ds_read_b64_tr_b16 a[196:197], v235 offset:0
  ds_read_b64_tr_b16 a[198:199], v235 offset:2048
  s_waitcnt lgkmcnt(8)
  v_mfma_f32_16x16x32_bf16 v[20:23], a[224:227], a[60:63], v[20:23]
  ds_read_b64_tr_b16 a[200:201], v232 offset:28672
  ds_read_b64_tr_b16 a[202:203], v232 offset:30720
  s_mov_b32 s41, 688128
  s_waitcnt lgkmcnt(8)
  v_mfma_f32_16x16x32_bf16 v[24:27], a[228:231], a[52:55], v[24:27]
  ds_read_b64_tr_b16 a[204:205], v232 offset:40960
  ds_read_b64_tr_b16 a[206:207], v232 offset:43008
  s_add_u32 m0, s42, 77824
  s_waitcnt lgkmcnt(8)
  v_mfma_f32_16x16x32_bf16 v[24:27], a[232:235], a[60:63], v[24:27]
  buffer_load_dwordx4 v227, s[16:19], s41 offen offset:0 lds
  ds_read_b64_tr_b16 a[208:209], v233 offset:28672
  ds_read_b64_tr_b16 a[210:211], v233 offset:30720
  s_waitcnt lgkmcnt(8)
  v_mfma_f32_16x16x32_bf16 v[28:31], a[192:195], a[52:55], v[28:31]
  ds_read_b64_tr_b16 a[212:213], v233 offset:40960
  ds_read_b64_tr_b16 a[214:215], v233 offset:43008
  s_mov_b32 s41, 458752
  s_waitcnt lgkmcnt(8)
  v_mfma_f32_16x16x32_bf16 v[28:31], a[196:199], a[60:63], v[28:31]
  s_barrier
  ds_read_b64_tr_b16 a[216:217], v234 offset:28672
  s_waitcnt vmcnt(19) lgkmcnt(7)
  v_mfma_f32_16x16x32_bf16 v[16:19], a[200:203], a[68:71], v[16:19]
  ds_read_b64_tr_b16 a[218:219], v234 offset:30720
  ds_read_b64_tr_b16 a[220:221], v234 offset:40960
  s_add_u32 m0, s42, 73728
  s_waitcnt lgkmcnt(7)
  v_mfma_f32_16x16x32_bf16 v[16:19], a[204:207], a[76:79], v[16:19]
  buffer_load_dwordx4 v226, s[12:15], s41 offen offset:0 lds
  ds_read_b64_tr_b16 a[222:223], v234 offset:43008
  ds_read_b64_tr_b16 a[224:225], v235 offset:28672
  s_waitcnt lgkmcnt(7)
  v_mfma_f32_16x16x32_bf16 v[20:23], a[208:211], a[68:71], v[20:23]
  ds_read_b64_tr_b16 a[226:227], v235 offset:30720
  ds_read_b64_tr_b16 a[228:229], v235 offset:40960
  s_mov_b32 s41, 688128
  s_waitcnt lgkmcnt(7)
  v_mfma_f32_16x16x32_bf16 v[20:23], a[212:215], a[76:79], v[20:23]
  ds_read_b64_tr_b16 a[230:231], v235 offset:43008
  ds_read_b64_tr_b16 a[232:233], v232 offset:49152
  s_add_u32 m0, s42, 86016
  s_waitcnt lgkmcnt(7)
  v_mfma_f32_16x16x32_bf16 v[24:27], a[216:219], a[68:71], v[24:27]
  buffer_load_dwordx4 v226, s[12:15], s41 offen offset:0 lds
  ds_read_b64_tr_b16 a[234:235], v232 offset:51200
  ds_read_b64_tr_b16 a[192:193], v228 offset:28672
  s_waitcnt lgkmcnt(7)
  v_mfma_f32_16x16x32_bf16 v[24:27], a[220:223], a[76:79], v[24:27]
  ds_read_b64_tr_b16 a[194:195], v228 offset:30720
  ds_read_b64_tr_b16 a[196:197], v233 offset:49152
  s_mov_b32 s41, 458752
  s_waitcnt lgkmcnt(7)
  v_mfma_f32_16x16x32_bf16 v[28:31], a[224:227], a[68:71], v[28:31]
  ds_read_b64_tr_b16 a[198:199], v233 offset:51200
  ds_read_b64_tr_b16 a[200:201], v229 offset:28672
  s_add_u32 m0, s42, 102400
  s_waitcnt lgkmcnt(7)
  v_mfma_f32_16x16x32_bf16 v[28:31], a[228:231], a[76:79], v[28:31]
  buffer_load_dwordx4 v226, s[16:19], s41 offen offset:0 lds
  ds_read_b64_tr_b16 a[202:203], v229 offset:30720
  ds_read_b64_tr_b16 a[204:205], v234 offset:49152
  s_waitcnt vmcnt(20) lgkmcnt(7)
  v_mfma_f32_16x16x32_bf16 v[16:19], a[232:235], a[84:87], v[16:19]
  ds_read_b64_tr_b16 a[206:207], v234 offset:51200
  ds_read_b64_tr_b16 a[208:209], v230 offset:28672
  s_mov_b32 s41, 688128
  s_waitcnt lgkmcnt(7)
  v_mfma_f32_16x16x32_bf16 v[16:19], a[192:195], a[92:95], v[16:19]
  ds_read_b64_tr_b16 a[210:211], v230 offset:30720
  ds_read_b64_tr_b16 a[212:213], v235 offset:49152
  s_add_u32 m0, s42, 98304
  s_waitcnt lgkmcnt(7)
  v_mfma_f32_16x16x32_bf16 v[20:23], a[196:199], a[84:87], v[20:23]
  buffer_load_dwordx4 v226, s[16:19], s41 offen offset:0 lds
  ds_read_b64_tr_b16 a[214:215], v235 offset:51200
  ds_read_b64_tr_b16 a[216:217], v231 offset:28672
  s_waitcnt lgkmcnt(7)
  v_mfma_f32_16x16x32_bf16 v[20:23], a[200:203], a[92:95], v[20:23]
  ds_read_b64_tr_b16 a[218:219], v231 offset:30720
  ds_read_b64_tr_b16 a[220:221], v228 offset:32768
  s_waitcnt lgkmcnt(7)
  v_mfma_f32_16x16x32_bf16 v[24:27], a[204:207], a[84:87], v[24:27]
  ds_read_b64_tr_b16 a[222:223], v228 offset:34816
  ds_read_b64_tr_b16 a[224:225], v228 offset:40960
  s_waitcnt lgkmcnt(7)
  v_mfma_f32_16x16x32_bf16 v[24:27], a[208:211], a[92:95], v[24:27]
  ds_read_b64_tr_b16 a[226:227], v228 offset:43008
  ds_read_b64_tr_b16 a[228:229], v229 offset:32768
  s_waitcnt lgkmcnt(7)
  v_mfma_f32_16x16x32_bf16 v[28:31], a[212:215], a[84:87], v[28:31]
  ds_read_b64_tr_b16 a[230:231], v229 offset:34816
  ds_read_b64_tr_b16 a[232:233], v229 offset:40960
  s_waitcnt lgkmcnt(7)
  v_mfma_f32_16x16x32_bf16 v[28:31], a[216:219], a[92:95], v[28:31]
  s_waitcnt vmcnt(19)
  s_barrier
  ds_read_b64_tr_b16 a[234:235], v229 offset:43008
  s_waitcnt vmcnt(15) lgkmcnt(6)
  v_mfma_f32_16x16x32_bf16 v[16:19], a[220:223], a[100:103], v[16:19]
  ds_read_b64_tr_b16 a[192:193], v230 offset:32768
  ds_read_b64_tr_b16 a[194:195], v230 offset:34816
  s_waitcnt lgkmcnt(6)
  v_mfma_f32_16x16x32_bf16 v[16:19], a[224:227], a[108:111], v[16:19]
  ds_read_b64_tr_b16 a[196:197], v230 offset:40960
  ds_read_b64_tr_b16 a[198:199], v230 offset:43008
  s_waitcnt lgkmcnt(6)
  v_mfma_f32_16x16x32_bf16 v[20:23], a[228:231], a[100:103], v[20:23]
  ds_read_b64_tr_b16 a[200:201], v231 offset:32768
  ds_read_b64_tr_b16 a[202:203], v231 offset:34816
  s_waitcnt lgkmcnt(6)
  v_mfma_f32_16x16x32_bf16 v[20:23], a[232:235], a[108:111], v[20:23]
  ds_read_b64_tr_b16 a[204:205], v231 offset:40960
  ds_read_b64_tr_b16 a[206:207], v231 offset:43008
  s_waitcnt lgkmcnt(6)
  v_mfma_f32_16x16x32_bf16 v[24:27], a[192:195], a[100:103], v[24:27]
  ds_read_b64_tr_b16 a[208:209], v232 offset:4096
  ds_read_b64_tr_b16 a[210:211], v232 offset:6144
  s_waitcnt lgkmcnt(6)
  v_mfma_f32_16x16x32_bf16 v[24:27], a[196:199], a[108:111], v[24:27]
  ds_read_b64_tr_b16 a[212:213], v232 offset:16384
  ds_read_b64_tr_b16 a[214:215], v232 offset:18432
  s_waitcnt lgkmcnt(6)
  v_mfma_f32_16x16x32_bf16 v[28:31], a[200:203], a[100:103], v[28:31]
  ds_read_b64_tr_b16 a[216:217], v233 offset:4096
  ds_read_b64_tr_b16 a[218:219], v233 offset:6144
  s_waitcnt lgkmcnt(6)
  v_mfma_f32_16x16x32_bf16 v[28:31], a[204:207], a[108:111], v[28:31]
  ds_read_b64_tr_b16 a[220:221], v233 offset:16384
  ds_read_b64_tr_b16 a[222:223], v233 offset:18432
  s_waitcnt vmcnt(13) lgkmcnt(6)
  v_mfma_f32_16x16x32_bf16 v[16:19], a[208:211], a[116:119], v[16:19]
  ds_read_b64_tr_b16 a[224:225], v234 offset:4096
  ds_read_b64_tr_b16 a[226:227], v234 offset:6144
  s_waitcnt lgkmcnt(6)
  v_mfma_f32_16x16x32_bf16 v[16:19], a[212:215], a[124:127], v[16:19]
  ds_read_b64_tr_b16 a[228:229], v234 offset:16384
  ds_read_b64_tr_b16 a[230:231], v234 offset:18432
  s_waitcnt lgkmcnt(6)
  v_mfma_f32_16x16x32_bf16 v[20:23], a[216:219], a[116:119], v[20:23]
  ds_read_b64_tr_b16 a[232:233], v235 offset:4096
  ds_read_b64_tr_b16 a[234:235], v235 offset:6144
  s_waitcnt lgkmcnt(6)
  v_mfma_f32_16x16x32_bf16 v[20:23], a[220:223], a[124:127], v[20:23]
  ds_read_b64_tr_b16 a[192:193], v235 offset:16384
  ds_read_b64_tr_b16 a[194:195], v235 offset:18432
  s_waitcnt lgkmcnt(6)
  v_mfma_f32_16x16x32_bf16 v[24:27], a[224:227], a[116:119], v[24:27]
  ds_read_b64_tr_b16 a[196:197], v232 offset:24576
  ds_read_b64_tr_b16 a[198:199], v232 offset:26624
  s_waitcnt lgkmcnt(6)
  v_mfma_f32_16x16x32_bf16 v[24:27], a[228:231], a[124:127], v[24:27]
  ds_read_b64_tr_b16 a[200:201], v232 offset:53248
  ds_read_b64_tr_b16 a[202:203], v232 offset:55296
  s_waitcnt lgkmcnt(6)
  v_mfma_f32_16x16x32_bf16 v[28:31], a[232:235], a[116:119], v[28:31]
  ds_read_b64_tr_b16 a[204:205], v233 offset:24576
  ds_read_b64_tr_b16 a[206:207], v233 offset:26624
  s_waitcnt lgkmcnt(6)
  v_mfma_f32_16x16x32_bf16 v[28:31], a[192:195], a[124:127], v[28:31]
  buffer_load_dwordx2 v[112:113], v212, s[4:7], s94 offen offset:0 sc1
  buffer_load_dwordx2 v[114:115], v212, s[4:7], s94 offen offset:1024 sc1
  buffer_load_dwordx2 v[116:117], v212, s[4:7], s94 offen offset:2048 sc1
  buffer_load_dwordx2 v[118:119], v212, s[4:7], s94 offen offset:3072 sc1
  v_pk_fma_f32 v[176:177], v[16:17], v[64:65], v[176:177]
  v_pk_fma_f32 v[178:179], v[18:19], v[66:67], v[178:179]
  v_pk_fma_f32 v[180:181], v[20:21], v[68:69], v[180:181]
  v_pk_fma_f32 v[182:183], v[22:23], v[70:71], v[182:183]
  v_pk_fma_f32 v[184:185], v[24:25], v[72:73], v[184:185]
  v_pk_fma_f32 v[186:187], v[26:27], v[74:75], v[186:187]
  v_pk_fma_f32 v[188:189], v[28:29], v[76:77], v[188:189]
  v_pk_fma_f32 v[190:191], v[30:31], v[78:79], v[190:191]
  v_pk_mul_f32 v[90:91], v[176:177], v[176:177]
  v_pk_fma_f32 v[90:91], v[178:179], v[178:179], v[90:91]
  v_pk_add_f32 v[88:89], v[176:177], v[178:179]
  v_pk_fma_f32 v[90:91], v[180:181], v[180:181], v[90:91]
  v_pk_add_f32 v[88:89], v[88:89], v[180:181]
  v_pk_fma_f32 v[90:91], v[182:183], v[182:183], v[90:91]
  v_pk_add_f32 v[88:89], v[88:89], v[182:183]
  v_pk_fma_f32 v[90:91], v[184:185], v[184:185], v[90:91]
  v_pk_add_f32 v[88:89], v[88:89], v[184:185]
  v_pk_fma_f32 v[90:91], v[186:187], v[186:187], v[90:91]
  v_pk_add_f32 v[88:89], v[88:89], v[186:187]
  v_pk_fma_f32 v[90:91], v[188:189], v[188:189], v[90:91]
  v_pk_add_f32 v[88:89], v[88:89], v[188:189]
  v_pk_fma_f32 v[90:91], v[190:191], v[190:191], v[90:91]
  v_pk_add_f32 v[88:89], v[88:89], v[190:191]
  v_add_f32 v88, v88, v89
  v_add_f32 v89, v90, v91
  v_mov_b32 v90, v88
  v_mov_b32 v91, v89
  s_nop 0
  v_permlane16_swap_b32 v90, v88
  v_permlane16_swap_b32 v91, v89
  s_nop 0
  v_add_f32 v88, v88, v90
  v_add_f32 v89, v89, v91
  v_mov_b32 v90, v88
  v_mov_b32 v91, v89
  s_nop 0
  v_permlane32_swap_b32 v90, v88
  v_permlane32_swap_b32 v91, v89
  s_nop 0
  v_add_f32 v88, v88, v90
  v_add_f32 v89, v89, v91
  v_and_b32 v88, -2, v88
  v_and_b32 v89, 0x7fffffff, v89
  buffer_store_dwordx2 v[88:89], v211, s[4:7], s95 offen offset:128 sc1
  v_cvt_pk_bf16_f32 v40, v176, v177
  v_cvt_pk_bf16_f32 v41, v178, v179
  v_cvt_pk_bf16_f32 v42, v180, v181
  v_cvt_pk_bf16_f32 v43, v182, v183
  v_cvt_pk_bf16_f32 v44, v184, v185
  v_cvt_pk_bf16_f32 v45, v186, v187
  v_cvt_pk_bf16_f32 v46, v188, v189
  v_cvt_pk_bf16_f32 v47, v190, v191
  v_accvgpr_write_b32 a244, v40
  v_lshlrev_b32 v16, 16, v40
  v_and_b32 v17, 0xffff0000, v40
  v_accvgpr_write_b32 a245, v41
  v_lshlrev_b32 v18, 16, v41
  v_and_b32 v19, 0xffff0000, v41
  v_accvgpr_write_b32 a246, v42
  v_lshlrev_b32 v20, 16, v42
  v_and_b32 v21, 0xffff0000, v42
  v_accvgpr_write_b32 a247, v43
  v_lshlrev_b32 v22, 16, v43
  v_and_b32 v23, 0xffff0000, v43
  v_accvgpr_write_b32 a248, v44
  v_lshlrev_b32 v24, 16, v44
  v_and_b32 v25, 0xffff0000, v44
  v_accvgpr_write_b32 a249, v45
  v_lshlrev_b32 v26, 16, v45
  v_and_b32 v27, 0xffff0000, v45
  v_accvgpr_write_b32 a250, v46
  v_lshlrev_b32 v28, 16, v46
  v_and_b32 v29, 0xffff0000, v46
  v_accvgpr_write_b32 a251, v47
  v_lshlrev_b32 v30, 16, v47
  v_and_b32 v31, 0xffff0000, v47
  s_mov_b32 s33, 262144
  s_waitcnt vmcnt(1)
  s_branch L_rchk_30
L_rl_28:
  buffer_load_dwordx2 v[112:113], v212, s[4:7], s94 offen offset:0 sc1
  buffer_load_dwordx2 v[114:115], v212, s[4:7], s94 offen offset:1024 sc1
  buffer_load_dwordx2 v[116:117], v212, s[4:7], s94 offen offset:2048 sc1
  buffer_load_dwordx2 v[118:119], v212, s[4:7], s94 offen offset:3072 sc1
  s_waitcnt vmcnt(0)
L_rchk_30:
  v_max3_u32 v84, v112, v113, v114
  v_max3_u32 v84, v84, v115, v116
  v_max3_u32 v84, v84, v117, v118
  v_max_u32 v84, v84, v119
  v_cmp_eq_u32 s[68:69], -1, v84
  s_nop 1
  s_cmp_eq_u64 s[68:69], 0
  s_cbranch_scc1 L_rok_29
  s_sub_u32 s33, s33, 1
  s_cmp_lg_u32 s33, 0
  s_cbranch_scc1 L_rl_28
L_rok_29:
  v_pk_add_f32 v[80:81], v[112:113], v[114:115]
  v_pk_add_f32 v[82:83], v[116:117], v[118:119]
  v_pk_add_f32 v[80:81], v[80:81], v[82:83]
  v_mov_b32 v82, v80
  v_mov_b32 v83, v81
  s_nop 0
  v_permlane16_swap_b32 v82, v80
  v_permlane16_swap_b32 v83, v81
  s_nop 0
  v_add_f32 v80, v80, v82
  v_add_f32 v81, v81, v83
  v_mov_b32 v82, v80
  v_mov_b32 v83, v81
  s_nop 0
  v_permlane32_swap_b32 v82, v80
  v_permlane32_swap_b32 v83, v81
  s_nop 0
  v_add_f32 v80, v80, v82
  v_add_f32 v81, v81, v83
  v_mul_f32 v160, 0x3a800000, v80
  v_mul_f32 v164, 0x3a800000, v81
  v_fma_f32 v164, -v160, v160, v164
  v_max_f32 v164, 0, v164
  v_cvt_pk_bf16_f32 v168, v160, v164
  v_lshlrev_b32 v160, 16, v168
  v_and_b32 v164, 0xffff0000, v168
  v_add_f32 v164, 0x3727c5ac, v164
  v_cvt_pk_bf16_f32 v168, v164, v165
  v_lshlrev_b32 v164, 16, v168
  v_and_b32 v165, 0xffff0000, v168
  v_sqrt_f32 v164, v164
  s_nop 0
  v_cvt_pk_bf16_f32 v168, v164, v165
  v_lshlrev_b32 v164, 16, v168
  v_and_b32 v165, 0xffff0000, v168
  v_rcp_f32 v164, v164
  v_mov_b32 v161, v160
  v_mov_b32 v165, v164
  v_pk_add_f32 v[0:1], v[0:1], v[160:161] neg_lo:[0,1] neg_hi:[0,1]
  v_pk_add_f32 v[2:3], v[2:3], v[160:161] neg_lo:[0,1] neg_hi:[0,1]
  v_pk_add_f32 v[4:5], v[4:5], v[160:161] neg_lo:[0,1] neg_hi:[0,1]
  v_pk_add_f32 v[6:7], v[6:7], v[160:161] neg_lo:[0,1] neg_hi:[0,1]
  v_pk_add_f32 v[8:9], v[8:9], v[160:161] neg_lo:[0,1] neg_hi:[0,1]
  v_pk_add_f32 v[10:11], v[10:11], v[160:161] neg_lo:[0,1] neg_hi:[0,1]
  v_pk_add_f32 v[12:13], v[12:13], v[160:161] neg_lo:[0,1] neg_hi:[0,1]
  v_pk_add_f32 v[14:15], v[14:15], v[160:161] neg_lo:[0,1] neg_hi:[0,1]
  v_pk_mul_f32 v[0:1], v[0:1], v[164:165]
  v_pk_mul_f32 v[2:3], v[2:3], v[164:165]
  v_pk_mul_f32 v[4:5], v[4:5], v[164:165]
  v_pk_mul_f32 v[6:7], v[6:7], v[164:165]
  v_pk_mul_f32 v[8:9], v[8:9], v[164:165]
  v_pk_mul_f32 v[10:11], v[10:11], v[164:165]
  v_pk_mul_f32 v[12:13], v[12:13], v[164:165]
  v_pk_mul_f32 v[14:15], v[14:15], v[164:165]
  v_pk_fma_f32 v[0:1], v[0:1], v[144:145], v[96:97]
  v_pk_fma_f32 v[2:3], v[2:3], v[146:147], v[98:99]
  v_pk_fma_f32 v[4:5], v[4:5], v[148:149], v[100:101]
  v_pk_fma_f32 v[6:7], v[6:7], v[150:151], v[102:103]
  v_pk_fma_f32 v[8:9], v[8:9], v[152:153], v[104:105]
  v_pk_fma_f32 v[10:11], v[10:11], v[154:155], v[106:107]
  v_pk_fma_f32 v[12:13], v[12:13], v[156:157], v[108:109]
  v_pk_fma_f32 v[14:15], v[14:15], v[158:159], v[110:111]
  v_cvt_pk_bf16_f32 v48, v0, v1
  v_cvt_pk_bf16_f32 v49, v2, v3
  v_cvt_pk_bf16_f32 v50, v4, v5
  v_cvt_pk_bf16_f32 v51, v6, v7
  v_cvt_pk_bf16_f32 v52, v8, v9
  v_cvt_pk_bf16_f32 v53, v10, v11
  v_cvt_pk_bf16_f32 v54, v12, v13
  v_cvt_pk_bf16_f32 v55, v14, v15
  buffer_store_dwordx4 v[48:51], v240, s[4:7], s98 offen offset:0 sc1
  buffer_store_dwordx4 v[52:55], v240, s[4:7], s99 offen offset:0 sc1
  s_barrier
  ds_read_b64_tr_b16 a[208:209], v233 offset:53248
  ds_read_b64_tr_b16 a[210:211], v233 offset:55296
  ds_read_b64_tr_b16 a[212:213], v236 offset:0
  ds_read_b64_tr_b16 a[214:215], v236 offset:2048
  ds_read_b64_tr_b16 a[216:217], v236 offset:8192
  ds_read_b64_tr_b16 a[218:219], v236 offset:10240
  ds_read_b64_tr_b16 a[220:221], v237 offset:0
  ds_read_b64_tr_b16 a[222:223], v237 offset:2048
  ds_read_b64_tr_b16 a[224:225], v237 offset:8192
  ds_read_b64_tr_b16 a[226:227], v237 offset:10240
  ds_read_b64_tr_b16 a[228:229], v234 offset:24576
  ds_read_b64_tr_b16 a[230:231], v234 offset:26624
  ds_read_b64_tr_b16 a[232:233], v234 offset:53248
  ds_read_b64_tr_b16 a[234:235], v234 offset:55296
  ds_read_b64_tr_b16 a[192:193], v238 offset:0
  ds_read_b64_tr_b16 a[194:195], v238 offset:2048
  s_mov_b64 vcc, -1
  s_cmp_eq_u32 s3, 0
  s_cbranch_scc1 L_wk1_0
  s_cmp_eq_u32 s3, 1
  s_cbranch_scc1 L_wk1_1
  s_cmp_eq_u32 s3, 2
  s_cbranch_scc1 L_wk1_2
  s_branch L_wk1_3
L_wk1_end:
  s_mov_b64 vcc, 0
  buffer_load_dwordx2 v[120:121], v212, s[4:7], s94 offen offset:128 sc1
  buffer_load_dwordx2 v[122:123], v212, s[4:7], s94 offen offset:1152 sc1
  buffer_load_dwordx2 v[124:125], v212, s[4:7], s94 offen offset:2176 sc1
  buffer_load_dwordx2 v[126:127], v212, s[4:7], s94 offen offset:3200 sc1
  s_mov_b32 s33, 262144
  s_waitcnt vmcnt(0)
  s_branch L_rchk_33
L_rl_31:
  buffer_load_dwordx2 v[120:121], v212, s[4:7], s94 offen offset:128 sc1
  buffer_load_dwordx2 v[122:123], v212, s[4:7], s94 offen offset:1152 sc1
  buffer_load_dwordx2 v[124:125], v212, s[4:7], s94 offen offset:2176 sc1
  buffer_load_dwordx2 v[126:127], v212, s[4:7], s94 offen offset:3200 sc1
  s_waitcnt vmcnt(0)
L_rchk_33:
  v_max3_u32 v92, v120, v121, v122
  v_max3_u32 v92, v92, v123, v124
  v_max3_u32 v92, v92, v125, v126
  v_max_u32 v92, v92, v127
  v_cmp_eq_u32 s[68:69], -1, v92
  s_nop 1
  s_cmp_eq_u64 s[68:69], 0
  s_cbranch_scc1 L_rok_32
  s_sub_u32 s33, s33, 1
  s_cmp_lg_u32 s33, 0
  s_cbranch_scc1 L_rl_31
L_rok_32:
  s_mov_b32 s30, 9437184
  buffer_load_dwordx4 v[128:131], v225, s[4:7], s30 offen offset:0 sc1
  buffer_load_dwordx4 v[132:135], v225, s[4:7], s30 offen offset:2048 sc1
  s_mov_b32 s30, 9568256
  buffer_load_dwordx4 v[136:139], v225, s[4:7], s30 offen offset:0 sc1
  buffer_load_dwordx4 v[140:143], v225, s[4:7], s30 offen offset:2048 sc1
  s_mov_b32 s30, 9699328
  buffer_load_dwordx4 v[0:3], v225, s[4:7], s30 offen offset:0 sc1
  buffer_load_dwordx4 v[4:7], v225, s[4:7], s30 offen offset:2048 sc1
  s_mov_b32 s30, 9830400
L_wk1_0:
  s_cbranch_vccnz L_wk1_4
  buffer_load_dwordx4 v[8:11], v225, s[4:7], s30 offen offset:0 sc1
  buffer_load_dwordx4 v[12:15], v225, s[4:7], s30 offen offset:2048 sc1
  v_pk_add_f32 v[88:89], v[120:121], v[122:123]
  v_pk_add_f32 v[90:91], v[124:125], v[126:127]
  v_pk_add_f32 v[88:89], v[88:89], v[90:91]
  v_mov_b32 v90, v88
  v_mov_b32 v91, v89
  s_nop 0
  v_permlane16_swap_b32 v90, v88
  v_permlane16_swap_b32 v91, v89
  s_nop 0
  v_add_f32 v88, v88, v90
  v_add_f32 v89, v89, v91
  v_mov_b32 v90, v88
  v_mov_b32 v91, v89
  s_nop 0
  v_permlane32_swap_b32 v90, v88
  v_permlane32_swap_b32 v91, v89
  s_nop 0
  v_add_f32 v88, v88, v90
  v_add_f32 v89, v89, v91
  v_mul_f32 v176, 0x3a800000, v88
  v_mul_f32 v180, 0x3a800000, v89
  v_fma_f32 v180, -v176, v176, v180
  v_max_f32 v180, 0, v180
  v_cvt_pk_bf16_f32 v184, v176, v180
  v_lshlrev_b32 v176, 16, v184
  v_and_b32 v180, 0xffff0000, v184
  v_add_f32 v180, 0x3727c5ac, v180
  v_cvt_pk_bf16_f32 v184, v180, v181
  v_lshlrev_b32 v180, 16, v184
  v_and_b32 v181, 0xffff0000, v184
  v_sqrt_f32 v180, v180
  s_nop 0
  v_cvt_pk_bf16_f32 v184, v180, v181
  v_lshlrev_b32 v180, 16, v184
  v_and_b32 v181, 0xffff0000, v184
  v_rcp_f32 v180, v180
  v_mov_b32 v177, v176
  v_mov_b32 v181, v180
  v_pk_add_f32 v[16:17], v[16:17], v[176:177] neg_lo:[0,1] neg_hi:[0,1]
  v_pk_add_f32 v[18:19], v[18:19], v[176:177] neg_lo:[0,1] neg_hi:[0,1]
  v_pk_add_f32 v[20:21], v[20:21], v[176:177] neg_lo:[0,1] neg_hi:[0,1]
  v_pk_add_f32 v[22:23], v[22:23], v[176:177] neg_lo:[0,1] neg_hi:[0,1]
  v_pk_add_f32 v[24:25], v[24:25], v[176:177] neg_lo:[0,1] neg_hi:[0,1]
  v_pk_add_f32 v[26:27], v[26:27], v[176:177] neg_lo:[0,1] neg_hi:[0,1]
  v_pk_add_f32 v[28:29], v[28:29], v[176:177] neg_lo:[0,1] neg_hi:[0,1]
  v_pk_add_f32 v[30:31], v[30:31], v[176:177] neg_lo:[0,1] neg_hi:[0,1]
  v_pk_mul_f32 v[16:17], v[16:17], v[180:181]
  v_pk_mul_f32 v[18:19], v[18:19], v[180:181]
  v_pk_mul_f32 v[20:21], v[20:21], v[180:181]
  v_pk_mul_f32 v[22:23], v[22:23], v[180:181]
  v_pk_mul_f32 v[24:25], v[24:25], v[180:181]
  v_pk_mul_f32 v[26:27], v[26:27], v[180:181]
  v_pk_mul_f32 v[28:29], v[28:29], v[180:181]
  v_pk_mul_f32 v[30:31], v[30:31], v[180:181]
  v_pk_fma_f32 v[16:17], v[16:17], v[144:145], v[96:97]
  v_pk_fma_f32 v[18:19], v[18:19], v[146:147], v[98:99]
  v_pk_fma_f32 v[20:21], v[20:21], v[148:149], v[100:101]
  v_pk_fma_f32 v[22:23], v[22:23], v[150:151], v[102:103]
  v_pk_fma_f32 v[24:25], v[24:25], v[152:153], v[104:105]
  v_pk_fma_f32 v[26:27], v[26:27], v[154:155], v[106:107]
  v_pk_fma_f32 v[28:29], v[28:29], v[156:157], v[108:109]
  v_pk_fma_f32 v[30:31], v[30:31], v[158:159], v[110:111]
  v_cvt_pk_bf16_f32 v56, v16, v17
  v_cvt_pk_bf16_f32 v57, v18, v19
  v_cvt_pk_bf16_f32 v58, v20, v21
  v_cvt_pk_bf16_f32 v59, v22, v23
  v_cvt_pk_bf16_f32 v60, v24, v25
  v_cvt_pk_bf16_f32 v61, v26, v27
  v_cvt_pk_bf16_f32 v62, v28, v29
  v_cvt_pk_bf16_f32 v63, v30, v31
  buffer_store_dwordx4 v[56:59], v240, s[4:7], s98 offen offset:1024 sc1
  buffer_store_dwordx4 v[60:63], v240, s[4:7], s99 offen offset:1024 sc1
  s_mov_b32 s33, 262144
  s_waitcnt vmcnt(2)
  s_branch L_rchk_36
L_rl_34:
  s_mov_b32 s30, 9437184
  buffer_load_dwordx4 v[128:131], v225, s[4:7], s30 offen offset:0 sc1
  buffer_load_dwordx4 v[132:135], v225, s[4:7], s30 offen offset:2048 sc1
  s_mov_b32 s30, 9568256
  buffer_load_dwordx4 v[136:139], v225, s[4:7], s30 offen offset:0 sc1
  buffer_load_dwordx4 v[140:143], v225, s[4:7], s30 offen offset:2048 sc1
  s_mov_b32 s30, 9699328
  buffer_load_dwordx4 v[0:3], v225, s[4:7], s30 offen offset:0 sc1
  buffer_load_dwordx4 v[4:7], v225, s[4:7], s30 offen offset:2048 sc1
  s_mov_b32 s30, 9830400
  buffer_load_dwordx4 v[8:11], v225, s[4:7], s30 offen offset:0 sc1
  buffer_load_dwordx4 v[12:15], v225, s[4:7], s30 offen offset:2048 sc1
  s_waitcnt vmcnt(0)
L_rchk_36:
  v_max3_u32 v80, v128, v129, v130
  v_max_u32 v80, v80, v131
  v_max3_u32 v80, v80, v132, v133
  v_max3_u32 v80, v80, v134, v135
  v_max3_u32 v80, v80, v136, v137
  v_max3_u32 v80, v80, v138, v139
  v_max3_u32 v80, v80, v140, v141
  v_max3_u32 v80, v80, v142, v143
  v_max3_u32 v80, v80, v0, v1
  v_max3_u32 v80, v80, v2, v3
  v_max3_u32 v80, v80, v4, v5
  v_max3_u32 v80, v80, v6, v7
  v_max3_u32 v80, v80, v8, v9
  v_max3_u32 v80, v80, v10, v11
  v_max3_u32 v80, v80, v12, v13
  v_max3_u32 v80, v80, v14, v15
  v_cmp_eq_u32 s[68:69], -1, v80
  s_nop 1
  s_cmp_eq_u64 s[68:69], 0
  s_cbranch_scc1 L_rok_35
  s_sub_u32 s33, s33, 1
  s_cmp_lg_u32 s33, 0
  s_cbranch_scc1 L_rl_34
L_rok_35:
  v_accvgpr_write_b32 a128, v128
  v_accvgpr_write_b32 a129, v129
  v_accvgpr_write_b32 a130, v130
  v_accvgpr_write_b32 a131, v131
  v_accvgpr_write_b32 a136, v132
  v_accvgpr_write_b32 a137, v133
  v_accvgpr_write_b32 a138, v134
  v_accvgpr_write_b32 a139, v135
  v_accvgpr_write_b32 a144, v136
  v_accvgpr_write_b32 a145, v137
  v_accvgpr_write_b32 a146, v138
  v_accvgpr_write_b32 a147, v139
  v_accvgpr_write_b32 a152, v140
  v_accvgpr_write_b32 a153, v141
  v_accvgpr_write_b32 a154, v142
  v_accvgpr_write_b32 a155, v143
  v_accvgpr_write_b32 a160, v0
  v_accvgpr_write_b32 a161, v1
  v_accvgpr_write_b32 a162, v2
  v_accvgpr_write_b32 a163, v3
  v_accvgpr_write_b32 a168, v4
  v_accvgpr_write_b32 a169, v5
  v_accvgpr_write_b32 a170, v6
  v_accvgpr_write_b32 a171, v7
  v_accvgpr_write_b32 a176, v8
  v_accvgpr_write_b32 a177, v9
  v_accvgpr_write_b32 a178, v10
  v_accvgpr_write_b32 a179, v11
  v_accvgpr_write_b32 a184, v12
  v_accvgpr_write_b32 a185, v13
  v_accvgpr_write_b32 a186, v14
  v_accvgpr_write_b32 a187, v15
  s_waitcnt lgkmcnt(13)
  v_mfma_f32_16x16x32_bf16 v[0:3], a[196:199], a[128:131], 0
  v_mfma_f32_16x16x32_bf16 v[0:3], a[200:203], a[144:147], v[0:3]
  v_mfma_f32_16x16x32_bf16 v[32:35], a[196:199], a[136:139], 0
  ds_read_b64_tr_b16 a[196:197], v238 offset:8192
  v_mfma_f32_16x16x32_bf16 v[32:35], a[200:203], a[152:155], v[32:35]
  ds_read_b64_tr_b16 a[198:199], v238 offset:10240
  s_load_dwordx2 s[66:67], s[36:37], 0x0
  v_mfma_f32_16x16x32_bf16 v[36:39], a[204:207], a[136:139], 0
  ds_read_b64_tr_b16 a[200:201], v228 offset:20480
  v_mfma_f32_16x16x32_bf16 v[36:39], a[208:211], a[152:155], v[36:39]
  ds_read_b64_tr_b16 a[202:203], v228 offset:22528
  v_mfma_f32_16x16x32_bf16 v[4:7], a[204:207], a[128:131], 0
  ds_read_b64_tr_b16 a[204:205], v236 offset:12288
  v_mfma_f32_16x16x32_bf16 v[4:7], a[208:211], a[144:147], v[4:7]
  ds_read_b64_tr_b16 a[206:207], v236 offset:14336
  s_waitcnt lgkmcnt(13)
  v_mfma_f32_16x16x32_bf16 v[8:11], a[212:215], a[128:131], 0
  ds_read_b64_tr_b16 a[208:209], v229 offset:20480
  v_mfma_f32_16x16x32_bf16 v[8:11], a[216:219], a[144:147], v[8:11]
  ds_read_b64_tr_b16 a[210:211], v229 offset:22528
  v_mfma_f32_16x16x32_bf16 v[40:43], a[212:215], a[136:139], 0
  ds_read_b64_tr_b16 a[212:213], v237 offset:12288
  v_mfma_f32_16x16x32_bf16 v[40:43], a[216:219], a[152:155], v[40:43]
  ds_read_b64_tr_b16 a[214:215], v237 offset:14336
  v_mfma_f32_16x16x32_bf16 v[44:47], a[220:223], a[136:139], 0
  ds_read_b64_tr_b16 a[216:217], v230 offset:20480
  s_waitcnt lgkmcnt(13)
  v_mfma_f32_16x16x32_bf16 v[44:47], a[224:227], a[152:155], v[44:47]
  ds_read_b64_tr_b16 a[218:219], v230 offset:22528
  s_mov_b32 s41, 917504
  v_mfma_f32_16x16x32_bf16 v[12:15], a[220:223], a[128:131], 0
  ds_read_b64_tr_b16 a[220:221], v238 offset:12288
  s_add_u32 m0, s42, 110592
  v_mfma_f32_16x16x32_bf16 v[12:15], a[224:227], a[144:147], v[12:15]
  buffer_load_dwordx4 v227, s[12:15], s41 offen offset:0 lds
  s_waitcnt vmcnt(1)
  v_add_u32 v248, 0, v245
  buffer_store_dword v248, v246, s[4:7], s92 offen sc1
  v_mfma_f32_16x16x32_bf16 v[64:67], a[228:231], a[128:131], 0
  ds_read_b64_tr_b16 a[222:223], v238 offset:14336
  s_mov_b32 s41, 1146880
  v_mfma_f32_16x16x32_bf16 v[64:67], a[232:235], a[144:147], v[64:67]
  s_barrier
  v_mfma_f32_16x16x32_bf16 v[80:83], a[228:231], a[136:139], 0
  ds_read_b64_tr_b16 a[224:225], v231 offset:20480
  ds_read_b64_tr_b16 a[226:227], v231 offset:22528
  v_mfma_f32_16x16x32_bf16 v[80:83], a[232:235], a[152:155], v[80:83]
  ds_read_b64_tr_b16 a[228:229], v239 offset:12288
  s_add_u32 m0, s42, 126976
  s_waitcnt lgkmcnt(13)
  v_mfma_f32_16x16x32_bf16 v[84:87], a[192:195], a[136:139], 0
  buffer_load_dwordx4 v227, s[12:15], s41 offen offset:0 lds
  v_mfma_f32_16x16x32_bf16 v[84:87], a[196:199], a[152:155], v[84:87]
  ds_read_b64_tr_b16 a[230:231], v239 offset:14336
  ds_read_b64_tr_b16 a[232:233], v236 offset:24576
  v_mfma_f32_16x16x32_bf16 v[68:71], a[192:195], a[128:131], 0
  ds_read_b64_tr_b16 a[234:235], v236 offset:26624
  s_mov_b32 s41, 917504
  v_mfma_f32_16x16x32_bf16 v[68:71], a[196:199], a[144:147], v[68:71]
  ds_read_b64_tr_b16 a[192:193], v228 offset:36864
  s_add_u32 m0, s42, 122880
  v_mfma_f32_16x16x32_bf16 v[96:99], a[200:203], a[128:131], 0
  ds_read_b64_tr_b16 a[194:195], v228 offset:38912
  s_waitcnt lgkmcnt(13)
  v_mfma_f32_16x16x32_bf16 v[96:99], a[204:207], a[144:147], v[96:99]
  buffer_load_dwordx4 v227, s[16:19], s41 offen offset:0 lds
  s_load_dwordx2 s[66:67], s[36:37], 0x1ff80
  v_mfma_f32_16x16x32_bf16 v[160:163], a[200:203], a[136:139], 0
  ds_read_b64_tr_b16 a[196:197], v237 offset:24576
  ds_read_b64_tr_b16 a[198:199], v237 offset:26624
  v_mfma_f32_16x16x32_bf16 v[160:163], a[204:207], a[152:155], v[160:163]
  ds_read_b64_tr_b16 a[200:201], v229 offset:36864
  s_mov_b32 s41, 1146880
  v_mfma_f32_16x16x32_bf16 v[164:167], a[208:211], a[136:139], 0
  ds_read_b64_tr_b16 a[202:203], v229 offset:38912
  s_add_u32 m0, s42, 135168
  s_waitcnt lgkmcnt(13)
  v_mfma_f32_16x16x32_bf16 v[164:167], a[212:215], a[152:155], v[164:167]
  ds_read_b64_tr_b16 a[204:205], v238 offset:24576
  ds_read_b64_tr_b16 a[206:207], v238 offset:26624
  v_mfma_f32_16x16x32_bf16 v[100:103], a[208:211], a[128:131], 0
  ds_read_b64_tr_b16 a[208:209], v230 offset:36864
  v_mfma_f32_16x16x32_bf16 v[100:103], a[212:215], a[144:147], v[100:103]
  buffer_load_dwordx4 v227, s[16:19], s41 offen offset:0 lds
  v_mfma_f32_16x16x32_bf16 v[104:107], a[216:219], a[128:131], 0
  ds_read_b64_tr_b16 a[210:211], v230 offset:38912
  s_waitcnt lgkmcnt(13)
  v_mfma_f32_16x16x32_bf16 v[104:107], a[220:223], a[144:147], v[104:107]
  ds_read_b64_tr_b16 a[212:213], v239 offset:24576
  ds_read_b64_tr_b16 a[214:215], v239 offset:26624
  v_mfma_f32_16x16x32_bf16 v[168:171], a[216:219], a[136:139], 0
  ds_read_b64_tr_b16 a[216:217], v231 offset:36864
  v_mfma_f32_16x16x32_bf16 v[168:171], a[220:223], a[152:155], v[168:171]
  ds_read_b64_tr_b16 a[218:219], v231 offset:38912
  v_mfma_f32_16x16x32_bf16 v[172:175], a[224:227], a[136:139], 0
  ds_read_b64_tr_b16 a[220:221], v228 offset:53248
  s_waitcnt lgkmcnt(13)
  v_mfma_f32_16x16x32_bf16 v[172:175], a[228:231], a[152:155], v[172:175]
  ds_read_b64_tr_b16 a[222:223], v228 offset:55296
  v_mfma_f32_16x16x32_bf16 v[108:111], a[224:227], a[128:131], 0
  ds_read_b64_tr_b16 a[224:225], v228 offset:49152
  v_mfma_f32_16x16x32_bf16 v[108:111], a[228:231], a[144:147], v[108:111]
  ds_read_b64_tr_b16 a[226:227], v228 offset:51200
  s_mov_b32 s30, 9437184
  buffer_load_dwordx4 v[128:131], v225, s[4:7], s30 offen offset:1024 sc1
  v_mfma_f32_16x16x32_bf16 v[112:115], a[232:235], a[128:131], 0
  ds_read_b64_tr_b16 a[228:229], v229 offset:53248
  buffer_load_dwordx4 v[132:135], v225, s[4:7], s30 offen offset:3072 sc1
  s_mov_b32 s30, 9568256
  v_mfma_f32_16x16x32_bf16 v[112:115], a[192:195], a[144:147], v[112:115]
  ds_read_b64_tr_b16 a[230:231], v229 offset:55296
  s_mov_b32 s41, 917504
  buffer_load_dwordx4 v[136:139], v225, s[4:7], s30 offen offset:1024 sc1
  v_mfma_f32_16x16x32_bf16 v[176:179], a[232:235], a[136:139], 0
  ds_read_b64_tr_b16 a[232:233], v229 offset:49152
  s_add_u32 m0, s42, 151552
  buffer_load_dwordx4 v[140:143], v225, s[4:7], s30 offen offset:3072 sc1
  v_mfma_f32_16x16x32_bf16 v[176:179], a[192:195], a[152:155], v[176:179]
  ds_read_b64_tr_b16 a[234:235], v229 offset:51200
  s_mov_b32 s30, 9699328
  buffer_load_dwordx4 v[144:147], v225, s[4:7], s30 offen offset:1024 sc1
  s_waitcnt lgkmcnt(13)
  v_mfma_f32_16x16x32_bf16 v[180:183], a[196:199], a[136:139], 0
  ds_read_b64_tr_b16 a[192:193], v228 offset:61440
  buffer_load_dwordx4 v[148:151], v225, s[4:7], s30 offen offset:3072 sc1
  s_mov_b32 s30, 9830400
  v_mfma_f32_16x16x32_bf16 v[180:183], a[200:203], a[152:155], v[180:183]
  ds_read_b64_tr_b16 a[194:195], v228 offset:63488
  buffer_load_dwordx4 v[152:155], v225, s[4:7], s30 offen offset:1024 sc1
  v_mfma_f32_16x16x32_bf16 v[116:119], a[196:199], a[128:131], 0
  ds_read_b64_tr_b16 a[196:197], v232 offset:12288
  buffer_load_dwordx4 v[156:159], v225, s[4:7], s30 offen offset:3072 sc1
  v_mfma_f32_16x16x32_bf16 v[116:119], a[200:203], a[144:147], v[116:119]
  ds_read_b64_tr_b16 a[198:199], v232 offset:14336
  s_load_dwordx2 s[66:67], s[36:37], 0x3ff00
  v_mfma_f32_16x16x32_bf16 v[120:123], a[204:207], a[128:131], 0
  buffer_load_dwordx4 v226, s[12:15], s41 offen offset:0 lds
  s_waitcnt lgkmcnt(13)
  v_mfma_f32_16x16x32_bf16 v[120:123], a[208:211], a[144:147], v[120:123]
  ds_read_b64_tr_b16 a[200:201], v229 offset:61440
  ds_read_b64_tr_b16 a[202:203], v229 offset:63488
  v_mfma_f32_16x16x32_bf16 v[184:187], a[204:207], a[136:139], 0
  ds_read_b64_tr_b16 a[204:205], v233 offset:12288
  s_mov_b32 s41, 1146880
  v_mfma_f32_16x16x32_bf16 v[184:187], a[208:211], a[152:155], v[184:187]
  ds_read_b64_tr_b16 a[206:207], v233 offset:14336
  s_add_u32 m0, s42, 147456
  v_mfma_f32_16x16x32_bf16 v[188:191], a[212:215], a[136:139], 0
  ds_read_b64_tr_b16 a[208:209], v230 offset:53248
  s_waitcnt lgkmcnt(13)
  v_mfma_f32_16x16x32_bf16 v[188:191], a[216:219], a[152:155], v[188:191]
  buffer_load_dwordx4 v226, s[12:15], s41 offen offset:0 lds
  v_mfma_f32_16x16x32_bf16 v[124:127], a[212:215], a[128:131], 0
  ds_read_b64_tr_b16 a[210:211], v230 offset:55296
  v_mfma_f32_16x16x32_bf16 v[124:127], a[216:219], a[144:147], v[124:127]
  ds_read_b64_tr_b16 a[212:213], v230 offset:49152
  v_mfma_f32_16x16x32_bf16 v[0:3], a[220:223], a[160:163], v[0:3]
  ds_read_b64_tr_b16 a[214:215], v230 offset:51200
  v_mfma_f32_16x16x32_bf16 v[0:3], a[224:227], a[176:179], v[0:3]
  ds_read_b64_tr_b16 a[216:217], v230 offset:61440
  ds_read_b64_tr_b16 a[218:219], v230 offset:63488
  v_mfma_f32_16x16x32_bf16 v[32:35], a[220:223], a[168:171], v[32:35]
  ds_read_b64_tr_b16 a[220:221], v234 offset:12288
  v_mfma_f32_16x16x32_bf16 v[32:35], a[224:227], a[184:187], v[32:35]
  ds_read_b64_tr_b16 a[222:223], v234 offset:14336
  s_mov_b32 s78, 1572864
  s_waitcnt lgkmcnt(13)
  v_mfma_f32_16x16x32_bf16 v[36:39], a[228:231], a[168:171], v[36:39]
  ds_read_b64_tr_b16 a[224:225], v232 offset:8192
  v_mfma_f32_16x16x32_bf16 v[36:39], a[232:235], a[184:187], v[36:39]
  ds_read_b64_tr_b16 a[226:227], v232 offset:10240
  v_mfma_f32_16x16x32_bf16 v[4:7], a[228:231], a[160:163], v[4:7]
  ds_read_b64_tr_b16 a[228:229], v232 offset:20480
  v_mfma_f32_16x16x32_bf16 v[4:7], a[232:235], a[176:179], v[4:7]
  ds_read_b64_tr_b16 a[230:231], v232 offset:22528
  v_mfma_f32_16x16x32_bf16 v[8:11], a[192:195], a[160:163], v[8:11]
  ds_read_b64_tr_b16 a[232:233], v233 offset:8192
  s_waitcnt lgkmcnt(13)
  v_mfma_f32_16x16x32_bf16 v[8:11], a[196:199], a[176:179], v[8:11]
  ds_read_b64_tr_b16 a[234:235], v233 offset:10240
  v_mfma_f32_16x16x32_bf16 v[40:43], a[192:195], a[168:171], v[40:43]
  ds_read_b64_tr_b16 a[192:193], v233 offset:20480
  v_mfma_f32_16x16x32_bf16 v[40:43], a[196:199], a[184:187], v[40:43]
  ds_read_b64_tr_b16 a[194:195], v233 offset:22528
  v_mfma_f32_16x16x32_bf16 v[44:47], a[200:203], a[168:171], v[44:47]
  ds_read_b64_tr_b16 a[196:197], v234 offset:8192
  v_mfma_f32_16x16x32_bf16 v[44:47], a[204:207], a[184:187], v[44:47]
  ds_read_b64_tr_b16 a[198:199], v234 offset:10240
  s_load_dwordx2 s[66:67], s[36:37], 0x5fe80
  v_mfma_f32_16x16x32_bf16 v[12:15], a[200:203], a[160:163], v[12:15]
  ds_read_b64_tr_b16 a[200:201], v234 offset:20480
  v_mfma_f32_16x16x32_bf16 v[12:15], a[204:207], a[176:179], v[12:15]
  ds_read_b64_tr_b16 a[202:203], v234 offset:22528
  s_waitcnt lgkmcnt(13)
  v_mfma_f32_16x16x32_bf16 v[64:67], a[208:211], a[160:163], v[64:67]
  ds_read_b64_tr_b16 a[204:205], v235 offset:8192
  v_mfma_f32_16x16x32_bf16 v[64:67], a[212:215], a[176:179], v[64:67]
  s_barrier
  v_mfma_f32_16x16x32_bf16 v[80:83], a[208:211], a[168:171], v[80:83]
  ds_read_b64_tr_b16 a[206:207], v235 offset:10240
  s_mov_b32 s41, 917504
  v_mfma_f32_16x16x32_bf16 v[80:83], a[212:215], a[184:187], v[80:83]
  ds_read_b64_tr_b16 a[208:209], v235 offset:20480
  s_add_u32 m0, s42, 159744
  v_mfma_f32_16x16x32_bf16 v[84:87], a[216:219], a[168:171], v[84:87]
  buffer_load_dwordx4 v226, s[16:19], s41 offen offset:0 lds
  s_waitcnt lgkmcnt(13)
  v_mfma_f32_16x16x32_bf16 v[84:87], a[220:223], a[184:187], v[84:87]
  ds_read_b64_tr_b16 a[210:211], v235 offset:22528
  ds_read_b64_tr_b16 a[212:213], v232 offset:36864
  v_mfma_f32_16x16x32_bf16 v[68:71], a[216:219], a[160:163], v[68:71]
  ds_read_b64_tr_b16 a[214:215], v232 offset:38912
  v_mfma_f32_16x16x32_bf16 v[68:71], a[220:223], a[176:179], v[68:71]
  ds_read_b64_tr_b16 a[216:217], v232 offset:32768
  v_mfma_f32_16x16x32_bf16 v[96:99], a[224:227], a[160:163], v[96:99]
  ds_read_b64_tr_b16 a[218:219], v232 offset:34816
  s_mov_b32 s41, 1146880
  s_waitcnt lgkmcnt(13)
  v_mfma_f32_16x16x32_bf16 v[96:99], a[228:231], a[176:179], v[96:99]
  ds_read_b64_tr_b16 a[220:221], v233 offset:36864
  ds_read_b64_tr_b16 a[222:223], v233 offset:38912
  v_mfma_f32_16x16x32_bf16 v[160:163], a[224:227], a[168:171], v[160:163]
  ds_read_b64_tr_b16 a[224:225], v233 offset:32768
  s_add_u32 m0, s42, 16384
  s_waitcnt vmcnt(3)
  v_max3_u32 v244, v128, v129, v130
  v_mfma_f32_16x16x32_bf16 v[160:163], a[228:231], a[184:187], v[160:163]
  buffer_load_dwordx4 v226, s[16:19], s41 offen offset:0 lds
  v_max_u32 v244, v244, v131
  v_max3_u32 v244, v244, v132, v133
  v_mfma_f32_16x16x32_bf16 v[164:167], a[232:235], a[168:171], v[164:167]
  ds_read_b64_tr_b16 a[226:227], v233 offset:34816
  v_max3_u32 v244, v244, v134, v135
  v_max3_u32 v244, v244, v136, v137
  v_max3_u32 v244, v244, v138, v139
  s_waitcnt lgkmcnt(13)
  v_mfma_f32_16x16x32_bf16 v[164:167], a[192:195], a[184:187], v[164:167]
  ds_read_b64_tr_b16 a[228:229], v234 offset:36864
  ds_read_b64_tr_b16 a[230:231], v234 offset:38912
  v_max3_u32 v244, v244, v140, v141
  v_max3_u32 v244, v244, v142, v143
  v_mfma_f32_16x16x32_bf16 v[100:103], a[232:235], a[160:163], v[100:103]
  ds_read_b64_tr_b16 a[232:233], v234 offset:32768
  v_max3_u32 v244, v244, v144, v145
  v_max3_u32 v244, v244, v146, v147
  v_max3_u32 v244, v244, v148, v149
  v_mfma_f32_16x16x32_bf16 v[100:103], a[192:195], a[176:179], v[100:103]
  ds_read_b64_tr_b16 a[234:235], v234 offset:34816
  v_max3_u32 v244, v244, v150, v151
  v_max3_u32 v244, v244, v152, v153
  v_max3_u32 v244, v244, v154, v155
  v_mfma_f32_16x16x32_bf16 v[104:107], a[196:199], a[160:163], v[104:107]
  ds_read_b64_tr_b16 a[192:193], v235 offset:36864
  v_max3_u32 v244, v244, v156, v157
  v_max3_u32 v244, v244, v158, v159
  v_cmp_eq_u32 s[68:69], -1, v244
  s_waitcnt lgkmcnt(13)
  v_mfma_f32_16x16x32_bf16 v[104:107], a[200:203], a[176:179], v[104:107]
  ds_read_b64_tr_b16 a[194:195], v235 offset:38912
  s_cmp_lg_u64 s[68:69], 0
  s_cbranch_scc1 L_slow_37
L_back_38:
  v_accvgpr_write_b32 a132, v128
  v_mfma_f32_16x16x32_bf16 v[168:171], a[196:199], a[168:171], v[168:171]
  ds_read_b64_tr_b16 a[196:197], v235 offset:32768
  v_accvgpr_write_b32 a133, v129
  v_accvgpr_write_b32 a134, v130
  v_accvgpr_write_b32 a135, v131
  v_mfma_f32_16x16x32_bf16 v[168:171], a[200:203], a[184:187], v[168:171]
  ds_read_b64_tr_b16 a[198:199], v235 offset:34816
  s_load_dwordx2 s[66:67], s[36:37], 0x7fe00
  v_accvgpr_write_b32 a140, v132
  v_accvgpr_write_b32 a141, v133
  v_mfma_f32_16x16x32_bf16 v[172:175], a[204:207], a[168:171], v[172:175]
  ds_read_b64_tr_b16 a[200:201], v232 offset:24576
  v_accvgpr_write_b32 a142, v134
  v_accvgpr_write_b32 a143, v135
  v_accvgpr_write_b32 a148, v136
  v_mfma_f32_16x16x32_bf16 v[172:175], a[208:211], a[184:187], v[172:175]
  ds_read_b64_tr_b16 a[202:203], v232 offset:26624
  v_accvgpr_write_b32 a149, v137
  v_accvgpr_write_b32 a150, v138
  v_accvgpr_write_b32 a151, v139
  v_mfma_f32_16x16x32_bf16 v[108:111], a[204:207], a[160:163], v[108:111]
  ds_read_b64_tr_b16 a[204:205], v232 offset:53248
  v_accvgpr_write_b32 a156, v140
  v_accvgpr_write_b32 a157, v141
  v_accvgpr_write_b32 a158, v142
  v_mfma_f32_16x16x32_bf16 v[108:111], a[208:211], a[176:179], v[108:111]
  ds_read_b64_tr_b16 a[206:207], v232 offset:55296
  v_accvgpr_write_b32 a159, v143
  v_accvgpr_write_b32 a164, v144
  v_accvgpr_write_b32 a165, v145
  s_waitcnt lgkmcnt(13)
  v_mfma_f32_16x16x32_bf16 v[112:115], a[212:215], a[160:163], v[112:115]
  ds_read_b64_tr_b16 a[208:209], v233 offset:24576
  v_accvgpr_write_b32 a166, v146
  v_accvgpr_write_b32 a167, v147
  v_accvgpr_write_b32 a172, v148
  v_mfma_f32_16x16x32_bf16 v[112:115], a[216:219], a[176:179], v[112:115]
  ds_read_b64_tr_b16 a[210:211], v233 offset:26624
  v_accvgpr_write_b32 a173, v149
  v_accvgpr_write_b32 a174, v150
  v_accvgpr_write_b32 a175, v151
  v_mfma_f32_16x16x32_bf16 v[176:179], a[212:215], a[168:171], v[176:179]
  ds_read_b64_tr_b16 a[212:213], v233 offset:53248
  v_accvgpr_write_b32 a180, v152
  v_accvgpr_write_b32 a181, v153
  v_accvgpr_write_b32 a182, v154
  v_mfma_f32_16x16x32_bf16 v[176:179], a[216:219], a[184:187], v[176:179]
  ds_read_b64_tr_b16 a[214:215], v233 offset:55296
  v_accvgpr_write_b32 a183, v155
  v_accvgpr_write_b32 a188, v156
  v_accvgpr_write_b32 a189, v157
  v_mfma_f32_16x16x32_bf16 v[180:183], a[220:223], a[168:171], v[180:183]
  ds_read_b64_tr_b16 a[216:217], v236 offset:0
  v_accvgpr_write_b32 a190, v158
  v_accvgpr_write_b32 a191, v159
  s_waitcnt lgkmcnt(13)
  v_mfma_f32_16x16x32_bf16 v[180:183], a[224:227], a[184:187], v[180:183]
  ds_read_b64_tr_b16 a[218:219], v236 offset:2048
  v_mfma_f32_16x16x32_bf16 v[116:119], a[220:223], a[160:163], v[116:119]
  ds_read_b64_tr_b16 a[220:221], v236 offset:8192
  v_mfma_f32_16x16x32_bf16 v[116:119], a[224:227], a[176:179], v[116:119]
  ds_read_b64_tr_b16 a[222:223], v236 offset:10240
  v_mfma_f32_16x16x32_bf16 v[120:123], a[228:231], a[160:163], v[120:123]
  ds_read_b64_tr_b16 a[224:225], v237 offset:0
  v_mfma_f32_16x16x32_bf16 v[120:123], a[232:235], a[176:179], v[120:123]
  ds_read_b64_tr_b16 a[226:227], v237 offset:2048
  s_mov_b32 s41, 1376256
  v_mfma_f32_16x16x32_bf16 v[184:187], a[228:231], a[168:171], v[184:187]
  ds_read_b64_tr_b16 a[228:229], v237 offset:8192
  s_add_u32 m0, s42, 12288
  v_mfma_f32_16x16x32_bf16 v[184:187], a[232:235], a[184:187], v[184:187]
  buffer_load_dwordx4 v227, s[12:15], s41 offen offset:0 lds
  s_waitcnt lgkmcnt(13)
  v_mfma_f32_16x16x32_bf16 v[188:191], a[192:195], a[168:171], v[188:191]
  ds_read_b64_tr_b16 a[230:231], v237 offset:10240
  v_mfma_f32_16x16x32_bf16 v[188:191], a[196:199], a[184:187], v[188:191]
  ds_read_b64_tr_b16 a[232:233], v234 offset:24576
  ds_read_b64_tr_b16 a[234:235], v234 offset:26624
  v_mfma_f32_16x16x32_bf16 v[124:127], a[192:195], a[160:163], v[124:127]
  ds_read_b64_tr_b16 a[192:193], v234 offset:53248
  v_mfma_f32_16x16x32_bf16 v[124:127], a[196:199], a[176:179], v[124:127]
  ds_read_b64_tr_b16 a[194:195], v234 offset:55296
  v_mfma_f32_16x16x32_bf16 v[16:19], a[200:203], a[132:135], 0
  ds_read_b64_tr_b16 a[196:197], v238 offset:0
  s_mov_b32 s41, 1605632
  s_waitcnt lgkmcnt(13)
  v_mfma_f32_16x16x32_bf16 v[16:19], a[204:207], a[148:151], v[16:19]
  ds_read_b64_tr_b16 a[198:199], v238 offset:2048
  s_add_u32 m0, s42, 24576
  s_load_dwordx2 s[66:67], s[36:37], 0x9fd80
  v_mfma_f32_16x16x32_bf16 v[48:51], a[200:203], a[140:143], 0
  buffer_load_dwordx4 v227, s[12:15], s41 offen offset:0 lds
  v_mfma_f32_16x16x32_bf16 v[48:51], a[204:207], a[156:159], v[48:51]
  ds_read_b64_tr_b16 a[200:201], v238 offset:8192
  v_mfma_f32_16x16x32_bf16 v[52:55], a[208:211], a[140:143], 0
  ds_read_b64_tr_b16 a[202:203], v238 offset:10240
  v_mfma_f32_16x16x32_bf16 v[52:55], a[212:215], a[156:159], v[52:55]
  ds_read_b64_tr_b16 a[204:205], v228 offset:20480
  ds_read_b64_tr_b16 a[206:207], v228 offset:22528
  v_mfma_f32_16x16x32_bf16 v[20:23], a[208:211], a[132:135], 0
  ds_read_b64_tr_b16 a[208:209], v236 offset:12288
  v_mfma_f32_16x16x32_bf16 v[20:23], a[212:215], a[148:151], v[20:23]
  ds_read_b64_tr_b16 a[210:211], v236 offset:14336
  s_waitcnt lgkmcnt(13)
  v_mfma_f32_16x16x32_bf16 v[24:27], a[216:219], a[132:135], 0
  ds_read_b64_tr_b16 a[212:213], v229 offset:20480
  v_mfma_f32_16x16x32_bf16 v[24:27], a[220:223], a[148:151], v[24:27]
  ds_read_b64_tr_b16 a[214:215], v229 offset:22528
  s_mov_b32 s41, 1376256
  v_mfma_f32_16x16x32_bf16 v[56:59], a[216:219], a[140:143], 0
  ds_read_b64_tr_b16 a[216:217], v237 offset:12288
  s_add_u32 m0, s42, 45056
  v_mfma_f32_16x16x32_bf16 v[56:59], a[220:223], a[156:159], v[56:59]
  buffer_load_dwordx4 v227, s[16:19], s41 offen offset:0 lds
  buffer_load_dword v244, v254, s[4:7], s93 offen sc1
  v_mfma_f32_16x16x32_bf16 v[60:63], a[224:227], a[140:143], 0
  ds_read_b64_tr_b16 a[218:219], v237 offset:14336
  s_waitcnt lgkmcnt(13)
  v_mfma_f32_16x16x32_bf16 v[60:63], a[228:231], a[156:159], v[60:63]
  ds_read_b64_tr_b16 a[220:221], v230 offset:20480
  ds_read_b64_tr_b16 a[222:223], v230 offset:22528
  v_mfma_f32_16x16x32_bf16 v[28:31], a[224:227], a[132:135], 0
  ds_read_b64_tr_b16 a[224:225], v238 offset:12288
  v_mfma_f32_16x16x32_bf16 v[28:31], a[228:231], a[148:151], v[28:31]
  ds_read_b64_tr_b16 a[226:227], v238 offset:14336
  v_mfma_f32_16x16x32_bf16 v[72:75], a[232:235], a[132:135], 0
  ds_read_b64_tr_b16 a[228:229], v231 offset:20480
  s_mov_b32 s41, 1605632
  s_waitcnt lgkmcnt(13)
  v_mfma_f32_16x16x32_bf16 v[72:75], a[192:195], a[148:151], v[72:75]
  s_barrier
  v_mfma_f32_16x16x32_bf16 v[88:91], a[232:235], a[140:143], 0
  ds_read_b64_tr_b16 a[230:231], v231 offset:22528
  s_add_u32 m0, s42, 57344
  v_mfma_f32_16x16x32_bf16 v[88:91], a[192:195], a[156:159], v[88:91]
  buffer_load_dwordx4 v227, s[16:19], s41 offen offset:0 lds
  v_mfma_f32_16x16x32_bf16 v[92:95], a[196:199], a[140:143], 0
  ds_read_b64_tr_b16 a[232:233], v239 offset:12288
L_wk1_1:
  s_cbranch_vccnz L_wk1_5
  ds_read_b64_tr_b16 a[234:235], v239 offset:14336
  v_mfma_f32_16x16x32_bf16 v[92:95], a[200:203], a[156:159], v[92:95]
  ds_read_b64_tr_b16 a[192:193], v236 offset:24576
  ds_read_b64_tr_b16 a[194:195], v236 offset:26624
  v_mfma_f32_16x16x32_bf16 v[76:79], a[196:199], a[132:135], 0
  ds_read_b64_tr_b16 a[196:197], v228 offset:36864
  v_mfma_f32_16x16x32_bf16 v[76:79], a[200:203], a[148:151], v[76:79]
  ds_read_b64_tr_b16 a[198:199], v228 offset:38912
  s_load_dwordx2 s[66:67], s[36:37], 0xbfd00
  s_waitcnt lgkmcnt(13)
  v_mfma_f32_16x16x32_bf16 v[128:131], a[204:207], a[132:135], 0
  ds_read_b64_tr_b16 a[200:201], v237 offset:24576
  v_mfma_f32_16x16x32_bf16 v[128:131], a[208:211], a[148:151], v[128:131]
  ds_read_b64_tr_b16 a[202:203], v237 offset:26624
  v_mfma_f32_16x16x32_bf16 v[192:195], a[204:207], a[140:143], 0
  ds_read_b64_tr_b16 a[204:205], v229 offset:36864
  v_mfma_f32_16x16x32_bf16 v[192:195], a[208:211], a[156:159], v[192:195]
  ds_read_b64_tr_b16 a[206:207], v229 offset:38912
  v_mfma_f32_16x16x32_bf16 v[196:199], a[212:215], a[140:143], 0
  ds_read_b64_tr_b16 a[208:209], v238 offset:24576
  s_waitcnt lgkmcnt(13)
  v_mfma_f32_16x16x32_bf16 v[196:199], a[216:219], a[156:159], v[196:199]
  ds_read_b64_tr_b16 a[210:211], v238 offset:26624
  v_mfma_f32_16x16x32_bf16 v[132:135], a[212:215], a[132:135], 0
  ds_read_b64_tr_b16 a[212:213], v230 offset:36864
  v_mfma_f32_16x16x32_bf16 v[132:135], a[216:219], a[148:151], v[132:135]
  ds_read_b64_tr_b16 a[214:215], v230 offset:38912
  v_mfma_f32_16x16x32_bf16 v[136:139], a[220:223], a[132:135], 0
  ds_read_b64_tr_b16 a[216:217], v239 offset:24576
  v_mfma_f32_16x16x32_bf16 v[136:139], a[224:227], a[148:151], v[136:139]
  ds_read_b64_tr_b16 a[218:219], v239 offset:26624
  v_mfma_f32_16x16x32_bf16 v[200:203], a[220:223], a[140:143], 0
  ds_read_b64_tr_b16 a[220:221], v231 offset:36864
  v_mfma_f32_16x16x32_bf16 v[200:203], a[224:227], a[156:159], v[200:203]
  ds_read_b64_tr_b16 a[222:223], v231 offset:38912
  s_waitcnt lgkmcnt(13)
  v_mfma_f32_16x16x32_bf16 v[204:207], a[228:231], a[140:143], 0
  ds_read_b64_tr_b16 a[224:225], v228 offset:53248
  v_mfma_f32_16x16x32_bf16 v[204:207], a[232:235], a[156:159], v[204:207]
  ds_read_b64_tr_b16 a[226:227], v228 offset:55296
  v_mfma_f32_16x16x32_bf16 v[140:143], a[228:231], a[132:135], 0
  ds_read_b64_tr_b16 a[228:229], v228 offset:49152
  v_mfma_f32_16x16x32_bf16 v[140:143], a[232:235], a[148:151], v[140:143]
  ds_read_b64_tr_b16 a[230:231], v228 offset:51200
  v_mfma_f32_16x16x32_bf16 v[144:147], a[192:195], a[132:135], 0
  ds_read_b64_tr_b16 a[232:233], v229 offset:53248
  s_waitcnt lgkmcnt(13)
  v_mfma_f32_16x16x32_bf16 v[144:147], a[196:199], a[148:151], v[144:147]
  ds_read_b64_tr_b16 a[234:235], v229 offset:55296
  s_mov_b32 s41, 1376256
  v_mfma_f32_16x16x32_bf16 v[208:211], a[192:195], a[140:143], 0
  ds_read_b64_tr_b16 a[192:193], v229 offset:49152
  s_add_u32 m0, s42, 65536
  v_mfma_f32_16x16x32_bf16 v[208:211], a[196:199], a[156:159], v[208:211]
  buffer_load_dwordx4 v226, s[12:15], s41 offen offset:0 lds
  v_mfma_f32_16x16x32_bf16 v[212:215], a[200:203], a[140:143], 0
  ds_read_b64_tr_b16 a[194:195], v229 offset:51200
  v_mfma_f32_16x16x32_bf16 v[212:215], a[204:207], a[156:159], v[212:215]
  ds_read_b64_tr_b16 a[196:197], v228 offset:61440
  ds_read_b64_tr_b16 a[198:199], v228 offset:63488
  s_load_dwordx2 s[66:67], s[36:37], 0xdfc80
  s_add_u32 s36, s36, 0xffc00
  s_addc_u32 s37, s37, 0
  v_mfma_f32_16x16x32_bf16 v[148:151], a[200:203], a[132:135], 0
  ds_read_b64_tr_b16 a[200:201], v232 offset:12288
  v_mfma_f32_16x16x32_bf16 v[148:151], a[204:207], a[148:151], v[148:151]
  ds_read_b64_tr_b16 a[202:203], v232 offset:14336
  s_waitcnt vmcnt(2)
  v_subrev_u32 v244, s100, v244
  v_cmp_lt_u32 s[68:69], 7, v244
  s_waitcnt lgkmcnt(13)
  v_mfma_f32_16x16x32_bf16 v[152:155], a[208:211], a[132:135], 0
  ds_read_b64_tr_b16 a[204:205], v229 offset:61440
  s_mov_b32 s41, 1605632
  s_cmp_lg_u64 s[68:69], 0
  s_cbranch_scc1 L_slow_39
L_back_40:
  v_mfma_f32_16x16x32_bf16 v[152:155], a[212:215], a[148:151], v[152:155]
  ds_read_b64_tr_b16 a[206:207], v229 offset:63488
  s_add_u32 m0, s42, 94208
  v_mfma_f32_16x16x32_bf16 v[216:219], a[208:211], a[140:143], 0
  buffer_load_dwordx4 v226, s[12:15], s41 offen offset:0 lds
  v_mfma_f32_16x16x32_bf16 v[216:219], a[212:215], a[156:159], v[216:219]
  ds_read_b64_tr_b16 a[208:209], v233 offset:12288
  s_mov_b32 s40, 9961472
  v_mfma_f32_16x16x32_bf16 v[220:223], a[216:219], a[140:143], 0
  buffer_load_dwordx4 a[0:3], v225, s[4:7], s40 offen offset:0 sc1
  s_waitcnt lgkmcnt(13)
  v_mfma_f32_16x16x32_bf16 v[220:223], a[220:223], a[156:159], v[220:223]
  ds_read_b64_tr_b16 a[210:211], v233 offset:14336
  ds_read_b64_tr_b16 a[212:213], v230 offset:53248
  v_mfma_f32_16x16x32_bf16 v[156:159], a[216:219], a[132:135], 0
  buffer_load_dwordx4 a[4:7], v225, s[4:7], s40 offen offset:1024 sc1
  v_mfma_f32_16x16x32_bf16 v[156:159], a[220:223], a[148:151], v[156:159]
  ds_read_b64_tr_b16 a[214:215], v230 offset:55296
  v_mfma_f32_16x16x32_bf16 v[16:19], a[224:227], a[164:167], v[16:19]
  buffer_load_dwordx4 a[8:11], v225, s[4:7], s40 offen offset:2048 sc1
  s_waitcnt lgkmcnt(13)
  v_mfma_f32_16x16x32_bf16 v[16:19], a[228:231], a[180:183], v[16:19]
  ds_read_b64_tr_b16 a[216:217], v230 offset:49152
  ds_read_b64_tr_b16 a[218:219], v230 offset:51200
  v_mfma_f32_16x16x32_bf16 v[48:51], a[224:227], a[172:175], v[48:51]
  buffer_load_dwordx4 a[12:15], v225, s[4:7], s40 offen offset:3072 sc1
  v_mfma_f32_16x16x32_bf16 v[48:51], a[228:231], a[188:191], v[48:51]
  ds_read_b64_tr_b16 a[220:221], v230 offset:61440
  ds_read_b64_tr_b16 a[222:223], v230 offset:63488
  s_waitcnt lgkmcnt(13)
  v_mfma_f32_16x16x32_bf16 v[52:55], a[232:235], a[172:175], v[52:55]
  ds_read_b64_tr_b16 a[224:225], v234 offset:12288
  ds_read_b64_tr_b16 a[226:227], v234 offset:14336
  v_mfma_f32_16x16x32_bf16 v[52:55], a[192:195], a[188:191], v[52:55]
  ds_read_b64_tr_b16 a[228:229], v232 offset:8192
  ds_read_b64_tr_b16 a[230:231], v232 offset:10240
  v_mfma_f32_16x16x32_bf16 v[20:23], a[232:235], a[164:167], v[20:23]
  ds_read_b64_tr_b16 a[232:233], v232 offset:20480
  s_mov_b32 s40, 10092544
  v_mfma_f32_16x16x32_bf16 v[20:23], a[192:195], a[180:183], v[20:23]
  buffer_load_dwordx4 a[16:19], v225, s[4:7], s40 offen offset:0 sc1
  s_waitcnt lgkmcnt(13)
  v_mfma_f32_16x16x32_bf16 v[24:27], a[196:199], a[164:167], v[24:27]
  ds_read_b64_tr_b16 a[234:235], v232 offset:22528
  v_mfma_f32_16x16x32_bf16 v[24:27], a[200:203], a[180:183], v[24:27]
  buffer_load_dwordx4 a[20:23], v225, s[4:7], s40 offen offset:1024 sc1
  v_mfma_f32_16x16x32_bf16 v[56:59], a[196:199], a[172:175], v[56:59]
  ds_read_b64_tr_b16 a[192:193], v233 offset:8192
  ds_read_b64_tr_b16 a[194:195], v233 offset:10240
  v_mfma_f32_16x16x32_bf16 v[56:59], a[200:203], a[188:191], v[56:59]
  buffer_load_dwordx4 a[24:27], v225, s[4:7], s40 offen offset:2048 sc1
  s_load_dwordx2 s[66:67], s[36:37], 0x0
  v_mfma_f32_16x16x32_bf16 v[60:63], a[204:207], a[172:175], v[60:63]
  ds_read_b64_tr_b16 a[196:197], v233 offset:20480
  ds_read_b64_tr_b16 a[198:199], v233 offset:22528
  s_waitcnt lgkmcnt(13)
  v_mfma_f32_16x16x32_bf16 v[60:63], a[208:211], a[188:191], v[60:63]
  buffer_load_dwordx4 a[28:31], v225, s[4:7], s40 offen offset:3072 sc1
  v_mfma_f32_16x16x32_bf16 v[28:31], a[204:207], a[164:167], v[28:31]
  ds_read_b64_tr_b16 a[200:201], v234 offset:8192
  ds_read_b64_tr_b16 a[202:203], v234 offset:10240
  v_mfma_f32_16x16x32_bf16 v[28:31], a[208:211], a[180:183], v[28:31]
  ds_read_b64_tr_b16 a[204:205], v234 offset:20480
  s_mov_b32 s40, 10223616
  v_mfma_f32_16x16x32_bf16 v[72:75], a[212:215], a[164:167], v[72:75]
  ds_read_b64_tr_b16 a[206:207], v234 offset:22528
  s_waitcnt lgkmcnt(13)
  v_mfma_f32_16x16x32_bf16 v[72:75], a[216:219], a[180:183], v[72:75]
  s_barrier
  v_mfma_f32_16x16x32_bf16 v[88:91], a[212:215], a[172:175], v[88:91]
  ds_read_b64_tr_b16 a[208:209], v235 offset:8192
  ds_read_b64_tr_b16 a[210:211], v235 offset:10240
  v_mfma_f32_16x16x32_bf16 v[88:91], a[216:219], a[188:191], v[88:91]
  ds_read_b64_tr_b16 a[212:213], v235 offset:20480
  v_mfma_f32_16x16x32_bf16 v[92:95], a[220:223], a[172:175], v[92:95]
  buffer_load_dwordx4 a[32:35], v225, s[4:7], s40 offen offset:0 sc1
  s_waitcnt lgkmcnt(13)
  v_mfma_f32_16x16x32_bf16 v[92:95], a[224:227], a[188:191], v[92:95]
  ds_read_b64_tr_b16 a[214:215], v235 offset:22528
  ds_read_b64_tr_b16 a[216:217], v232 offset:36864
  v_mfma_f32_16x16x32_bf16 v[76:79], a[220:223], a[164:167], v[76:79]
  ds_read_b64_tr_b16 a[218:219], v232 offset:38912
  v_mfma_f32_16x16x32_bf16 v[76:79], a[224:227], a[180:183], v[76:79]
  ds_read_b64_tr_b16 a[220:221], v232 offset:32768
  v_mfma_f32_16x16x32_bf16 v[128:131], a[228:231], a[164:167], v[128:131]
  ds_read_b64_tr_b16 a[222:223], v232 offset:34816
  s_waitcnt lgkmcnt(13)
  v_mfma_f32_16x16x32_bf16 v[128:131], a[232:235], a[180:183], v[128:131]
  buffer_load_dwordx4 a[36:39], v225, s[4:7], s40 offen offset:1024 sc1
  v_mfma_f32_16x16x32_bf16 v[192:195], a[228:231], a[172:175], v[192:195]
  ds_read_b64_tr_b16 a[224:225], v233 offset:36864
  ds_read_b64_tr_b16 a[226:227], v233 offset:38912
  v_mfma_f32_16x16x32_bf16 v[192:195], a[232:235], a[188:191], v[192:195]
  ds_read_b64_tr_b16 a[228:229], v233 offset:32768
  v_mfma_f32_16x16x32_bf16 v[196:199], a[192:195], a[172:175], v[196:199]
  ds_read_b64_tr_b16 a[230:231], v233 offset:34816
  s_waitcnt lgkmcnt(13)
  v_mfma_f32_16x16x32_bf16 v[196:199], a[196:199], a[188:191], v[196:199]
  ds_read_b64_tr_b16 a[232:233], v234 offset:36864
  ds_read_b64_tr_b16 a[234:235], v234 offset:38912
  v_mfma_f32_16x16x32_bf16 v[132:135], a[192:195], a[164:167], v[132:135]
  ds_read_b64_tr_b16 a[192:193], v234 offset:32768
  v_mfma_f32_16x16x32_bf16 v[132:135], a[196:199], a[180:183], v[132:135]
  buffer_load_dwordx4 a[40:43], v225, s[4:7], s40 offen offset:2048 sc1
  v_mfma_f32_16x16x32_bf16 v[136:139], a[200:203], a[164:167], v[136:139]
  ds_read_b64_tr_b16 a[194:195], v234 offset:34816
  s_waitcnt lgkmcnt(13)
  v_mfma_f32_16x16x32_bf16 v[136:139], a[204:207], a[180:183], v[136:139]
  ds_read_b64_tr_b16 a[196:197], v235 offset:36864
  ds_read_b64_tr_b16 a[198:199], v235 offset:38912
  s_load_dwordx2 s[66:67], s[36:37], 0x1ff80
  v_mfma_f32_16x16x32_bf16 v[200:203], a[200:203], a[172:175], v[200:203]
  ds_read_b64_tr_b16 a[200:201], v235 offset:32768
  v_mfma_f32_16x16x32_bf16 v[200:203], a[204:207], a[188:191], v[200:203]
  ds_read_b64_tr_b16 a[202:203], v235 offset:34816
  v_mfma_f32_16x16x32_bf16 v[204:207], a[208:211], a[172:175], v[204:207]
  buffer_load_dwordx4 a[44:47], v225, s[4:7], s40 offen offset:3072 sc1
  s_waitcnt lgkmcnt(13)
  v_mfma_f32_16x16x32_bf16 v[204:207], a[212:215], a[188:191], v[204:207]
  ds_read_b64_tr_b16 a[204:205], v232 offset:45056
  ds_read_b64_tr_b16 a[206:207], v232 offset:47104
  v_mfma_f32_16x16x32_bf16 v[140:143], a[208:211], a[164:167], v[140:143]
  ds_read_b64_tr_b16 a[208:209], v232 offset:61440
  s_mov_b32 s40, 10354688
  v_mfma_f32_16x16x32_bf16 v[140:143], a[212:215], a[180:183], v[140:143]
  ds_read_b64_tr_b16 a[210:211], v232 offset:63488
  v_mfma_f32_16x16x32_bf16 v[144:147], a[216:219], a[164:167], v[144:147]
  ds_read_b64_tr_b16 a[212:213], v233 offset:45056
  s_waitcnt lgkmcnt(13)
  v_mfma_f32_16x16x32_bf16 v[144:147], a[220:223], a[180:183], v[144:147]
  ds_read_b64_tr_b16 a[214:215], v233 offset:47104
  v_mfma_f32_16x16x32_bf16 v[208:211], a[216:219], a[172:175], v[208:211]
  buffer_load_dwordx4 a[48:51], v225, s[4:7], s40 offen offset:0 sc1
  v_mfma_f32_16x16x32_bf16 v[208:211], a[220:223], a[188:191], v[208:211]
  ds_read_b64_tr_b16 a[216:217], v233 offset:61440
  v_mfma_f32_16x16x32_bf16 v[212:215], a[224:227], a[172:175], v[212:215]
  ds_read_b64_tr_b16 a[218:219], v233 offset:63488
  v_mfma_f32_16x16x32_bf16 v[212:215], a[228:231], a[188:191], v[212:215]
  ds_read_b64_tr_b16 a[220:221], v232 offset:57344
  ds_read_b64_tr_b16 a[222:223], v232 offset:59392
  v_mfma_f32_16x16x32_bf16 v[148:151], a[224:227], a[164:167], v[148:151]
  ds_read_b64_tr_b16 a[224:225], v236 offset:4096
  v_mfma_f32_16x16x32_bf16 v[148:151], a[228:231], a[180:183], v[148:151]
  buffer_load_dwordx4 a[52:55], v225, s[4:7], s40 offen offset:1024 sc1
  s_waitcnt lgkmcnt(13)
  v_mfma_f32_16x16x32_bf16 v[152:155], a[232:235], a[164:167], v[152:155]
  ds_read_b64_tr_b16 a[226:227], v236 offset:6144
  v_mfma_f32_16x16x32_bf16 v[152:155], a[192:195], a[180:183], v[152:155]
  ds_read_b64_tr_b16 a[228:229], v233 offset:57344
  ds_read_b64_tr_b16 a[230:231], v233 offset:59392
  v_mfma_f32_16x16x32_bf16 v[216:219], a[232:235], a[172:175], v[216:219]
  ds_read_b64_tr_b16 a[232:233], v237 offset:4096
  v_mfma_f32_16x16x32_bf16 v[216:219], a[192:195], a[188:191], v[216:219]
  ds_read_b64_tr_b16 a[234:235], v237 offset:6144
  v_mfma_f32_16x16x32_bf16 v[220:223], a[196:199], a[172:175], v[220:223]
  ds_read_b64_tr_b16 a[192:193], v234 offset:45056
  s_waitcnt lgkmcnt(13)
  v_mfma_f32_16x16x32_bf16 v[220:223], a[200:203], a[188:191], v[220:223]
  buffer_load_dwordx4 a[56:59], v225, s[4:7], s40 offen offset:2048 sc1
  v_mfma_f32_16x16x32_bf16 v[156:159], a[196:199], a[164:167], v[156:159]
  ds_read_b64_tr_b16 a[194:195], v234 offset:47104
  v_mfma_f32_16x16x32_bf16 v[156:159], a[200:203], a[180:183], v[156:159]
  ds_read_b64_tr_b16 a[196:197], v234 offset:61440
  s_load_dwordx2 s[66:67], s[36:37], 0x3ff00
  s_waitcnt vmcnt(11)
  v_mfma_f32_16x16x32_bf16 v[0:3], a[204:207], a[0:3], v[0:3]
  ds_read_b64_tr_b16 a[198:199], v234 offset:63488
  s_waitcnt vmcnt(7)
  v_mfma_f32_16x16x32_bf16 v[0:3], a[208:211], a[16:19], v[0:3]
  ds_read_b64_tr_b16 a[200:201], v234 offset:57344
  ds_read_b64_tr_b16 a[202:203], v234 offset:59392
  v_mfma_f32_16x16x32_bf16 v[16:19], a[204:207], a[4:7], v[16:19]
  buffer_load_dwordx4 a[60:63], v225, s[4:7], s40 offen offset:3072 sc1
  v_mfma_f32_16x16x32_bf16 v[16:19], a[208:211], a[20:23], v[16:19]
  s_mov_b32 s41, 1376256
  s_add_u32 m0, s42, 106496
  v_mfma_f32_16x16x32_bf16 v[32:35], a[204:207], a[8:11], v[32:35]
  buffer_load_dword v241, v247, s[56:59], s78 offen
  v_mfma_f32_16x16x32_bf16 v[32:35], a[208:211], a[24:27], v[32:35]
  s_mov_b32 s78, 2097152
  v_mfma_f32_16x16x32_bf16 v[48:51], a[204:207], a[12:15], v[48:51]
  ds_read_b64_tr_b16 a[204:205], v238 offset:4096
  v_mfma_f32_16x16x32_bf16 v[48:51], a[208:211], a[28:31], v[48:51]
  ds_read_b64_tr_b16 a[206:207], v238 offset:6144
  s_waitcnt lgkmcnt(13)
  v_mfma_f32_16x16x32_bf16 v[52:55], a[212:215], a[12:15], v[52:55]
  buffer_load_dwordx4 v226, s[16:19], s41 offen offset:0 lds
  v_mfma_f32_16x16x32_bf16 v[52:55], a[216:219], a[28:31], v[52:55]
  ds_read_b64_tr_b16 a[208:209], v236 offset:20480
  ds_read_b64_tr_b16 a[210:211], v236 offset:22528
  v_mfma_f32_16x16x32_bf16 v[36:39], a[212:215], a[8:11], v[36:39]
  s_mov_b32 s41, 1605632
  s_add_u32 m0, s42, 114688
  v_mfma_f32_16x16x32_bf16 v[36:39], a[216:219], a[24:27], v[36:39]
  buffer_load_dword v241, v247, s[56:59], s78 offen
  v_mfma_f32_16x16x32_bf16 v[20:23], a[212:215], a[4:7], v[20:23]
  s_mov_b32 s78, 2621440
  v_mfma_f32_16x16x32_bf16 v[20:23], a[216:219], a[20:23], v[20:23]
  buffer_load_dwordx4 v226, s[16:19], s41 offen offset:0 lds
  v_mfma_f32_16x16x32_bf16 v[4:7], a[212:215], a[0:3], v[4:7]
  ds_read_b64_tr_b16 a[212:213], v236 offset:16384
  s_mov_b32 s41, 1835008
  v_mfma_f32_16x16x32_bf16 v[4:7], a[216:219], a[16:19], v[4:7]
  ds_read_b64_tr_b16 a[214:215], v236 offset:18432
  s_add_u32 m0, s42, 28672
  v_mfma_f32_16x16x32_bf16 v[8:11], a[220:223], a[0:3], v[8:11]
  ds_read_b64_tr_b16 a[216:217], v237 offset:20480
  s_waitcnt lgkmcnt(13)
  v_mfma_f32_16x16x32_bf16 v[8:11], a[224:227], a[16:19], v[8:11]
  s_barrier
  v_mfma_f32_16x16x32_bf16 v[24:27], a[220:223], a[4:7], v[24:27]
  ds_read_b64_tr_b16 a[218:219], v237 offset:22528
  v_mfma_f32_16x16x32_bf16 v[24:27], a[224:227], a[20:23], v[24:27]
  buffer_load_dwordx4 v227, s[12:15], s41 offen offset:0 lds
  v_mfma_f32_16x16x32_bf16 v[40:43], a[220:223], a[8:11], v[40:43]
  s_mov_b32 s41, 2064384
  s_add_u32 m0, s42, 32768
  v_mfma_f32_16x16x32_bf16 v[40:43], a[224:227], a[24:27], v[40:43]
  s_load_dwordx2 s[66:67], s[36:37], 0x5fe80
  v_mfma_f32_16x16x32_bf16 v[56:59], a[220:223], a[12:15], v[56:59]
  ds_read_b64_tr_b16 a[220:221], v237 offset:16384
  v_mfma_f32_16x16x32_bf16 v[56:59], a[224:227], a[28:31], v[56:59]
  ds_read_b64_tr_b16 a[222:223], v237 offset:18432
  v_mfma_f32_16x16x32_bf16 v[60:63], a[228:231], a[12:15], v[60:63]
  buffer_load_dwordx4 v227, s[12:15], s41 offen offset:0 lds
  v_mfma_f32_16x16x32_bf16 v[60:63], a[232:235], a[28:31], v[60:63]
  ds_read_b64_tr_b16 a[224:225], v238 offset:20480
  ds_read_b64_tr_b16 a[226:227], v238 offset:22528
  v_mfma_f32_16x16x32_bf16 v[44:47], a[228:231], a[8:11], v[44:47]
  s_mov_b32 s41, 1835008
  s_add_u32 m0, s42, 40960
  v_mfma_f32_16x16x32_bf16 v[44:47], a[232:235], a[24:27], v[44:47]
  buffer_load_dword v241, v247, s[56:59], s78 offen
  v_mfma_f32_16x16x32_bf16 v[28:31], a[228:231], a[4:7], v[28:31]
  v_mfma_f32_16x16x32_bf16 v[28:31], a[232:235], a[20:23], v[28:31]
  v_mfma_f32_16x16x32_bf16 v[12:15], a[228:231], a[0:3], v[12:15]
  buffer_load_dwordx4 v227, s[16:19], s41 offen offset:0 lds
  v_mfma_f32_16x16x32_bf16 v[12:15], a[232:235], a[16:19], v[12:15]
  ds_read_b64_tr_b16 a[228:229], v238 offset:16384
  s_mov_b32 s41, 2064384
  s_waitcnt lgkmcnt(13)
  v_mfma_f32_16x16x32_bf16 v[64:67], a[192:195], a[0:3], v[64:67]
  ds_read_b64_tr_b16 a[230:231], v238 offset:18432
  s_add_u32 m0, s42, 69632
  v_mfma_f32_16x16x32_bf16 v[64:67], a[196:199], a[16:19], v[64:67]
  ds_read_b64_tr_b16 a[232:233], v239 offset:20480
  ds_read_b64_tr_b16 a[234:235], v239 offset:22528
  v_mfma_f32_16x16x32_bf16 v[72:75], a[192:195], a[4:7], v[72:75]
  v_mfma_f32_16x16x32_bf16 v[72:75], a[196:199], a[20:23], v[72:75]
  buffer_load_dwordx4 v227, s[16:19], s41 offen offset:0 lds
  v_mfma_f32_16x16x32_bf16 v[80:83], a[192:195], a[8:11], v[80:83]
  s_mov_b32 s40, 10485760
  v_mfma_f32_16x16x32_bf16 v[80:83], a[196:199], a[24:27], v[80:83]
  v_mfma_f32_16x16x32_bf16 v[88:91], a[192:195], a[12:15], v[88:91]
  ds_read_b64_tr_b16 a[192:193], v239 offset:16384
  v_mfma_f32_16x16x32_bf16 v[88:91], a[196:199], a[28:31], v[88:91]
  ds_read_b64_tr_b16 a[194:195], v239 offset:18432
  v_mfma_f32_16x16x32_bf16 v[92:95], a[200:203], a[12:15], v[92:95]
  ds_read_b64_tr_b16 a[196:197], v236 offset:28672
  s_waitcnt lgkmcnt(13)
  v_mfma_f32_16x16x32_bf16 v[92:95], a[204:207], a[28:31], v[92:95]
  buffer_load_dwordx4 a[64:67], v225, s[4:7], s40 offen offset:0 sc1
  v_mfma_f32_16x16x32_bf16 v[84:87], a[200:203], a[8:11], v[84:87]
  ds_read_b64_tr_b16 a[198:199], v236 offset:30720
  v_mfma_f32_16x16x32_bf16 v[84:87], a[204:207], a[24:27], v[84:87]
  s_load_dwordx2 s[66:67], s[36:37], 0x7fe00
  v_mfma_f32_16x16x32_bf16 v[76:79], a[200:203], a[4:7], v[76:79]
  v_mfma_f32_16x16x32_bf16 v[76:79], a[204:207], a[20:23], v[76:79]
  v_mfma_f32_16x16x32_bf16 v[68:71], a[200:203], a[0:3], v[68:71]
  buffer_load_dwordx4 a[68:71], v225, s[4:7], s40 offen offset:1024 sc1
  v_mfma_f32_16x16x32_bf16 v[68:71], a[204:207], a[16:19], v[68:71]
  ds_read_b64_tr_b16 a[200:201], v228 offset:16384
  v_mfma_f32_16x16x32_bf16 v[96:99], a[208:211], a[0:3], v[96:99]
  ds_read_b64_tr_b16 a[202:203], v228 offset:18432
  v_mfma_f32_16x16x32_bf16 v[96:99], a[212:215], a[16:19], v[96:99]
  ds_read_b64_tr_b16 a[204:205], v237 offset:28672
  ds_read_b64_tr_b16 a[206:207], v237 offset:30720
  v_mfma_f32_16x16x32_bf16 v[128:131], a[208:211], a[4:7], v[128:131]
  v_mfma_f32_16x16x32_bf16 v[128:131], a[212:215], a[20:23], v[128:131]
  v_mfma_f32_16x16x32_bf16 v[160:163], a[208:211], a[8:11], v[160:163]
  buffer_load_dwordx4 a[72:75], v225, s[4:7], s40 offen offset:2048 sc1
  v_mfma_f32_16x16x32_bf16 v[160:163], a[212:215], a[24:27], v[160:163]
  v_mfma_f32_16x16x32_bf16 v[192:195], a[208:211], a[12:15], v[192:195]
  ds_read_b64_tr_b16 a[208:209], v229 offset:16384
  v_mfma_f32_16x16x32_bf16 v[192:195], a[212:215], a[28:31], v[192:195]
  ds_read_b64_tr_b16 a[210:211], v229 offset:18432
  s_waitcnt lgkmcnt(13)
  v_mfma_f32_16x16x32_bf16 v[196:199], a[216:219], a[12:15], v[196:199]
  ds_read_b64_tr_b16 a[212:213], v238 offset:28672
  v_mfma_f32_16x16x32_bf16 v[196:199], a[220:223], a[28:31], v[196:199]
  buffer_load_dwordx4 a[76:79], v225, s[4:7], s40 offen offset:3072 sc1
  v_mfma_f32_16x16x32_bf16 v[164:167], a[216:219], a[8:11], v[164:167]
  ds_read_b64_tr_b16 a[214:215], v238 offset:30720
  s_mov_b32 s41, 1835008
  v_mfma_f32_16x16x32_bf16 v[164:167], a[220:223], a[24:27], v[164:167]
  s_add_u32 m0, s42, 81920
  v_mfma_f32_16x16x32_bf16 v[132:135], a[216:219], a[4:7], v[132:135]
  v_mfma_f32_16x16x32_bf16 v[132:135], a[220:223], a[20:23], v[132:135]
  v_mfma_f32_16x16x32_bf16 v[100:103], a[216:219], a[0:3], v[100:103]
  ds_read_b64_tr_b16 a[216:217], v230 offset:16384
  v_mfma_f32_16x16x32_bf16 v[100:103], a[220:223], a[16:19], v[100:103]
  buffer_load_dwordx4 v226, s[12:15], s41 offen offset:0 lds
  v_mfma_f32_16x16x32_bf16 v[104:107], a[224:227], a[0:3], v[104:107]
  ds_read_b64_tr_b16 a[218:219], v230 offset:18432
  s_mov_b32 s41, 2064384
  s_waitcnt lgkmcnt(13)
  v_mfma_f32_16x16x32_bf16 v[104:107], a[228:231], a[16:19], v[104:107]
  ds_read_b64_tr_b16 a[220:221], v239 offset:28672
  ds_read_b64_tr_b16 a[222:223], v239 offset:30720
  s_load_dwordx2 s[66:67], s[36:37], 0x9fd80
  v_mfma_f32_16x16x32_bf16 v[136:139], a[224:227], a[4:7], v[136:139]
  s_add_u32 m0, s42, 90112
  v_mfma_f32_16x16x32_bf16 v[136:139], a[228:231], a[20:23], v[136:139]
  v_mfma_f32_16x16x32_bf16 v[168:171], a[224:227], a[8:11], v[168:171]
  buffer_load_dwordx4 v226, s[12:15], s41 offen offset:0 lds
  v_mfma_f32_16x16x32_bf16 v[168:171], a[228:231], a[24:27], v[168:171]
  s_mov_b32 s40, 10616832
  v_mfma_f32_16x16x32_bf16 v[200:203], a[224:227], a[12:15], v[200:203]
  ds_read_b64_tr_b16 a[224:225], v231 offset:16384
  v_mfma_f32_16x16x32_bf16 v[200:203], a[228:231], a[28:31], v[200:203]
  ds_read_b64_tr_b16 a[226:227], v231 offset:18432
  v_mfma_f32_16x16x32_bf16 v[204:207], a[232:235], a[12:15], v[204:207]
  ds_read_b64_tr_b16 a[228:229], v228 offset:12288
  s_waitcnt lgkmcnt(13)
  v_mfma_f32_16x16x32_bf16 v[204:207], a[192:195], a[28:31], v[204:207]
  s_barrier
  v_mfma_f32_16x16x32_bf16 v[172:175], a[232:235], a[8:11], v[172:175]
  buffer_load_dwordx4 a[80:83], v225, s[4:7], s40 offen offset:0 sc1
  v_mfma_f32_16x16x32_bf16 v[172:175], a[192:195], a[24:27], v[172:175]
  ds_read_b64_tr_b16 a[230:231], v228 offset:14336
  v_lshrrev_b32 v254, 4, v224
  v_lshl_add_u32 v254, v254, 12, v243
  s_lshl_b32 s32, s3, 14
  v_mfma_f32_16x16x32_bf16 v[140:143], a[232:235], a[4:7], v[140:143]
  s_add_u32 s32, s32, 0x90000
  s_cmp_eq_u32 s2, 0
  s_cselect_b32 s32, s32, s79
  s_cselect_b32 s31, -1, 0
  v_mfma_f32_16x16x32_bf16 v[140:143], a[192:195], a[20:23], v[140:143]
  v_and_b32 v254, s31, v254
  v_mfma_f32_16x16x32_bf16 v[108:111], a[232:235], a[0:3], v[108:111]
  ds_read_b64_tr_b16 a[232:233], v228 offset:24576
  v_mfma_f32_16x16x32_bf16 v[108:111], a[192:195], a[16:19], v[108:111]
  buffer_load_dwordx4 a[84:87], v225, s[4:7], s40 offen offset:1024 sc1
  v_mfma_f32_16x16x32_bf16 v[112:115], a[196:199], a[0:3], v[112:115]
  ds_read_b64_tr_b16 a[234:235], v228 offset:26624
  v_mfma_f32_16x16x32_bf16 v[112:115], a[200:203], a[16:19], v[112:115]
  ds_read_b64_tr_b16 a[192:193], v229 offset:12288
  ds_read_b64_tr_b16 a[194:195], v229 offset:14336
  v_mfma_f32_16x16x32_bf16 v[144:147], a[196:199], a[4:7], v[144:147]
  v_mfma_f32_16x16x32_bf16 v[144:147], a[200:203], a[20:23], v[144:147]
  v_mfma_f32_16x16x32_bf16 v[176:179], a[196:199], a[8:11], v[176:179]
  v_mfma_f32_16x16x32_bf16 v[176:179], a[200:203], a[24:27], v[176:179]
  buffer_load_dwordx4 a[88:91], v225, s[4:7], s40 offen offset:2048 sc1
  buffer_load_dword v244, v254, s[4:7], s32 offen sc1
  v_mfma_f32_16x16x32_bf16 v[208:211], a[196:199], a[12:15], v[208:211]
  ds_read_b64_tr_b16 a[196:197], v229 offset:24576
  v_mfma_f32_16x16x32_bf16 v[208:211], a[200:203], a[28:31], v[208:211]
  ds_read_b64_tr_b16 a[198:199], v229 offset:26624
  s_load_dwordx2 s[66:67], s[36:37], 0xbfd00
  s_waitcnt lgkmcnt(13)
  v_mfma_f32_16x16x32_bf16 v[212:215], a[204:207], a[12:15], v[212:215]
  ds_read_b64_tr_b16 a[200:201], v228 offset:45056
  s_mov_b32 s78, 3145728
  v_mfma_f32_16x16x32_bf16 v[212:215], a[208:211], a[28:31], v[212:215]
  ds_read_b64_tr_b16 a[202:203], v228 offset:47104
  v_mfma_f32_16x16x32_bf16 v[180:183], a[204:207], a[8:11], v[180:183]
  buffer_load_dwordx4 a[92:95], v225, s[4:7], s40 offen offset:3072 sc1
  v_mfma_f32_16x16x32_bf16 v[180:183], a[208:211], a[24:27], v[180:183]
  s_mov_b32 s41, 1835008
  s_add_u32 m0, s42, 118784
  v_mfma_f32_16x16x32_bf16 v[148:151], a[204:207], a[4:7], v[148:151]
  buffer_load_dword v241, v247, s[56:59], s78 offen
  v_mfma_f32_16x16x32_bf16 v[148:151], a[208:211], a[20:23], v[148:151]
  v_mfma_f32_16x16x32_bf16 v[116:119], a[204:207], a[0:3], v[116:119]
  ds_read_b64_tr_b16 a[204:205], v228 offset:57344
  v_mfma_f32_16x16x32_bf16 v[116:119], a[208:211], a[16:19], v[116:119]
  ds_read_b64_tr_b16 a[206:207], v228 offset:59392
  v_mfma_f32_16x16x32_bf16 v[120:123], a[212:215], a[0:3], v[120:123]
  buffer_load_dwordx4 v226, s[16:19], s41 offen offset:0 lds
  s_waitcnt lgkmcnt(13)
  v_mfma_f32_16x16x32_bf16 v[120:123], a[216:219], a[16:19], v[120:123]
  ds_read_b64_tr_b16 a[208:209], v229 offset:45056
  ds_read_b64_tr_b16 a[210:211], v229 offset:47104
  v_mfma_f32_16x16x32_bf16 v[152:155], a[212:215], a[4:7], v[152:155]
  s_mov_b32 s41, 2064384
  s_add_u32 m0, s42, 131072
  v_mfma_f32_16x16x32_bf16 v[152:155], a[216:219], a[20:23], v[152:155]
  v_mfma_f32_16x16x32_bf16 v[184:187], a[212:215], a[8:11], v[184:187]
  v_mfma_f32_16x16x32_bf16 v[184:187], a[216:219], a[24:27], v[184:187]
  buffer_load_dwordx4 v226, s[16:19], s41 offen offset:0 lds
  v_mfma_f32_16x16x32_bf16 v[216:219], a[212:215], a[12:15], v[216:219]
  ds_read_b64_tr_b16 a[212:213], v229 offset:57344
  v_mfma_f32_16x16x32_bf16 v[216:219], a[216:219], a[28:31], v[216:219]
  ds_read_b64_tr_b16 a[214:215], v229 offset:59392
  v_mfma_f32_16x16x32_bf16 v[220:223], a[220:223], a[12:15], v[220:223]
  ds_read_b64_tr_b16 a[216:217], v230 offset:12288
  s_waitcnt lgkmcnt(13)
  v_mfma_f32_16x16x32_bf16 v[220:223], a[224:227], a[28:31], v[220:223]
  ds_read_b64_tr_b16 a[218:219], v230 offset:14336
  s_mov_b32 s41, 2293760
  v_mfma_f32_16x16x32_bf16 v[188:191], a[220:223], a[8:11], v[188:191]
  s_add_u32 m0, s42, 139264
  v_mfma_f32_16x16x32_bf16 v[188:191], a[224:227], a[24:27], v[188:191]
  buffer_load_dwordx4 v227, s[12:15], s41 offen offset:0 lds
  v_mfma_f32_16x16x32_bf16 v[156:159], a[220:223], a[4:7], v[156:159]
  v_mfma_f32_16x16x32_bf16 v[156:159], a[224:227], a[20:23], v[156:159]
  s_load_dwordx2 s[66:67], s[36:37], 0xdfc80
  s_add_u32 s36, s36, 0xffc00
  s_addc_u32 s37, s37, 0
  v_mfma_f32_16x16x32_bf16 v[124:127], a[220:223], a[0:3], v[124:127]
  ds_read_b64_tr_b16 a[220:221], v230 offset:24576
  v_mfma_f32_16x16x32_bf16 v[124:127], a[224:227], a[16:19], v[124:127]
  ds_read_b64_tr_b16 a[222:223], v230 offset:26624
  s_waitcnt vmcnt(28)
  v_mfma_f32_16x16x32_bf16 v[0:3], a[228:231], a[32:35], v[0:3]
  ds_read_b64_tr_b16 a[224:225], v230 offset:45056
  s_mov_b32 s41, 2523136
  s_waitcnt vmcnt(24)
  v_mfma_f32_16x16x32_bf16 v[0:3], a[232:235], a[48:51], v[0:3]
  ds_read_b64_tr_b16 a[226:227], v230 offset:47104
  s_add_u32 m0, s42, 20480
  v_mfma_f32_16x16x32_bf16 v[16:19], a[228:231], a[36:39], v[16:19]
  buffer_load_dwordx4 v227, s[12:15], s41 offen offset:0 lds
  v_mfma_f32_16x16x32_bf16 v[16:19], a[232:235], a[52:55], v[16:19]
  v_mfma_f32_16x16x32_bf16 v[32:35], a[228:231], a[40:43], v[32:35]
  v_mfma_f32_16x16x32_bf16 v[32:35], a[232:235], a[56:59], v[32:35]
  v_mfma_f32_16x16x32_bf16 v[48:51], a[228:231], a[44:47], v[48:51]
  ds_read_b64_tr_b16 a[228:229], v230 offset:57344
  v_mfma_f32_16x16x32_bf16 v[48:51], a[232:235], a[60:63], v[48:51]
  ds_read_b64_tr_b16 a[230:231], v230 offset:59392
  s_waitcnt lgkmcnt(13)
  v_mfma_f32_16x16x32_bf16 v[52:55], a[192:195], a[44:47], v[52:55]
  ds_read_b64_tr_b16 a[232:233], v232 offset:0
  v_mfma_f32_16x16x32_bf16 v[52:55], a[196:199], a[60:63], v[52:55]
  ds_read_b64_tr_b16 a[234:235], v232 offset:2048
  s_mov_b32 s41, 2293760
  v_mfma_f32_16x16x32_bf16 v[36:39], a[192:195], a[40:43], v[36:39]
  s_add_u32 m0, s42, 143360
  v_mfma_f32_16x16x32_bf16 v[36:39], a[196:199], a[56:59], v[36:39]
  buffer_load_dwordx4 v227, s[16:19], s41 offen offset:0 lds
  v_mfma_f32_16x16x32_bf16 v[20:23], a[192:195], a[36:39], v[20:23]
  v_mfma_f32_16x16x32_bf16 v[20:23], a[196:199], a[52:55], v[20:23]
  v_mfma_f32_16x16x32_bf16 v[4:7], a[192:195], a[32:35], v[4:7]
  ds_read_b64_tr_b16 a[192:193], v232 offset:28672
  v_mfma_f32_16x16x32_bf16 v[4:7], a[196:199], a[48:51], v[4:7]
  ds_read_b64_tr_b16 a[194:195], v232 offset:30720
  v_mfma_f32_16x16x32_bf16 v[8:11], a[200:203], a[32:35], v[8:11]
  ds_read_b64_tr_b16 a[196:197], v233 offset:0
  s_mov_b32 s41, 2523136
  s_waitcnt lgkmcnt(13)
  v_mfma_f32_16x16x32_bf16 v[8:11], a[204:207], a[48:51], v[8:11]
  s_waitcnt vmcnt(21)
  s_barrier
  v_mfma_f32_16x16x32_bf16 v[24:27], a[200:203], a[36:39], v[24:27]
  ds_read_b64_tr_b16 a[198:199], v233 offset:2048
  s_add_u32 m0, s42, 155648
  v_mfma_f32_16x16x32_bf16 v[24:27], a[204:207], a[52:55], v[24:27]
  buffer_load_dwordx4 v227, s[16:19], s41 offen offset:0 lds
  s_load_dwordx2 s[66:67], s[36:37], 0x0
  v_mfma_f32_16x16x32_bf16 v[40:43], a[200:203], a[40:43], v[40:43]
L_wk1_2:
  s_cbranch_vccnz L_wk1_6
  v_mfma_f32_16x16x32_bf16 v[40:43], a[204:207], a[56:59], v[40:43]
  v_mfma_f32_16x16x32_bf16 v[56:59], a[200:203], a[44:47], v[56:59]
  ds_read_b64_tr_b16 a[200:201], v233 offset:28672
  v_mfma_f32_16x16x32_bf16 v[56:59], a[204:207], a[60:63], v[56:59]
  ds_read_b64_tr_b16 a[202:203], v233 offset:30720
  v_mfma_f32_16x16x32_bf16 v[60:63], a[208:211], a[44:47], v[60:63]
  ds_read_b64_tr_b16 a[204:205], v234 offset:0
  v_mfma_f32_16x16x32_bf16 v[60:63], a[212:215], a[60:63], v[60:63]
  ds_read_b64_tr_b16 a[206:207], v234 offset:2048
  v_mfma_f32_16x16x32_bf16 v[44:47], a[208:211], a[40:43], v[44:47]
  v_mfma_f32_16x16x32_bf16 v[44:47], a[212:215], a[56:59], v[44:47]
  v_mfma_f32_16x16x32_bf16 v[28:31], a[208:211], a[36:39], v[28:31]
  v_mfma_f32_16x16x32_bf16 v[28:31], a[212:215], a[52:55], v[28:31]
  v_mfma_f32_16x16x32_bf16 v[12:15], a[208:211], a[32:35], v[12:15]
  ds_read_b64_tr_b16 a[208:209], v234 offset:28672
  v_mfma_f32_16x16x32_bf16 v[12:15], a[212:215], a[48:51], v[12:15]
  ds_read_b64_tr_b16 a[210:211], v234 offset:30720
  s_waitcnt lgkmcnt(13)
  v_mfma_f32_16x16x32_bf16 v[64:67], a[216:219], a[32:35], v[64:67]
  ds_read_b64_tr_b16 a[212:213], v235 offset:0
  v_mfma_f32_16x16x32_bf16 v[64:67], a[220:223], a[48:51], v[64:67]
  ds_read_b64_tr_b16 a[214:215], v235 offset:2048
  s_mov_b32 s40, 10747904
  v_mfma_f32_16x16x32_bf16 v[72:75], a[216:219], a[36:39], v[72:75]
  buffer_load_dwordx4 a[96:99], v225, s[4:7], s40 offen offset:0 sc1
  v_mfma_f32_16x16x32_bf16 v[72:75], a[220:223], a[52:55], v[72:75]
  v_mfma_f32_16x16x32_bf16 v[80:83], a[216:219], a[40:43], v[80:83]
  v_mfma_f32_16x16x32_bf16 v[80:83], a[220:223], a[56:59], v[80:83]
  v_mfma_f32_16x16x32_bf16 v[88:91], a[216:219], a[44:47], v[88:91]
  ds_read_b64_tr_b16 a[216:217], v235 offset:28672
  v_mfma_f32_16x16x32_bf16 v[88:91], a[220:223], a[60:63], v[88:91]
  buffer_load_dwordx4 a[100:103], v225, s[4:7], s40 offen offset:1024 sc1
  v_mfma_f32_16x16x32_bf16 v[92:95], a[224:227], a[44:47], v[92:95]
  ds_read_b64_tr_b16 a[218:219], v235 offset:30720
  s_waitcnt lgkmcnt(13)
  v_mfma_f32_16x16x32_bf16 v[92:95], a[228:231], a[60:63], v[92:95]
  ds_read_b64_tr_b16 a[220:221], v232 offset:40960
  ds_read_b64_tr_b16 a[222:223], v232 offset:43008
  s_load_dwordx2 s[66:67], s[36:37], 0x1ff80
  v_mfma_f32_16x16x32_bf16 v[84:87], a[224:227], a[40:43], v[84:87]
  v_mfma_f32_16x16x32_bf16 v[84:87], a[228:231], a[56:59], v[84:87]
  v_mfma_f32_16x16x32_bf16 v[76:79], a[224:227], a[36:39], v[76:79]
  buffer_load_dwordx4 a[104:107], v225, s[4:7], s40 offen offset:2048 sc1
  v_mfma_f32_16x16x32_bf16 v[76:79], a[228:231], a[52:55], v[76:79]
  v_mfma_f32_16x16x32_bf16 v[68:71], a[224:227], a[32:35], v[68:71]
  ds_read_b64_tr_b16 a[224:225], v232 offset:49152
  v_mfma_f32_16x16x32_bf16 v[68:71], a[228:231], a[48:51], v[68:71]
  ds_read_b64_tr_b16 a[226:227], v232 offset:51200
  v_mfma_f32_16x16x32_bf16 v[96:99], a[232:235], a[32:35], v[96:99]
  ds_read_b64_tr_b16 a[228:229], v233 offset:40960
  s_waitcnt lgkmcnt(13)
  v_mfma_f32_16x16x32_bf16 v[96:99], a[192:195], a[48:51], v[96:99]
  ds_read_b64_tr_b16 a[230:231], v233 offset:43008
  v_mfma_f32_16x16x32_bf16 v[128:131], a[232:235], a[36:39], v[128:131]
  buffer_load_dwordx4 a[108:111], v225, s[4:7], s40 offen offset:3072 sc1
  v_mfma_f32_16x16x32_bf16 v[128:131], a[192:195], a[52:55], v[128:131]
  s_mov_b32 s41, 2293760
  s_add_u32 m0, s42, 36864
  v_mfma_f32_16x16x32_bf16 v[160:163], a[232:235], a[40:43], v[160:163]
  v_mfma_f32_16x16x32_bf16 v[160:163], a[192:195], a[56:59], v[160:163]
  v_mfma_f32_16x16x32_bf16 v[192:195], a[232:235], a[44:47], v[192:195]
  ds_read_b64_tr_b16 a[232:233], v233 offset:49152
  v_mfma_f32_16x16x32_bf16 v[192:195], a[192:195], a[60:63], v[192:195]
  buffer_load_dwordx4 v226, s[12:15], s41 offen offset:0 lds
  v_mfma_f32_16x16x32_bf16 v[196:199], a[196:199], a[44:47], v[196:199]
  ds_read_b64_tr_b16 a[234:235], v233 offset:51200
  s_mov_b32 s41, 2523136
  v_mfma_f32_16x16x32_bf16 v[196:199], a[200:203], a[60:63], v[196:199]
  ds_read_b64_tr_b16 a[192:193], v234 offset:40960
  ds_read_b64_tr_b16 a[194:195], v234 offset:43008
  v_mfma_f32_16x16x32_bf16 v[164:167], a[196:199], a[40:43], v[164:167]
  s_add_u32 m0, s42, 53248
  v_mfma_f32_16x16x32_bf16 v[164:167], a[200:203], a[56:59], v[164:167]
  s_mov_b32 s78, 3670016
  v_mfma_f32_16x16x32_bf16 v[132:135], a[196:199], a[36:39], v[132:135]
  buffer_load_dword v241, v247, s[56:59], s78 offen
  v_mfma_f32_16x16x32_bf16 v[132:135], a[200:203], a[52:55], v[132:135]
  v_mfma_f32_16x16x32_bf16 v[100:103], a[196:199], a[32:35], v[100:103]
  buffer_load_dwordx4 v226, s[12:15], s41 offen offset:0 lds
  v_mfma_f32_16x16x32_bf16 v[100:103], a[200:203], a[48:51], v[100:103]
  ds_read_b64_tr_b16 a[196:197], v234 offset:49152
  s_mov_b32 s40, 10878976
  s_load_dwordx2 s[66:67], s[36:37], 0x3ff00
  s_waitcnt lgkmcnt(13)
  v_mfma_f32_16x16x32_bf16 v[104:107], a[204:207], a[32:35], v[104:107]
  ds_read_b64_tr_b16 a[198:199], v234 offset:51200
  v_mfma_f32_16x16x32_bf16 v[104:107], a[208:211], a[48:51], v[104:107]
  ds_read_b64_tr_b16 a[200:201], v235 offset:40960
  ds_read_b64_tr_b16 a[202:203], v235 offset:43008
  v_mfma_f32_16x16x32_bf16 v[136:139], a[204:207], a[36:39], v[136:139]
  v_mfma_f32_16x16x32_bf16 v[136:139], a[208:211], a[52:55], v[136:139]
  buffer_load_dwordx4 a[112:115], v225, s[4:7], s40 offen offset:0 sc1
  v_mfma_f32_16x16x32_bf16 v[168:171], a[204:207], a[40:43], v[168:171]
  v_mfma_f32_16x16x32_bf16 v[168:171], a[208:211], a[56:59], v[168:171]
  v_mfma_f32_16x16x32_bf16 v[200:203], a[204:207], a[44:47], v[200:203]
  ds_read_b64_tr_b16 a[204:205], v235 offset:49152
  v_mfma_f32_16x16x32_bf16 v[200:203], a[208:211], a[60:63], v[200:203]
  ds_read_b64_tr_b16 a[206:207], v235 offset:51200
  v_mfma_f32_16x16x32_bf16 v[204:207], a[212:215], a[44:47], v[204:207]
  buffer_load_dwordx4 a[116:119], v225, s[4:7], s40 offen offset:1024 sc1
  s_waitcnt lgkmcnt(13)
  v_mfma_f32_16x16x32_bf16 v[204:207], a[216:219], a[60:63], v[204:207]
  s_waitcnt vmcnt(21)
  s_barrier
  v_mfma_f32_16x16x32_bf16 v[172:175], a[212:215], a[40:43], v[172:175]
  ds_read_b64_tr_b16 a[208:209], v228 offset:28672
  ds_read_b64_tr_b16 a[210:211], v228 offset:30720
  v_mfma_f32_16x16x32_bf16 v[172:175], a[216:219], a[56:59], v[172:175]
  v_mfma_f32_16x16x32_bf16 v[140:143], a[212:215], a[36:39], v[140:143]
  v_mfma_f32_16x16x32_bf16 v[140:143], a[216:219], a[52:55], v[140:143]
  v_mfma_f32_16x16x32_bf16 v[108:111], a[212:215], a[32:35], v[108:111]
  buffer_load_dwordx4 a[120:123], v225, s[4:7], s40 offen offset:2048 sc1
  v_mfma_f32_16x16x32_bf16 v[108:111], a[216:219], a[48:51], v[108:111]
  ds_read_b64_tr_b16 a[212:213], v228 offset:32768
  v_mfma_f32_16x16x32_bf16 v[112:115], a[220:223], a[32:35], v[112:115]
  ds_read_b64_tr_b16 a[214:215], v228 offset:34816
  s_waitcnt lgkmcnt(13)
  v_mfma_f32_16x16x32_bf16 v[112:115], a[224:227], a[48:51], v[112:115]
  ds_read_b64_tr_b16 a[216:217], v229 offset:28672
  ds_read_b64_tr_b16 a[218:219], v229 offset:30720
  v_mfma_f32_16x16x32_bf16 v[144:147], a[220:223], a[36:39], v[144:147]
  v_mfma_f32_16x16x32_bf16 v[144:147], a[224:227], a[52:55], v[144:147]
  buffer_load_dwordx4 a[124:127], v225, s[4:7], s40 offen offset:3072 sc1
  v_mfma_f32_16x16x32_bf16 v[176:179], a[220:223], a[40:43], v[176:179]
  s_mov_b32 s41, 2293760
  s_add_u32 m0, s42, 49152
  v_mfma_f32_16x16x32_bf16 v[176:179], a[224:227], a[56:59], v[176:179]
  s_load_dwordx2 s[66:67], s[36:37], 0x5fe80
  v_mfma_f32_16x16x32_bf16 v[208:211], a[220:223], a[44:47], v[208:211]
  ds_read_b64_tr_b16 a[220:221], v229 offset:32768
  v_mfma_f32_16x16x32_bf16 v[208:211], a[224:227], a[60:63], v[208:211]
  ds_read_b64_tr_b16 a[222:223], v229 offset:34816
  v_mfma_f32_16x16x32_bf16 v[212:215], a[228:231], a[44:47], v[212:215]
  ds_read_b64_tr_b16 a[224:225], v228 offset:40960
  s_waitcnt lgkmcnt(13)
  v_mfma_f32_16x16x32_bf16 v[212:215], a[232:235], a[60:63], v[212:215]
  buffer_load_dwordx4 v226, s[16:19], s41 offen offset:0 lds
  v_mfma_f32_16x16x32_bf16 v[180:183], a[228:231], a[40:43], v[180:183]
  ds_read_b64_tr_b16 a[226:227], v228 offset:43008
  s_mov_b32 s41, 2523136
  v_mfma_f32_16x16x32_bf16 v[180:183], a[232:235], a[56:59], v[180:183]
  s_add_u32 m0, s42, 61440
  v_mfma_f32_16x16x32_bf16 v[148:151], a[228:231], a[36:39], v[148:151]
  v_mfma_f32_16x16x32_bf16 v[148:151], a[232:235], a[52:55], v[148:151]
  v_mfma_f32_16x16x32_bf16 v[116:119], a[228:231], a[32:35], v[116:119]
  buffer_load_dwordx4 v226, s[16:19], s41 offen offset:0 lds
  v_mfma_f32_16x16x32_bf16 v[116:119], a[232:235], a[48:51], v[116:119]
  ds_read_b64_tr_b16 a[228:229], v232 offset:4096
  v_mfma_f32_16x16x32_bf16 v[120:123], a[192:195], a[32:35], v[120:123]
  ds_read_b64_tr_b16 a[230:231], v232 offset:6144
  v_mfma_f32_16x16x32_bf16 v[120:123], a[196:199], a[48:51], v[120:123]
  ds_read_b64_tr_b16 a[232:233], v229 offset:40960
  ds_read_b64_tr_b16 a[234:235], v229 offset:43008
  v_mfma_f32_16x16x32_bf16 v[152:155], a[192:195], a[36:39], v[152:155]
  v_mfma_f32_16x16x32_bf16 v[152:155], a[196:199], a[52:55], v[152:155]
  v_mfma_f32_16x16x32_bf16 v[184:187], a[192:195], a[40:43], v[184:187]
  v_mfma_f32_16x16x32_bf16 v[184:187], a[196:199], a[56:59], v[184:187]
  v_mfma_f32_16x16x32_bf16 v[216:219], a[192:195], a[44:47], v[216:219]
  ds_read_b64_tr_b16 a[192:193], v233 offset:4096
  v_mfma_f32_16x16x32_bf16 v[216:219], a[196:199], a[60:63], v[216:219]
  ds_read_b64_tr_b16 a[194:195], v233 offset:6144
  s_waitcnt vmcnt(21)
  v_subrev_u32 v244, s100, v244
  v_cmp_lt_u32 s[68:69], 7, v244
  s_waitcnt lgkmcnt(13)
  v_mfma_f32_16x16x32_bf16 v[220:223], a[200:203], a[44:47], v[220:223]
  ds_read_b64_tr_b16 a[196:197], v230 offset:28672
  s_cmp_lg_u64 s[68:69], 0
  s_cbranch_scc1 L_slow_41
L_back_42:
  v_mfma_f32_16x16x32_bf16 v[220:223], a[204:207], a[60:63], v[220:223]
  ds_read_b64_tr_b16 a[198:199], v230 offset:30720
  s_mov_b32 s41, 2752512
  s_or_b32 s32, s2, s3
  s_cselect_b32 s32, 0x40000000, 0
  s_add_u32 s32, s32, 0xd2d00
  v_mfma_f32_16x16x32_bf16 v[188:191], a[200:203], a[40:43], v[188:191]
  s_add_u32 m0, s42, 77824
  v_mfma_f32_16x16x32_bf16 v[188:191], a[204:207], a[56:59], v[188:191]
  buffer_load_dwordx4 v227, s[12:15], s41 offen offset:0 lds
  s_load_dwordx2 s[66:67], s[36:37], 0x7fe00
  v_mfma_f32_16x16x32_bf16 v[156:159], a[200:203], a[36:39], v[156:159]
  v_mfma_f32_16x16x32_bf16 v[156:159], a[204:207], a[52:55], v[156:159]
  v_mfma_f32_16x16x32_bf16 v[124:127], a[200:203], a[32:35], v[124:127]
  ds_read_b64_tr_b16 a[200:201], v230 offset:32768
  v_mfma_f32_16x16x32_bf16 v[124:127], a[204:207], a[48:51], v[124:127]
  ds_read_b64_tr_b16 a[202:203], v230 offset:34816
  v_mfma_f32_16x16x32_bf16 v[0:3], a[208:211], a[64:67], v[0:3]
  ds_read_b64_tr_b16 a[204:205], v230 offset:40960
  s_mov_b32 s41, 2981888
  s_waitcnt vmcnt(21) lgkmcnt(13)
  v_mfma_f32_16x16x32_bf16 v[0:3], a[212:215], a[80:83], v[0:3]
  ds_read_b64_tr_b16 a[206:207], v230 offset:43008
  s_add_u32 m0, s42, 73728
  v_mfma_f32_16x16x32_bf16 v[16:19], a[208:211], a[68:71], v[16:19]
  buffer_load_dwordx4 v227, s[12:15], s41 offen offset:0 lds
  v_mfma_f32_16x16x32_bf16 v[16:19], a[212:215], a[84:87], v[16:19]
  v_mfma_f32_16x16x32_bf16 v[32:35], a[208:211], a[72:75], v[32:35]
  v_mfma_f32_16x16x32_bf16 v[32:35], a[212:215], a[88:91], v[32:35]
  v_mfma_f32_16x16x32_bf16 v[48:51], a[208:211], a[76:79], v[48:51]
  ds_read_b64_tr_b16 a[208:209], v234 offset:4096
  v_mfma_f32_16x16x32_bf16 v[48:51], a[212:215], a[92:95], v[48:51]
  ds_read_b64_tr_b16 a[210:211], v234 offset:6144
  v_mfma_f32_16x16x32_bf16 v[52:55], a[216:219], a[76:79], v[52:55]
  ds_read_b64_tr_b16 a[212:213], v232 offset:16384
  v_mfma_f32_16x16x32_bf16 v[52:55], a[220:223], a[92:95], v[52:55]
  ds_read_b64_tr_b16 a[214:215], v232 offset:18432
  s_mov_b32 s41, 2752512
  v_mfma_f32_16x16x32_bf16 v[36:39], a[216:219], a[72:75], v[36:39]
  s_add_u32 m0, s42, 86016
  v_mfma_f32_16x16x32_bf16 v[36:39], a[220:223], a[88:91], v[36:39]
  buffer_load_dwordx4 v227, s[16:19], s41 offen offset:0 lds
  v_mfma_f32_16x16x32_bf16 v[20:23], a[216:219], a[68:71], v[20:23]
  v_mfma_f32_16x16x32_bf16 v[20:23], a[220:223], a[84:87], v[20:23]
  v_mfma_f32_16x16x32_bf16 v[4:7], a[216:219], a[64:67], v[4:7]
  ds_read_b64_tr_b16 a[216:217], v232 offset:24576
  v_mfma_f32_16x16x32_bf16 v[4:7], a[220:223], a[80:83], v[4:7]
  ds_read_b64_tr_b16 a[218:219], v232 offset:26624
  s_waitcnt lgkmcnt(13)
  v_mfma_f32_16x16x32_bf16 v[8:11], a[224:227], a[64:67], v[8:11]
  ds_read_b64_tr_b16 a[220:221], v233 offset:16384
  s_mov_b32 s41, 2981888
  v_mfma_f32_16x16x32_bf16 v[8:11], a[228:231], a[80:83], v[8:11]
  s_waitcnt vmcnt(19)
  s_barrier
  s_load_dwordx2 s[66:67], s[36:37], 0x9fd80
  v_mfma_f32_16x16x32_bf16 v[24:27], a[224:227], a[68:71], v[24:27]
  ds_read_b64_tr_b16 a[222:223], v233 offset:18432
  s_add_u32 m0, s42, 102400
  buffer_store_dword v245, v246, s[4:7], s32 offen sc1
  v_mfma_f32_16x16x32_bf16 v[24:27], a[228:231], a[84:87], v[24:27]
  v_add_u32 v243, s91, v243
  s_mov_b32 s91, 0
  v_accvgpr_write_b32 a252, -1
  v_accvgpr_write_b32 a253, -1
  v_mfma_f32_16x16x32_bf16 v[40:43], a[224:227], a[72:75], v[40:43]
  buffer_load_dwordx4 v227, s[16:19], s41 offen offset:0 lds
  v_accvgpr_write_b32 a254, -1
  v_accvgpr_write_b32 a255, -1
  v_mfma_f32_16x16x32_bf16 v[40:43], a[228:231], a[88:91], v[40:43]
  v_mfma_f32_16x16x32_bf16 v[56:59], a[224:227], a[76:79], v[56:59]
  ds_read_b64_tr_b16 a[224:225], v233 offset:24576
  v_mfma_f32_16x16x32_bf16 v[56:59], a[228:231], a[92:95], v[56:59]
  ds_read_b64_tr_b16 a[226:227], v233 offset:26624
  v_mfma_f32_16x16x32_bf16 v[60:63], a[232:235], a[76:79], v[60:63]
  ds_read_b64_tr_b16 a[228:229], v234 offset:16384
  s_waitcnt lgkmcnt(13)
  v_mfma_f32_16x16x32_bf16 v[60:63], a[192:195], a[92:95], v[60:63]
  ds_read_b64_tr_b16 a[230:231], v234 offset:18432
  v_mfma_f32_16x16x32_bf16 v[44:47], a[232:235], a[72:75], v[44:47]
  v_mfma_f32_16x16x32_bf16 v[44:47], a[192:195], a[88:91], v[44:47]
  v_mfma_f32_16x16x32_bf16 v[28:31], a[232:235], a[68:71], v[28:31]
  v_mfma_f32_16x16x32_bf16 v[28:31], a[192:195], a[84:87], v[28:31]
  v_mfma_f32_16x16x32_bf16 v[12:15], a[232:235], a[64:67], v[12:15]
  ds_read_b64_tr_b16 a[232:233], v234 offset:24576
  v_mfma_f32_16x16x32_bf16 v[12:15], a[192:195], a[80:83], v[12:15]
  ds_read_b64_tr_b16 a[234:235], v234 offset:26624
  s_mov_b32 s78, 4194304
  v_mfma_f32_16x16x32_bf16 v[64:67], a[196:199], a[64:67], v[64:67]
  ds_read_b64_tr_b16 a[192:193], v235 offset:16384
  v_mfma_f32_16x16x32_bf16 v[64:67], a[200:203], a[80:83], v[64:67]
  ds_read_b64_tr_b16 a[194:195], v235 offset:18432
  s_mov_b32 s40, 11010048
  v_mfma_f32_16x16x32_bf16 v[72:75], a[196:199], a[68:71], v[72:75]
  buffer_load_dwordx4 a[128:131], v225, s[4:7], s40 offen offset:0 sc1
  v_mfma_f32_16x16x32_bf16 v[72:75], a[200:203], a[84:87], v[72:75]
  buffer_load_dword v241, v247, s[56:59], s78 offen
  v_mfma_f32_16x16x32_bf16 v[80:83], a[196:199], a[72:75], v[80:83]
  v_mfma_f32_16x16x32_bf16 v[80:83], a[200:203], a[88:91], v[80:83]
  v_mfma_f32_16x16x32_bf16 v[88:91], a[196:199], a[76:79], v[88:91]
  ds_read_b64_tr_b16 a[196:197], v235 offset:24576
  v_mfma_f32_16x16x32_bf16 v[88:91], a[200:203], a[92:95], v[88:91]
  buffer_load_dwordx4 a[132:135], v225, s[4:7], s40 offen offset:1024 sc1
  s_load_dwordx2 s[66:67], s[36:37], 0xbfd00
  s_waitcnt lgkmcnt(13)
  v_mfma_f32_16x16x32_bf16 v[92:95], a[204:207], a[76:79], v[92:95]
  ds_read_b64_tr_b16 a[198:199], v235 offset:26624
  v_mfma_f32_16x16x32_bf16 v[92:95], a[208:211], a[92:95], v[92:95]
  ds_read_b64_tr_b16 a[200:201], v232 offset:53248
  ds_read_b64_tr_b16 a[202:203], v232 offset:55296
  v_mfma_f32_16x16x32_bf16 v[84:87], a[204:207], a[72:75], v[84:87]
  v_mfma_f32_16x16x32_bf16 v[84:87], a[208:211], a[88:91], v[84:87]
  v_mfma_f32_16x16x32_bf16 v[76:79], a[204:207], a[68:71], v[76:79]
  buffer_load_dwordx4 a[136:139], v225, s[4:7], s40 offen offset:2048 sc1
  v_mfma_f32_16x16x32_bf16 v[76:79], a[208:211], a[84:87], v[76:79]
  v_mfma_f32_16x16x32_bf16 v[68:71], a[204:207], a[64:67], v[68:71]
  ds_read_b64_tr_b16 a[204:205], v236 offset:0
  v_mfma_f32_16x16x32_bf16 v[68:71], a[208:211], a[80:83], v[68:71]
  ds_read_b64_tr_b16 a[206:207], v236 offset:2048
  v_mfma_f32_16x16x32_bf16 v[96:99], a[212:215], a[64:67], v[96:99]
  ds_read_b64_tr_b16 a[208:209], v233 offset:53248
  s_waitcnt lgkmcnt(13)
  v_mfma_f32_16x16x32_bf16 v[96:99], a[216:219], a[80:83], v[96:99]
  ds_read_b64_tr_b16 a[210:211], v233 offset:55296
  v_mfma_f32_16x16x32_bf16 v[128:131], a[212:215], a[68:71], v[128:131]
  buffer_load_dwordx4 a[140:143], v225, s[4:7], s40 offen offset:3072 sc1
  v_mfma_f32_16x16x32_bf16 v[128:131], a[216:219], a[84:87], v[128:131]
  s_mov_b32 s41, 2752512
  s_add_u32 m0, s42, 98304
  v_mfma_f32_16x16x32_bf16 v[160:163], a[212:215], a[72:75], v[160:163]
  v_mfma_f32_16x16x32_bf16 v[160:163], a[216:219], a[88:91], v[160:163]
  v_mfma_f32_16x16x32_bf16 v[192:195], a[212:215], a[76:79], v[192:195]
  ds_read_b64_tr_b16 a[212:213], v237 offset:0
  v_mfma_f32_16x16x32_bf16 v[192:195], a[216:219], a[92:95], v[192:195]
  buffer_load_dwordx4 v226, s[12:15], s41 offen offset:0 lds
  v_mfma_f32_16x16x32_bf16 v[196:199], a[220:223], a[76:79], v[196:199]
  ds_read_b64_tr_b16 a[214:215], v237 offset:2048
  s_mov_b32 s41, 2981888
  v_mfma_f32_16x16x32_bf16 v[196:199], a[224:227], a[92:95], v[196:199]
  ds_read_b64_tr_b16 a[216:217], v234 offset:53248
  ds_read_b64_tr_b16 a[218:219], v234 offset:55296
  v_mfma_f32_16x16x32_bf16 v[164:167], a[220:223], a[72:75], v[164:167]
  s_add_u32 m0, s42, 110592
  v_mfma_f32_16x16x32_bf16 v[164:167], a[224:227], a[88:91], v[164:167]
  v_mfma_f32_16x16x32_bf16 v[132:135], a[220:223], a[68:71], v[132:135]
  v_mfma_f32_16x16x32_bf16 v[132:135], a[224:227], a[84:87], v[132:135]
  buffer_load_dwordx4 v226, s[12:15], s41 offen offset:0 lds
  s_load_dwordx2 s[66:67], s[36:37], 0xdfc80
  s_add_u32 s36, s36, 0xffc00
  s_addc_u32 s37, s37, 0
  v_mfma_f32_16x16x32_bf16 v[100:103], a[220:223], a[64:67], v[100:103]
  ds_read_b64_tr_b16 a[220:221], v238 offset:0
  s_mov_b32 s40, 11141120
  v_mfma_f32_16x16x32_bf16 v[100:103], a[224:227], a[80:83], v[100:103]
  ds_read_b64_tr_b16 a[222:223], v238 offset:2048
  s_waitcnt lgkmcnt(13)
  v_mfma_f32_16x16x32_bf16 v[104:107], a[228:231], a[64:67], v[104:107]
  ds_read_b64_tr_b16 a[224:225], v235 offset:53248
  v_mfma_f32_16x16x32_bf16 v[104:107], a[232:235], a[80:83], v[104:107]
  ds_read_b64_tr_b16 a[226:227], v235 offset:55296
  v_mfma_f32_16x16x32_bf16 v[136:139], a[228:231], a[68:71], v[136:139]
  buffer_load_dwordx4 a[144:147], v225, s[4:7], s40 offen offset:0 sc1
  v_mfma_f32_16x16x32_bf16 v[136:139], a[232:235], a[84:87], v[136:139]
  v_mfma_f32_16x16x32_bf16 v[168:171], a[228:231], a[72:75], v[168:171]
  v_mfma_f32_16x16x32_bf16 v[168:171], a[232:235], a[88:91], v[168:171]
  v_mfma_f32_16x16x32_bf16 v[200:203], a[228:231], a[76:79], v[200:203]
  ds_read_b64_tr_b16 a[228:229], v239 offset:0
  v_mfma_f32_16x16x32_bf16 v[200:203], a[232:235], a[92:95], v[200:203]
  ds_read_b64_tr_b16 a[230:231], v239 offset:2048
  v_mfma_f32_16x16x32_bf16 v[204:207], a[192:195], a[76:79], v[204:207]
  buffer_load_dwordx4 a[148:151], v225, s[4:7], s40 offen offset:1024 sc1
  s_waitcnt lgkmcnt(13)
  v_mfma_f32_16x16x32_bf16 v[204:207], a[196:199], a[92:95], v[204:207]
  s_waitcnt vmcnt(20)
  s_barrier
  v_mfma_f32_16x16x32_bf16 v[172:175], a[192:195], a[72:75], v[172:175]
  ds_read_b64_tr_b16 a[232:233], v236 offset:8192
  ds_read_b64_tr_b16 a[234:235], v236 offset:10240
  v_mfma_f32_16x16x32_bf16 v[172:175], a[196:199], a[88:91], v[172:175]
  v_mfma_f32_16x16x32_bf16 v[140:143], a[192:195], a[68:71], v[140:143]
  v_mfma_f32_16x16x32_bf16 v[140:143], a[196:199], a[84:87], v[140:143]
  buffer_load_dwordx4 a[152:155], v225, s[4:7], s40 offen offset:2048 sc1
  v_mfma_f32_16x16x32_bf16 v[108:111], a[192:195], a[64:67], v[108:111]
  ds_read_b64_tr_b16 a[192:193], v228 offset:20480
  v_mfma_f32_16x16x32_bf16 v[108:111], a[196:199], a[80:83], v[108:111]
  ds_read_b64_tr_b16 a[194:195], v228 offset:22528
  v_mfma_f32_16x16x32_bf16 v[112:115], a[200:203], a[64:67], v[112:115]
  ds_read_b64_tr_b16 a[196:197], v237 offset:8192
  s_waitcnt lgkmcnt(13)
  v_mfma_f32_16x16x32_bf16 v[112:115], a[204:207], a[80:83], v[112:115]
  ds_read_b64_tr_b16 a[198:199], v237 offset:10240
  v_mfma_f32_16x16x32_bf16 v[144:147], a[200:203], a[68:71], v[144:147]
  v_mfma_f32_16x16x32_bf16 v[144:147], a[204:207], a[84:87], v[144:147]
  buffer_load_dwordx4 a[156:159], v225, s[4:7], s40 offen offset:3072 sc1
  s_load_dwordx2 s[66:67], s[36:37], 0x0
  v_mfma_f32_16x16x32_bf16 v[176:179], a[200:203], a[72:75], v[176:179]
  s_mov_b32 s41, 2752512
  s_add_u32 m0, s42, 126976
  v_mfma_f32_16x16x32_bf16 v[176:179], a[204:207], a[88:91], v[176:179]
  v_mfma_f32_16x16x32_bf16 v[208:211], a[200:203], a[76:79], v[208:211]
  ds_read_b64_tr_b16 a[200:201], v229 offset:20480
  v_mfma_f32_16x16x32_bf16 v[208:211], a[204:207], a[92:95], v[208:211]
  ds_read_b64_tr_b16 a[202:203], v229 offset:22528
  v_mfma_f32_16x16x32_bf16 v[212:215], a[208:211], a[76:79], v[212:215]
  buffer_load_dwordx4 v226, s[16:19], s41 offen offset:0 lds
  v_mfma_f32_16x16x32_bf16 v[212:215], a[212:215], a[92:95], v[212:215]
  ds_read_b64_tr_b16 a[204:205], v236 offset:12288
  ds_read_b64_tr_b16 a[206:207], v236 offset:14336
  v_mfma_f32_16x16x32_bf16 v[180:183], a[208:211], a[72:75], v[180:183]
  s_mov_b32 s41, 2981888
  s_add_u32 m0, s42, 122880
  v_mfma_f32_16x16x32_bf16 v[180:183], a[212:215], a[88:91], v[180:183]
  v_mfma_f32_16x16x32_bf16 v[148:151], a[208:211], a[68:71], v[148:151]
  v_mfma_f32_16x16x32_bf16 v[148:151], a[212:215], a[84:87], v[148:151]
  v_mfma_f32_16x16x32_bf16 v[116:119], a[208:211], a[64:67], v[116:119]
  buffer_load_dwordx4 v226, s[16:19], s41 offen offset:0 lds
  v_mfma_f32_16x16x32_bf16 v[116:119], a[212:215], a[80:83], v[116:119]
  ds_read_b64_tr_b16 a[208:209], v236 offset:24576
  s_waitcnt lgkmcnt(13)
  v_mfma_f32_16x16x32_bf16 v[120:123], a[216:219], a[64:67], v[120:123]
  ds_read_b64_tr_b16 a[210:211], v236 offset:26624
  v_mfma_f32_16x16x32_bf16 v[120:123], a[220:223], a[80:83], v[120:123]
  ds_read_b64_tr_b16 a[212:213], v237 offset:12288
  ds_read_b64_tr_b16 a[214:215], v237 offset:14336
  v_mfma_f32_16x16x32_bf16 v[152:155], a[216:219], a[68:71], v[152:155]
  v_mfma_f32_16x16x32_bf16 v[152:155], a[220:223], a[84:87], v[152:155]
  v_mfma_f32_16x16x32_bf16 v[184:187], a[216:219], a[72:75], v[184:187]
  v_mfma_f32_16x16x32_bf16 v[184:187], a[220:223], a[88:91], v[184:187]
  v_mfma_f32_16x16x32_bf16 v[216:219], a[216:219], a[76:79], v[216:219]
  ds_read_b64_tr_b16 a[216:217], v237 offset:24576
  v_mfma_f32_16x16x32_bf16 v[216:219], a[220:223], a[92:95], v[216:219]
  ds_read_b64_tr_b16 a[218:219], v237 offset:26624
  v_mfma_f32_16x16x32_bf16 v[220:223], a[224:227], a[76:79], v[220:223]
  ds_read_b64_tr_b16 a[220:221], v238 offset:8192
  s_waitcnt lgkmcnt(13)
  v_mfma_f32_16x16x32_bf16 v[220:223], a[228:231], a[92:95], v[220:223]
  ds_read_b64_tr_b16 a[222:223], v238 offset:10240
  s_mov_b32 s41, 3211264
  s_load_dwordx2 s[66:67], s[36:37], 0x1ff80
  v_mfma_f32_16x16x32_bf16 v[188:191], a[224:227], a[72:75], v[188:191]
  s_add_u32 m0, s42, 135168
  v_mfma_f32_16x16x32_bf16 v[188:191], a[228:231], a[88:91], v[188:191]
  buffer_load_dwordx4 v227, s[12:15], s41 offen offset:0 lds
  v_mfma_f32_16x16x32_bf16 v[156:159], a[224:227], a[68:71], v[156:159]
  v_mfma_f32_16x16x32_bf16 v[156:159], a[228:231], a[84:87], v[156:159]
  v_mfma_f32_16x16x32_bf16 v[124:127], a[224:227], a[64:67], v[124:127]
  ds_read_b64_tr_b16 a[224:225], v230 offset:20480
  v_mfma_f32_16x16x32_bf16 v[124:127], a[228:231], a[80:83], v[124:127]
  ds_read_b64_tr_b16 a[226:227], v230 offset:22528
  v_mfma_f32_16x16x32_bf16 v[0:3], a[232:235], a[96:99], v[0:3]
  ds_read_b64_tr_b16 a[228:229], v238 offset:12288
  s_mov_b32 s41, 3440640
  s_waitcnt vmcnt(21)
  v_mfma_f32_16x16x32_bf16 v[0:3], a[192:195], a[112:115], v[0:3]
  ds_read_b64_tr_b16 a[230:231], v238 offset:14336
  s_add_u32 m0, s42, 151552
  v_mfma_f32_16x16x32_bf16 v[16:19], a[232:235], a[100:103], v[16:19]
  buffer_load_dwordx4 v227, s[12:15], s41 offen offset:0 lds
  v_mfma_f32_16x16x32_bf16 v[16:19], a[192:195], a[116:119], v[16:19]
  s_mov_b32 s78, 4718592
  v_mfma_f32_16x16x32_bf16 v[32:35], a[232:235], a[104:107], v[32:35]
  buffer_load_dword v241, v247, s[56:59], s78 offen
  v_mfma_f32_16x16x32_bf16 v[32:35], a[192:195], a[120:123], v[32:35]
  v_mfma_f32_16x16x32_bf16 v[48:51], a[232:235], a[108:111], v[48:51]
  ds_read_b64_tr_b16 a[232:233], v238 offset:24576
  v_mfma_f32_16x16x32_bf16 v[48:51], a[192:195], a[124:127], v[48:51]
  ds_read_b64_tr_b16 a[234:235], v238 offset:26624
  s_waitcnt lgkmcnt(13)
  v_mfma_f32_16x16x32_bf16 v[52:55], a[196:199], a[108:111], v[52:55]
  ds_read_b64_tr_b16 a[192:193], v228 offset:36864
  v_mfma_f32_16x16x32_bf16 v[52:55], a[200:203], a[124:127], v[52:55]
  ds_read_b64_tr_b16 a[194:195], v228 offset:38912
  s_mov_b32 s41, 3211264
  v_mfma_f32_16x16x32_bf16 v[36:39], a[196:199], a[104:107], v[36:39]
  s_add_u32 m0, s42, 147456
  v_mfma_f32_16x16x32_bf16 v[36:39], a[200:203], a[120:123], v[36:39]
  buffer_load_dwordx4 v227, s[16:19], s41 offen offset:0 lds
  v_mfma_f32_16x16x32_bf16 v[20:23], a[196:199], a[100:103], v[20:23]
  v_mfma_f32_16x16x32_bf16 v[20:23], a[200:203], a[116:119], v[20:23]
  v_mfma_f32_16x16x32_bf16 v[4:7], a[196:199], a[96:99], v[4:7]
  ds_read_b64_tr_b16 a[196:197], v228 offset:53248
  v_mfma_f32_16x16x32_bf16 v[4:7], a[200:203], a[112:115], v[4:7]
  ds_read_b64_tr_b16 a[198:199], v228 offset:55296
  s_load_dwordx2 s[66:67], s[36:37], 0x3ff00
  v_mfma_f32_16x16x32_bf16 v[8:11], a[204:207], a[96:99], v[8:11]
  ds_read_b64_tr_b16 a[200:201], v229 offset:36864
  s_mov_b32 s41, 3440640
  s_waitcnt lgkmcnt(13)
  v_mfma_f32_16x16x32_bf16 v[8:11], a[208:211], a[112:115], v[8:11]
  s_waitcnt vmcnt(21)
  s_barrier
  v_mfma_f32_16x16x32_bf16 v[24:27], a[204:207], a[100:103], v[24:27]
  ds_read_b64_tr_b16 a[202:203], v229 offset:38912
  s_add_u32 m0, s42, 159744
  v_mfma_f32_16x16x32_bf16 v[24:27], a[208:211], a[116:119], v[24:27]
  buffer_load_dwordx4 v227, s[16:19], s41 offen offset:0 lds
  v_mfma_f32_16x16x32_bf16 v[40:43], a[204:207], a[104:107], v[40:43]
  v_mfma_f32_16x16x32_bf16 v[40:43], a[208:211], a[120:123], v[40:43]
  v_mfma_f32_16x16x32_bf16 v[56:59], a[204:207], a[108:111], v[56:59]
  ds_read_b64_tr_b16 a[204:205], v229 offset:53248
  v_mfma_f32_16x16x32_bf16 v[56:59], a[208:211], a[124:127], v[56:59]
  ds_read_b64_tr_b16 a[206:207], v229 offset:55296
  v_mfma_f32_16x16x32_bf16 v[60:63], a[212:215], a[108:111], v[60:63]
  ds_read_b64_tr_b16 a[208:209], v230 offset:36864
  v_mfma_f32_16x16x32_bf16 v[60:63], a[216:219], a[124:127], v[60:63]
  ds_read_b64_tr_b16 a[210:211], v230 offset:38912
  v_mfma_f32_16x16x32_bf16 v[44:47], a[212:215], a[104:107], v[44:47]
  v_mfma_f32_16x16x32_bf16 v[44:47], a[216:219], a[120:123], v[44:47]
  v_mfma_f32_16x16x32_bf16 v[28:31], a[212:215], a[100:103], v[28:31]
  v_mfma_f32_16x16x32_bf16 v[28:31], a[216:219], a[116:119], v[28:31]
  v_mfma_f32_16x16x32_bf16 v[12:15], a[212:215], a[96:99], v[12:15]
  ds_read_b64_tr_b16 a[212:213], v230 offset:53248
  v_mfma_f32_16x16x32_bf16 v[12:15], a[216:219], a[112:115], v[12:15]
  ds_read_b64_tr_b16 a[214:215], v230 offset:55296
  s_waitcnt lgkmcnt(13)
  v_mfma_f32_16x16x32_bf16 v[64:67], a[220:223], a[96:99], v[64:67]
  ds_read_b64_tr_b16 a[216:217], v231 offset:36864
  v_mfma_f32_16x16x32_bf16 v[64:67], a[224:227], a[112:115], v[64:67]
  ds_read_b64_tr_b16 a[218:219], v231 offset:38912
  s_mov_b32 s40, 11272192
  v_mfma_f32_16x16x32_bf16 v[72:75], a[220:223], a[100:103], v[72:75]
  buffer_load_dwordx4 a[160:163], v225, s[4:7], s40 offen offset:0 sc1
  v_mfma_f32_16x16x32_bf16 v[72:75], a[224:227], a[116:119], v[72:75]
  v_mfma_f32_16x16x32_bf16 v[80:83], a[220:223], a[104:107], v[80:83]
  v_mfma_f32_16x16x32_bf16 v[80:83], a[224:227], a[120:123], v[80:83]
  s_load_dwordx2 s[66:67], s[36:37], 0x5fe80
  v_mfma_f32_16x16x32_bf16 v[88:91], a[220:223], a[108:111], v[88:91]
  ds_read_b64_tr_b16 a[220:221], v231 offset:53248
  v_mfma_f32_16x16x32_bf16 v[88:91], a[224:227], a[124:127], v[88:91]
  buffer_load_dwordx4 a[164:167], v225, s[4:7], s40 offen offset:1024 sc1
  v_mfma_f32_16x16x32_bf16 v[92:95], a[228:231], a[108:111], v[92:95]
  ds_read_b64_tr_b16 a[222:223], v231 offset:55296
  s_waitcnt lgkmcnt(13)
  v_mfma_f32_16x16x32_bf16 v[92:95], a[232:235], a[124:127], v[92:95]
  ds_read_b64_tr_b16 a[224:225], v228 offset:49152
  ds_read_b64_tr_b16 a[226:227], v228 offset:51200
  v_mfma_f32_16x16x32_bf16 v[84:87], a[228:231], a[104:107], v[84:87]
  v_mfma_f32_16x16x32_bf16 v[84:87], a[232:235], a[120:123], v[84:87]
  v_mfma_f32_16x16x32_bf16 v[76:79], a[228:231], a[100:103], v[76:79]
  buffer_load_dwordx4 a[168:171], v225, s[4:7], s40 offen offset:2048 sc1
  v_mfma_f32_16x16x32_bf16 v[76:79], a[232:235], a[116:119], v[76:79]
  v_mfma_f32_16x16x32_bf16 v[68:71], a[228:231], a[96:99], v[68:71]
  ds_read_b64_tr_b16 a[228:229], v228 offset:61440
  v_mfma_f32_16x16x32_bf16 v[68:71], a[232:235], a[112:115], v[68:71]
  ds_read_b64_tr_b16 a[230:231], v228 offset:63488
  v_mfma_f32_16x16x32_bf16 v[96:99], a[192:195], a[96:99], v[96:99]
  ds_read_b64_tr_b16 a[232:233], v229 offset:49152
  s_waitcnt lgkmcnt(13)
  v_mfma_f32_16x16x32_bf16 v[96:99], a[196:199], a[112:115], v[96:99]
  ds_read_b64_tr_b16 a[234:235], v229 offset:51200
  v_mfma_f32_16x16x32_bf16 v[128:131], a[192:195], a[100:103], v[128:131]
  buffer_load_dwordx4 a[172:175], v225, s[4:7], s40 offen offset:3072 sc1
  v_mfma_f32_16x16x32_bf16 v[128:131], a[196:199], a[116:119], v[128:131]
  s_mov_b32 s41, 3211264
  s_add_u32 m0, s42, 16384
  v_mfma_f32_16x16x32_bf16 v[160:163], a[192:195], a[104:107], v[160:163]
  v_mfma_f32_16x16x32_bf16 v[160:163], a[196:199], a[120:123], v[160:163]
  v_mfma_f32_16x16x32_bf16 v[192:195], a[192:195], a[108:111], v[192:195]
  ds_read_b64_tr_b16 a[192:193], v229 offset:61440
  v_mfma_f32_16x16x32_bf16 v[192:195], a[196:199], a[124:127], v[192:195]
  buffer_load_dwordx4 v226, s[12:15], s41 offen offset:0 lds
  v_mfma_f32_16x16x32_bf16 v[196:199], a[200:203], a[108:111], v[196:199]
  ds_read_b64_tr_b16 a[194:195], v229 offset:63488
L_wk1_3:
  s_cbranch_vccnz L_wk1_7
  s_mov_b32 s41, 3440640
  v_mfma_f32_16x16x32_bf16 v[196:199], a[204:207], a[124:127], v[196:199]
  ds_read_b64_tr_b16 a[196:197], v230 offset:49152
  ds_read_b64_tr_b16 a[198:199], v230 offset:51200
  v_mfma_f32_16x16x32_bf16 v[164:167], a[200:203], a[104:107], v[164:167]
  s_add_u32 m0, s42, 12288
  v_mfma_f32_16x16x32_bf16 v[164:167], a[204:207], a[120:123], v[164:167]
  s_load_dwordx2 s[66:67], s[36:37], 0x7fe00
  v_mfma_f32_16x16x32_bf16 v[132:135], a[200:203], a[100:103], v[132:135]
  v_mfma_f32_16x16x32_bf16 v[132:135], a[204:207], a[116:119], v[132:135]
  buffer_load_dwordx4 v226, s[12:15], s41 offen offset:0 lds
  v_mfma_f32_16x16x32_bf16 v[100:103], a[200:203], a[96:99], v[100:103]
  ds_read_b64_tr_b16 a[200:201], v230 offset:61440
  s_mov_b32 s40, 11403264
  v_mfma_f32_16x16x32_bf16 v[100:103], a[204:207], a[112:115], v[100:103]
  ds_read_b64_tr_b16 a[202:203], v230 offset:63488
  s_waitcnt lgkmcnt(13)
  v_mfma_f32_16x16x32_bf16 v[104:107], a[208:211], a[96:99], v[104:107]
  ds_read_b64_tr_b16 a[204:205], v231 offset:49152
  v_mfma_f32_16x16x32_bf16 v[104:107], a[212:215], a[112:115], v[104:107]
  ds_read_b64_tr_b16 a[206:207], v231 offset:51200
  v_mfma_f32_16x16x32_bf16 v[136:139], a[208:211], a[100:103], v[136:139]
  buffer_load_dwordx4 a[176:179], v225, s[4:7], s40 offen offset:0 sc1
  v_mfma_f32_16x16x32_bf16 v[136:139], a[212:215], a[116:119], v[136:139]
  v_mfma_f32_16x16x32_bf16 v[168:171], a[208:211], a[104:107], v[168:171]
  v_mfma_f32_16x16x32_bf16 v[168:171], a[212:215], a[120:123], v[168:171]
  v_mfma_f32_16x16x32_bf16 v[200:203], a[208:211], a[108:111], v[200:203]
  ds_read_b64_tr_b16 a[208:209], v231 offset:61440
  v_mfma_f32_16x16x32_bf16 v[200:203], a[212:215], a[124:127], v[200:203]
  ds_read_b64_tr_b16 a[210:211], v231 offset:63488
  v_mfma_f32_16x16x32_bf16 v[204:207], a[216:219], a[108:111], v[204:207]
  buffer_load_dwordx4 a[180:183], v225, s[4:7], s40 offen offset:1024 sc1
  s_waitcnt lgkmcnt(13)
  v_mfma_f32_16x16x32_bf16 v[204:207], a[220:223], a[124:127], v[204:207]
  s_waitcnt vmcnt(19)
  s_barrier
  v_mfma_f32_16x16x32_bf16 v[172:175], a[216:219], a[104:107], v[172:175]
  ds_read_b64_tr_b16 a[212:213], v232 offset:12288
  ds_read_b64_tr_b16 a[214:215], v232 offset:14336
  v_mfma_f32_16x16x32_bf16 v[172:175], a[220:223], a[120:123], v[172:175]
  v_mfma_f32_16x16x32_bf16 v[140:143], a[216:219], a[100:103], v[140:143]
  v_mfma_f32_16x16x32_bf16 v[140:143], a[220:223], a[116:119], v[140:143]
  buffer_load_dwordx4 a[184:187], v225, s[4:7], s40 offen offset:2048 sc1
  v_mfma_f32_16x16x32_bf16 v[108:111], a[216:219], a[96:99], v[108:111]
  ds_read_b64_tr_b16 a[216:217], v232 offset:8192
  v_mfma_f32_16x16x32_bf16 v[108:111], a[220:223], a[112:115], v[108:111]
  ds_read_b64_tr_b16 a[218:219], v232 offset:10240
  v_mfma_f32_16x16x32_bf16 v[112:115], a[224:227], a[96:99], v[112:115]
  ds_read_b64_tr_b16 a[220:221], v233 offset:12288
  s_waitcnt lgkmcnt(13)
  v_mfma_f32_16x16x32_bf16 v[112:115], a[228:231], a[112:115], v[112:115]
  ds_read_b64_tr_b16 a[222:223], v233 offset:14336
  s_load_dwordx2 s[66:67], s[36:37], 0x9fd80
  v_mfma_f32_16x16x32_bf16 v[144:147], a[224:227], a[100:103], v[144:147]
  v_mfma_f32_16x16x32_bf16 v[144:147], a[228:231], a[116:119], v[144:147]
  buffer_load_dwordx4 a[188:191], v225, s[4:7], s40 offen offset:3072 sc1
  v_mfma_f32_16x16x32_bf16 v[176:179], a[224:227], a[104:107], v[176:179]
  s_mov_b32 s41, 3211264
  s_add_u32 m0, s42, 24576
  v_mfma_f32_16x16x32_bf16 v[176:179], a[228:231], a[120:123], v[176:179]
  v_mfma_f32_16x16x32_bf16 v[208:211], a[224:227], a[108:111], v[208:211]
  ds_read_b64_tr_b16 a[224:225], v233 offset:8192
  v_mfma_f32_16x16x32_bf16 v[208:211], a[228:231], a[124:127], v[208:211]
  ds_read_b64_tr_b16 a[226:227], v233 offset:10240
  s_mov_b32 s78, 5242880
  v_mfma_f32_16x16x32_bf16 v[212:215], a[232:235], a[108:111], v[212:215]
  buffer_load_dwordx4 v226, s[16:19], s41 offen offset:0 lds
  v_mfma_f32_16x16x32_bf16 v[212:215], a[192:195], a[124:127], v[212:215]
  ds_read_b64_tr_b16 a[228:229], v232 offset:20480
  ds_read_b64_tr_b16 a[230:231], v232 offset:22528
  v_mfma_f32_16x16x32_bf16 v[180:183], a[232:235], a[104:107], v[180:183]
  s_mov_b32 s41, 3440640
  s_add_u32 m0, s42, 45056
  v_mfma_f32_16x16x32_bf16 v[180:183], a[192:195], a[120:123], v[180:183]
  buffer_load_dword v241, v247, s[56:59], s78 offen
  v_mfma_f32_16x16x32_bf16 v[148:151], a[232:235], a[100:103], v[148:151]
  v_mfma_f32_16x16x32_bf16 v[148:151], a[192:195], a[116:119], v[148:151]
  v_mfma_f32_16x16x32_bf16 v[116:119], a[232:235], a[96:99], v[116:119]
  buffer_load_dwordx4 v226, s[16:19], s41 offen offset:0 lds
  v_mfma_f32_16x16x32_bf16 v[116:119], a[192:195], a[112:115], v[116:119]
  ds_read_b64_tr_b16 a[232:233], v232 offset:36864
  s_waitcnt lgkmcnt(13)
  v_mfma_f32_16x16x32_bf16 v[120:123], a[196:199], a[96:99], v[120:123]
  ds_read_b64_tr_b16 a[234:235], v232 offset:38912
  v_mfma_f32_16x16x32_bf16 v[120:123], a[200:203], a[112:115], v[120:123]
  ds_read_b64_tr_b16 a[192:193], v233 offset:20480
  ds_read_b64_tr_b16 a[194:195], v233 offset:22528
  v_mfma_f32_16x16x32_bf16 v[152:155], a[196:199], a[100:103], v[152:155]
  v_mfma_f32_16x16x32_bf16 v[152:155], a[200:203], a[116:119], v[152:155]
  v_mfma_f32_16x16x32_bf16 v[184:187], a[196:199], a[104:107], v[184:187]
  v_mfma_f32_16x16x32_bf16 v[184:187], a[200:203], a[120:123], v[184:187]
  v_mfma_f32_16x16x32_bf16 v[216:219], a[196:199], a[108:111], v[216:219]
  ds_read_b64_tr_b16 a[196:197], v233 offset:36864
  v_mfma_f32_16x16x32_bf16 v[216:219], a[200:203], a[124:127], v[216:219]
  ds_read_b64_tr_b16 a[198:199], v233 offset:38912
  s_load_dwordx2 s[66:67], s[36:37], 0xbfd00
  v_mfma_f32_16x16x32_bf16 v[220:223], a[204:207], a[108:111], v[220:223]
  ds_read_b64_tr_b16 a[200:201], v234 offset:12288
  s_waitcnt lgkmcnt(13)
  v_mfma_f32_16x16x32_bf16 v[220:223], a[208:211], a[124:127], v[220:223]
  ds_read_b64_tr_b16 a[202:203], v234 offset:14336
  s_mov_b32 s41, 3670016
  v_mfma_f32_16x16x32_bf16 v[188:191], a[204:207], a[104:107], v[188:191]
  s_add_u32 m0, s42, 57344
  v_mfma_f32_16x16x32_bf16 v[188:191], a[208:211], a[120:123], v[188:191]
  buffer_load_dwordx4 v227, s[12:15], s41 offen offset:0 lds
  v_mfma_f32_16x16x32_bf16 v[156:159], a[204:207], a[100:103], v[156:159]
  v_mfma_f32_16x16x32_bf16 v[156:159], a[208:211], a[116:119], v[156:159]
  v_mfma_f32_16x16x32_bf16 v[124:127], a[204:207], a[96:99], v[124:127]
  ds_read_b64_tr_b16 a[204:205], v234 offset:8192
  v_mfma_f32_16x16x32_bf16 v[124:127], a[208:211], a[112:115], v[124:127]
  ds_read_b64_tr_b16 a[206:207], v234 offset:10240
  v_mfma_f32_16x16x32_bf16 v[0:3], a[212:215], a[128:131], v[0:3]
  ds_read_b64_tr_b16 a[208:209], v234 offset:20480
  s_mov_b32 s41, 3899392
  s_waitcnt vmcnt(21)
  v_mfma_f32_16x16x32_bf16 v[0:3], a[216:219], a[144:147], v[0:3]
  ds_read_b64_tr_b16 a[210:211], v234 offset:22528
  s_add_u32 m0, s42, 65536
  v_mfma_f32_16x16x32_bf16 v[16:19], a[212:215], a[132:135], v[16:19]
  buffer_load_dwordx4 v227, s[12:15], s41 offen offset:0 lds
  v_mfma_f32_16x16x32_bf16 v[16:19], a[216:219], a[148:151], v[16:19]
  v_mfma_f32_16x16x32_bf16 v[32:35], a[212:215], a[136:139], v[32:35]
  v_mfma_f32_16x16x32_bf16 v[32:35], a[216:219], a[152:155], v[32:35]
  v_mfma_f32_16x16x32_bf16 v[48:51], a[212:215], a[140:143], v[48:51]
  ds_read_b64_tr_b16 a[212:213], v234 offset:36864
  v_mfma_f32_16x16x32_bf16 v[48:51], a[216:219], a[156:159], v[48:51]
  ds_read_b64_tr_b16 a[214:215], v234 offset:38912
  s_waitcnt lgkmcnt(13)
  v_mfma_f32_16x16x32_bf16 v[52:55], a[220:223], a[140:143], v[52:55]
  ds_read_b64_tr_b16 a[216:217], v232 offset:32768
  v_mfma_f32_16x16x32_bf16 v[52:55], a[224:227], a[156:159], v[52:55]
  ds_read_b64_tr_b16 a[218:219], v232 offset:34816
  s_mov_b32 s41, 3670016
  v_mfma_f32_16x16x32_bf16 v[36:39], a[220:223], a[136:139], v[36:39]
  s_add_u32 m0, s42, 94208
  v_mfma_f32_16x16x32_bf16 v[36:39], a[224:227], a[152:155], v[36:39]
  buffer_load_dwordx4 v227, s[16:19], s41 offen offset:0 lds
  v_mfma_f32_16x16x32_bf16 v[20:23], a[220:223], a[132:135], v[20:23]
  v_mfma_f32_16x16x32_bf16 v[20:23], a[224:227], a[148:151], v[20:23]
  s_load_dwordx2 s[66:67], s[36:37], 0xdfc80
  s_add_u32 s36, s36, 0xffc00
  s_addc_u32 s37, s37, 0
  v_mfma_f32_16x16x32_bf16 v[4:7], a[220:223], a[128:131], v[4:7]
  ds_read_b64_tr_b16 a[220:221], v232 offset:45056
  v_mfma_f32_16x16x32_bf16 v[4:7], a[224:227], a[144:147], v[4:7]
  ds_read_b64_tr_b16 a[222:223], v232 offset:47104
  v_mfma_f32_16x16x32_bf16 v[8:11], a[228:231], a[128:131], v[8:11]
  ds_read_b64_tr_b16 a[224:225], v233 offset:32768
  s_mov_b32 s41, 3899392
  s_waitcnt lgkmcnt(13)
  v_mfma_f32_16x16x32_bf16 v[8:11], a[232:235], a[144:147], v[8:11]
  s_waitcnt vmcnt(20)
  s_barrier
  v_mfma_f32_16x16x32_bf16 v[24:27], a[228:231], a[132:135], v[24:27]
  ds_read_b64_tr_b16 a[226:227], v233 offset:34816
  s_add_u32 m0, s42, 106496
  v_mfma_f32_16x16x32_bf16 v[24:27], a[232:235], a[148:151], v[24:27]
  buffer_load_dwordx4 v227, s[16:19], s41 offen offset:0 lds
  v_mfma_f32_16x16x32_bf16 v[40:43], a[228:231], a[136:139], v[40:43]
  v_mfma_f32_16x16x32_bf16 v[40:43], a[232:235], a[152:155], v[40:43]
  v_mfma_f32_16x16x32_bf16 v[56:59], a[228:231], a[140:143], v[56:59]
  ds_read_b64_tr_b16 a[228:229], v233 offset:45056
  v_mfma_f32_16x16x32_bf16 v[56:59], a[232:235], a[156:159], v[56:59]
  ds_read_b64_tr_b16 a[230:231], v233 offset:47104
  v_mfma_f32_16x16x32_bf16 v[60:63], a[192:195], a[140:143], v[60:63]
  ds_read_b64_tr_b16 a[232:233], v234 offset:32768
  v_mfma_f32_16x16x32_bf16 v[60:63], a[196:199], a[156:159], v[60:63]
  ds_read_b64_tr_b16 a[234:235], v234 offset:34816
  v_mfma_f32_16x16x32_bf16 v[44:47], a[192:195], a[136:139], v[44:47]
  v_mfma_f32_16x16x32_bf16 v[44:47], a[196:199], a[152:155], v[44:47]
  v_mfma_f32_16x16x32_bf16 v[28:31], a[192:195], a[132:135], v[28:31]
  v_mfma_f32_16x16x32_bf16 v[28:31], a[196:199], a[148:151], v[28:31]
  v_mfma_f32_16x16x32_bf16 v[12:15], a[192:195], a[128:131], v[12:15]
  ds_read_b64_tr_b16 a[192:193], v234 offset:45056
  v_mfma_f32_16x16x32_bf16 v[12:15], a[196:199], a[144:147], v[12:15]
  ds_read_b64_tr_b16 a[194:195], v234 offset:47104
  s_waitcnt lgkmcnt(13)
  v_mfma_f32_16x16x32_bf16 v[64:67], a[200:203], a[128:131], v[64:67]
  ds_read_b64_tr_b16 a[196:197], v235 offset:32768
  v_mfma_f32_16x16x32_bf16 v[64:67], a[204:207], a[144:147], v[64:67]
  ds_read_b64_tr_b16 a[198:199], v235 offset:34816
  s_mov_b32 s40, 11534336
  v_mfma_f32_16x16x32_bf16 v[72:75], a[200:203], a[132:135], v[72:75]
  buffer_load_dwordx4 a[0:3], v225, s[4:7], s40 offen offset:0 sc1
  v_mfma_f32_16x16x32_bf16 v[72:75], a[204:207], a[148:151], v[72:75]
  s_load_dwordx2 s[66:67], s[36:37], 0x0
  v_mfma_f32_16x16x32_bf16 v[80:83], a[200:203], a[136:139], v[80:83]
  v_mfma_f32_16x16x32_bf16 v[80:83], a[204:207], a[152:155], v[80:83]
  v_mfma_f32_16x16x32_bf16 v[88:91], a[200:203], a[140:143], v[88:91]
  ds_read_b64_tr_b16 a[200:201], v235 offset:45056
  v_mfma_f32_16x16x32_bf16 v[88:91], a[204:207], a[156:159], v[88:91]
  buffer_load_dwordx4 a[4:7], v225, s[4:7], s40 offen offset:1024 sc1
  v_mfma_f32_16x16x32_bf16 v[92:95], a[208:211], a[140:143], v[92:95]
  ds_read_b64_tr_b16 a[202:203], v235 offset:47104
  s_waitcnt lgkmcnt(13)
  v_mfma_f32_16x16x32_bf16 v[92:95], a[212:215], a[156:159], v[92:95]
  ds_read_b64_tr_b16 a[204:205], v232 offset:61440
  ds_read_b64_tr_b16 a[206:207], v232 offset:63488
  v_mfma_f32_16x16x32_bf16 v[84:87], a[208:211], a[136:139], v[84:87]
  v_mfma_f32_16x16x32_bf16 v[84:87], a[212:215], a[152:155], v[84:87]
  v_mfma_f32_16x16x32_bf16 v[76:79], a[208:211], a[132:135], v[76:79]
  buffer_load_dwordx4 a[8:11], v225, s[4:7], s40 offen offset:2048 sc1
  v_mfma_f32_16x16x32_bf16 v[76:79], a[212:215], a[148:151], v[76:79]
  v_mfma_f32_16x16x32_bf16 v[68:71], a[208:211], a[128:131], v[68:71]
  ds_read_b64_tr_b16 a[208:209], v232 offset:57344
  v_mfma_f32_16x16x32_bf16 v[68:71], a[212:215], a[144:147], v[68:71]
  ds_read_b64_tr_b16 a[210:211], v232 offset:59392
  v_mfma_f32_16x16x32_bf16 v[96:99], a[216:219], a[128:131], v[96:99]
  ds_read_b64_tr_b16 a[212:213], v233 offset:61440
  s_waitcnt lgkmcnt(13)
  v_mfma_f32_16x16x32_bf16 v[96:99], a[220:223], a[144:147], v[96:99]
  ds_read_b64_tr_b16 a[214:215], v233 offset:63488
  v_mfma_f32_16x16x32_bf16 v[128:131], a[216:219], a[132:135], v[128:131]
  buffer_load_dwordx4 a[12:15], v225, s[4:7], s40 offen offset:3072 sc1
  v_mfma_f32_16x16x32_bf16 v[128:131], a[220:223], a[148:151], v[128:131]
  s_mov_b32 s41, 3670016
  s_add_u32 m0, s42, 114688
  v_mfma_f32_16x16x32_bf16 v[160:163], a[216:219], a[136:139], v[160:163]
  v_mfma_f32_16x16x32_bf16 v[160:163], a[220:223], a[152:155], v[160:163]
  v_mfma_f32_16x16x32_bf16 v[192:195], a[216:219], a[140:143], v[192:195]
  ds_read_b64_tr_b16 a[216:217], v233 offset:57344
  v_mfma_f32_16x16x32_bf16 v[192:195], a[220:223], a[156:159], v[192:195]
  buffer_load_dwordx4 v226, s[12:15], s41 offen offset:0 lds
  v_mfma_f32_16x16x32_bf16 v[196:199], a[224:227], a[140:143], v[196:199]
  ds_read_b64_tr_b16 a[218:219], v233 offset:59392
  s_mov_b32 s41, 3899392
  v_mfma_f32_16x16x32_bf16 v[196:199], a[228:231], a[156:159], v[196:199]
  ds_read_b64_tr_b16 a[220:221], v234 offset:61440
  ds_read_b64_tr_b16 a[222:223], v234 offset:63488
  s_load_dwordx2 s[66:67], s[36:37], 0x1ff80
  v_mfma_f32_16x16x32_bf16 v[164:167], a[224:227], a[136:139], v[164:167]
  s_add_u32 m0, s42, 28672
  v_mfma_f32_16x16x32_bf16 v[164:167], a[228:231], a[152:155], v[164:167]
  s_mov_b32 s78, 5767168
  v_mfma_f32_16x16x32_bf16 v[132:135], a[224:227], a[132:135], v[132:135]
  buffer_load_dword v241, v247, s[56:59], s78 offen
  v_mfma_f32_16x16x32_bf16 v[132:135], a[228:231], a[148:151], v[132:135]
  v_mfma_f32_16x16x32_bf16 v[100:103], a[224:227], a[128:131], v[100:103]
  buffer_load_dwordx4 v226, s[12:15], s41 offen offset:0 lds
  v_mfma_f32_16x16x32_bf16 v[100:103], a[228:231], a[144:147], v[100:103]
  ds_read_b64_tr_b16 a[224:225], v234 offset:57344
  s_mov_b32 s40, 11665408
  s_waitcnt lgkmcnt(13)
  v_mfma_f32_16x16x32_bf16 v[104:107], a[232:235], a[128:131], v[104:107]
  ds_read_b64_tr_b16 a[226:227], v234 offset:59392
  v_mfma_f32_16x16x32_bf16 v[104:107], a[192:195], a[144:147], v[104:107]
  ds_read_b64_tr_b16 a[228:229], v235 offset:61440
  ds_read_b64_tr_b16 a[230:231], v235 offset:63488
  v_mfma_f32_16x16x32_bf16 v[136:139], a[232:235], a[132:135], v[136:139]
  v_mfma_f32_16x16x32_bf16 v[136:139], a[192:195], a[148:151], v[136:139]
  buffer_load_dwordx4 a[16:19], v225, s[4:7], s40 offen offset:0 sc1
  v_mfma_f32_16x16x32_bf16 v[168:171], a[232:235], a[136:139], v[168:171]
  v_mfma_f32_16x16x32_bf16 v[168:171], a[192:195], a[152:155], v[168:171]
  v_mfma_f32_16x16x32_bf16 v[200:203], a[232:235], a[140:143], v[200:203]
  ds_read_b64_tr_b16 a[232:233], v235 offset:57344
  v_mfma_f32_16x16x32_bf16 v[200:203], a[192:195], a[156:159], v[200:203]
  ds_read_b64_tr_b16 a[234:235], v235 offset:59392
  v_mfma_f32_16x16x32_bf16 v[204:207], a[196:199], a[140:143], v[204:207]
  buffer_load_dwordx4 a[20:23], v225, s[4:7], s40 offen offset:1024 sc1
  s_waitcnt lgkmcnt(13)
  v_mfma_f32_16x16x32_bf16 v[204:207], a[200:203], a[156:159], v[204:207]
  s_waitcnt vmcnt(20)
  s_barrier
  v_mfma_f32_16x16x32_bf16 v[172:175], a[196:199], a[136:139], v[172:175]
  ds_read_b64_tr_b16 a[192:193], v236 offset:4096
  ds_read_b64_tr_b16 a[194:195], v236 offset:6144
  v_mfma_f32_16x16x32_bf16 v[172:175], a[200:203], a[152:155], v[172:175]
  v_mfma_f32_16x16x32_bf16 v[140:143], a[196:199], a[132:135], v[140:143]
  v_mfma_f32_16x16x32_bf16 v[140:143], a[200:203], a[148:151], v[140:143]
  v_mfma_f32_16x16x32_bf16 v[108:111], a[196:199], a[128:131], v[108:111]
  buffer_load_dwordx4 a[24:27], v225, s[4:7], s40 offen offset:2048 sc1
  v_mfma_f32_16x16x32_bf16 v[108:111], a[200:203], a[144:147], v[108:111]
  ds_read_b64_tr_b16 a[196:197], v236 offset:20480
  s_load_dwordx2 s[66:67], s[36:37], 0x3ff00
  v_mfma_f32_16x16x32_bf16 v[112:115], a[204:207], a[128:131], v[112:115]
  ds_read_b64_tr_b16 a[198:199], v236 offset:22528
  s_waitcnt lgkmcnt(13)
  v_mfma_f32_16x16x32_bf16 v[112:115], a[208:211], a[144:147], v[112:115]
  ds_read_b64_tr_b16 a[200:201], v237 offset:4096
  ds_read_b64_tr_b16 a[202:203], v237 offset:6144
  v_mfma_f32_16x16x32_bf16 v[144:147], a[204:207], a[132:135], v[144:147]
  v_mfma_f32_16x16x32_bf16 v[144:147], a[208:211], a[148:151], v[144:147]
  buffer_load_dwordx4 a[28:31], v225, s[4:7], s40 offen offset:3072 sc1
  v_mfma_f32_16x16x32_bf16 v[176:179], a[204:207], a[136:139], v[176:179]
  s_mov_b32 s41, 3670016
  s_add_u32 m0, s42, 32768
  v_mfma_f32_16x16x32_bf16 v[176:179], a[208:211], a[152:155], v[176:179]
  v_mfma_f32_16x16x32_bf16 v[208:211], a[204:207], a[140:143], v[208:211]
  ds_read_b64_tr_b16 a[204:205], v237 offset:20480
  v_mfma_f32_16x16x32_bf16 v[208:211], a[208:211], a[156:159], v[208:211]
  ds_read_b64_tr_b16 a[206:207], v237 offset:22528
  v_mfma_f32_16x16x32_bf16 v[212:215], a[212:215], a[140:143], v[212:215]
  ds_read_b64_tr_b16 a[208:209], v236 offset:16384
  s_waitcnt lgkmcnt(13)
  v_mfma_f32_16x16x32_bf16 v[212:215], a[216:219], a[156:159], v[212:215]
  buffer_load_dwordx4 v226, s[16:19], s41 offen offset:0 lds
  v_mfma_f32_16x16x32_bf16 v[180:183], a[212:215], a[136:139], v[180:183]
  ds_read_b64_tr_b16 a[210:211], v236 offset:18432
  s_mov_b32 s41, 3899392
  v_mfma_f32_16x16x32_bf16 v[180:183], a[216:219], a[152:155], v[180:183]
  s_add_u32 m0, s42, 40960
  v_mfma_f32_16x16x32_bf16 v[148:151], a[212:215], a[132:135], v[148:151]
  v_mfma_f32_16x16x32_bf16 v[148:151], a[216:219], a[148:151], v[148:151]
  v_mfma_f32_16x16x32_bf16 v[116:119], a[212:215], a[128:131], v[116:119]
  buffer_load_dwordx4 v226, s[16:19], s41 offen offset:0 lds
  v_mfma_f32_16x16x32_bf16 v[116:119], a[216:219], a[144:147], v[116:119]
  ds_read_b64_tr_b16 a[212:213], v236 offset:28672
  v_mfma_f32_16x16x32_bf16 v[120:123], a[220:223], a[128:131], v[120:123]
  ds_read_b64_tr_b16 a[214:215], v236 offset:30720
  v_mfma_f32_16x16x32_bf16 v[120:123], a[224:227], a[144:147], v[120:123]
  ds_read_b64_tr_b16 a[216:217], v237 offset:16384
  ds_read_b64_tr_b16 a[218:219], v237 offset:18432
  v_mfma_f32_16x16x32_bf16 v[152:155], a[220:223], a[132:135], v[152:155]
  v_mfma_f32_16x16x32_bf16 v[152:155], a[224:227], a[148:151], v[152:155]
  v_mfma_f32_16x16x32_bf16 v[184:187], a[220:223], a[136:139], v[184:187]
  v_mfma_f32_16x16x32_bf16 v[184:187], a[224:227], a[152:155], v[184:187]
  s_load_dwordx2 s[66:67], s[36:37], 0x5fe80
  v_mfma_f32_16x16x32_bf16 v[216:219], a[220:223], a[140:143], v[216:219]
  ds_read_b64_tr_b16 a[220:221], v237 offset:28672
  v_mfma_f32_16x16x32_bf16 v[216:219], a[224:227], a[156:159], v[216:219]
  ds_read_b64_tr_b16 a[222:223], v237 offset:30720
  s_waitcnt lgkmcnt(13)
  v_mfma_f32_16x16x32_bf16 v[220:223], a[228:231], a[140:143], v[220:223]
  ds_read_b64_tr_b16 a[224:225], v238 offset:4096
  v_mfma_f32_16x16x32_bf16 v[220:223], a[232:235], a[156:159], v[220:223]
  ds_read_b64_tr_b16 a[226:227], v238 offset:6144
  s_mov_b32 s41, 4128768
  v_mfma_f32_16x16x32_bf16 v[188:191], a[228:231], a[136:139], v[188:191]
  s_add_u32 m0, s42, 69632
  v_mfma_f32_16x16x32_bf16 v[188:191], a[232:235], a[152:155], v[188:191]
  buffer_load_dwordx4 v227, s[12:15], s41 offen offset:0 lds
  v_mfma_f32_16x16x32_bf16 v[156:159], a[228:231], a[132:135], v[156:159]
  v_mfma_f32_16x16x32_bf16 v[156:159], a[232:235], a[148:151], v[156:159]
  v_mfma_f32_16x16x32_bf16 v[124:127], a[228:231], a[128:131], v[124:127]
  ds_read_b64_tr_b16 a[228:229], v238 offset:20480
  v_mfma_f32_16x16x32_bf16 v[124:127], a[232:235], a[144:147], v[124:127]
  ds_read_b64_tr_b16 a[230:231], v238 offset:22528
  v_mfma_f32_16x16x32_bf16 v[0:3], a[192:195], a[160:163], v[0:3]
  ds_read_b64_tr_b16 a[232:233], v238 offset:16384
  s_mov_b32 s41, 4358144
  s_waitcnt vmcnt(21) lgkmcnt(13)
  v_mfma_f32_16x16x32_bf16 v[0:3], a[196:199], a[176:179], v[0:3]
  ds_read_b64_tr_b16 a[234:235], v238 offset:18432
  s_add_u32 m0, s42, 81920
  v_mfma_f32_16x16x32_bf16 v[16:19], a[192:195], a[164:167], v[16:19]
  buffer_load_dwordx4 v227, s[12:15], s41 offen offset:0 lds
  v_mfma_f32_16x16x32_bf16 v[16:19], a[196:199], a[180:183], v[16:19]
  v_mfma_f32_16x16x32_bf16 v[32:35], a[192:195], a[168:171], v[32:35]
  v_mfma_f32_16x16x32_bf16 v[32:35], a[196:199], a[184:187], v[32:35]
  v_mfma_f32_16x16x32_bf16 v[48:51], a[192:195], a[172:175], v[48:51]
  ds_read_b64_tr_b16 a[192:193], v238 offset:28672
  v_mfma_f32_16x16x32_bf16 v[48:51], a[196:199], a[188:191], v[48:51]
  ds_read_b64_tr_b16 a[194:195], v238 offset:30720
  v_mfma_f32_16x16x32_bf16 v[52:55], a[200:203], a[172:175], v[52:55]
  ds_read_b64_tr_b16 a[196:197], v228 offset:16384
  v_mfma_f32_16x16x32_bf16 v[52:55], a[204:207], a[188:191], v[52:55]
  ds_read_b64_tr_b16 a[198:199], v228 offset:18432
  s_mov_b32 s41, 4128768
  v_mfma_f32_16x16x32_bf16 v[36:39], a[200:203], a[168:171], v[36:39]
  s_add_u32 m0, s42, 90112
  v_mfma_f32_16x16x32_bf16 v[36:39], a[204:207], a[184:187], v[36:39]
  buffer_load_dwordx4 v227, s[16:19], s41 offen offset:0 lds
  s_load_dwordx2 s[66:67], s[36:37], 0x7fe00
  v_mfma_f32_16x16x32_bf16 v[20:23], a[200:203], a[164:167], v[20:23]
  v_mfma_f32_16x16x32_bf16 v[20:23], a[204:207], a[180:183], v[20:23]
  v_mfma_f32_16x16x32_bf16 v[4:7], a[200:203], a[160:163], v[4:7]
  ds_read_b64_tr_b16 a[200:201], v228 offset:12288
  v_mfma_f32_16x16x32_bf16 v[4:7], a[204:207], a[176:179], v[4:7]
  ds_read_b64_tr_b16 a[202:203], v228 offset:14336
  s_waitcnt lgkmcnt(13)
  v_mfma_f32_16x16x32_bf16 v[8:11], a[208:211], a[160:163], v[8:11]
  ds_read_b64_tr_b16 a[204:205], v229 offset:16384
  s_mov_b32 s41, 4358144
  v_mfma_f32_16x16x32_bf16 v[8:11], a[212:215], a[176:179], v[8:11]
  s_waitcnt vmcnt(19)
  s_barrier
  v_mfma_f32_16x16x32_bf16 v[24:27], a[208:211], a[164:167], v[24:27]
  ds_read_b64_tr_b16 a[206:207], v229 offset:18432
  s_add_u32 m0, s42, 118784
  v_mfma_f32_16x16x32_bf16 v[24:27], a[212:215], a[180:183], v[24:27]
  buffer_load_dwordx4 v227, s[16:19], s41 offen offset:0 lds
  v_mfma_f32_16x16x32_bf16 v[40:43], a[208:211], a[168:171], v[40:43]
  v_mfma_f32_16x16x32_bf16 v[40:43], a[212:215], a[184:187], v[40:43]
  v_mfma_f32_16x16x32_bf16 v[56:59], a[208:211], a[172:175], v[56:59]
  ds_read_b64_tr_b16 a[208:209], v229 offset:12288
  v_mfma_f32_16x16x32_bf16 v[56:59], a[212:215], a[188:191], v[56:59]
  ds_read_b64_tr_b16 a[210:211], v229 offset:14336
  v_mfma_f32_16x16x32_bf16 v[60:63], a[216:219], a[172:175], v[60:63]
  ds_read_b64_tr_b16 a[212:213], v230 offset:16384
  s_waitcnt lgkmcnt(13)
  v_mfma_f32_16x16x32_bf16 v[60:63], a[220:223], a[188:191], v[60:63]
  ds_read_b64_tr_b16 a[214:215], v230 offset:18432
  v_mfma_f32_16x16x32_bf16 v[44:47], a[216:219], a[168:171], v[44:47]
  v_mfma_f32_16x16x32_bf16 v[44:47], a[220:223], a[184:187], v[44:47]
  v_mfma_f32_16x16x32_bf16 v[28:31], a[216:219], a[164:167], v[28:31]
  v_mfma_f32_16x16x32_bf16 v[28:31], a[220:223], a[180:183], v[28:31]
  v_mfma_f32_16x16x32_bf16 v[12:15], a[216:219], a[160:163], v[12:15]
  ds_read_b64_tr_b16 a[216:217], v230 offset:12288
  v_mfma_f32_16x16x32_bf16 v[12:15], a[220:223], a[176:179], v[12:15]
  ds_read_b64_tr_b16 a[218:219], v230 offset:14336
  s_mov_b32 s78, 6291456
  v_mfma_f32_16x16x32_bf16 v[64:67], a[224:227], a[160:163], v[64:67]
  ds_read_b64_tr_b16 a[220:221], v231 offset:16384
  v_mfma_f32_16x16x32_bf16 v[64:67], a[228:231], a[176:179], v[64:67]
  ds_read_b64_tr_b16 a[222:223], v231 offset:18432
  s_mov_b32 s40, 11796480
  s_load_dwordx2 s[66:67], s[36:37], 0x9fd80
  v_mfma_f32_16x16x32_bf16 v[72:75], a[224:227], a[164:167], v[72:75]
  buffer_load_dwordx4 a[32:35], v225, s[4:7], s40 offen offset:0 sc1
  v_mfma_f32_16x16x32_bf16 v[72:75], a[228:231], a[180:183], v[72:75]
  buffer_load_dword v241, v247, s[56:59], s78 offen
  v_mfma_f32_16x16x32_bf16 v[80:83], a[224:227], a[168:171], v[80:83]
  v_mfma_f32_16x16x32_bf16 v[80:83], a[228:231], a[184:187], v[80:83]
  v_mfma_f32_16x16x32_bf16 v[88:91], a[224:227], a[172:175], v[88:91]
  ds_read_b64_tr_b16 a[224:225], v231 offset:12288
  v_mfma_f32_16x16x32_bf16 v[88:91], a[228:231], a[188:191], v[88:91]
  buffer_load_dwordx4 a[36:39], v225, s[4:7], s40 offen offset:1024 sc1
  s_waitcnt lgkmcnt(13)
  v_mfma_f32_16x16x32_bf16 v[92:95], a[232:235], a[172:175], v[92:95]
  ds_read_b64_tr_b16 a[226:227], v231 offset:14336
  v_mfma_f32_16x16x32_bf16 v[92:95], a[192:195], a[188:191], v[92:95]
  ds_read_b64_tr_b16 a[228:229], v228 offset:24576
  ds_read_b64_tr_b16 a[230:231], v228 offset:26624
  v_mfma_f32_16x16x32_bf16 v[84:87], a[232:235], a[168:171], v[84:87]
  v_mfma_f32_16x16x32_bf16 v[84:87], a[192:195], a[184:187], v[84:87]
  v_mfma_f32_16x16x32_bf16 v[76:79], a[232:235], a[164:167], v[76:79]
  buffer_load_dwordx4 a[40:43], v225, s[4:7], s40 offen offset:2048 sc1
  v_mfma_f32_16x16x32_bf16 v[76:79], a[192:195], a[180:183], v[76:79]
  v_mfma_f32_16x16x32_bf16 v[68:71], a[232:235], a[160:163], v[68:71]
  ds_read_b64_tr_b16 a[232:233], v228 offset:45056
  v_mfma_f32_16x16x32_bf16 v[68:71], a[192:195], a[176:179], v[68:71]
  ds_read_b64_tr_b16 a[234:235], v228 offset:47104
  v_mfma_f32_16x16x32_bf16 v[96:99], a[196:199], a[160:163], v[96:99]
  ds_read_b64_tr_b16 a[192:193], v229 offset:24576
  s_waitcnt lgkmcnt(13)
  v_mfma_f32_16x16x32_bf16 v[96:99], a[200:203], a[176:179], v[96:99]
  ds_read_b64_tr_b16 a[194:195], v229 offset:26624
  v_mfma_f32_16x16x32_bf16 v[128:131], a[196:199], a[164:167], v[128:131]
  buffer_load_dwordx4 a[44:47], v225, s[4:7], s40 offen offset:3072 sc1
  v_mfma_f32_16x16x32_bf16 v[128:131], a[200:203], a[180:183], v[128:131]
  s_mov_b32 s41, 4128768
  s_add_u32 m0, s42, 131072
  v_mfma_f32_16x16x32_bf16 v[160:163], a[196:199], a[168:171], v[160:163]
  v_mfma_f32_16x16x32_bf16 v[160:163], a[200:203], a[184:187], v[160:163]
  v_mfma_f32_16x16x32_bf16 v[192:195], a[196:199], a[172:175], v[192:195]
  ds_read_b64_tr_b16 a[196:197], v229 offset:45056
  v_mfma_f32_16x16x32_bf16 v[192:195], a[200:203], a[188:191], v[192:195]
  buffer_load_dwordx4 v226, s[12:15], s41 offen offset:0 lds
  s_load_dwordx2 s[66:67], s[36:37], 0xbfd00
  v_mfma_f32_16x16x32_bf16 v[196:199], a[204:207], a[172:175], v[196:199]
  ds_read_b64_tr_b16 a[198:199], v229 offset:47104
  s_mov_b32 s41, 4358144
  v_mfma_f32_16x16x32_bf16 v[196:199], a[208:211], a[188:191], v[196:199]
  ds_read_b64_tr_b16 a[200:201], v230 offset:24576
  ds_read_b64_tr_b16 a[202:203], v230 offset:26624
  v_mfma_f32_16x16x32_bf16 v[164:167], a[204:207], a[168:171], v[164:167]
  s_add_u32 m0, s42, 139264
  v_mfma_f32_16x16x32_bf16 v[164:167], a[208:211], a[184:187], v[164:167]
  v_mfma_f32_16x16x32_bf16 v[132:135], a[204:207], a[164:167], v[132:135]
  v_mfma_f32_16x16x32_bf16 v[132:135], a[208:211], a[180:183], v[132:135]
  buffer_load_dwordx4 v226, s[12:15], s41 offen offset:0 lds
  v_mfma_f32_16x16x32_bf16 v[100:103], a[204:207], a[160:163], v[100:103]
  ds_read_b64_tr_b16 a[204:205], v230 offset:45056
  s_mov_b32 s40, 11927552
  v_mfma_f32_16x16x32_bf16 v[100:103], a[208:211], a[176:179], v[100:103]
  ds_read_b64_tr_b16 a[206:207], v230 offset:47104
  s_waitcnt lgkmcnt(13)
  v_mfma_f32_16x16x32_bf16 v[104:107], a[212:215], a[160:163], v[104:107]
  ds_read_b64_tr_b16 a[208:209], v231 offset:24576
  v_mfma_f32_16x16x32_bf16 v[104:107], a[216:219], a[176:179], v[104:107]
  ds_read_b64_tr_b16 a[210:211], v231 offset:26624
  v_mfma_f32_16x16x32_bf16 v[136:139], a[212:215], a[164:167], v[136:139]
  buffer_load_dwordx4 a[48:51], v225, s[4:7], s40 offen offset:0 sc1
  v_mfma_f32_16x16x32_bf16 v[136:139], a[216:219], a[180:183], v[136:139]
  v_mfma_f32_16x16x32_bf16 v[168:171], a[212:215], a[168:171], v[168:171]
  v_mfma_f32_16x16x32_bf16 v[168:171], a[216:219], a[184:187], v[168:171]
  v_mfma_f32_16x16x32_bf16 v[200:203], a[212:215], a[172:175], v[200:203]
  ds_read_b64_tr_b16 a[212:213], v231 offset:45056
  v_mfma_f32_16x16x32_bf16 v[200:203], a[216:219], a[188:191], v[200:203]
  ds_read_b64_tr_b16 a[214:215], v231 offset:47104
  v_mfma_f32_16x16x32_bf16 v[204:207], a[220:223], a[172:175], v[204:207]
  buffer_load_dwordx4 a[52:55], v225, s[4:7], s40 offen offset:1024 sc1
  s_waitcnt lgkmcnt(13)
  v_mfma_f32_16x16x32_bf16 v[204:207], a[224:227], a[188:191], v[204:207]
  s_waitcnt vmcnt(19)
  s_barrier
  v_mfma_f32_16x16x32_bf16 v[172:175], a[220:223], a[168:171], v[172:175]
  ds_read_b64_tr_b16 a[216:217], v228 offset:57344
  ds_read_b64_tr_b16 a[218:219], v228 offset:59392
  v_mfma_f32_16x16x32_bf16 v[172:175], a[224:227], a[184:187], v[172:175]
  v_mfma_f32_16x16x32_bf16 v[140:143], a[220:223], a[164:167], v[140:143]
  v_mfma_f32_16x16x32_bf16 v[140:143], a[224:227], a[180:183], v[140:143]
  buffer_load_dwordx4 a[56:59], v225, s[4:7], s40 offen offset:2048 sc1
  s_load_dwordx2 s[66:67], s[36:37], 0xdfc80
  s_add_u32 s36, s36, 0xffc00
  s_addc_u32 s37, s37, 0
  v_mfma_f32_16x16x32_bf16 v[108:111], a[220:223], a[160:163], v[108:111]
  ds_read_b64_tr_b16 a[220:221], v232 offset:0
  v_mfma_f32_16x16x32_bf16 v[108:111], a[224:227], a[176:179], v[108:111]
  ds_read_b64_tr_b16 a[222:223], v232 offset:2048
  v_mfma_f32_16x16x32_bf16 v[112:115], a[228:231], a[160:163], v[112:115]
  ds_read_b64_tr_b16 a[224:225], v229 offset:57344
  s_waitcnt lgkmcnt(13)
  v_mfma_f32_16x16x32_bf16 v[112:115], a[232:235], a[176:179], v[112:115]
  ds_read_b64_tr_b16 a[226:227], v229 offset:59392
  v_mfma_f32_16x16x32_bf16 v[144:147], a[228:231], a[164:167], v[144:147]
  v_mfma_f32_16x16x32_bf16 v[144:147], a[232:235], a[180:183], v[144:147]
  buffer_load_dwordx4 a[60:63], v225, s[4:7], s40 offen offset:3072 sc1
  v_mfma_f32_16x16x32_bf16 v[176:179], a[228:231], a[168:171], v[176:179]
  s_mov_b32 s41, 4128768
  s_add_u32 m0, s42, 20480
  v_mfma_f32_16x16x32_bf16 v[176:179], a[232:235], a[184:187], v[176:179]
  v_mfma_f32_16x16x32_bf16 v[208:211], a[228:231], a[172:175], v[208:211]
  ds_read_b64_tr_b16 a[228:229], v233 offset:0
  v_mfma_f32_16x16x32_bf16 v[208:211], a[232:235], a[188:191], v[208:211]
  ds_read_b64_tr_b16 a[230:231], v233 offset:2048
  v_mfma_f32_16x16x32_bf16 v[212:215], a[192:195], a[172:175], v[212:215]
  buffer_load_dwordx4 v226, s[16:19], s41 offen offset:0 lds
  v_mfma_f32_16x16x32_bf16 v[212:215], a[196:199], a[188:191], v[212:215]
  ds_read_b64_tr_b16 a[232:233], v232 offset:28672
  ds_read_b64_tr_b16 a[234:235], v232 offset:30720
  v_mfma_f32_16x16x32_bf16 v[180:183], a[192:195], a[168:171], v[180:183]
  s_mov_b32 s41, 4358144
  s_add_u32 m0, s42, 143360
  v_mfma_f32_16x16x32_bf16 v[180:183], a[196:199], a[184:187], v[180:183]
  v_mfma_f32_16x16x32_bf16 v[148:151], a[192:195], a[164:167], v[148:151]
  v_mfma_f32_16x16x32_bf16 v[148:151], a[196:199], a[180:183], v[148:151]
  v_mfma_f32_16x16x32_bf16 v[116:119], a[192:195], a[160:163], v[116:119]
  buffer_load_dwordx4 v226, s[16:19], s41 offen offset:0 lds
L_wk1_4:
  s_cbranch_vccnz L_wk1_end
  v_mfma_f32_16x16x32_bf16 v[116:119], a[196:199], a[176:179], v[116:119]
  ds_read_b64_tr_b16 a[192:193], v232 offset:40960
  s_waitcnt lgkmcnt(13)
  v_mfma_f32_16x16x32_bf16 v[120:123], a[200:203], a[160:163], v[120:123]
  ds_read_b64_tr_b16 a[194:195], v232 offset:43008
  v_mfma_f32_16x16x32_bf16 v[120:123], a[204:207], a[176:179], v[120:123]
  ds_read_b64_tr_b16 a[196:197], v233 offset:28672
  ds_read_b64_tr_b16 a[198:199], v233 offset:30720
  v_mfma_f32_16x16x32_bf16 v[152:155], a[200:203], a[164:167], v[152:155]
  v_mfma_f32_16x16x32_bf16 v[152:155], a[204:207], a[180:183], v[152:155]
  s_load_dwordx2 s[66:67], s[36:37], 0x0
  v_mfma_f32_16x16x32_bf16 v[184:187], a[200:203], a[168:171], v[184:187]
  v_mfma_f32_16x16x32_bf16 v[184:187], a[204:207], a[184:187], v[184:187]
  v_mfma_f32_16x16x32_bf16 v[216:219], a[200:203], a[172:175], v[216:219]
  ds_read_b64_tr_b16 a[200:201], v233 offset:40960
  v_mfma_f32_16x16x32_bf16 v[216:219], a[204:207], a[188:191], v[216:219]
  ds_read_b64_tr_b16 a[202:203], v233 offset:43008
  v_mfma_f32_16x16x32_bf16 v[220:223], a[208:211], a[172:175], v[220:223]
  ds_read_b64_tr_b16 a[204:205], v230 offset:57344
  s_waitcnt lgkmcnt(13)
  v_mfma_f32_16x16x32_bf16 v[220:223], a[212:215], a[188:191], v[220:223]
  ds_read_b64_tr_b16 a[206:207], v230 offset:59392
  s_mov_b32 s41, 4587520
  v_mfma_f32_16x16x32_bf16 v[188:191], a[208:211], a[168:171], v[188:191]
  s_add_u32 m0, s42, 155648
  v_mfma_f32_16x16x32_bf16 v[188:191], a[212:215], a[184:187], v[188:191]
  buffer_load_dwordx4 v227, s[12:15], s41 offen offset:0 lds
  v_mfma_f32_16x16x32_bf16 v[156:159], a[208:211], a[164:167], v[156:159]
  v_mfma_f32_16x16x32_bf16 v[156:159], a[212:215], a[180:183], v[156:159]
  v_mfma_f32_16x16x32_bf16 v[124:127], a[208:211], a[160:163], v[124:127]
  ds_read_b64_tr_b16 a[208:209], v234 offset:0
  v_mfma_f32_16x16x32_bf16 v[124:127], a[212:215], a[176:179], v[124:127]
  ds_read_b64_tr_b16 a[210:211], v234 offset:2048
  v_mfma_f32_16x16x32_bf16 v[0:3], a[216:219], a[0:3], v[0:3]
  ds_read_b64_tr_b16 a[212:213], v234 offset:28672
  s_mov_b32 s41, 4816896
  s_waitcnt vmcnt(20)
  v_mfma_f32_16x16x32_bf16 v[0:3], a[220:223], a[16:19], v[0:3]
  ds_read_b64_tr_b16 a[214:215], v234 offset:30720
  s_add_u32 m0, s42, 36864
  v_mfma_f32_16x16x32_bf16 v[16:19], a[216:219], a[4:7], v[16:19]
  buffer_load_dwordx4 v227, s[12:15], s41 offen offset:0 lds
  v_mfma_f32_16x16x32_bf16 v[16:19], a[220:223], a[20:23], v[16:19]
  s_mov_b32 s78, 6815744
  v_mfma_f32_16x16x32_bf16 v[32:35], a[216:219], a[8:11], v[32:35]
  buffer_load_dword v241, v247, s[56:59], s78 offen
  v_mfma_f32_16x16x32_bf16 v[32:35], a[220:223], a[24:27], v[32:35]
  v_mfma_f32_16x16x32_bf16 v[48:51], a[216:219], a[12:15], v[48:51]
  ds_read_b64_tr_b16 a[216:217], v234 offset:40960
  v_mfma_f32_16x16x32_bf16 v[48:51], a[220:223], a[28:31], v[48:51]
  ds_read_b64_tr_b16 a[218:219], v234 offset:43008
  s_waitcnt lgkmcnt(13)
  v_mfma_f32_16x16x32_bf16 v[52:55], a[224:227], a[12:15], v[52:55]
  ds_read_b64_tr_b16 a[220:221], v232 offset:49152
  v_mfma_f32_16x16x32_bf16 v[52:55], a[228:231], a[28:31], v[52:55]
  ds_read_b64_tr_b16 a[222:223], v232 offset:51200
  s_mov_b32 s41, 4587520
  s_load_dwordx2 s[66:67], s[36:37], 0x1ff80
  v_mfma_f32_16x16x32_bf16 v[36:39], a[224:227], a[8:11], v[36:39]
  s_add_u32 m0, s42, 53248
  v_mfma_f32_16x16x32_bf16 v[36:39], a[228:231], a[24:27], v[36:39]
  buffer_load_dwordx4 v227, s[16:19], s41 offen offset:0 lds
  v_mfma_f32_16x16x32_bf16 v[20:23], a[224:227], a[4:7], v[20:23]
  v_mfma_f32_16x16x32_bf16 v[20:23], a[228:231], a[20:23], v[20:23]
  v_mfma_f32_16x16x32_bf16 v[4:7], a[224:227], a[0:3], v[4:7]
  ds_read_b64_tr_b16 a[224:225], v228 offset:28672
  v_mfma_f32_16x16x32_bf16 v[4:7], a[228:231], a[16:19], v[4:7]
  ds_read_b64_tr_b16 a[226:227], v228 offset:30720
  v_mfma_f32_16x16x32_bf16 v[8:11], a[232:235], a[0:3], v[8:11]
  ds_read_b64_tr_b16 a[228:229], v233 offset:49152
  s_mov_b32 s41, 4816896
  s_waitcnt lgkmcnt(13)
  v_mfma_f32_16x16x32_bf16 v[8:11], a[192:195], a[16:19], v[8:11]
  s_waitcnt vmcnt(20)
  s_barrier
  v_mfma_f32_16x16x32_bf16 v[24:27], a[232:235], a[4:7], v[24:27]
  ds_read_b64_tr_b16 a[230:231], v233 offset:51200
  s_add_u32 m0, s42, 49152
  v_mfma_f32_16x16x32_bf16 v[24:27], a[192:195], a[20:23], v[24:27]
  buffer_load_dwordx4 v227, s[16:19], s41 offen offset:0 lds
  v_mfma_f32_16x16x32_bf16 v[40:43], a[232:235], a[8:11], v[40:43]
  v_mfma_f32_16x16x32_bf16 v[40:43], a[192:195], a[24:27], v[40:43]
  v_mfma_f32_16x16x32_bf16 v[56:59], a[232:235], a[12:15], v[56:59]
  ds_read_b64_tr_b16 a[232:233], v229 offset:28672
  v_mfma_f32_16x16x32_bf16 v[56:59], a[192:195], a[28:31], v[56:59]
  ds_read_b64_tr_b16 a[234:235], v229 offset:30720
  v_mfma_f32_16x16x32_bf16 v[60:63], a[196:199], a[12:15], v[60:63]
  ds_read_b64_tr_b16 a[192:193], v234 offset:49152
  v_mfma_f32_16x16x32_bf16 v[60:63], a[200:203], a[28:31], v[60:63]
  ds_read_b64_tr_b16 a[194:195], v234 offset:51200
  v_mfma_f32_16x16x32_bf16 v[44:47], a[196:199], a[8:11], v[44:47]
  v_mfma_f32_16x16x32_bf16 v[44:47], a[200:203], a[24:27], v[44:47]
  v_mfma_f32_16x16x32_bf16 v[28:31], a[196:199], a[4:7], v[28:31]
  v_mfma_f32_16x16x32_bf16 v[28:31], a[200:203], a[20:23], v[28:31]
  v_mfma_f32_16x16x32_bf16 v[12:15], a[196:199], a[0:3], v[12:15]
  ds_read_b64_tr_b16 a[196:197], v230 offset:28672
  v_mfma_f32_16x16x32_bf16 v[12:15], a[200:203], a[16:19], v[12:15]
  ds_read_b64_tr_b16 a[198:199], v230 offset:30720
  s_load_dwordx2 s[66:67], s[36:37], 0x3ff00
  s_waitcnt lgkmcnt(13)
  v_mfma_f32_16x16x32_bf16 v[64:67], a[204:207], a[0:3], v[64:67]
  ds_read_b64_tr_b16 a[200:201], v235 offset:49152
  v_mfma_f32_16x16x32_bf16 v[64:67], a[208:211], a[16:19], v[64:67]
  ds_read_b64_tr_b16 a[202:203], v235 offset:51200
  s_mov_b32 s40, 12058624
  v_mfma_f32_16x16x32_bf16 v[72:75], a[204:207], a[4:7], v[72:75]
  buffer_load_dwordx4 a[64:67], v225, s[4:7], s40 offen offset:0 sc1
  v_mfma_f32_16x16x32_bf16 v[72:75], a[208:211], a[20:23], v[72:75]
  v_mfma_f32_16x16x32_bf16 v[80:83], a[204:207], a[8:11], v[80:83]
  v_mfma_f32_16x16x32_bf16 v[80:83], a[208:211], a[24:27], v[80:83]
  v_mfma_f32_16x16x32_bf16 v[88:91], a[204:207], a[12:15], v[88:91]
  ds_read_b64_tr_b16 a[204:205], v231 offset:28672
  v_mfma_f32_16x16x32_bf16 v[88:91], a[208:211], a[28:31], v[88:91]
  buffer_load_dwordx4 a[68:71], v225, s[4:7], s40 offen offset:1024 sc1
  v_mfma_f32_16x16x32_bf16 v[92:95], a[212:215], a[12:15], v[92:95]
  ds_read_b64_tr_b16 a[206:207], v231 offset:30720
  s_waitcnt lgkmcnt(13)
  v_mfma_f32_16x16x32_bf16 v[92:95], a[216:219], a[28:31], v[92:95]
  ds_read_b64_tr_b16 a[208:209], v228 offset:32768
  ds_read_b64_tr_b16 a[210:211], v228 offset:34816
  v_mfma_f32_16x16x32_bf16 v[84:87], a[212:215], a[8:11], v[84:87]
  v_mfma_f32_16x16x32_bf16 v[84:87], a[216:219], a[24:27], v[84:87]
  v_mfma_f32_16x16x32_bf16 v[76:79], a[212:215], a[4:7], v[76:79]
  buffer_load_dwordx4 a[72:75], v225, s[4:7], s40 offen offset:2048 sc1
  v_mfma_f32_16x16x32_bf16 v[76:79], a[216:219], a[20:23], v[76:79]
  v_mfma_f32_16x16x32_bf16 v[68:71], a[212:215], a[0:3], v[68:71]
  ds_read_b64_tr_b16 a[212:213], v228 offset:40960
  v_mfma_f32_16x16x32_bf16 v[68:71], a[216:219], a[16:19], v[68:71]
  ds_read_b64_tr_b16 a[214:215], v228 offset:43008
  v_mfma_f32_16x16x32_bf16 v[96:99], a[220:223], a[0:3], v[96:99]
  ds_read_b64_tr_b16 a[216:217], v229 offset:32768
  s_waitcnt lgkmcnt(13)
  v_mfma_f32_16x16x32_bf16 v[96:99], a[224:227], a[16:19], v[96:99]
  ds_read_b64_tr_b16 a[218:219], v229 offset:34816
  v_mfma_f32_16x16x32_bf16 v[128:131], a[220:223], a[4:7], v[128:131]
  buffer_load_dwordx4 a[76:79], v225, s[4:7], s40 offen offset:3072 sc1
  v_mfma_f32_16x16x32_bf16 v[128:131], a[224:227], a[20:23], v[128:131]
  s_mov_b32 s41, 4587520
  s_add_u32 m0, s42, 61440
  v_mfma_f32_16x16x32_bf16 v[160:163], a[220:223], a[8:11], v[160:163]
  v_mfma_f32_16x16x32_bf16 v[160:163], a[224:227], a[24:27], v[160:163]
  s_load_dwordx2 s[66:67], s[36:37], 0x5fe80
  v_mfma_f32_16x16x32_bf16 v[192:195], a[220:223], a[12:15], v[192:195]
  ds_read_b64_tr_b16 a[220:221], v229 offset:40960
  v_mfma_f32_16x16x32_bf16 v[192:195], a[224:227], a[28:31], v[192:195]
  buffer_load_dwordx4 v226, s[12:15], s41 offen offset:0 lds
  v_mfma_f32_16x16x32_bf16 v[196:199], a[228:231], a[12:15], v[196:199]
  ds_read_b64_tr_b16 a[222:223], v229 offset:43008
  s_mov_b32 s41, 4816896
  v_mfma_f32_16x16x32_bf16 v[196:199], a[232:235], a[28:31], v[196:199]
  ds_read_b64_tr_b16 a[224:225], v230 offset:32768
  ds_read_b64_tr_b16 a[226:227], v230 offset:34816
  v_mfma_f32_16x16x32_bf16 v[164:167], a[228:231], a[8:11], v[164:167]
  s_add_u32 m0, s42, 77824
  v_mfma_f32_16x16x32_bf16 v[164:167], a[232:235], a[24:27], v[164:167]
  v_mfma_f32_16x16x32_bf16 v[132:135], a[228:231], a[4:7], v[132:135]
  v_mfma_f32_16x16x32_bf16 v[132:135], a[232:235], a[20:23], v[132:135]
  buffer_load_dwordx4 v226, s[12:15], s41 offen offset:0 lds
  v_mfma_f32_16x16x32_bf16 v[100:103], a[228:231], a[0:3], v[100:103]
  ds_read_b64_tr_b16 a[228:229], v230 offset:40960
  s_mov_b32 s40, 12189696
  v_mfma_f32_16x16x32_bf16 v[100:103], a[232:235], a[16:19], v[100:103]
  ds_read_b64_tr_b16 a[230:231], v230 offset:43008
  s_waitcnt lgkmcnt(13)
  v_mfma_f32_16x16x32_bf16 v[104:107], a[192:195], a[0:3], v[104:107]
  ds_read_b64_tr_b16 a[232:233], v231 offset:32768
  v_mfma_f32_16x16x32_bf16 v[104:107], a[196:199], a[16:19], v[104:107]
  ds_read_b64_tr_b16 a[234:235], v231 offset:34816
  v_mfma_f32_16x16x32_bf16 v[136:139], a[192:195], a[4:7], v[136:139]
  buffer_load_dwordx4 a[80:83], v225, s[4:7], s40 offen offset:0 sc1
  v_mfma_f32_16x16x32_bf16 v[136:139], a[196:199], a[20:23], v[136:139]
  v_mfma_f32_16x16x32_bf16 v[168:171], a[192:195], a[8:11], v[168:171]
  v_mfma_f32_16x16x32_bf16 v[168:171], a[196:199], a[24:27], v[168:171]
  v_mfma_f32_16x16x32_bf16 v[200:203], a[192:195], a[12:15], v[200:203]
  ds_read_b64_tr_b16 a[192:193], v231 offset:40960
  v_mfma_f32_16x16x32_bf16 v[200:203], a[196:199], a[28:31], v[200:203]
  ds_read_b64_tr_b16 a[194:195], v231 offset:43008
  v_mfma_f32_16x16x32_bf16 v[204:207], a[200:203], a[12:15], v[204:207]
  buffer_load_dwordx4 a[84:87], v225, s[4:7], s40 offen offset:1024 sc1
  s_waitcnt lgkmcnt(13)
  v_mfma_f32_16x16x32_bf16 v[204:207], a[204:207], a[28:31], v[204:207]
  s_waitcnt vmcnt(19)
  s_barrier
  v_mfma_f32_16x16x32_bf16 v[172:175], a[200:203], a[8:11], v[172:175]
  ds_read_b64_tr_b16 a[196:197], v232 offset:4096
  ds_read_b64_tr_b16 a[198:199], v232 offset:6144
  v_mfma_f32_16x16x32_bf16 v[172:175], a[204:207], a[24:27], v[172:175]
  s_load_dwordx2 s[66:67], s[36:37], 0x7fe00
  v_mfma_f32_16x16x32_bf16 v[140:143], a[200:203], a[4:7], v[140:143]
  v_mfma_f32_16x16x32_bf16 v[140:143], a[204:207], a[20:23], v[140:143]
  buffer_load_dwordx4 a[88:91], v225, s[4:7], s40 offen offset:2048 sc1
  v_mfma_f32_16x16x32_bf16 v[108:111], a[200:203], a[0:3], v[108:111]
  ds_read_b64_tr_b16 a[200:201], v232 offset:16384
  v_mfma_f32_16x16x32_bf16 v[108:111], a[204:207], a[16:19], v[108:111]
  ds_read_b64_tr_b16 a[202:203], v232 offset:18432
  v_mfma_f32_16x16x32_bf16 v[112:115], a[208:211], a[0:3], v[112:115]
  ds_read_b64_tr_b16 a[204:205], v233 offset:4096
  s_waitcnt lgkmcnt(13)
  v_mfma_f32_16x16x32_bf16 v[112:115], a[212:215], a[16:19], v[112:115]
  ds_read_b64_tr_b16 a[206:207], v233 offset:6144
  v_mfma_f32_16x16x32_bf16 v[144:147], a[208:211], a[4:7], v[144:147]
  v_mfma_f32_16x16x32_bf16 v[144:147], a[212:215], a[20:23], v[144:147]
  buffer_load_dwordx4 a[92:95], v225, s[4:7], s40 offen offset:3072 sc1
  v_mfma_f32_16x16x32_bf16 v[176:179], a[208:211], a[8:11], v[176:179]
  s_mov_b32 s41, 4587520
  s_add_u32 m0, s42, 73728
  v_mfma_f32_16x16x32_bf16 v[176:179], a[212:215], a[24:27], v[176:179]
  v_mfma_f32_16x16x32_bf16 v[208:211], a[208:211], a[12:15], v[208:211]
  ds_read_b64_tr_b16 a[208:209], v233 offset:16384
  v_mfma_f32_16x16x32_bf16 v[208:211], a[212:215], a[28:31], v[208:211]
  ds_read_b64_tr_b16 a[210:211], v233 offset:18432
  v_mfma_f32_16x16x32_bf16 v[212:215], a[216:219], a[12:15], v[212:215]
  buffer_load_dwordx4 v226, s[16:19], s41 offen offset:0 lds
  v_mfma_f32_16x16x32_bf16 v[212:215], a[220:223], a[28:31], v[212:215]
  ds_read_b64_tr_b16 a[212:213], v232 offset:24576
  ds_read_b64_tr_b16 a[214:215], v232 offset:26624
  v_mfma_f32_16x16x32_bf16 v[180:183], a[216:219], a[8:11], v[180:183]
  s_mov_b32 s41, 4816896
  s_add_u32 m0, s42, 86016
  v_mfma_f32_16x16x32_bf16 v[180:183], a[220:223], a[24:27], v[180:183]
  v_mfma_f32_16x16x32_bf16 v[148:151], a[216:219], a[4:7], v[148:151]
  v_mfma_f32_16x16x32_bf16 v[148:151], a[220:223], a[20:23], v[148:151]
  v_mfma_f32_16x16x32_bf16 v[116:119], a[216:219], a[0:3], v[116:119]
  buffer_load_dwordx4 v226, s[16:19], s41 offen offset:0 lds
  v_mfma_f32_16x16x32_bf16 v[116:119], a[220:223], a[16:19], v[116:119]
  ds_read_b64_tr_b16 a[216:217], v232 offset:53248
  s_mov_b32 s40, 12320768
  s_waitcnt lgkmcnt(13)
  v_mfma_f32_16x16x32_bf16 v[120:123], a[224:227], a[0:3], v[120:123]
  ds_read_b64_tr_b16 a[218:219], v232 offset:55296
  v_mfma_f32_16x16x32_bf16 v[120:123], a[228:231], a[16:19], v[120:123]
  ds_read_b64_tr_b16 a[220:221], v233 offset:24576
  ds_read_b64_tr_b16 a[222:223], v233 offset:26624
  s_load_dwordx2 s[66:67], s[36:37], 0x9fd80
  v_mfma_f32_16x16x32_bf16 v[152:155], a[224:227], a[4:7], v[152:155]
  v_mfma_f32_16x16x32_bf16 v[152:155], a[228:231], a[20:23], v[152:155]
  buffer_load_dwordx4 a[96:99], v225, s[4:7], s40 offen offset:0 sc1
  v_mfma_f32_16x16x32_bf16 v[184:187], a[224:227], a[8:11], v[184:187]
  v_mfma_f32_16x16x32_bf16 v[184:187], a[228:231], a[24:27], v[184:187]
  v_mfma_f32_16x16x32_bf16 v[216:219], a[224:227], a[12:15], v[216:219]
  ds_read_b64_tr_b16 a[224:225], v233 offset:53248
  v_mfma_f32_16x16x32_bf16 v[216:219], a[228:231], a[28:31], v[216:219]
  ds_read_b64_tr_b16 a[226:227], v233 offset:55296
  s_getpc_b64 s[30:31]
L_pc_43:
  s_lshr_b32 s32, s2, 4
  s_lshl_b32 s32, s32, 2
  s_add_u32 s32, s32, s3
  s_lshl_b32 s32, s32, 13
  v_lshlrev_b32 v244, 7, v224
  v_add_u32 v244, s32, v244
  v_min_u32 v244, L_code_end-L_pc_43-4, v244
  global_load_dword v241, v244, s[30:31]
  v_mfma_f32_16x16x32_bf16 v[220:223], a[232:235], a[12:15], v[220:223]
  ds_read_b64_tr_b16 a[228:229], v234 offset:4096
  s_waitcnt lgkmcnt(13)
  v_mfma_f32_16x16x32_bf16 v[220:223], a[192:195], a[28:31], v[220:223]
  buffer_load_dwordx4 a[100:103], v225, s[4:7], s40 offen offset:1024 sc1
  buffer_store_dwordx4 a[252:255], v251, s[4:7], s96 offen offset:0 sc1
  v_mfma_f32_16x16x32_bf16 v[188:191], a[232:235], a[8:11], v[188:191]
  ds_read_b64_tr_b16 a[230:231], v234 offset:6144
  v_mfma_f32_16x16x32_bf16 v[188:191], a[192:195], a[24:27], v[188:191]
  buffer_store_dwordx4 a[252:255], v251, s[4:7], s96 offen offset:1024 sc1
  v_mfma_f32_16x16x32_bf16 v[156:159], a[232:235], a[4:7], v[156:159]
  v_mfma_f32_16x16x32_bf16 v[156:159], a[192:195], a[20:23], v[156:159]
  buffer_store_dwordx4 a[252:255], v251, s[4:7], s96 offen offset:2048 sc1
  v_mfma_f32_16x16x32_bf16 v[124:127], a[232:235], a[0:3], v[124:127]
  ds_read_b64_tr_b16 a[232:233], v234 offset:16384
  v_mfma_f32_16x16x32_bf16 v[124:127], a[192:195], a[16:19], v[124:127]
  buffer_load_dwordx4 a[104:107], v225, s[4:7], s40 offen offset:2048 sc1
  buffer_store_dwordx4 a[252:255], v251, s[4:7], s96 offen offset:3072 sc1
  v_mfma_f32_16x16x32_bf16 v[0:3], a[196:199], a[32:35], v[0:3]
  ds_read_b64_tr_b16 a[234:235], v234 offset:18432
  s_waitcnt vmcnt(27)
  v_mfma_f32_16x16x32_bf16 v[0:3], a[200:203], a[48:51], v[0:3]
  ds_read_b64_tr_b16 a[192:193], v234 offset:24576
  ds_read_b64_tr_b16 a[194:195], v234 offset:26624
  v_mfma_f32_16x16x32_bf16 v[16:19], a[196:199], a[36:39], v[16:19]
  v_mfma_f32_16x16x32_bf16 v[16:19], a[200:203], a[52:55], v[16:19]
  v_mfma_f32_16x16x32_bf16 v[32:35], a[196:199], a[40:43], v[32:35]
  buffer_load_dwordx4 a[108:111], v225, s[4:7], s40 offen offset:3072 sc1
  v_mfma_f32_16x16x32_bf16 v[32:35], a[200:203], a[56:59], v[32:35]
  s_mov_b32 s41, 5046272
  s_add_u32 m0, s42, 102400
  v_mfma_f32_16x16x32_bf16 v[48:51], a[196:199], a[44:47], v[48:51]
  ds_read_b64_tr_b16 a[196:197], v234 offset:53248
  v_mfma_f32_16x16x32_bf16 v[48:51], a[200:203], a[60:63], v[48:51]
  ds_read_b64_tr_b16 a[198:199], v234 offset:55296
  s_load_dwordx2 s[66:67], s[36:37], 0xbfd00
  s_waitcnt lgkmcnt(13)
  v_mfma_f32_16x16x32_bf16 v[52:55], a[204:207], a[44:47], v[52:55]
  ds_read_b64_tr_b16 a[200:201], v236 offset:0
  v_mfma_f32_16x16x32_bf16 v[52:55], a[208:211], a[60:63], v[52:55]
  buffer_load_dwordx4 v227, s[12:15], s41 offen offset:0 lds
  v_mfma_f32_16x16x32_bf16 v[36:39], a[204:207], a[40:43], v[36:39]
  ds_read_b64_tr_b16 a[202:203], v236 offset:2048
  s_mov_b32 s41, 5275648
  v_mfma_f32_16x16x32_bf16 v[36:39], a[208:211], a[56:59], v[36:39]
  s_add_u32 m0, s42, 98304
  v_mfma_f32_16x16x32_bf16 v[20:23], a[204:207], a[36:39], v[20:23]
  v_mfma_f32_16x16x32_bf16 v[20:23], a[208:211], a[52:55], v[20:23]
  v_mfma_f32_16x16x32_bf16 v[4:7], a[204:207], a[32:35], v[4:7]
  ds_read_b64_tr_b16 a[204:205], v236 offset:8192
  v_mfma_f32_16x16x32_bf16 v[4:7], a[208:211], a[48:51], v[4:7]
  buffer_load_dwordx4 v227, s[12:15], s41 offen offset:0 lds
  v_mfma_f32_16x16x32_bf16 v[8:11], a[212:215], a[32:35], v[8:11]
  ds_read_b64_tr_b16 a[206:207], v236 offset:10240
  s_mov_b32 s41, 5046272
  s_waitcnt lgkmcnt(13)
  v_mfma_f32_16x16x32_bf16 v[8:11], a[216:219], a[48:51], v[8:11]
  s_waitcnt vmcnt(27)
  s_barrier
  v_mfma_f32_16x16x32_bf16 v[24:27], a[212:215], a[36:39], v[24:27]
  ds_read_b64_tr_b16 a[208:209], v237 offset:0
  ds_read_b64_tr_b16 a[210:211], v237 offset:2048
  v_mfma_f32_16x16x32_bf16 v[24:27], a[216:219], a[52:55], v[24:27]
  s_add_u32 m0, s42, 110592
  v_mfma_f32_16x16x32_bf16 v[40:43], a[212:215], a[40:43], v[40:43]
  buffer_load_dwordx4 v227, s[16:19], s41 offen offset:0 lds
  v_mfma_f32_16x16x32_bf16 v[40:43], a[216:219], a[56:59], v[40:43]
  s_mov_b32 s41, 5275648
  s_add_u32 m0, s42, 126976
  v_mfma_f32_16x16x32_bf16 v[56:59], a[212:215], a[44:47], v[56:59]
  ds_read_b64_tr_b16 a[212:213], v237 offset:8192
  v_mfma_f32_16x16x32_bf16 v[56:59], a[216:219], a[60:63], v[56:59]
  ds_read_b64_tr_b16 a[214:215], v237 offset:10240
  v_mfma_f32_16x16x32_bf16 v[60:63], a[220:223], a[44:47], v[60:63]
  ds_read_b64_tr_b16 a[216:217], v238 offset:0
  s_waitcnt lgkmcnt(13)
  v_mfma_f32_16x16x32_bf16 v[60:63], a[224:227], a[60:63], v[60:63]
  ds_read_b64_tr_b16 a[218:219], v238 offset:2048
  v_mfma_f32_16x16x32_bf16 v[44:47], a[220:223], a[40:43], v[44:47]
  buffer_load_dwordx4 v227, s[16:19], s41 offen offset:0 lds
  v_mfma_f32_16x16x32_bf16 v[44:47], a[224:227], a[56:59], v[44:47]
  s_mov_b32 s41, 5505024
  s_add_u32 m0, s42, 122880
  v_mfma_f32_16x16x32_bf16 v[28:31], a[220:223], a[36:39], v[28:31]
  v_mfma_f32_16x16x32_bf16 v[28:31], a[224:227], a[52:55], v[28:31]
  s_load_dwordx2 s[66:67], s[36:37], 0xdfc80
  s_add_u32 s36, s36, 0xffc00
  s_addc_u32 s37, s37, 0
  v_mfma_f32_16x16x32_bf16 v[12:15], a[220:223], a[32:35], v[12:15]
  ds_read_b64_tr_b16 a[220:221], v238 offset:8192
  v_mfma_f32_16x16x32_bf16 v[12:15], a[224:227], a[48:51], v[12:15]
  buffer_load_dwordx4 v227, s[12:15], s41 offen offset:0 lds
  v_mfma_f32_16x16x32_bf16 v[64:67], a[228:231], a[32:35], v[64:67]
  ds_read_b64_tr_b16 a[222:223], v238 offset:10240
  s_mov_b32 s41, 5734400
  v_mfma_f32_16x16x32_bf16 v[64:67], a[232:235], a[48:51], v[64:67]
  ds_read_b64_tr_b16 a[224:225], v239 offset:0
  ds_read_b64_tr_b16 a[226:227], v239 offset:2048
  v_mfma_f32_16x16x32_bf16 v[72:75], a[228:231], a[36:39], v[72:75]
  s_add_u32 m0, s42, 135168
  v_mfma_f32_16x16x32_bf16 v[72:75], a[232:235], a[52:55], v[72:75]
  v_mfma_f32_16x16x32_bf16 v[80:83], a[228:231], a[40:43], v[80:83]
  v_mfma_f32_16x16x32_bf16 v[80:83], a[232:235], a[56:59], v[80:83]
  buffer_load_dwordx4 v227, s[12:15], s41 offen offset:0 lds
  v_mfma_f32_16x16x32_bf16 v[88:91], a[228:231], a[44:47], v[88:91]
  ds_read_b64_tr_b16 a[228:229], v239 offset:8192
  s_mov_b32 s40, 12451840
  v_mfma_f32_16x16x32_bf16 v[88:91], a[232:235], a[60:63], v[88:91]
  ds_read_b64_tr_b16 a[230:231], v239 offset:10240
  s_waitcnt lgkmcnt(13)
  v_mfma_f32_16x16x32_bf16 v[92:95], a[192:195], a[44:47], v[92:95]
  ds_read_b64_tr_b16 a[232:233], v228 offset:20480
  v_mfma_f32_16x16x32_bf16 v[92:95], a[196:199], a[60:63], v[92:95]
  ds_read_b64_tr_b16 a[234:235], v228 offset:22528
  v_mfma_f32_16x16x32_bf16 v[84:87], a[192:195], a[40:43], v[84:87]
  buffer_load_dwordx4 a[112:115], v225, s[4:7], s40 offen offset:0 sc1
  v_mfma_f32_16x16x32_bf16 v[84:87], a[196:199], a[56:59], v[84:87]
  v_mfma_f32_16x16x32_bf16 v[76:79], a[192:195], a[36:39], v[76:79]
  v_mfma_f32_16x16x32_bf16 v[76:79], a[196:199], a[52:55], v[76:79]
  v_mfma_f32_16x16x32_bf16 v[68:71], a[192:195], a[32:35], v[68:71]
  ds_read_b64_tr_b16 a[192:193], v236 offset:12288
  v_mfma_f32_16x16x32_bf16 v[68:71], a[196:199], a[48:51], v[68:71]
  ds_read_b64_tr_b16 a[194:195], v236 offset:14336
  v_mfma_f32_16x16x32_bf16 v[96:99], a[200:203], a[32:35], v[96:99]
  buffer_load_dwordx4 a[116:119], v225, s[4:7], s40 offen offset:1024 sc1
  s_waitcnt lgkmcnt(13)
  v_mfma_f32_16x16x32_bf16 v[96:99], a[204:207], a[48:51], v[96:99]
  ds_read_b64_tr_b16 a[196:197], v229 offset:20480
  ds_read_b64_tr_b16 a[198:199], v229 offset:22528
  v_mfma_f32_16x16x32_bf16 v[128:131], a[200:203], a[36:39], v[128:131]
  v_mfma_f32_16x16x32_bf16 v[128:131], a[204:207], a[52:55], v[128:131]
  s_load_dwordx2 s[66:67], s[36:37], 0x0
  v_mfma_f32_16x16x32_bf16 v[160:163], a[200:203], a[40:43], v[160:163]
  v_mfma_f32_16x16x32_bf16 v[160:163], a[204:207], a[56:59], v[160:163]
  buffer_load_dwordx4 a[120:123], v225, s[4:7], s40 offen offset:2048 sc1
  v_mfma_f32_16x16x32_bf16 v[192:195], a[200:203], a[44:47], v[192:195]
  ds_read_b64_tr_b16 a[200:201], v237 offset:12288
  v_mfma_f32_16x16x32_bf16 v[192:195], a[204:207], a[60:63], v[192:195]
  ds_read_b64_tr_b16 a[202:203], v237 offset:14336
  v_mfma_f32_16x16x32_bf16 v[196:199], a[208:211], a[44:47], v[196:199]
  ds_read_b64_tr_b16 a[204:205], v230 offset:20480
  s_waitcnt lgkmcnt(13)
  v_mfma_f32_16x16x32_bf16 v[196:199], a[212:215], a[60:63], v[196:199]
  ds_read_b64_tr_b16 a[206:207], v230 offset:22528
  v_mfma_f32_16x16x32_bf16 v[164:167], a[208:211], a[40:43], v[164:167]
  v_mfma_f32_16x16x32_bf16 v[164:167], a[212:215], a[56:59], v[164:167]
  buffer_load_dwordx4 a[124:127], v225, s[4:7], s40 offen offset:3072 sc1
  v_mfma_f32_16x16x32_bf16 v[132:135], a[208:211], a[36:39], v[132:135]
  s_mov_b32 s41, 5505024
  s_add_u32 m0, s42, 151552
  v_mfma_f32_16x16x32_bf16 v[132:135], a[212:215], a[52:55], v[132:135]
  v_mfma_f32_16x16x32_bf16 v[100:103], a[208:211], a[32:35], v[100:103]
  ds_read_b64_tr_b16 a[208:209], v238 offset:12288
  v_mfma_f32_16x16x32_bf16 v[100:103], a[212:215], a[48:51], v[100:103]
  ds_read_b64_tr_b16 a[210:211], v238 offset:14336
  v_mfma_f32_16x16x32_bf16 v[104:107], a[216:219], a[32:35], v[104:107]
  buffer_load_dwordx4 v227, s[16:19], s41 offen offset:0 lds
  v_mfma_f32_16x16x32_bf16 v[104:107], a[220:223], a[48:51], v[104:107]
  ds_read_b64_tr_b16 a[212:213], v231 offset:20480
  ds_read_b64_tr_b16 a[214:215], v231 offset:22528
  v_mfma_f32_16x16x32_bf16 v[136:139], a[216:219], a[36:39], v[136:139]
  s_mov_b32 s41, 5734400
  s_add_u32 m0, s42, 147456
  v_mfma_f32_16x16x32_bf16 v[136:139], a[220:223], a[52:55], v[136:139]
  v_mfma_f32_16x16x32_bf16 v[168:171], a[216:219], a[40:43], v[168:171]
  v_mfma_f32_16x16x32_bf16 v[168:171], a[220:223], a[56:59], v[168:171]
  v_mfma_f32_16x16x32_bf16 v[200:203], a[216:219], a[44:47], v[200:203]
  buffer_load_dwordx4 v227, s[16:19], s41 offen offset:0 lds
  v_mfma_f32_16x16x32_bf16 v[200:203], a[220:223], a[60:63], v[200:203]
  ds_read_b64_tr_b16 a[216:217], v239 offset:12288
  s_mov_b32 s41, 5963776
  s_waitcnt lgkmcnt(13)
  v_mfma_f32_16x16x32_bf16 v[204:207], a[224:227], a[44:47], v[204:207]
  ds_read_b64_tr_b16 a[218:219], v239 offset:14336
  s_add_u32 m0, s42, 159744
  v_mfma_f32_16x16x32_bf16 v[204:207], a[228:231], a[60:63], v[204:207]
  s_waitcnt vmcnt(27)
  s_barrier
  s_load_dwordx2 s[66:67], s[36:37], 0x1ff80
  v_mfma_f32_16x16x32_bf16 v[172:175], a[224:227], a[40:43], v[172:175]
  ds_read_b64_tr_b16 a[220:221], v236 offset:24576
  ds_read_b64_tr_b16 a[222:223], v236 offset:26624
  v_mfma_f32_16x16x32_bf16 v[172:175], a[228:231], a[56:59], v[172:175]
  buffer_load_dwordx4 v227, s[12:15], s41 offen offset:0 lds
  v_mfma_f32_16x16x32_bf16 v[140:143], a[224:227], a[36:39], v[140:143]
  s_mov_b32 s41, 6193152
  s_add_u32 m0, s42, 16384
  v_mfma_f32_16x16x32_bf16 v[140:143], a[228:231], a[52:55], v[140:143]
  v_mfma_f32_16x16x32_bf16 v[108:111], a[224:227], a[32:35], v[108:111]
  ds_read_b64_tr_b16 a[224:225], v228 offset:36864
  v_mfma_f32_16x16x32_bf16 v[108:111], a[228:231], a[48:51], v[108:111]
  ds_read_b64_tr_b16 a[226:227], v228 offset:38912
  v_mfma_f32_16x16x32_bf16 v[112:115], a[232:235], a[32:35], v[112:115]
  ds_read_b64_tr_b16 a[228:229], v237 offset:24576
  s_waitcnt lgkmcnt(13)
  v_mfma_f32_16x16x32_bf16 v[112:115], a[192:195], a[48:51], v[112:115]
  buffer_load_dwordx4 v227, s[12:15], s41 offen offset:0 lds
  v_mfma_f32_16x16x32_bf16 v[144:147], a[232:235], a[36:39], v[144:147]
  ds_read_b64_tr_b16 a[230:231], v237 offset:26624
  s_mov_b32 s41, 5963776
  v_mfma_f32_16x16x32_bf16 v[144:147], a[192:195], a[52:55], v[144:147]
  s_add_u32 m0, s42, 12288
  v_mfma_f32_16x16x32_bf16 v[176:179], a[232:235], a[40:43], v[176:179]
  v_mfma_f32_16x16x32_bf16 v[176:179], a[192:195], a[56:59], v[176:179]
  v_mfma_f32_16x16x32_bf16 v[208:211], a[232:235], a[44:47], v[208:211]
  buffer_load_dwordx4 v227, s[16:19], s41 offen offset:0 lds
  v_mfma_f32_16x16x32_bf16 v[208:211], a[192:195], a[60:63], v[208:211]
  ds_read_b64_tr_b16 a[232:233], v229 offset:36864
  s_mov_b32 s40, 12582912
  v_mfma_f32_16x16x32_bf16 v[212:215], a[196:199], a[44:47], v[212:215]
  ds_read_b64_tr_b16 a[234:235], v229 offset:38912
  v_mfma_f32_16x16x32_bf16 v[212:215], a[200:203], a[60:63], v[212:215]
  ds_read_b64_tr_b16 a[192:193], v228 offset:53248
  ds_read_b64_tr_b16 a[194:195], v228 offset:55296
  v_mfma_f32_16x16x32_bf16 v[180:183], a[196:199], a[40:43], v[180:183]
  v_mfma_f32_16x16x32_bf16 v[180:183], a[200:203], a[56:59], v[180:183]
  v_mfma_f32_16x16x32_bf16 v[148:151], a[196:199], a[36:39], v[148:151]
  buffer_load_dwordx4 a[128:131], v225, s[4:7], s40 offen offset:0 sc1
  v_mfma_f32_16x16x32_bf16 v[148:151], a[200:203], a[52:55], v[148:151]
  v_mfma_f32_16x16x32_bf16 v[116:119], a[196:199], a[32:35], v[116:119]
  ds_read_b64_tr_b16 a[196:197], v228 offset:49152
  v_mfma_f32_16x16x32_bf16 v[116:119], a[200:203], a[48:51], v[116:119]
  ds_read_b64_tr_b16 a[198:199], v228 offset:51200
  s_load_dwordx2 s[66:67], s[36:37], 0x3ff00
  s_waitcnt lgkmcnt(13)
  v_mfma_f32_16x16x32_bf16 v[120:123], a[204:207], a[32:35], v[120:123]
  ds_read_b64_tr_b16 a[200:201], v229 offset:53248
  v_mfma_f32_16x16x32_bf16 v[120:123], a[208:211], a[48:51], v[120:123]
  buffer_load_dwordx4 a[132:135], v225, s[4:7], s40 offen offset:1024 sc1
  v_mfma_f32_16x16x32_bf16 v[152:155], a[204:207], a[36:39], v[152:155]
  ds_read_b64_tr_b16 a[202:203], v229 offset:55296
  v_mfma_f32_16x16x32_bf16 v[152:155], a[208:211], a[52:55], v[152:155]
  v_mfma_f32_16x16x32_bf16 v[184:187], a[204:207], a[40:43], v[184:187]
  v_mfma_f32_16x16x32_bf16 v[184:187], a[208:211], a[56:59], v[184:187]
  v_mfma_f32_16x16x32_bf16 v[216:219], a[204:207], a[44:47], v[216:219]
  ds_read_b64_tr_b16 a[204:205], v229 offset:49152
  v_mfma_f32_16x16x32_bf16 v[216:219], a[208:211], a[60:63], v[216:219]
  buffer_load_dwordx4 a[136:139], v225, s[4:7], s40 offen offset:2048 sc1
  v_mfma_f32_16x16x32_bf16 v[220:223], a[212:215], a[44:47], v[220:223]
  ds_read_b64_tr_b16 a[206:207], v229 offset:51200
  s_waitcnt lgkmcnt(13)
  v_mfma_f32_16x16x32_bf16 v[220:223], a[216:219], a[60:63], v[220:223]
  ds_read_b64_tr_b16 a[208:209], v238 offset:24576
  ds_read_b64_tr_b16 a[210:211], v238 offset:26624
  v_mfma_f32_16x16x32_bf16 v[188:191], a[212:215], a[40:43], v[188:191]
  v_mfma_f32_16x16x32_bf16 v[188:191], a[216:219], a[56:59], v[188:191]
  v_mfma_f32_16x16x32_bf16 v[156:159], a[212:215], a[36:39], v[156:159]
  buffer_load_dwordx4 a[140:143], v225, s[4:7], s40 offen offset:3072 sc1
  v_mfma_f32_16x16x32_bf16 v[156:159], a[216:219], a[52:55], v[156:159]
  s_mov_b32 s40, 12713984
  v_mfma_f32_16x16x32_bf16 v[124:127], a[212:215], a[32:35], v[124:127]
  ds_read_b64_tr_b16 a[212:213], v230 offset:36864
  v_mfma_f32_16x16x32_bf16 v[124:127], a[216:219], a[48:51], v[124:127]
  ds_read_b64_tr_b16 a[214:215], v230 offset:38912
  v_mfma_f32_16x16x32_bf16 v[0:3], a[220:223], a[64:67], v[0:3]
  ds_read_b64_tr_b16 a[216:217], v230 offset:53248
  s_waitcnt vmcnt(30) lgkmcnt(13)
  v_mfma_f32_16x16x32_bf16 v[0:3], a[224:227], a[80:83], v[0:3]
  ds_read_b64_tr_b16 a[218:219], v230 offset:55296
  v_mfma_f32_16x16x32_bf16 v[16:19], a[220:223], a[68:71], v[16:19]
  buffer_load_dwordx4 a[144:147], v225, s[4:7], s40 offen offset:0 sc1
  v_mfma_f32_16x16x32_bf16 v[16:19], a[224:227], a[84:87], v[16:19]
  v_mfma_f32_16x16x32_bf16 v[32:35], a[220:223], a[72:75], v[32:35]
  v_mfma_f32_16x16x32_bf16 v[32:35], a[224:227], a[88:91], v[32:35]
  s_load_dwordx2 s[66:67], s[36:37], 0x5fe80
  v_mfma_f32_16x16x32_bf16 v[48:51], a[220:223], a[76:79], v[48:51]
  ds_read_b64_tr_b16 a[220:221], v230 offset:49152
  v_mfma_f32_16x16x32_bf16 v[48:51], a[224:227], a[92:95], v[48:51]
  buffer_load_dwordx4 a[148:151], v225, s[4:7], s40 offen offset:1024 sc1
  v_mfma_f32_16x16x32_bf16 v[52:55], a[228:231], a[76:79], v[52:55]
  ds_read_b64_tr_b16 a[222:223], v230 offset:51200
  v_mfma_f32_16x16x32_bf16 v[52:55], a[232:235], a[92:95], v[52:55]
  ds_read_b64_tr_b16 a[224:225], v228 offset:61440
  ds_read_b64_tr_b16 a[226:227], v228 offset:63488
  v_mfma_f32_16x16x32_bf16 v[36:39], a[228:231], a[72:75], v[36:39]
  v_mfma_f32_16x16x32_bf16 v[36:39], a[232:235], a[88:91], v[36:39]
  v_mfma_f32_16x16x32_bf16 v[20:23], a[228:231], a[68:71], v[20:23]
  v_mfma_f32_16x16x32_bf16 v[20:23], a[232:235], a[84:87], v[20:23]
  buffer_load_dwordx4 a[152:155], v225, s[4:7], s40 offen offset:2048 sc1
  v_mfma_f32_16x16x32_bf16 v[4:7], a[228:231], a[64:67], v[4:7]
L_wk1_5:
  s_cbranch_vccnz L_wk1_end
  ds_read_b64_tr_b16 a[228:229], v232 offset:12288
  v_mfma_f32_16x16x32_bf16 v[4:7], a[232:235], a[80:83], v[4:7]
  ds_read_b64_tr_b16 a[230:231], v232 offset:14336
  s_waitcnt lgkmcnt(13)
  v_mfma_f32_16x16x32_bf16 v[8:11], a[192:195], a[64:67], v[8:11]
  ds_read_b64_tr_b16 a[232:233], v229 offset:61440
  v_mfma_f32_16x16x32_bf16 v[8:11], a[196:199], a[80:83], v[8:11]
  s_waitcnt vmcnt(21)
  s_barrier
  v_mfma_f32_16x16x32_bf16 v[24:27], a[192:195], a[68:71], v[24:27]
  buffer_load_dwordx4 a[156:159], v225, s[4:7], s40 offen offset:3072 sc1
  v_mfma_f32_16x16x32_bf16 v[24:27], a[196:199], a[84:87], v[24:27]
  ds_read_b64_tr_b16 a[234:235], v229 offset:63488
  s_mov_b32 s41, 6193152
  v_mfma_f32_16x16x32_bf16 v[40:43], a[192:195], a[72:75], v[40:43]
  s_add_u32 m0, s42, 24576
  v_mfma_f32_16x16x32_bf16 v[40:43], a[196:199], a[88:91], v[40:43]
  v_mfma_f32_16x16x32_bf16 v[56:59], a[192:195], a[76:79], v[56:59]
  ds_read_b64_tr_b16 a[192:193], v233 offset:12288
  v_mfma_f32_16x16x32_bf16 v[56:59], a[196:199], a[92:95], v[56:59]
  ds_read_b64_tr_b16 a[194:195], v233 offset:14336
  v_mfma_f32_16x16x32_bf16 v[60:63], a[200:203], a[76:79], v[60:63]
  buffer_load_dwordx4 v227, s[16:19], s41 offen offset:0 lds
  s_waitcnt lgkmcnt(13)
  v_mfma_f32_16x16x32_bf16 v[60:63], a[204:207], a[92:95], v[60:63]
  ds_read_b64_tr_b16 a[196:197], v230 offset:61440
  ds_read_b64_tr_b16 a[198:199], v230 offset:63488
  v_mfma_f32_16x16x32_bf16 v[44:47], a[200:203], a[72:75], v[44:47]
  s_mov_b32 s41, 6422528
  s_add_u32 m0, s42, 45056
  v_mfma_f32_16x16x32_bf16 v[44:47], a[204:207], a[88:91], v[44:47]
  s_load_dwordx2 s[66:67], s[36:37], 0x7fe00
  v_mfma_f32_16x16x32_bf16 v[28:31], a[200:203], a[68:71], v[28:31]
  v_mfma_f32_16x16x32_bf16 v[28:31], a[204:207], a[84:87], v[28:31]
  buffer_load_dwordx4 v227, s[12:15], s41 offen offset:0 lds
  v_mfma_f32_16x16x32_bf16 v[12:15], a[200:203], a[64:67], v[12:15]
  ds_read_b64_tr_b16 a[200:201], v234 offset:12288
  s_mov_b32 s41, 6651904
  v_mfma_f32_16x16x32_bf16 v[12:15], a[204:207], a[80:83], v[12:15]
  ds_read_b64_tr_b16 a[202:203], v234 offset:14336
  s_add_u32 m0, s42, 57344
  v_mfma_f32_16x16x32_bf16 v[64:67], a[208:211], a[64:67], v[64:67]
  ds_read_b64_tr_b16 a[204:205], v231 offset:61440
  s_waitcnt lgkmcnt(13)
  v_mfma_f32_16x16x32_bf16 v[64:67], a[212:215], a[80:83], v[64:67]
  ds_read_b64_tr_b16 a[206:207], v231 offset:63488
  v_mfma_f32_16x16x32_bf16 v[72:75], a[208:211], a[68:71], v[72:75]
  v_mfma_f32_16x16x32_bf16 v[72:75], a[212:215], a[84:87], v[72:75]
  buffer_load_dwordx4 v227, s[12:15], s41 offen offset:0 lds
  v_mfma_f32_16x16x32_bf16 v[80:83], a[208:211], a[72:75], v[80:83]
  s_mov_b32 s41, 6422528
  s_add_u32 m0, s42, 65536
  v_mfma_f32_16x16x32_bf16 v[80:83], a[212:215], a[88:91], v[80:83]
  v_mfma_f32_16x16x32_bf16 v[88:91], a[208:211], a[76:79], v[88:91]
  ds_read_b64_tr_b16 a[208:209], v235 offset:12288
  v_mfma_f32_16x16x32_bf16 v[88:91], a[212:215], a[92:95], v[88:91]
  ds_read_b64_tr_b16 a[210:211], v235 offset:14336
  v_mfma_f32_16x16x32_bf16 v[92:95], a[216:219], a[76:79], v[92:95]
  buffer_load_dwordx4 v227, s[16:19], s41 offen offset:0 lds
  v_mfma_f32_16x16x32_bf16 v[92:95], a[220:223], a[92:95], v[92:95]
  ds_read_b64_tr_b16 a[212:213], v232 offset:8192
  ds_read_b64_tr_b16 a[214:215], v232 offset:10240
  v_mfma_f32_16x16x32_bf16 v[84:87], a[216:219], a[72:75], v[84:87]
  s_mov_b32 s41, 6651904
  s_add_u32 m0, s42, 94208
  v_mfma_f32_16x16x32_bf16 v[84:87], a[220:223], a[88:91], v[84:87]
  v_mfma_f32_16x16x32_bf16 v[76:79], a[216:219], a[68:71], v[76:79]
  v_mfma_f32_16x16x32_bf16 v[76:79], a[220:223], a[84:87], v[76:79]
  v_mfma_f32_16x16x32_bf16 v[68:71], a[216:219], a[64:67], v[68:71]
  buffer_load_dwordx4 v227, s[16:19], s41 offen offset:0 lds
  v_mfma_f32_16x16x32_bf16 v[68:71], a[220:223], a[80:83], v[68:71]
  ds_read_b64_tr_b16 a[216:217], v232 offset:20480
  s_mov_b32 s40, 12845056
  s_waitcnt lgkmcnt(13)
  v_mfma_f32_16x16x32_bf16 v[96:99], a[224:227], a[64:67], v[96:99]
  ds_read_b64_tr_b16 a[218:219], v232 offset:22528
  v_mfma_f32_16x16x32_bf16 v[96:99], a[228:231], a[80:83], v[96:99]
  ds_read_b64_tr_b16 a[220:221], v233 offset:8192
  ds_read_b64_tr_b16 a[222:223], v233 offset:10240
  s_load_dwordx2 s[66:67], s[36:37], 0x9fd80
  v_mfma_f32_16x16x32_bf16 v[128:131], a[224:227], a[68:71], v[128:131]
  v_mfma_f32_16x16x32_bf16 v[128:131], a[228:231], a[84:87], v[128:131]
  buffer_load_dwordx4 a[160:163], v225, s[4:7], s40 offen offset:0 sc1
  v_mfma_f32_16x16x32_bf16 v[160:163], a[224:227], a[72:75], v[160:163]
  v_mfma_f32_16x16x32_bf16 v[160:163], a[228:231], a[88:91], v[160:163]
  v_mfma_f32_16x16x32_bf16 v[192:195], a[224:227], a[76:79], v[192:195]
  ds_read_b64_tr_b16 a[224:225], v233 offset:20480
  v_mfma_f32_16x16x32_bf16 v[192:195], a[228:231], a[92:95], v[192:195]
  ds_read_b64_tr_b16 a[226:227], v233 offset:22528
  v_mfma_f32_16x16x32_bf16 v[196:199], a[232:235], a[76:79], v[196:199]
  ds_read_b64_tr_b16 a[228:229], v234 offset:8192
  s_waitcnt lgkmcnt(13)
  v_mfma_f32_16x16x32_bf16 v[196:199], a[192:195], a[92:95], v[196:199]
  buffer_load_dwordx4 a[164:167], v225, s[4:7], s40 offen offset:1024 sc1
  v_mfma_f32_16x16x32_bf16 v[164:167], a[232:235], a[72:75], v[164:167]
  ds_read_b64_tr_b16 a[230:231], v234 offset:10240
  v_mfma_f32_16x16x32_bf16 v[164:167], a[192:195], a[88:91], v[164:167]
  v_mfma_f32_16x16x32_bf16 v[132:135], a[232:235], a[68:71], v[132:135]
  v_mfma_f32_16x16x32_bf16 v[132:135], a[192:195], a[84:87], v[132:135]
  v_mfma_f32_16x16x32_bf16 v[100:103], a[232:235], a[64:67], v[100:103]
  buffer_load_dwordx4 a[168:171], v225, s[4:7], s40 offen offset:2048 sc1
  v_mfma_f32_16x16x32_bf16 v[100:103], a[192:195], a[80:83], v[100:103]
  ds_read_b64_tr_b16 a[232:233], v234 offset:20480
  v_mfma_f32_16x16x32_bf16 v[104:107], a[196:199], a[64:67], v[104:107]
  ds_read_b64_tr_b16 a[234:235], v234 offset:22528
  v_mfma_f32_16x16x32_bf16 v[104:107], a[200:203], a[80:83], v[104:107]
  ds_read_b64_tr_b16 a[192:193], v235 offset:8192
  ds_read_b64_tr_b16 a[194:195], v235 offset:10240
  v_mfma_f32_16x16x32_bf16 v[136:139], a[196:199], a[68:71], v[136:139]
  v_mfma_f32_16x16x32_bf16 v[136:139], a[200:203], a[84:87], v[136:139]
  v_mfma_f32_16x16x32_bf16 v[168:171], a[196:199], a[72:75], v[168:171]
  buffer_load_dwordx4 a[172:175], v225, s[4:7], s40 offen offset:3072 sc1
  v_mfma_f32_16x16x32_bf16 v[168:171], a[200:203], a[88:91], v[168:171]
  s_mov_b32 s40, 12976128
  v_mfma_f32_16x16x32_bf16 v[200:203], a[196:199], a[76:79], v[200:203]
  ds_read_b64_tr_b16 a[196:197], v235 offset:20480
  v_mfma_f32_16x16x32_bf16 v[200:203], a[200:203], a[92:95], v[200:203]
  ds_read_b64_tr_b16 a[198:199], v235 offset:22528
  s_load_dwordx2 s[66:67], s[36:37], 0xbfd00
  s_waitcnt lgkmcnt(13)
  v_mfma_f32_16x16x32_bf16 v[204:207], a[204:207], a[76:79], v[204:207]
  ds_read_b64_tr_b16 a[200:201], v232 offset:36864
  v_mfma_f32_16x16x32_bf16 v[204:207], a[208:211], a[92:95], v[204:207]
  s_waitcnt vmcnt(26)
  s_barrier
  v_mfma_f32_16x16x32_bf16 v[172:175], a[204:207], a[72:75], v[172:175]
  buffer_load_dwordx4 a[176:179], v225, s[4:7], s40 offen offset:0 sc1
  v_mfma_f32_16x16x32_bf16 v[172:175], a[208:211], a[88:91], v[172:175]
  ds_read_b64_tr_b16 a[202:203], v232 offset:38912
  v_mfma_f32_16x16x32_bf16 v[140:143], a[204:207], a[68:71], v[140:143]
  v_mfma_f32_16x16x32_bf16 v[140:143], a[208:211], a[84:87], v[140:143]
  v_mfma_f32_16x16x32_bf16 v[108:111], a[204:207], a[64:67], v[108:111]
  ds_read_b64_tr_b16 a[204:205], v232 offset:32768
  v_mfma_f32_16x16x32_bf16 v[108:111], a[208:211], a[80:83], v[108:111]
  buffer_load_dwordx4 a[180:183], v225, s[4:7], s40 offen offset:1024 sc1
  v_mfma_f32_16x16x32_bf16 v[112:115], a[212:215], a[64:67], v[112:115]
  ds_read_b64_tr_b16 a[206:207], v232 offset:34816
  s_waitcnt lgkmcnt(13)
  v_mfma_f32_16x16x32_bf16 v[112:115], a[216:219], a[80:83], v[112:115]
  ds_read_b64_tr_b16 a[208:209], v233 offset:36864
  ds_read_b64_tr_b16 a[210:211], v233 offset:38912
  v_mfma_f32_16x16x32_bf16 v[144:147], a[212:215], a[68:71], v[144:147]
  v_mfma_f32_16x16x32_bf16 v[144:147], a[216:219], a[84:87], v[144:147]
  v_mfma_f32_16x16x32_bf16 v[176:179], a[212:215], a[72:75], v[176:179]
  buffer_load_dwordx4 a[184:187], v225, s[4:7], s40 offen offset:2048 sc1
  v_mfma_f32_16x16x32_bf16 v[176:179], a[216:219], a[88:91], v[176:179]
  v_mfma_f32_16x16x32_bf16 v[208:211], a[212:215], a[76:79], v[208:211]
  ds_read_b64_tr_b16 a[212:213], v233 offset:32768
  v_mfma_f32_16x16x32_bf16 v[208:211], a[216:219], a[92:95], v[208:211]
  ds_read_b64_tr_b16 a[214:215], v233 offset:34816
  v_mfma_f32_16x16x32_bf16 v[212:215], a[220:223], a[76:79], v[212:215]
  ds_read_b64_tr_b16 a[216:217], v232 offset:45056
  s_waitcnt lgkmcnt(13)
  v_mfma_f32_16x16x32_bf16 v[212:215], a[224:227], a[92:95], v[212:215]
  ds_read_b64_tr_b16 a[218:219], v232 offset:47104
  v_mfma_f32_16x16x32_bf16 v[180:183], a[220:223], a[72:75], v[180:183]
  buffer_load_dwordx4 a[188:191], v225, s[4:7], s40 offen offset:3072 sc1
  v_mfma_f32_16x16x32_bf16 v[180:183], a[224:227], a[88:91], v[180:183]
  s_mov_b32 s41, 6881280
  s_add_u32 m0, s42, 106496
  v_mfma_f32_16x16x32_bf16 v[148:151], a[220:223], a[68:71], v[148:151]
  v_mfma_f32_16x16x32_bf16 v[148:151], a[224:227], a[84:87], v[148:151]
  s_load_dwordx2 s[66:67], s[36:37], 0xdfc80
  v_mfma_f32_16x16x32_bf16 v[116:119], a[220:223], a[64:67], v[116:119]
  ds_read_b64_tr_b16 a[220:221], v232 offset:61440
  v_mfma_f32_16x16x32_bf16 v[116:119], a[224:227], a[80:83], v[116:119]
  buffer_load_dwordx4 v227, s[12:15], s41 offen offset:0 lds
  v_mfma_f32_16x16x32_bf16 v[120:123], a[228:231], a[64:67], v[120:123]
  ds_read_b64_tr_b16 a[222:223], v232 offset:63488
  s_mov_b32 s41, 7110656
  v_mfma_f32_16x16x32_bf16 v[120:123], a[232:235], a[80:83], v[120:123]
  ds_read_b64_tr_b16 a[224:225], v233 offset:45056
  ds_read_b64_tr_b16 a[226:227], v233 offset:47104
  v_mfma_f32_16x16x32_bf16 v[152:155], a[228:231], a[68:71], v[152:155]
  s_add_u32 m0, s42, 114688
  v_mfma_f32_16x16x32_bf16 v[152:155], a[232:235], a[84:87], v[152:155]
  v_mfma_f32_16x16x32_bf16 v[184:187], a[228:231], a[72:75], v[184:187]
  v_mfma_f32_16x16x32_bf16 v[184:187], a[232:235], a[88:91], v[184:187]
  buffer_load_dwordx4 v227, s[12:15], s41 offen offset:0 lds
  v_mfma_f32_16x16x32_bf16 v[216:219], a[228:231], a[76:79], v[216:219]
  ds_read_b64_tr_b16 a[228:229], v233 offset:61440
  s_mov_b32 s41, 6881280
  v_mfma_f32_16x16x32_bf16 v[216:219], a[232:235], a[92:95], v[216:219]
  ds_read_b64_tr_b16 a[230:231], v233 offset:63488
  s_add_u32 m0, s42, 28672
  s_waitcnt lgkmcnt(13)
  v_mfma_f32_16x16x32_bf16 v[220:223], a[192:195], a[76:79], v[220:223]
  ds_read_b64_tr_b16 a[232:233], v234 offset:36864
  v_mfma_f32_16x16x32_bf16 v[220:223], a[196:199], a[92:95], v[220:223]
  ds_read_b64_tr_b16 a[234:235], v234 offset:38912
  v_mfma_f32_16x16x32_bf16 v[188:191], a[192:195], a[72:75], v[188:191]
  buffer_load_dwordx4 v227, s[16:19], s41 offen offset:0 lds
  v_mfma_f32_16x16x32_bf16 v[188:191], a[196:199], a[88:91], v[188:191]
  s_mov_b32 s41, 7110656
  s_add_u32 m0, s42, 32768
  v_mfma_f32_16x16x32_bf16 v[156:159], a[192:195], a[68:71], v[156:159]
  v_mfma_f32_16x16x32_bf16 v[156:159], a[196:199], a[84:87], v[156:159]
  v_mfma_f32_16x16x32_bf16 v[124:127], a[192:195], a[64:67], v[124:127]
  ds_read_b64_tr_b16 a[192:193], v234 offset:32768
  v_mfma_f32_16x16x32_bf16 v[124:127], a[196:199], a[80:83], v[124:127]
  ds_read_b64_tr_b16 a[194:195], v234 offset:34816
  v_mfma_f32_16x16x32_bf16 v[0:3], a[200:203], a[96:99], v[0:3]
  buffer_load_dwordx4 v227, s[16:19], s41 offen offset:0 lds
  s_waitcnt vmcnt(30) lgkmcnt(13)
  v_mfma_f32_16x16x32_bf16 v[0:3], a[204:207], a[112:115], v[0:3]
  ds_read_b64_tr_b16 a[196:197], v234 offset:45056
  ds_read_b64_tr_b16 a[198:199], v234 offset:47104
  v_mfma_f32_16x16x32_bf16 v[16:19], a[200:203], a[100:103], v[16:19]
  s_mov_b32 s40, 13107200
  v_mfma_f32_16x16x32_bf16 v[16:19], a[204:207], a[116:119], v[16:19]
  v_mfma_f32_16x16x32_bf16 v[32:35], a[200:203], a[104:107], v[32:35]
  v_mfma_f32_16x16x32_bf16 v[32:35], a[204:207], a[120:123], v[32:35]
  buffer_load_dwordx4 a[0:3], v225, s[4:7], s40 offen offset:0 sc1
  v_mfma_f32_16x16x32_bf16 v[48:51], a[200:203], a[108:111], v[48:51]
  ds_read_b64_tr_b16 a[200:201], v234 offset:61440
  v_mfma_f32_16x16x32_bf16 v[48:51], a[204:207], a[124:127], v[48:51]
  ds_read_b64_tr_b16 a[202:203], v234 offset:63488
  v_mfma_f32_16x16x32_bf16 v[52:55], a[208:211], a[108:111], v[52:55]
  ds_read_b64_tr_b16 a[204:205], v232 offset:57344
  s_waitcnt lgkmcnt(13)
  v_mfma_f32_16x16x32_bf16 v[52:55], a[212:215], a[124:127], v[52:55]
  ds_read_b64_tr_b16 a[206:207], v232 offset:59392
  v_mfma_f32_16x16x32_bf16 v[36:39], a[208:211], a[104:107], v[36:39]
  v_mfma_f32_16x16x32_bf16 v[36:39], a[212:215], a[120:123], v[36:39]
  buffer_load_dwordx4 a[4:7], v225, s[4:7], s40 offen offset:1024 sc1
  v_mfma_f32_16x16x32_bf16 v[20:23], a[208:211], a[100:103], v[20:23]
  v_mfma_f32_16x16x32_bf16 v[20:23], a[212:215], a[116:119], v[20:23]
  v_mfma_f32_16x16x32_bf16 v[4:7], a[208:211], a[96:99], v[4:7]
  ds_read_b64_tr_b16 a[208:209], v236 offset:4096
  v_mfma_f32_16x16x32_bf16 v[4:7], a[212:215], a[112:115], v[4:7]
  ds_read_b64_tr_b16 a[210:211], v236 offset:6144
  v_mfma_f32_16x16x32_bf16 v[8:11], a[216:219], a[96:99], v[8:11]
  buffer_load_dwordx4 a[8:11], v225, s[4:7], s40 offen offset:2048 sc1
  v_mfma_f32_16x16x32_bf16 v[8:11], a[220:223], a[112:115], v[8:11]
  s_waitcnt vmcnt(28)
  s_barrier
  v_mfma_f32_16x16x32_bf16 v[24:27], a[216:219], a[100:103], v[24:27]
  ds_read_b64_tr_b16 a[212:213], v233 offset:57344
  ds_read_b64_tr_b16 a[214:215], v233 offset:59392
  v_mfma_f32_16x16x32_bf16 v[24:27], a[220:223], a[116:119], v[24:27]
  v_mfma_f32_16x16x32_bf16 v[40:43], a[216:219], a[104:107], v[40:43]
  v_mfma_f32_16x16x32_bf16 v[40:43], a[220:223], a[120:123], v[40:43]
  v_mfma_f32_16x16x32_bf16 v[56:59], a[216:219], a[108:111], v[56:59]
  buffer_load_dwordx4 a[12:15], v225, s[4:7], s40 offen offset:3072 sc1
  v_mfma_f32_16x16x32_bf16 v[56:59], a[220:223], a[124:127], v[56:59]
  ds_read_b64_tr_b16 a[216:217], v237 offset:4096
  s_mov_b32 s40, 13238272
  s_waitcnt lgkmcnt(13)
  v_mfma_f32_16x16x32_bf16 v[60:63], a[224:227], a[108:111], v[60:63]
  ds_read_b64_tr_b16 a[218:219], v237 offset:6144
  v_mfma_f32_16x16x32_bf16 v[60:63], a[228:231], a[124:127], v[60:63]
  ds_read_b64_tr_b16 a[220:221], v236 offset:20480
  ds_read_b64_tr_b16 a[222:223], v236 offset:22528
  v_mfma_f32_16x16x32_bf16 v[44:47], a[224:227], a[104:107], v[44:47]
  v_mfma_f32_16x16x32_bf16 v[44:47], a[228:231], a[120:123], v[44:47]
  buffer_load_dwordx4 a[16:19], v225, s[4:7], s40 offen offset:0 sc1
  v_mfma_f32_16x16x32_bf16 v[28:31], a[224:227], a[100:103], v[28:31]
  v_mfma_f32_16x16x32_bf16 v[28:31], a[228:231], a[116:119], v[28:31]
  v_mfma_f32_16x16x32_bf16 v[12:15], a[224:227], a[96:99], v[12:15]
  ds_read_b64_tr_b16 a[224:225], v236 offset:16384
  v_mfma_f32_16x16x32_bf16 v[12:15], a[228:231], a[112:115], v[12:15]
  ds_read_b64_tr_b16 a[226:227], v236 offset:18432
  v_mfma_f32_16x16x32_bf16 v[64:67], a[232:235], a[96:99], v[64:67]
  ds_read_b64_tr_b16 a[228:229], v237 offset:20480
  s_waitcnt lgkmcnt(13)
  v_mfma_f32_16x16x32_bf16 v[64:67], a[192:195], a[112:115], v[64:67]
  buffer_load_dwordx4 a[20:23], v225, s[4:7], s40 offen offset:1024 sc1
  v_mfma_f32_16x16x32_bf16 v[72:75], a[232:235], a[100:103], v[72:75]
  ds_read_b64_tr_b16 a[230:231], v237 offset:22528
  v_mfma_f32_16x16x32_bf16 v[72:75], a[192:195], a[116:119], v[72:75]
  v_mfma_f32_16x16x32_bf16 v[80:83], a[232:235], a[104:107], v[80:83]
  v_mfma_f32_16x16x32_bf16 v[80:83], a[192:195], a[120:123], v[80:83]
  v_mfma_f32_16x16x32_bf16 v[88:91], a[232:235], a[108:111], v[88:91]
  buffer_load_dwordx4 a[24:27], v225, s[4:7], s40 offen offset:2048 sc1
  v_mfma_f32_16x16x32_bf16 v[88:91], a[192:195], a[124:127], v[88:91]
  ds_read_b64_tr_b16 a[232:233], v237 offset:16384
  v_mfma_f32_16x16x32_bf16 v[92:95], a[196:199], a[108:111], v[92:95]
  ds_read_b64_tr_b16 a[234:235], v237 offset:18432
  v_mfma_f32_16x16x32_bf16 v[92:95], a[200:203], a[124:127], v[92:95]
  ds_read_b64_tr_b16 a[192:193], v234 offset:57344
  ds_read_b64_tr_b16 a[194:195], v234 offset:59392
  v_mfma_f32_16x16x32_bf16 v[84:87], a[196:199], a[104:107], v[84:87]
  v_mfma_f32_16x16x32_bf16 v[84:87], a[200:203], a[120:123], v[84:87]
  v_mfma_f32_16x16x32_bf16 v[76:79], a[196:199], a[100:103], v[76:79]
  buffer_load_dwordx4 a[28:31], v225, s[4:7], s40 offen offset:3072 sc1
  v_mfma_f32_16x16x32_bf16 v[76:79], a[200:203], a[116:119], v[76:79]
  s_mov_b32 s41, 5046272
  s_add_u32 m0, s42, 40960
  v_mfma_f32_16x16x32_bf16 v[68:71], a[196:199], a[96:99], v[68:71]
  ds_read_b64_tr_b16 a[196:197], v238 offset:4096
  v_mfma_f32_16x16x32_bf16 v[68:71], a[200:203], a[112:115], v[68:71]
  ds_read_b64_tr_b16 a[198:199], v238 offset:6144
  s_waitcnt vmcnt(29) lgkmcnt(13)
  v_mfma_f32_16x16x32_bf16 v[0:3], a[204:207], a[128:131], v[0:3]
  ds_read_b64_tr_b16 a[200:201], v238 offset:20480
  s_waitcnt vmcnt(25)
  v_mfma_f32_16x16x32_bf16 v[0:3], a[208:211], a[144:147], v[0:3]
  buffer_load_dwordx4 v226, s[12:15], s41 offen offset:0 lds
  v_mfma_f32_16x16x32_bf16 v[16:19], a[204:207], a[132:135], v[16:19]
  ds_read_b64_tr_b16 a[202:203], v238 offset:22528
  s_mov_b32 s41, 5275648
  v_mfma_f32_16x16x32_bf16 v[16:19], a[208:211], a[148:151], v[16:19]
  s_add_u32 m0, s42, 69632
  v_mfma_f32_16x16x32_bf16 v[32:35], a[204:207], a[136:139], v[32:35]
  v_mfma_f32_16x16x32_bf16 v[32:35], a[208:211], a[152:155], v[32:35]
  v_mfma_f32_16x16x32_bf16 v[48:51], a[204:207], a[140:143], v[48:51]
  ds_read_b64_tr_b16 a[204:205], v238 offset:16384
  v_mfma_f32_16x16x32_bf16 v[48:51], a[208:211], a[156:159], v[48:51]
  buffer_load_dwordx4 v226, s[12:15], s41 offen offset:0 lds
  v_mfma_f32_16x16x32_bf16 v[52:55], a[212:215], a[140:143], v[52:55]
  ds_read_b64_tr_b16 a[206:207], v238 offset:18432
  s_mov_b32 s41, 5046272
  s_waitcnt lgkmcnt(13)
  v_mfma_f32_16x16x32_bf16 v[52:55], a[216:219], a[156:159], v[52:55]
  ds_read_b64_tr_b16 a[208:209], v236 offset:28672
  ds_read_b64_tr_b16 a[210:211], v236 offset:30720
  v_mfma_f32_16x16x32_bf16 v[36:39], a[212:215], a[136:139], v[36:39]
  s_add_u32 m0, s42, 81920
  v_mfma_f32_16x16x32_bf16 v[36:39], a[216:219], a[152:155], v[36:39]
  v_mfma_f32_16x16x32_bf16 v[20:23], a[212:215], a[132:135], v[20:23]
  buffer_load_dwordx4 v226, s[16:19], s41 offen offset:0 lds
  v_mfma_f32_16x16x32_bf16 v[20:23], a[216:219], a[148:151], v[20:23]
  s_mov_b32 s41, 5275648
  s_add_u32 m0, s42, 90112
  v_mfma_f32_16x16x32_bf16 v[4:7], a[212:215], a[128:131], v[4:7]
  ds_read_b64_tr_b16 a[212:213], v228 offset:16384
  v_mfma_f32_16x16x32_bf16 v[4:7], a[216:219], a[144:147], v[4:7]
  ds_read_b64_tr_b16 a[214:215], v228 offset:18432
  v_mfma_f32_16x16x32_bf16 v[8:11], a[220:223], a[128:131], v[8:11]
  ds_read_b64_tr_b16 a[216:217], v237 offset:28672
  s_waitcnt lgkmcnt(13)
  v_mfma_f32_16x16x32_bf16 v[8:11], a[224:227], a[144:147], v[8:11]
  ds_read_b64_tr_b16 a[218:219], v237 offset:30720
  v_mfma_f32_16x16x32_bf16 v[24:27], a[220:223], a[132:135], v[24:27]
  buffer_load_dwordx4 v226, s[16:19], s41 offen offset:0 lds
  v_mfma_f32_16x16x32_bf16 v[24:27], a[224:227], a[148:151], v[24:27]
  s_mov_b32 s41, 5505024
  s_add_u32 m0, s42, 118784
  v_mfma_f32_16x16x32_bf16 v[40:43], a[220:223], a[136:139], v[40:43]
  v_mfma_f32_16x16x32_bf16 v[40:43], a[224:227], a[152:155], v[40:43]
  v_mfma_f32_16x16x32_bf16 v[56:59], a[220:223], a[140:143], v[56:59]
  ds_read_b64_tr_b16 a[220:221], v229 offset:16384
  v_mfma_f32_16x16x32_bf16 v[56:59], a[224:227], a[156:159], v[56:59]
  buffer_load_dwordx4 v226, s[12:15], s41 offen offset:0 lds
  v_mfma_f32_16x16x32_bf16 v[60:63], a[228:231], a[140:143], v[60:63]
  ds_read_b64_tr_b16 a[222:223], v229 offset:18432
  s_mov_b32 s41, 5734400
  v_mfma_f32_16x16x32_bf16 v[60:63], a[232:235], a[156:159], v[60:63]
  s_waitcnt vmcnt(25)
  s_barrier
  v_mfma_f32_16x16x32_bf16 v[44:47], a[228:231], a[136:139], v[44:47]
  ds_read_b64_tr_b16 a[224:225], v228 offset:12288
  ds_read_b64_tr_b16 a[226:227], v228 offset:14336
  v_mfma_f32_16x16x32_bf16 v[44:47], a[232:235], a[152:155], v[44:47]
  s_add_u32 m0, s42, 131072
  v_mfma_f32_16x16x32_bf16 v[28:31], a[228:231], a[132:135], v[28:31]
  v_mfma_f32_16x16x32_bf16 v[28:31], a[232:235], a[148:151], v[28:31]
  buffer_load_dwordx4 v226, s[12:15], s41 offen offset:0 lds
  v_mfma_f32_16x16x32_bf16 v[12:15], a[228:231], a[128:131], v[12:15]
  ds_read_b64_tr_b16 a[228:229], v228 offset:24576
  s_mov_b32 s40, 13369344
  v_mfma_f32_16x16x32_bf16 v[12:15], a[232:235], a[144:147], v[12:15]
  ds_read_b64_tr_b16 a[230:231], v228 offset:26624
  s_waitcnt lgkmcnt(13)
  v_mfma_f32_16x16x32_bf16 v[64:67], a[192:195], a[128:131], v[64:67]
  ds_read_b64_tr_b16 a[232:233], v229 offset:12288
  v_mfma_f32_16x16x32_bf16 v[64:67], a[196:199], a[144:147], v[64:67]
  ds_read_b64_tr_b16 a[234:235], v229 offset:14336
  v_mfma_f32_16x16x32_bf16 v[72:75], a[192:195], a[132:135], v[72:75]
  buffer_load_dwordx4 a[32:35], v225, s[4:7], s40 offen offset:0 sc1
  v_mfma_f32_16x16x32_bf16 v[72:75], a[196:199], a[148:151], v[72:75]
  v_mfma_f32_16x16x32_bf16 v[80:83], a[192:195], a[136:139], v[80:83]
  v_mfma_f32_16x16x32_bf16 v[80:83], a[196:199], a[152:155], v[80:83]
  v_mfma_f32_16x16x32_bf16 v[88:91], a[192:195], a[140:143], v[88:91]
  ds_read_b64_tr_b16 a[192:193], v229 offset:24576
  v_mfma_f32_16x16x32_bf16 v[88:91], a[196:199], a[156:159], v[88:91]
  ds_read_b64_tr_b16 a[194:195], v229 offset:26624
  v_mfma_f32_16x16x32_bf16 v[92:95], a[200:203], a[140:143], v[92:95]
  buffer_load_dwordx4 a[36:39], v225, s[4:7], s40 offen offset:1024 sc1
  s_waitcnt lgkmcnt(13)
  v_mfma_f32_16x16x32_bf16 v[92:95], a[204:207], a[156:159], v[92:95]
  ds_read_b64_tr_b16 a[196:197], v238 offset:28672
  ds_read_b64_tr_b16 a[198:199], v238 offset:30720
  v_mfma_f32_16x16x32_bf16 v[84:87], a[200:203], a[136:139], v[84:87]
  v_mfma_f32_16x16x32_bf16 v[84:87], a[204:207], a[152:155], v[84:87]
  v_mfma_f32_16x16x32_bf16 v[76:79], a[200:203], a[132:135], v[76:79]
  v_mfma_f32_16x16x32_bf16 v[76:79], a[204:207], a[148:151], v[76:79]
  buffer_load_dwordx4 a[40:43], v225, s[4:7], s40 offen offset:2048 sc1
  v_mfma_f32_16x16x32_bf16 v[68:71], a[200:203], a[128:131], v[68:71]
  ds_read_b64_tr_b16 a[200:201], v230 offset:16384
  v_mfma_f32_16x16x32_bf16 v[68:71], a[204:207], a[144:147], v[68:71]
  ds_read_b64_tr_b16 a[202:203], v230 offset:18432
  s_waitcnt vmcnt(25)
  v_mfma_f32_16x16x32_bf16 v[0:3], a[208:211], a[160:163], v[0:3]
  ds_read_b64_tr_b16 a[204:205], v230 offset:12288
  s_waitcnt vmcnt(21) lgkmcnt(13)
  v_mfma_f32_16x16x32_bf16 v[0:3], a[212:215], a[176:179], v[0:3]
  ds_read_b64_tr_b16 a[206:207], v230 offset:14336
  v_mfma_f32_16x16x32_bf16 v[16:19], a[208:211], a[164:167], v[16:19]
  v_mfma_f32_16x16x32_bf16 v[16:19], a[212:215], a[180:183], v[16:19]
  buffer_load_dwordx4 a[44:47], v225, s[4:7], s40 offen offset:3072 sc1
  v_mfma_f32_16x16x32_bf16 v[32:35], a[208:211], a[168:171], v[32:35]
  s_mov_b32 s40, 13500416
  v_mfma_f32_16x16x32_bf16 v[32:35], a[212:215], a[184:187], v[32:35]
  v_mfma_f32_16x16x32_bf16 v[48:51], a[208:211], a[172:175], v[48:51]
  ds_read_b64_tr_b16 a[208:209], v230 offset:24576
  v_mfma_f32_16x16x32_bf16 v[48:51], a[212:215], a[188:191], v[48:51]
  ds_read_b64_tr_b16 a[210:211], v230 offset:26624
  v_mfma_f32_16x16x32_bf16 v[52:55], a[216:219], a[172:175], v[52:55]
  buffer_load_dwordx4 a[48:51], v225, s[4:7], s40 offen offset:0 sc1
  v_mfma_f32_16x16x32_bf16 v[52:55], a[220:223], a[188:191], v[52:55]
  ds_read_b64_tr_b16 a[212:213], v228 offset:45056
  ds_read_b64_tr_b16 a[214:215], v228 offset:47104
  v_mfma_f32_16x16x32_bf16 v[36:39], a[216:219], a[168:171], v[36:39]
  v_mfma_f32_16x16x32_bf16 v[36:39], a[220:223], a[184:187], v[36:39]
  v_mfma_f32_16x16x32_bf16 v[20:23], a[216:219], a[164:167], v[20:23]
  v_mfma_f32_16x16x32_bf16 v[20:23], a[220:223], a[180:183], v[20:23]
  v_mfma_f32_16x16x32_bf16 v[4:7], a[216:219], a[160:163], v[4:7]
  buffer_load_dwordx4 a[52:55], v225, s[4:7], s40 offen offset:1024 sc1
  v_mfma_f32_16x16x32_bf16 v[4:7], a[220:223], a[176:179], v[4:7]
  ds_read_b64_tr_b16 a[216:217], v228 offset:57344
  s_waitcnt lgkmcnt(13)
  v_mfma_f32_16x16x32_bf16 v[8:11], a[224:227], a[160:163], v[8:11]
  ds_read_b64_tr_b16 a[218:219], v228 offset:59392
  v_mfma_f32_16x16x32_bf16 v[8:11], a[228:231], a[176:179], v[8:11]
  ds_read_b64_tr_b16 a[220:221], v229 offset:45056
  ds_read_b64_tr_b16 a[222:223], v229 offset:47104
  v_mfma_f32_16x16x32_bf16 v[24:27], a[224:227], a[164:167], v[24:27]
  v_mfma_f32_16x16x32_bf16 v[24:27], a[228:231], a[180:183], v[24:27]
  buffer_load_dwordx4 a[56:59], v225, s[4:7], s40 offen offset:2048 sc1
  v_mfma_f32_16x16x32_bf16 v[40:43], a[224:227], a[168:171], v[40:43]
  v_mfma_f32_16x16x32_bf16 v[40:43], a[228:231], a[184:187], v[40:43]
  v_mfma_f32_16x16x32_bf16 v[56:59], a[224:227], a[172:175], v[56:59]
  ds_read_b64_tr_b16 a[224:225], v229 offset:57344
  v_mfma_f32_16x16x32_bf16 v[56:59], a[228:231], a[188:191], v[56:59]
  ds_read_b64_tr_b16 a[226:227], v229 offset:59392
  v_mfma_f32_16x16x32_bf16 v[60:63], a[232:235], a[172:175], v[60:63]
  ds_read_b64_tr_b16 a[228:229], v232 offset:0
  s_waitcnt lgkmcnt(13)
  v_mfma_f32_16x16x32_bf16 v[60:63], a[192:195], a[188:191], v[60:63]
  buffer_load_dwordx4 a[60:63], v225, s[4:7], s40 offen offset:3072 sc1
  v_mfma_f32_16x16x32_bf16 v[44:47], a[232:235], a[168:171], v[44:47]
  ds_read_b64_tr_b16 a[230:231], v232 offset:2048
  s_mov_b32 s41, 5505024
  v_mfma_f32_16x16x32_bf16 v[44:47], a[192:195], a[184:187], v[44:47]
  s_add_u32 m0, s42, 139264
  v_mfma_f32_16x16x32_bf16 v[28:31], a[232:235], a[164:167], v[28:31]
  v_mfma_f32_16x16x32_bf16 v[28:31], a[192:195], a[180:183], v[28:31]
  v_mfma_f32_16x16x32_bf16 v[12:15], a[232:235], a[160:163], v[12:15]
  buffer_load_dwordx4 v226, s[16:19], s41 offen offset:0 lds
  v_mfma_f32_16x16x32_bf16 v[12:15], a[192:195], a[176:179], v[12:15]
  ds_read_b64_tr_b16 a[232:233], v232 offset:28672
  s_mov_b32 s41, 5734400
  v_mfma_f32_16x16x32_bf16 v[64:67], a[196:199], a[160:163], v[64:67]
  ds_read_b64_tr_b16 a[234:235], v232 offset:30720
  s_add_u32 m0, s42, 20480
  v_mfma_f32_16x16x32_bf16 v[64:67], a[200:203], a[176:179], v[64:67]
  s_waitcnt vmcnt(23)
  s_barrier
  v_mfma_f32_16x16x32_bf16 v[72:75], a[196:199], a[164:167], v[72:75]
  ds_read_b64_tr_b16 a[192:193], v233 offset:0
  ds_read_b64_tr_b16 a[194:195], v233 offset:2048
  v_mfma_f32_16x16x32_bf16 v[72:75], a[200:203], a[180:183], v[72:75]
  v_mfma_f32_16x16x32_bf16 v[80:83], a[196:199], a[168:171], v[80:83]
  buffer_load_dwordx4 v226, s[16:19], s41 offen offset:0 lds
  v_mfma_f32_16x16x32_bf16 v[80:83], a[200:203], a[184:187], v[80:83]
  s_mov_b32 s41, 5963776
  s_add_u32 m0, s42, 143360
  v_mfma_f32_16x16x32_bf16 v[88:91], a[196:199], a[172:175], v[88:91]
  ds_read_b64_tr_b16 a[196:197], v233 offset:28672
  v_mfma_f32_16x16x32_bf16 v[88:91], a[200:203], a[188:191], v[88:91]
  ds_read_b64_tr_b16 a[198:199], v233 offset:30720
  s_waitcnt lgkmcnt(13)
  v_mfma_f32_16x16x32_bf16 v[92:95], a[204:207], a[172:175], v[92:95]
  ds_read_b64_tr_b16 a[200:201], v230 offset:45056
  v_mfma_f32_16x16x32_bf16 v[92:95], a[208:211], a[188:191], v[92:95]
  buffer_load_dwordx4 v226, s[12:15], s41 offen offset:0 lds
  v_mfma_f32_16x16x32_bf16 v[84:87], a[204:207], a[168:171], v[84:87]
  ds_read_b64_tr_b16 a[202:203], v230 offset:47104
  s_mov_b32 s41, 6193152
  v_mfma_f32_16x16x32_bf16 v[84:87], a[208:211], a[184:187], v[84:87]
  s_add_u32 m0, s42, 155648
  v_mfma_f32_16x16x32_bf16 v[76:79], a[204:207], a[164:167], v[76:79]
  v_mfma_f32_16x16x32_bf16 v[76:79], a[208:211], a[180:183], v[76:79]
  v_mfma_f32_16x16x32_bf16 v[68:71], a[204:207], a[160:163], v[68:71]
  ds_read_b64_tr_b16 a[204:205], v230 offset:57344
  v_mfma_f32_16x16x32_bf16 v[68:71], a[208:211], a[176:179], v[68:71]
  buffer_load_dwordx4 v226, s[12:15], s41 offen offset:0 lds
  s_waitcnt vmcnt(22)
  v_mfma_f32_16x16x32_bf16 v[0:3], a[212:215], a[0:3], v[0:3]
  ds_read_b64_tr_b16 a[206:207], v230 offset:59392
  s_mov_b32 s41, 5963776
  s_waitcnt vmcnt(18) lgkmcnt(13)
  v_mfma_f32_16x16x32_bf16 v[0:3], a[216:219], a[16:19], v[0:3]
  ds_read_b64_tr_b16 a[208:209], v234 offset:0
  ds_read_b64_tr_b16 a[210:211], v234 offset:2048
  v_mfma_f32_16x16x32_bf16 v[16:19], a[212:215], a[4:7], v[16:19]
  s_add_u32 m0, s42, 36864
  v_mfma_f32_16x16x32_bf16 v[16:19], a[216:219], a[20:23], v[16:19]
  v_mfma_f32_16x16x32_bf16 v[32:35], a[212:215], a[8:11], v[32:35]
  buffer_load_dwordx4 v226, s[16:19], s41 offen offset:0 lds
  v_mfma_f32_16x16x32_bf16 v[32:35], a[216:219], a[24:27], v[32:35]
  s_mov_b32 s41, 6193152
  s_add_u32 m0, s42, 53248
  v_mfma_f32_16x16x32_bf16 v[48:51], a[212:215], a[12:15], v[48:51]
  ds_read_b64_tr_b16 a[212:213], v234 offset:28672
  v_mfma_f32_16x16x32_bf16 v[48:51], a[216:219], a[28:31], v[48:51]
  ds_read_b64_tr_b16 a[214:215], v234 offset:30720
  v_mfma_f32_16x16x32_bf16 v[52:55], a[220:223], a[12:15], v[52:55]
  ds_read_b64_tr_b16 a[216:217], v232 offset:40960
  s_waitcnt lgkmcnt(13)
  v_mfma_f32_16x16x32_bf16 v[52:55], a[224:227], a[28:31], v[52:55]
  ds_read_b64_tr_b16 a[218:219], v232 offset:43008
  v_mfma_f32_16x16x32_bf16 v[36:39], a[220:223], a[8:11], v[36:39]
  buffer_load_dwordx4 v226, s[16:19], s41 offen offset:0 lds
  v_mfma_f32_16x16x32_bf16 v[36:39], a[224:227], a[24:27], v[36:39]
  s_mov_b32 s41, 6422528
  s_add_u32 m0, s42, 49152
  v_mfma_f32_16x16x32_bf16 v[20:23], a[220:223], a[4:7], v[20:23]
  v_mfma_f32_16x16x32_bf16 v[20:23], a[224:227], a[20:23], v[20:23]
  v_mfma_f32_16x16x32_bf16 v[4:7], a[220:223], a[0:3], v[4:7]
  ds_read_b64_tr_b16 a[220:221], v232 offset:49152
  v_mfma_f32_16x16x32_bf16 v[4:7], a[224:227], a[16:19], v[4:7]
  buffer_load_dwordx4 v226, s[12:15], s41 offen offset:0 lds
  v_mfma_f32_16x16x32_bf16 v[8:11], a[228:231], a[0:3], v[8:11]
  ds_read_b64_tr_b16 a[222:223], v232 offset:51200
  s_mov_b32 s41, 6651904
  v_mfma_f32_16x16x32_bf16 v[8:11], a[232:235], a[16:19], v[8:11]
  ds_read_b64_tr_b16 a[224:225], v233 offset:40960
  ds_read_b64_tr_b16 a[226:227], v233 offset:43008
L_wk1_6:
  s_cbranch_vccnz L_wk1_end
  v_mfma_f32_16x16x32_bf16 v[24:27], a[228:231], a[4:7], v[24:27]
  s_add_u32 m0, s42, 61440
  v_mfma_f32_16x16x32_bf16 v[24:27], a[232:235], a[20:23], v[24:27]
  v_mfma_f32_16x16x32_bf16 v[40:43], a[228:231], a[8:11], v[40:43]
  v_mfma_f32_16x16x32_bf16 v[40:43], a[232:235], a[24:27], v[40:43]
  buffer_load_dwordx4 v226, s[12:15], s41 offen offset:0 lds
  v_mfma_f32_16x16x32_bf16 v[56:59], a[228:231], a[12:15], v[56:59]
  ds_read_b64_tr_b16 a[228:229], v233 offset:49152
  s_mov_b32 s41, 6422528
  v_mfma_f32_16x16x32_bf16 v[56:59], a[232:235], a[28:31], v[56:59]
  ds_read_b64_tr_b16 a[230:231], v233 offset:51200
  s_add_u32 m0, s42, 77824
  s_waitcnt lgkmcnt(13)
  v_mfma_f32_16x16x32_bf16 v[60:63], a[192:195], a[12:15], v[60:63]
  ds_read_b64_tr_b16 a[232:233], v228 offset:28672
  v_mfma_f32_16x16x32_bf16 v[60:63], a[196:199], a[28:31], v[60:63]
  ds_read_b64_tr_b16 a[234:235], v228 offset:30720
  v_mfma_f32_16x16x32_bf16 v[44:47], a[192:195], a[8:11], v[44:47]
  buffer_load_dwordx4 v226, s[16:19], s41 offen offset:0 lds
  v_mfma_f32_16x16x32_bf16 v[44:47], a[196:199], a[24:27], v[44:47]
  s_mov_b32 s41, 6651904
  s_add_u32 m0, s42, 73728
  v_mfma_f32_16x16x32_bf16 v[28:31], a[192:195], a[4:7], v[28:31]
  v_mfma_f32_16x16x32_bf16 v[28:31], a[196:199], a[20:23], v[28:31]
  v_mfma_f32_16x16x32_bf16 v[12:15], a[192:195], a[0:3], v[12:15]
  ds_read_b64_tr_b16 a[192:193], v228 offset:32768
  v_mfma_f32_16x16x32_bf16 v[12:15], a[196:199], a[16:19], v[12:15]
  ds_read_b64_tr_b16 a[194:195], v228 offset:34816
  v_mfma_f32_16x16x32_bf16 v[64:67], a[200:203], a[0:3], v[64:67]
  buffer_load_dwordx4 v226, s[16:19], s41 offen offset:0 lds
  s_waitcnt lgkmcnt(13)
  v_mfma_f32_16x16x32_bf16 v[64:67], a[204:207], a[16:19], v[64:67]
  ds_read_b64_tr_b16 a[196:197], v229 offset:28672
  ds_read_b64_tr_b16 a[198:199], v229 offset:30720
  v_mfma_f32_16x16x32_bf16 v[72:75], a[200:203], a[4:7], v[72:75]
  s_mov_b32 s41, 6881280
  s_add_u32 m0, s42, 86016
  v_mfma_f32_16x16x32_bf16 v[72:75], a[204:207], a[20:23], v[72:75]
  v_mfma_f32_16x16x32_bf16 v[80:83], a[200:203], a[8:11], v[80:83]
  v_mfma_f32_16x16x32_bf16 v[80:83], a[204:207], a[24:27], v[80:83]
  buffer_load_dwordx4 v226, s[12:15], s41 offen offset:0 lds
  v_mfma_f32_16x16x32_bf16 v[88:91], a[200:203], a[12:15], v[88:91]
  ds_read_b64_tr_b16 a[200:201], v229 offset:32768
  s_mov_b32 s41, 7110656
  v_mfma_f32_16x16x32_bf16 v[88:91], a[204:207], a[28:31], v[88:91]
  ds_read_b64_tr_b16 a[202:203], v229 offset:34816
  s_add_u32 m0, s42, 102400
  v_mfma_f32_16x16x32_bf16 v[92:95], a[208:211], a[12:15], v[92:95]
  ds_read_b64_tr_b16 a[204:205], v234 offset:40960
  s_waitcnt lgkmcnt(13)
  v_mfma_f32_16x16x32_bf16 v[92:95], a[212:215], a[28:31], v[92:95]
  s_waitcnt vmcnt(19)
  s_barrier
  v_mfma_f32_16x16x32_bf16 v[84:87], a[208:211], a[8:11], v[84:87]
  ds_read_b64_tr_b16 a[206:207], v234 offset:43008
  v_mfma_f32_16x16x32_bf16 v[84:87], a[212:215], a[24:27], v[84:87]
  buffer_load_dwordx4 v226, s[12:15], s41 offen offset:0 lds
  v_mfma_f32_16x16x32_bf16 v[76:79], a[208:211], a[4:7], v[76:79]
  s_mov_b32 s41, 6881280
  s_add_u32 m0, s42, 98304
  v_mfma_f32_16x16x32_bf16 v[76:79], a[212:215], a[20:23], v[76:79]
  v_mfma_f32_16x16x32_bf16 v[68:71], a[208:211], a[0:3], v[68:71]
  ds_read_b64_tr_b16 a[208:209], v234 offset:49152
  v_mfma_f32_16x16x32_bf16 v[68:71], a[212:215], a[16:19], v[68:71]
  ds_read_b64_tr_b16 a[210:211], v234 offset:51200
  s_waitcnt vmcnt(16)
  v_mfma_f32_16x16x32_bf16 v[0:3], a[216:219], a[32:35], v[0:3]
  buffer_load_dwordx4 v226, s[16:19], s41 offen offset:0 lds
  s_waitcnt vmcnt(13)
  v_mfma_f32_16x16x32_bf16 v[0:3], a[220:223], a[48:51], v[0:3]
  ds_read_b64_tr_b16 a[212:213], v230 offset:28672
  ds_read_b64_tr_b16 a[214:215], v230 offset:30720
  v_mfma_f32_16x16x32_bf16 v[16:19], a[216:219], a[36:39], v[16:19]
  s_mov_b32 s41, 7110656
  s_add_u32 m0, s42, 110592
  v_mfma_f32_16x16x32_bf16 v[16:19], a[220:223], a[52:55], v[16:19]
  v_mfma_f32_16x16x32_bf16 v[32:35], a[216:219], a[40:43], v[32:35]
  v_mfma_f32_16x16x32_bf16 v[32:35], a[220:223], a[56:59], v[32:35]
  v_mfma_f32_16x16x32_bf16 v[48:51], a[216:219], a[44:47], v[48:51]
  buffer_load_dwordx4 v226, s[16:19], s41 offen offset:0 lds
  v_mfma_f32_16x16x32_bf16 v[48:51], a[220:223], a[60:63], v[48:51]
  ds_read_b64_tr_b16 a[216:217], v230 offset:32768
  s_mov_b32 s41, 131072
  s_waitcnt lgkmcnt(13)
  v_mfma_f32_16x16x32_bf16 v[52:55], a[224:227], a[44:47], v[52:55]
  ds_read_b64_tr_b16 a[218:219], v230 offset:34816
  s_add_u32 m0, s42, 126976
  v_mfma_f32_16x16x32_bf16 v[52:55], a[228:231], a[60:63], v[52:55]
  ds_read_b64_tr_b16 a[220:221], v228 offset:40960
  ds_read_b64_tr_b16 a[222:223], v228 offset:43008
  v_mfma_f32_16x16x32_bf16 v[36:39], a[224:227], a[40:43], v[36:39]
  v_mfma_f32_16x16x32_bf16 v[36:39], a[228:231], a[56:59], v[36:39]
  buffer_load_dwordx4 v242, s[44:47], s41 offen offset:0 lds
  v_mfma_f32_16x16x32_bf16 v[20:23], a[224:227], a[36:39], v[20:23]
  s_mov_b32 s41, 393216
  s_add_u32 m0, s42, 122880
  v_mfma_f32_16x16x32_bf16 v[20:23], a[228:231], a[52:55], v[20:23]
  v_mfma_f32_16x16x32_bf16 v[4:7], a[224:227], a[32:35], v[4:7]
  ds_read_b64_tr_b16 a[224:225], v232 offset:4096
  v_mfma_f32_16x16x32_bf16 v[4:7], a[228:231], a[48:51], v[4:7]
  ds_read_b64_tr_b16 a[226:227], v232 offset:6144
  v_mfma_f32_16x16x32_bf16 v[8:11], a[232:235], a[32:35], v[8:11]
  ds_read_b64_tr_b16 a[228:229], v229 offset:40960
  s_waitcnt lgkmcnt(13)
  v_mfma_f32_16x16x32_bf16 v[8:11], a[192:195], a[48:51], v[8:11]
  buffer_load_dwordx4 v242, s[44:47], s41 offen offset:0 lds
  v_mfma_f32_16x16x32_bf16 v[24:27], a[232:235], a[36:39], v[24:27]
  ds_read_b64_tr_b16 a[230:231], v229 offset:43008
  s_mov_b32 s41, 131072
  v_mfma_f32_16x16x32_bf16 v[24:27], a[192:195], a[52:55], v[24:27]
  s_add_u32 m0, s42, 135168
  v_mfma_f32_16x16x32_bf16 v[40:43], a[232:235], a[40:43], v[40:43]
  v_mfma_f32_16x16x32_bf16 v[40:43], a[192:195], a[56:59], v[40:43]
  v_mfma_f32_16x16x32_bf16 v[56:59], a[232:235], a[44:47], v[56:59]
  buffer_load_dwordx4 v253, s[44:47], s41 offen offset:0 lds
  v_mfma_f32_16x16x32_bf16 v[56:59], a[192:195], a[60:63], v[56:59]
  ds_read_b64_tr_b16 a[232:233], v233 offset:4096
  s_mov_b32 s41, 393216
  v_mfma_f32_16x16x32_bf16 v[60:63], a[196:199], a[44:47], v[60:63]
  ds_read_b64_tr_b16 a[234:235], v233 offset:6144
  s_add_u32 m0, s42, 151552
  v_mfma_f32_16x16x32_bf16 v[60:63], a[200:203], a[60:63], v[60:63]
  ds_read_b64_tr_b16 a[192:193], v232 offset:16384
  ds_read_b64_tr_b16 a[194:195], v232 offset:18432
  v_mfma_f32_16x16x32_bf16 v[44:47], a[196:199], a[40:43], v[44:47]
  v_mfma_f32_16x16x32_bf16 v[44:47], a[200:203], a[56:59], v[44:47]
  v_mfma_f32_16x16x32_bf16 v[28:31], a[196:199], a[36:39], v[28:31]
  buffer_load_dwordx4 v253, s[44:47], s41 offen offset:0 lds
  v_mfma_f32_16x16x32_bf16 v[28:31], a[200:203], a[52:55], v[28:31]
  s_mov_b32 s41, 458752
  s_add_u32 m0, s42, 147456
  v_mfma_f32_16x16x32_bf16 v[12:15], a[196:199], a[32:35], v[12:15]
  ds_read_b64_tr_b16 a[196:197], v232 offset:24576
  v_mfma_f32_16x16x32_bf16 v[12:15], a[200:203], a[48:51], v[12:15]
  ds_read_b64_tr_b16 a[198:199], v232 offset:26624
  ds_read_b64_tr_b16 a[200:201], v233 offset:16384
  v_mul_f32 v0, s43, v0
  v_mul_f32 v1, s43, v1
  v_mul_f32 v2, s43, v2
  s_waitcnt lgkmcnt(13)
  v_mfma_f32_16x16x32_bf16 v[64:67], a[204:207], a[32:35], v[64:67]
  ds_read_b64_tr_b16 a[202:203], v233 offset:18432
  v_mul_f32 v3, s43, v3
  v_mul_f32 v4, s43, v4
  v_mul_f32 v5, s43, v5
  v_mul_f32 v6, s43, v6
  v_mfma_f32_16x16x32_bf16 v[64:67], a[208:211], a[48:51], v[64:67]
  buffer_load_dwordx4 v242, s[44:47], s41 offen offset:0 lds
  v_mul_f32 v7, s43, v7
  v_exp_f32 v0, v0
  v_mfma_f32_16x16x32_bf16 v[72:75], a[204:207], a[36:39], v[72:75]
  s_mov_b32 s41, 720896
  s_add_u32 m0, s42, 159744
  v_exp_f32 v1, v1
  v_exp_f32 v2, v2
  v_mfma_f32_16x16x32_bf16 v[72:75], a[208:211], a[52:55], v[72:75]
  v_exp_f32 v3, v3
  v_exp_f32 v4, v4
  v_mfma_f32_16x16x32_bf16 v[80:83], a[204:207], a[40:43], v[80:83]
  v_exp_f32 v5, v5
  v_exp_f32 v6, v6
  v_mfma_f32_16x16x32_bf16 v[80:83], a[208:211], a[56:59], v[80:83]
  v_exp_f32 v7, v7
  v_add_f32 v0, 1.0, v0
  v_add_f32 v1, 1.0, v1
  v_add_f32 v2, 1.0, v2
  v_mfma_f32_16x16x32_bf16 v[88:91], a[204:207], a[44:47], v[88:91]
  ds_read_b64_tr_b16 a[204:205], v233 offset:24576
  ds_read_b64_tr_b16 a[206:207], v233 offset:26624
  v_add_f32 v3, 1.0, v3
  v_add_f32 v4, 1.0, v4
  v_add_f32 v5, 1.0, v5
  v_add_f32 v6, 1.0, v6
  v_mfma_f32_16x16x32_bf16 v[88:91], a[208:211], a[60:63], v[88:91]
  buffer_load_dwordx4 v242, s[44:47], s41 offen offset:0 lds
  v_add_f32 v7, 1.0, v7
  v_rcp_f32 v0, v0
  v_mfma_f32_16x16x32_bf16 v[92:95], a[212:215], a[44:47], v[92:95]
  ds_read_b64_tr_b16 a[208:209], v232 offset:53248
  ds_read_b64_tr_b16 a[210:211], v232 offset:55296
  v_rcp_f32 v1, v1
  v_rcp_f32 v2, v2
  v_mfma_f32_16x16x32_bf16 v[92:95], a[216:219], a[60:63], v[92:95]
  s_mov_b32 s41, 458752
  s_add_u32 m0, s42, 16384
  v_rcp_f32 v3, v3
  v_rcp_f32 v4, v4
  v_mfma_f32_16x16x32_bf16 v[84:87], a[212:215], a[40:43], v[84:87]
  v_rcp_f32 v5, v5
  v_rcp_f32 v6, v6
  v_mfma_f32_16x16x32_bf16 v[84:87], a[216:219], a[56:59], v[84:87]
  v_rcp_f32 v7, v7
  v_mul_f32 v0, v0, v8
  v_mul_f32 v1, v1, v9
  v_mul_f32 v2, v2, v10
  v_mfma_f32_16x16x32_bf16 v[76:79], a[212:215], a[36:39], v[76:79]
  buffer_load_dwordx4 v253, s[44:47], s41 offen offset:0 lds
  v_mul_f32 v3, v3, v11
  v_mul_f32 v4, v4, v12
  v_mul_f32 v5, v5, v13
  v_mul_f32 v6, v6, v14
  v_mfma_f32_16x16x32_bf16 v[76:79], a[216:219], a[52:55], v[76:79]
  s_mov_b32 s41, 720896
  s_add_u32 m0, s42, 12288
  v_mul_f32 v7, v7, v15
  v_cvt_pk_bf16_f32 v0, v0, v1
  v_cvt_pk_bf16_f32 v1, v2, v3
  v_cvt_pk_bf16_f32 v2, v4, v5
  v_mfma_f32_16x16x32_bf16 v[68:71], a[212:215], a[32:35], v[68:71]
  ds_read_b64_tr_b16 a[212:213], v236 offset:0
  ds_read_b64_tr_b16 a[214:215], v236 offset:2048
  v_cvt_pk_bf16_f32 v3, v6, v7
  buffer_store_dwordx4 v[0:3], v225, s[4:7], s64 offen offset:0 sc1
  v_mul_f32 v16, s43, v16
  v_mfma_f32_16x16x32_bf16 v[68:71], a[216:219], a[48:51], v[68:71]
  ds_read_b64_tr_b16 a[216:217], v233 offset:53248
  ds_read_b64_tr_b16 a[218:219], v233 offset:55296
  v_mul_f32 v17, s43, v17
  v_mul_f32 v18, s43, v18
  v_mul_f32 v19, s43, v19
  v_mul_f32 v20, s43, v20
  s_waitcnt lgkmcnt(13)
  v_mfma_f32_16x16x32_bf16 v[96:99], a[220:223], a[96:99], v[96:99]
  v_mul_f32 v21, s43, v21
  v_mul_f32 v22, s43, v22
  v_mul_f32 v23, s43, v23
  v_mfma_f32_16x16x32_bf16 v[96:99], a[224:227], a[112:115], v[96:99]
  s_waitcnt vmcnt(15)
  s_barrier
  v_exp_f32 v16, v16
  v_exp_f32 v17, v17
  v_mfma_f32_16x16x32_bf16 v[128:131], a[220:223], a[100:103], v[128:131]
  buffer_load_dwordx4 v253, s[44:47], s41 offen offset:0 lds
  v_exp_f32 v18, v18
  v_exp_f32 v19, v19
  v_mfma_f32_16x16x32_bf16 v[128:131], a[224:227], a[116:119], v[128:131]
  s_mov_b32 s41, 1048576
  s_add_u32 m0, s42, 24576
  v_exp_f32 v20, v20
  v_exp_f32 v21, v21
  v_mfma_f32_16x16x32_bf16 v[160:163], a[220:223], a[104:107], v[160:163]
  v_exp_f32 v22, v22
  v_exp_f32 v23, v23
  v_add_f32 v16, 1.0, v16
  v_mfma_f32_16x16x32_bf16 v[160:163], a[224:227], a[120:123], v[160:163]
  v_add_f32 v17, 1.0, v17
  v_add_f32 v18, 1.0, v18
  v_add_f32 v19, 1.0, v19
  v_add_f32 v20, 1.0, v20
  v_mfma_f32_16x16x32_bf16 v[192:195], a[220:223], a[108:111], v[192:195]
  ds_read_b64_tr_b16 a[220:221], v237 offset:0
  ds_read_b64_tr_b16 a[222:223], v237 offset:2048
  v_add_f32 v21, 1.0, v21
  v_add_f32 v22, 1.0, v22
  v_add_f32 v23, 1.0, v23
  v_mfma_f32_16x16x32_bf16 v[192:195], a[224:227], a[124:127], v[192:195]
  buffer_load_dwordx4 v242, s[44:47], s41 offen offset:0 lds
  v_rcp_f32 v16, v16
  v_rcp_f32 v17, v17
  v_mfma_f32_16x16x32_bf16 v[196:199], a[228:231], a[108:111], v[196:199]
  ds_read_b64_tr_b16 a[224:225], v236 offset:8192
  ds_read_b64_tr_b16 a[226:227], v236 offset:10240
  v_rcp_f32 v18, v18
  v_rcp_f32 v19, v19
  v_mfma_f32_16x16x32_bf16 v[196:199], a[232:235], a[124:127], v[196:199]
  s_mov_b32 s41, 1310720
  s_add_u32 m0, s42, 45056
  v_rcp_f32 v20, v20
  v_rcp_f32 v21, v21
  v_mfma_f32_16x16x32_bf16 v[164:167], a[228:231], a[104:107], v[164:167]
  v_rcp_f32 v22, v22
  v_rcp_f32 v23, v23
  v_mul_f32 v16, v16, v24
  v_mfma_f32_16x16x32_bf16 v[164:167], a[232:235], a[120:123], v[164:167]
  v_mul_f32 v17, v17, v25
  v_mul_f32 v18, v18, v26
  v_mul_f32 v19, v19, v27
  v_mul_f32 v20, v20, v28
  v_mfma_f32_16x16x32_bf16 v[132:135], a[228:231], a[100:103], v[132:135]
  v_mul_f32 v21, v21, v29
  v_mul_f32 v22, v22, v30
  v_mul_f32 v23, v23, v31
  v_cvt_pk_bf16_f32 v16, v16, v17
  v_mfma_f32_16x16x32_bf16 v[132:135], a[232:235], a[116:119], v[132:135]
  buffer_load_dwordx4 v242, s[44:47], s41 offen offset:0 lds
  v_cvt_pk_bf16_f32 v17, v18, v19
  v_cvt_pk_bf16_f32 v18, v20, v21
  v_cvt_pk_bf16_f32 v19, v22, v23
  v_mfma_f32_16x16x32_bf16 v[100:103], a[228:231], a[96:99], v[100:103]
  ds_read_b64_tr_b16 a[228:229], v228 offset:20480
  ds_read_b64_tr_b16 a[230:231], v228 offset:22528
  buffer_store_dwordx4 v[16:19], v225, s[4:7], s64 offen offset:1024 sc1
  v_mul_f32 v32, s43, v32
  v_mul_f32 v33, s43, v33
  v_mul_f32 v34, s43, v34
  v_mfma_f32_16x16x32_bf16 v[100:103], a[232:235], a[112:115], v[100:103]
  ds_read_b64_tr_b16 a[232:233], v237 offset:8192
  ds_read_b64_tr_b16 a[234:235], v237 offset:10240
  v_mul_f32 v35, s43, v35
  v_mul_f32 v36, s43, v36
  v_mul_f32 v37, s43, v37
  v_mul_f32 v38, s43, v38
  s_waitcnt lgkmcnt(13)
  v_mfma_f32_16x16x32_bf16 v[112:115], a[192:195], a[96:99], v[112:115]
  s_mov_b32 s41, 1048576
  s_add_u32 m0, s42, 57344
  v_mul_f32 v39, s43, v39
  v_exp_f32 v32, v32
  v_mfma_f32_16x16x32_bf16 v[112:115], a[196:199], a[112:115], v[112:115]
  v_exp_f32 v33, v33
  v_exp_f32 v34, v34
  v_mfma_f32_16x16x32_bf16 v[144:147], a[192:195], a[100:103], v[144:147]
  buffer_load_dwordx4 v253, s[44:47], s41 offen offset:0 lds
  v_exp_f32 v35, v35
  v_exp_f32 v36, v36
  v_mfma_f32_16x16x32_bf16 v[144:147], a[196:199], a[116:119], v[144:147]
  s_mov_b32 s41, 1310720
  s_add_u32 m0, s42, 65536
  v_exp_f32 v37, v37
  v_exp_f32 v38, v38
  v_mfma_f32_16x16x32_bf16 v[176:179], a[192:195], a[104:107], v[176:179]
  v_exp_f32 v39, v39
  v_add_f32 v32, 1.0, v32
  v_add_f32 v33, 1.0, v33
  v_add_f32 v34, 1.0, v34
  v_mfma_f32_16x16x32_bf16 v[176:179], a[196:199], a[120:123], v[176:179]
  v_add_f32 v35, 1.0, v35
  v_add_f32 v36, 1.0, v36
  v_add_f32 v37, 1.0, v37
  v_add_f32 v38, 1.0, v38
  v_mfma_f32_16x16x32_bf16 v[208:211], a[192:195], a[108:111], v[208:211]
  ds_read_b64_tr_b16 a[192:193], v229 offset:20480
  ds_read_b64_tr_b16 a[194:195], v229 offset:22528
  v_add_f32 v39, 1.0, v39
  v_rcp_f32 v32, v32
  v_mfma_f32_16x16x32_bf16 v[208:211], a[196:199], a[124:127], v[208:211]
  ds_read_b64_tr_b16 a[196:197], v236 offset:12288
  ds_read_b64_tr_b16 a[198:199], v236 offset:14336
  v_rcp_f32 v33, v33
  v_rcp_f32 v34, v34
  v_mfma_f32_16x16x32_bf16 v[212:215], a[200:203], a[108:111], v[212:215]
  buffer_load_dwordx4 v253, s[44:47], s41 offen offset:0 lds
  v_rcp_f32 v35, v35
  v_rcp_f32 v36, v36
  v_mfma_f32_16x16x32_bf16 v[212:215], a[204:207], a[124:127], v[212:215]
  s_mov_b32 s41, 1376256
  s_add_u32 m0, s42, 94208
  v_rcp_f32 v37, v37
  v_rcp_f32 v38, v38
  v_mfma_f32_16x16x32_bf16 v[180:183], a[200:203], a[104:107], v[180:183]
  v_rcp_f32 v39, v39
  v_mul_f32 v32, v32, v40
  v_mul_f32 v33, v33, v41
  v_mul_f32 v34, v34, v42
  v_mfma_f32_16x16x32_bf16 v[180:183], a[204:207], a[120:123], v[180:183]
  v_mul_f32 v35, v35, v43
  v_mul_f32 v36, v36, v44
  v_mul_f32 v37, v37, v45
  v_mul_f32 v38, v38, v46
  v_mfma_f32_16x16x32_bf16 v[148:151], a[200:203], a[100:103], v[148:151]
  v_mul_f32 v39, v39, v47
  v_cvt_pk_bf16_f32 v32, v32, v33
  v_cvt_pk_bf16_f32 v33, v34, v35
  v_cvt_pk_bf16_f32 v34, v36, v37
  v_mfma_f32_16x16x32_bf16 v[148:151], a[204:207], a[116:119], v[148:151]
  buffer_load_dwordx4 v242, s[44:47], s41 offen offset:0 lds
  v_cvt_pk_bf16_f32 v35, v38, v39
  buffer_store_dwordx4 v[32:35], v225, s[4:7], s64 offen offset:2048 sc1
  v_mul_f32 v48, s43, v48
  v_mfma_f32_16x16x32_bf16 v[116:119], a[200:203], a[96:99], v[116:119]
  ds_read_b64_tr_b16 a[200:201], v236 offset:24576
  ds_read_b64_tr_b16 a[202:203], v236 offset:26624
  v_mul_f32 v49, s43, v49
  v_mul_f32 v50, s43, v50
  v_mul_f32 v51, s43, v51
  v_mul_f32 v52, s43, v52
  v_mfma_f32_16x16x32_bf16 v[116:119], a[204:207], a[112:115], v[116:119]
  ds_read_b64_tr_b16 a[204:205], v237 offset:12288
  ds_read_b64_tr_b16 a[206:207], v237 offset:14336
  v_mul_f32 v53, s43, v53
  v_mul_f32 v54, s43, v54
  v_mul_f32 v55, s43, v55
  s_waitcnt lgkmcnt(13)
  v_mfma_f32_16x16x32_bf16 v[96:99], a[208:211], a[128:131], v[96:99]
  s_mov_b32 s41, 1638400
  s_add_u32 m0, s42, 106496
  v_exp_f32 v48, v48
  v_exp_f32 v49, v49
  v_mfma_f32_16x16x32_bf16 v[96:99], a[212:215], a[144:147], v[96:99]
  v_exp_f32 v50, v50
  v_exp_f32 v51, v51
  v_mfma_f32_16x16x32_bf16 v[128:131], a[208:211], a[132:135], v[128:131]
  v_exp_f32 v52, v52
  v_exp_f32 v53, v53
  v_mfma_f32_16x16x32_bf16 v[128:131], a[212:215], a[148:151], v[128:131]
  buffer_load_dwordx4 v242, s[44:47], s41 offen offset:0 lds
  v_exp_f32 v54, v54
  v_exp_f32 v55, v55
  v_add_f32 v48, 1.0, v48
  v_mfma_f32_16x16x32_bf16 v[160:163], a[208:211], a[136:139], v[160:163]
  s_mov_b32 s41, 1376256
  s_add_u32 m0, s42, 114688
  v_add_f32 v49, 1.0, v49
  v_add_f32 v50, 1.0, v50
  v_add_f32 v51, 1.0, v51
  v_add_f32 v52, 1.0, v52
  v_mfma_f32_16x16x32_bf16 v[160:163], a[212:215], a[152:155], v[160:163]
  v_add_f32 v53, 1.0, v53
  v_add_f32 v54, 1.0, v54
  v_add_f32 v55, 1.0, v55
  v_mfma_f32_16x16x32_bf16 v[192:195], a[208:211], a[140:143], v[192:195]
  ds_read_b64_tr_b16 a[208:209], v237 offset:24576
  ds_read_b64_tr_b16 a[210:211], v237 offset:26624
  v_rcp_f32 v48, v48
  v_rcp_f32 v49, v49
  v_mfma_f32_16x16x32_bf16 v[192:195], a[212:215], a[156:159], v[192:195]
  ds_read_b64_tr_b16 a[212:213], v228 offset:36864
  ds_read_b64_tr_b16 a[214:215], v228 offset:38912
  v_rcp_f32 v50, v50
  v_rcp_f32 v51, v51
  v_mfma_f32_16x16x32_bf16 v[196:199], a[216:219], a[140:143], v[196:199]
  buffer_load_dwordx4 v253, s[44:47], s41 offen offset:0 lds
  v_rcp_f32 v52, v52
  v_rcp_f32 v53, v53
  v_mfma_f32_16x16x32_bf16 v[196:199], a[220:223], a[156:159], v[196:199]
  s_mov_b32 s41, 1638400
  s_add_u32 m0, s42, 28672
  v_rcp_f32 v54, v54
  v_rcp_f32 v55, v55
  v_mul_f32 v48, v48, v56
  v_mfma_f32_16x16x32_bf16 v[164:167], a[216:219], a[136:139], v[164:167]
  v_mul_f32 v49, v49, v57
  v_mul_f32 v50, v50, v58
  v_mul_f32 v51, v51, v59
  v_mul_f32 v52, v52, v60
  v_mfma_f32_16x16x32_bf16 v[164:167], a[220:223], a[152:155], v[164:167]
  v_mul_f32 v53, v53, v61
  v_mul_f32 v54, v54, v62
  v_mul_f32 v55, v55, v63
  v_cvt_pk_bf16_f32 v48, v48, v49
  v_mfma_f32_16x16x32_bf16 v[132:135], a[216:219], a[132:135], v[132:135]
  v_cvt_pk_bf16_f32 v49, v50, v51
  v_cvt_pk_bf16_f32 v50, v52, v53
  v_cvt_pk_bf16_f32 v51, v54, v55
  v_mfma_f32_16x16x32_bf16 v[132:135], a[220:223], a[148:151], v[132:135]
  buffer_store_dwordx4 v[48:51], v225, s[4:7], s64 offen offset:3072 sc1
  v_mul_f32 v64, s43, v64
  v_mul_f32 v65, s43, v65
  v_mul_f32 v66, s43, v66
  v_mfma_f32_16x16x32_bf16 v[100:103], a[216:219], a[128:131], v[100:103]
  ds_read_b64_tr_b16 a[216:217], v228 offset:53248
  ds_read_b64_tr_b16 a[218:219], v228 offset:55296
  v_mul_f32 v67, s43, v67
  v_mfma_f32_16x16x32_bf16 v[100:103], a[220:223], a[144:147], v[100:103]
  buffer_load_dwordx4 v253, s[44:47], s41 offen offset:0 lds
  s_waitcnt lgkmcnt(13)
  v_mfma_f32_16x16x32_bf16 v[112:115], a[224:227], a[128:131], v[112:115]
  ds_read_b64_tr_b16 a[220:221], v229 offset:36864
  ds_read_b64_tr_b16 a[222:223], v229 offset:38912
  v_exp_f32 v64, v64
  v_mfma_f32_16x16x32_bf16 v[112:115], a[228:231], a[144:147], v[112:115]
  s_mov_b32 s41, 1966080
  s_add_u32 m0, s42, 32768
  v_exp_f32 v65, v65
  v_mfma_f32_16x16x32_bf16 v[144:147], a[224:227], a[132:135], v[144:147]
  v_exp_f32 v66, v66
  v_mfma_f32_16x16x32_bf16 v[144:147], a[228:231], a[148:151], v[144:147]
  v_exp_f32 v67, v67
  v_mfma_f32_16x16x32_bf16 v[176:179], a[224:227], a[136:139], v[176:179]
  buffer_load_dwordx4 v242, s[44:47], s41 offen offset:0 lds
  v_add_f32 v64, 1.0, v64
  v_mfma_f32_16x16x32_bf16 v[176:179], a[228:231], a[152:155], v[176:179]
  v_add_f32 v65, 1.0, v65
  v_add_f32 v66, 1.0, v66
  v_mfma_f32_16x16x32_bf16 v[208:211], a[224:227], a[140:143], v[208:211]
  ds_read_b64_tr_b16 a[224:225], v229 offset:53248
  ds_read_b64_tr_b16 a[226:227], v229 offset:55296
  v_add_f32 v67, 1.0, v67
  v_mfma_f32_16x16x32_bf16 v[208:211], a[228:231], a[156:159], v[208:211]
  ds_read_b64_tr_b16 a[228:229], v228 offset:49152
  ds_read_b64_tr_b16 a[230:231], v228 offset:51200
  v_mfma_f32_16x16x32_bf16 v[212:215], a[232:235], a[140:143], v[212:215]
  v_rcp_f32 v64, v64
  s_waitcnt lgkmcnt(13)
  v_mfma_f32_16x16x32_bf16 v[212:215], a[192:195], a[156:159], v[212:215]
  s_waitcnt vmcnt(21)
  s_barrier
  v_rcp_f32 v65, v65
  v_mfma_f32_16x16x32_bf16 v[180:183], a[232:235], a[136:139], v[180:183]
  v_rcp_f32 v66, v66
  v_mfma_f32_16x16x32_bf16 v[180:183], a[192:195], a[152:155], v[180:183]
  v_rcp_f32 v67, v67
  v_mfma_f32_16x16x32_bf16 v[148:151], a[232:235], a[132:135], v[148:151]
  v_mul_f32 v64, v64, v68
  v_mul_f32 v65, v65, v69
  v_mfma_f32_16x16x32_bf16 v[148:151], a[192:195], a[148:151], v[148:151]
  v_mul_f32 v66, v66, v70
  v_mul_f32 v67, v67, v71
  v_mfma_f32_16x16x32_bf16 v[116:119], a[232:235], a[128:131], v[116:119]
  ds_read_b64_tr_b16 a[232:233], v228 offset:61440
  ds_read_b64_tr_b16 a[234:235], v228 offset:63488
  v_mfma_f32_16x16x32_bf16 v[116:119], a[192:195], a[144:147], v[116:119]
  ds_read_b64_tr_b16 a[192:193], v229 offset:49152
  ds_read_b64_tr_b16 a[194:195], v229 offset:51200
  v_cvt_pk_bf16_f32 v64, v64, v65
  v_cvt_pk_bf16_f32 v65, v66, v67
  v_mfma_f32_16x16x32_bf16 v[96:99], a[196:199], a[160:163], v[96:99]
  v_mul_f32 v72, s43, v72
  v_mul_f32 v73, s43, v73
  v_mfma_f32_16x16x32_bf16 v[96:99], a[200:203], a[176:179], v[96:99]
  v_mul_f32 v74, s43, v74
  v_mul_f32 v75, s43, v75
  v_mfma_f32_16x16x32_bf16 v[128:131], a[196:199], a[164:167], v[128:131]
  v_exp_f32 v72, v72
  v_mfma_f32_16x16x32_bf16 v[128:131], a[200:203], a[180:183], v[128:131]
  v_exp_f32 v73, v73
  v_mfma_f32_16x16x32_bf16 v[160:163], a[196:199], a[168:171], v[160:163]
  v_exp_f32 v74, v74
  v_mfma_f32_16x16x32_bf16 v[160:163], a[200:203], a[184:187], v[160:163]
  v_exp_f32 v75, v75
  v_mfma_f32_16x16x32_bf16 v[192:195], a[196:199], a[172:175], v[192:195]
  ds_read_b64_tr_b16 a[196:197], v229 offset:61440
  ds_read_b64_tr_b16 a[198:199], v229 offset:63488
  v_mfma_f32_16x16x32_bf16 v[192:195], a[200:203], a[188:191], v[192:195]
  ds_read_b64_tr_b16 a[200:201], v232 offset:12288
  ds_read_b64_tr_b16 a[202:203], v232 offset:14336
  s_waitcnt lgkmcnt(13)
  v_mfma_f32_16x16x32_bf16 v[196:199], a[204:207], a[172:175], v[196:199]
  v_add_f32 v72, 1.0, v72
  v_add_f32 v73, 1.0, v73
  v_mfma_f32_16x16x32_bf16 v[196:199], a[208:211], a[188:191], v[196:199]
  v_add_f32 v74, 1.0, v74
  v_add_f32 v75, 1.0, v75
  v_mfma_f32_16x16x32_bf16 v[164:167], a[204:207], a[168:171], v[164:167]
  v_rcp_f32 v72, v72
  v_mfma_f32_16x16x32_bf16 v[164:167], a[208:211], a[184:187], v[164:167]
  v_rcp_f32 v73, v73
  v_mfma_f32_16x16x32_bf16 v[132:135], a[204:207], a[164:167], v[132:135]
  v_rcp_f32 v74, v74
  v_mfma_f32_16x16x32_bf16 v[132:135], a[208:211], a[180:183], v[132:135]
  v_rcp_f32 v75, v75
  v_mfma_f32_16x16x32_bf16 v[100:103], a[204:207], a[160:163], v[100:103]
  ds_read_b64_tr_b16 a[204:205], v232 offset:8192
  ds_read_b64_tr_b16 a[206:207], v232 offset:10240
  v_mfma_f32_16x16x32_bf16 v[100:103], a[208:211], a[176:179], v[100:103]
  ds_read_b64_tr_b16 a[208:209], v233 offset:12288
  ds_read_b64_tr_b16 a[210:211], v233 offset:14336
  v_mfma_f32_16x16x32_bf16 v[112:115], a[212:215], a[160:163], v[112:115]
  v_mul_f32 v72, v72, v76
  v_mul_f32 v73, v73, v77
  v_mfma_f32_16x16x32_bf16 v[112:115], a[216:219], a[176:179], v[112:115]
  v_mul_f32 v74, v74, v78
  v_mul_f32 v75, v75, v79
  v_mfma_f32_16x16x32_bf16 v[144:147], a[212:215], a[164:167], v[144:147]
  v_cvt_pk_bf16_f32 v66, v72, v73
  v_cvt_pk_bf16_f32 v67, v74, v75
  v_mfma_f32_16x16x32_bf16 v[144:147], a[216:219], a[180:183], v[144:147]
  buffer_store_dwordx4 v[64:67], v225, s[4:7], s65 offen offset:0 sc1
  v_mfma_f32_16x16x32_bf16 v[176:179], a[212:215], a[168:171], v[176:179]
  v_mul_f32 v80, s43, v80
  v_mul_f32 v81, s43, v81
  v_mfma_f32_16x16x32_bf16 v[176:179], a[216:219], a[184:187], v[176:179]
  v_mul_f32 v82, s43, v82
  v_mul_f32 v83, s43, v83
  v_mfma_f32_16x16x32_bf16 v[208:211], a[212:215], a[172:175], v[208:211]
  ds_read_b64_tr_b16 a[212:213], v233 offset:8192
  ds_read_b64_tr_b16 a[214:215], v233 offset:10240
  v_mfma_f32_16x16x32_bf16 v[208:211], a[216:219], a[188:191], v[208:211]
  ds_read_b64_tr_b16 a[216:217], v232 offset:20480
  ds_read_b64_tr_b16 a[218:219], v232 offset:22528
  s_waitcnt lgkmcnt(13)
  v_mfma_f32_16x16x32_bf16 v[212:215], a[220:223], a[172:175], v[212:215]
  v_exp_f32 v80, v80
  v_mfma_f32_16x16x32_bf16 v[212:215], a[224:227], a[188:191], v[212:215]
  v_exp_f32 v81, v81
  v_mfma_f32_16x16x32_bf16 v[180:183], a[220:223], a[168:171], v[180:183]
  s_waitcnt vmcnt(3)
  v_add_u32 v248, 0, v245
  buffer_store_dword v248, v246, s[4:7], s90 offen sc1
  v_mfma_f32_16x16x32_bf16 v[180:183], a[224:227], a[184:187], v[180:183]
  v_exp_f32 v82, v82
  v_mfma_f32_16x16x32_bf16 v[148:151], a[220:223], a[164:167], v[148:151]
  v_exp_f32 v83, v83
  v_mfma_f32_16x16x32_bf16 v[148:151], a[224:227], a[180:183], v[148:151]
  v_add_f32 v80, 1.0, v80
  v_add_f32 v81, 1.0, v81
  v_mfma_f32_16x16x32_bf16 v[116:119], a[220:223], a[160:163], v[116:119]
  ds_read_b64_tr_b16 a[220:221], v232 offset:36864
  ds_read_b64_tr_b16 a[222:223], v232 offset:38912
  v_mfma_f32_16x16x32_bf16 v[116:119], a[224:227], a[176:179], v[116:119]
  ds_read_b64_tr_b16 a[224:225], v233 offset:20480
  ds_read_b64_tr_b16 a[226:227], v233 offset:22528
  v_add_f32 v82, 1.0, v82
  v_add_f32 v83, 1.0, v83
  v_mfma_f32_16x16x32_bf16 v[96:99], a[228:231], a[0:3], v[96:99]
  v_rcp_f32 v80, v80
  v_mfma_f32_16x16x32_bf16 v[96:99], a[232:235], a[16:19], v[96:99]
  v_rcp_f32 v81, v81
  v_mfma_f32_16x16x32_bf16 v[128:131], a[228:231], a[4:7], v[128:131]
  v_rcp_f32 v82, v82
  v_mfma_f32_16x16x32_bf16 v[128:131], a[232:235], a[20:23], v[128:131]
  v_rcp_f32 v83, v83
  v_mfma_f32_16x16x32_bf16 v[160:163], a[228:231], a[8:11], v[160:163]
  v_mul_f32 v80, v80, v84
  v_mul_f32 v81, v81, v85
  v_mfma_f32_16x16x32_bf16 v[160:163], a[232:235], a[24:27], v[160:163]
  v_mul_f32 v82, v82, v86
  v_mul_f32 v83, v83, v87
  v_mfma_f32_16x16x32_bf16 v[192:195], a[228:231], a[12:15], v[192:195]
  ds_read_b64_tr_b16 a[228:229], v233 offset:36864
  ds_read_b64_tr_b16 a[230:231], v233 offset:38912
  v_mfma_f32_16x16x32_bf16 v[192:195], a[232:235], a[28:31], v[192:195]
  ds_read_b64_tr_b16 a[232:233], v232 offset:32768
  ds_read_b64_tr_b16 a[234:235], v232 offset:34816
  s_waitcnt lgkmcnt(13)
  v_mfma_f32_16x16x32_bf16 v[196:199], a[192:195], a[12:15], v[196:199]
  v_cvt_pk_bf16_f32 v80, v80, v81
  v_cvt_pk_bf16_f32 v81, v82, v83
  v_mfma_f32_16x16x32_bf16 v[196:199], a[196:199], a[28:31], v[196:199]
  v_mul_f32 v88, s43, v88
  v_mul_f32 v89, s43, v89
  v_mfma_f32_16x16x32_bf16 v[164:167], a[192:195], a[8:11], v[164:167]
  v_mul_f32 v90, s43, v90
  v_mul_f32 v91, s43, v91
  v_mfma_f32_16x16x32_bf16 v[164:167], a[196:199], a[24:27], v[164:167]
  v_exp_f32 v88, v88
  v_mfma_f32_16x16x32_bf16 v[132:135], a[192:195], a[4:7], v[132:135]
  v_exp_f32 v89, v89
  v_mfma_f32_16x16x32_bf16 v[132:135], a[196:199], a[20:23], v[132:135]
  v_exp_f32 v90, v90
  v_mfma_f32_16x16x32_bf16 v[100:103], a[192:195], a[0:3], v[100:103]
  ds_read_b64_tr_b16 a[192:193], v232 offset:45056
  ds_read_b64_tr_b16 a[194:195], v232 offset:47104
  v_mfma_f32_16x16x32_bf16 v[100:103], a[196:199], a[16:19], v[100:103]
  ds_read_b64_tr_b16 a[196:197], v233 offset:32768
  ds_read_b64_tr_b16 a[198:199], v233 offset:34816
  v_mfma_f32_16x16x32_bf16 v[112:115], a[200:203], a[0:3], v[112:115]
L_wk1_7:
  s_cbranch_vccnz L_wk1_end
  v_exp_f32 v91, v91
  v_mfma_f32_16x16x32_bf16 v[112:115], a[204:207], a[16:19], v[112:115]
  s_barrier
  v_add_f32 v88, 1.0, v88
  v_mfma_f32_16x16x32_bf16 v[144:147], a[200:203], a[4:7], v[144:147]
  v_add_f32 v89, 1.0, v89
  v_add_f32 v90, 1.0, v90
  v_mfma_f32_16x16x32_bf16 v[144:147], a[204:207], a[20:23], v[144:147]
  v_add_f32 v91, 1.0, v91
  v_mfma_f32_16x16x32_bf16 v[176:179], a[200:203], a[8:11], v[176:179]
  v_rcp_f32 v88, v88
  v_mfma_f32_16x16x32_bf16 v[176:179], a[204:207], a[24:27], v[176:179]
  v_rcp_f32 v89, v89
  v_mfma_f32_16x16x32_bf16 v[208:211], a[200:203], a[12:15], v[208:211]
  ds_read_b64_tr_b16 a[200:201], v233 offset:45056
  ds_read_b64_tr_b16 a[202:203], v233 offset:47104
  v_mfma_f32_16x16x32_bf16 v[208:211], a[204:207], a[28:31], v[208:211]
  ds_read_b64_tr_b16 a[204:205], v230 offset:40960
  ds_read_b64_tr_b16 a[206:207], v230 offset:43008
  s_waitcnt lgkmcnt(13)
  v_mfma_f32_16x16x32_bf16 v[212:215], a[208:211], a[12:15], v[212:215]
  v_rcp_f32 v90, v90
  v_mfma_f32_16x16x32_bf16 v[212:215], a[212:215], a[28:31], v[212:215]
  v_rcp_f32 v91, v91
  v_mul_f32 v88, v88, v92
  v_mfma_f32_16x16x32_bf16 v[180:183], a[208:211], a[8:11], v[180:183]
  v_mul_f32 v89, v89, v93
  v_mul_f32 v90, v90, v94
  v_mfma_f32_16x16x32_bf16 v[180:183], a[212:215], a[24:27], v[180:183]
  v_mul_f32 v91, v91, v95
  v_cvt_pk_bf16_f32 v82, v88, v89
  v_mfma_f32_16x16x32_bf16 v[148:151], a[208:211], a[4:7], v[148:151]
  v_cvt_pk_bf16_f32 v83, v90, v91
  v_mfma_f32_16x16x32_bf16 v[148:151], a[212:215], a[20:23], v[148:151]
  buffer_store_dwordx4 v[80:83], v225, s[4:7], s65 offen offset:2048 sc1
  v_mfma_f32_16x16x32_bf16 v[116:119], a[208:211], a[0:3], v[116:119]
  ds_read_b64_tr_b16 a[208:209], v234 offset:4096
  ds_read_b64_tr_b16 a[210:211], v234 offset:6144
  v_mfma_f32_16x16x32_bf16 v[116:119], a[212:215], a[16:19], v[116:119]
  ds_read_b64_tr_b16 a[212:213], v231 offset:40960
  ds_read_b64_tr_b16 a[214:215], v231 offset:43008
  v_mfma_f32_16x16x32_bf16 v[96:99], a[216:219], a[32:35], v[96:99]
  v_mfma_f32_16x16x32_bf16 v[96:99], a[220:223], a[48:51], v[96:99]
  v_mfma_f32_16x16x32_bf16 v[128:131], a[216:219], a[36:39], v[128:131]
  v_mfma_f32_16x16x32_bf16 v[128:131], a[220:223], a[52:55], v[128:131]
  v_mfma_f32_16x16x32_bf16 v[160:163], a[216:219], a[40:43], v[160:163]
  v_mfma_f32_16x16x32_bf16 v[160:163], a[220:223], a[56:59], v[160:163]
  v_mfma_f32_16x16x32_bf16 v[192:195], a[216:219], a[44:47], v[192:195]
  ds_read_b64_tr_b16 a[216:217], v235 offset:4096
  ds_read_b64_tr_b16 a[218:219], v235 offset:6144
  v_mfma_f32_16x16x32_bf16 v[192:195], a[220:223], a[60:63], v[192:195]
  ds_read_b64_tr_b16 a[220:221], v234 offset:16384
  ds_read_b64_tr_b16 a[222:223], v234 offset:18432
  s_waitcnt lgkmcnt(13)
  v_mfma_f32_16x16x32_bf16 v[196:199], a[224:227], a[44:47], v[196:199]
  v_mfma_f32_16x16x32_bf16 v[196:199], a[228:231], a[60:63], v[196:199]
  v_mfma_f32_16x16x32_bf16 v[164:167], a[224:227], a[40:43], v[164:167]
  v_mfma_f32_16x16x32_bf16 v[164:167], a[228:231], a[56:59], v[164:167]
  v_mfma_f32_16x16x32_bf16 v[132:135], a[224:227], a[36:39], v[132:135]
  v_mfma_f32_16x16x32_bf16 v[132:135], a[228:231], a[52:55], v[132:135]
  v_mfma_f32_16x16x32_bf16 v[100:103], a[224:227], a[32:35], v[100:103]
  ds_read_b64_tr_b16 a[224:225], v234 offset:24576
  ds_read_b64_tr_b16 a[226:227], v234 offset:26624
  v_mfma_f32_16x16x32_bf16 v[100:103], a[228:231], a[48:51], v[100:103]
  ds_read_b64_tr_b16 a[228:229], v235 offset:16384
  ds_read_b64_tr_b16 a[230:231], v235 offset:18432
  v_mfma_f32_16x16x32_bf16 v[112:115], a[232:235], a[32:35], v[112:115]
  v_mfma_f32_16x16x32_bf16 v[112:115], a[192:195], a[48:51], v[112:115]
  v_mfma_f32_16x16x32_bf16 v[144:147], a[232:235], a[36:39], v[144:147]
  v_mfma_f32_16x16x32_bf16 v[144:147], a[192:195], a[52:55], v[144:147]
  v_mfma_f32_16x16x32_bf16 v[176:179], a[232:235], a[40:43], v[176:179]
  v_mfma_f32_16x16x32_bf16 v[176:179], a[192:195], a[56:59], v[176:179]
  v_mfma_f32_16x16x32_bf16 v[208:211], a[232:235], a[44:47], v[208:211]
  ds_read_b64_tr_b16 a[232:233], v235 offset:24576
  ds_read_b64_tr_b16 a[234:235], v235 offset:26624
  v_mfma_f32_16x16x32_bf16 v[208:211], a[192:195], a[60:63], v[208:211]
  ds_read_b64_tr_b16 a[192:193], v234 offset:53248
  ds_read_b64_tr_b16 a[194:195], v234 offset:55296
  s_waitcnt lgkmcnt(13)
  v_mfma_f32_16x16x32_bf16 v[212:215], a[196:199], a[44:47], v[212:215]
  v_mfma_f32_16x16x32_bf16 v[212:215], a[200:203], a[60:63], v[212:215]
  v_mfma_f32_16x16x32_bf16 v[180:183], a[196:199], a[40:43], v[180:183]
  v_mfma_f32_16x16x32_bf16 v[180:183], a[200:203], a[56:59], v[180:183]
  v_mfma_f32_16x16x32_bf16 v[148:151], a[196:199], a[36:39], v[148:151]
  v_mfma_f32_16x16x32_bf16 v[148:151], a[200:203], a[52:55], v[148:151]
  v_mfma_f32_16x16x32_bf16 v[116:119], a[196:199], a[32:35], v[116:119]
  ds_read_b64_tr_b16 a[196:197], v238 offset:0
  ds_read_b64_tr_b16 a[198:199], v238 offset:2048
  v_mfma_f32_16x16x32_bf16 v[116:119], a[200:203], a[48:51], v[116:119]
  ds_read_b64_tr_b16 a[200:201], v235 offset:53248
  ds_read_b64_tr_b16 a[202:203], v235 offset:55296
  v_mfma_f32_16x16x32_bf16 v[104:107], a[204:207], a[96:99], v[104:107]
  v_mul_f32 v96, s43, v96
  v_mul_f32 v97, s43, v97
  v_mfma_f32_16x16x32_bf16 v[104:107], a[208:211], a[112:115], v[104:107]
  v_mul_f32 v98, s43, v98
  v_mul_f32 v99, s43, v99
  v_mfma_f32_16x16x32_bf16 v[136:139], a[204:207], a[100:103], v[136:139]
  v_mul_f32 v100, s43, v100
  v_mul_f32 v101, s43, v101
  v_mfma_f32_16x16x32_bf16 v[136:139], a[208:211], a[116:119], v[136:139]
  v_mul_f32 v102, s43, v102
  v_mul_f32 v103, s43, v103
  v_mfma_f32_16x16x32_bf16 v[168:171], a[204:207], a[104:107], v[168:171]
  v_exp_f32 v96, v96
  v_mfma_f32_16x16x32_bf16 v[168:171], a[208:211], a[120:123], v[168:171]
  v_exp_f32 v97, v97
  v_mfma_f32_16x16x32_bf16 v[200:203], a[204:207], a[108:111], v[200:203]
  ds_read_b64_tr_b16 a[204:205], v239 offset:0
  ds_read_b64_tr_b16 a[206:207], v239 offset:2048
  v_mfma_f32_16x16x32_bf16 v[200:203], a[208:211], a[124:127], v[200:203]
  ds_read_b64_tr_b16 a[208:209], v238 offset:8192
  ds_read_b64_tr_b16 a[210:211], v238 offset:10240
  s_waitcnt lgkmcnt(13)
  v_mfma_f32_16x16x32_bf16 v[204:207], a[212:215], a[108:111], v[204:207]
  v_exp_f32 v98, v98
  v_mfma_f32_16x16x32_bf16 v[204:207], a[216:219], a[124:127], v[204:207]
  s_barrier
  v_exp_f32 v99, v99
  v_mfma_f32_16x16x32_bf16 v[172:175], a[212:215], a[104:107], v[172:175]
  s_mov_b32 s41, 2228224
  s_add_u32 m0, s42, 40960
  v_exp_f32 v100, v100
  v_mfma_f32_16x16x32_bf16 v[172:175], a[216:219], a[120:123], v[172:175]
  buffer_load_dwordx4 v242, s[44:47], s41 offen offset:0 lds
  v_exp_f32 v101, v101
  v_mfma_f32_16x16x32_bf16 v[140:143], a[212:215], a[100:103], v[140:143]
  s_mov_b32 s41, 1966080
  s_add_u32 m0, s42, 69632
  v_exp_f32 v102, v102
  v_mfma_f32_16x16x32_bf16 v[140:143], a[216:219], a[116:119], v[140:143]
  v_exp_f32 v103, v103
  v_add_f32 v96, 1.0, v96
  v_mfma_f32_16x16x32_bf16 v[108:111], a[212:215], a[96:99], v[108:111]
  ds_read_b64_tr_b16 a[212:213], v230 offset:20480
  ds_read_b64_tr_b16 a[214:215], v230 offset:22528
  v_add_f32 v97, 1.0, v97
  v_add_f32 v98, 1.0, v98
  v_mfma_f32_16x16x32_bf16 v[108:111], a[216:219], a[112:115], v[108:111]
  ds_read_b64_tr_b16 a[216:217], v239 offset:8192
  ds_read_b64_tr_b16 a[218:219], v239 offset:10240
  v_add_f32 v99, 1.0, v99
  v_mfma_f32_16x16x32_bf16 v[120:123], a[220:223], a[96:99], v[120:123]
  buffer_load_dwordx4 v253, s[44:47], s41 offen offset:0 lds
  v_add_f32 v100, 1.0, v100
  v_add_f32 v101, 1.0, v101
  v_mfma_f32_16x16x32_bf16 v[120:123], a[224:227], a[112:115], v[120:123]
  v_add_f32 v102, 1.0, v102
  v_add_f32 v103, 1.0, v103
  v_mfma_f32_16x16x32_bf16 v[152:155], a[220:223], a[100:103], v[152:155]
  v_rcp_f32 v96, v96
  v_mfma_f32_16x16x32_bf16 v[152:155], a[224:227], a[116:119], v[152:155]
  v_rcp_f32 v97, v97
  v_mfma_f32_16x16x32_bf16 v[184:187], a[220:223], a[104:107], v[184:187]
  v_rcp_f32 v98, v98
  v_mfma_f32_16x16x32_bf16 v[184:187], a[224:227], a[120:123], v[184:187]
  v_rcp_f32 v99, v99
  v_mfma_f32_16x16x32_bf16 v[216:219], a[220:223], a[108:111], v[216:219]
  ds_read_b64_tr_b16 a[220:221], v231 offset:20480
  ds_read_b64_tr_b16 a[222:223], v231 offset:22528
  v_mfma_f32_16x16x32_bf16 v[216:219], a[224:227], a[124:127], v[216:219]
  ds_read_b64_tr_b16 a[224:225], v238 offset:12288
  ds_read_b64_tr_b16 a[226:227], v238 offset:14336
  s_waitcnt lgkmcnt(13)
  v_mfma_f32_16x16x32_bf16 v[220:223], a[228:231], a[108:111], v[220:223]
  v_rcp_f32 v100, v100
  v_mfma_f32_16x16x32_bf16 v[220:223], a[232:235], a[124:127], v[220:223]
  v_rcp_f32 v101, v101
  v_mfma_f32_16x16x32_bf16 v[188:191], a[228:231], a[104:107], v[188:191]
  s_waitcnt vmcnt(2)
  v_add_u32 v248, 1, v245
  buffer_store_dword v248, v246, s[4:7], s90 offen sc1
  v_rcp_f32 v102, v102
  v_mfma_f32_16x16x32_bf16 v[188:191], a[232:235], a[120:123], v[188:191]
  v_rcp_f32 v103, v103
  v_mul_f32 v96, v96, v112
  v_mfma_f32_16x16x32_bf16 v[156:159], a[228:231], a[100:103], v[156:159]
  v_mul_f32 v97, v97, v113
  v_mul_f32 v98, v98, v114
  v_mfma_f32_16x16x32_bf16 v[156:159], a[232:235], a[116:119], v[156:159]
  v_mul_f32 v99, v99, v115
  v_mul_f32 v100, v100, v116
  v_mfma_f32_16x16x32_bf16 v[124:127], a[228:231], a[96:99], v[124:127]
  ds_read_b64_tr_b16 a[228:229], v238 offset:24576
  ds_read_b64_tr_b16 a[230:231], v238 offset:26624
  v_mul_f32 v101, v101, v117
  v_mul_f32 v102, v102, v118
  v_mfma_f32_16x16x32_bf16 v[124:127], a[232:235], a[112:115], v[124:127]
  ds_read_b64_tr_b16 a[232:233], v239 offset:12288
  ds_read_b64_tr_b16 a[234:235], v239 offset:14336
  v_mul_f32 v103, v103, v119
  v_mfma_f32_16x16x32_bf16 v[104:107], a[192:195], a[128:131], v[104:107]
  v_cvt_pk_bf16_f32 v96, v96, v97
  v_cvt_pk_bf16_f32 v97, v98, v99
  v_mfma_f32_16x16x32_bf16 v[104:107], a[196:199], a[144:147], v[104:107]
  v_cvt_pk_bf16_f32 v98, v100, v101
  v_cvt_pk_bf16_f32 v99, v102, v103
  v_mfma_f32_16x16x32_bf16 v[136:139], a[192:195], a[132:135], v[136:139]
  buffer_store_dwordx4 v[96:99], v225, s[4:7], s20 offen offset:0 sc1
  v_mfma_f32_16x16x32_bf16 v[136:139], a[196:199], a[148:151], v[136:139]
  v_mul_f32 v128, s43, v128
  v_mul_f32 v129, s43, v129
  v_mfma_f32_16x16x32_bf16 v[168:171], a[192:195], a[136:139], v[168:171]
  v_mul_f32 v130, s43, v130
  v_mul_f32 v131, s43, v131
  v_mfma_f32_16x16x32_bf16 v[168:171], a[196:199], a[152:155], v[168:171]
  v_mul_f32 v132, s43, v132
  v_mul_f32 v133, s43, v133
  v_mfma_f32_16x16x32_bf16 v[200:203], a[192:195], a[140:143], v[200:203]
  ds_read_b64_tr_b16 a[192:193], v239 offset:24576
  ds_read_b64_tr_b16 a[194:195], v239 offset:26624
  v_mul_f32 v134, s43, v134
  v_mfma_f32_16x16x32_bf16 v[200:203], a[196:199], a[156:159], v[200:203]
  ds_read_b64_tr_b16 a[196:197], v230 offset:36864
  ds_read_b64_tr_b16 a[198:199], v230 offset:38912
  v_mul_f32 v135, s43, v135
  s_waitcnt lgkmcnt(13)
  v_mfma_f32_16x16x32_bf16 v[204:207], a[200:203], a[140:143], v[204:207]
  v_exp_f32 v128, v128
  v_mfma_f32_16x16x32_bf16 v[204:207], a[204:207], a[156:159], v[204:207]
  v_exp_f32 v129, v129
  v_mfma_f32_16x16x32_bf16 v[172:175], a[200:203], a[136:139], v[172:175]
  v_exp_f32 v130, v130
  v_mfma_f32_16x16x32_bf16 v[172:175], a[204:207], a[152:155], v[172:175]
  v_exp_f32 v131, v131
  v_mfma_f32_16x16x32_bf16 v[140:143], a[200:203], a[132:135], v[140:143]
  v_exp_f32 v132, v132
  v_mfma_f32_16x16x32_bf16 v[140:143], a[204:207], a[148:151], v[140:143]
  v_exp_f32 v133, v133
  v_mfma_f32_16x16x32_bf16 v[108:111], a[200:203], a[128:131], v[108:111]
  ds_read_b64_tr_b16 a[200:201], v230 offset:53248
  ds_read_b64_tr_b16 a[202:203], v230 offset:55296
  v_mfma_f32_16x16x32_bf16 v[108:111], a[204:207], a[144:147], v[108:111]
  ds_read_b64_tr_b16 a[204:205], v231 offset:36864
  ds_read_b64_tr_b16 a[206:207], v231 offset:38912
  v_mfma_f32_16x16x32_bf16 v[120:123], a[208:211], a[128:131], v[120:123]
  v_exp_f32 v134, v134
  v_mfma_f32_16x16x32_bf16 v[120:123], a[212:215], a[144:147], v[120:123]
  v_exp_f32 v135, v135
  v_add_f32 v128, 1.0, v128
  v_add_f32 v129, 1.0, v129
  v_mfma_f32_16x16x32_bf16 v[152:155], a[208:211], a[132:135], v[152:155]
  v_add_f32 v130, 1.0, v130
  v_add_f32 v131, 1.0, v131
  v_mfma_f32_16x16x32_bf16 v[152:155], a[212:215], a[148:151], v[152:155]
  v_add_f32 v132, 1.0, v132
  v_add_f32 v133, 1.0, v133
  v_mfma_f32_16x16x32_bf16 v[184:187], a[208:211], a[136:139], v[184:187]
  v_add_f32 v134, 1.0, v134
  v_add_f32 v135, 1.0, v135
  v_mfma_f32_16x16x32_bf16 v[184:187], a[212:215], a[152:155], v[184:187]
  v_rcp_f32 v128, v128
  v_mfma_f32_16x16x32_bf16 v[216:219], a[208:211], a[140:143], v[216:219]
  ds_read_b64_tr_b16 a[208:209], v231 offset:53248
  ds_read_b64_tr_b16 a[210:211], v231 offset:55296
  v_mfma_f32_16x16x32_bf16 v[216:219], a[212:215], a[156:159], v[216:219]
  ds_read_b64_tr_b16 a[212:213], v230 offset:49152
  ds_read_b64_tr_b16 a[214:215], v230 offset:51200
  s_waitcnt lgkmcnt(13)
  v_mfma_f32_16x16x32_bf16 v[220:223], a[216:219], a[140:143], v[220:223]
  v_rcp_f32 v129, v129
  v_mfma_f32_16x16x32_bf16 v[220:223], a[220:223], a[156:159], v[220:223]
  v_rcp_f32 v130, v130
  v_mfma_f32_16x16x32_bf16 v[188:191], a[216:219], a[136:139], v[188:191]
  v_rcp_f32 v131, v131
  v_mfma_f32_16x16x32_bf16 v[188:191], a[220:223], a[152:155], v[188:191]
  v_rcp_f32 v132, v132
  v_mfma_f32_16x16x32_bf16 v[156:159], a[216:219], a[132:135], v[156:159]
  v_rcp_f32 v133, v133
  v_mfma_f32_16x16x32_bf16 v[156:159], a[220:223], a[148:151], v[156:159]
  v_rcp_f32 v134, v134
  v_mfma_f32_16x16x32_bf16 v[124:127], a[216:219], a[128:131], v[124:127]
  ds_read_b64_tr_b16 a[216:217], v230 offset:61440
  ds_read_b64_tr_b16 a[218:219], v230 offset:63488
  v_rcp_f32 v135, v135
  v_mul_f32 v128, v128, v144
  v_mfma_f32_16x16x32_bf16 v[124:127], a[220:223], a[144:147], v[124:127]
  ds_read_b64_tr_b16 a[220:221], v231 offset:49152
  ds_read_b64_tr_b16 a[222:223], v231 offset:51200
  v_mul_f32 v129, v129, v145
  v_mfma_f32_16x16x32_bf16 v[104:107], a[224:227], a[160:163], v[104:107]
  v_mul_f32 v130, v130, v146
  v_mul_f32 v131, v131, v147
  v_mfma_f32_16x16x32_bf16 v[104:107], a[228:231], a[176:179], v[104:107]
  s_barrier
  v_mul_f32 v132, v132, v148
  v_mul_f32 v133, v133, v149
  v_mfma_f32_16x16x32_bf16 v[136:139], a[224:227], a[164:167], v[136:139]
  s_mov_b32 s41, 2228224
  s_add_u32 m0, s42, 81920
  v_mul_f32 v134, v134, v150
  v_mul_f32 v135, v135, v151
  v_mfma_f32_16x16x32_bf16 v[136:139], a[228:231], a[180:183], v[136:139]
  buffer_load_dwordx4 v253, s[44:47], s41 offen offset:0 lds
  v_cvt_pk_bf16_f32 v128, v128, v129
  v_mfma_f32_16x16x32_bf16 v[168:171], a[224:227], a[168:171], v[168:171]
  s_mov_b32 s41, 2293760
  s_add_u32 m0, s42, 90112
  v_cvt_pk_bf16_f32 v129, v130, v131
  v_cvt_pk_bf16_f32 v130, v132, v133
  v_mfma_f32_16x16x32_bf16 v[168:171], a[228:231], a[184:187], v[168:171]
  buffer_load_dword v244, v243, s[4:7], s91 offen sc1
  v_cvt_pk_bf16_f32 v131, v134, v135
  v_mfma_f32_16x16x32_bf16 v[200:203], a[224:227], a[172:175], v[200:203]
  ds_read_b64_tr_b16 a[224:225], v231 offset:61440
  ds_read_b64_tr_b16 a[226:227], v231 offset:63488
  buffer_store_dwordx4 v[128:131], v225, s[4:7], s20 offen offset:1024 sc1
  v_mul_f32 v160, s43, v160
  v_mfma_f32_16x16x32_bf16 v[200:203], a[228:231], a[188:191], v[200:203]
  ds_read_b64_tr_b16 a[228:229], v234 offset:12288
  ds_read_b64_tr_b16 a[230:231], v234 offset:14336
  v_mul_f32 v161, s43, v161
  s_waitcnt lgkmcnt(13)
  v_mfma_f32_16x16x32_bf16 v[204:207], a[232:235], a[172:175], v[204:207]
  buffer_load_dwordx4 v242, s[44:47], s41 offen offset:0 lds
  v_mul_f32 v162, s43, v162
  v_mul_f32 v163, s43, v163
  v_mfma_f32_16x16x32_bf16 v[204:207], a[192:195], a[188:191], v[204:207]
  s_mov_b32 s41, 2555904
  s_add_u32 m0, s42, 118784
  v_mul_f32 v164, s43, v164
  v_mul_f32 v165, s43, v165
  v_mfma_f32_16x16x32_bf16 v[172:175], a[232:235], a[168:171], v[172:175]
  v_mul_f32 v166, s43, v166
  v_mul_f32 v167, s43, v167
  v_mfma_f32_16x16x32_bf16 v[172:175], a[192:195], a[184:187], v[172:175]
  v_exp_f32 v160, v160
  v_mfma_f32_16x16x32_bf16 v[140:143], a[232:235], a[164:167], v[140:143]
  v_exp_f32 v161, v161
  v_mfma_f32_16x16x32_bf16 v[140:143], a[192:195], a[180:183], v[140:143]
  buffer_load_dwordx4 v242, s[44:47], s41 offen offset:0 lds
  v_mfma_f32_16x16x32_bf16 v[108:111], a[232:235], a[160:163], v[108:111]
  ds_read_b64_tr_b16 a[232:233], v234 offset:8192
  ds_read_b64_tr_b16 a[234:235], v234 offset:10240
  v_exp_f32 v162, v162
  v_mfma_f32_16x16x32_bf16 v[108:111], a[192:195], a[176:179], v[108:111]
  ds_read_b64_tr_b16 a[192:193], v235 offset:12288
  ds_read_b64_tr_b16 a[194:195], v235 offset:14336
  v_mfma_f32_16x16x32_bf16 v[120:123], a[196:199], a[160:163], v[120:123]
  s_mov_b32 s41, 2293760
  s_add_u32 m0, s42, 131072
  v_exp_f32 v163, v163
  v_mfma_f32_16x16x32_bf16 v[120:123], a[200:203], a[176:179], v[120:123]
  v_exp_f32 v164, v164
  v_mfma_f32_16x16x32_bf16 v[152:155], a[196:199], a[164:167], v[152:155]
  v_exp_f32 v165, v165
  v_mfma_f32_16x16x32_bf16 v[152:155], a[200:203], a[180:183], v[152:155]
  buffer_load_dwordx4 v253, s[44:47], s41 offen offset:0 lds
  v_exp_f32 v166, v166
  v_mfma_f32_16x16x32_bf16 v[184:187], a[196:199], a[168:171], v[184:187]
  s_mov_b32 s41, 2555904
  s_add_u32 m0, s42, 139264
  v_exp_f32 v167, v167
  v_add_f32 v160, 1.0, v160
  v_mfma_f32_16x16x32_bf16 v[184:187], a[200:203], a[184:187], v[184:187]
  v_add_f32 v161, 1.0, v161
  v_add_f32 v162, 1.0, v162
  v_mfma_f32_16x16x32_bf16 v[216:219], a[196:199], a[172:175], v[216:219]
  ds_read_b64_tr_b16 a[196:197], v235 offset:8192
  ds_read_b64_tr_b16 a[198:199], v235 offset:10240
  v_add_f32 v163, 1.0, v163
  v_add_f32 v164, 1.0, v164
  v_mfma_f32_16x16x32_bf16 v[216:219], a[200:203], a[188:191], v[216:219]
  ds_read_b64_tr_b16 a[200:201], v234 offset:20480
  ds_read_b64_tr_b16 a[202:203], v234 offset:22528
  v_add_f32 v165, 1.0, v165
  s_waitcnt lgkmcnt(13)
  v_mfma_f32_16x16x32_bf16 v[220:223], a[204:207], a[172:175], v[220:223]
  buffer_load_dwordx4 v253, s[44:47], s41 offen offset:0 lds
  v_add_f32 v166, 1.0, v166
  v_add_f32 v167, 1.0, v167
  v_mfma_f32_16x16x32_bf16 v[220:223], a[208:211], a[188:191], v[220:223]
  s_mov_b32 s41, 2883584
  s_add_u32 m0, s42, 20480
  v_mfma_f32_16x16x32_bf16 v[188:191], a[204:207], a[168:171], v[188:191]
  v_rcp_f32 v160, v160
  v_mfma_f32_16x16x32_bf16 v[188:191], a[208:211], a[184:187], v[188:191]
  v_rcp_f32 v161, v161
  v_mfma_f32_16x16x32_bf16 v[156:159], a[204:207], a[164:167], v[156:159]
  v_rcp_f32 v162, v162
  v_mfma_f32_16x16x32_bf16 v[156:159], a[208:211], a[180:183], v[156:159]
  v_rcp_f32 v163, v163
  v_mfma_f32_16x16x32_bf16 v[124:127], a[204:207], a[160:163], v[124:127]
  buffer_load_dwordx4 v242, s[44:47], s41 offen offset:0 lds
  v_rcp_f32 v164, v164
  v_mfma_f32_16x16x32_bf16 v[124:127], a[208:211], a[176:179], v[124:127]
  ds_read_b64_tr_b16 a[204:205], v234 offset:36864
  ds_read_b64_tr_b16 a[206:207], v234 offset:38912
  v_mfma_f32_16x16x32_bf16 v[104:107], a[212:215], a[0:3], v[104:107]
  ds_read_b64_tr_b16 a[208:209], v235 offset:20480
  ds_read_b64_tr_b16 a[210:211], v235 offset:22528
  v_rcp_f32 v165, v165
  v_mfma_f32_16x16x32_bf16 v[104:107], a[216:219], a[16:19], v[104:107]
  v_rcp_f32 v166, v166
  v_mfma_f32_16x16x32_bf16 v[136:139], a[212:215], a[4:7], v[136:139]
  v_rcp_f32 v167, v167
  v_mul_f32 v160, v160, v176
  v_mul_f32 v161, v161, v177
  v_mfma_f32_16x16x32_bf16 v[136:139], a[216:219], a[20:23], v[136:139]
  v_mul_f32 v162, v162, v178
  v_mul_f32 v163, v163, v179
  v_mfma_f32_16x16x32_bf16 v[168:171], a[212:215], a[8:11], v[168:171]
  v_mul_f32 v164, v164, v180
  v_mul_f32 v165, v165, v181
  v_mfma_f32_16x16x32_bf16 v[168:171], a[216:219], a[24:27], v[168:171]
  v_mul_f32 v166, v166, v182
  v_mul_f32 v167, v167, v183
  v_mfma_f32_16x16x32_bf16 v[200:203], a[212:215], a[12:15], v[200:203]
  ds_read_b64_tr_b16 a[212:213], v235 offset:36864
  ds_read_b64_tr_b16 a[214:215], v235 offset:38912
  v_cvt_pk_bf16_f32 v160, v160, v161
  v_mfma_f32_16x16x32_bf16 v[200:203], a[216:219], a[28:31], v[200:203]
  ds_read_b64_tr_b16 a[216:217], v234 offset:32768
  ds_read_b64_tr_b16 a[218:219], v234 offset:34816
  v_cvt_pk_bf16_f32 v161, v162, v163
  s_waitcnt lgkmcnt(13)
  v_mfma_f32_16x16x32_bf16 v[204:207], a[220:223], a[12:15], v[204:207]
  v_cvt_pk_bf16_f32 v162, v164, v165
  v_cvt_pk_bf16_f32 v163, v166, v167
  v_mfma_f32_16x16x32_bf16 v[204:207], a[224:227], a[28:31], v[204:207]
  buffer_store_dwordx4 v[160:163], v225, s[4:7], s20 offen offset:2048 sc1
  v_mfma_f32_16x16x32_bf16 v[172:175], a[220:223], a[8:11], v[172:175]
  v_mul_f32 v192, s43, v192
  v_mul_f32 v193, s43, v193
  v_mfma_f32_16x16x32_bf16 v[172:175], a[224:227], a[24:27], v[172:175]
  v_mul_f32 v194, s43, v194
  v_mul_f32 v195, s43, v195
  v_mfma_f32_16x16x32_bf16 v[140:143], a[220:223], a[4:7], v[140:143]
  v_mul_f32 v196, s43, v196
  v_mul_f32 v197, s43, v197
  v_mfma_f32_16x16x32_bf16 v[140:143], a[224:227], a[20:23], v[140:143]
  s_waitcnt vmcnt(7)
  v_subrev_u32 v244, s100, v244
  v_cmp_lt_u32 s[68:69], 7, v244
  v_mul_f32 v198, s43, v198
  v_mfma_f32_16x16x32_bf16 v[108:111], a[220:223], a[0:3], v[108:111]
  ds_read_b64_tr_b16 a[220:221], v234 offset:45056
  ds_read_b64_tr_b16 a[222:223], v234 offset:47104
  s_cmp_lg_u64 s[68:69], 0
  s_cbranch_scc1 L_slow_44
L_back_45:
  v_mul_f32 v199, s43, v199
  v_mfma_f32_16x16x32_bf16 v[108:111], a[224:227], a[16:19], v[108:111]
  ds_read_b64_tr_b16 a[224:225], v235 offset:32768
  ds_read_b64_tr_b16 a[226:227], v235 offset:34816
  v_mfma_f32_16x16x32_bf16 v[120:123], a[228:231], a[0:3], v[120:123]
  s_mov_b32 s40, 17825792
  v_exp_f32 v192, v192
  v_mfma_f32_16x16x32_bf16 v[120:123], a[232:235], a[16:19], v[120:123]
  buffer_load_dwordx4 a[64:67], v252, s[4:7], s40 offen offset:0 sc1
  v_exp_f32 v193, v193
  v_mfma_f32_16x16x32_bf16 v[152:155], a[228:231], a[4:7], v[152:155]
  v_exp_f32 v194, v194
  v_mfma_f32_16x16x32_bf16 v[152:155], a[232:235], a[20:23], v[152:155]
  buffer_load_dwordx4 a[68:71], v252, s[4:7], s40 offen offset:1024 sc1
  v_exp_f32 v195, v195
  v_mfma_f32_16x16x32_bf16 v[184:187], a[228:231], a[8:11], v[184:187]
  s_mov_b32 s40, 17956864
  v_exp_f32 v196, v196
  v_mfma_f32_16x16x32_bf16 v[184:187], a[232:235], a[24:27], v[184:187]
  buffer_load_dwordx4 a[72:75], v252, s[4:7], s40 offen offset:0 sc1
  v_exp_f32 v197, v197
  v_mfma_f32_16x16x32_bf16 v[216:219], a[228:231], a[12:15], v[216:219]
  ds_read_b64_tr_b16 a[228:229], v235 offset:45056
  ds_read_b64_tr_b16 a[230:231], v235 offset:47104
  v_exp_f32 v198, v198
  v_mfma_f32_16x16x32_bf16 v[216:219], a[232:235], a[28:31], v[216:219]
  buffer_load_dwordx4 a[76:79], v252, s[4:7], s40 offen offset:1024 sc1
  s_waitcnt lgkmcnt(13)
  v_mfma_f32_16x16x32_bf16 v[220:223], a[192:195], a[12:15], v[220:223]
  ds_read_b64_tr_b16 a[232:233], v232 offset:61440
  ds_read_b64_tr_b16 a[234:235], v232 offset:63488
  v_exp_f32 v199, v199
  v_add_f32 v192, 1.0, v192
  v_add_f32 v193, 1.0, v193
  v_mfma_f32_16x16x32_bf16 v[220:223], a[196:199], a[28:31], v[220:223]
  s_barrier
  v_add_f32 v194, 1.0, v194
  v_add_f32 v195, 1.0, v195
  v_mfma_f32_16x16x32_bf16 v[188:191], a[192:195], a[8:11], v[188:191]
  s_mov_b32 s40, 18087936
  v_add_f32 v196, 1.0, v196
  v_add_f32 v197, 1.0, v197
  v_mfma_f32_16x16x32_bf16 v[188:191], a[196:199], a[24:27], v[188:191]
  v_add_f32 v198, 1.0, v198
  v_add_f32 v199, 1.0, v199
  v_mfma_f32_16x16x32_bf16 v[156:159], a[192:195], a[4:7], v[156:159]
  v_rcp_f32 v192, v192
  v_mfma_f32_16x16x32_bf16 v[156:159], a[196:199], a[20:23], v[156:159]
  v_rcp_f32 v193, v193
  v_mfma_f32_16x16x32_bf16 v[124:127], a[192:195], a[0:3], v[124:127]
  buffer_load_dwordx4 a[80:83], v252, s[4:7], s40 offen offset:0 sc1
  v_mfma_f32_16x16x32_bf16 v[124:127], a[196:199], a[16:19], v[124:127]
  ds_read_b64_tr_b16 a[192:193], v232 offset:57344
  ds_read_b64_tr_b16 a[194:195], v232 offset:59392
  v_mfma_f32_16x16x32_bf16 v[104:107], a[200:203], a[32:35], v[104:107]
  ds_read_b64_tr_b16 a[196:197], v233 offset:61440
  ds_read_b64_tr_b16 a[198:199], v233 offset:63488
  v_rcp_f32 v194, v194
  s_waitcnt lgkmcnt(13)
  v_mfma_f32_16x16x32_bf16 v[104:107], a[204:207], a[48:51], v[104:107]
  v_rcp_f32 v195, v195
  v_mfma_f32_16x16x32_bf16 v[136:139], a[200:203], a[36:39], v[136:139]
  v_rcp_f32 v196, v196
  v_mfma_f32_16x16x32_bf16 v[136:139], a[204:207], a[52:55], v[136:139]
  buffer_load_dwordx4 a[84:87], v252, s[4:7], s40 offen offset:1024 sc1
  v_rcp_f32 v197, v197
  v_mfma_f32_16x16x32_bf16 v[168:171], a[200:203], a[40:43], v[168:171]
  s_mov_b32 s40, 18219008
  v_rcp_f32 v198, v198
  v_mfma_f32_16x16x32_bf16 v[168:171], a[204:207], a[56:59], v[168:171]
  buffer_load_dwordx4 a[88:91], v252, s[4:7], s40 offen offset:0 sc1
  v_rcp_f32 v199, v199
  v_mul_f32 v192, v192, v208
  v_mfma_f32_16x16x32_bf16 v[200:203], a[200:203], a[44:47], v[200:203]
  ds_read_b64_tr_b16 a[200:201], v233 offset:57344
  ds_read_b64_tr_b16 a[202:203], v233 offset:59392
  v_mul_f32 v193, v193, v209
  v_mul_f32 v194, v194, v210
  v_mfma_f32_16x16x32_bf16 v[200:203], a[204:207], a[60:63], v[200:203]
  buffer_load_dwordx4 a[92:95], v252, s[4:7], s40 offen offset:1024 sc1
  v_mul_f32 v195, v195, v211
  v_mfma_f32_16x16x32_bf16 v[204:207], a[208:211], a[44:47], v[204:207]
  ds_read_b64_tr_b16 a[204:205], v234 offset:61440
  ds_read_b64_tr_b16 a[206:207], v234 offset:63488
  v_mul_f32 v196, v196, v212
  v_mul_f32 v197, v197, v213
  v_mfma_f32_16x16x32_bf16 v[204:207], a[212:215], a[60:63], v[204:207]
  s_mov_b32 s40, 18350080
  v_mul_f32 v198, v198, v214
  v_mul_f32 v199, v199, v215
  v_mfma_f32_16x16x32_bf16 v[172:175], a[208:211], a[40:43], v[172:175]
  v_cvt_pk_bf16_f32 v192, v192, v193
  v_cvt_pk_bf16_f32 v193, v194, v195
  v_mfma_f32_16x16x32_bf16 v[172:175], a[212:215], a[56:59], v[172:175]
  v_cvt_pk_bf16_f32 v194, v196, v197
  v_cvt_pk_bf16_f32 v195, v198, v199
  v_mfma_f32_16x16x32_bf16 v[140:143], a[208:211], a[36:39], v[140:143]
  buffer_store_dwordx4 v[192:195], v225, s[4:7], s20 offen offset:3072 sc1
  v_mfma_f32_16x16x32_bf16 v[140:143], a[212:215], a[52:55], v[140:143]
  v_mfma_f32_16x16x32_bf16 v[108:111], a[208:211], a[32:35], v[108:111]
  buffer_load_dwordx4 a[96:99], v252, s[4:7], s40 offen offset:0 sc1
  v_mfma_f32_16x16x32_bf16 v[108:111], a[212:215], a[48:51], v[108:111]
  ds_read_b64_tr_b16 a[208:209], v234 offset:57344
  ds_read_b64_tr_b16 a[210:211], v234 offset:59392
  s_waitcnt lgkmcnt(13)
  v_mfma_f32_16x16x32_bf16 v[120:123], a[216:219], a[32:35], v[120:123]
  ds_read_b64_tr_b16 a[212:213], v235 offset:61440
  ds_read_b64_tr_b16 a[214:215], v235 offset:63488
  v_mfma_f32_16x16x32_bf16 v[120:123], a[220:223], a[48:51], v[120:123]
  v_mfma_f32_16x16x32_bf16 v[152:155], a[216:219], a[36:39], v[152:155]
  v_mfma_f32_16x16x32_bf16 v[152:155], a[220:223], a[52:55], v[152:155]
  buffer_load_dwordx4 a[100:103], v252, s[4:7], s40 offen offset:1024 sc1
  v_mfma_f32_16x16x32_bf16 v[184:187], a[216:219], a[40:43], v[184:187]
  s_mov_b32 s40, 18481152
  v_mfma_f32_16x16x32_bf16 v[184:187], a[220:223], a[56:59], v[184:187]
  v_mfma_f32_16x16x32_bf16 v[216:219], a[216:219], a[44:47], v[216:219]
  ds_read_b64_tr_b16 a[216:217], v235 offset:57344
  ds_read_b64_tr_b16 a[218:219], v235 offset:59392
  v_mfma_f32_16x16x32_bf16 v[216:219], a[220:223], a[60:63], v[216:219]
  ds_read_b64_tr_b16 a[220:221], v236 offset:4096
  ds_read_b64_tr_b16 a[222:223], v236 offset:6144
  v_mfma_f32_16x16x32_bf16 v[220:223], a[224:227], a[44:47], v[220:223]
  s_waitcnt lgkmcnt(13)
  v_mfma_f32_16x16x32_bf16 v[220:223], a[228:231], a[60:63], v[220:223]
  buffer_load_dwordx4 a[104:107], v252, s[4:7], s40 offen offset:0 sc1
  v_mfma_f32_16x16x32_bf16 v[188:191], a[224:227], a[40:43], v[188:191]
  v_mfma_f32_16x16x32_bf16 v[188:191], a[228:231], a[56:59], v[188:191]
  v_mfma_f32_16x16x32_bf16 v[156:159], a[224:227], a[36:39], v[156:159]
  v_mfma_f32_16x16x32_bf16 v[156:159], a[228:231], a[52:55], v[156:159]
  v_mfma_f32_16x16x32_bf16 v[124:127], a[224:227], a[32:35], v[124:127]
  buffer_load_dwordx4 a[108:111], v252, s[4:7], s40 offen offset:1024 sc1
  v_mfma_f32_16x16x32_bf16 v[124:127], a[228:231], a[48:51], v[124:127]
  ds_read_b64_tr_b16 a[224:225], v236 offset:20480
  ds_read_b64_tr_b16 a[226:227], v236 offset:22528
  s_waitcnt vmcnt(9)
  v_mfma_f32_16x16x32_bf16 v[32:35], a[232:235], a[64:67], 0
  ds_read_b64_tr_b16 a[228:229], v237 offset:4096
  ds_read_b64_tr_b16 a[230:231], v237 offset:6144
  v_mul_f32 v104, s43, v104
  v_mfma_f32_16x16x32_bf16 v[32:35], a[192:195], a[72:75], v[32:35]
  s_barrier
  v_mfma_f32_16x16x32_bf16 v[48:51], a[232:235], a[68:71], 0
  ds_read_b64_tr_b16 a[232:233], v237 offset:20480
  ds_read_b64_tr_b16 a[234:235], v237 offset:22528
  v_mul_f32 v105, s43, v105
  v_mfma_f32_16x16x32_bf16 v[48:51], a[192:195], a[76:79], v[48:51]
  ds_read_b64_tr_b16 a[192:193], v238 offset:4096
  ds_read_b64_tr_b16 a[194:195], v238 offset:6144
  v_mul_f32 v106, s43, v106
  s_waitcnt lgkmcnt(13)
  v_mfma_f32_16x16x32_bf16 v[52:55], a[196:199], a[68:71], 0
  s_mov_b32 s40, 18612224
  v_mul_f32 v107, s43, v107
  v_mfma_f32_16x16x32_bf16 v[52:55], a[200:203], a[76:79], v[52:55]
  buffer_load_dwordx4 a[112:115], v252, s[4:7], s40 offen offset:0 sc1
  v_mfma_f32_16x16x32_bf16 v[36:39], a[196:199], a[64:67], 0
  ds_read_b64_tr_b16 a[196:197], v238 offset:20480
  ds_read_b64_tr_b16 a[198:199], v238 offset:22528
  v_mul_f32 v108, s43, v108
  v_mfma_f32_16x16x32_bf16 v[36:39], a[200:203], a[72:75], v[36:39]
  ds_read_b64_tr_b16 a[200:201], v239 offset:4096
  ds_read_b64_tr_b16 a[202:203], v239 offset:6144
  v_mul_f32 v109, s43, v109
  v_mfma_f32_16x16x32_bf16 v[40:43], a[204:207], a[64:67], 0
  buffer_load_dwordx4 a[116:119], v252, s[4:7], s40 offen offset:1024 sc1
  v_mul_f32 v110, s43, v110
  v_mfma_f32_16x16x32_bf16 v[40:43], a[208:211], a[72:75], v[40:43]
  s_mov_b32 s40, 18743296
  v_mul_f32 v111, s43, v111
  v_mfma_f32_16x16x32_bf16 v[56:59], a[204:207], a[68:71], 0
  ds_read_b64_tr_b16 a[204:205], v239 offset:20480
  ds_read_b64_tr_b16 a[206:207], v239 offset:22528
  v_mfma_f32_16x16x32_bf16 v[56:59], a[208:211], a[76:79], v[56:59]
  ds_read_b64_tr_b16 a[208:209], v236 offset:16384
  ds_read_b64_tr_b16 a[210:211], v236 offset:18432
L_wk2_0:
  s_cbranch_vccnz L_wk2_4
  s_waitcnt lgkmcnt(13)
  v_mfma_f32_16x16x32_bf16 v[60:63], a[212:215], a[68:71], 0
  buffer_load_dwordx4 a[120:123], v252, s[4:7], s40 offen offset:0 sc1
  v_mfma_f32_16x16x32_bf16 v[60:63], a[216:219], a[76:79], v[60:63]
  v_exp_f32 v104, v104
  v_mfma_f32_16x16x32_bf16 v[44:47], a[212:215], a[64:67], 0
  ds_read_b64_tr_b16 a[212:213], v236 offset:28672
  ds_read_b64_tr_b16 a[214:215], v236 offset:30720
  v_mfma_f32_16x16x32_bf16 v[44:47], a[216:219], a[72:75], v[44:47]
  ds_read_b64_tr_b16 a[216:217], v237 offset:16384
  ds_read_b64_tr_b16 a[218:219], v237 offset:18432
  v_mfma_f32_16x16x32_bf16 v[0:3], a[220:223], a[64:67], 0
  buffer_load_dwordx4 a[124:127], v252, s[4:7], s40 offen offset:1024 sc1
  v_exp_f32 v105, v105
  v_mfma_f32_16x16x32_bf16 v[0:3], a[224:227], a[72:75], v[0:3]
  s_mov_b32 s40, 18874368
  v_mfma_f32_16x16x32_bf16 v[16:19], a[220:223], a[68:71], 0
  ds_read_b64_tr_b16 a[220:221], v237 offset:28672
  ds_read_b64_tr_b16 a[222:223], v237 offset:30720
  v_mfma_f32_16x16x32_bf16 v[16:19], a[224:227], a[76:79], v[16:19]
  ds_read_b64_tr_b16 a[224:225], v238 offset:16384
  ds_read_b64_tr_b16 a[226:227], v238 offset:18432
  v_exp_f32 v106, v106
  s_waitcnt lgkmcnt(13)
  v_mfma_f32_16x16x32_bf16 v[20:23], a[228:231], a[68:71], 0
  buffer_load_dwordx4 a[128:131], v252, s[4:7], s40 offen offset:0 sc1
  v_mfma_f32_16x16x32_bf16 v[20:23], a[232:235], a[76:79], v[20:23]
  v_exp_f32 v107, v107
  v_mfma_f32_16x16x32_bf16 v[4:7], a[228:231], a[64:67], 0
  ds_read_b64_tr_b16 a[228:229], v238 offset:28672
  ds_read_b64_tr_b16 a[230:231], v238 offset:30720
  v_mfma_f32_16x16x32_bf16 v[4:7], a[232:235], a[72:75], v[4:7]
  ds_read_b64_tr_b16 a[232:233], v239 offset:16384
  ds_read_b64_tr_b16 a[234:235], v239 offset:18432
  v_mfma_f32_16x16x32_bf16 v[8:11], a[192:195], a[64:67], 0
  buffer_load_dwordx4 a[132:135], v252, s[4:7], s40 offen offset:1024 sc1
  v_exp_f32 v108, v108
  v_mfma_f32_16x16x32_bf16 v[8:11], a[196:199], a[72:75], v[8:11]
  s_mov_b32 s40, 19005440
  v_mfma_f32_16x16x32_bf16 v[24:27], a[192:195], a[68:71], 0
  ds_read_b64_tr_b16 a[192:193], v239 offset:28672
  ds_read_b64_tr_b16 a[194:195], v239 offset:30720
  v_mfma_f32_16x16x32_bf16 v[24:27], a[196:199], a[76:79], v[24:27]
  buffer_load_dwordx4 a[136:139], v252, s[4:7], s40 offen offset:0 sc1
  v_exp_f32 v109, v109
  s_waitcnt lgkmcnt(13)
  v_mfma_f32_16x16x32_bf16 v[28:31], a[200:203], a[68:71], 0
  ds_read_b64_tr_b16 a[196:197], v228 offset:16384
  ds_read_b64_tr_b16 a[198:199], v228 offset:18432
  v_mfma_f32_16x16x32_bf16 v[28:31], a[204:207], a[76:79], v[28:31]
  v_exp_f32 v110, v110
  v_mfma_f32_16x16x32_bf16 v[12:15], a[200:203], a[64:67], 0
  ds_read_b64_tr_b16 a[200:201], v228 offset:12288
  ds_read_b64_tr_b16 a[202:203], v228 offset:14336
  v_mfma_f32_16x16x32_bf16 v[12:15], a[204:207], a[72:75], v[12:15]
  buffer_load_dwordx4 a[140:143], v252, s[4:7], s40 offen offset:1024 sc1
  s_waitcnt vmcnt(13)
  v_mfma_f32_16x16x32_bf16 v[32:35], a[208:211], a[80:83], v[32:35]
  ds_read_b64_tr_b16 a[204:205], v229 offset:16384
  ds_read_b64_tr_b16 a[206:207], v229 offset:18432
  v_exp_f32 v111, v111
  v_add_f32 v104, 1.0, v104
  s_waitcnt lgkmcnt(13)
  v_mfma_f32_16x16x32_bf16 v[32:35], a[212:215], a[88:91], v[32:35]
  s_barrier
  v_mfma_f32_16x16x32_bf16 v[48:51], a[208:211], a[84:87], v[48:51]
  ds_read_b64_tr_b16 a[208:209], v229 offset:12288
  ds_read_b64_tr_b16 a[210:211], v229 offset:14336
  v_add_f32 v105, 1.0, v105
  v_mfma_f32_16x16x32_bf16 v[48:51], a[212:215], a[92:95], v[48:51]
  ds_read_b64_tr_b16 a[212:213], v230 offset:16384
  ds_read_b64_tr_b16 a[214:215], v230 offset:18432
  v_add_f32 v106, 1.0, v106
  v_mfma_f32_16x16x32_bf16 v[52:55], a[216:219], a[84:87], v[52:55]
  s_mov_b32 s40, 19136512
  v_add_f32 v107, 1.0, v107
  v_mfma_f32_16x16x32_bf16 v[52:55], a[220:223], a[92:95], v[52:55]
  buffer_load_dwordx4 a[144:147], v252, s[4:7], s40 offen offset:0 sc1
  v_mfma_f32_16x16x32_bf16 v[36:39], a[216:219], a[80:83], v[36:39]
  ds_read_b64_tr_b16 a[216:217], v230 offset:12288
  ds_read_b64_tr_b16 a[218:219], v230 offset:14336
  v_add_f32 v108, 1.0, v108
  v_mfma_f32_16x16x32_bf16 v[36:39], a[220:223], a[88:91], v[36:39]
  ds_read_b64_tr_b16 a[220:221], v231 offset:16384
  ds_read_b64_tr_b16 a[222:223], v231 offset:18432
  v_add_f32 v109, 1.0, v109
  s_waitcnt lgkmcnt(13)
  v_mfma_f32_16x16x32_bf16 v[40:43], a[224:227], a[80:83], v[40:43]
  buffer_load_dwordx4 a[148:151], v252, s[4:7], s40 offen offset:1024 sc1
  v_add_f32 v110, 1.0, v110
  v_mfma_f32_16x16x32_bf16 v[40:43], a[228:231], a[88:91], v[40:43]
  s_mov_b32 s40, 19267584
  s_waitcnt vmcnt(14)
  v_add_u32 v248, 2, v245
  buffer_store_dword v248, v246, s[4:7], s90 offen sc1
  v_mfma_f32_16x16x32_bf16 v[56:59], a[224:227], a[84:87], v[56:59]
  ds_read_b64_tr_b16 a[224:225], v231 offset:12288
  ds_read_b64_tr_b16 a[226:227], v231 offset:14336
  v_add_f32 v111, 1.0, v111
  v_mfma_f32_16x16x32_bf16 v[56:59], a[228:231], a[92:95], v[56:59]
  ds_read_b64_tr_b16 a[228:229], v228 offset:24576
  ds_read_b64_tr_b16 a[230:231], v228 offset:26624
  v_mfma_f32_16x16x32_bf16 v[60:63], a[232:235], a[84:87], v[60:63]
  buffer_load_dwordx4 a[152:155], v252, s[4:7], s40 offen offset:0 sc1
  v_mfma_f32_16x16x32_bf16 v[60:63], a[192:195], a[92:95], v[60:63]
  v_rcp_f32 v104, v104
  v_mfma_f32_16x16x32_bf16 v[44:47], a[232:235], a[80:83], v[44:47]
  ds_read_b64_tr_b16 a[232:233], v228 offset:45056
  ds_read_b64_tr_b16 a[234:235], v228 offset:47104
  v_mfma_f32_16x16x32_bf16 v[44:47], a[192:195], a[88:91], v[44:47]
  ds_read_b64_tr_b16 a[192:193], v229 offset:24576
  ds_read_b64_tr_b16 a[194:195], v229 offset:26624
  s_waitcnt lgkmcnt(13)
  v_mfma_f32_16x16x32_bf16 v[0:3], a[196:199], a[80:83], v[0:3]
  buffer_load_dwordx4 a[156:159], v252, s[4:7], s40 offen offset:1024 sc1
  v_rcp_f32 v105, v105
  v_mfma_f32_16x16x32_bf16 v[0:3], a[200:203], a[88:91], v[0:3]
  s_mov_b32 s41, 3145728
  s_add_u32 m0, s42, 143360
  v_mfma_f32_16x16x32_bf16 v[16:19], a[196:199], a[84:87], v[16:19]
  ds_read_b64_tr_b16 a[196:197], v229 offset:45056
  ds_read_b64_tr_b16 a[198:199], v229 offset:47104
  v_mfma_f32_16x16x32_bf16 v[16:19], a[200:203], a[92:95], v[16:19]
  ds_read_b64_tr_b16 a[200:201], v230 offset:24576
  ds_read_b64_tr_b16 a[202:203], v230 offset:26624
  v_rcp_f32 v106, v106
  v_mfma_f32_16x16x32_bf16 v[20:23], a[204:207], a[84:87], v[20:23]
  buffer_load_dwordx4 v242, s[44:47], s41 offen offset:0 lds
  v_mfma_f32_16x16x32_bf16 v[20:23], a[208:211], a[92:95], v[20:23]
  s_mov_b32 s41, 2883584
  s_add_u32 m0, s42, 155648
  v_mfma_f32_16x16x32_bf16 v[4:7], a[204:207], a[80:83], v[4:7]
  ds_read_b64_tr_b16 a[204:205], v230 offset:45056
  ds_read_b64_tr_b16 a[206:207], v230 offset:47104
  v_rcp_f32 v107, v107
  v_mfma_f32_16x16x32_bf16 v[4:7], a[208:211], a[88:91], v[4:7]
  ds_read_b64_tr_b16 a[208:209], v231 offset:24576
  ds_read_b64_tr_b16 a[210:211], v231 offset:26624
  s_waitcnt lgkmcnt(13)
  v_mfma_f32_16x16x32_bf16 v[8:11], a[212:215], a[80:83], v[8:11]
  buffer_load_dwordx4 v253, s[44:47], s41 offen offset:0 lds
  v_rcp_f32 v108, v108
  v_mfma_f32_16x16x32_bf16 v[8:11], a[216:219], a[88:91], v[8:11]
  s_mov_b32 s41, 3145728
  s_add_u32 m0, s42, 36864
  v_mfma_f32_16x16x32_bf16 v[24:27], a[212:215], a[84:87], v[24:27]
  ds_read_b64_tr_b16 a[212:213], v231 offset:45056
  ds_read_b64_tr_b16 a[214:215], v231 offset:47104
  v_mfma_f32_16x16x32_bf16 v[24:27], a[216:219], a[92:95], v[24:27]
  buffer_load_dwordx4 v253, s[44:47], s41 offen offset:0 lds
  v_rcp_f32 v109, v109
  v_mfma_f32_16x16x32_bf16 v[28:31], a[220:223], a[84:87], v[28:31]
  ds_read_b64_tr_b16 a[216:217], v228 offset:57344
  ds_read_b64_tr_b16 a[218:219], v228 offset:59392
  v_mfma_f32_16x16x32_bf16 v[28:31], a[224:227], a[92:95], v[28:31]
  s_mov_b32 s40, 19398656
  v_rcp_f32 v110, v110
  v_mfma_f32_16x16x32_bf16 v[12:15], a[220:223], a[80:83], v[12:15]
  ds_read_b64_tr_b16 a[220:221], v232 offset:0
  ds_read_b64_tr_b16 a[222:223], v232 offset:2048
  v_mfma_f32_16x16x32_bf16 v[12:15], a[224:227], a[88:91], v[12:15]
  buffer_load_dwordx4 a[160:163], v252, s[4:7], s40 offen offset:0 sc1
  s_waitcnt vmcnt(17) lgkmcnt(13)
  v_mfma_f32_16x16x32_bf16 v[32:35], a[228:231], a[96:99], v[32:35]
  ds_read_b64_tr_b16 a[224:225], v229 offset:57344
  ds_read_b64_tr_b16 a[226:227], v229 offset:59392
  v_rcp_f32 v111, v111
  v_mul_f32 v104, v104, v120
  v_mfma_f32_16x16x32_bf16 v[32:35], a[232:235], a[104:107], v[32:35]
  s_barrier
  v_mfma_f32_16x16x32_bf16 v[48:51], a[228:231], a[100:103], v[48:51]
  ds_read_b64_tr_b16 a[228:229], v233 offset:0
  ds_read_b64_tr_b16 a[230:231], v233 offset:2048
  v_mul_f32 v105, v105, v121
  v_mfma_f32_16x16x32_bf16 v[48:51], a[232:235], a[108:111], v[48:51]
  buffer_load_dwordx4 a[164:167], v252, s[4:7], s40 offen offset:1024 sc1
  v_mul_f32 v106, v106, v122
  v_mfma_f32_16x16x32_bf16 v[52:55], a[192:195], a[100:103], v[52:55]
  ds_read_b64_tr_b16 a[232:233], v230 offset:57344
  ds_read_b64_tr_b16 a[234:235], v230 offset:59392
  v_mul_f32 v107, v107, v123
  s_waitcnt lgkmcnt(13)
  v_mfma_f32_16x16x32_bf16 v[52:55], a[196:199], a[108:111], v[52:55]
  s_mov_b32 s40, 19529728
  v_mul_f32 v108, v108, v124
  v_mfma_f32_16x16x32_bf16 v[36:39], a[192:195], a[96:99], v[36:39]
  ds_read_b64_tr_b16 a[192:193], v234 offset:0
  ds_read_b64_tr_b16 a[194:195], v234 offset:2048
  v_mfma_f32_16x16x32_bf16 v[36:39], a[196:199], a[104:107], v[36:39]
  buffer_load_dwordx4 a[168:171], v252, s[4:7], s40 offen offset:0 sc1
  v_mul_f32 v109, v109, v125
  v_mfma_f32_16x16x32_bf16 v[40:43], a[200:203], a[96:99], v[40:43]
  ds_read_b64_tr_b16 a[196:197], v231 offset:57344
  ds_read_b64_tr_b16 a[198:199], v231 offset:59392
  v_mul_f32 v110, v110, v126
  v_mfma_f32_16x16x32_bf16 v[40:43], a[204:207], a[104:107], v[40:43]
  v_mul_f32 v111, v111, v127
  v_cvt_pk_bf16_f32 v104, v104, v105
  v_mfma_f32_16x16x32_bf16 v[56:59], a[200:203], a[100:103], v[56:59]
  ds_read_b64_tr_b16 a[200:201], v235 offset:0
  ds_read_b64_tr_b16 a[202:203], v235 offset:2048
  v_mfma_f32_16x16x32_bf16 v[56:59], a[204:207], a[108:111], v[56:59]
  buffer_load_dwordx4 a[172:175], v252, s[4:7], s40 offen offset:1024 sc1
  s_waitcnt lgkmcnt(13)
  v_mfma_f32_16x16x32_bf16 v[60:63], a[208:211], a[100:103], v[60:63]
  ds_read_b64_tr_b16 a[204:205], v232 offset:28672
  ds_read_b64_tr_b16 a[206:207], v232 offset:30720
  v_cvt_pk_bf16_f32 v105, v106, v107
  v_mfma_f32_16x16x32_bf16 v[60:63], a[212:215], a[108:111], v[60:63]
  s_mov_b32 s41, 3211264
  s_add_u32 m0, s42, 53248
  v_mfma_f32_16x16x32_bf16 v[44:47], a[208:211], a[96:99], v[44:47]
  buffer_load_dwordx4 v242, s[44:47], s41 offen offset:0 lds
  v_cvt_pk_bf16_f32 v106, v108, v109
  v_mfma_f32_16x16x32_bf16 v[44:47], a[212:215], a[104:107], v[44:47]
  ds_read_b64_tr_b16 a[208:209], v232 offset:40960
  ds_read_b64_tr_b16 a[210:211], v232 offset:43008
  v_cvt_pk_bf16_f32 v107, v110, v111
  v_mfma_f32_16x16x32_bf16 v[0:3], a[216:219], a[96:99], v[0:3]
  ds_read_b64_tr_b16 a[212:213], v233 offset:28672
  ds_read_b64_tr_b16 a[214:215], v233 offset:30720
  s_waitcnt lgkmcnt(13)
  v_mfma_f32_16x16x32_bf16 v[0:3], a[220:223], a[104:107], v[0:3]
  s_mov_b32 s41, 3473408
  s_add_u32 m0, s42, 49152
  v_mfma_f32_16x16x32_bf16 v[16:19], a[216:219], a[100:103], v[16:19]
  buffer_load_dwordx4 v242, s[44:47], s41 offen offset:0 lds
  v_mfma_f32_16x16x32_bf16 v[16:19], a[220:223], a[108:111], v[16:19]
  ds_read_b64_tr_b16 a[216:217], v233 offset:40960
  ds_read_b64_tr_b16 a[218:219], v233 offset:43008
  buffer_store_dwordx4 v[104:107], v225, s[4:7], s21 offen offset:0 sc1
  v_mul_f32 v136, s43, v136
  v_mfma_f32_16x16x32_bf16 v[20:23], a[224:227], a[100:103], v[20:23]
  ds_read_b64_tr_b16 a[220:221], v234 offset:28672
  ds_read_b64_tr_b16 a[222:223], v234 offset:30720
  v_mul_f32 v137, s43, v137
  v_mfma_f32_16x16x32_bf16 v[20:23], a[228:231], a[108:111], v[20:23]
  s_mov_b32 s41, 3211264
  s_add_u32 m0, s42, 61440
  v_mfma_f32_16x16x32_bf16 v[4:7], a[224:227], a[96:99], v[4:7]
  buffer_load_dwordx4 v253, s[44:47], s41 offen offset:0 lds
  v_mul_f32 v138, s43, v138
  v_mfma_f32_16x16x32_bf16 v[4:7], a[228:231], a[104:107], v[4:7]
  ds_read_b64_tr_b16 a[224:225], v234 offset:40960
  ds_read_b64_tr_b16 a[226:227], v234 offset:43008
  v_mul_f32 v139, s43, v139
  s_waitcnt lgkmcnt(13)
  v_mfma_f32_16x16x32_bf16 v[8:11], a[232:235], a[96:99], v[8:11]
  ds_read_b64_tr_b16 a[228:229], v235 offset:28672
  ds_read_b64_tr_b16 a[230:231], v235 offset:30720
  v_mul_f32 v140, s43, v140
  v_mfma_f32_16x16x32_bf16 v[8:11], a[192:195], a[104:107], v[8:11]
  s_mov_b32 s41, 3473408
  s_add_u32 m0, s42, 77824
  v_mfma_f32_16x16x32_bf16 v[24:27], a[232:235], a[100:103], v[24:27]
  buffer_load_dwordx4 v253, s[44:47], s41 offen offset:0 lds
  v_mul_f32 v141, s43, v141
  v_mfma_f32_16x16x32_bf16 v[24:27], a[192:195], a[108:111], v[24:27]
  ds_read_b64_tr_b16 a[232:233], v235 offset:40960
  ds_read_b64_tr_b16 a[234:235], v235 offset:43008
  v_mul_f32 v142, s43, v142
  v_mfma_f32_16x16x32_bf16 v[28:31], a[196:199], a[100:103], v[28:31]
  ds_read_b64_tr_b16 a[192:193], v232 offset:49152
  ds_read_b64_tr_b16 a[194:195], v232 offset:51200
  v_mul_f32 v143, s43, v143
  s_waitcnt lgkmcnt(13)
  v_mfma_f32_16x16x32_bf16 v[28:31], a[200:203], a[108:111], v[28:31]
  s_mov_b32 s40, 19660800
  v_mfma_f32_16x16x32_bf16 v[12:15], a[196:199], a[96:99], v[12:15]
  buffer_load_dwordx4 a[176:179], v252, s[4:7], s40 offen offset:0 sc1
  v_mfma_f32_16x16x32_bf16 v[12:15], a[200:203], a[104:107], v[12:15]
  ds_read_b64_tr_b16 a[196:197], v228 offset:28672
  ds_read_b64_tr_b16 a[198:199], v228 offset:30720
  s_waitcnt vmcnt(22)
  v_mfma_f32_16x16x32_bf16 v[32:35], a[204:207], a[112:115], v[32:35]
  ds_read_b64_tr_b16 a[200:201], v233 offset:49152
  ds_read_b64_tr_b16 a[202:203], v233 offset:51200
  v_exp_f32 v136, v136
  v_mfma_f32_16x16x32_bf16 v[32:35], a[208:211], a[120:123], v[32:35]
  s_barrier
  v_mfma_f32_16x16x32_bf16 v[48:51], a[204:207], a[116:119], v[48:51]
  buffer_load_dwordx4 a[180:183], v252, s[4:7], s40 offen offset:1024 sc1
  v_mfma_f32_16x16x32_bf16 v[48:51], a[208:211], a[124:127], v[48:51]
  ds_read_b64_tr_b16 a[204:205], v229 offset:28672
  ds_read_b64_tr_b16 a[206:207], v229 offset:30720
  v_exp_f32 v137, v137
  s_waitcnt lgkmcnt(13)
  v_mfma_f32_16x16x32_bf16 v[52:55], a[212:215], a[116:119], v[52:55]
  ds_read_b64_tr_b16 a[208:209], v234 offset:49152
  ds_read_b64_tr_b16 a[210:211], v234 offset:51200
  v_mfma_f32_16x16x32_bf16 v[52:55], a[216:219], a[124:127], v[52:55]
  s_mov_b32 s40, 19791872
  v_exp_f32 v138, v138
  v_mfma_f32_16x16x32_bf16 v[36:39], a[212:215], a[112:115], v[36:39]
  buffer_load_dwordx4 a[184:187], v252, s[4:7], s40 offen offset:0 sc1
  v_mfma_f32_16x16x32_bf16 v[36:39], a[216:219], a[120:123], v[36:39]
  ds_read_b64_tr_b16 a[212:213], v230 offset:28672
  ds_read_b64_tr_b16 a[214:215], v230 offset:30720
  v_mfma_f32_16x16x32_bf16 v[40:43], a[220:223], a[112:115], v[40:43]
  ds_read_b64_tr_b16 a[216:217], v235 offset:49152
  ds_read_b64_tr_b16 a[218:219], v235 offset:51200
  v_exp_f32 v139, v139
  s_waitcnt lgkmcnt(13)
  v_mfma_f32_16x16x32_bf16 v[40:43], a[224:227], a[120:123], v[40:43]
  buffer_load_dwordx4 a[188:191], v252, s[4:7], s40 offen offset:1024 sc1
  v_mfma_f32_16x16x32_bf16 v[56:59], a[220:223], a[116:119], v[56:59]
  ds_read_b64_tr_b16 a[220:221], v231 offset:28672
  ds_read_b64_tr_b16 a[222:223], v231 offset:30720
  v_mfma_f32_16x16x32_bf16 v[56:59], a[224:227], a[124:127], v[56:59]
  ds_read_b64_tr_b16 a[224:225], v228 offset:32768
  ds_read_b64_tr_b16 a[226:227], v228 offset:34816
  v_exp_f32 v140, v140
  v_mfma_f32_16x16x32_bf16 v[60:63], a[228:231], a[116:119], v[60:63]
  s_mov_b32 s41, 196608
  s_add_u32 m0, s42, 73728
  v_mfma_f32_16x16x32_bf16 v[60:63], a[232:235], a[124:127], v[60:63]
  buffer_load_dwordx4 v242, s[44:47], s41 offen offset:0 lds
  v_mfma_f32_16x16x32_bf16 v[44:47], a[228:231], a[112:115], v[44:47]
  ds_read_b64_tr_b16 a[228:229], v228 offset:40960
  ds_read_b64_tr_b16 a[230:231], v228 offset:43008
  v_exp_f32 v141, v141
  v_mfma_f32_16x16x32_bf16 v[44:47], a[232:235], a[120:123], v[44:47]
  ds_read_b64_tr_b16 a[232:233], v229 offset:32768
  ds_read_b64_tr_b16 a[234:235], v229 offset:34816
  s_waitcnt lgkmcnt(13)
  v_mfma_f32_16x16x32_bf16 v[0:3], a[192:195], a[112:115], v[0:3]
  s_mov_b32 s41, 655360
  s_add_u32 m0, s42, 86016
  v_exp_f32 v142, v142
  v_mfma_f32_16x16x32_bf16 v[0:3], a[196:199], a[120:123], v[0:3]
  buffer_load_dwordx4 v242, s[44:47], s41 offen offset:0 lds
  v_mfma_f32_16x16x32_bf16 v[16:19], a[192:195], a[116:119], v[16:19]
  ds_read_b64_tr_b16 a[192:193], v229 offset:40960
  ds_read_b64_tr_b16 a[194:195], v229 offset:43008
  v_mfma_f32_16x16x32_bf16 v[16:19], a[196:199], a[124:127], v[16:19]
  ds_read_b64_tr_b16 a[196:197], v230 offset:32768
  ds_read_b64_tr_b16 a[198:199], v230 offset:34816
  v_exp_f32 v143, v143
  v_add_f32 v136, 1.0, v136
  v_mfma_f32_16x16x32_bf16 v[20:23], a[200:203], a[116:119], v[20:23]
  s_mov_b32 s41, 196608
  s_add_u32 m0, s42, 102400
  v_add_f32 v137, 1.0, v137
  v_mfma_f32_16x16x32_bf16 v[20:23], a[204:207], a[124:127], v[20:23]
  buffer_load_dwordx4 v253, s[44:47], s41 offen offset:0 lds
  v_mfma_f32_16x16x32_bf16 v[4:7], a[200:203], a[112:115], v[4:7]
  ds_read_b64_tr_b16 a[200:201], v230 offset:40960
  ds_read_b64_tr_b16 a[202:203], v230 offset:43008
  v_add_f32 v138, 1.0, v138
  v_mfma_f32_16x16x32_bf16 v[4:7], a[204:207], a[120:123], v[4:7]
  ds_read_b64_tr_b16 a[204:205], v231 offset:32768
  ds_read_b64_tr_b16 a[206:207], v231 offset:34816
  v_add_f32 v139, 1.0, v139
  s_waitcnt lgkmcnt(13)
  v_mfma_f32_16x16x32_bf16 v[8:11], a[208:211], a[112:115], v[8:11]
  s_mov_b32 s41, 655360
  s_add_u32 m0, s42, 98304
  v_add_f32 v140, 1.0, v140
  v_mfma_f32_16x16x32_bf16 v[8:11], a[212:215], a[120:123], v[8:11]
  buffer_load_dwordx4 v253, s[44:47], s41 offen offset:0 lds
  v_mfma_f32_16x16x32_bf16 v[24:27], a[208:211], a[116:119], v[24:27]
  ds_read_b64_tr_b16 a[208:209], v231 offset:40960
  ds_read_b64_tr_b16 a[210:211], v231 offset:43008
  v_add_f32 v141, 1.0, v141
  v_mfma_f32_16x16x32_bf16 v[24:27], a[212:215], a[124:127], v[24:27]
  ds_read_b64_tr_b16 a[212:213], v232 offset:4096
  ds_read_b64_tr_b16 a[214:215], v232 offset:6144
  v_add_f32 v142, 1.0, v142
  v_mfma_f32_16x16x32_bf16 v[28:31], a[216:219], a[116:119], v[28:31]
  s_mov_b32 s41, 1114112
  s_add_u32 m0, s42, 110592
  v_add_f32 v143, 1.0, v143
  v_mfma_f32_16x16x32_bf16 v[28:31], a[220:223], a[124:127], v[28:31]
  buffer_load_dwordx4 v242, s[44:47], s41 offen offset:0 lds
  v_mfma_f32_16x16x32_bf16 v[12:15], a[216:219], a[112:115], v[12:15]
  ds_read_b64_tr_b16 a[216:217], v232 offset:16384
  ds_read_b64_tr_b16 a[218:219], v232 offset:18432
  v_mfma_f32_16x16x32_bf16 v[12:15], a[220:223], a[120:123], v[12:15]
  ds_read_b64_tr_b16 a[220:221], v233 offset:4096
  ds_read_b64_tr_b16 a[222:223], v233 offset:6144
  s_waitcnt vmcnt(26) lgkmcnt(13)
  v_mfma_f32_16x16x32_bf16 v[32:35], a[224:227], a[128:131], v[32:35]
  s_mov_b32 s41, 1572864
  s_add_u32 m0, s42, 126976
  v_rcp_f32 v136, v136
  v_mfma_f32_16x16x32_bf16 v[32:35], a[228:231], a[136:139], v[32:35]
  s_barrier
  v_mfma_f32_16x16x32_bf16 v[48:51], a[224:227], a[132:135], v[48:51]
  buffer_load_dwordx4 v242, s[44:47], s41 offen offset:0 lds
  v_mfma_f32_16x16x32_bf16 v[48:51], a[228:231], a[140:143], v[48:51]
  ds_read_b64_tr_b16 a[224:225], v233 offset:16384
  ds_read_b64_tr_b16 a[226:227], v233 offset:18432
  v_rcp_f32 v137, v137
  v_mfma_f32_16x16x32_bf16 v[52:55], a[232:235], a[132:135], v[52:55]
  ds_read_b64_tr_b16 a[228:229], v234 offset:4096
  ds_read_b64_tr_b16 a[230:231], v234 offset:6144
  v_mfma_f32_16x16x32_bf16 v[52:55], a[192:195], a[140:143], v[52:55]
  s_mov_b32 s41, 1114112
  s_add_u32 m0, s42, 122880
  v_mfma_f32_16x16x32_bf16 v[36:39], a[232:235], a[128:131], v[36:39]
  buffer_load_dwordx4 v253, s[44:47], s41 offen offset:0 lds
  v_rcp_f32 v138, v138
  v_mfma_f32_16x16x32_bf16 v[36:39], a[192:195], a[136:139], v[36:39]
  ds_read_b64_tr_b16 a[232:233], v234 offset:16384
  ds_read_b64_tr_b16 a[234:235], v234 offset:18432
  s_waitcnt lgkmcnt(13)
  v_mfma_f32_16x16x32_bf16 v[40:43], a[196:199], a[128:131], v[40:43]
  ds_read_b64_tr_b16 a[192:193], v235 offset:4096
  ds_read_b64_tr_b16 a[194:195], v235 offset:6144
  v_rcp_f32 v139, v139
  v_mfma_f32_16x16x32_bf16 v[40:43], a[200:203], a[136:139], v[40:43]
  s_mov_b32 s41, 1572864
  s_add_u32 m0, s42, 135168
  v_mfma_f32_16x16x32_bf16 v[56:59], a[196:199], a[132:135], v[56:59]
  buffer_load_dwordx4 v253, s[44:47], s41 offen offset:0 lds
  v_mfma_f32_16x16x32_bf16 v[56:59], a[200:203], a[140:143], v[56:59]
  ds_read_b64_tr_b16 a[196:197], v235 offset:16384
  ds_read_b64_tr_b16 a[198:199], v235 offset:18432
  v_rcp_f32 v140, v140
  v_mfma_f32_16x16x32_bf16 v[60:63], a[204:207], a[132:135], v[60:63]
  ds_read_b64_tr_b16 a[200:201], v232 offset:24576
  ds_read_b64_tr_b16 a[202:203], v232 offset:26624
  s_waitcnt lgkmcnt(13)
  v_mfma_f32_16x16x32_bf16 v[60:63], a[208:211], a[140:143], v[60:63]
  s_mov_b32 s41, 2031616
  s_add_u32 m0, s42, 151552
  v_mfma_f32_16x16x32_bf16 v[44:47], a[204:207], a[128:131], v[44:47]
  buffer_load_dwordx4 v242, s[44:47], s41 offen offset:0 lds
  v_rcp_f32 v141, v141
  v_mfma_f32_16x16x32_bf16 v[44:47], a[208:211], a[136:139], v[44:47]
  ds_read_b64_tr_b16 a[204:205], v232 offset:53248
  ds_read_b64_tr_b16 a[206:207], v232 offset:55296
  v_mfma_f32_16x16x32_bf16 v[0:3], a[212:215], a[128:131], v[0:3]
  ds_read_b64_tr_b16 a[208:209], v233 offset:24576
  ds_read_b64_tr_b16 a[210:211], v233 offset:26624
  v_rcp_f32 v142, v142
  v_mfma_f32_16x16x32_bf16 v[0:3], a[216:219], a[136:139], v[0:3]
  s_mov_b32 s41, 2490368
  s_add_u32 m0, s42, 147456
  v_mfma_f32_16x16x32_bf16 v[16:19], a[212:215], a[132:135], v[16:19]
  buffer_load_dwordx4 v242, s[44:47], s41 offen offset:0 lds
  v_mfma_f32_16x16x32_bf16 v[16:19], a[216:219], a[140:143], v[16:19]
  ds_read_b64_tr_b16 a[212:213], v233 offset:53248
  ds_read_b64_tr_b16 a[214:215], v233 offset:55296
  v_rcp_f32 v143, v143
  v_mul_f32 v136, v136, v152
  s_waitcnt lgkmcnt(13)
  v_mfma_f32_16x16x32_bf16 v[20:23], a[220:223], a[132:135], v[20:23]
  ds_read_b64_tr_b16 a[216:217], v234 offset:24576
  ds_read_b64_tr_b16 a[218:219], v234 offset:26624
  v_mul_f32 v137, v137, v153
  v_mfma_f32_16x16x32_bf16 v[20:23], a[224:227], a[140:143], v[20:23]
  s_mov_b32 s41, 2031616
  s_add_u32 m0, s42, 159744
  v_mfma_f32_16x16x32_bf16 v[4:7], a[220:223], a[128:131], v[4:7]
  buffer_load_dwordx4 v253, s[44:47], s41 offen offset:0 lds
  v_mul_f32 v138, v138, v154
  v_mfma_f32_16x16x32_bf16 v[4:7], a[224:227], a[136:139], v[4:7]
  ds_read_b64_tr_b16 a[220:221], v234 offset:53248
  ds_read_b64_tr_b16 a[222:223], v234 offset:55296
  buffer_load_dword v244, v243, s[4:7], s91 offen sc1
  v_mul_f32 v139, v139, v155
  v_mfma_f32_16x16x32_bf16 v[8:11], a[228:231], a[128:131], v[8:11]
  ds_read_b64_tr_b16 a[224:225], v235 offset:24576
  ds_read_b64_tr_b16 a[226:227], v235 offset:26624
  v_mul_f32 v140, v140, v156
  s_waitcnt lgkmcnt(13)
  v_mfma_f32_16x16x32_bf16 v[8:11], a[232:235], a[136:139], v[8:11]
  s_mov_b32 s41, 2490368
  s_add_u32 m0, s42, 16384
  v_mfma_f32_16x16x32_bf16 v[24:27], a[228:231], a[132:135], v[24:27]
  buffer_load_dwordx4 v253, s[44:47], s41 offen offset:0 lds
  v_mul_f32 v141, v141, v157
  v_mfma_f32_16x16x32_bf16 v[24:27], a[232:235], a[140:143], v[24:27]
  ds_read_b64_tr_b16 a[228:229], v235 offset:53248
  ds_read_b64_tr_b16 a[230:231], v235 offset:55296
  v_mul_f32 v142, v142, v158
  v_mfma_f32_16x16x32_bf16 v[28:31], a[192:195], a[132:135], v[28:31]
  ds_read_b64_tr_b16 a[232:233], v236 offset:0
  ds_read_b64_tr_b16 a[234:235], v236 offset:2048
  v_mul_f32 v143, v143, v159
  v_mfma_f32_16x16x32_bf16 v[28:31], a[196:199], a[140:143], v[28:31]
  s_mov_b32 s41, 2949120
  s_add_u32 m0, s42, 12288
  v_mfma_f32_16x16x32_bf16 v[12:15], a[192:195], a[128:131], v[12:15]
  buffer_load_dwordx4 v242, s[44:47], s41 offen offset:0 lds
  v_cvt_pk_bf16_f32 v136, v136, v137
  v_mfma_f32_16x16x32_bf16 v[12:15], a[196:199], a[136:139], v[12:15]
  ds_read_b64_tr_b16 a[192:193], v236 offset:8192
  ds_read_b64_tr_b16 a[194:195], v236 offset:10240
  v_cvt_pk_bf16_f32 v137, v138, v139
  s_waitcnt vmcnt(30) lgkmcnt(13)
  v_mfma_f32_16x16x32_bf16 v[32:35], a[200:203], a[144:147], v[32:35]
  ds_read_b64_tr_b16 a[196:197], v237 offset:0
  ds_read_b64_tr_b16 a[198:199], v237 offset:2048
  v_cvt_pk_bf16_f32 v138, v140, v141
  v_mfma_f32_16x16x32_bf16 v[32:35], a[204:207], a[152:155], v[32:35]
  s_waitcnt vmcnt(27)
  s_barrier
  v_mfma_f32_16x16x32_bf16 v[48:51], a[200:203], a[148:151], v[48:51]
  ds_read_b64_tr_b16 a[200:201], v237 offset:8192
  ds_read_b64_tr_b16 a[202:203], v237 offset:10240
  v_cvt_pk_bf16_f32 v139, v142, v143
  v_mfma_f32_16x16x32_bf16 v[48:51], a[204:207], a[156:159], v[48:51]
  ds_read_b64_tr_b16 a[204:205], v238 offset:0
  ds_read_b64_tr_b16 a[206:207], v238 offset:2048
  v_mfma_f32_16x16x32_bf16 v[52:55], a[208:211], a[148:151], v[52:55]
  s_mov_b32 s41, 3407872
  s_add_u32 m0, s42, 24576
  s_waitcnt lgkmcnt(13)
  v_mfma_f32_16x16x32_bf16 v[52:55], a[212:215], a[156:159], v[52:55]
  buffer_load_dwordx4 v242, s[44:47], s41 offen offset:0 lds
  v_mfma_f32_16x16x32_bf16 v[36:39], a[208:211], a[144:147], v[36:39]
  ds_read_b64_tr_b16 a[208:209], v238 offset:8192
  ds_read_b64_tr_b16 a[210:211], v238 offset:10240
  buffer_store_dwordx4 v[136:139], v225, s[4:7], s21 offen offset:1024 sc1
  v_mul_f32 v168, s43, v168
  v_mfma_f32_16x16x32_bf16 v[36:39], a[212:215], a[152:155], v[36:39]
  ds_read_b64_tr_b16 a[212:213], v239 offset:0
  ds_read_b64_tr_b16 a[214:215], v239 offset:2048
  v_mul_f32 v169, s43, v169
  v_mfma_f32_16x16x32_bf16 v[40:43], a[216:219], a[144:147], v[40:43]
  s_mov_b32 s41, 2949120
  s_add_u32 m0, s42, 45056
  v_mul_f32 v170, s43, v170
  v_mfma_f32_16x16x32_bf16 v[40:43], a[220:223], a[152:155], v[40:43]
  buffer_load_dwordx4 v253, s[44:47], s41 offen offset:0 lds
  v_mfma_f32_16x16x32_bf16 v[56:59], a[216:219], a[148:151], v[56:59]
  ds_read_b64_tr_b16 a[216:217], v239 offset:8192
  ds_read_b64_tr_b16 a[218:219], v239 offset:10240
  v_mul_f32 v171, s43, v171
  v_mfma_f32_16x16x32_bf16 v[56:59], a[220:223], a[156:159], v[56:59]
  ds_read_b64_tr_b16 a[220:221], v228 offset:20480
  ds_read_b64_tr_b16 a[222:223], v228 offset:22528
  v_mul_f32 v172, s43, v172
  s_waitcnt lgkmcnt(13)
  v_mfma_f32_16x16x32_bf16 v[60:63], a[224:227], a[148:151], v[60:63]
  s_mov_b32 s41, 3407872
  s_add_u32 m0, s42, 57344
  v_mul_f32 v173, s43, v173
  v_mfma_f32_16x16x32_bf16 v[60:63], a[228:231], a[156:159], v[60:63]
  buffer_load_dwordx4 v253, s[44:47], s41 offen offset:0 lds
  v_mfma_f32_16x16x32_bf16 v[44:47], a[224:227], a[144:147], v[44:47]
  ds_read_b64_tr_b16 a[224:225], v236 offset:12288
  ds_read_b64_tr_b16 a[226:227], v236 offset:14336
  v_mul_f32 v174, s43, v174
  v_mfma_f32_16x16x32_bf16 v[44:47], a[228:231], a[152:155], v[44:47]
  ds_read_b64_tr_b16 a[228:229], v229 offset:20480
  ds_read_b64_tr_b16 a[230:231], v229 offset:22528
  v_mul_f32 v175, s43, v175
  v_mfma_f32_16x16x32_bf16 v[0:3], a[232:235], a[144:147], v[0:3]
  s_mov_b32 s41, 0
  s_add_u32 m0, s42, 65536
  v_mfma_f32_16x16x32_bf16 v[0:3], a[192:195], a[152:155], v[0:3]
  buffer_load_dwordx4 v242, s[44:47], s41 offen offset:0 lds
  v_mfma_f32_16x16x32_bf16 v[16:19], a[232:235], a[148:151], v[16:19]
  ds_read_b64_tr_b16 a[232:233], v237 offset:12288
  ds_read_b64_tr_b16 a[234:235], v237 offset:14336
  v_mfma_f32_16x16x32_bf16 v[16:19], a[192:195], a[156:159], v[16:19]
  ds_read_b64_tr_b16 a[192:193], v230 offset:20480
  ds_read_b64_tr_b16 a[194:195], v230 offset:22528
  v_exp_f32 v168, v168
  s_waitcnt lgkmcnt(13)
  v_mfma_f32_16x16x32_bf16 v[20:23], a[196:199], a[148:151], v[20:23]
  s_mov_b32 s41, 262144
  s_add_u32 m0, s42, 94208
  v_mfma_f32_16x16x32_bf16 v[20:23], a[200:203], a[156:159], v[20:23]
  buffer_load_dwordx4 v242, s[44:47], s41 offen offset:0 lds
  v_mfma_f32_16x16x32_bf16 v[4:7], a[196:199], a[144:147], v[4:7]
  ds_read_b64_tr_b16 a[196:197], v238 offset:12288
  ds_read_b64_tr_b16 a[198:199], v238 offset:14336
L_wk2_1:
  s_cbranch_vccnz L_wk2_end
  v_exp_f32 v169, v169
  v_mfma_f32_16x16x32_bf16 v[4:7], a[200:203], a[152:155], v[4:7]
  ds_read_b64_tr_b16 a[200:201], v231 offset:20480
  ds_read_b64_tr_b16 a[202:203], v231 offset:22528
  v_mfma_f32_16x16x32_bf16 v[8:11], a[204:207], a[144:147], v[8:11]
  s_mov_b32 s41, 0
  s_add_u32 m0, s42, 106496
  v_exp_f32 v170, v170
  v_mfma_f32_16x16x32_bf16 v[8:11], a[208:211], a[152:155], v[8:11]
  buffer_load_dwordx4 v253, s[44:47], s41 offen offset:0 lds
  v_mfma_f32_16x16x32_bf16 v[24:27], a[204:207], a[148:151], v[24:27]
  ds_read_b64_tr_b16 a[204:205], v239 offset:12288
  ds_read_b64_tr_b16 a[206:207], v239 offset:14336
  v_mfma_f32_16x16x32_bf16 v[24:27], a[208:211], a[156:159], v[24:27]
  ds_read_b64_tr_b16 a[208:209], v236 offset:24576
  ds_read_b64_tr_b16 a[210:211], v236 offset:26624
  v_exp_f32 v171, v171
  s_waitcnt lgkmcnt(13)
  v_mfma_f32_16x16x32_bf16 v[28:31], a[212:215], a[148:151], v[28:31]
  s_mov_b32 s41, 262144
  s_add_u32 m0, s42, 114688
  v_mfma_f32_16x16x32_bf16 v[28:31], a[216:219], a[156:159], v[28:31]
  buffer_load_dwordx4 v253, s[44:47], s41 offen offset:0 lds
  v_mfma_f32_16x16x32_bf16 v[12:15], a[212:215], a[144:147], v[12:15]
  ds_read_b64_tr_b16 a[212:213], v228 offset:36864
  ds_read_b64_tr_b16 a[214:215], v228 offset:38912
  v_exp_f32 v172, v172
  v_mfma_f32_16x16x32_bf16 v[12:15], a[216:219], a[152:155], v[12:15]
  ds_read_b64_tr_b16 a[216:217], v237 offset:24576
  ds_read_b64_tr_b16 a[218:219], v237 offset:26624
  s_waitcnt vmcnt(10)
  v_subrev_u32 v244, s100, v244
  v_mfma_f32_16x16x32_bf16 v[32:35], a[220:223], a[160:163], v[32:35]
  s_mov_b32 s41, 524288
  s_add_u32 m0, s42, 28672
  v_subrev_u32 v244, 1, v244
  v_cmp_lt_u32 s[68:69], 6, v244
  v_exp_f32 v173, v173
  v_mfma_f32_16x16x32_bf16 v[32:35], a[224:227], a[168:171], v[32:35]
  s_barrier
  s_cmp_lg_u64 s[68:69], 0
  s_cbranch_scc1 L_slow_46
L_back_47:
  v_mfma_f32_16x16x32_bf16 v[48:51], a[220:223], a[164:167], v[48:51]
  buffer_load_dwordx4 v242, s[44:47], s41 offen offset:0 lds
  v_mfma_f32_16x16x32_bf16 v[48:51], a[224:227], a[172:175], v[48:51]
  ds_read_b64_tr_b16 a[220:221], v229 offset:36864
  ds_read_b64_tr_b16 a[222:223], v229 offset:38912
  v_exp_f32 v174, v174
  s_waitcnt lgkmcnt(13)
  v_mfma_f32_16x16x32_bf16 v[52:55], a[228:231], a[164:167], v[52:55]
  ds_read_b64_tr_b16 a[224:225], v238 offset:24576
  ds_read_b64_tr_b16 a[226:227], v238 offset:26624
  v_mfma_f32_16x16x32_bf16 v[52:55], a[232:235], a[172:175], v[52:55]
  s_mov_b32 s40, 19922944
  v_exp_f32 v175, v175
  v_mfma_f32_16x16x32_bf16 v[36:39], a[228:231], a[160:163], v[36:39]
  buffer_load_dwordx4 v[96:99], v252, s[4:7], s40 offen offset:0 sc1
  v_add_f32 v168, 1.0, v168
  v_mfma_f32_16x16x32_bf16 v[36:39], a[232:235], a[168:171], v[36:39]
  ds_read_b64_tr_b16 a[228:229], v230 offset:36864
  ds_read_b64_tr_b16 a[230:231], v230 offset:38912
  v_add_f32 v169, 1.0, v169
  v_mfma_f32_16x16x32_bf16 v[40:43], a[192:195], a[160:163], v[40:43]
  ds_read_b64_tr_b16 a[232:233], v239 offset:24576
  ds_read_b64_tr_b16 a[234:235], v239 offset:26624
  v_add_f32 v170, 1.0, v170
  s_waitcnt lgkmcnt(13)
  v_mfma_f32_16x16x32_bf16 v[40:43], a[196:199], a[168:171], v[40:43]
  buffer_load_dwordx4 v[100:103], v252, s[4:7], s40 offen offset:1024 sc1
  v_mfma_f32_16x16x32_bf16 v[56:59], a[192:195], a[164:167], v[56:59]
  ds_read_b64_tr_b16 a[192:193], v231 offset:36864
  ds_read_b64_tr_b16 a[194:195], v231 offset:38912
  v_add_f32 v171, 1.0, v171
  v_mfma_f32_16x16x32_bf16 v[56:59], a[196:199], a[172:175], v[56:59]
  ds_read_b64_tr_b16 a[196:197], v228 offset:53248
  ds_read_b64_tr_b16 a[198:199], v228 offset:55296
  v_add_f32 v172, 1.0, v172
  v_mfma_f32_16x16x32_bf16 v[60:63], a[200:203], a[164:167], v[60:63]
  s_mov_b32 s40, 20054016
  v_add_f32 v173, 1.0, v173
  v_mfma_f32_16x16x32_bf16 v[60:63], a[204:207], a[172:175], v[60:63]
  buffer_load_dwordx4 v[112:115], v252, s[4:7], s40 offen offset:0 sc1
  v_mfma_f32_16x16x32_bf16 v[44:47], a[200:203], a[160:163], v[44:47]
  ds_read_b64_tr_b16 a[200:201], v228 offset:49152
  ds_read_b64_tr_b16 a[202:203], v228 offset:51200
  v_add_f32 v174, 1.0, v174
  v_mfma_f32_16x16x32_bf16 v[44:47], a[204:207], a[168:171], v[44:47]
  ds_read_b64_tr_b16 a[204:205], v229 offset:53248
  ds_read_b64_tr_b16 a[206:207], v229 offset:55296
  v_add_f32 v175, 1.0, v175
  s_waitcnt lgkmcnt(13)
  v_mfma_f32_16x16x32_bf16 v[0:3], a[208:211], a[160:163], v[0:3]
  v_rcp_f32 v168, v168
  v_mfma_f32_16x16x32_bf16 v[0:3], a[212:215], a[168:171], v[0:3]
  buffer_load_dwordx4 v[116:119], v252, s[4:7], s40 offen offset:1024 sc1
  v_mfma_f32_16x16x32_bf16 v[16:19], a[208:211], a[164:167], v[16:19]
  ds_read_b64_tr_b16 a[208:209], v229 offset:49152
  ds_read_b64_tr_b16 a[210:211], v229 offset:51200
  v_mfma_f32_16x16x32_bf16 v[16:19], a[212:215], a[172:175], v[16:19]
  ds_read_b64_tr_b16 a[212:213], v230 offset:53248
  ds_read_b64_tr_b16 a[214:215], v230 offset:55296
  v_mfma_f32_16x16x32_bf16 v[20:23], a[216:219], a[164:167], v[20:23]
  s_mov_b32 s40, 20185088
  v_rcp_f32 v169, v169
  v_mfma_f32_16x16x32_bf16 v[20:23], a[220:223], a[172:175], v[20:23]
  buffer_load_dwordx4 v[128:131], v252, s[4:7], s40 offen offset:0 sc1
  v_mfma_f32_16x16x32_bf16 v[4:7], a[216:219], a[160:163], v[4:7]
  ds_read_b64_tr_b16 a[216:217], v230 offset:49152
  ds_read_b64_tr_b16 a[218:219], v230 offset:51200
  v_mfma_f32_16x16x32_bf16 v[4:7], a[220:223], a[168:171], v[4:7]
  ds_read_b64_tr_b16 a[220:221], v231 offset:53248
  ds_read_b64_tr_b16 a[222:223], v231 offset:55296
  s_waitcnt lgkmcnt(13)
  v_mfma_f32_16x16x32_bf16 v[8:11], a[224:227], a[160:163], v[8:11]
  v_rcp_f32 v170, v170
  v_mfma_f32_16x16x32_bf16 v[8:11], a[228:231], a[168:171], v[8:11]
  buffer_load_dwordx4 v[132:135], v252, s[4:7], s40 offen offset:1024 sc1
  v_mfma_f32_16x16x32_bf16 v[24:27], a[224:227], a[164:167], v[24:27]
  ds_read_b64_tr_b16 a[224:225], v231 offset:49152
  ds_read_b64_tr_b16 a[226:227], v231 offset:51200
  v_mfma_f32_16x16x32_bf16 v[24:27], a[228:231], a[172:175], v[24:27]
  ds_read_b64_tr_b16 a[228:229], v228 offset:61440
  ds_read_b64_tr_b16 a[230:231], v228 offset:63488
  v_rcp_f32 v171, v171
  v_mfma_f32_16x16x32_bf16 v[28:31], a[232:235], a[164:167], v[28:31]
  s_mov_b32 s40, 20316160
  v_rcp_f32 v172, v172
  v_mfma_f32_16x16x32_bf16 v[28:31], a[192:195], a[172:175], v[28:31]
  buffer_load_dwordx4 v[144:147], v252, s[4:7], s40 offen offset:0 sc1
  v_mfma_f32_16x16x32_bf16 v[12:15], a[232:235], a[160:163], v[12:15]
  ds_read_b64_tr_b16 a[232:233], v232 offset:12288
  ds_read_b64_tr_b16 a[234:235], v232 offset:14336
  v_mfma_f32_16x16x32_bf16 v[12:15], a[192:195], a[168:171], v[12:15]
  ds_read_b64_tr_b16 a[192:193], v229 offset:61440
  ds_read_b64_tr_b16 a[194:195], v229 offset:63488
  s_waitcnt lgkmcnt(13)
  v_mfma_f32_16x16x32_bf16 v[32:35], a[196:199], a[176:179], v[32:35]
  buffer_load_dwordx4 v[148:151], v252, s[4:7], s40 offen offset:1024 sc1
  v_rcp_f32 v173, v173
  v_mfma_f32_16x16x32_bf16 v[32:35], a[200:203], a[184:187], v[32:35]
  s_barrier
  v_mfma_f32_16x16x32_bf16 v[48:51], a[196:199], a[180:183], v[48:51]
  ds_read_b64_tr_b16 a[196:197], v233 offset:12288
  ds_read_b64_tr_b16 a[198:199], v233 offset:14336
  v_mfma_f32_16x16x32_bf16 v[48:51], a[200:203], a[188:191], v[48:51]
  ds_read_b64_tr_b16 a[200:201], v230 offset:61440
  ds_read_b64_tr_b16 a[202:203], v230 offset:63488
  v_rcp_f32 v174, v174
  v_mfma_f32_16x16x32_bf16 v[52:55], a[204:207], a[180:183], v[52:55]
  s_mov_b32 s40, 20447232
  v_rcp_f32 v175, v175
  v_mfma_f32_16x16x32_bf16 v[52:55], a[208:211], a[188:191], v[52:55]
  buffer_load_dwordx4 v[160:163], v252, s[4:7], s40 offen offset:0 sc1
  v_mfma_f32_16x16x32_bf16 v[36:39], a[204:207], a[176:179], v[36:39]
  ds_read_b64_tr_b16 a[204:205], v234 offset:12288
  ds_read_b64_tr_b16 a[206:207], v234 offset:14336
  v_mul_f32 v168, v168, v184
  v_mfma_f32_16x16x32_bf16 v[36:39], a[208:211], a[184:187], v[36:39]
  ds_read_b64_tr_b16 a[208:209], v231 offset:61440
  ds_read_b64_tr_b16 a[210:211], v231 offset:63488
  v_mul_f32 v169, v169, v185
  s_waitcnt lgkmcnt(13)
  v_mfma_f32_16x16x32_bf16 v[40:43], a[212:215], a[176:179], v[40:43]
  buffer_load_dwordx4 v[164:167], v252, s[4:7], s40 offen offset:1024 sc1
  v_mul_f32 v170, v170, v186
  v_mfma_f32_16x16x32_bf16 v[40:43], a[216:219], a[184:187], v[40:43]
  s_mov_b32 s40, 20578304
  v_mul_f32 v171, v171, v187
  v_mfma_f32_16x16x32_bf16 v[56:59], a[212:215], a[180:183], v[56:59]
  ds_read_b64_tr_b16 a[212:213], v235 offset:12288
  ds_read_b64_tr_b16 a[214:215], v235 offset:14336
  v_mfma_f32_16x16x32_bf16 v[56:59], a[216:219], a[188:191], v[56:59]
  ds_read_b64_tr_b16 a[216:217], v232 offset:8192
  ds_read_b64_tr_b16 a[218:219], v232 offset:10240
  v_mul_f32 v172, v172, v188
  v_mfma_f32_16x16x32_bf16 v[60:63], a[220:223], a[180:183], v[60:63]
  buffer_load_dwordx4 v[176:179], v252, s[4:7], s40 offen offset:0 sc1
  v_mul_f32 v173, v173, v189
  v_mfma_f32_16x16x32_bf16 v[60:63], a[224:227], a[188:191], v[60:63]
  v_mul_f32 v174, v174, v190
  v_mul_f32 v175, v175, v191
  v_mfma_f32_16x16x32_bf16 v[44:47], a[220:223], a[176:179], v[44:47]
  ds_read_b64_tr_b16 a[220:221], v232 offset:20480
  ds_read_b64_tr_b16 a[222:223], v232 offset:22528
  v_mfma_f32_16x16x32_bf16 v[44:47], a[224:227], a[184:187], v[44:47]
  ds_read_b64_tr_b16 a[224:225], v233 offset:8192
  ds_read_b64_tr_b16 a[226:227], v233 offset:10240
  s_waitcnt lgkmcnt(13)
  v_mfma_f32_16x16x32_bf16 v[0:3], a[228:231], a[176:179], v[0:3]
  buffer_load_dwordx4 v[180:183], v252, s[4:7], s40 offen offset:1024 sc1
  v_cvt_pk_bf16_f32 v168, v168, v169
  v_mfma_f32_16x16x32_bf16 v[0:3], a[232:235], a[184:187], v[0:3]
  s_mov_b32 s40, 20709376
  v_cvt_pk_bf16_f32 v169, v170, v171
  v_mfma_f32_16x16x32_bf16 v[16:19], a[228:231], a[180:183], v[16:19]
  ds_read_b64_tr_b16 a[228:229], v233 offset:20480
  ds_read_b64_tr_b16 a[230:231], v233 offset:22528
  v_mfma_f32_16x16x32_bf16 v[16:19], a[232:235], a[188:191], v[16:19]
  ds_read_b64_tr_b16 a[232:233], v234 offset:8192
  ds_read_b64_tr_b16 a[234:235], v234 offset:10240
  v_cvt_pk_bf16_f32 v170, v172, v173
  v_mfma_f32_16x16x32_bf16 v[20:23], a[192:195], a[180:183], v[20:23]
  buffer_load_dwordx4 v[192:195], v252, s[4:7], s40 offen offset:0 sc1
  v_cvt_pk_bf16_f32 v171, v174, v175
  v_mfma_f32_16x16x32_bf16 v[20:23], a[196:199], a[188:191], v[20:23]
  buffer_store_dwordx4 v[168:171], v225, s[4:7], s21 offen offset:2048 sc1
  v_mfma_f32_16x16x32_bf16 v[4:7], a[192:195], a[176:179], v[4:7]
  ds_read_b64_tr_b16 a[192:193], v234 offset:20480
  ds_read_b64_tr_b16 a[194:195], v234 offset:22528
  v_mfma_f32_16x16x32_bf16 v[4:7], a[196:199], a[184:187], v[4:7]
  ds_read_b64_tr_b16 a[196:197], v235 offset:8192
  ds_read_b64_tr_b16 a[198:199], v235 offset:10240
  s_waitcnt lgkmcnt(13)
  v_mfma_f32_16x16x32_bf16 v[8:11], a[200:203], a[176:179], v[8:11]
  buffer_load_dwordx4 v[196:199], v252, s[4:7], s40 offen offset:1024 sc1
  v_mul_f32 v200, s43, v200
  v_mfma_f32_16x16x32_bf16 v[8:11], a[204:207], a[184:187], v[8:11]
  s_mov_b32 s40, 20840448
  v_mul_f32 v201, s43, v201
  v_mfma_f32_16x16x32_bf16 v[24:27], a[200:203], a[180:183], v[24:27]
  ds_read_b64_tr_b16 a[200:201], v235 offset:20480
  ds_read_b64_tr_b16 a[202:203], v235 offset:22528
  v_mfma_f32_16x16x32_bf16 v[24:27], a[204:207], a[188:191], v[24:27]
  buffer_load_dwordx4 v[208:211], v252, s[4:7], s40 offen offset:0 sc1
  v_mul_f32 v202, s43, v202
  v_mfma_f32_16x16x32_bf16 v[28:31], a[208:211], a[180:183], v[28:31]
  s_waitcnt vmcnt(12)
  v_swap_b32 v98, v100
  v_swap_b32 v99, v101
  v_swap_b32 v114, v116
  v_swap_b32 v115, v117
  ds_read_b64_tr_b16 a[204:205], v232 offset:36864
  ds_read_b64_tr_b16 a[206:207], v232 offset:38912
  v_mul_f32 v203, s43, v203
  v_mfma_f32_16x16x32_bf16 v[28:31], a[212:215], a[188:191], v[28:31]
  v_mul_f32 v204, s43, v204
  v_mul_f32 v205, s43, v205
  v_mfma_f32_16x16x32_bf16 v[12:15], a[208:211], a[176:179], v[12:15]
  ds_read_b64_tr_b16 a[208:209], v232 offset:32768
  ds_read_b64_tr_b16 a[210:211], v232 offset:34816
  v_mfma_f32_16x16x32_bf16 v[12:15], a[212:215], a[184:187], v[12:15]
  buffer_load_dwordx4 v[212:215], v252, s[4:7], s40 offen offset:1024 sc1
  s_waitcnt lgkmcnt(13)
  v_mfma_f32_16x16x32_bf16 v[32:35], a[216:219], v[96:99], v[32:35]
  ds_read_b64_tr_b16 a[212:213], v233 offset:36864
  ds_read_b64_tr_b16 a[214:215], v233 offset:38912
  v_mul_f32 v206, s43, v206
  v_mfma_f32_16x16x32_bf16 v[32:35], a[220:223], v[112:115], v[32:35]
  s_barrier
  v_mfma_f32_16x16x32_bf16 v[48:51], a[216:219], v[100:103], v[48:51]
  ds_read_b64_tr_b16 a[216:217], v233 offset:32768
  ds_read_b64_tr_b16 a[218:219], v233 offset:34816
  v_mul_f32 v207, s43, v207
  v_mfma_f32_16x16x32_bf16 v[48:51], a[220:223], v[116:119], v[48:51]
  ds_read_b64_tr_b16 a[220:221], v234 offset:36864
  ds_read_b64_tr_b16 a[222:223], v234 offset:38912
  v_mfma_f32_16x16x32_bf16 v[52:55], a[224:227], v[100:103], v[52:55]
  s_mov_b32 s41, 786432
  s_add_u32 m0, s42, 32768
  s_waitcnt lgkmcnt(13)
  v_mfma_f32_16x16x32_bf16 v[52:55], a[228:231], v[116:119], v[52:55]
  buffer_load_dwordx4 v242, s[44:47], s41 offen offset:0 lds
  v_mfma_f32_16x16x32_bf16 v[36:39], a[224:227], v[96:99], v[36:39]
  ds_read_b64_tr_b16 a[224:225], v234 offset:32768
  ds_read_b64_tr_b16 a[226:227], v234 offset:34816
  v_exp_f32 v200, v200
  v_mfma_f32_16x16x32_bf16 v[36:39], a[228:231], v[112:115], v[36:39]
  ds_read_b64_tr_b16 a[228:229], v235 offset:36864
  ds_read_b64_tr_b16 a[230:231], v235 offset:38912
  v_mfma_f32_16x16x32_bf16 v[40:43], a[232:235], v[96:99], v[40:43]
  s_mov_b32 s41, 524288
  s_add_u32 m0, s42, 40960
  v_exp_f32 v201, v201
  v_mfma_f32_16x16x32_bf16 v[40:43], a[192:195], v[112:115], v[40:43]
  buffer_load_dwordx4 v253, s[44:47], s41 offen offset:0 lds
  v_mfma_f32_16x16x32_bf16 v[56:59], a[232:235], v[100:103], v[56:59]
  ds_read_b64_tr_b16 a[232:233], v235 offset:32768
  ds_read_b64_tr_b16 a[234:235], v235 offset:34816
  v_mfma_f32_16x16x32_bf16 v[56:59], a[192:195], v[116:119], v[56:59]
  ds_read_b64_tr_b16 a[192:193], v232 offset:45056
  ds_read_b64_tr_b16 a[194:195], v232 offset:47104
  v_exp_f32 v202, v202
  s_waitcnt lgkmcnt(13)
  v_mfma_f32_16x16x32_bf16 v[60:63], a[196:199], v[100:103], v[60:63]
  s_mov_b32 s41, 786432
  s_add_u32 m0, s42, 69632
  v_mfma_f32_16x16x32_bf16 v[60:63], a[200:203], v[116:119], v[60:63]
  buffer_load_dwordx4 v253, s[44:47], s41 offen offset:0 lds
  v_mfma_f32_16x16x32_bf16 v[44:47], a[196:199], v[96:99], v[44:47]
  ds_read_b64_tr_b16 a[196:197], v232 offset:61440
  ds_read_b64_tr_b16 a[198:199], v232 offset:63488
  v_exp_f32 v203, v203
  v_mfma_f32_16x16x32_bf16 v[44:47], a[200:203], v[112:115], v[44:47]
  ds_read_b64_tr_b16 a[200:201], v233 offset:45056
  ds_read_b64_tr_b16 a[202:203], v233 offset:47104
  v_mfma_f32_16x16x32_bf16 v[0:3], a[204:207], v[96:99], v[0:3]
  s_mov_b32 s41, 917504
  s_add_u32 m0, s42, 81920
  v_exp_f32 v204, v204
  v_mfma_f32_16x16x32_bf16 v[0:3], a[208:211], v[112:115], v[0:3]
  buffer_load_dwordx4 v242, s[44:47], s41 offen offset:0 lds
  v_mfma_f32_16x16x32_bf16 v[16:19], a[204:207], v[100:103], v[16:19]
  ds_read_b64_tr_b16 a[204:205], v233 offset:61440
  ds_read_b64_tr_b16 a[206:207], v233 offset:63488
  v_mfma_f32_16x16x32_bf16 v[16:19], a[208:211], v[116:119], v[16:19]
  ds_read_b64_tr_b16 a[208:209], v234 offset:45056
  ds_read_b64_tr_b16 a[210:211], v234 offset:47104
  v_exp_f32 v205, v205
  s_waitcnt lgkmcnt(13)
  v_mfma_f32_16x16x32_bf16 v[20:23], a[212:215], v[100:103], v[20:23]
  s_mov_b32 s41, 1179648
  s_add_u32 m0, s42, 90112
  v_mfma_f32_16x16x32_bf16 v[20:23], a[216:219], v[116:119], v[20:23]
  buffer_load_dwordx4 v242, s[44:47], s41 offen offset:0 lds
  v_mfma_f32_16x16x32_bf16 v[4:7], a[212:215], v[96:99], v[4:7]
  ds_read_b64_tr_b16 a[212:213], v234 offset:61440
  ds_read_b64_tr_b16 a[214:215], v234 offset:63488
  v_exp_f32 v206, v206
  v_mfma_f32_16x16x32_bf16 v[4:7], a[216:219], v[112:115], v[4:7]
  ds_read_b64_tr_b16 a[216:217], v235 offset:45056
  ds_read_b64_tr_b16 a[218:219], v235 offset:47104
  buffer_load_dword v244, v243, s[4:7], s91 offen sc1
  v_mfma_f32_16x16x32_bf16 v[8:11], a[220:223], v[96:99], v[8:11]
  s_mov_b32 s41, 917504
  s_add_u32 m0, s42, 118784
  v_exp_f32 v207, v207
  v_add_f32 v200, 1.0, v200
  v_mfma_f32_16x16x32_bf16 v[8:11], a[224:227], v[112:115], v[8:11]
  buffer_load_dwordx4 v253, s[44:47], s41 offen offset:0 lds
  v_mfma_f32_16x16x32_bf16 v[24:27], a[220:223], v[100:103], v[24:27]
  ds_read_b64_tr_b16 a[220:221], v235 offset:61440
  ds_read_b64_tr_b16 a[222:223], v235 offset:63488
  v_add_f32 v201, 1.0, v201
  v_mfma_f32_16x16x32_bf16 v[24:27], a[224:227], v[116:119], v[24:27]
  ds_read_b64_tr_b16 a[224:225], v232 offset:57344
  ds_read_b64_tr_b16 a[226:227], v232 offset:59392
  v_add_f32 v202, 1.0, v202
  s_waitcnt lgkmcnt(13)
  v_mfma_f32_16x16x32_bf16 v[28:31], a[228:231], v[100:103], v[28:31]
  s_waitcnt vmcnt(16)
  v_swap_b32 v130, v132
  v_swap_b32 v131, v133
  v_swap_b32 v146, v148
  v_swap_b32 v147, v149
  s_mov_b32 s41, 1179648
  s_add_u32 m0, s42, 131072
  v_add_f32 v203, 1.0, v203
  v_mfma_f32_16x16x32_bf16 v[28:31], a[232:235], v[116:119], v[28:31]
  buffer_load_dwordx4 v253, s[44:47], s41 offen offset:0 lds
  v_mfma_f32_16x16x32_bf16 v[12:15], a[228:231], v[96:99], v[12:15]
  ds_read_b64_tr_b16 a[228:229], v236 offset:4096
  ds_read_b64_tr_b16 a[230:231], v236 offset:6144
  v_add_f32 v204, 1.0, v204
  v_mfma_f32_16x16x32_bf16 v[12:15], a[232:235], v[112:115], v[12:15]
  ds_read_b64_tr_b16 a[232:233], v233 offset:57344
  ds_read_b64_tr_b16 a[234:235], v233 offset:59392
  v_add_f32 v205, 1.0, v205
  v_mfma_f32_16x16x32_bf16 v[32:35], a[192:195], v[128:131], v[32:35]
  s_mov_b32 s41, 1441792
  s_add_u32 m0, s42, 139264
  v_add_f32 v206, 1.0, v206
  v_mfma_f32_16x16x32_bf16 v[32:35], a[196:199], v[144:147], v[32:35]
  s_barrier
  v_mfma_f32_16x16x32_bf16 v[48:51], a[192:195], v[132:135], v[48:51]
  buffer_load_dwordx4 v242, s[44:47], s41 offen offset:0 lds
  v_add_f32 v207, 1.0, v207
  v_mfma_f32_16x16x32_bf16 v[48:51], a[196:199], v[148:151], v[48:51]
  ds_read_b64_tr_b16 a[192:193], v237 offset:4096
  ds_read_b64_tr_b16 a[194:195], v237 offset:6144
  s_waitcnt lgkmcnt(13)
  v_mfma_f32_16x16x32_bf16 v[52:55], a[200:203], v[132:135], v[52:55]
  ds_read_b64_tr_b16 a[196:197], v234 offset:57344
  ds_read_b64_tr_b16 a[198:199], v234 offset:59392
  v_mfma_f32_16x16x32_bf16 v[52:55], a[204:207], v[148:151], v[52:55]
  s_mov_b32 s41, 1703936
  s_add_u32 m0, s42, 20480
  v_mfma_f32_16x16x32_bf16 v[36:39], a[200:203], v[128:131], v[36:39]
  buffer_load_dwordx4 v242, s[44:47], s41 offen offset:0 lds
  v_rcp_f32 v200, v200
  v_mfma_f32_16x16x32_bf16 v[36:39], a[204:207], v[144:147], v[36:39]
  ds_read_b64_tr_b16 a[200:201], v238 offset:4096
  ds_read_b64_tr_b16 a[202:203], v238 offset:6144
  v_mfma_f32_16x16x32_bf16 v[40:43], a[208:211], v[128:131], v[40:43]
  ds_read_b64_tr_b16 a[204:205], v235 offset:57344
  ds_read_b64_tr_b16 a[206:207], v235 offset:59392
  v_rcp_f32 v201, v201
  s_waitcnt lgkmcnt(13)
  v_mfma_f32_16x16x32_bf16 v[40:43], a[212:215], v[144:147], v[40:43]
  s_mov_b32 s41, 1441792
  s_add_u32 m0, s42, 143360
  v_mfma_f32_16x16x32_bf16 v[56:59], a[208:211], v[132:135], v[56:59]
  buffer_load_dwordx4 v253, s[44:47], s41 offen offset:0 lds
  v_mfma_f32_16x16x32_bf16 v[56:59], a[212:215], v[148:151], v[56:59]
  ds_read_b64_tr_b16 a[208:209], v239 offset:4096
  ds_read_b64_tr_b16 a[210:211], v239 offset:6144
  v_rcp_f32 v202, v202
  v_mfma_f32_16x16x32_bf16 v[60:63], a[216:219], v[132:135], v[60:63]
  ds_read_b64_tr_b16 a[212:213], v236 offset:20480
  ds_read_b64_tr_b16 a[214:215], v236 offset:22528
  v_mfma_f32_16x16x32_bf16 v[60:63], a[220:223], v[148:151], v[60:63]
  s_mov_b32 s41, 1703936
  s_add_u32 m0, s42, 155648
  v_mfma_f32_16x16x32_bf16 v[44:47], a[216:219], v[128:131], v[44:47]
  buffer_load_dwordx4 v253, s[44:47], s41 offen offset:0 lds
  v_rcp_f32 v203, v203
  v_mfma_f32_16x16x32_bf16 v[44:47], a[220:223], v[144:147], v[44:47]
  ds_read_b64_tr_b16 a[216:217], v236 offset:16384
  ds_read_b64_tr_b16 a[218:219], v236 offset:18432
  s_waitcnt lgkmcnt(13)
  v_mfma_f32_16x16x32_bf16 v[0:3], a[224:227], v[128:131], v[0:3]
  ds_read_b64_tr_b16 a[220:221], v237 offset:20480
  ds_read_b64_tr_b16 a[222:223], v237 offset:22528
  v_rcp_f32 v204, v204
  v_mfma_f32_16x16x32_bf16 v[0:3], a[228:231], v[144:147], v[0:3]
  s_mov_b32 s41, 1835008
  s_add_u32 m0, s42, 36864
  v_mfma_f32_16x16x32_bf16 v[16:19], a[224:227], v[132:135], v[16:19]
  buffer_load_dwordx4 v242, s[44:47], s41 offen offset:0 lds
  v_mfma_f32_16x16x32_bf16 v[16:19], a[228:231], v[148:151], v[16:19]
  ds_read_b64_tr_b16 a[224:225], v237 offset:16384
  ds_read_b64_tr_b16 a[226:227], v237 offset:18432
  v_rcp_f32 v205, v205
  v_mfma_f32_16x16x32_bf16 v[20:23], a[232:235], v[132:135], v[20:23]
  ds_read_b64_tr_b16 a[228:229], v238 offset:20480
  ds_read_b64_tr_b16 a[230:231], v238 offset:22528
  s_waitcnt lgkmcnt(13)
  v_mfma_f32_16x16x32_bf16 v[20:23], a[192:195], v[148:151], v[20:23]
  s_mov_b32 s41, 2097152
  s_add_u32 m0, s42, 53248
  v_mfma_f32_16x16x32_bf16 v[4:7], a[232:235], v[128:131], v[4:7]
  buffer_load_dwordx4 v242, s[44:47], s41 offen offset:0 lds
  v_rcp_f32 v206, v206
  v_mfma_f32_16x16x32_bf16 v[4:7], a[192:195], v[144:147], v[4:7]
  ds_read_b64_tr_b16 a[232:233], v238 offset:16384
  ds_read_b64_tr_b16 a[234:235], v238 offset:18432
  v_mfma_f32_16x16x32_bf16 v[8:11], a[196:199], v[128:131], v[8:11]
  ds_read_b64_tr_b16 a[192:193], v239 offset:20480
  ds_read_b64_tr_b16 a[194:195], v239 offset:22528
  v_rcp_f32 v207, v207
  v_mul_f32 v200, v200, v216
  v_mfma_f32_16x16x32_bf16 v[8:11], a[200:203], v[144:147], v[8:11]
  s_mov_b32 s41, 1835008
  s_add_u32 m0, s42, 49152
  v_mfma_f32_16x16x32_bf16 v[24:27], a[196:199], v[132:135], v[24:27]
  buffer_load_dwordx4 v253, s[44:47], s41 offen offset:0 lds
  v_mul_f32 v201, v201, v217
  v_mfma_f32_16x16x32_bf16 v[24:27], a[200:203], v[148:151], v[24:27]
  ds_read_b64_tr_b16 a[196:197], v239 offset:16384
  ds_read_b64_tr_b16 a[198:199], v239 offset:18432
  v_mul_f32 v202, v202, v218
  s_waitcnt lgkmcnt(13)
  v_mfma_f32_16x16x32_bf16 v[28:31], a[204:207], v[132:135], v[28:31]
  s_waitcnt vmcnt(20)
  v_swap_b32 v162, v164
  v_swap_b32 v163, v165
  v_swap_b32 v178, v180
  v_swap_b32 v179, v181
  ds_read_b64_tr_b16 a[200:201], v236 offset:28672
  ds_read_b64_tr_b16 a[202:203], v236 offset:30720
  v_mul_f32 v203, v203, v219
  v_mfma_f32_16x16x32_bf16 v[28:31], a[208:211], v[148:151], v[28:31]
  s_mov_b32 s41, 2097152
  s_add_u32 m0, s42, 61440
  v_mfma_f32_16x16x32_bf16 v[12:15], a[204:207], v[128:131], v[12:15]
  buffer_load_dwordx4 v253, s[44:47], s41 offen offset:0 lds
  v_mul_f32 v204, v204, v220
  v_mfma_f32_16x16x32_bf16 v[12:15], a[208:211], v[144:147], v[12:15]
  ds_read_b64_tr_b16 a[204:205], v228 offset:16384
  ds_read_b64_tr_b16 a[206:207], v228 offset:18432
  s_waitcnt vmcnt(10)
  v_subrev_u32 v244, s100, v244
  v_mul_f32 v205, v205, v221
  v_mfma_f32_16x16x32_bf16 v[32:35], a[212:215], v[160:163], v[32:35]
  ds_read_b64_tr_b16 a[208:209], v237 offset:28672
  ds_read_b64_tr_b16 a[210:211], v237 offset:30720
  v_subrev_u32 v244, 2, v244
  v_cmp_lt_u32 s[68:69], 5, v244
  v_mul_f32 v206, v206, v222
  s_waitcnt lgkmcnt(13)
  v_mfma_f32_16x16x32_bf16 v[32:35], a[216:219], v[176:179], v[32:35]
  s_barrier
  s_cmp_lg_u64 s[68:69], 0
  s_cbranch_scc1 L_slow_48
L_back_49:
  v_mfma_f32_16x16x32_bf16 v[48:51], a[212:215], v[164:167], v[48:51]
  ds_read_b64_tr_b16 a[212:213], v229 offset:16384
  ds_read_b64_tr_b16 a[214:215], v229 offset:18432
  s_xor_b32 s32, s90, 0x8000
  v_mov_b32 v254, s32
  v_mul_f32 v207, v207, v223
  v_mfma_f32_16x16x32_bf16 v[48:51], a[216:219], v[180:183], v[48:51]
  ds_read_b64_tr_b16 a[216:217], v238 offset:28672
  ds_read_b64_tr_b16 a[218:219], v238 offset:30720
  v_cndmask_b32_e64 v243, v254, v243, s[34:35]
  v_cvt_pk_bf16_f32 v200, v200, v201
  v_mfma_f32_16x16x32_bf16 v[52:55], a[220:223], v[164:167], v[52:55]
  s_mov_b32 s41, 2359296
  s_add_u32 m0, s42, 77824
  v_cvt_pk_bf16_f32 v201, v202, v203
  v_mfma_f32_16x16x32_bf16 v[52:55], a[224:227], v[180:183], v[52:55]
  buffer_load_dwordx4 v242, s[44:47], s41 offen offset:0 lds
  v_mfma_f32_16x16x32_bf16 v[36:39], a[220:223], v[160:163], v[36:39]
  ds_read_b64_tr_b16 a[220:221], v230 offset:16384
  ds_read_b64_tr_b16 a[222:223], v230 offset:18432
  v_cvt_pk_bf16_f32 v202, v204, v205
  v_mfma_f32_16x16x32_bf16 v[36:39], a[224:227], v[176:179], v[36:39]
  ds_read_b64_tr_b16 a[224:225], v239 offset:28672
  ds_read_b64_tr_b16 a[226:227], v239 offset:30720
  v_cvt_pk_bf16_f32 v203, v206, v207
  s_waitcnt lgkmcnt(13)
  v_mfma_f32_16x16x32_bf16 v[40:43], a[228:231], v[160:163], v[40:43]
  s_mov_b32 s40, 20971520
  v_mfma_f32_16x16x32_bf16 v[40:43], a[232:235], v[176:179], v[40:43]
  buffer_load_dwordx4 a[64:67], v252, s[4:7], s40 offen offset:0 sc1
  v_mfma_f32_16x16x32_bf16 v[56:59], a[228:231], v[164:167], v[56:59]
  ds_read_b64_tr_b16 a[228:229], v231 offset:16384
  ds_read_b64_tr_b16 a[230:231], v231 offset:18432
  v_mfma_f32_16x16x32_bf16 v[56:59], a[232:235], v[180:183], v[56:59]
  ds_read_b64_tr_b16 a[232:233], v228 offset:12288
  ds_read_b64_tr_b16 a[234:235], v228 offset:14336
  buffer_store_dwordx4 v[200:203], v225, s[4:7], s21 offen offset:3072 sc1
  v_mfma_f32_16x16x32_bf16 v[60:63], a[192:195], v[164:167], v[60:63]
  v_mfma_f32_16x16x32_bf16 v[60:63], a[196:199], v[180:183], v[60:63]
  buffer_load_dwordx4 a[68:71], v252, s[4:7], s40 offen offset:1024 sc1
  v_mfma_f32_16x16x32_bf16 v[44:47], a[192:195], v[160:163], v[44:47]
  ds_read_b64_tr_b16 a[192:193], v228 offset:24576
  ds_read_b64_tr_b16 a[194:195], v228 offset:26624
  v_mfma_f32_16x16x32_bf16 v[44:47], a[196:199], v[176:179], v[44:47]
  ds_read_b64_tr_b16 a[196:197], v229 offset:12288
  ds_read_b64_tr_b16 a[198:199], v229 offset:14336
  s_waitcnt lgkmcnt(13)
  v_mfma_f32_16x16x32_bf16 v[0:3], a[200:203], v[160:163], v[0:3]
  s_mov_b32 s40, 21102592
  v_mfma_f32_16x16x32_bf16 v[0:3], a[204:207], v[176:179], v[0:3]
  buffer_load_dwordx4 a[72:75], v252, s[4:7], s40 offen offset:0 sc1
  v_mfma_f32_16x16x32_bf16 v[16:19], a[200:203], v[164:167], v[16:19]
  ds_read_b64_tr_b16 a[200:201], v229 offset:24576
  ds_read_b64_tr_b16 a[202:203], v229 offset:26624
  v_mfma_f32_16x16x32_bf16 v[16:19], a[204:207], v[180:183], v[16:19]
  ds_read_b64_tr_b16 a[204:205], v230 offset:12288
  ds_read_b64_tr_b16 a[206:207], v230 offset:14336
  v_mfma_f32_16x16x32_bf16 v[20:23], a[208:211], v[164:167], v[20:23]
  buffer_load_dwordx4 a[76:79], v252, s[4:7], s40 offen offset:1024 sc1
  v_mfma_f32_16x16x32_bf16 v[20:23], a[212:215], v[180:183], v[20:23]
  s_mov_b32 s40, 21233664
  v_mfma_f32_16x16x32_bf16 v[4:7], a[208:211], v[160:163], v[4:7]
  ds_read_b64_tr_b16 a[208:209], v230 offset:24576
  ds_read_b64_tr_b16 a[210:211], v230 offset:26624
  v_mfma_f32_16x16x32_bf16 v[4:7], a[212:215], v[176:179], v[4:7]
  ds_read_b64_tr_b16 a[212:213], v231 offset:12288
  ds_read_b64_tr_b16 a[214:215], v231 offset:14336
  s_waitcnt lgkmcnt(13)
  v_mfma_f32_16x16x32_bf16 v[8:11], a[216:219], v[160:163], v[8:11]
  buffer_load_dwordx4 a[80:83], v252, s[4:7], s40 offen offset:0 sc1
  v_mfma_f32_16x16x32_bf16 v[8:11], a[220:223], v[176:179], v[8:11]
  v_mfma_f32_16x16x32_bf16 v[24:27], a[216:219], v[164:167], v[24:27]
  ds_read_b64_tr_b16 a[216:217], v231 offset:24576
  ds_read_b64_tr_b16 a[218:219], v231 offset:26624
  v_mfma_f32_16x16x32_bf16 v[24:27], a[220:223], v[180:183], v[24:27]
  ds_read_b64_tr_b16 a[220:221], v228 offset:45056
  ds_read_b64_tr_b16 a[222:223], v228 offset:47104
  v_mfma_f32_16x16x32_bf16 v[28:31], a[224:227], v[164:167], v[28:31]
  v_swap_b32 v194, v196
  v_swap_b32 v195, v197
  v_swap_b32 v210, v212
  v_swap_b32 v211, v213
  buffer_load_dwordx4 a[84:87], v252, s[4:7], s40 offen offset:1024 sc1
  v_mfma_f32_16x16x32_bf16 v[28:31], a[228:231], v[180:183], v[28:31]
  s_mov_b32 s40, 21364736
  v_mfma_f32_16x16x32_bf16 v[12:15], a[224:227], v[160:163], v[12:15]
  ds_read_b64_tr_b16 a[224:225], v228 offset:57344
  ds_read_b64_tr_b16 a[226:227], v228 offset:59392
  v_mfma_f32_16x16x32_bf16 v[12:15], a[228:231], v[176:179], v[12:15]
  ds_read_b64_tr_b16 a[228:229], v229 offset:45056
  ds_read_b64_tr_b16 a[230:231], v229 offset:47104
  s_waitcnt lgkmcnt(13)
  v_mfma_f32_16x16x32_bf16 v[32:35], a[232:235], v[192:195], v[32:35]
  buffer_load_dwordx4 a[88:91], v252, s[4:7], s40 offen offset:0 sc1
L_wk2_2:
  s_cbranch_vccnz L_wk2_end
  v_mfma_f32_16x16x32_bf16 v[32:35], a[192:195], v[208:211], v[32:35]
  s_barrier
  v_mfma_f32_16x16x32_bf16 v[48:51], a[232:235], v[196:199], v[48:51]
  ds_read_b64_tr_b16 a[232:233], v229 offset:57344
  ds_read_b64_tr_b16 a[234:235], v229 offset:59392
  v_mfma_f32_16x16x32_bf16 v[48:51], a[192:195], v[212:215], v[48:51]
  ds_read_b64_tr_b16 a[192:193], v230 offset:45056
  ds_read_b64_tr_b16 a[194:195], v230 offset:47104
  v_mfma_f32_16x16x32_bf16 v[52:55], a[196:199], v[196:199], v[52:55]
  buffer_load_dwordx4 a[92:95], v252, s[4:7], s40 offen offset:1024 sc1
  v_mfma_f32_16x16x32_bf16 v[52:55], a[200:203], v[212:215], v[52:55]
  s_mov_b32 s40, 21495808
  v_mfma_f32_16x16x32_bf16 v[36:39], a[196:199], v[192:195], v[36:39]
  ds_read_b64_tr_b16 a[196:197], v230 offset:57344
  ds_read_b64_tr_b16 a[198:199], v230 offset:59392
  v_mfma_f32_16x16x32_bf16 v[36:39], a[200:203], v[208:211], v[36:39]
  buffer_load_dwordx4 a[96:99], v252, s[4:7], s40 offen offset:0 sc1
  s_waitcnt lgkmcnt(13)
  v_mfma_f32_16x16x32_bf16 v[40:43], a[204:207], v[192:195], v[40:43]
  ds_read_b64_tr_b16 a[200:201], v231 offset:45056
  ds_read_b64_tr_b16 a[202:203], v231 offset:47104
  v_mfma_f32_16x16x32_bf16 v[40:43], a[208:211], v[208:211], v[40:43]
  v_mfma_f32_16x16x32_bf16 v[56:59], a[204:207], v[196:199], v[56:59]
  ds_read_b64_tr_b16 a[204:205], v231 offset:57344
  ds_read_b64_tr_b16 a[206:207], v231 offset:59392
  v_mfma_f32_16x16x32_bf16 v[56:59], a[208:211], v[212:215], v[56:59]
  buffer_load_dwordx4 a[100:103], v252, s[4:7], s40 offen offset:1024 sc1
  v_mfma_f32_16x16x32_bf16 v[60:63], a[212:215], v[196:199], v[60:63]
  ds_read_b64_tr_b16 a[208:209], v232 offset:0
  ds_read_b64_tr_b16 a[210:211], v232 offset:2048
  s_waitcnt lgkmcnt(13)
  v_mfma_f32_16x16x32_bf16 v[60:63], a[216:219], v[212:215], v[60:63]
  s_mov_b32 s40, 21626880
  v_mfma_f32_16x16x32_bf16 v[44:47], a[212:215], v[192:195], v[44:47]
  ds_read_b64_tr_b16 a[212:213], v232 offset:28672
  ds_read_b64_tr_b16 a[214:215], v232 offset:30720
  v_mfma_f32_16x16x32_bf16 v[44:47], a[216:219], v[208:211], v[44:47]
  buffer_load_dwordx4 a[104:107], v252, s[4:7], s40 offen offset:0 sc1
  v_mfma_f32_16x16x32_bf16 v[0:3], a[220:223], v[192:195], v[0:3]
  ds_read_b64_tr_b16 a[216:217], v233 offset:0
  ds_read_b64_tr_b16 a[218:219], v233 offset:2048
  v_mfma_f32_16x16x32_bf16 v[0:3], a[224:227], v[208:211], v[0:3]
  v_mfma_f32_16x16x32_bf16 v[16:19], a[220:223], v[196:199], v[16:19]
  ds_read_b64_tr_b16 a[220:221], v233 offset:28672
  ds_read_b64_tr_b16 a[222:223], v233 offset:30720
  v_mfma_f32_16x16x32_bf16 v[16:19], a[224:227], v[212:215], v[16:19]
  buffer_load_dwordx4 a[108:111], v252, s[4:7], s40 offen offset:1024 sc1
  s_waitcnt lgkmcnt(13)
  v_mfma_f32_16x16x32_bf16 v[20:23], a[228:231], v[196:199], v[20:23]
  ds_read_b64_tr_b16 a[224:225], v234 offset:0
  ds_read_b64_tr_b16 a[226:227], v234 offset:2048
  v_mfma_f32_16x16x32_bf16 v[20:23], a[232:235], v[212:215], v[20:23]
  s_mov_b32 s40, 21757952
  v_mfma_f32_16x16x32_bf16 v[4:7], a[228:231], v[192:195], v[4:7]
  ds_read_b64_tr_b16 a[228:229], v234 offset:28672
  ds_read_b64_tr_b16 a[230:231], v234 offset:30720
  v_mfma_f32_16x16x32_bf16 v[4:7], a[232:235], v[208:211], v[4:7]
  buffer_load_dwordx4 a[112:115], v252, s[4:7], s40 offen offset:0 sc1
  v_mfma_f32_16x16x32_bf16 v[8:11], a[192:195], v[192:195], v[8:11]
  ds_read_b64_tr_b16 a[232:233], v235 offset:0
  ds_read_b64_tr_b16 a[234:235], v235 offset:2048
  s_waitcnt lgkmcnt(13)
  v_mfma_f32_16x16x32_bf16 v[8:11], a[196:199], v[208:211], v[8:11]
  v_mfma_f32_16x16x32_bf16 v[24:27], a[192:195], v[196:199], v[24:27]
  buffer_load_dwordx4 a[116:119], v252, s[4:7], s40 offen offset:1024 sc1
  v_mfma_f32_16x16x32_bf16 v[24:27], a[196:199], v[212:215], v[24:27]
  ds_read_b64_tr_b16 a[192:193], v235 offset:28672
  ds_read_b64_tr_b16 a[194:195], v235 offset:30720
  v_mfma_f32_16x16x32_bf16 v[28:31], a[200:203], v[196:199], v[28:31]
  ds_read_b64_tr_b16 a[196:197], v232 offset:40960
  ds_read_b64_tr_b16 a[198:199], v232 offset:43008
  v_mfma_f32_16x16x32_bf16 v[28:31], a[204:207], v[212:215], v[28:31]
  s_mov_b32 s40, 21889024
  v_mfma_f32_16x16x32_bf16 v[12:15], a[200:203], v[192:195], v[12:15]
  buffer_load_dwordx4 a[120:123], v252, s[4:7], s40 offen offset:0 sc1
  v_mfma_f32_16x16x32_bf16 v[12:15], a[204:207], v[208:211], v[12:15]
  ds_read_b64_tr_b16 a[200:201], v232 offset:49152
  ds_read_b64_tr_b16 a[202:203], v232 offset:51200
  s_waitcnt vmcnt(11) lgkmcnt(13)
  v_mfma_f32_16x16x32_bf16 v[32:35], a[208:211], a[64:67], v[32:35]
  ds_read_b64_tr_b16 a[204:205], v233 offset:40960
  ds_read_b64_tr_b16 a[206:207], v233 offset:43008
  v_mfma_f32_16x16x32_bf16 v[32:35], a[212:215], a[72:75], v[32:35]
  s_barrier
  v_mfma_f32_16x16x32_bf16 v[48:51], a[208:211], a[68:71], v[48:51]
  buffer_load_dwordx4 a[124:127], v252, s[4:7], s40 offen offset:1024 sc1
  v_mfma_f32_16x16x32_bf16 v[48:51], a[212:215], a[76:79], v[48:51]
  ds_read_b64_tr_b16 a[208:209], v233 offset:49152
  ds_read_b64_tr_b16 a[210:211], v233 offset:51200
  v_mfma_f32_16x16x32_bf16 v[52:55], a[216:219], a[68:71], v[52:55]
  ds_read_b64_tr_b16 a[212:213], v234 offset:40960
  ds_read_b64_tr_b16 a[214:215], v234 offset:43008
  s_waitcnt lgkmcnt(13)
  v_mfma_f32_16x16x32_bf16 v[52:55], a[220:223], a[76:79], v[52:55]
  s_mov_b32 s40, 22020096
  v_mfma_f32_16x16x32_bf16 v[36:39], a[216:219], a[64:67], v[36:39]
  buffer_load_dwordx4 a[128:131], v252, s[4:7], s40 offen offset:0 sc1
  v_mfma_f32_16x16x32_bf16 v[36:39], a[220:223], a[72:75], v[36:39]
  ds_read_b64_tr_b16 a[216:217], v234 offset:49152
  ds_read_b64_tr_b16 a[218:219], v234 offset:51200
  v_mfma_f32_16x16x32_bf16 v[40:43], a[224:227], a[64:67], v[40:43]
  ds_read_b64_tr_b16 a[220:221], v235 offset:40960
  ds_read_b64_tr_b16 a[222:223], v235 offset:43008
  v_add_u32 v248, 3, v245
  buffer_store_dword v248, v246, s[4:7], s90 offen sc1
  v_mfma_f32_16x16x32_bf16 v[40:43], a[228:231], a[72:75], v[40:43]
  v_mfma_f32_16x16x32_bf16 v[56:59], a[224:227], a[68:71], v[56:59]
  buffer_load_dwordx4 a[132:135], v252, s[4:7], s40 offen offset:1024 sc1
  v_mfma_f32_16x16x32_bf16 v[56:59], a[228:231], a[76:79], v[56:59]
  ds_read_b64_tr_b16 a[224:225], v235 offset:49152
  ds_read_b64_tr_b16 a[226:227], v235 offset:51200
  s_waitcnt lgkmcnt(13)
  v_mfma_f32_16x16x32_bf16 v[60:63], a[232:235], a[68:71], v[60:63]
  ds_read_b64_tr_b16 a[228:229], v228 offset:28672
  ds_read_b64_tr_b16 a[230:231], v228 offset:30720
  v_mfma_f32_16x16x32_bf16 v[60:63], a[192:195], a[76:79], v[60:63]
  s_mov_b32 s40, 22151168
  v_mfma_f32_16x16x32_bf16 v[44:47], a[232:235], a[64:67], v[44:47]
  buffer_load_dwordx4 a[136:139], v252, s[4:7], s40 offen offset:0 sc1
  v_mfma_f32_16x16x32_bf16 v[44:47], a[192:195], a[72:75], v[44:47]
  ds_read_b64_tr_b16 a[232:233], v228 offset:32768
  ds_read_b64_tr_b16 a[234:235], v228 offset:34816
  v_mfma_f32_16x16x32_bf16 v[0:3], a[196:199], a[64:67], v[0:3]
  ds_read_b64_tr_b16 a[192:193], v229 offset:28672
  ds_read_b64_tr_b16 a[194:195], v229 offset:30720
  s_waitcnt lgkmcnt(13)
  v_mfma_f32_16x16x32_bf16 v[0:3], a[200:203], a[72:75], v[0:3]
  buffer_load_dwordx4 a[140:143], v252, s[4:7], s40 offen offset:1024 sc1
  v_mfma_f32_16x16x32_bf16 v[16:19], a[196:199], a[68:71], v[16:19]
  ds_read_b64_tr_b16 a[196:197], v229 offset:32768
  ds_read_b64_tr_b16 a[198:199], v229 offset:34816
  v_mfma_f32_16x16x32_bf16 v[16:19], a[200:203], a[76:79], v[16:19]
  ds_read_b64_tr_b16 a[200:201], v230 offset:28672
  ds_read_b64_tr_b16 a[202:203], v230 offset:30720
  v_mfma_f32_16x16x32_bf16 v[20:23], a[204:207], a[68:71], v[20:23]
  s_mov_b32 s41, 2621440
  s_add_u32 m0, s42, 73728
  v_mfma_f32_16x16x32_bf16 v[20:23], a[208:211], a[76:79], v[20:23]
  buffer_load_dwordx4 v242, s[44:47], s41 offen offset:0 lds
  v_mfma_f32_16x16x32_bf16 v[4:7], a[204:207], a[64:67], v[4:7]
  ds_read_b64_tr_b16 a[204:205], v230 offset:32768
  ds_read_b64_tr_b16 a[206:207], v230 offset:34816
  v_mfma_f32_16x16x32_bf16 v[4:7], a[208:211], a[72:75], v[4:7]
  ds_read_b64_tr_b16 a[208:209], v231 offset:28672
  ds_read_b64_tr_b16 a[210:211], v231 offset:30720
  s_waitcnt lgkmcnt(13)
  v_mfma_f32_16x16x32_bf16 v[8:11], a[212:215], a[64:67], v[8:11]
  s_mov_b32 s41, 2359296
  s_add_u32 m0, s42, 86016
  v_mfma_f32_16x16x32_bf16 v[8:11], a[216:219], a[72:75], v[8:11]
  buffer_load_dwordx4 v253, s[44:47], s41 offen offset:0 lds
  v_mfma_f32_16x16x32_bf16 v[24:27], a[212:215], a[68:71], v[24:27]
  ds_read_b64_tr_b16 a[212:213], v231 offset:32768
  ds_read_b64_tr_b16 a[214:215], v231 offset:34816
  v_mfma_f32_16x16x32_bf16 v[24:27], a[216:219], a[76:79], v[24:27]
  ds_read_b64_tr_b16 a[216:217], v228 offset:40960
  ds_read_b64_tr_b16 a[218:219], v228 offset:43008
  v_mfma_f32_16x16x32_bf16 v[28:31], a[220:223], a[68:71], v[28:31]
  s_mov_b32 s41, 2621440
  s_add_u32 m0, s42, 102400
  v_mfma_f32_16x16x32_bf16 v[28:31], a[224:227], a[76:79], v[28:31]
  buffer_load_dwordx4 v253, s[44:47], s41 offen offset:0 lds
  v_mfma_f32_16x16x32_bf16 v[12:15], a[220:223], a[64:67], v[12:15]
  ds_read_b64_tr_b16 a[220:221], v232 offset:4096
  ds_read_b64_tr_b16 a[222:223], v232 offset:6144
  v_mfma_f32_16x16x32_bf16 v[12:15], a[224:227], a[72:75], v[12:15]
  ds_read_b64_tr_b16 a[224:225], v229 offset:40960
  ds_read_b64_tr_b16 a[226:227], v229 offset:43008
  s_waitcnt vmcnt(16) lgkmcnt(13)
  v_mfma_f32_16x16x32_bf16 v[32:35], a[228:231], a[80:83], v[32:35]
  s_mov_b32 s40, 22282240
  v_mfma_f32_16x16x32_bf16 v[32:35], a[232:235], a[88:91], v[32:35]
  s_barrier
  v_mfma_f32_16x16x32_bf16 v[48:51], a[228:231], a[84:87], v[48:51]
  buffer_load_dwordx4 a[144:147], v252, s[4:7], s40 offen offset:0 sc1
  v_mfma_f32_16x16x32_bf16 v[48:51], a[232:235], a[92:95], v[48:51]
  ds_read_b64_tr_b16 a[228:229], v233 offset:4096
  ds_read_b64_tr_b16 a[230:231], v233 offset:6144
  v_mfma_f32_16x16x32_bf16 v[52:55], a[192:195], a[84:87], v[52:55]
  ds_read_b64_tr_b16 a[232:233], v230 offset:40960
  ds_read_b64_tr_b16 a[234:235], v230 offset:43008
  v_mfma_f32_16x16x32_bf16 v[52:55], a[196:199], a[92:95], v[52:55]
  buffer_load_dwordx4 a[148:151], v252, s[4:7], s40 offen offset:1024 sc1
  v_mfma_f32_16x16x32_bf16 v[36:39], a[192:195], a[80:83], v[36:39]
  ds_read_b64_tr_b16 a[192:193], v234 offset:4096
  ds_read_b64_tr_b16 a[194:195], v234 offset:6144
  v_mfma_f32_16x16x32_bf16 v[36:39], a[196:199], a[88:91], v[36:39]
  ds_read_b64_tr_b16 a[196:197], v231 offset:40960
  ds_read_b64_tr_b16 a[198:199], v231 offset:43008
  s_waitcnt lgkmcnt(13)
  v_mfma_f32_16x16x32_bf16 v[40:43], a[200:203], a[80:83], v[40:43]
  s_mov_b32 s40, 22413312
  v_mfma_f32_16x16x32_bf16 v[40:43], a[204:207], a[88:91], v[40:43]
  buffer_load_dwordx4 a[152:155], v252, s[4:7], s40 offen offset:0 sc1
  v_mfma_f32_16x16x32_bf16 v[56:59], a[200:203], a[84:87], v[56:59]
  ds_read_b64_tr_b16 a[200:201], v235 offset:4096
  ds_read_b64_tr_b16 a[202:203], v235 offset:6144
  v_mfma_f32_16x16x32_bf16 v[56:59], a[204:207], a[92:95], v[56:59]
  ds_read_b64_tr_b16 a[204:205], v232 offset:16384
  ds_read_b64_tr_b16 a[206:207], v232 offset:18432
  v_mfma_f32_16x16x32_bf16 v[60:63], a[208:211], a[84:87], v[60:63]
  v_mfma_f32_16x16x32_bf16 v[60:63], a[212:215], a[92:95], v[60:63]
  buffer_load_dwordx4 a[156:159], v252, s[4:7], s40 offen offset:1024 sc1
  v_mfma_f32_16x16x32_bf16 v[44:47], a[208:211], a[80:83], v[44:47]
  ds_read_b64_tr_b16 a[208:209], v232 offset:24576
  ds_read_b64_tr_b16 a[210:211], v232 offset:26624
  v_mfma_f32_16x16x32_bf16 v[44:47], a[212:215], a[88:91], v[44:47]
  ds_read_b64_tr_b16 a[212:213], v233 offset:16384
  ds_read_b64_tr_b16 a[214:215], v233 offset:18432
  s_waitcnt lgkmcnt(13)
  v_mfma_f32_16x16x32_bf16 v[0:3], a[216:219], a[80:83], v[0:3]
  s_mov_b32 s41, 2752512
  s_add_u32 m0, s42, 98304
  v_mfma_f32_16x16x32_bf16 v[0:3], a[220:223], a[88:91], v[0:3]
  buffer_load_dwordx4 v242, s[44:47], s41 offen offset:0 lds
  v_mfma_f32_16x16x32_bf16 v[16:19], a[216:219], a[84:87], v[16:19]
  ds_read_b64_tr_b16 a[216:217], v233 offset:24576
  ds_read_b64_tr_b16 a[218:219], v233 offset:26624
  v_mfma_f32_16x16x32_bf16 v[16:19], a[220:223], a[92:95], v[16:19]
  ds_read_b64_tr_b16 a[220:221], v234 offset:16384
  ds_read_b64_tr_b16 a[222:223], v234 offset:18432
  v_mfma_f32_16x16x32_bf16 v[20:23], a[224:227], a[84:87], v[20:23]
  s_mov_b32 s41, 3014656
  s_add_u32 m0, s42, 110592
  v_mfma_f32_16x16x32_bf16 v[20:23], a[228:231], a[92:95], v[20:23]
  buffer_load_dwordx4 v242, s[44:47], s41 offen offset:0 lds
  v_mfma_f32_16x16x32_bf16 v[4:7], a[224:227], a[80:83], v[4:7]
  ds_read_b64_tr_b16 a[224:225], v234 offset:24576
  ds_read_b64_tr_b16 a[226:227], v234 offset:26624
  v_mfma_f32_16x16x32_bf16 v[4:7], a[228:231], a[88:91], v[4:7]
  ds_read_b64_tr_b16 a[228:229], v235 offset:16384
  ds_read_b64_tr_b16 a[230:231], v235 offset:18432
  s_waitcnt lgkmcnt(13)
  v_mfma_f32_16x16x32_bf16 v[8:11], a[232:235], a[80:83], v[8:11]
  s_mov_b32 s41, 2752512
  s_add_u32 m0, s42, 126976
  v_mfma_f32_16x16x32_bf16 v[8:11], a[192:195], a[88:91], v[8:11]
  buffer_load_dwordx4 v253, s[44:47], s41 offen offset:0 lds
  v_mfma_f32_16x16x32_bf16 v[24:27], a[232:235], a[84:87], v[24:27]
  ds_read_b64_tr_b16 a[232:233], v235 offset:24576
  ds_read_b64_tr_b16 a[234:235], v235 offset:26624
  v_mfma_f32_16x16x32_bf16 v[24:27], a[192:195], a[92:95], v[24:27]
  ds_read_b64_tr_b16 a[192:193], v232 offset:53248
  ds_read_b64_tr_b16 a[194:195], v232 offset:55296
  v_mfma_f32_16x16x32_bf16 v[28:31], a[196:199], a[84:87], v[28:31]
  s_mov_b32 s41, 3014656
  s_add_u32 m0, s42, 122880
  v_mfma_f32_16x16x32_bf16 v[28:31], a[200:203], a[92:95], v[28:31]
  buffer_load_dwordx4 v253, s[44:47], s41 offen offset:0 lds
  v_mfma_f32_16x16x32_bf16 v[12:15], a[196:199], a[80:83], v[12:15]
  ds_read_b64_tr_b16 a[196:197], v236 offset:0
  ds_read_b64_tr_b16 a[198:199], v236 offset:2048
  v_mfma_f32_16x16x32_bf16 v[12:15], a[200:203], a[88:91], v[12:15]
  ds_read_b64_tr_b16 a[200:201], v233 offset:53248
  ds_read_b64_tr_b16 a[202:203], v233 offset:55296
  s_waitcnt vmcnt(20) lgkmcnt(13)
  v_mfma_f32_16x16x32_bf16 v[32:35], a[204:207], a[96:99], v[32:35]
  s_mov_b32 s40, 22544384
  v_mfma_f32_16x16x32_bf16 v[32:35], a[208:211], a[104:107], v[32:35]
  s_barrier
  v_mfma_f32_16x16x32_bf16 v[48:51], a[204:207], a[100:103], v[48:51]
  buffer_load_dwordx4 a[160:163], v252, s[4:7], s40 offen offset:0 sc1
  v_mfma_f32_16x16x32_bf16 v[48:51], a[208:211], a[108:111], v[48:51]
  ds_read_b64_tr_b16 a[204:205], v237 offset:0
  ds_read_b64_tr_b16 a[206:207], v237 offset:2048
  v_mfma_f32_16x16x32_bf16 v[52:55], a[212:215], a[100:103], v[52:55]
  ds_read_b64_tr_b16 a[208:209], v234 offset:53248
  ds_read_b64_tr_b16 a[210:211], v234 offset:55296
  v_mfma_f32_16x16x32_bf16 v[52:55], a[216:219], a[108:111], v[52:55]
  buffer_load_dwordx4 a[164:167], v252, s[4:7], s40 offen offset:1024 sc1
  v_mfma_f32_16x16x32_bf16 v[36:39], a[212:215], a[96:99], v[36:39]
  ds_read_b64_tr_b16 a[212:213], v238 offset:0
  ds_read_b64_tr_b16 a[214:215], v238 offset:2048
  v_mfma_f32_16x16x32_bf16 v[36:39], a[216:219], a[104:107], v[36:39]
  ds_read_b64_tr_b16 a[216:217], v235 offset:53248
  ds_read_b64_tr_b16 a[218:219], v235 offset:55296
  s_waitcnt lgkmcnt(13)
  v_mfma_f32_16x16x32_bf16 v[40:43], a[220:223], a[96:99], v[40:43]
  s_mov_b32 s40, 22675456
  v_mfma_f32_16x16x32_bf16 v[40:43], a[224:227], a[104:107], v[40:43]
  buffer_load_dwordx4 a[168:171], v252, s[4:7], s40 offen offset:0 sc1
  v_mfma_f32_16x16x32_bf16 v[56:59], a[220:223], a[100:103], v[56:59]
  ds_read_b64_tr_b16 a[220:221], v239 offset:0
  ds_read_b64_tr_b16 a[222:223], v239 offset:2048
  v_mfma_f32_16x16x32_bf16 v[56:59], a[224:227], a[108:111], v[56:59]
  ds_read_b64_tr_b16 a[224:225], v236 offset:8192
  ds_read_b64_tr_b16 a[226:227], v236 offset:10240
  v_mfma_f32_16x16x32_bf16 v[60:63], a[228:231], a[100:103], v[60:63]
  v_mfma_f32_16x16x32_bf16 v[60:63], a[232:235], a[108:111], v[60:63]
  buffer_load_dwordx4 a[172:175], v252, s[4:7], s40 offen offset:1024 sc1
  v_mfma_f32_16x16x32_bf16 v[44:47], a[228:231], a[96:99], v[44:47]
  ds_read_b64_tr_b16 a[228:229], v228 offset:20480
  ds_read_b64_tr_b16 a[230:231], v228 offset:22528
  v_mfma_f32_16x16x32_bf16 v[44:47], a[232:235], a[104:107], v[44:47]
  ds_read_b64_tr_b16 a[232:233], v237 offset:8192
  ds_read_b64_tr_b16 a[234:235], v237 offset:10240
  s_waitcnt lgkmcnt(13)
  v_mfma_f32_16x16x32_bf16 v[0:3], a[192:195], a[96:99], v[0:3]
  s_mov_b32 s41, 3276800
  s_add_u32 m0, s42, 135168
  v_mfma_f32_16x16x32_bf16 v[0:3], a[196:199], a[104:107], v[0:3]
  buffer_load_dwordx4 v242, s[44:47], s41 offen offset:0 lds
  v_mfma_f32_16x16x32_bf16 v[16:19], a[192:195], a[100:103], v[16:19]
  ds_read_b64_tr_b16 a[192:193], v229 offset:20480
  ds_read_b64_tr_b16 a[194:195], v229 offset:22528
  v_mfma_f32_16x16x32_bf16 v[16:19], a[196:199], a[108:111], v[16:19]
  ds_read_b64_tr_b16 a[196:197], v238 offset:8192
  ds_read_b64_tr_b16 a[198:199], v238 offset:10240
  v_mfma_f32_16x16x32_bf16 v[20:23], a[200:203], a[100:103], v[20:23]
  s_mov_b32 s41, 3538944
  s_add_u32 m0, s42, 151552
  v_mfma_f32_16x16x32_bf16 v[20:23], a[204:207], a[108:111], v[20:23]
  buffer_load_dwordx4 v242, s[44:47], s41 offen offset:0 lds
  v_mfma_f32_16x16x32_bf16 v[4:7], a[200:203], a[96:99], v[4:7]
  ds_read_b64_tr_b16 a[200:201], v230 offset:20480
  ds_read_b64_tr_b16 a[202:203], v230 offset:22528
  v_mfma_f32_16x16x32_bf16 v[4:7], a[204:207], a[104:107], v[4:7]
  ds_read_b64_tr_b16 a[204:205], v239 offset:8192
  ds_read_b64_tr_b16 a[206:207], v239 offset:10240
  s_waitcnt lgkmcnt(13)
  v_mfma_f32_16x16x32_bf16 v[8:11], a[208:211], a[96:99], v[8:11]
  s_mov_b32 s41, 3276800
  s_add_u32 m0, s42, 147456
  v_mfma_f32_16x16x32_bf16 v[8:11], a[212:215], a[104:107], v[8:11]
  buffer_load_dwordx4 v253, s[44:47], s41 offen offset:0 lds
  v_mfma_f32_16x16x32_bf16 v[24:27], a[208:211], a[100:103], v[24:27]
  ds_read_b64_tr_b16 a[208:209], v231 offset:20480
  ds_read_b64_tr_b16 a[210:211], v231 offset:22528
  v_mfma_f32_16x16x32_bf16 v[24:27], a[212:215], a[108:111], v[24:27]
  ds_read_b64_tr_b16 a[212:213], v236 offset:12288
  ds_read_b64_tr_b16 a[214:215], v236 offset:14336
  v_mfma_f32_16x16x32_bf16 v[28:31], a[216:219], a[100:103], v[28:31]
  s_mov_b32 s41, 3538944
  s_add_u32 m0, s42, 159744
  v_mfma_f32_16x16x32_bf16 v[28:31], a[220:223], a[108:111], v[28:31]
  buffer_load_dwordx4 v253, s[44:47], s41 offen offset:0 lds
  v_mfma_f32_16x16x32_bf16 v[12:15], a[216:219], a[96:99], v[12:15]
  ds_read_b64_tr_b16 a[216:217], v236 offset:24576
  ds_read_b64_tr_b16 a[218:219], v236 offset:26624
  v_mfma_f32_16x16x32_bf16 v[12:15], a[220:223], a[104:107], v[12:15]
  ds_read_b64_tr_b16 a[220:221], v237 offset:12288
  ds_read_b64_tr_b16 a[222:223], v237 offset:14336
  s_waitcnt vmcnt(24) lgkmcnt(13)
  v_mfma_f32_16x16x32_bf16 v[32:35], a[224:227], a[112:115], v[32:35]
  s_mov_b32 s40, 22806528
  v_mfma_f32_16x16x32_bf16 v[32:35], a[228:231], a[120:123], v[32:35]
  s_barrier
  v_mfma_f32_16x16x32_bf16 v[48:51], a[224:227], a[116:119], v[48:51]
  buffer_load_dwordx4 a[176:179], v252, s[4:7], s40 offen offset:0 sc1
  v_mfma_f32_16x16x32_bf16 v[48:51], a[228:231], a[124:127], v[48:51]
  ds_read_b64_tr_b16 a[224:225], v237 offset:24576
  ds_read_b64_tr_b16 a[226:227], v237 offset:26624
  v_mfma_f32_16x16x32_bf16 v[52:55], a[232:235], a[116:119], v[52:55]
  ds_read_b64_tr_b16 a[228:229], v238 offset:12288
  ds_read_b64_tr_b16 a[230:231], v238 offset:14336
  v_mfma_f32_16x16x32_bf16 v[52:55], a[192:195], a[124:127], v[52:55]
  buffer_load_dwordx4 a[180:183], v252, s[4:7], s40 offen offset:1024 sc1
  v_mfma_f32_16x16x32_bf16 v[36:39], a[232:235], a[112:115], v[36:39]
  ds_read_b64_tr_b16 a[232:233], v238 offset:24576
  ds_read_b64_tr_b16 a[234:235], v238 offset:26624
  v_mfma_f32_16x16x32_bf16 v[36:39], a[192:195], a[120:123], v[36:39]
  ds_read_b64_tr_b16 a[192:193], v239 offset:12288
  ds_read_b64_tr_b16 a[194:195], v239 offset:14336
  s_waitcnt lgkmcnt(13)
  v_mfma_f32_16x16x32_bf16 v[40:43], a[196:199], a[112:115], v[40:43]
  s_mov_b32 s40, 22937600
  v_mfma_f32_16x16x32_bf16 v[40:43], a[200:203], a[120:123], v[40:43]
  buffer_load_dwordx4 a[184:187], v252, s[4:7], s40 offen offset:0 sc1
  v_mfma_f32_16x16x32_bf16 v[56:59], a[196:199], a[116:119], v[56:59]
  ds_read_b64_tr_b16 a[196:197], v239 offset:24576
  ds_read_b64_tr_b16 a[198:199], v239 offset:26624
  v_mfma_f32_16x16x32_bf16 v[56:59], a[200:203], a[124:127], v[56:59]
  ds_read_b64_tr_b16 a[200:201], v228 offset:36864
  ds_read_b64_tr_b16 a[202:203], v228 offset:38912
  v_mfma_f32_16x16x32_bf16 v[60:63], a[204:207], a[116:119], v[60:63]
  v_mfma_f32_16x16x32_bf16 v[60:63], a[208:211], a[124:127], v[60:63]
  buffer_load_dwordx4 a[188:191], v252, s[4:7], s40 offen offset:1024 sc1
  v_mfma_f32_16x16x32_bf16 v[44:47], a[204:207], a[112:115], v[44:47]
  ds_read_b64_tr_b16 a[204:205], v228 offset:53248
  ds_read_b64_tr_b16 a[206:207], v228 offset:55296
  v_mfma_f32_16x16x32_bf16 v[44:47], a[208:211], a[120:123], v[44:47]
  ds_read_b64_tr_b16 a[208:209], v229 offset:36864
  ds_read_b64_tr_b16 a[210:211], v229 offset:38912
  s_waitcnt lgkmcnt(13)
  v_mfma_f32_16x16x32_bf16 v[0:3], a[212:215], a[112:115], v[0:3]
  s_mov_b32 s41, 65536
  s_add_u32 m0, s42, 16384
  v_mfma_f32_16x16x32_bf16 v[0:3], a[216:219], a[120:123], v[0:3]
  buffer_load_dwordx4 v242, s[44:47], s41 offen offset:0 lds
  v_mfma_f32_16x16x32_bf16 v[16:19], a[212:215], a[116:119], v[16:19]
  ds_read_b64_tr_b16 a[212:213], v229 offset:53248
  ds_read_b64_tr_b16 a[214:215], v229 offset:55296
  v_mfma_f32_16x16x32_bf16 v[16:19], a[216:219], a[124:127], v[16:19]
  ds_read_b64_tr_b16 a[216:217], v230 offset:36864
  ds_read_b64_tr_b16 a[218:219], v230 offset:38912
  v_mfma_f32_16x16x32_bf16 v[20:23], a[220:223], a[116:119], v[20:23]
  s_mov_b32 s41, 327680
  s_add_u32 m0, s42, 12288
  v_mfma_f32_16x16x32_bf16 v[20:23], a[224:227], a[124:127], v[20:23]
  buffer_load_dwordx4 v242, s[44:47], s41 offen offset:0 lds
  v_mfma_f32_16x16x32_bf16 v[4:7], a[220:223], a[112:115], v[4:7]
  ds_read_b64_tr_b16 a[220:221], v230 offset:53248
  ds_read_b64_tr_b16 a[222:223], v230 offset:55296
  v_mfma_f32_16x16x32_bf16 v[4:7], a[224:227], a[120:123], v[4:7]
  ds_read_b64_tr_b16 a[224:225], v231 offset:36864
  ds_read_b64_tr_b16 a[226:227], v231 offset:38912
  s_waitcnt lgkmcnt(13)
  v_mfma_f32_16x16x32_bf16 v[8:11], a[228:231], a[112:115], v[8:11]
  s_mov_b32 s41, 65536
  s_add_u32 m0, s42, 24576
  v_mfma_f32_16x16x32_bf16 v[8:11], a[232:235], a[120:123], v[8:11]
  buffer_load_dwordx4 v253, s[44:47], s41 offen offset:0 lds
  v_mfma_f32_16x16x32_bf16 v[24:27], a[228:231], a[116:119], v[24:27]
  ds_read_b64_tr_b16 a[228:229], v231 offset:53248
  ds_read_b64_tr_b16 a[230:231], v231 offset:55296
  v_mfma_f32_16x16x32_bf16 v[24:27], a[232:235], a[124:127], v[24:27]
  ds_read_b64_tr_b16 a[232:233], v228 offset:49152
  ds_read_b64_tr_b16 a[234:235], v228 offset:51200
  v_mfma_f32_16x16x32_bf16 v[28:31], a[192:195], a[116:119], v[28:31]
  s_mov_b32 s41, 327680
  s_add_u32 m0, s42, 45056
  v_mfma_f32_16x16x32_bf16 v[28:31], a[196:199], a[124:127], v[28:31]
  buffer_load_dwordx4 v253, s[44:47], s41 offen offset:0 lds
  v_mfma_f32_16x16x32_bf16 v[12:15], a[192:195], a[112:115], v[12:15]
  ds_read_b64_tr_b16 a[192:193], v228 offset:61440
  ds_read_b64_tr_b16 a[194:195], v228 offset:63488
  v_mfma_f32_16x16x32_bf16 v[12:15], a[196:199], a[120:123], v[12:15]
  ds_read_b64_tr_b16 a[196:197], v229 offset:49152
  ds_read_b64_tr_b16 a[198:199], v229 offset:51200
  s_waitcnt vmcnt(27) lgkmcnt(13)
  v_mfma_f32_16x16x32_bf16 v[32:35], a[200:203], a[128:131], v[32:35]
  s_mov_b32 s41, 589824
  s_add_u32 m0, s42, 57344
  v_mfma_f32_16x16x32_bf16 v[32:35], a[204:207], a[136:139], v[32:35]
  s_waitcnt vmcnt(24)
  s_barrier
  v_mfma_f32_16x16x32_bf16 v[48:51], a[200:203], a[132:135], v[48:51]
  buffer_load_dwordx4 v242, s[44:47], s41 offen offset:0 lds
  v_mfma_f32_16x16x32_bf16 v[48:51], a[204:207], a[140:143], v[48:51]
  ds_read_b64_tr_b16 a[200:201], v229 offset:61440
  ds_read_b64_tr_b16 a[202:203], v229 offset:63488
  v_mfma_f32_16x16x32_bf16 v[52:55], a[208:211], a[132:135], v[52:55]
  ds_read_b64_tr_b16 a[204:205], v230 offset:49152
  ds_read_b64_tr_b16 a[206:207], v230 offset:51200
  v_mfma_f32_16x16x32_bf16 v[52:55], a[212:215], a[140:143], v[52:55]
  s_mov_b32 s41, 851968
  s_add_u32 m0, s42, 65536
  v_mfma_f32_16x16x32_bf16 v[36:39], a[208:211], a[128:131], v[36:39]
  buffer_load_dwordx4 v242, s[44:47], s41 offen offset:0 lds
  v_mfma_f32_16x16x32_bf16 v[36:39], a[212:215], a[136:139], v[36:39]
  ds_read_b64_tr_b16 a[208:209], v230 offset:61440
  ds_read_b64_tr_b16 a[210:211], v230 offset:63488
  s_waitcnt lgkmcnt(13)
  v_mfma_f32_16x16x32_bf16 v[40:43], a[216:219], a[128:131], v[40:43]
  ds_read_b64_tr_b16 a[212:213], v231 offset:49152
  ds_read_b64_tr_b16 a[214:215], v231 offset:51200
  v_mfma_f32_16x16x32_bf16 v[40:43], a[220:223], a[136:139], v[40:43]
  s_mov_b32 s41, 589824
  s_add_u32 m0, s42, 94208
  v_mfma_f32_16x16x32_bf16 v[56:59], a[216:219], a[132:135], v[56:59]
  buffer_load_dwordx4 v253, s[44:47], s41 offen offset:0 lds
  v_mfma_f32_16x16x32_bf16 v[56:59], a[220:223], a[140:143], v[56:59]
  ds_read_b64_tr_b16 a[216:217], v231 offset:61440
  ds_read_b64_tr_b16 a[218:219], v231 offset:63488
  v_mfma_f32_16x16x32_bf16 v[60:63], a[224:227], a[132:135], v[60:63]
  ds_read_b64_tr_b16 a[220:221], v232 offset:12288
  ds_read_b64_tr_b16 a[222:223], v232 offset:14336
  s_waitcnt lgkmcnt(13)
  v_mfma_f32_16x16x32_bf16 v[60:63], a[228:231], a[140:143], v[60:63]
  s_mov_b32 s41, 851968
  s_add_u32 m0, s42, 106496
  v_mfma_f32_16x16x32_bf16 v[44:47], a[224:227], a[128:131], v[44:47]
  buffer_load_dwordx4 v253, s[44:47], s41 offen offset:0 lds
  v_mfma_f32_16x16x32_bf16 v[44:47], a[228:231], a[136:139], v[44:47]
  ds_read_b64_tr_b16 a[224:225], v232 offset:8192
  ds_read_b64_tr_b16 a[226:227], v232 offset:10240
  v_mfma_f32_16x16x32_bf16 v[0:3], a[232:235], a[128:131], v[0:3]
  ds_read_b64_tr_b16 a[228:229], v233 offset:12288
  ds_read_b64_tr_b16 a[230:231], v233 offset:14336
  v_mfma_f32_16x16x32_bf16 v[0:3], a[192:195], a[136:139], v[0:3]
  s_mov_b32 s41, 983040
  s_add_u32 m0, s42, 114688
  v_mfma_f32_16x16x32_bf16 v[16:19], a[232:235], a[132:135], v[16:19]
  buffer_load_dwordx4 v242, s[44:47], s41 offen offset:0 lds
  v_mfma_f32_16x16x32_bf16 v[16:19], a[192:195], a[140:143], v[16:19]
  ds_read_b64_tr_b16 a[232:233], v233 offset:8192
  ds_read_b64_tr_b16 a[234:235], v233 offset:10240
  s_waitcnt lgkmcnt(13)
  v_mfma_f32_16x16x32_bf16 v[20:23], a[196:199], a[132:135], v[20:23]
  ds_read_b64_tr_b16 a[192:193], v234 offset:12288
  ds_read_b64_tr_b16 a[194:195], v234 offset:14336
  v_mfma_f32_16x16x32_bf16 v[20:23], a[200:203], a[140:143], v[20:23]
  s_mov_b32 s41, 1245184
  s_add_u32 m0, s42, 28672
  v_mfma_f32_16x16x32_bf16 v[4:7], a[196:199], a[128:131], v[4:7]
  buffer_load_dwordx4 v242, s[44:47], s41 offen offset:0 lds
  v_mfma_f32_16x16x32_bf16 v[4:7], a[200:203], a[136:139], v[4:7]
  ds_read_b64_tr_b16 a[196:197], v234 offset:8192
  ds_read_b64_tr_b16 a[198:199], v234 offset:10240
  buffer_load_dword v244, v243, s[4:7], s91 offen sc1
  v_mfma_f32_16x16x32_bf16 v[8:11], a[204:207], a[128:131], v[8:11]
  ds_read_b64_tr_b16 a[200:201], v235 offset:12288
  ds_read_b64_tr_b16 a[202:203], v235 offset:14336
  s_waitcnt lgkmcnt(13)
  v_mfma_f32_16x16x32_bf16 v[8:11], a[208:211], a[136:139], v[8:11]
  s_mov_b32 s41, 983040
  s_add_u32 m0, s42, 32768
  v_mfma_f32_16x16x32_bf16 v[24:27], a[204:207], a[132:135], v[24:27]
  buffer_load_dwordx4 v253, s[44:47], s41 offen offset:0 lds
  v_mfma_f32_16x16x32_bf16 v[24:27], a[208:211], a[140:143], v[24:27]
  ds_read_b64_tr_b16 a[204:205], v235 offset:8192
  ds_read_b64_tr_b16 a[206:207], v235 offset:10240
  v_mfma_f32_16x16x32_bf16 v[28:31], a[212:215], a[132:135], v[28:31]
  ds_read_b64_tr_b16 a[208:209], v232 offset:20480
  ds_read_b64_tr_b16 a[210:211], v232 offset:22528
  v_mfma_f32_16x16x32_bf16 v[28:31], a[216:219], a[140:143], v[28:31]
  s_mov_b32 s41, 1245184
  s_add_u32 m0, s42, 40960
  v_mfma_f32_16x16x32_bf16 v[12:15], a[212:215], a[128:131], v[12:15]
  buffer_load_dwordx4 v253, s[44:47], s41 offen offset:0 lds
  v_mfma_f32_16x16x32_bf16 v[12:15], a[216:219], a[136:139], v[12:15]
  ds_read_b64_tr_b16 a[212:213], v232 offset:36864
  ds_read_b64_tr_b16 a[214:215], v232 offset:38912
  s_waitcnt vmcnt(29) lgkmcnt(13)
  v_mfma_f32_16x16x32_bf16 v[32:35], a[220:223], a[144:147], v[32:35]
  ds_read_b64_tr_b16 a[216:217], v233 offset:20480
  ds_read_b64_tr_b16 a[218:219], v233 offset:22528
  v_mfma_f32_16x16x32_bf16 v[32:35], a[224:227], a[152:155], v[32:35]
  s_waitcnt vmcnt(25)
L_wk2_3:
  s_cbranch_vccnz L_wk2_end
  s_barrier
  v_mfma_f32_16x16x32_bf16 v[48:51], a[220:223], a[148:151], v[48:51]
  ds_read_b64_tr_b16 a[220:221], v233 offset:36864
  ds_read_b64_tr_b16 a[222:223], v233 offset:38912
  v_mfma_f32_16x16x32_bf16 v[48:51], a[224:227], a[156:159], v[48:51]
  ds_read_b64_tr_b16 a[224:225], v234 offset:20480
  ds_read_b64_tr_b16 a[226:227], v234 offset:22528
  v_mfma_f32_16x16x32_bf16 v[52:55], a[228:231], a[148:151], v[52:55]
  s_mov_b32 s41, 1507328
  s_add_u32 m0, s42, 69632
  s_waitcnt lgkmcnt(13)
  v_mfma_f32_16x16x32_bf16 v[52:55], a[232:235], a[156:159], v[52:55]
  buffer_load_dwordx4 v242, s[44:47], s41 offen offset:0 lds
  v_mfma_f32_16x16x32_bf16 v[36:39], a[228:231], a[144:147], v[36:39]
  ds_read_b64_tr_b16 a[228:229], v234 offset:36864
  ds_read_b64_tr_b16 a[230:231], v234 offset:38912
  v_mfma_f32_16x16x32_bf16 v[36:39], a[232:235], a[152:155], v[36:39]
  ds_read_b64_tr_b16 a[232:233], v235 offset:20480
  ds_read_b64_tr_b16 a[234:235], v235 offset:22528
  v_mfma_f32_16x16x32_bf16 v[40:43], a[192:195], a[144:147], v[40:43]
  s_mov_b32 s41, 1769472
  s_add_u32 m0, s42, 81920
  v_mfma_f32_16x16x32_bf16 v[40:43], a[196:199], a[152:155], v[40:43]
  buffer_load_dwordx4 v242, s[44:47], s41 offen offset:0 lds
  v_mfma_f32_16x16x32_bf16 v[56:59], a[192:195], a[148:151], v[56:59]
  ds_read_b64_tr_b16 a[192:193], v235 offset:36864
  ds_read_b64_tr_b16 a[194:195], v235 offset:38912
  v_mfma_f32_16x16x32_bf16 v[56:59], a[196:199], a[156:159], v[56:59]
  ds_read_b64_tr_b16 a[196:197], v232 offset:32768
  ds_read_b64_tr_b16 a[198:199], v232 offset:34816
  s_waitcnt lgkmcnt(13)
  v_mfma_f32_16x16x32_bf16 v[60:63], a[200:203], a[148:151], v[60:63]
  s_mov_b32 s41, 1507328
  s_add_u32 m0, s42, 90112
  v_mfma_f32_16x16x32_bf16 v[60:63], a[204:207], a[156:159], v[60:63]
  buffer_load_dwordx4 v253, s[44:47], s41 offen offset:0 lds
  v_mfma_f32_16x16x32_bf16 v[44:47], a[200:203], a[144:147], v[44:47]
  ds_read_b64_tr_b16 a[200:201], v232 offset:45056
  ds_read_b64_tr_b16 a[202:203], v232 offset:47104
  v_mfma_f32_16x16x32_bf16 v[44:47], a[204:207], a[152:155], v[44:47]
  ds_read_b64_tr_b16 a[204:205], v233 offset:32768
  ds_read_b64_tr_b16 a[206:207], v233 offset:34816
  v_mfma_f32_16x16x32_bf16 v[0:3], a[208:211], a[144:147], v[0:3]
  s_mov_b32 s41, 1769472
  s_add_u32 m0, s42, 118784
  v_mfma_f32_16x16x32_bf16 v[0:3], a[212:215], a[152:155], v[0:3]
  buffer_load_dwordx4 v253, s[44:47], s41 offen offset:0 lds
  v_mfma_f32_16x16x32_bf16 v[16:19], a[208:211], a[148:151], v[16:19]
  ds_read_b64_tr_b16 a[208:209], v233 offset:45056
  ds_read_b64_tr_b16 a[210:211], v233 offset:47104
  v_mfma_f32_16x16x32_bf16 v[16:19], a[212:215], a[156:159], v[16:19]
  ds_read_b64_tr_b16 a[212:213], v234 offset:32768
  ds_read_b64_tr_b16 a[214:215], v234 offset:34816
  s_waitcnt lgkmcnt(13)
  v_mfma_f32_16x16x32_bf16 v[20:23], a[216:219], a[148:151], v[20:23]
  s_mov_b32 s41, 1900544
  s_add_u32 m0, s42, 131072
  v_mfma_f32_16x16x32_bf16 v[20:23], a[220:223], a[156:159], v[20:23]
  buffer_load_dwordx4 v242, s[44:47], s41 offen offset:0 lds
  v_mfma_f32_16x16x32_bf16 v[4:7], a[216:219], a[144:147], v[4:7]
  ds_read_b64_tr_b16 a[216:217], v234 offset:45056
  ds_read_b64_tr_b16 a[218:219], v234 offset:47104
  v_mfma_f32_16x16x32_bf16 v[4:7], a[220:223], a[152:155], v[4:7]
  ds_read_b64_tr_b16 a[220:221], v235 offset:32768
  ds_read_b64_tr_b16 a[222:223], v235 offset:34816
  v_mfma_f32_16x16x32_bf16 v[8:11], a[224:227], a[144:147], v[8:11]
  s_mov_b32 s41, 2162688
  s_add_u32 m0, s42, 139264
  v_mfma_f32_16x16x32_bf16 v[8:11], a[228:231], a[152:155], v[8:11]
  buffer_load_dwordx4 v242, s[44:47], s41 offen offset:0 lds
  v_mfma_f32_16x16x32_bf16 v[24:27], a[224:227], a[148:151], v[24:27]
  ds_read_b64_tr_b16 a[224:225], v235 offset:45056
  ds_read_b64_tr_b16 a[226:227], v235 offset:47104
  v_mfma_f32_16x16x32_bf16 v[24:27], a[228:231], a[156:159], v[24:27]
  ds_read_b64_tr_b16 a[228:229], v232 offset:61440
  ds_read_b64_tr_b16 a[230:231], v232 offset:63488
  s_waitcnt lgkmcnt(13)
  v_mfma_f32_16x16x32_bf16 v[28:31], a[232:235], a[148:151], v[28:31]
  s_mov_b32 s41, 2424832
  s_add_u32 m0, s42, 20480
  v_mfma_f32_16x16x32_bf16 v[28:31], a[192:195], a[156:159], v[28:31]
  buffer_load_dwordx4 v242, s[44:47], s41 offen offset:0 lds
  v_mfma_f32_16x16x32_bf16 v[12:15], a[232:235], a[144:147], v[12:15]
  ds_read_b64_tr_b16 a[232:233], v232 offset:57344
  ds_read_b64_tr_b16 a[234:235], v232 offset:59392
  v_mfma_f32_16x16x32_bf16 v[12:15], a[192:195], a[152:155], v[12:15]
  ds_read_b64_tr_b16 a[192:193], v233 offset:61440
  ds_read_b64_tr_b16 a[194:195], v233 offset:63488
  s_waitcnt vmcnt(9)
  v_subrev_u32 v244, s100, v244
  v_mfma_f32_16x16x32_bf16 v[32:35], a[196:199], a[160:163], v[32:35]
  s_mov_b32 s41, 2686976
  s_add_u32 m0, s42, 143360
  v_subrev_u32 v244, 3, v244
  v_cmp_lt_u32 s[68:69], 4, v244
  v_mfma_f32_16x16x32_bf16 v[32:35], a[200:203], a[168:171], v[32:35]
  s_barrier
  s_cmp_lg_u64 s[68:69], 0
  s_cbranch_scc1 L_slow_50
L_back_51:
  v_mfma_f32_16x16x32_bf16 v[48:51], a[196:199], a[164:167], v[48:51]
  buffer_load_dwordx4 v242, s[44:47], s41 offen offset:0 lds
  v_mfma_f32_16x16x32_bf16 v[48:51], a[200:203], a[172:175], v[48:51]
  ds_read_b64_tr_b16 a[196:197], v233 offset:57344
  ds_read_b64_tr_b16 a[198:199], v233 offset:59392
  s_waitcnt lgkmcnt(13)
  v_mfma_f32_16x16x32_bf16 v[52:55], a[204:207], a[164:167], v[52:55]
  ds_read_b64_tr_b16 a[200:201], v234 offset:61440
  ds_read_b64_tr_b16 a[202:203], v234 offset:63488
  v_mfma_f32_16x16x32_bf16 v[52:55], a[208:211], a[172:175], v[52:55]
  s_mov_b32 s40, 23068672
  v_mfma_f32_16x16x32_bf16 v[36:39], a[204:207], a[160:163], v[36:39]
  buffer_load_dwordx4 a[0:3], v252, s[4:7], s40 offen offset:0 sc1
  v_mfma_f32_16x16x32_bf16 v[36:39], a[208:211], a[168:171], v[36:39]
  ds_read_b64_tr_b16 a[204:205], v234 offset:57344
  ds_read_b64_tr_b16 a[206:207], v234 offset:59392
  v_mfma_f32_16x16x32_bf16 v[40:43], a[212:215], a[160:163], v[40:43]
  ds_read_b64_tr_b16 a[208:209], v235 offset:61440
  ds_read_b64_tr_b16 a[210:211], v235 offset:63488
  s_waitcnt lgkmcnt(13)
  v_mfma_f32_16x16x32_bf16 v[40:43], a[216:219], a[168:171], v[40:43]
  buffer_load_dwordx4 a[4:7], v252, s[4:7], s40 offen offset:1024 sc1
  v_mfma_f32_16x16x32_bf16 v[56:59], a[212:215], a[164:167], v[56:59]
  ds_read_b64_tr_b16 a[212:213], v235 offset:57344
  ds_read_b64_tr_b16 a[214:215], v235 offset:59392
  v_mfma_f32_16x16x32_bf16 v[56:59], a[216:219], a[172:175], v[56:59]
  ds_read_b64_tr_b16 a[216:217], v236 offset:4096
  ds_read_b64_tr_b16 a[218:219], v236 offset:6144
  v_mfma_f32_16x16x32_bf16 v[60:63], a[220:223], a[164:167], v[60:63]
  s_mov_b32 s40, 23199744
  v_mfma_f32_16x16x32_bf16 v[60:63], a[224:227], a[172:175], v[60:63]
  buffer_load_dwordx4 a[8:11], v252, s[4:7], s40 offen offset:0 sc1
  v_mfma_f32_16x16x32_bf16 v[44:47], a[220:223], a[160:163], v[44:47]
  ds_read_b64_tr_b16 a[220:221], v236 offset:20480
  ds_read_b64_tr_b16 a[222:223], v236 offset:22528
  v_mfma_f32_16x16x32_bf16 v[44:47], a[224:227], a[168:171], v[44:47]
  ds_read_b64_tr_b16 a[224:225], v237 offset:4096
  ds_read_b64_tr_b16 a[226:227], v237 offset:6144
  s_waitcnt lgkmcnt(13)
  v_mfma_f32_16x16x32_bf16 v[0:3], a[228:231], a[160:163], v[0:3]
  v_mfma_f32_16x16x32_bf16 v[0:3], a[232:235], a[168:171], v[0:3]
  buffer_load_dwordx4 a[12:15], v252, s[4:7], s40 offen offset:1024 sc1
  v_mfma_f32_16x16x32_bf16 v[16:19], a[228:231], a[164:167], v[16:19]
  ds_read_b64_tr_b16 a[228:229], v237 offset:20480
  ds_read_b64_tr_b16 a[230:231], v237 offset:22528
  v_mfma_f32_16x16x32_bf16 v[16:19], a[232:235], a[172:175], v[16:19]
  ds_read_b64_tr_b16 a[232:233], v238 offset:4096
  ds_read_b64_tr_b16 a[234:235], v238 offset:6144
  v_mfma_f32_16x16x32_bf16 v[20:23], a[192:195], a[164:167], v[20:23]
  s_mov_b32 s40, 23330816
  v_mfma_f32_16x16x32_bf16 v[20:23], a[196:199], a[172:175], v[20:23]
  buffer_load_dwordx4 a[16:19], v252, s[4:7], s40 offen offset:0 sc1
  v_mfma_f32_16x16x32_bf16 v[4:7], a[192:195], a[160:163], v[4:7]
  ds_read_b64_tr_b16 a[192:193], v238 offset:20480
  ds_read_b64_tr_b16 a[194:195], v238 offset:22528
  v_mfma_f32_16x16x32_bf16 v[4:7], a[196:199], a[168:171], v[4:7]
  ds_read_b64_tr_b16 a[196:197], v239 offset:4096
  ds_read_b64_tr_b16 a[198:199], v239 offset:6144
  s_waitcnt lgkmcnt(13)
  v_mfma_f32_16x16x32_bf16 v[8:11], a[200:203], a[160:163], v[8:11]
  v_mfma_f32_16x16x32_bf16 v[8:11], a[204:207], a[168:171], v[8:11]
  buffer_load_dwordx4 a[20:23], v252, s[4:7], s40 offen offset:1024 sc1
  v_mfma_f32_16x16x32_bf16 v[24:27], a[200:203], a[164:167], v[24:27]
  ds_read_b64_tr_b16 a[200:201], v239 offset:20480
  ds_read_b64_tr_b16 a[202:203], v239 offset:22528
  v_mfma_f32_16x16x32_bf16 v[24:27], a[204:207], a[172:175], v[24:27]
  ds_read_b64_tr_b16 a[204:205], v236 offset:16384
  ds_read_b64_tr_b16 a[206:207], v236 offset:18432
  v_mfma_f32_16x16x32_bf16 v[28:31], a[208:211], a[164:167], v[28:31]
  s_mov_b32 s40, 23461888
  v_mfma_f32_16x16x32_bf16 v[28:31], a[212:215], a[172:175], v[28:31]
  buffer_load_dwordx4 a[24:27], v252, s[4:7], s40 offen offset:0 sc1
  v_mfma_f32_16x16x32_bf16 v[12:15], a[208:211], a[160:163], v[12:15]
  ds_read_b64_tr_b16 a[208:209], v236 offset:28672
  ds_read_b64_tr_b16 a[210:211], v236 offset:30720
  v_mfma_f32_16x16x32_bf16 v[12:15], a[212:215], a[168:171], v[12:15]
  ds_read_b64_tr_b16 a[212:213], v237 offset:16384
  ds_read_b64_tr_b16 a[214:215], v237 offset:18432
  s_waitcnt lgkmcnt(13)
  v_mfma_f32_16x16x32_bf16 v[32:35], a[216:219], a[176:179], v[32:35]
  buffer_load_dwordx4 a[28:31], v252, s[4:7], s40 offen offset:1024 sc1
  v_mfma_f32_16x16x32_bf16 v[32:35], a[220:223], a[184:187], v[32:35]
  s_barrier
  v_mfma_f32_16x16x32_bf16 v[48:51], a[216:219], a[180:183], v[48:51]
  ds_read_b64_tr_b16 a[216:217], v237 offset:28672
  ds_read_b64_tr_b16 a[218:219], v237 offset:30720
  v_mfma_f32_16x16x32_bf16 v[48:51], a[220:223], a[188:191], v[48:51]
  ds_read_b64_tr_b16 a[220:221], v238 offset:16384
  ds_read_b64_tr_b16 a[222:223], v238 offset:18432
  v_mfma_f32_16x16x32_bf16 v[52:55], a[224:227], a[180:183], v[52:55]
  s_mov_b32 s40, 23592960
  v_mfma_f32_16x16x32_bf16 v[52:55], a[228:231], a[188:191], v[52:55]
  buffer_load_dwordx4 a[32:35], v252, s[4:7], s40 offen offset:0 sc1
  v_mfma_f32_16x16x32_bf16 v[36:39], a[224:227], a[176:179], v[36:39]
  ds_read_b64_tr_b16 a[224:225], v238 offset:28672
  ds_read_b64_tr_b16 a[226:227], v238 offset:30720
  v_mfma_f32_16x16x32_bf16 v[36:39], a[228:231], a[184:187], v[36:39]
  ds_read_b64_tr_b16 a[228:229], v239 offset:16384
  ds_read_b64_tr_b16 a[230:231], v239 offset:18432
  s_waitcnt lgkmcnt(13)
  v_mfma_f32_16x16x32_bf16 v[40:43], a[232:235], a[176:179], v[40:43]
  buffer_load_dwordx4 a[36:39], v252, s[4:7], s40 offen offset:1024 sc1
  v_mfma_f32_16x16x32_bf16 v[40:43], a[192:195], a[184:187], v[40:43]
  s_mov_b32 s40, 23724032
  v_mfma_f32_16x16x32_bf16 v[56:59], a[232:235], a[180:183], v[56:59]
  ds_read_b64_tr_b16 a[232:233], v239 offset:28672
  ds_read_b64_tr_b16 a[234:235], v239 offset:30720
  v_mfma_f32_16x16x32_bf16 v[56:59], a[192:195], a[188:191], v[56:59]
  ds_read_b64_tr_b16 a[192:193], v228 offset:16384
  ds_read_b64_tr_b16 a[194:195], v228 offset:18432
  v_mfma_f32_16x16x32_bf16 v[60:63], a[196:199], a[180:183], v[60:63]
  buffer_load_dwordx4 a[40:43], v252, s[4:7], s40 offen offset:0 sc1
  v_mfma_f32_16x16x32_bf16 v[60:63], a[200:203], a[188:191], v[60:63]
  v_mfma_f32_16x16x32_bf16 v[44:47], a[196:199], a[176:179], v[44:47]
  ds_read_b64_tr_b16 a[196:197], v228 offset:12288
  ds_read_b64_tr_b16 a[198:199], v228 offset:14336
  v_mfma_f32_16x16x32_bf16 v[44:47], a[200:203], a[184:187], v[44:47]
  ds_read_b64_tr_b16 a[200:201], v229 offset:16384
  ds_read_b64_tr_b16 a[202:203], v229 offset:18432
  s_waitcnt lgkmcnt(13)
  v_mfma_f32_16x16x32_bf16 v[0:3], a[204:207], a[176:179], v[0:3]
  buffer_load_dwordx4 a[44:47], v252, s[4:7], s40 offen offset:1024 sc1
  v_mfma_f32_16x16x32_bf16 v[0:3], a[208:211], a[184:187], v[0:3]
  s_mov_b32 s40, 23855104
  v_mfma_f32_16x16x32_bf16 v[16:19], a[204:207], a[180:183], v[16:19]
  ds_read_b64_tr_b16 a[204:205], v229 offset:12288
  ds_read_b64_tr_b16 a[206:207], v229 offset:14336
  v_mfma_f32_16x16x32_bf16 v[16:19], a[208:211], a[188:191], v[16:19]
  ds_read_b64_tr_b16 a[208:209], v230 offset:16384
  ds_read_b64_tr_b16 a[210:211], v230 offset:18432
  v_mfma_f32_16x16x32_bf16 v[20:23], a[212:215], a[180:183], v[20:23]
  buffer_load_dwordx4 a[48:51], v252, s[4:7], s40 offen offset:0 sc1
  v_mfma_f32_16x16x32_bf16 v[20:23], a[216:219], a[188:191], v[20:23]
  v_mfma_f32_16x16x32_bf16 v[4:7], a[212:215], a[176:179], v[4:7]
  ds_read_b64_tr_b16 a[212:213], v230 offset:12288
  ds_read_b64_tr_b16 a[214:215], v230 offset:14336
  v_mfma_f32_16x16x32_bf16 v[4:7], a[216:219], a[184:187], v[4:7]
  ds_read_b64_tr_b16 a[216:217], v231 offset:16384
  ds_read_b64_tr_b16 a[218:219], v231 offset:18432
  s_waitcnt lgkmcnt(13)
  v_mfma_f32_16x16x32_bf16 v[8:11], a[220:223], a[176:179], v[8:11]
  buffer_load_dwordx4 a[52:55], v252, s[4:7], s40 offen offset:1024 sc1
  v_mfma_f32_16x16x32_bf16 v[8:11], a[224:227], a[184:187], v[8:11]
  s_mov_b32 s40, 23986176
  v_mfma_f32_16x16x32_bf16 v[24:27], a[220:223], a[180:183], v[24:27]
  ds_read_b64_tr_b16 a[220:221], v231 offset:12288
  ds_read_b64_tr_b16 a[222:223], v231 offset:14336
  v_mfma_f32_16x16x32_bf16 v[24:27], a[224:227], a[188:191], v[24:27]
  buffer_load_dwordx4 a[56:59], v252, s[4:7], s40 offen offset:0 sc1
  v_mfma_f32_16x16x32_bf16 v[28:31], a[228:231], a[180:183], v[28:31]
  ds_read_b64_tr_b16 a[224:225], v228 offset:24576
  ds_read_b64_tr_b16 a[226:227], v228 offset:26624
  v_mfma_f32_16x16x32_bf16 v[28:31], a[232:235], a[188:191], v[28:31]
  v_mfma_f32_16x16x32_bf16 v[12:15], a[228:231], a[176:179], v[12:15]
  ds_read_b64_tr_b16 a[228:229], v228 offset:45056
  ds_read_b64_tr_b16 a[230:231], v228 offset:47104
  v_mfma_f32_16x16x32_bf16 v[12:15], a[232:235], a[184:187], v[12:15]
  buffer_load_dwordx4 a[60:63], v252, s[4:7], s40 offen offset:1024 sc1
  s_waitcnt vmcnt(12) lgkmcnt(13)
  v_mfma_f32_16x16x32_bf16 v[32:35], a[192:195], a[0:3], v[32:35]
  ds_read_b64_tr_b16 a[232:233], v229 offset:24576
  ds_read_b64_tr_b16 a[234:235], v229 offset:26624
  v_mfma_f32_16x16x32_bf16 v[32:35], a[196:199], a[8:11], v[32:35]
  s_barrier
  v_mfma_f32_16x16x32_bf16 v[48:51], a[192:195], a[4:7], v[48:51]
  ds_read_b64_tr_b16 a[192:193], v229 offset:45056
  ds_read_b64_tr_b16 a[194:195], v229 offset:47104
  v_mfma_f32_16x16x32_bf16 v[48:51], a[196:199], a[12:15], v[48:51]
  ds_read_b64_tr_b16 a[196:197], v230 offset:24576
  ds_read_b64_tr_b16 a[198:199], v230 offset:26624
  v_mfma_f32_16x16x32_bf16 v[52:55], a[200:203], a[4:7], v[52:55]
  s_mov_b32 s40, 24117248
  s_waitcnt lgkmcnt(13)
  v_mfma_f32_16x16x32_bf16 v[52:55], a[204:207], a[12:15], v[52:55]
  buffer_load_dwordx4 a[64:67], v252, s[4:7], s40 offen offset:0 sc1
  v_mfma_f32_16x16x32_bf16 v[36:39], a[200:203], a[0:3], v[36:39]
  ds_read_b64_tr_b16 a[200:201], v230 offset:45056
  ds_read_b64_tr_b16 a[202:203], v230 offset:47104
  v_mfma_f32_16x16x32_bf16 v[36:39], a[204:207], a[8:11], v[36:39]
  ds_read_b64_tr_b16 a[204:205], v231 offset:24576
  ds_read_b64_tr_b16 a[206:207], v231 offset:26624
  v_mfma_f32_16x16x32_bf16 v[40:43], a[208:211], a[0:3], v[40:43]
  buffer_load_dwordx4 a[68:71], v252, s[4:7], s40 offen offset:1024 sc1
  v_mfma_f32_16x16x32_bf16 v[40:43], a[212:215], a[8:11], v[40:43]
  s_mov_b32 s40, 24248320
  v_mfma_f32_16x16x32_bf16 v[56:59], a[208:211], a[4:7], v[56:59]
  ds_read_b64_tr_b16 a[208:209], v231 offset:45056
  ds_read_b64_tr_b16 a[210:211], v231 offset:47104
  v_mfma_f32_16x16x32_bf16 v[56:59], a[212:215], a[12:15], v[56:59]
  ds_read_b64_tr_b16 a[212:213], v228 offset:57344
  ds_read_b64_tr_b16 a[214:215], v228 offset:59392
  s_waitcnt lgkmcnt(13)
  v_mfma_f32_16x16x32_bf16 v[60:63], a[216:219], a[4:7], v[60:63]
  buffer_load_dwordx4 a[72:75], v252, s[4:7], s40 offen offset:0 sc1
  v_mfma_f32_16x16x32_bf16 v[60:63], a[220:223], a[12:15], v[60:63]
  v_mfma_f32_16x16x32_bf16 v[44:47], a[216:219], a[0:3], v[44:47]
  ds_read_b64_tr_b16 a[216:217], v232 offset:0
  ds_read_b64_tr_b16 a[218:219], v232 offset:2048
  v_mfma_f32_16x16x32_bf16 v[44:47], a[220:223], a[8:11], v[44:47]
  ds_read_b64_tr_b16 a[220:221], v229 offset:57344
  ds_read_b64_tr_b16 a[222:223], v229 offset:59392
  v_mfma_f32_16x16x32_bf16 v[0:3], a[224:227], a[0:3], v[0:3]
  buffer_load_dwordx4 a[76:79], v252, s[4:7], s40 offen offset:1024 sc1
  v_mfma_f32_16x16x32_bf16 v[0:3], a[228:231], a[8:11], v[0:3]
  s_mov_b32 s41, 2818048
  s_add_u32 m0, s42, 155648
  v_mfma_f32_16x16x32_bf16 v[16:19], a[224:227], a[4:7], v[16:19]
  ds_read_b64_tr_b16 a[224:225], v233 offset:0
  ds_read_b64_tr_b16 a[226:227], v233 offset:2048
  v_mfma_f32_16x16x32_bf16 v[16:19], a[228:231], a[12:15], v[16:19]
  ds_read_b64_tr_b16 a[228:229], v230 offset:57344
  ds_read_b64_tr_b16 a[230:231], v230 offset:59392
  s_waitcnt lgkmcnt(13)
  v_mfma_f32_16x16x32_bf16 v[20:23], a[232:235], a[4:7], v[20:23]
  buffer_load_dwordx4 v242, s[44:47], s41 offen offset:0 lds
  v_mfma_f32_16x16x32_bf16 v[20:23], a[192:195], a[12:15], v[20:23]
  s_mov_b32 s41, 3080192
  s_add_u32 m0, s42, 36864
  v_mfma_f32_16x16x32_bf16 v[4:7], a[232:235], a[0:3], v[4:7]
  ds_read_b64_tr_b16 a[232:233], v234 offset:0
  ds_read_b64_tr_b16 a[234:235], v234 offset:2048
  v_mfma_f32_16x16x32_bf16 v[4:7], a[192:195], a[8:11], v[4:7]
  ds_read_b64_tr_b16 a[192:193], v231 offset:57344
  ds_read_b64_tr_b16 a[194:195], v231 offset:59392
  v_mfma_f32_16x16x32_bf16 v[8:11], a[196:199], a[0:3], v[8:11]
  buffer_load_dwordx4 v242, s[44:47], s41 offen offset:0 lds
  v_mfma_f32_16x16x32_bf16 v[8:11], a[200:203], a[8:11], v[8:11]
  s_mov_b32 s41, 3342336
  s_add_u32 m0, s42, 53248
  v_mfma_f32_16x16x32_bf16 v[24:27], a[196:199], a[4:7], v[24:27]
  ds_read_b64_tr_b16 a[196:197], v235 offset:0
  ds_read_b64_tr_b16 a[198:199], v235 offset:2048
  v_mfma_f32_16x16x32_bf16 v[24:27], a[200:203], a[12:15], v[24:27]
  buffer_load_dwordx4 v242, s[44:47], s41 offen offset:0 lds
  s_waitcnt lgkmcnt(13)
  v_mfma_f32_16x16x32_bf16 v[28:31], a[204:207], a[4:7], v[28:31]
  ds_read_b64_tr_b16 a[200:201], v232 offset:28672
  ds_read_b64_tr_b16 a[202:203], v232 offset:30720
  v_mfma_f32_16x16x32_bf16 v[28:31], a[208:211], a[12:15], v[28:31]
  s_mov_b32 s41, 3604480
  s_add_u32 m0, s42, 49152
  v_mfma_f32_16x16x32_bf16 v[12:15], a[204:207], a[0:3], v[12:15]
  ds_read_b64_tr_b16 a[204:205], v232 offset:40960
  ds_read_b64_tr_b16 a[206:207], v232 offset:43008
  v_mfma_f32_16x16x32_bf16 v[12:15], a[208:211], a[8:11], v[12:15]
  buffer_load_dwordx4 v242, s[44:47], s41 offen offset:0 lds
  s_waitcnt vmcnt(16)
  v_mfma_f32_16x16x32_bf16 v[32:35], a[212:215], a[16:19], v[32:35]
  ds_read_b64_tr_b16 a[208:209], v233 offset:28672
  ds_read_b64_tr_b16 a[210:211], v233 offset:30720
  s_waitcnt lgkmcnt(13)
  v_mfma_f32_16x16x32_bf16 v[32:35], a[216:219], a[24:27], v[32:35]
  s_barrier
  v_mfma_f32_16x16x32_bf16 v[48:51], a[212:215], a[20:23], v[48:51]
  ds_read_b64_tr_b16 a[212:213], v233 offset:40960
  ds_read_b64_tr_b16 a[214:215], v233 offset:43008
  v_mfma_f32_16x16x32_bf16 v[48:51], a[216:219], a[28:31], v[48:51]
  ds_read_b64_tr_b16 a[216:217], v234 offset:28672
  ds_read_b64_tr_b16 a[218:219], v234 offset:30720
  v_mfma_f32_16x16x32_bf16 v[52:55], a[220:223], a[20:23], v[52:55]
  s_mov_b32 s40, 24379392
  v_mfma_f32_16x16x32_bf16 v[52:55], a[224:227], a[28:31], v[52:55]
  buffer_load_dwordx4 a[80:83], v252, s[4:7], s40 offen offset:0 sc1
  v_mfma_f32_16x16x32_bf16 v[36:39], a[220:223], a[16:19], v[36:39]
  ds_read_b64_tr_b16 a[220:221], v234 offset:40960
  ds_read_b64_tr_b16 a[222:223], v234 offset:43008
  v_mfma_f32_16x16x32_bf16 v[36:39], a[224:227], a[24:27], v[36:39]
  ds_read_b64_tr_b16 a[224:225], v235 offset:28672
  ds_read_b64_tr_b16 a[226:227], v235 offset:30720
  s_waitcnt lgkmcnt(13)
  v_mfma_f32_16x16x32_bf16 v[40:43], a[228:231], a[16:19], v[40:43]
  buffer_load_dwordx4 a[84:87], v252, s[4:7], s40 offen offset:1024 sc1
  v_mfma_f32_16x16x32_bf16 v[40:43], a[232:235], a[24:27], v[40:43]
  s_mov_b32 s40, 24510464
  v_mfma_f32_16x16x32_bf16 v[56:59], a[228:231], a[20:23], v[56:59]
  ds_read_b64_tr_b16 a[228:229], v235 offset:40960
  ds_read_b64_tr_b16 a[230:231], v235 offset:43008
  v_mfma_f32_16x16x32_bf16 v[56:59], a[232:235], a[28:31], v[56:59]
  ds_read_b64_tr_b16 a[232:233], v232 offset:49152
  ds_read_b64_tr_b16 a[234:235], v232 offset:51200
  v_mfma_f32_16x16x32_bf16 v[60:63], a[192:195], a[20:23], v[60:63]
  buffer_load_dwordx4 a[88:91], v252, s[4:7], s40 offen offset:0 sc1
  v_mfma_f32_16x16x32_bf16 v[60:63], a[196:199], a[28:31], v[60:63]
  v_mfma_f32_16x16x32_bf16 v[44:47], a[192:195], a[16:19], v[44:47]
  ds_read_b64_tr_b16 a[192:193], v228 offset:28672
  ds_read_b64_tr_b16 a[194:195], v228 offset:30720
  v_mfma_f32_16x16x32_bf16 v[44:47], a[196:199], a[24:27], v[44:47]
  ds_read_b64_tr_b16 a[196:197], v233 offset:49152
  ds_read_b64_tr_b16 a[198:199], v233 offset:51200
  s_waitcnt lgkmcnt(13)
  v_mfma_f32_16x16x32_bf16 v[0:3], a[200:203], a[16:19], v[0:3]
  buffer_load_dwordx4 a[92:95], v252, s[4:7], s40 offen offset:1024 sc1
  v_mfma_f32_16x16x32_bf16 v[0:3], a[204:207], a[24:27], v[0:3]
  s_mov_b32 s40, 24641536
  v_mfma_f32_16x16x32_bf16 v[16:19], a[200:203], a[20:23], v[16:19]
  ds_read_b64_tr_b16 a[200:201], v229 offset:28672
  ds_read_b64_tr_b16 a[202:203], v229 offset:30720
  v_mfma_f32_16x16x32_bf16 v[16:19], a[204:207], a[28:31], v[16:19]
  ds_read_b64_tr_b16 a[204:205], v234 offset:49152
  ds_read_b64_tr_b16 a[206:207], v234 offset:51200
  v_mfma_f32_16x16x32_bf16 v[20:23], a[208:211], a[20:23], v[20:23]
  buffer_load_dwordx4 a[96:99], v252, s[4:7], s40 offen offset:0 sc1
  v_mfma_f32_16x16x32_bf16 v[20:23], a[212:215], a[28:31], v[20:23]
  v_mfma_f32_16x16x32_bf16 v[4:7], a[208:211], a[16:19], v[4:7]
  ds_read_b64_tr_b16 a[208:209], v230 offset:28672
  ds_read_b64_tr_b16 a[210:211], v230 offset:30720
  v_mfma_f32_16x16x32_bf16 v[4:7], a[212:215], a[24:27], v[4:7]
  ds_read_b64_tr_b16 a[212:213], v235 offset:49152
  ds_read_b64_tr_b16 a[214:215], v235 offset:51200
  s_waitcnt lgkmcnt(13)
  v_mfma_f32_16x16x32_bf16 v[8:11], a[216:219], a[16:19], v[8:11]
  buffer_load_dwordx4 a[100:103], v252, s[4:7], s40 offen offset:1024 sc1
  v_mfma_f32_16x16x32_bf16 v[8:11], a[220:223], a[24:27], v[8:11]
  s_mov_b32 s40, 24772608
  v_mfma_f32_16x16x32_bf16 v[24:27], a[216:219], a[20:23], v[24:27]
  ds_read_b64_tr_b16 a[216:217], v231 offset:28672
  ds_read_b64_tr_b16 a[218:219], v231 offset:30720
  v_mfma_f32_16x16x32_bf16 v[24:27], a[220:223], a[28:31], v[24:27]
  buffer_load_dwordx4 a[104:107], v252, s[4:7], s40 offen offset:0 sc1
  v_mfma_f32_16x16x32_bf16 v[28:31], a[224:227], a[20:23], v[28:31]
  ds_read_b64_tr_b16 a[220:221], v228 offset:32768
  ds_read_b64_tr_b16 a[222:223], v228 offset:34816
  v_mfma_f32_16x16x32_bf16 v[28:31], a[228:231], a[28:31], v[28:31]
  v_mfma_f32_16x16x32_bf16 v[12:15], a[224:227], a[16:19], v[12:15]
  ds_read_b64_tr_b16 a[224:225], v228 offset:40960
  ds_read_b64_tr_b16 a[226:227], v228 offset:43008
  v_mfma_f32_16x16x32_bf16 v[12:15], a[228:231], a[24:27], v[12:15]
  buffer_load_dwordx4 a[108:111], v252, s[4:7], s40 offen offset:1024 sc1
  s_waitcnt vmcnt(20) lgkmcnt(13)
  v_mfma_f32_16x16x32_bf16 v[32:35], a[232:235], a[32:35], v[32:35]
  ds_read_b64_tr_b16 a[228:229], v229 offset:32768
  ds_read_b64_tr_b16 a[230:231], v229 offset:34816
  v_mfma_f32_16x16x32_bf16 v[32:35], a[192:195], a[40:43], v[32:35]
  s_barrier
  v_mfma_f32_16x16x32_bf16 v[48:51], a[232:235], a[36:39], v[48:51]
  ds_read_b64_tr_b16 a[232:233], v229 offset:40960
  ds_read_b64_tr_b16 a[234:235], v229 offset:43008
  v_mfma_f32_16x16x32_bf16 v[48:51], a[192:195], a[44:47], v[48:51]
  ds_read_b64_tr_b16 a[192:193], v230 offset:32768
  ds_read_b64_tr_b16 a[194:195], v230 offset:34816
  v_mfma_f32_16x16x32_bf16 v[52:55], a[196:199], a[36:39], v[52:55]
  s_mov_b32 s41, 1900544
  s_add_u32 m0, s42, 61440
  s_waitcnt lgkmcnt(13)
  v_mfma_f32_16x16x32_bf16 v[52:55], a[200:203], a[44:47], v[52:55]
  buffer_load_dwordx4 v253, s[44:47], s41 offen offset:0 lds
  v_mfma_f32_16x16x32_bf16 v[36:39], a[196:199], a[32:35], v[36:39]
  ds_read_b64_tr_b16 a[196:197], v230 offset:40960
  ds_read_b64_tr_b16 a[198:199], v230 offset:43008
  v_mfma_f32_16x16x32_bf16 v[36:39], a[200:203], a[40:43], v[36:39]
  ds_read_b64_tr_b16 a[200:201], v231 offset:32768
  ds_read_b64_tr_b16 a[202:203], v231 offset:34816
  v_mfma_f32_16x16x32_bf16 v[40:43], a[204:207], a[32:35], v[40:43]
  s_mov_b32 s41, 2162688
  s_add_u32 m0, s42, 77824
  v_mfma_f32_16x16x32_bf16 v[40:43], a[208:211], a[40:43], v[40:43]
  buffer_load_dwordx4 v253, s[44:47], s41 offen offset:0 lds
  v_mfma_f32_16x16x32_bf16 v[56:59], a[204:207], a[36:39], v[56:59]
  ds_read_b64_tr_b16 a[204:205], v231 offset:40960
  ds_read_b64_tr_b16 a[206:207], v231 offset:43008
  v_mfma_f32_16x16x32_bf16 v[56:59], a[208:211], a[44:47], v[56:59]
  ds_read_b64_tr_b16 a[208:209], v232 offset:4096
  ds_read_b64_tr_b16 a[210:211], v232 offset:6144
  s_waitcnt lgkmcnt(13)
  v_mfma_f32_16x16x32_bf16 v[60:63], a[212:215], a[36:39], v[60:63]
  s_mov_b32 s41, 2424832
  s_add_u32 m0, s42, 73728
  v_mfma_f32_16x16x32_bf16 v[60:63], a[216:219], a[44:47], v[60:63]
  buffer_load_dwordx4 v253, s[44:47], s41 offen offset:0 lds
  v_mfma_f32_16x16x32_bf16 v[44:47], a[212:215], a[32:35], v[44:47]
  ds_read_b64_tr_b16 a[212:213], v232 offset:16384
  ds_read_b64_tr_b16 a[214:215], v232 offset:18432
  v_mfma_f32_16x16x32_bf16 v[44:47], a[216:219], a[40:43], v[44:47]
  ds_read_b64_tr_b16 a[216:217], v233 offset:4096
  ds_read_b64_tr_b16 a[218:219], v233 offset:6144
  v_mfma_f32_16x16x32_bf16 v[0:3], a[220:223], a[32:35], v[0:3]
  s_mov_b32 s41, 2686976
  s_add_u32 m0, s42, 86016
  v_mfma_f32_16x16x32_bf16 v[0:3], a[224:227], a[40:43], v[0:3]
  buffer_load_dwordx4 v253, s[44:47], s41 offen offset:0 lds
  v_mfma_f32_16x16x32_bf16 v[16:19], a[220:223], a[36:39], v[16:19]
  ds_read_b64_tr_b16 a[220:221], v233 offset:16384
  ds_read_b64_tr_b16 a[222:223], v233 offset:18432
  v_mfma_f32_16x16x32_bf16 v[16:19], a[224:227], a[44:47], v[16:19]
  ds_read_b64_tr_b16 a[224:225], v234 offset:4096
  ds_read_b64_tr_b16 a[226:227], v234 offset:6144
  s_waitcnt lgkmcnt(13)
  v_mfma_f32_16x16x32_bf16 v[20:23], a[228:231], a[36:39], v[20:23]
  s_mov_b32 s41, 2818048
  s_add_u32 m0, s42, 102400
  v_mfma_f32_16x16x32_bf16 v[20:23], a[232:235], a[44:47], v[20:23]
  buffer_load_dwordx4 v253, s[44:47], s41 offen offset:0 lds
  v_mfma_f32_16x16x32_bf16 v[4:7], a[228:231], a[32:35], v[4:7]
  ds_read_b64_tr_b16 a[228:229], v234 offset:16384
  ds_read_b64_tr_b16 a[230:231], v234 offset:18432
  v_mfma_f32_16x16x32_bf16 v[4:7], a[232:235], a[40:43], v[4:7]
  ds_read_b64_tr_b16 a[232:233], v235 offset:4096
  ds_read_b64_tr_b16 a[234:235], v235 offset:6144
  v_mfma_f32_16x16x32_bf16 v[8:11], a[192:195], a[32:35], v[8:11]
  s_mov_b32 s41, 3080192
  s_add_u32 m0, s42, 98304
  v_mfma_f32_16x16x32_bf16 v[8:11], a[196:199], a[40:43], v[8:11]
  buffer_load_dwordx4 v253, s[44:47], s41 offen offset:0 lds
  v_mfma_f32_16x16x32_bf16 v[24:27], a[192:195], a[36:39], v[24:27]
  ds_read_b64_tr_b16 a[192:193], v235 offset:16384
  ds_read_b64_tr_b16 a[194:195], v235 offset:18432
  v_mfma_f32_16x16x32_bf16 v[24:27], a[196:199], a[44:47], v[24:27]
  ds_read_b64_tr_b16 a[196:197], v232 offset:24576
  ds_read_b64_tr_b16 a[198:199], v232 offset:26624
  s_waitcnt lgkmcnt(13)
  v_mfma_f32_16x16x32_bf16 v[28:31], a[200:203], a[36:39], v[28:31]
  s_mov_b32 s40, 24903680
  v_mfma_f32_16x16x32_bf16 v[28:31], a[204:207], a[44:47], v[28:31]
  buffer_load_dwordx4 a[112:115], v252, s[4:7], s40 offen offset:0 sc1
  v_mfma_f32_16x16x32_bf16 v[12:15], a[200:203], a[32:35], v[12:15]
  ds_read_b64_tr_b16 a[200:201], v232 offset:53248
  ds_read_b64_tr_b16 a[202:203], v232 offset:55296
  v_mfma_f32_16x16x32_bf16 v[12:15], a[204:207], a[40:43], v[12:15]
  ds_read_b64_tr_b16 a[204:205], v233 offset:24576
  ds_read_b64_tr_b16 a[206:207], v233 offset:26624
  s_waitcnt vmcnt(23)
  v_mfma_f32_16x16x32_bf16 v[32:35], a[208:211], a[48:51], v[32:35]
  buffer_load_dwordx4 a[116:119], v252, s[4:7], s40 offen offset:1024 sc1
  v_mfma_f32_16x16x32_bf16 v[32:35], a[212:215], a[56:59], v[32:35]
  s_barrier
  v_mfma_f32_16x16x32_bf16 v[48:51], a[208:211], a[52:55], v[48:51]
  ds_read_b64_tr_b16 a[208:209], v233 offset:53248
  ds_read_b64_tr_b16 a[210:211], v233 offset:55296
  v_mfma_f32_16x16x32_bf16 v[48:51], a[212:215], a[60:63], v[48:51]
  ds_read_b64_tr_b16 a[212:213], v234 offset:24576
  ds_read_b64_tr_b16 a[214:215], v234 offset:26624
  s_waitcnt lgkmcnt(13)
  v_mfma_f32_16x16x32_bf16 v[52:55], a[216:219], a[52:55], v[52:55]
L_wk2_4:
  s_cbranch_vccnz L_wk2_end
  s_mov_b32 s40, 25034752
  v_mfma_f32_16x16x32_bf16 v[52:55], a[220:223], a[60:63], v[52:55]
  buffer_load_dwordx4 a[120:123], v252, s[4:7], s40 offen offset:0 sc1
  v_mfma_f32_16x16x32_bf16 v[36:39], a[216:219], a[48:51], v[36:39]
  ds_read_b64_tr_b16 a[216:217], v234 offset:53248
  ds_read_b64_tr_b16 a[218:219], v234 offset:55296
  v_mfma_f32_16x16x32_bf16 v[36:39], a[220:223], a[56:59], v[36:39]
  ds_read_b64_tr_b16 a[220:221], v235 offset:24576
  ds_read_b64_tr_b16 a[222:223], v235 offset:26624
  v_mfma_f32_16x16x32_bf16 v[40:43], a[224:227], a[48:51], v[40:43]
  buffer_load_dwordx4 a[124:127], v252, s[4:7], s40 offen offset:1024 sc1
  v_mfma_f32_16x16x32_bf16 v[40:43], a[228:231], a[56:59], v[40:43]
  s_mov_b32 s41, 3342336
  s_add_u32 m0, s42, 110592
  v_mfma_f32_16x16x32_bf16 v[56:59], a[224:227], a[52:55], v[56:59]
  ds_read_b64_tr_b16 a[224:225], v235 offset:53248
  ds_read_b64_tr_b16 a[226:227], v235 offset:55296
  v_mfma_f32_16x16x32_bf16 v[56:59], a[228:231], a[60:63], v[56:59]
  ds_read_b64_tr_b16 a[228:229], v236 offset:0
  ds_read_b64_tr_b16 a[230:231], v236 offset:2048
  s_waitcnt lgkmcnt(13)
  v_mfma_f32_16x16x32_bf16 v[60:63], a[232:235], a[52:55], v[60:63]
  buffer_load_dwordx4 v253, s[44:47], s41 offen offset:0 lds
  v_mfma_f32_16x16x32_bf16 v[60:63], a[192:195], a[60:63], v[60:63]
  s_mov_b32 s41, 3604480
  s_add_u32 m0, s42, 126976
  v_mfma_f32_16x16x32_bf16 v[44:47], a[232:235], a[48:51], v[44:47]
  ds_read_b64_tr_b16 a[232:233], v236 offset:8192
  ds_read_b64_tr_b16 a[234:235], v236 offset:10240
  v_mfma_f32_16x16x32_bf16 v[44:47], a[192:195], a[56:59], v[44:47]
  ds_read_b64_tr_b16 a[192:193], v237 offset:0
  ds_read_b64_tr_b16 a[194:195], v237 offset:2048
  v_mfma_f32_16x16x32_bf16 v[0:3], a[196:199], a[48:51], v[0:3]
  buffer_load_dwordx4 v253, s[44:47], s41 offen offset:0 lds
  v_mfma_f32_16x16x32_bf16 v[0:3], a[200:203], a[56:59], v[0:3]
  v_mfma_f32_16x16x32_bf16 v[16:19], a[196:199], a[52:55], v[16:19]
  ds_read_b64_tr_b16 a[196:197], v237 offset:8192
  ds_read_b64_tr_b16 a[198:199], v237 offset:10240
  v_mfma_f32_16x16x32_bf16 v[16:19], a[200:203], a[60:63], v[16:19]
  ds_read_b64_tr_b16 a[200:201], v238 offset:0
  ds_read_b64_tr_b16 a[202:203], v238 offset:2048
  s_waitcnt lgkmcnt(13)
  v_mfma_f32_16x16x32_bf16 v[20:23], a[204:207], a[52:55], v[20:23]
  v_mfma_f32_16x16x32_bf16 v[20:23], a[208:211], a[60:63], v[20:23]
  v_mfma_f32_16x16x32_bf16 v[4:7], a[204:207], a[48:51], v[4:7]
  ds_read_b64_tr_b16 a[204:205], v238 offset:8192
  ds_read_b64_tr_b16 a[206:207], v238 offset:10240
  v_mfma_f32_16x16x32_bf16 v[4:7], a[208:211], a[56:59], v[4:7]
  ds_read_b64_tr_b16 a[208:209], v239 offset:0
  ds_read_b64_tr_b16 a[210:211], v239 offset:2048
  v_mfma_f32_16x16x32_bf16 v[8:11], a[212:215], a[48:51], v[8:11]
  v_mfma_f32_16x16x32_bf16 v[8:11], a[216:219], a[56:59], v[8:11]
  v_mfma_f32_16x16x32_bf16 v[24:27], a[212:215], a[52:55], v[24:27]
  ds_read_b64_tr_b16 a[212:213], v239 offset:8192
  ds_read_b64_tr_b16 a[214:215], v239 offset:10240
  v_mfma_f32_16x16x32_bf16 v[24:27], a[216:219], a[60:63], v[24:27]
  ds_read_b64_tr_b16 a[216:217], v228 offset:20480
  ds_read_b64_tr_b16 a[218:219], v228 offset:22528
  s_waitcnt lgkmcnt(13)
  v_mfma_f32_16x16x32_bf16 v[28:31], a[220:223], a[52:55], v[28:31]
  v_mfma_f32_16x16x32_bf16 v[28:31], a[224:227], a[60:63], v[28:31]
  v_mfma_f32_16x16x32_bf16 v[12:15], a[220:223], a[48:51], v[12:15]
  ds_read_b64_tr_b16 a[220:221], v236 offset:12288
  ds_read_b64_tr_b16 a[222:223], v236 offset:14336
  v_mfma_f32_16x16x32_bf16 v[12:15], a[224:227], a[56:59], v[12:15]
  ds_read_b64_tr_b16 a[224:225], v229 offset:20480
  ds_read_b64_tr_b16 a[226:227], v229 offset:22528
  s_waitcnt vmcnt(24)
  v_mfma_f32_16x16x32_bf16 v[32:35], a[228:231], a[64:67], v[32:35]
  v_mfma_f32_16x16x32_bf16 v[32:35], a[232:235], a[72:75], v[32:35]
  s_waitcnt vmcnt(20)
  s_barrier
  v_mfma_f32_16x16x32_bf16 v[48:51], a[228:231], a[68:71], v[48:51]
  ds_read_b64_tr_b16 a[228:229], v237 offset:12288
  ds_read_b64_tr_b16 a[230:231], v237 offset:14336
  v_mfma_f32_16x16x32_bf16 v[48:51], a[232:235], a[76:79], v[48:51]
  ds_read_b64_tr_b16 a[232:233], v230 offset:20480
  ds_read_b64_tr_b16 a[234:235], v230 offset:22528
  s_waitcnt lgkmcnt(13)
  v_mfma_f32_16x16x32_bf16 v[52:55], a[192:195], a[68:71], v[52:55]
  v_mfma_f32_16x16x32_bf16 v[52:55], a[196:199], a[76:79], v[52:55]
  v_mfma_f32_16x16x32_bf16 v[36:39], a[192:195], a[64:67], v[36:39]
  ds_read_b64_tr_b16 a[192:193], v238 offset:12288
  ds_read_b64_tr_b16 a[194:195], v238 offset:14336
  v_mfma_f32_16x16x32_bf16 v[36:39], a[196:199], a[72:75], v[36:39]
  ds_read_b64_tr_b16 a[196:197], v231 offset:20480
  ds_read_b64_tr_b16 a[198:199], v231 offset:22528
  v_mfma_f32_16x16x32_bf16 v[40:43], a[200:203], a[64:67], v[40:43]
  v_mfma_f32_16x16x32_bf16 v[40:43], a[204:207], a[72:75], v[40:43]
  v_mfma_f32_16x16x32_bf16 v[56:59], a[200:203], a[68:71], v[56:59]
  ds_read_b64_tr_b16 a[200:201], v239 offset:12288
  ds_read_b64_tr_b16 a[202:203], v239 offset:14336
  v_mfma_f32_16x16x32_bf16 v[56:59], a[204:207], a[76:79], v[56:59]
  ds_read_b64_tr_b16 a[204:205], v236 offset:24576
  ds_read_b64_tr_b16 a[206:207], v236 offset:26624
  s_waitcnt lgkmcnt(13)
  v_mfma_f32_16x16x32_bf16 v[60:63], a[208:211], a[68:71], v[60:63]
  v_mfma_f32_16x16x32_bf16 v[60:63], a[212:215], a[76:79], v[60:63]
  v_mfma_f32_16x16x32_bf16 v[44:47], a[208:211], a[64:67], v[44:47]
  ds_read_b64_tr_b16 a[208:209], v228 offset:36864
  ds_read_b64_tr_b16 a[210:211], v228 offset:38912
  v_mfma_f32_16x16x32_bf16 v[44:47], a[212:215], a[72:75], v[44:47]
  ds_read_b64_tr_b16 a[212:213], v237 offset:24576
  ds_read_b64_tr_b16 a[214:215], v237 offset:26624
  s_waitcnt vmcnt(16)
  v_mfma_f32_16x16x32_bf16 v[32:35], a[216:219], a[80:83], v[32:35]
  v_mfma_f32_16x16x32_bf16 v[32:35], a[220:223], a[88:91], v[32:35]
  v_mfma_f32_16x16x32_bf16 v[48:51], a[216:219], a[84:87], v[48:51]
  ds_read_b64_tr_b16 a[216:217], v229 offset:36864
  ds_read_b64_tr_b16 a[218:219], v229 offset:38912
  v_mfma_f32_16x16x32_bf16 v[48:51], a[220:223], a[92:95], v[48:51]
  ds_read_b64_tr_b16 a[220:221], v238 offset:24576
  ds_read_b64_tr_b16 a[222:223], v238 offset:26624
  s_waitcnt lgkmcnt(13)
  v_mfma_f32_16x16x32_bf16 v[52:55], a[224:227], a[84:87], v[52:55]
  v_mfma_f32_16x16x32_bf16 v[52:55], a[228:231], a[92:95], v[52:55]
  v_mfma_f32_16x16x32_bf16 v[36:39], a[224:227], a[80:83], v[36:39]
  ds_read_b64_tr_b16 a[224:225], v230 offset:36864
  ds_read_b64_tr_b16 a[226:227], v230 offset:38912
  v_mfma_f32_16x16x32_bf16 v[36:39], a[228:231], a[88:91], v[36:39]
  ds_read_b64_tr_b16 a[228:229], v239 offset:24576
  ds_read_b64_tr_b16 a[230:231], v239 offset:26624
  v_mfma_f32_16x16x32_bf16 v[40:43], a[232:235], a[80:83], v[40:43]
  v_mfma_f32_16x16x32_bf16 v[40:43], a[192:195], a[88:91], v[40:43]
  v_mfma_f32_16x16x32_bf16 v[56:59], a[232:235], a[84:87], v[56:59]
  ds_read_b64_tr_b16 a[232:233], v231 offset:36864
  ds_read_b64_tr_b16 a[234:235], v231 offset:38912
  v_mfma_f32_16x16x32_bf16 v[56:59], a[192:195], a[92:95], v[56:59]
  ds_read_b64_tr_b16 a[192:193], v228 offset:53248
  ds_read_b64_tr_b16 a[194:195], v228 offset:55296
  s_waitcnt lgkmcnt(13)
  v_mfma_f32_16x16x32_bf16 v[60:63], a[196:199], a[84:87], v[60:63]
  v_mfma_f32_16x16x32_bf16 v[60:63], a[200:203], a[92:95], v[60:63]
  v_mfma_f32_16x16x32_bf16 v[44:47], a[196:199], a[80:83], v[44:47]
  ds_read_b64_tr_b16 a[196:197], v228 offset:49152
  ds_read_b64_tr_b16 a[198:199], v228 offset:51200
  v_mfma_f32_16x16x32_bf16 v[44:47], a[200:203], a[88:91], v[44:47]
  ds_read_b64_tr_b16 a[200:201], v229 offset:53248
  ds_read_b64_tr_b16 a[202:203], v229 offset:55296
  s_waitcnt vmcnt(12)
  v_mfma_f32_16x16x32_bf16 v[32:35], a[204:207], a[96:99], v[32:35]
  v_mfma_f32_16x16x32_bf16 v[32:35], a[208:211], a[104:107], v[32:35]
  s_waitcnt vmcnt(6)
  s_barrier
  v_mfma_f32_16x16x32_bf16 v[48:51], a[204:207], a[100:103], v[48:51]
  ds_read_b64_tr_b16 a[204:205], v229 offset:49152
  ds_read_b64_tr_b16 a[206:207], v229 offset:51200
  v_mfma_f32_16x16x32_bf16 v[48:51], a[208:211], a[108:111], v[48:51]
  ds_read_b64_tr_b16 a[208:209], v230 offset:53248
  ds_read_b64_tr_b16 a[210:211], v230 offset:55296
  s_waitcnt lgkmcnt(13)
  v_mfma_f32_16x16x32_bf16 v[52:55], a[212:215], a[100:103], v[52:55]
  v_mfma_f32_16x16x32_bf16 v[52:55], a[216:219], a[108:111], v[52:55]
  v_mfma_f32_16x16x32_bf16 v[36:39], a[212:215], a[96:99], v[36:39]
  ds_read_b64_tr_b16 a[212:213], v230 offset:49152
  ds_read_b64_tr_b16 a[214:215], v230 offset:51200
  v_mfma_f32_16x16x32_bf16 v[36:39], a[216:219], a[104:107], v[36:39]
  ds_read_b64_tr_b16 a[216:217], v231 offset:53248
  ds_read_b64_tr_b16 a[218:219], v231 offset:55296
  v_mfma_f32_16x16x32_bf16 v[40:43], a[220:223], a[96:99], v[40:43]
  v_mfma_f32_16x16x32_bf16 v[40:43], a[224:227], a[104:107], v[40:43]
  v_mfma_f32_16x16x32_bf16 v[56:59], a[220:223], a[100:103], v[56:59]
  ds_read_b64_tr_b16 a[220:221], v231 offset:49152
  ds_read_b64_tr_b16 a[222:223], v231 offset:51200
  v_mfma_f32_16x16x32_bf16 v[56:59], a[224:227], a[108:111], v[56:59]
  ds_read_b64_tr_b16 a[224:225], v228 offset:61440
  ds_read_b64_tr_b16 a[226:227], v228 offset:63488
  s_waitcnt lgkmcnt(13)
  v_mfma_f32_16x16x32_bf16 v[60:63], a[228:231], a[100:103], v[60:63]
  v_mfma_f32_16x16x32_bf16 v[60:63], a[232:235], a[108:111], v[60:63]
  v_mfma_f32_16x16x32_bf16 v[44:47], a[228:231], a[96:99], v[44:47]
  ds_read_b64_tr_b16 a[228:229], v232 offset:12288
  ds_read_b64_tr_b16 a[230:231], v232 offset:14336
  v_mfma_f32_16x16x32_bf16 v[44:47], a[232:235], a[104:107], v[44:47]
  ds_read_b64_tr_b16 a[232:233], v229 offset:61440
  ds_read_b64_tr_b16 a[234:235], v229 offset:63488
  s_waitcnt vmcnt(2)
  v_mfma_f32_16x16x32_bf16 v[32:35], a[192:195], a[112:115], v[32:35]
  v_mfma_f32_16x16x32_bf16 v[32:35], a[196:199], a[120:123], v[32:35]
  v_mfma_f32_16x16x32_bf16 v[48:51], a[192:195], a[116:119], v[48:51]
  ds_read_b64_tr_b16 a[192:193], v233 offset:12288
  ds_read_b64_tr_b16 a[194:195], v233 offset:14336
  v_mfma_f32_16x16x32_bf16 v[48:51], a[196:199], a[124:127], v[48:51]
  ds_read_b64_tr_b16 a[196:197], v232 offset:8192
  ds_read_b64_tr_b16 a[198:199], v232 offset:10240
  s_waitcnt lgkmcnt(13)
  v_mfma_f32_16x16x32_bf16 v[52:55], a[200:203], a[116:119], v[52:55]
  v_mfma_f32_16x16x32_bf16 v[52:55], a[204:207], a[124:127], v[52:55]
  v_mfma_f32_16x16x32_bf16 v[36:39], a[200:203], a[112:115], v[36:39]
  ds_read_b64_tr_b16 a[200:201], v232 offset:20480
  ds_read_b64_tr_b16 a[202:203], v232 offset:22528
  v_mfma_f32_16x16x32_bf16 v[36:39], a[204:207], a[120:123], v[36:39]
  ds_read_b64_tr_b16 a[204:205], v233 offset:8192
  ds_read_b64_tr_b16 a[206:207], v233 offset:10240
  v_cvt_pk_bf16_f32 v64, v32, v33
  v_cvt_pk_bf16_f32 v65, v34, v35
  v_mfma_f32_16x16x32_bf16 v[40:43], a[208:211], a[112:115], v[40:43]
  v_mfma_f32_16x16x32_bf16 v[40:43], a[212:215], a[120:123], v[40:43]
  v_mfma_f32_16x16x32_bf16 v[56:59], a[208:211], a[116:119], v[56:59]
  ds_read_b64_tr_b16 a[208:209], v233 offset:20480
  ds_read_b64_tr_b16 a[210:211], v233 offset:22528
  v_cvt_pk_bf16_f32 v66, v36, v37
  v_cvt_pk_bf16_f32 v67, v38, v39
  buffer_store_dwordx4 v[64:67], v251, s[4:7], s97 offen offset:0 sc1
  v_cvt_pk_bf16_f32 v72, v48, v49
  v_mfma_f32_16x16x32_bf16 v[56:59], a[212:215], a[124:127], v[56:59]
  ds_read_b64_tr_b16 a[212:213], v232 offset:36864
  ds_read_b64_tr_b16 a[214:215], v232 offset:38912
  v_cvt_pk_bf16_f32 v73, v50, v51
  v_cvt_pk_bf16_f32 v74, v52, v53
  v_cvt_pk_bf16_f32 v75, v54, v55
  s_waitcnt lgkmcnt(13)
  v_mfma_f32_16x16x32_bf16 v[60:63], a[216:219], a[116:119], v[60:63]
  buffer_store_dwordx4 v[72:75], v251, s[4:7], s97 offen offset:2048 sc1
  v_mfma_f32_16x16x32_bf16 v[60:63], a[220:223], a[124:127], v[60:63]
  v_mfma_f32_16x16x32_bf16 v[44:47], a[216:219], a[112:115], v[44:47]
  ds_read_b64_tr_b16 a[216:217], v232 offset:32768
  ds_read_b64_tr_b16 a[218:219], v232 offset:34816
  v_mfma_f32_16x16x32_bf16 v[44:47], a[220:223], a[120:123], v[44:47]
  ds_read_b64_tr_b16 a[220:221], v233 offset:36864
  ds_read_b64_tr_b16 a[222:223], v233 offset:38912
  v_cvt_pk_bf16_f32 v68, v40, v41
  v_cvt_pk_bf16_f32 v69, v42, v43
  v_mfma_f32_16x16x32_bf16 v[0:3], a[224:227], a[64:67], v[0:3]
  v_mfma_f32_16x16x32_bf16 v[0:3], a[228:231], a[72:75], v[0:3]
  s_waitcnt vmcnt(2)
  s_barrier
  v_cvt_pk_bf16_f32 v70, v44, v45
  v_cvt_pk_bf16_f32 v71, v46, v47
  buffer_store_dwordx4 v[68:71], v251, s[4:7], s97 offen offset:1024 sc1
  v_cvt_pk_bf16_f32 v76, v56, v57
  v_mfma_f32_16x16x32_bf16 v[16:19], a[224:227], a[68:71], v[16:19]
  ds_read_b64_tr_b16 a[224:225], v233 offset:32768
  ds_read_b64_tr_b16 a[226:227], v233 offset:34816
  v_cvt_pk_bf16_f32 v77, v58, v59
  v_cvt_pk_bf16_f32 v78, v60, v61
  v_cvt_pk_bf16_f32 v79, v62, v63
  v_mfma_f32_16x16x32_bf16 v[16:19], a[228:231], a[76:79], v[16:19]
  ds_read_b64_tr_b16 a[228:229], v232 offset:45056
  ds_read_b64_tr_b16 a[230:231], v232 offset:47104
  buffer_store_dwordx4 v[76:79], v251, s[4:7], s97 offen offset:3072 sc1
  v_accvgpr_read_b32 v80, a236
  s_waitcnt lgkmcnt(13)
  v_mfma_f32_16x16x32_bf16 v[20:23], a[232:235], a[68:71], v[20:23]
  v_accvgpr_read_b32 v81, a237
  v_accvgpr_read_b32 v82, a238
  v_accvgpr_read_b32 v83, a239
  v_mfma_f32_16x16x32_bf16 v[20:23], a[192:195], a[76:79], v[20:23]
  v_accvgpr_read_b32 v84, a240
  v_accvgpr_read_b32 v85, a241
  v_accvgpr_read_b32 v86, a242
  v_mfma_f32_16x16x32_bf16 v[4:7], a[232:235], a[64:67], v[4:7]
  ds_read_b64_tr_b16 a[232:233], v232 offset:61440
  ds_read_b64_tr_b16 a[234:235], v232 offset:63488
  v_accvgpr_read_b32 v87, a243
  v_accvgpr_read_b32 v88, a244
  v_accvgpr_read_b32 v89, a245
  v_mfma_f32_16x16x32_bf16 v[4:7], a[192:195], a[72:75], v[4:7]
  ds_read_b64_tr_b16 a[192:193], v233 offset:45056
  ds_read_b64_tr_b16 a[194:195], v233 offset:47104
  v_accvgpr_read_b32 v90, a246
  v_accvgpr_read_b32 v91, a247
  v_accvgpr_read_b32 v92, a248
  v_mfma_f32_16x16x32_bf16 v[0:3], a[196:199], a[80:83], v[0:3]
  v_accvgpr_read_b32 v93, a249
  v_accvgpr_read_b32 v94, a250
  v_accvgpr_read_b32 v95, a251
  v_mfma_f32_16x16x32_bf16 v[0:3], a[200:203], a[88:91], v[0:3]
  v_lshlrev_b32 v96, 16, v80
  v_and_b32 v97, 0xffff0000, v80
  v_lshlrev_b32 v98, 16, v81
  v_mfma_f32_16x16x32_bf16 v[16:19], a[196:199], a[84:87], v[16:19]
  ds_read_b64_tr_b16 a[196:197], v233 offset:61440
  ds_read_b64_tr_b16 a[198:199], v233 offset:63488
  v_and_b32 v99, 0xffff0000, v81
  v_lshlrev_b32 v100, 16, v82
  v_and_b32 v101, 0xffff0000, v82
  v_mfma_f32_16x16x32_bf16 v[16:19], a[200:203], a[92:95], v[16:19]
  ds_read_b64_tr_b16 a[200:201], v230 offset:61440
  ds_read_b64_tr_b16 a[202:203], v230 offset:63488
  v_lshlrev_b32 v102, 16, v83
  v_and_b32 v103, 0xffff0000, v83
  v_lshlrev_b32 v104, 16, v84
  s_waitcnt lgkmcnt(13)
  v_mfma_f32_16x16x32_bf16 v[20:23], a[204:207], a[84:87], v[20:23]
  v_and_b32 v105, 0xffff0000, v84
  v_lshlrev_b32 v106, 16, v85
  v_and_b32 v107, 0xffff0000, v85
  v_mfma_f32_16x16x32_bf16 v[20:23], a[208:211], a[92:95], v[20:23]
  v_lshlrev_b32 v108, 16, v86
  v_and_b32 v109, 0xffff0000, v86
  v_lshlrev_b32 v110, 16, v87
  v_mfma_f32_16x16x32_bf16 v[4:7], a[204:207], a[80:83], v[4:7]
  ds_read_b64_tr_b16 a[204:205], v234 offset:12288
  ds_read_b64_tr_b16 a[206:207], v234 offset:14336
  v_and_b32 v111, 0xffff0000, v87
  v_lshlrev_b32 v112, 16, v88
  v_and_b32 v113, 0xffff0000, v88
  v_mfma_f32_16x16x32_bf16 v[4:7], a[208:211], a[88:91], v[4:7]
  ds_read_b64_tr_b16 a[208:209], v231 offset:61440
  ds_read_b64_tr_b16 a[210:211], v231 offset:63488
  v_lshlrev_b32 v114, 16, v89
  v_and_b32 v115, 0xffff0000, v89
  v_lshlrev_b32 v116, 16, v90
  v_mfma_f32_16x16x32_bf16 v[0:3], a[212:215], a[96:99], v[0:3]
  v_and_b32 v117, 0xffff0000, v90
  v_lshlrev_b32 v118, 16, v91
  v_and_b32 v119, 0xffff0000, v91
  v_mfma_f32_16x16x32_bf16 v[0:3], a[216:219], a[104:107], v[0:3]
  v_lshlrev_b32 v120, 16, v92
  v_and_b32 v121, 0xffff0000, v92
  v_lshlrev_b32 v122, 16, v93
  v_mfma_f32_16x16x32_bf16 v[16:19], a[212:215], a[100:103], v[16:19]
  ds_read_b64_tr_b16 a[212:213], v235 offset:12288
  ds_read_b64_tr_b16 a[214:215], v235 offset:14336
  v_and_b32 v123, 0xffff0000, v93
  v_lshlrev_b32 v124, 16, v94
  v_and_b32 v125, 0xffff0000, v94
  v_mfma_f32_16x16x32_bf16 v[16:19], a[216:219], a[108:111], v[16:19]
  ds_read_b64_tr_b16 a[216:217], v234 offset:8192
  ds_read_b64_tr_b16 a[218:219], v234 offset:10240
  v_lshlrev_b32 v126, 16, v95
  v_and_b32 v127, 0xffff0000, v95
  ds_read_b128 v[128:131], v250 offset:11008
  s_waitcnt lgkmcnt(13)
  v_mfma_f32_16x16x32_bf16 v[20:23], a[220:223], a[100:103], v[20:23]
  ds_read_b128 v[132:135], v250 offset:11072
  ds_read_b128 v[136:139], v250 offset:11136
  ds_read_b128 v[140:143], v250 offset:11200
  v_mfma_f32_16x16x32_bf16 v[20:23], a[224:227], a[108:111], v[20:23]
  v_mfma_f32_16x16x32_bf16 v[4:7], a[220:223], a[96:99], v[4:7]
  ds_read_b64_tr_b16 a[220:221], v234 offset:20480
  ds_read_b64_tr_b16 a[222:223], v234 offset:22528
  v_mfma_f32_16x16x32_bf16 v[4:7], a[224:227], a[104:107], v[4:7]
  ds_read_b64_tr_b16 a[224:225], v235 offset:8192
  ds_read_b64_tr_b16 a[226:227], v235 offset:10240
  v_mfma_f32_16x16x32_bf16 v[0:3], a[228:231], a[112:115], v[0:3]
  v_mfma_f32_16x16x32_bf16 v[0:3], a[232:235], a[120:123], v[0:3]
  v_mfma_f32_16x16x32_bf16 v[16:19], a[228:231], a[116:119], v[16:19]
  ds_read_b64_tr_b16 a[228:229], v235 offset:20480
  ds_read_b64_tr_b16 a[230:231], v235 offset:22528
  v_mfma_f32_16x16x32_bf16 v[16:19], a[232:235], a[124:127], v[16:19]
  ds_read_b64_tr_b16 a[232:233], v234 offset:36864
  ds_read_b64_tr_b16 a[234:235], v234 offset:38912
  buffer_load_dwordx4 v[64:67], v251, s[4:7], s96 offen offset:0 sc1
  v_mfma_f32_16x16x32_bf16 v[20:23], a[192:195], a[116:119], v[20:23]
  buffer_load_dwordx4 v[68:71], v251, s[4:7], s96 offen offset:1024 sc1
  s_waitcnt lgkmcnt(13)
  v_mfma_f32_16x16x32_bf16 v[20:23], a[196:199], a[124:127], v[20:23]
  buffer_load_dwordx4 v[72:75], v251, s[4:7], s96 offen offset:2048 sc1
  buffer_load_dwordx4 v[76:79], v251, s[4:7], s96 offen offset:3072 sc1
  v_mfma_f32_16x16x32_bf16 v[4:7], a[192:195], a[112:115], v[4:7]
  ds_read_b64_tr_b16 a[192:193], v234 offset:32768
  ds_read_b64_tr_b16 a[194:195], v234 offset:34816
  v_mfma_f32_16x16x32_bf16 v[4:7], a[196:199], a[120:123], v[4:7]
  ds_read_b64_tr_b16 a[196:197], v235 offset:36864
  ds_read_b64_tr_b16 a[198:199], v235 offset:38912
  v_mfma_f32_16x16x32_bf16 v[8:11], a[200:203], a[64:67], v[8:11]
  v_mfma_f32_16x16x32_bf16 v[8:11], a[204:207], a[72:75], v[8:11]
  s_barrier
  v_mfma_f32_16x16x32_bf16 v[24:27], a[200:203], a[68:71], v[24:27]
  ds_read_b64_tr_b16 a[200:201], v235 offset:32768
  ds_read_b64_tr_b16 a[202:203], v235 offset:34816
  v_mfma_f32_16x16x32_bf16 v[24:27], a[204:207], a[76:79], v[24:27]
  ds_read_b64_tr_b16 a[204:205], v234 offset:45056
  ds_read_b64_tr_b16 a[206:207], v234 offset:47104
  v_mfma_f32_16x16x32_bf16 v[28:31], a[208:211], a[68:71], v[28:31]
  v_mfma_f32_16x16x32_bf16 v[28:31], a[212:215], a[76:79], v[28:31]
  v_mfma_f32_16x16x32_bf16 v[12:15], a[208:211], a[64:67], v[12:15]
  ds_read_b64_tr_b16 a[208:209], v234 offset:61440
  ds_read_b64_tr_b16 a[210:211], v234 offset:63488
  v_mfma_f32_16x16x32_bf16 v[12:15], a[212:215], a[72:75], v[12:15]
  ds_read_b64_tr_b16 a[212:213], v235 offset:45056
  ds_read_b64_tr_b16 a[214:215], v235 offset:47104
  s_waitcnt lgkmcnt(13)
  v_mfma_f32_16x16x32_bf16 v[8:11], a[216:219], a[80:83], v[8:11]
  v_mfma_f32_16x16x32_bf16 v[8:11], a[220:223], a[88:91], v[8:11]
  v_mfma_f32_16x16x32_bf16 v[24:27], a[216:219], a[84:87], v[24:27]
  ds_read_b64_tr_b16 a[216:217], v235 offset:61440
  ds_read_b64_tr_b16 a[218:219], v235 offset:63488
  v_mfma_f32_16x16x32_bf16 v[24:27], a[220:223], a[92:95], v[24:27]
  v_mfma_f32_16x16x32_bf16 v[28:31], a[224:227], a[84:87], v[28:31]
  v_mfma_f32_16x16x32_bf16 v[28:31], a[228:231], a[92:95], v[28:31]
  v_mfma_f32_16x16x32_bf16 v[12:15], a[224:227], a[80:83], v[12:15]
  v_mfma_f32_16x16x32_bf16 v[12:15], a[228:231], a[88:91], v[12:15]
  s_waitcnt lgkmcnt(13)
  v_mfma_f32_16x16x32_bf16 v[8:11], a[232:235], a[96:99], v[8:11]
  s_waitcnt lgkmcnt(12)
  v_mfma_f32_16x16x32_bf16 v[8:11], a[192:195], a[104:107], v[8:11]
  v_mfma_f32_16x16x32_bf16 v[24:27], a[232:235], a[100:103], v[24:27]
  v_mfma_f32_16x16x32_bf16 v[24:27], a[192:195], a[108:111], v[24:27]
  s_waitcnt lgkmcnt(10)
  v_mfma_f32_16x16x32_bf16 v[28:31], a[196:199], a[100:103], v[28:31]
  s_waitcnt lgkmcnt(8)
  v_mfma_f32_16x16x32_bf16 v[28:31], a[200:203], a[108:111], v[28:31]
  v_mfma_f32_16x16x32_bf16 v[12:15], a[196:199], a[96:99], v[12:15]
  v_mfma_f32_16x16x32_bf16 v[12:15], a[200:203], a[104:107], v[12:15]
  s_waitcnt lgkmcnt(6)
  v_mfma_f32_16x16x32_bf16 v[8:11], a[204:207], a[112:115], v[8:11]
  s_waitcnt lgkmcnt(4)
  v_mfma_f32_16x16x32_bf16 v[8:11], a[208:211], a[120:123], v[8:11]
  v_mfma_f32_16x16x32_bf16 v[24:27], a[204:207], a[116:119], v[24:27]
  v_mfma_f32_16x16x32_bf16 v[24:27], a[208:211], a[124:127], v[24:27]
  s_waitcnt vmcnt(0)
  v_max3_u32 v244, v64, v65, v66
  v_max3_u32 v244, v244, v67, v68
  v_max3_u32 v244, v244, v69, v70
  v_max3_u32 v244, v244, v71, v72
  s_waitcnt lgkmcnt(2)
  v_mfma_f32_16x16x32_bf16 v[28:31], a[212:215], a[116:119], v[28:31]
  v_max3_u32 v244, v244, v73, v74
  v_max3_u32 v244, v244, v75, v76
  v_max3_u32 v244, v244, v77, v78
  s_waitcnt lgkmcnt(0)
  v_mfma_f32_16x16x32_bf16 v[28:31], a[216:219], a[124:127], v[28:31]
  v_max_u32 v244, v244, v79
  v_cmp_eq_u32 s[68:69], -1, v244
  v_mfma_f32_16x16x32_bf16 v[12:15], a[212:215], a[112:115], v[12:15]
  v_mfma_f32_16x16x32_bf16 v[12:15], a[216:219], a[120:123], v[12:15]
  s_cmp_lg_u64 s[68:69], 0
  s_cbranch_scc1 L_slow_52
L_back_53:
  v_lshlrev_b32 v144, 16, v64
  v_and_b32 v64, 0xffff0000, v64
  v_fmac_f32 v96, v144, v128
  v_fmac_f32 v97, v64, v129
  v_lshlrev_b32 v145, 16, v65
  v_and_b32 v65, 0xffff0000, v65
  v_fmac_f32 v98, v145, v130
  v_fmac_f32 v99, v65, v131
  v_lshlrev_b32 v146, 16, v66
  v_and_b32 v66, 0xffff0000, v66
  v_fmac_f32 v100, v146, v132
  v_fmac_f32 v101, v66, v133
  v_lshlrev_b32 v147, 16, v67
  v_and_b32 v67, 0xffff0000, v67
  v_fmac_f32 v102, v147, v134
  v_fmac_f32 v103, v67, v135
  v_lshlrev_b32 v144, 16, v68
  v_and_b32 v68, 0xffff0000, v68
  v_fmac_f32 v104, v144, v136
  v_fmac_f32 v105, v68, v137
  v_lshlrev_b32 v145, 16, v69
  v_and_b32 v69, 0xffff0000, v69
  v_fmac_f32 v106, v145, v138
  v_fmac_f32 v107, v69, v139
  v_lshlrev_b32 v146, 16, v70
  v_and_b32 v70, 0xffff0000, v70
  v_fmac_f32 v108, v146, v140
  v_fmac_f32 v109, v70, v141
  v_lshlrev_b32 v147, 16, v71
  v_and_b32 v71, 0xffff0000, v71
  v_fmac_f32 v110, v147, v142
  v_fmac_f32 v111, v71, v143
  v_lshlrev_b32 v144, 16, v72
  v_and_b32 v72, 0xffff0000, v72
  v_fmac_f32 v112, v144, v128
  v_fmac_f32 v113, v72, v129
  v_lshlrev_b32 v145, 16, v73
  v_and_b32 v73, 0xffff0000, v73
  v_fmac_f32 v114, v145, v130
  v_fmac_f32 v115, v73, v131
  v_lshlrev_b32 v146, 16, v74
  v_and_b32 v74, 0xffff0000, v74
  v_fmac_f32 v116, v146, v132
  v_fmac_f32 v117, v74, v133
  v_lshlrev_b32 v147, 16, v75
  v_and_b32 v75, 0xffff0000, v75
  v_fmac_f32 v118, v147, v134
  v_fmac_f32 v119, v75, v135
  v_lshlrev_b32 v144, 16, v76
  v_and_b32 v76, 0xffff0000, v76
  v_fmac_f32 v120, v144, v136
  v_fmac_f32 v121, v76, v137
  v_lshlrev_b32 v145, 16, v77
  v_and_b32 v77, 0xffff0000, v77
  v_fmac_f32 v122, v145, v138
  v_fmac_f32 v123, v77, v139
  v_lshlrev_b32 v146, 16, v78
  v_and_b32 v78, 0xffff0000, v78
  v_fmac_f32 v124, v146, v140
  v_fmac_f32 v125, v78, v141
  v_lshlrev_b32 v147, 16, v79
  v_and_b32 v79, 0xffff0000, v79
  v_fmac_f32 v126, v147, v142
  v_fmac_f32 v127, v79, v143
  v_fmac_f32 v96, v0, v128
  v_fmac_f32 v97, v1, v129
  v_fmac_f32 v98, v2, v130
  v_fmac_f32 v99, v3, v131
  v_fmac_f32 v100, v4, v132
  v_fmac_f32 v101, v5, v133
  v_fmac_f32 v102, v6, v134
  v_fmac_f32 v103, v7, v135
  v_cvt_pk_bf16_f32 v80, v96, v97
  v_cvt_pk_bf16_f32 v81, v98, v99
  v_cvt_pk_bf16_f32 v82, v100, v101
  v_cvt_pk_bf16_f32 v83, v102, v103
  s_nop 0
  v_permlane16_swap_b32 v80, v82
  v_permlane16_swap_b32 v81, v83
  s_nop 1
  buffer_store_dwordx4 v[80:83], v249, s[52:55], 0 offen offset:0 sc1
  v_fmac_f32 v112, v16, v128
  v_fmac_f32 v113, v17, v129
  v_fmac_f32 v114, v18, v130
  v_fmac_f32 v115, v19, v131
  v_fmac_f32 v116, v20, v132
  v_fmac_f32 v117, v21, v133
  v_fmac_f32 v118, v22, v134
  v_fmac_f32 v119, v23, v135
  v_cvt_pk_bf16_f32 v88, v112, v113
  v_cvt_pk_bf16_f32 v89, v114, v115
  v_cvt_pk_bf16_f32 v90, v116, v117
  v_cvt_pk_bf16_f32 v91, v118, v119
  s_nop 0
  v_permlane16_swap_b32 v88, v90
  v_permlane16_swap_b32 v89, v91
  s_nop 1
  buffer_store_dwordx4 v[88:91], v249, s[52:55], s38 offen offset:0 sc1
  v_pk_fma_f32 v[104:105], v[8:9], v[136:137], v[104:105]
  v_pk_fma_f32 v[106:107], v[10:11], v[138:139], v[106:107]
  v_pk_fma_f32 v[108:109], v[12:13], v[140:141], v[108:109]
  v_pk_fma_f32 v[110:111], v[14:15], v[142:143], v[110:111]
  v_cvt_pk_bf16_f32 v84, v104, v105
  v_cvt_pk_bf16_f32 v85, v106, v107
  v_cvt_pk_bf16_f32 v86, v108, v109
  v_cvt_pk_bf16_f32 v87, v110, v111
  s_nop 0
  v_permlane16_swap_b32 v84, v86
  v_permlane16_swap_b32 v85, v87
  s_nop 1
  buffer_store_dwordx4 v[84:87], v249, s[52:55], 0 offen offset:64 sc1
  v_pk_fma_f32 v[120:121], v[24:25], v[136:137], v[120:121]
  v_pk_fma_f32 v[122:123], v[26:27], v[138:139], v[122:123]
  v_pk_fma_f32 v[124:125], v[28:29], v[140:141], v[124:125]
  v_pk_fma_f32 v[126:127], v[30:31], v[142:143], v[126:127]
  v_cvt_pk_bf16_f32 v92, v120, v121
  v_cvt_pk_bf16_f32 v93, v122, v123
  v_cvt_pk_bf16_f32 v94, v124, v125
  v_cvt_pk_bf16_f32 v95, v126, v127
  s_nop 0
  v_permlane16_swap_b32 v92, v94
  v_permlane16_swap_b32 v93, v95
  s_nop 1
  buffer_store_dwordx4 v[92:95], v249, s[52:55], s38 offen offset:64 sc1
L_hot_end:
  s_endpgm
L_slow_13:
  s_mov_b32 s33, 262144
L_spin_54:
  buffer_load_dword v244, v189, s[4:7], 0 offen sc1
  s_waitcnt vmcnt(0)
  v_subrev_u32 v244, s100, v244
  v_subrev_u32 v244, 1, v244
  v_cmp_lt_u32 s[68:69], 6, v244
  s_nop 1
  s_cmp_eq_u64 s[68:69], 0
  s_cbranch_scc1 L_back_14
  s_sub_u32 s33, s33, 1
  s_cmp_lg_u32 s33, 0
  s_cbranch_scc1 L_spin_54
  s_branch L_back_14
L_slow_15:
  s_mov_b32 s33, 262144
L_spin_55:
  buffer_load_dword v244, v243, s[4:7], s88 offen sc1
  s_waitcnt vmcnt(0)
  v_subrev_u32 v244, s100, v244
  v_cmp_lt_u32 s[68:69], 7, v244
  s_nop 1
  s_cmp_eq_u64 s[68:69], 0
  s_cbranch_scc1 L_back_16
  s_sub_u32 s33, s33, 1
  s_cmp_lg_u32 s33, 0
  s_cbranch_scc1 L_spin_55
  s_branch L_back_16
L_slow_17:
  s_mov_b32 s33, 262144
L_spin_56:
  buffer_load_dword v244, v243, s[4:7], s88 offen sc1
  s_waitcnt vmcnt(0)
  v_subrev_u32 v244, s100, v244
  v_subrev_u32 v244, 1, v244
  v_cmp_lt_u32 s[68:69], 6, v244
  s_nop 1
  s_cmp_eq_u64 s[68:69], 0
  s_cbranch_scc1 L_back_18
  s_sub_u32 s33, s33, 1
  s_cmp_lg_u32 s33, 0
  s_cbranch_scc1 L_spin_56
  s_branch L_back_18
L_slow_19:
  s_mov_b32 s33, 262144
L_spin_57:
  buffer_load_dword v244, v192, s[4:7], s89 offen sc1
  s_waitcnt vmcnt(0)
  v_subrev_u32 v244, s100, v244
  v_cmp_lt_u32 s[68:69], 7, v244
  s_nop 1
  s_cmp_eq_u64 s[68:69], 0
  s_cbranch_scc1 L_back_20
  s_sub_u32 s33, s33, 1
  s_cmp_lg_u32 s33, 0
  s_cbranch_scc1 L_spin_57
  s_branch L_back_20
L_slow_21:
  s_mov_b32 s33, 262144
L_spin_58:
  buffer_load_dwordx4 v[160:163], v182, s[4:7], 0 offen offset:0 sc1
  buffer_load_dwordx4 v[164:167], v182, s[4:7], 0 offen offset:1024 sc1
  buffer_load_dwordx4 v[168:171], v182, s[4:7], 0 offen offset:2048 sc1
  buffer_load_dwordx4 v[172:175], v182, s[4:7], 0 offen offset:3072 sc1
  s_waitcnt vmcnt(0)
  v_xor_b32 v196, v183, v161
  v_bitop3_b32 v196, v163, v183, v196 bitop3:0xbe
  v_bitop3_b32 v196, v165, v183, v196 bitop3:0xbe
  v_bitop3_b32 v196, v167, v183, v196 bitop3:0xbe
  v_bitop3_b32 v196, v169, v183, v196 bitop3:0xbe
  v_bitop3_b32 v196, v171, v183, v196 bitop3:0xbe
  v_bitop3_b32 v196, v173, v183, v196 bitop3:0xbe
  v_bitop3_b32 v196, v175, v183, v196 bitop3:0xbe
  v_cmp_ne_u32 s[0:1], 0, v196
  s_nop 1
  s_cmp_eq_u64 s[0:1], 0
  s_cbranch_scc1 L_back_22
  s_sub_u32 s33, s33, 1
  s_cmp_lg_u32 s33, 0
  s_cbranch_scc1 L_spin_58
  s_branch L_back_22
L_slow_23:
  s_mov_b32 s33, 262144
L_spin_59:
  buffer_load_dwordx4 v[160:163], v182, s[4:7], 0 offen offset:0 sc1
  buffer_load_dwordx4 v[164:167], v182, s[4:7], 0 offen offset:1024 sc1
  buffer_load_dwordx4 v[168:171], v182, s[4:7], 0 offen offset:2048 sc1
  buffer_load_dwordx4 v[172:175], v182, s[4:7], 0 offen offset:3072 sc1
  s_waitcnt vmcnt(0)
  v_xor_b32 v196, v183, v161
  v_bitop3_b32 v196, v163, v183, v196 bitop3:0xbe
  v_bitop3_b32 v196, v165, v183, v196 bitop3:0xbe
  v_bitop3_b32 v196, v167, v183, v196 bitop3:0xbe
  v_bitop3_b32 v196, v169, v183, v196 bitop3:0xbe
  v_bitop3_b32 v196, v171, v183, v196 bitop3:0xbe
  v_bitop3_b32 v196, v173, v183, v196 bitop3:0xbe
  v_bitop3_b32 v196, v175, v183, v196 bitop3:0xbe
  v_cmp_ne_u32 s[0:1], 0, v196
  s_nop 1
  s_cmp_eq_u64 s[0:1], 0
  s_cbranch_scc1 L_back_24
  s_sub_u32 s33, s33, 1
  s_cmp_lg_u32 s33, 0
  s_cbranch_scc1 L_spin_59
  s_branch L_back_24
L_slow_26:
  s_mov_b32 s33, 262144
L_spin_60:
  buffer_load_dwordx4 v[96:99], v210, s[4:7], s101 offen sc1
  s_waitcnt vmcnt(0)
  v_xor_b32 v96, s84, v96
  v_xor_b32 v97, s85, v97
  v_or_b32 v100, v96, v97
  v_xor_b32 v98, s86, v98
  v_xor_b32 v99, s87, v99
  v_or3_b32 v100, v100, v98, v99
  v_and_b32 v100, 0xff, v100
  v_cmp_ne_u32 s[24:25], 0, v100
  s_nop 1
  s_cmp_eq_u64 s[24:25], 0
  s_cbranch_scc1 L_back_27
  s_sub_u32 s33, s33, 1
  s_cmp_lg_u32 s33, 0
  s_cbranch_scc1 L_spin_60
  s_branch L_back_27
L_slow_37:
  s_mov_b32 s33, 262144
L_spin_61:
  s_mov_b32 s30, 9437184
  buffer_load_dwordx4 v[128:131], v225, s[4:7], s30 offen offset:1024 sc1
  buffer_load_dwordx4 v[132:135], v225, s[4:7], s30 offen offset:3072 sc1
  s_mov_b32 s30, 9568256
  buffer_load_dwordx4 v[136:139], v225, s[4:7], s30 offen offset:1024 sc1
  buffer_load_dwordx4 v[140:143], v225, s[4:7], s30 offen offset:3072 sc1
  s_mov_b32 s30, 9699328
  buffer_load_dwordx4 v[144:147], v225, s[4:7], s30 offen offset:1024 sc1
  buffer_load_dwordx4 v[148:151], v225, s[4:7], s30 offen offset:3072 sc1
  s_mov_b32 s30, 9830400
  buffer_load_dwordx4 v[152:155], v225, s[4:7], s30 offen offset:1024 sc1
  buffer_load_dwordx4 v[156:159], v225, s[4:7], s30 offen offset:3072 sc1
  s_waitcnt vmcnt(0)
  v_max3_u32 v244, v128, v129, v130
  v_max_u32 v244, v244, v131
  v_max3_u32 v244, v244, v132, v133
  v_max3_u32 v244, v244, v134, v135
  v_max3_u32 v244, v244, v136, v137
  v_max3_u32 v244, v244, v138, v139
  v_max3_u32 v244, v244, v140, v141
  v_max3_u32 v244, v244, v142, v143
  v_max3_u32 v244, v244, v144, v145
  v_max3_u32 v244, v244, v146, v147
  v_max3_u32 v244, v244, v148, v149
  v_max3_u32 v244, v244, v150, v151
  v_max3_u32 v244, v244, v152, v153
  v_max3_u32 v244, v244, v154, v155
  v_max3_u32 v244, v244, v156, v157
  v_max3_u32 v244, v244, v158, v159
  v_cmp_eq_u32 s[68:69], -1, v244
  s_nop 1
  s_cmp_eq_u64 s[68:69], 0
  s_cbranch_scc1 L_back_38
  s_sub_u32 s33, s33, 1
  s_cmp_lg_u32 s33, 0
  s_cbranch_scc1 L_spin_61
  s_branch L_back_38
L_slow_39:
  s_mov_b32 s33, 262144
L_spin_62:
  buffer_load_dword v244, v254, s[4:7], s93 offen sc1
  s_waitcnt vmcnt(0)
  v_subrev_u32 v244, s100, v244
  v_cmp_lt_u32 s[68:69], 7, v244
  s_nop 1
  s_cmp_eq_u64 s[68:69], 0
  s_cbranch_scc1 L_back_40
  s_sub_u32 s33, s33, 1
  s_cmp_lg_u32 s33, 0
  s_cbranch_scc1 L_spin_62
  s_branch L_back_40
L_slow_41:
  s_mov_b32 s33, 262144
L_spin_63:
  buffer_load_dword v244, v254, s[4:7], s32 offen sc1
  s_waitcnt vmcnt(0)
  v_subrev_u32 v244, s100, v244
  v_cmp_lt_u32 s[68:69], 7, v244
  s_nop 1
  s_cmp_eq_u64 s[68:69], 0
  s_cbranch_scc1 L_back_42
  s_sub_u32 s33, s33, 1
  s_cmp_lg_u32 s33, 0
  s_cbranch_scc1 L_spin_63
  s_branch L_back_42
L_slow_44:
  s_mov_b32 s33, 262144
L_spin_64:
  buffer_load_dword v244, v243, s[4:7], s91 offen sc1
  s_waitcnt vmcnt(0)
  v_subrev_u32 v244, s100, v244
  v_cmp_lt_u32 s[68:69], 7, v244
  s_nop 1
  s_cmp_eq_u64 s[68:69], 0
  s_cbranch_scc1 L_back_45
  s_sub_u32 s33, s33, 1
  s_cmp_lg_u32 s33, 0
  s_cbranch_scc1 L_spin_64
  s_branch L_back_45
L_slow_46:
  s_mov_b32 s33, 262144
L_spin_65:
  buffer_load_dword v244, v243, s[4:7], s91 offen sc1
  s_waitcnt vmcnt(0)
  v_subrev_u32 v244, s100, v244
  v_subrev_u32 v244, 1, v244
  v_cmp_lt_u32 s[68:69], 6, v244
  s_nop 1
  s_cmp_eq_u64 s[68:69], 0
  s_cbranch_scc1 L_back_47
  s_sub_u32 s33, s33, 1
  s_cmp_lg_u32 s33, 0
  s_cbranch_scc1 L_spin_65
  s_branch L_back_47
L_slow_48:
  s_mov_b32 s33, 262144
L_spin_66:
  buffer_load_dword v244, v243, s[4:7], s91 offen sc1
  s_waitcnt vmcnt(0)
  v_subrev_u32 v244, s100, v244
  v_subrev_u32 v244, 2, v244
  v_cmp_lt_u32 s[68:69], 5, v244
  s_nop 1
  s_cmp_eq_u64 s[68:69], 0
  s_cbranch_scc1 L_back_49
  s_sub_u32 s33, s33, 1
  s_cmp_lg_u32 s33, 0
  s_cbranch_scc1 L_spin_66
  s_branch L_back_49
L_slow_50:
  s_mov_b32 s33, 262144
L_spin_67:
  buffer_load_dword v244, v243, s[4:7], s91 offen sc1
  s_waitcnt vmcnt(0)
  v_subrev_u32 v244, s100, v244
  v_subrev_u32 v244, 3, v244
  v_cmp_lt_u32 s[68:69], 4, v244
  s_nop 1
  s_cmp_eq_u64 s[68:69], 0
  s_cbranch_scc1 L_back_51
  s_sub_u32 s33, s33, 1
  s_cmp_lg_u32 s33, 0
  s_cbranch_scc1 L_spin_67
  s_branch L_back_51
L_slow_52:
  s_mov_b32 s33, 262144
L_spin_68:
  buffer_load_dwordx4 v[64:67], v251, s[4:7], s96 offen offset:0 sc1
  buffer_load_dwordx4 v[68:71], v251, s[4:7], s96 offen offset:1024 sc1
  buffer_load_dwordx4 v[72:75], v251, s[4:7], s96 offen offset:2048 sc1
  buffer_load_dwordx4 v[76:79], v251, s[4:7], s96 offen offset:3072 sc1
  s_waitcnt vmcnt(0)
  v_max3_u32 v244, v64, v65, v66
  v_max3_u32 v244, v244, v67, v68
  v_max3_u32 v244, v244, v69, v70
  v_max3_u32 v244, v244, v71, v72
  v_max3_u32 v244, v244, v73, v74
  v_max3_u32 v244, v244, v75, v76
  v_max3_u32 v244, v244, v77, v78
  v_max_u32 v244, v244, v79
  v_cmp_eq_u32 s[68:69], -1, v244
  s_nop 1
  s_cmp_eq_u64 s[68:69], 0
  s_cbranch_scc1 L_back_53
  s_sub_u32 s33, s33, 1
  s_cmp_lg_u32 s33, 0
  s_cbranch_scc1 L_spin_68
  s_branch L_back_53
L_end_1:
  s_endpgm
L_code_end:
  s_endpgm
.section .rodata,"a"
.p2align 6
.amdhsa_kernel adaLN_cond__sliding_local_dilated__glu_gated_glu__prompt_kernel
  .amdhsa_next_free_vgpr 512
  .amdhsa_next_free_sgpr 102
  .amdhsa_accum_offset 256
  .amdhsa_group_segment_fixed_size 0
  .amdhsa_kernarg_size 96
  .amdhsa_user_sgpr_count 2
  .amdhsa_user_sgpr_kernarg_segment_ptr 1
  .amdhsa_system_sgpr_workgroup_id_x 1
  .amdhsa_float_denorm_mode_32 3
.end_amdhsa_kernel
```
